```python
import torch

def _softmax(x, axis=-1):
    return torch.softmax(x, dim=axis)
def _gelu(x):
    return torch.nn.functional.gelu(x, approximate="tanh")
def _silu(x):
    return torch.nn.functional.silu(x)
def _sigmoid(x):
    return torch.sigmoid(x)
def _layernorm(x, axis=-1, eps=1e-5):
    m = x.mean(dim=axis, keepdim=True)
    v = x.var(dim=axis, keepdim=True, unbiased=False)
    return (x - m) / torch.sqrt(v + eps)
def _scatter_add(tgt, idx, src, axis=0):
    return tgt.clone().index_add_(axis, idx, src)
def _segment_sum(src, seg, n):
    out = torch.zeros((n,) + src.shape[1:], dtype=src.dtype)
    return out.index_add_(0, seg, src)
def _pad(x, pw):
    flat = tuple(v for pair in reversed(pw) for v in pair)
    return torch.nn.functional.pad(x, flat)

kernel_name = 'standalone__kv_cache_quant_int4_int2_kv_with_per_channel_or_per_token_scales__decode'

def setup_inputs():

    _w = (lambda a: (lambda t: t.to(torch.bfloat16) if t.is_floating_point() else t)(torch.as_tensor(a)))
    B = 1
    Sq = 1
    Skv = 32768
    Hq = 32
    Hkv = 32
    Dh = 192
    bits = 4
    G = 64
    if G <= 0 or G >= Skv:
        G = max(1, Skv // 2)
    Skv = (Skv // G) * G
    ngk = Skv // G
    qmax = (1 << bits) - 1
    return {
        "q": _w((lambda *s: torch.randn(*s, dtype=torch.bfloat16) * 1.6)(B, Hq, Sq, Dh)),
        "qk": _w(torch.randint(0, qmax + 1, (B, Hkv, Skv, Dh)).to(torch.int32)),
        "qv": _w(torch.randint(0, qmax + 1, (B, Hkv, Skv, Dh)).to(torch.int32)),
        "k_scales": _w(torch.abs((lambda *s: torch.randn(*s, dtype=torch.bfloat16) * 1.6)(B, Hkv, ngk, Dh)) * 0.05 + 0.02),
        "k_zeros": _w((lambda *s: torch.randn(*s, dtype=torch.bfloat16) * 1.6)(B, Hkv, ngk, Dh) + float(qmax) / 2.0),
        "v_scales": _w(torch.abs((lambda *s: torch.randn(*s, dtype=torch.bfloat16) * 0.05)(B, Hkv, Skv, 1)) * 0.05 + 0.02),
        "v_zeros": _w((lambda *s: torch.randn(*s, dtype=torch.bfloat16) * 0.05)(B, Hkv, Skv, 1) + float(qmax) / 2.0),
    }

def reference(q, qk, qv, k_scales, k_zeros, v_scales, v_zeros):
    B, Hq, Sq, Dh = q.shape
    Hkv, Skv = qk.shape[1], qk.shape[2]
    ngk = k_scales.shape[2]
    G = Skv // ngk
    ks = (lambda x, n, axis: torch.repeat_interleave(x, n, dim=axis))(k_scales, G, axis=2)
    kz = (lambda x, n, axis: torch.repeat_interleave(x, n, dim=axis))(k_zeros, G, axis=2)
    k = ((lambda x, dt: x.to(dt))(qk, q.dtype) - kz) * ks
    v = ((lambda x, dt: x.to(dt))(qv, q.dtype) - v_zeros) * v_scales
    rep = Hq // Hkv
    if rep > 1:
        k = (lambda x, n, axis: torch.repeat_interleave(x, n, dim=axis))(k, rep, axis=1)
        v = (lambda x, n, axis: torch.repeat_interleave(x, n, dim=axis))(v, rep, axis=1)
    scale = float(Dh) ** -0.5
    logits = torch.einsum("bhqd,bhkd->bhqk", q, k) * scale
    p = _softmax(logits, axis=-1)
    o = torch.einsum("bhqk,bhkd->bhqd", p, v)
    return o
```

```asm
; @launch kernel=part_kernel grid=(1024,1,1) block=(256,1,1) lds=12416
; @launch kernel=standalone__kv_cache_quant_int4_int2_kv_with_per_channel_or_per_token_scales__decode_kernel grid=(32,1,1) block=(192,1,1) lds=0
.amdgcn_target "amdgcn-amd-amdhsa--gfx950"
.text
.globl part_kernel
.p2align 8
.type part_kernel,@function
part_kernel:
    s_cmp_ge_u32 s2, 1024
    s_cbranch_scc1 L_exit1
    s_mov_b32 s54, s2
    s_load_dwordx16 s[64:79], s[0:1], 0
    s_load_dwordx4 s[80:83], s[0:1], 64
    v_lshrrev_b32 v10, 6, v0
    v_and_b32 v11, 63, v0
    v_readfirstlane_b32 s42, v10
    v_lshrrev_b32 v10, 4, v11
    v_and_b32 v11, 15, v11
    v_mul_u32_u24 v1, 768, v10
    v_lshl_add_u32 v1, v11, 4, v1
    v_lshlrev_b32 v2, 3, v11
    v_lshl_add_u32 v3, v11, 2, v10
    v_lshlrev_b32 v3, 1, v3
    s_lshr_b32 s40, s2, 5
    s_and_b32 s41, s2, 31
    s_mov_b32 s48, 0x3dd53b95
    s_mul_i32 s50, s41, 16
    s_add_u32 s51, s50, s42
    s_add_u32 s52, s50, 16
    s_mul_i32 s43, s51, 49152
    s_mov_b32 s44, s43
    s_mul_i32 s45, s51, 384
    s_mul_i32 s46, s51, 128
    s_waitcnt lgkmcnt(0)
    s_mul_i32 s53, s40, 384
    s_mul_hi_u32 s50, s40, 384
    s_add_u32 s32, s64, s53
    s_addc_u32 s33, s65, s50
    s_and_b32 s33, s33, 0xffff
    s_mov_b32 s34, 384
    s_mov_b32 s35, 0x00020000
    s_mul_i32 s53, s40, 25165824
    s_mul_hi_u32 s50, s40, 25165824
    s_add_u32 s8, s66, s53
    s_addc_u32 s9, s67, s50
    s_and_b32 s9, s9, 0xffff
    s_mul_i32 s10, s52, 49152
    s_mov_b32 s11, 0x00020000
    s_mul_i32 s53, s40, 25165824
    s_mul_hi_u32 s50, s40, 25165824
    s_add_u32 s12, s68, s53
    s_addc_u32 s13, s69, s50
    s_and_b32 s13, s13, 0xffff
    s_mul_i32 s14, s52, 49152
    s_mov_b32 s15, 0x00020000
    s_mul_i32 s53, s40, 196608
    s_mul_hi_u32 s50, s40, 196608
    s_add_u32 s16, s70, s53
    s_addc_u32 s17, s71, s50
    s_and_b32 s17, s17, 0xffff
    s_mul_i32 s18, s52, 384
    s_mov_b32 s19, 0x00020000
    s_mul_i32 s53, s40, 196608
    s_mul_hi_u32 s50, s40, 196608
    s_add_u32 s20, s72, s53
    s_addc_u32 s21, s73, s50
    s_and_b32 s21, s21, 0xffff
    s_mul_i32 s22, s52, 384
    s_mov_b32 s23, 0x00020000
    s_mul_i32 s53, s40, 65536
    s_mul_hi_u32 s50, s40, 65536
    s_add_u32 s24, s74, s53
    s_addc_u32 s25, s75, s50
    s_and_b32 s25, s25, 0xffff
    s_mul_i32 s26, s52, 128
    s_mov_b32 s27, 0x00020000
    s_mul_i32 s53, s40, 65536
    s_mul_hi_u32 s50, s40, 65536
    s_add_u32 s28, s76, s53
    s_addc_u32 s29, s77, s50
    s_and_b32 s29, s29, 0xffff
    s_mul_i32 s30, s52, 128
    s_mov_b32 s31, 0x00020000
    s_mov_b32 s36, s82
    s_and_b32 s37, s83, 0xffff
    s_mov_b32 s38, 1048576
    s_mov_b32 s39, 0x00020000
    v_mov_b32 v4, 0xff7fffff
    v_mov_b32 v5, 0
    v_mov_b32 v6, 0
    v_mov_b32 v8, 0
    v_mov_b32 v9, 0
    v_mov_b32 v12, 0
    v_mov_b32 v13, 0
    v_mov_b32 v14, 0
    v_mov_b32 v15, 0
    v_mov_b32 v16, 0
    v_mov_b32 v17, 0
    v_mov_b32 v18, 0
    v_mov_b32 v19, 0
    v_mov_b32 v20, 0
    v_mov_b32 v21, 0
    v_mov_b32 v22, 0
    v_mov_b32 v23, 0
    buffer_load_dwordx2 v[48:49], v2, s[32:35], 0 offen offset:0
    buffer_load_dwordx2 v[50:51], v2, s[32:35], 0 offen offset:128
    buffer_load_dwordx2 v[52:53], v2, s[32:35], 0 offen offset:256
    buffer_load_dwordx2 v[64:65], v2, s[16:19], s45 offen offset:0
    buffer_load_dwordx2 v[66:67], v2, s[16:19], s45 offen offset:128
    buffer_load_dwordx2 v[68:69], v2, s[16:19], s45 offen offset:256
    buffer_load_dwordx2 v[70:71], v2, s[20:23], s45 offen offset:0
    buffer_load_dwordx2 v[72:73], v2, s[20:23], s45 offen offset:128
    buffer_load_dwordx2 v[74:75], v2, s[20:23], s45 offen offset:256
    buffer_load_ushort v8, v3, s[24:27], s46 offen
    buffer_load_ushort v9, v3, s[28:31], s46 offen
    s_add_u32 s45, s45, 1536
    s_add_u32 s46, s46, 512
    buffer_load_dwordx4 v[76:79], v1, s[8:11], s43 offen offset:0 nt
    buffer_load_dwordx4 v[80:83], v1, s[8:11], s43 offen offset:256 nt
    buffer_load_dwordx4 v[84:87], v1, s[8:11], s43 offen offset:512 nt
    buffer_load_dwordx4 v[88:91], v1, s[8:11], s43 offen offset:3072 nt
    buffer_load_dwordx4 v[92:95], v1, s[8:11], s43 offen offset:3328 nt
    buffer_load_dwordx4 v[96:99], v1, s[8:11], s43 offen offset:3584 nt
    s_add_u32 s43, s43, 6144
    buffer_load_dwordx4 v[100:103], v1, s[8:11], s43 offen offset:0 nt
    buffer_load_dwordx4 v[104:107], v1, s[8:11], s43 offen offset:256 nt
    buffer_load_dwordx4 v[108:111], v1, s[8:11], s43 offen offset:512 nt
    buffer_load_dwordx4 v[112:115], v1, s[8:11], s43 offen offset:3072 nt
    buffer_load_dwordx4 v[116:119], v1, s[8:11], s43 offen offset:3328 nt
    buffer_load_dwordx4 v[120:123], v1, s[8:11], s43 offen offset:3584 nt
    s_add_u32 s43, s43, 6144
    s_waitcnt vmcnt(20)
    v_lshlrev_b32 v24, 16, v48
    v_and_b32 v25, 0xffff0000, v48
    v_lshlrev_b32 v26, 16, v49
    v_and_b32 v27, 0xffff0000, v49
    v_lshlrev_b32 v28, 16, v50
    v_and_b32 v29, 0xffff0000, v50
    v_lshlrev_b32 v30, 16, v51
    v_and_b32 v31, 0xffff0000, v51
    v_lshlrev_b32 v32, 16, v52
    v_and_b32 v33, 0xffff0000, v52
    v_lshlrev_b32 v34, 16, v53
    v_and_b32 v35, 0xffff0000, v53
    v_mul_f32 v24, s48, v24
    v_mul_f32 v25, s48, v25
    v_mul_f32 v26, s48, v26
    v_mul_f32 v27, s48, v27
    v_mul_f32 v28, s48, v28
    v_mul_f32 v29, s48, v29
    v_mul_f32 v30, s48, v30
    v_mul_f32 v31, s48, v31
    v_mul_f32 v32, s48, v32
    v_mul_f32 v33, s48, v33
    v_mul_f32 v34, s48, v34
    v_mul_f32 v35, s48, v35
    s_waitcnt vmcnt(14)
    v_lshlrev_b32 v36, 16, v64
    v_and_b32 v37, 0xffff0000, v64
    v_lshlrev_b32 v38, 16, v65
    v_and_b32 v39, 0xffff0000, v65
    v_lshlrev_b32 v40, 16, v66
    v_and_b32 v41, 0xffff0000, v66
    v_lshlrev_b32 v42, 16, v67
    v_and_b32 v43, 0xffff0000, v67
    v_lshlrev_b32 v44, 16, v68
    v_and_b32 v45, 0xffff0000, v68
    v_lshlrev_b32 v46, 16, v69
    v_and_b32 v47, 0xffff0000, v69
    v_mul_f32 v36, v36, v24
    v_mul_f32 v37, v37, v25
    v_mul_f32 v38, v38, v26
    v_mul_f32 v39, v39, v27
    v_mul_f32 v40, v40, v28
    v_mul_f32 v41, v41, v29
    v_mul_f32 v42, v42, v30
    v_mul_f32 v43, v43, v31
    v_mul_f32 v44, v44, v32
    v_mul_f32 v45, v45, v33
    v_mul_f32 v46, v46, v34
    v_mul_f32 v47, v47, v35
    v_lshlrev_b32 v10, 16, v70
    v_and_b32 v11, 0xffff0000, v70
    v_mul_f32 v7, v10, v36
    v_fmac_f32 v7, v11, v37
    v_lshlrev_b32 v10, 16, v71
    v_and_b32 v11, 0xffff0000, v71
    v_fmac_f32 v7, v10, v38
    v_fmac_f32 v7, v11, v39
    v_lshlrev_b32 v10, 16, v72
    v_and_b32 v11, 0xffff0000, v72
    v_fmac_f32 v7, v10, v40
    v_fmac_f32 v7, v11, v41
    v_lshlrev_b32 v10, 16, v73
    v_and_b32 v11, 0xffff0000, v73
    v_fmac_f32 v7, v10, v42
    v_fmac_f32 v7, v11, v43
    v_lshlrev_b32 v10, 16, v74
    v_and_b32 v11, 0xffff0000, v74
    v_fmac_f32 v7, v10, v44
    v_fmac_f32 v7, v11, v45
    v_lshlrev_b32 v10, 16, v75
    v_and_b32 v11, 0xffff0000, v75
    v_fmac_f32 v7, v10, v46
    v_fmac_f32 v7, v11, v47
    v_sub_f32 v7, 0, v7
    s_mov_b32 s47, 4
.p2align 6
L_loop:
    s_waitcnt vmcnt(9)
    v_cvt_f32_i32 v76, v76
    v_cvt_f32_i32 v77, v77
    v_cvt_f32_i32 v78, v78
    v_cvt_f32_i32 v79, v79
    v_cvt_f32_i32 v80, v80
    v_cvt_f32_i32 v81, v81
    v_cvt_f32_i32 v82, v82
    v_cvt_f32_i32 v83, v83
    v_cvt_f32_i32 v84, v84
    v_cvt_f32_i32 v85, v85
    v_cvt_f32_i32 v86, v86
    v_cvt_f32_i32 v87, v87
    v_fma_f32 v48, v76, v36, v7
    v_mul_f32 v10, v77, v37
    v_fmac_f32 v48, v78, v38
    v_fmac_f32 v10, v79, v39
    v_fmac_f32 v48, v80, v40
    v_fmac_f32 v10, v81, v41
    v_fmac_f32 v48, v82, v42
    v_fmac_f32 v10, v83, v43
    v_fmac_f32 v48, v84, v44
    v_fmac_f32 v10, v85, v45
    v_fmac_f32 v48, v86, v46
    v_fmac_f32 v10, v87, v47
    v_add_f32 v48, v48, v10
    buffer_load_dwordx4 v[76:79], v1, s[8:11], s43 offen offset:0 nt
    buffer_load_dwordx4 v[80:83], v1, s[8:11], s43 offen offset:256 nt
    buffer_load_dwordx4 v[84:87], v1, s[8:11], s43 offen offset:512 nt
    s_waitcnt vmcnt(9)
    v_cvt_f32_i32 v88, v88
    v_cvt_f32_i32 v89, v89
    v_cvt_f32_i32 v90, v90
    v_add_f32_dpp v48, v48, v48 row_ror:8 row_mask:0xf bank_mask:0xf
    v_cvt_f32_i32 v91, v91
    v_cvt_f32_i32 v92, v92
    v_cvt_f32_i32 v93, v93
    v_add_f32_dpp v48, v48, v48 row_ror:4 row_mask:0xf bank_mask:0xf
    v_cvt_f32_i32 v94, v94
    v_cvt_f32_i32 v95, v95
    v_cvt_f32_i32 v96, v96
    v_add_f32_dpp v48, v48, v48 row_ror:2 row_mask:0xf bank_mask:0xf
    v_cvt_f32_i32 v97, v97
    v_cvt_f32_i32 v98, v98
    v_cvt_f32_i32 v99, v99
    v_add_f32_dpp v48, v48, v48 row_ror:1 row_mask:0xf bank_mask:0xf
    v_fma_f32 v49, v88, v36, v7
    v_mul_f32 v10, v89, v37
    v_fmac_f32 v49, v90, v38
    v_fmac_f32 v10, v91, v39
    v_fmac_f32 v49, v92, v40
    v_fmac_f32 v10, v93, v41
    v_fmac_f32 v49, v94, v42
    v_fmac_f32 v10, v95, v43
    v_fmac_f32 v49, v96, v44
    v_fmac_f32 v10, v97, v45
    v_fmac_f32 v49, v98, v46
    v_fmac_f32 v10, v99, v47
    v_add_f32 v49, v49, v10
    buffer_load_dwordx4 v[88:91], v1, s[8:11], s43 offen offset:3072 nt
    buffer_load_dwordx4 v[92:95], v1, s[8:11], s43 offen offset:3328 nt
    buffer_load_dwordx4 v[96:99], v1, s[8:11], s43 offen offset:3584 nt
    s_add_u32 s43, s43, 6144
    s_waitcnt vmcnt(9)
    v_cvt_f32_i32 v100, v100
    v_cvt_f32_i32 v101, v101
    v_cvt_f32_i32 v102, v102
    v_add_f32_dpp v49, v49, v49 row_ror:8 row_mask:0xf bank_mask:0xf
    v_cvt_f32_i32 v103, v103
    v_cvt_f32_i32 v104, v104
    v_cvt_f32_i32 v105, v105
    v_add_f32_dpp v49, v49, v49 row_ror:4 row_mask:0xf bank_mask:0xf
    v_cvt_f32_i32 v106, v106
    v_cvt_f32_i32 v107, v107
    v_cvt_f32_i32 v108, v108
    v_add_f32_dpp v49, v49, v49 row_ror:2 row_mask:0xf bank_mask:0xf
    v_cvt_f32_i32 v109, v109
    v_cvt_f32_i32 v110, v110
    v_cvt_f32_i32 v111, v111
    v_add_f32_dpp v49, v49, v49 row_ror:1 row_mask:0xf bank_mask:0xf
    v_fma_f32 v50, v100, v36, v7
    v_mul_f32 v10, v101, v37
    v_fmac_f32 v50, v102, v38
    v_fmac_f32 v10, v103, v39
    v_fmac_f32 v50, v104, v40
    v_fmac_f32 v10, v105, v41
    v_fmac_f32 v50, v106, v42
    v_fmac_f32 v10, v107, v43
    v_fmac_f32 v50, v108, v44
    v_fmac_f32 v10, v109, v45
    v_fmac_f32 v50, v110, v46
    v_fmac_f32 v10, v111, v47
    v_add_f32 v50, v50, v10
    buffer_load_dwordx4 v[100:103], v1, s[8:11], s43 offen offset:0 nt
    buffer_load_dwordx4 v[104:107], v1, s[8:11], s43 offen offset:256 nt
    buffer_load_dwordx4 v[108:111], v1, s[8:11], s43 offen offset:512 nt
    s_waitcnt vmcnt(9)
    v_cvt_f32_i32 v112, v112
    v_cvt_f32_i32 v113, v113
    v_cvt_f32_i32 v114, v114
    v_add_f32_dpp v50, v50, v50 row_ror:8 row_mask:0xf bank_mask:0xf
    v_cvt_f32_i32 v115, v115
    v_cvt_f32_i32 v116, v116
    v_cvt_f32_i32 v117, v117
    v_add_f32_dpp v50, v50, v50 row_ror:4 row_mask:0xf bank_mask:0xf
    v_cvt_f32_i32 v118, v118
    v_cvt_f32_i32 v119, v119
    v_cvt_f32_i32 v120, v120
    v_add_f32_dpp v50, v50, v50 row_ror:2 row_mask:0xf bank_mask:0xf
    v_cvt_f32_i32 v121, v121
    v_cvt_f32_i32 v122, v122
    v_cvt_f32_i32 v123, v123
    v_add_f32_dpp v50, v50, v50 row_ror:1 row_mask:0xf bank_mask:0xf
    v_fma_f32 v51, v112, v36, v7
    v_mul_f32 v10, v113, v37
    v_fmac_f32 v51, v114, v38
    v_fmac_f32 v10, v115, v39
    v_fmac_f32 v51, v116, v40
    v_fmac_f32 v10, v117, v41
    v_fmac_f32 v51, v118, v42
    v_fmac_f32 v10, v119, v43
    v_fmac_f32 v51, v120, v44
    v_fmac_f32 v10, v121, v45
    v_fmac_f32 v51, v122, v46
    v_fmac_f32 v10, v123, v47
    v_add_f32 v51, v51, v10
    buffer_load_dwordx4 v[112:115], v1, s[8:11], s43 offen offset:3072 nt
    buffer_load_dwordx4 v[116:119], v1, s[8:11], s43 offen offset:3328 nt
    buffer_load_dwordx4 v[120:123], v1, s[8:11], s43 offen offset:3584 nt
    s_add_u32 s43, s43, 6144
    s_waitcnt vmcnt(9)
    v_cvt_f32_i32 v76, v76
    v_cvt_f32_i32 v77, v77
    v_cvt_f32_i32 v78, v78
    v_add_f32_dpp v51, v51, v51 row_ror:8 row_mask:0xf bank_mask:0xf
    v_cvt_f32_i32 v79, v79
    v_cvt_f32_i32 v80, v80
    v_cvt_f32_i32 v81, v81
    v_add_f32_dpp v51, v51, v51 row_ror:4 row_mask:0xf bank_mask:0xf
    v_cvt_f32_i32 v82, v82
    v_cvt_f32_i32 v83, v83
    v_cvt_f32_i32 v84, v84
    v_add_f32_dpp v51, v51, v51 row_ror:2 row_mask:0xf bank_mask:0xf
    v_cvt_f32_i32 v85, v85
    v_cvt_f32_i32 v86, v86
    v_cvt_f32_i32 v87, v87
    v_add_f32_dpp v51, v51, v51 row_ror:1 row_mask:0xf bank_mask:0xf
    v_fma_f32 v52, v76, v36, v7
    v_mul_f32 v10, v77, v37
    v_fmac_f32 v52, v78, v38
    v_fmac_f32 v10, v79, v39
    v_fmac_f32 v52, v80, v40
    v_fmac_f32 v10, v81, v41
    v_fmac_f32 v52, v82, v42
    v_fmac_f32 v10, v83, v43
    v_fmac_f32 v52, v84, v44
    v_fmac_f32 v10, v85, v45
    v_fmac_f32 v52, v86, v46
    v_fmac_f32 v10, v87, v47
    v_add_f32 v52, v52, v10
    buffer_load_dwordx4 v[76:79], v1, s[8:11], s43 offen offset:0 nt
    buffer_load_dwordx4 v[80:83], v1, s[8:11], s43 offen offset:256 nt
    buffer_load_dwordx4 v[84:87], v1, s[8:11], s43 offen offset:512 nt
    s_waitcnt vmcnt(9)
    v_cvt_f32_i32 v88, v88
    v_cvt_f32_i32 v89, v89
    v_cvt_f32_i32 v90, v90
    v_add_f32_dpp v52, v52, v52 row_ror:8 row_mask:0xf bank_mask:0xf
    v_cvt_f32_i32 v91, v91
    v_cvt_f32_i32 v92, v92
    v_cvt_f32_i32 v93, v93
    v_add_f32_dpp v52, v52, v52 row_ror:4 row_mask:0xf bank_mask:0xf
    v_cvt_f32_i32 v94, v94
    v_cvt_f32_i32 v95, v95
    v_cvt_f32_i32 v96, v96
    v_add_f32_dpp v52, v52, v52 row_ror:2 row_mask:0xf bank_mask:0xf
    v_cvt_f32_i32 v97, v97
    v_cvt_f32_i32 v98, v98
    v_cvt_f32_i32 v99, v99
    v_add_f32_dpp v52, v52, v52 row_ror:1 row_mask:0xf bank_mask:0xf
    v_fma_f32 v53, v88, v36, v7
    v_mul_f32 v10, v89, v37
    v_fmac_f32 v53, v90, v38
    v_fmac_f32 v10, v91, v39
    v_fmac_f32 v53, v92, v40
    v_fmac_f32 v10, v93, v41
    v_fmac_f32 v53, v94, v42
    v_fmac_f32 v10, v95, v43
    v_fmac_f32 v53, v96, v44
    v_fmac_f32 v10, v97, v45
    v_fmac_f32 v53, v98, v46
    v_fmac_f32 v10, v99, v47
    v_add_f32 v53, v53, v10
    buffer_load_dwordx4 v[88:91], v1, s[8:11], s43 offen offset:3072 nt
    buffer_load_dwordx4 v[92:95], v1, s[8:11], s43 offen offset:3328 nt
    buffer_load_dwordx4 v[96:99], v1, s[8:11], s43 offen offset:3584 nt
    s_add_u32 s43, s43, 6144
    s_waitcnt vmcnt(9)
    v_cvt_f32_i32 v100, v100
    v_cvt_f32_i32 v101, v101
    v_cvt_f32_i32 v102, v102
    v_add_f32_dpp v53, v53, v53 row_ror:8 row_mask:0xf bank_mask:0xf
    v_cvt_f32_i32 v103, v103
    v_cvt_f32_i32 v104, v104
    v_cvt_f32_i32 v105, v105
    v_add_f32_dpp v53, v53, v53 row_ror:4 row_mask:0xf bank_mask:0xf
    v_cvt_f32_i32 v106, v106
    v_cvt_f32_i32 v107, v107
    v_cvt_f32_i32 v108, v108
    v_add_f32_dpp v53, v53, v53 row_ror:2 row_mask:0xf bank_mask:0xf
    v_cvt_f32_i32 v109, v109
    v_cvt_f32_i32 v110, v110
    v_cvt_f32_i32 v111, v111
    v_add_f32_dpp v53, v53, v53 row_ror:1 row_mask:0xf bank_mask:0xf
    v_fma_f32 v54, v100, v36, v7
    v_mul_f32 v10, v101, v37
    v_fmac_f32 v54, v102, v38
    v_fmac_f32 v10, v103, v39
    v_fmac_f32 v54, v104, v40
    v_fmac_f32 v10, v105, v41
    v_fmac_f32 v54, v106, v42
    v_fmac_f32 v10, v107, v43
    v_fmac_f32 v54, v108, v44
    v_fmac_f32 v10, v109, v45
    v_fmac_f32 v54, v110, v46
    v_fmac_f32 v10, v111, v47
    v_add_f32 v54, v54, v10
    buffer_load_dwordx4 v[100:103], v1, s[8:11], s43 offen offset:0 nt
    buffer_load_dwordx4 v[104:107], v1, s[8:11], s43 offen offset:256 nt
    buffer_load_dwordx4 v[108:111], v1, s[8:11], s43 offen offset:512 nt
    s_waitcnt vmcnt(9)
    v_cvt_f32_i32 v112, v112
    v_cvt_f32_i32 v113, v113
    v_cvt_f32_i32 v114, v114
    v_add_f32_dpp v54, v54, v54 row_ror:8 row_mask:0xf bank_mask:0xf
    v_cvt_f32_i32 v115, v115
    v_cvt_f32_i32 v116, v116
    v_cvt_f32_i32 v117, v117
    v_add_f32_dpp v54, v54, v54 row_ror:4 row_mask:0xf bank_mask:0xf
    v_cvt_f32_i32 v118, v118
    v_cvt_f32_i32 v119, v119
    v_cvt_f32_i32 v120, v120
    v_add_f32_dpp v54, v54, v54 row_ror:2 row_mask:0xf bank_mask:0xf
    v_cvt_f32_i32 v121, v121
    v_cvt_f32_i32 v122, v122
    v_cvt_f32_i32 v123, v123
    v_add_f32_dpp v54, v54, v54 row_ror:1 row_mask:0xf bank_mask:0xf
    v_fma_f32 v55, v112, v36, v7
    v_mul_f32 v10, v113, v37
    v_fmac_f32 v55, v114, v38
    v_fmac_f32 v10, v115, v39
    v_fmac_f32 v55, v116, v40
    v_fmac_f32 v10, v117, v41
    v_fmac_f32 v55, v118, v42
    v_fmac_f32 v10, v119, v43
    v_fmac_f32 v55, v120, v44
    v_fmac_f32 v10, v121, v45
    v_fmac_f32 v55, v122, v46
    v_fmac_f32 v10, v123, v47
    v_add_f32 v55, v55, v10
    buffer_load_dwordx4 v[112:115], v1, s[8:11], s43 offen offset:3072 nt
    buffer_load_dwordx4 v[116:119], v1, s[8:11], s43 offen offset:3328 nt
    buffer_load_dwordx4 v[120:123], v1, s[8:11], s43 offen offset:3584 nt
    s_add_u32 s43, s43, 6144
    s_waitcnt vmcnt(9)
    v_cvt_f32_i32 v76, v76
    v_cvt_f32_i32 v77, v77
    v_cvt_f32_i32 v78, v78
    v_add_f32_dpp v55, v55, v55 row_ror:8 row_mask:0xf bank_mask:0xf
    v_cvt_f32_i32 v79, v79
    v_cvt_f32_i32 v80, v80
    v_cvt_f32_i32 v81, v81
    v_add_f32_dpp v55, v55, v55 row_ror:4 row_mask:0xf bank_mask:0xf
    v_cvt_f32_i32 v82, v82
    v_cvt_f32_i32 v83, v83
    v_cvt_f32_i32 v84, v84
    v_add_f32_dpp v55, v55, v55 row_ror:2 row_mask:0xf bank_mask:0xf
    v_cvt_f32_i32 v85, v85
    v_cvt_f32_i32 v86, v86
    v_cvt_f32_i32 v87, v87
    v_add_f32_dpp v55, v55, v55 row_ror:1 row_mask:0xf bank_mask:0xf
    v_fma_f32 v56, v76, v36, v7
    v_mul_f32 v10, v77, v37
    v_fmac_f32 v56, v78, v38
    v_fmac_f32 v10, v79, v39
    v_fmac_f32 v56, v80, v40
    v_fmac_f32 v10, v81, v41
    v_fmac_f32 v56, v82, v42
    v_fmac_f32 v10, v83, v43
    v_fmac_f32 v56, v84, v44
    v_fmac_f32 v10, v85, v45
    v_fmac_f32 v56, v86, v46
    v_fmac_f32 v10, v87, v47
    v_add_f32 v56, v56, v10
    buffer_load_dwordx4 v[76:79], v1, s[8:11], s43 offen offset:0 nt
    buffer_load_dwordx4 v[80:83], v1, s[8:11], s43 offen offset:256 nt
    buffer_load_dwordx4 v[84:87], v1, s[8:11], s43 offen offset:512 nt
    s_waitcnt vmcnt(9)
    v_cvt_f32_i32 v88, v88
    v_cvt_f32_i32 v89, v89
    v_cvt_f32_i32 v90, v90
    v_add_f32_dpp v56, v56, v56 row_ror:8 row_mask:0xf bank_mask:0xf
    v_cvt_f32_i32 v91, v91
    v_cvt_f32_i32 v92, v92
    v_cvt_f32_i32 v93, v93
    v_add_f32_dpp v56, v56, v56 row_ror:4 row_mask:0xf bank_mask:0xf
    v_cvt_f32_i32 v94, v94
    v_cvt_f32_i32 v95, v95
    v_cvt_f32_i32 v96, v96
    v_add_f32_dpp v56, v56, v56 row_ror:2 row_mask:0xf bank_mask:0xf
    v_cvt_f32_i32 v97, v97
    v_cvt_f32_i32 v98, v98
    v_cvt_f32_i32 v99, v99
    v_add_f32_dpp v56, v56, v56 row_ror:1 row_mask:0xf bank_mask:0xf
    v_fma_f32 v57, v88, v36, v7
    v_mul_f32 v10, v89, v37
    v_fmac_f32 v57, v90, v38
    v_fmac_f32 v10, v91, v39
    v_fmac_f32 v57, v92, v40
    v_fmac_f32 v10, v93, v41
    v_fmac_f32 v57, v94, v42
    v_fmac_f32 v10, v95, v43
    v_fmac_f32 v57, v96, v44
    v_fmac_f32 v10, v97, v45
    v_fmac_f32 v57, v98, v46
    v_fmac_f32 v10, v99, v47
    v_add_f32 v57, v57, v10
    buffer_load_dwordx4 v[88:91], v1, s[8:11], s43 offen offset:3072 nt
    buffer_load_dwordx4 v[92:95], v1, s[8:11], s43 offen offset:3328 nt
    buffer_load_dwordx4 v[96:99], v1, s[8:11], s43 offen offset:3584 nt
    s_add_u32 s43, s43, 6144
    s_waitcnt vmcnt(9)
    v_cvt_f32_i32 v100, v100
    v_cvt_f32_i32 v101, v101
    v_cvt_f32_i32 v102, v102
    v_add_f32_dpp v57, v57, v57 row_ror:8 row_mask:0xf bank_mask:0xf
    v_cvt_f32_i32 v103, v103
    v_cvt_f32_i32 v104, v104
    v_cvt_f32_i32 v105, v105
    v_add_f32_dpp v57, v57, v57 row_ror:4 row_mask:0xf bank_mask:0xf
    v_cvt_f32_i32 v106, v106
    v_cvt_f32_i32 v107, v107
    v_cvt_f32_i32 v108, v108
    v_add_f32_dpp v57, v57, v57 row_ror:2 row_mask:0xf bank_mask:0xf
    v_cvt_f32_i32 v109, v109
    v_cvt_f32_i32 v110, v110
    v_cvt_f32_i32 v111, v111
    v_add_f32_dpp v57, v57, v57 row_ror:1 row_mask:0xf bank_mask:0xf
    v_fma_f32 v58, v100, v36, v7
    v_mul_f32 v10, v101, v37
    v_fmac_f32 v58, v102, v38
    v_fmac_f32 v10, v103, v39
    v_fmac_f32 v58, v104, v40
    v_fmac_f32 v10, v105, v41
    v_fmac_f32 v58, v106, v42
    v_fmac_f32 v10, v107, v43
    v_fmac_f32 v58, v108, v44
    v_fmac_f32 v10, v109, v45
    v_fmac_f32 v58, v110, v46
    v_fmac_f32 v10, v111, v47
    v_add_f32 v58, v58, v10
    buffer_load_dwordx4 v[100:103], v1, s[8:11], s43 offen offset:0 nt
    buffer_load_dwordx4 v[104:107], v1, s[8:11], s43 offen offset:256 nt
    buffer_load_dwordx4 v[108:111], v1, s[8:11], s43 offen offset:512 nt
    s_waitcnt vmcnt(9)
    v_cvt_f32_i32 v112, v112
    v_cvt_f32_i32 v113, v113
    v_cvt_f32_i32 v114, v114
    v_add_f32_dpp v58, v58, v58 row_ror:8 row_mask:0xf bank_mask:0xf
    v_cvt_f32_i32 v115, v115
    v_cvt_f32_i32 v116, v116
    v_cvt_f32_i32 v117, v117
    v_add_f32_dpp v58, v58, v58 row_ror:4 row_mask:0xf bank_mask:0xf
    v_cvt_f32_i32 v118, v118
    v_cvt_f32_i32 v119, v119
    v_cvt_f32_i32 v120, v120
    v_add_f32_dpp v58, v58, v58 row_ror:2 row_mask:0xf bank_mask:0xf
    v_cvt_f32_i32 v121, v121
    v_cvt_f32_i32 v122, v122
    v_cvt_f32_i32 v123, v123
    v_add_f32_dpp v58, v58, v58 row_ror:1 row_mask:0xf bank_mask:0xf
    v_fma_f32 v59, v112, v36, v7
    v_mul_f32 v10, v113, v37
    v_fmac_f32 v59, v114, v38
    v_fmac_f32 v10, v115, v39
    v_fmac_f32 v59, v116, v40
    v_fmac_f32 v10, v117, v41
    v_fmac_f32 v59, v118, v42
    v_fmac_f32 v10, v119, v43
    v_fmac_f32 v59, v120, v44
    v_fmac_f32 v10, v121, v45
    v_fmac_f32 v59, v122, v46
    v_fmac_f32 v10, v123, v47
    v_add_f32 v59, v59, v10
    buffer_load_dwordx4 v[112:115], v1, s[8:11], s43 offen offset:3072 nt
    buffer_load_dwordx4 v[116:119], v1, s[8:11], s43 offen offset:3328 nt
    buffer_load_dwordx4 v[120:123], v1, s[8:11], s43 offen offset:3584 nt
    s_add_u32 s43, s43, 153600
    s_waitcnt vmcnt(9)
    v_cvt_f32_i32 v76, v76
    v_cvt_f32_i32 v77, v77
    v_cvt_f32_i32 v78, v78
    v_add_f32_dpp v59, v59, v59 row_ror:8 row_mask:0xf bank_mask:0xf
    v_cvt_f32_i32 v79, v79
    v_cvt_f32_i32 v80, v80
    v_cvt_f32_i32 v81, v81
    v_add_f32_dpp v59, v59, v59 row_ror:4 row_mask:0xf bank_mask:0xf
    v_cvt_f32_i32 v82, v82
    v_cvt_f32_i32 v83, v83
    v_cvt_f32_i32 v84, v84
    v_add_f32_dpp v59, v59, v59 row_ror:2 row_mask:0xf bank_mask:0xf
    v_cvt_f32_i32 v85, v85
    v_cvt_f32_i32 v86, v86
    v_cvt_f32_i32 v87, v87
    v_add_f32_dpp v59, v59, v59 row_ror:1 row_mask:0xf bank_mask:0xf
    v_fma_f32 v60, v76, v36, v7
    v_mul_f32 v10, v77, v37
    v_fmac_f32 v60, v78, v38
    v_fmac_f32 v10, v79, v39
    v_fmac_f32 v60, v80, v40
    v_fmac_f32 v10, v81, v41
    v_fmac_f32 v60, v82, v42
    v_fmac_f32 v10, v83, v43
    v_fmac_f32 v60, v84, v44
    v_fmac_f32 v10, v85, v45
    v_fmac_f32 v60, v86, v46
    v_fmac_f32 v10, v87, v47
    v_add_f32 v60, v60, v10
    buffer_load_dwordx4 v[76:79], v1, s[12:15], s44 offen offset:0 nt
    buffer_load_dwordx4 v[80:83], v1, s[12:15], s44 offen offset:256 nt
    buffer_load_dwordx4 v[84:87], v1, s[12:15], s44 offen offset:512 nt
    s_waitcnt vmcnt(9)
    v_cvt_f32_i32 v88, v88
    v_cvt_f32_i32 v89, v89
    v_cvt_f32_i32 v90, v90
    v_add_f32_dpp v60, v60, v60 row_ror:8 row_mask:0xf bank_mask:0xf
    v_cvt_f32_i32 v91, v91
    v_cvt_f32_i32 v92, v92
    v_cvt_f32_i32 v93, v93
    v_add_f32_dpp v60, v60, v60 row_ror:4 row_mask:0xf bank_mask:0xf
    v_cvt_f32_i32 v94, v94
    v_cvt_f32_i32 v95, v95
    v_cvt_f32_i32 v96, v96
    v_add_f32_dpp v60, v60, v60 row_ror:2 row_mask:0xf bank_mask:0xf
    v_cvt_f32_i32 v97, v97
    v_cvt_f32_i32 v98, v98
    v_cvt_f32_i32 v99, v99
    v_add_f32_dpp v60, v60, v60 row_ror:1 row_mask:0xf bank_mask:0xf
    v_fma_f32 v61, v88, v36, v7
    v_mul_f32 v10, v89, v37
    v_fmac_f32 v61, v90, v38
    v_fmac_f32 v10, v91, v39
    v_fmac_f32 v61, v92, v40
    v_fmac_f32 v10, v93, v41
    v_fmac_f32 v61, v94, v42
    v_fmac_f32 v10, v95, v43
    v_fmac_f32 v61, v96, v44
    v_fmac_f32 v10, v97, v45
    v_fmac_f32 v61, v98, v46
    v_fmac_f32 v10, v99, v47
    v_add_f32 v61, v61, v10
    buffer_load_dwordx4 v[88:91], v1, s[12:15], s44 offen offset:3072 nt
    buffer_load_dwordx4 v[92:95], v1, s[12:15], s44 offen offset:3328 nt
    buffer_load_dwordx4 v[96:99], v1, s[12:15], s44 offen offset:3584 nt
    s_add_u32 s44, s44, 6144
    s_waitcnt vmcnt(9)
    v_cvt_f32_i32 v100, v100
    v_cvt_f32_i32 v101, v101
    v_cvt_f32_i32 v102, v102
    v_add_f32_dpp v61, v61, v61 row_ror:8 row_mask:0xf bank_mask:0xf
    v_cvt_f32_i32 v103, v103
    v_cvt_f32_i32 v104, v104
    v_cvt_f32_i32 v105, v105
    v_add_f32_dpp v61, v61, v61 row_ror:4 row_mask:0xf bank_mask:0xf
    v_cvt_f32_i32 v106, v106
    v_cvt_f32_i32 v107, v107
    v_cvt_f32_i32 v108, v108
    v_add_f32_dpp v61, v61, v61 row_ror:2 row_mask:0xf bank_mask:0xf
    v_cvt_f32_i32 v109, v109
    v_cvt_f32_i32 v110, v110
    v_cvt_f32_i32 v111, v111
    v_add_f32_dpp v61, v61, v61 row_ror:1 row_mask:0xf bank_mask:0xf
    v_fma_f32 v62, v100, v36, v7
    v_mul_f32 v10, v101, v37
    v_fmac_f32 v62, v102, v38
    v_fmac_f32 v10, v103, v39
    v_fmac_f32 v62, v104, v40
    v_fmac_f32 v10, v105, v41
    v_fmac_f32 v62, v106, v42
    v_fmac_f32 v10, v107, v43
    v_fmac_f32 v62, v108, v44
    v_fmac_f32 v10, v109, v45
    v_fmac_f32 v62, v110, v46
    v_fmac_f32 v10, v111, v47
    v_add_f32 v62, v62, v10
    buffer_load_dwordx4 v[100:103], v1, s[12:15], s44 offen offset:0 nt
    buffer_load_dwordx4 v[104:107], v1, s[12:15], s44 offen offset:256 nt
    buffer_load_dwordx4 v[108:111], v1, s[12:15], s44 offen offset:512 nt
    s_waitcnt vmcnt(9)
    v_cvt_f32_i32 v112, v112
    v_cvt_f32_i32 v113, v113
    v_cvt_f32_i32 v114, v114
    v_add_f32_dpp v62, v62, v62 row_ror:8 row_mask:0xf bank_mask:0xf
    v_cvt_f32_i32 v115, v115
    v_cvt_f32_i32 v116, v116
    v_cvt_f32_i32 v117, v117
    v_add_f32_dpp v62, v62, v62 row_ror:4 row_mask:0xf bank_mask:0xf
    v_cvt_f32_i32 v118, v118
    v_cvt_f32_i32 v119, v119
    v_cvt_f32_i32 v120, v120
    v_add_f32_dpp v62, v62, v62 row_ror:2 row_mask:0xf bank_mask:0xf
    v_cvt_f32_i32 v121, v121
    v_cvt_f32_i32 v122, v122
    v_cvt_f32_i32 v123, v123
    v_add_f32_dpp v62, v62, v62 row_ror:1 row_mask:0xf bank_mask:0xf
    v_fma_f32 v63, v112, v36, v7
    v_mul_f32 v10, v113, v37
    v_fmac_f32 v63, v114, v38
    v_fmac_f32 v10, v115, v39
    v_fmac_f32 v63, v116, v40
    v_fmac_f32 v10, v117, v41
    v_fmac_f32 v63, v118, v42
    v_fmac_f32 v10, v119, v43
    v_fmac_f32 v63, v120, v44
    v_fmac_f32 v10, v121, v45
    v_fmac_f32 v63, v122, v46
    v_fmac_f32 v10, v123, v47
    v_add_f32 v63, v63, v10
    buffer_load_dwordx4 v[112:115], v1, s[12:15], s44 offen offset:3072 nt
    buffer_load_dwordx4 v[116:119], v1, s[12:15], s44 offen offset:3328 nt
    buffer_load_dwordx4 v[120:123], v1, s[12:15], s44 offen offset:3584 nt
    s_add_u32 s44, s44, 6144
    v_lshlrev_b32 v8, 16, v8
    v_lshlrev_b32 v9, 16, v9
    v_add_f32_dpp v63, v63, v63 row_ror:8 row_mask:0xf bank_mask:0xf
    v_max3_f32 v10, v4, v48, v49
    v_max3_f32 v11, v50, v51, v52
    v_add_f32_dpp v63, v63, v63 row_ror:4 row_mask:0xf bank_mask:0xf
    v_max3_f32 v10, v10, v53, v54
    v_max3_f32 v11, v11, v55, v56
    v_add_f32_dpp v63, v63, v63 row_ror:2 row_mask:0xf bank_mask:0xf
    v_max3_f32 v10, v10, v57, v58
    v_max3_f32 v11, v11, v59, v60
    v_add_f32_dpp v63, v63, v63 row_ror:1 row_mask:0xf bank_mask:0xf
    v_max3_f32 v10, v10, v61, v62
    s_nop 0
    v_max3_f32 v10, v10, v11, v63
    v_sub_f32 v11, v4, v10
    v_exp_f32 v11, v11
    v_mov_b32 v4, v10
    v_sub_f32 v48, v48, v10
    v_sub_f32 v49, v49, v10
    v_sub_f32 v50, v50, v10
    v_sub_f32 v51, v51, v10
    v_sub_f32 v52, v52, v10
    v_sub_f32 v53, v53, v10
    v_sub_f32 v54, v54, v10
    v_sub_f32 v55, v55, v10
    v_sub_f32 v56, v56, v10
    v_sub_f32 v57, v57, v10
    v_sub_f32 v58, v58, v10
    v_sub_f32 v59, v59, v10
    v_sub_f32 v60, v60, v10
    v_sub_f32 v61, v61, v10
    v_sub_f32 v62, v62, v10
    v_sub_f32 v63, v63, v10
    v_exp_f32 v48, v48
    v_exp_f32 v49, v49
    v_exp_f32 v50, v50
    v_exp_f32 v51, v51
    v_exp_f32 v52, v52
    v_exp_f32 v53, v53
    v_exp_f32 v54, v54
    v_exp_f32 v55, v55
    v_exp_f32 v56, v56
    v_exp_f32 v57, v57
    v_exp_f32 v58, v58
    v_exp_f32 v59, v59
    v_exp_f32 v60, v60
    v_exp_f32 v61, v61
    v_exp_f32 v62, v62
    v_exp_f32 v63, v63
    v_mul_f32 v5, v5, v11
    v_mul_f32 v6, v6, v11
    v_mul_f32 v12, v12, v11
    v_mul_f32 v13, v13, v11
    v_mul_f32 v14, v14, v11
    v_mul_f32 v15, v15, v11
    v_mul_f32 v16, v16, v11
    v_mul_f32 v17, v17, v11
    v_mul_f32 v18, v18, v11
    v_mul_f32 v19, v19, v11
    v_mul_f32 v20, v20, v11
    v_mul_f32 v21, v21, v11
    v_mul_f32 v22, v22, v11
    v_mul_f32 v23, v23, v11
    v_add_f32 v5, v5, v48
    v_mul_f32_dpp v48, v8, v48 row_newbcast:0 row_mask:0xf bank_mask:0xf
    v_add_f32 v5, v5, v49
    v_mul_f32_dpp v49, v8, v49 row_newbcast:1 row_mask:0xf bank_mask:0xf
    v_fmac_f32_dpp v6, v9, v48 row_newbcast:0 row_mask:0xf bank_mask:0xf
    v_add_f32 v5, v5, v50
    v_mul_f32_dpp v50, v8, v50 row_newbcast:2 row_mask:0xf bank_mask:0xf
    v_fmac_f32_dpp v6, v9, v49 row_newbcast:1 row_mask:0xf bank_mask:0xf
    v_add_f32 v5, v5, v51
    v_mul_f32_dpp v51, v8, v51 row_newbcast:3 row_mask:0xf bank_mask:0xf
    v_fmac_f32_dpp v6, v9, v50 row_newbcast:2 row_mask:0xf bank_mask:0xf
    v_add_f32 v5, v5, v52
    v_mul_f32_dpp v52, v8, v52 row_newbcast:4 row_mask:0xf bank_mask:0xf
    v_fmac_f32_dpp v6, v9, v51 row_newbcast:3 row_mask:0xf bank_mask:0xf
    v_add_f32 v5, v5, v53
    v_mul_f32_dpp v53, v8, v53 row_newbcast:5 row_mask:0xf bank_mask:0xf
    v_fmac_f32_dpp v6, v9, v52 row_newbcast:4 row_mask:0xf bank_mask:0xf
    v_add_f32 v5, v5, v54
    v_mul_f32_dpp v54, v8, v54 row_newbcast:6 row_mask:0xf bank_mask:0xf
    v_fmac_f32_dpp v6, v9, v53 row_newbcast:5 row_mask:0xf bank_mask:0xf
    v_add_f32 v5, v5, v55
    v_mul_f32_dpp v55, v8, v55 row_newbcast:7 row_mask:0xf bank_mask:0xf
    v_fmac_f32_dpp v6, v9, v54 row_newbcast:6 row_mask:0xf bank_mask:0xf
    v_add_f32 v5, v5, v56
    v_mul_f32_dpp v56, v8, v56 row_newbcast:8 row_mask:0xf bank_mask:0xf
    v_fmac_f32_dpp v6, v9, v55 row_newbcast:7 row_mask:0xf bank_mask:0xf
    v_add_f32 v5, v5, v57
    v_mul_f32_dpp v57, v8, v57 row_newbcast:9 row_mask:0xf bank_mask:0xf
    v_fmac_f32_dpp v6, v9, v56 row_newbcast:8 row_mask:0xf bank_mask:0xf
    v_add_f32 v5, v5, v58
    v_mul_f32_dpp v58, v8, v58 row_newbcast:10 row_mask:0xf bank_mask:0xf
    v_fmac_f32_dpp v6, v9, v57 row_newbcast:9 row_mask:0xf bank_mask:0xf
    v_add_f32 v5, v5, v59
    v_mul_f32_dpp v59, v8, v59 row_newbcast:11 row_mask:0xf bank_mask:0xf
    v_fmac_f32_dpp v6, v9, v58 row_newbcast:10 row_mask:0xf bank_mask:0xf
    v_add_f32 v5, v5, v60
    v_mul_f32_dpp v60, v8, v60 row_newbcast:12 row_mask:0xf bank_mask:0xf
    v_fmac_f32_dpp v6, v9, v59 row_newbcast:11 row_mask:0xf bank_mask:0xf
    v_add_f32 v5, v5, v61
    v_mul_f32_dpp v61, v8, v61 row_newbcast:13 row_mask:0xf bank_mask:0xf
    v_fmac_f32_dpp v6, v9, v60 row_newbcast:12 row_mask:0xf bank_mask:0xf
    v_add_f32 v5, v5, v62
    v_mul_f32_dpp v62, v8, v62 row_newbcast:14 row_mask:0xf bank_mask:0xf
    v_fmac_f32_dpp v6, v9, v61 row_newbcast:13 row_mask:0xf bank_mask:0xf
    v_add_f32 v5, v5, v63
    v_mul_f32_dpp v63, v8, v63 row_newbcast:15 row_mask:0xf bank_mask:0xf
    v_fmac_f32_dpp v6, v9, v62 row_newbcast:14 row_mask:0xf bank_mask:0xf
    s_nop 1
    v_fmac_f32_dpp v6, v9, v63 row_newbcast:15 row_mask:0xf bank_mask:0xf
    buffer_load_dwordx2 v[64:65], v2, s[16:19], s45 offen offset:0
    buffer_load_dwordx2 v[66:67], v2, s[16:19], s45 offen offset:128
    buffer_load_dwordx2 v[68:69], v2, s[16:19], s45 offen offset:256
    buffer_load_dwordx2 v[70:71], v2, s[20:23], s45 offen offset:0
    buffer_load_dwordx2 v[72:73], v2, s[20:23], s45 offen offset:128
    buffer_load_dwordx2 v[74:75], v2, s[20:23], s45 offen offset:256
    buffer_load_ushort v8, v3, s[24:27], s46 offen
    buffer_load_ushort v9, v3, s[28:31], s46 offen
    s_add_u32 s45, s45, 1536
    s_add_u32 s46, s46, 512
    s_waitcnt vmcnt(17)
    v_cvt_f32_i32 v76, v76
    v_cvt_f32_i32 v77, v77
    v_cvt_f32_i32 v78, v78
    v_cvt_f32_i32 v79, v79
    v_cvt_f32_i32 v80, v80
    v_cvt_f32_i32 v81, v81
    v_cvt_f32_i32 v82, v82
    v_cvt_f32_i32 v83, v83
    v_cvt_f32_i32 v84, v84
    v_cvt_f32_i32 v85, v85
    v_cvt_f32_i32 v86, v86
    v_cvt_f32_i32 v87, v87
    v_fmac_f32 v12, v76, v48
    v_fmac_f32 v13, v77, v48
    v_fmac_f32 v14, v78, v48
    v_fmac_f32 v15, v79, v48
    v_fmac_f32 v16, v80, v48
    v_fmac_f32 v17, v81, v48
    v_fmac_f32 v18, v82, v48
    v_fmac_f32 v19, v83, v48
    v_fmac_f32 v20, v84, v48
    v_fmac_f32 v21, v85, v48
    v_fmac_f32 v22, v86, v48
    v_fmac_f32 v23, v87, v48
    buffer_load_dwordx4 v[76:79], v1, s[12:15], s44 offen offset:0 nt
    buffer_load_dwordx4 v[80:83], v1, s[12:15], s44 offen offset:256 nt
    buffer_load_dwordx4 v[84:87], v1, s[12:15], s44 offen offset:512 nt
    s_waitcnt vmcnt(17)
    v_cvt_f32_i32 v88, v88
    v_cvt_f32_i32 v89, v89
    v_cvt_f32_i32 v90, v90
    v_cvt_f32_i32 v91, v91
    v_cvt_f32_i32 v92, v92
    v_cvt_f32_i32 v93, v93
    v_cvt_f32_i32 v94, v94
    v_cvt_f32_i32 v95, v95
    v_cvt_f32_i32 v96, v96
    v_cvt_f32_i32 v97, v97
    v_cvt_f32_i32 v98, v98
    v_cvt_f32_i32 v99, v99
    v_fmac_f32 v12, v88, v49
    v_fmac_f32 v13, v89, v49
    v_fmac_f32 v14, v90, v49
    v_fmac_f32 v15, v91, v49
    v_fmac_f32 v16, v92, v49
    v_fmac_f32 v17, v93, v49
    v_fmac_f32 v18, v94, v49
    v_fmac_f32 v19, v95, v49
    v_fmac_f32 v20, v96, v49
    v_fmac_f32 v21, v97, v49
    v_fmac_f32 v22, v98, v49
    v_fmac_f32 v23, v99, v49
    buffer_load_dwordx4 v[88:91], v1, s[12:15], s44 offen offset:3072 nt
    buffer_load_dwordx4 v[92:95], v1, s[12:15], s44 offen offset:3328 nt
    buffer_load_dwordx4 v[96:99], v1, s[12:15], s44 offen offset:3584 nt
    s_add_u32 s44, s44, 6144
    s_waitcnt vmcnt(17)
    v_cvt_f32_i32 v100, v100
    v_cvt_f32_i32 v101, v101
    v_cvt_f32_i32 v102, v102
    v_cvt_f32_i32 v103, v103
    v_cvt_f32_i32 v104, v104
    v_cvt_f32_i32 v105, v105
    v_cvt_f32_i32 v106, v106
    v_cvt_f32_i32 v107, v107
    v_cvt_f32_i32 v108, v108
    v_cvt_f32_i32 v109, v109
    v_cvt_f32_i32 v110, v110
    v_cvt_f32_i32 v111, v111
    v_fmac_f32 v12, v100, v50
    v_fmac_f32 v13, v101, v50
    v_fmac_f32 v14, v102, v50
    v_fmac_f32 v15, v103, v50
    v_fmac_f32 v16, v104, v50
    v_fmac_f32 v17, v105, v50
    v_fmac_f32 v18, v106, v50
    v_fmac_f32 v19, v107, v50
    v_fmac_f32 v20, v108, v50
    v_fmac_f32 v21, v109, v50
    v_fmac_f32 v22, v110, v50
    v_fmac_f32 v23, v111, v50
    buffer_load_dwordx4 v[100:103], v1, s[12:15], s44 offen offset:0 nt
    buffer_load_dwordx4 v[104:107], v1, s[12:15], s44 offen offset:256 nt
    buffer_load_dwordx4 v[108:111], v1, s[12:15], s44 offen offset:512 nt
    s_waitcnt vmcnt(17)
    v_cvt_f32_i32 v112, v112
    v_cvt_f32_i32 v113, v113
    v_cvt_f32_i32 v114, v114
    v_cvt_f32_i32 v115, v115
    v_cvt_f32_i32 v116, v116
    v_cvt_f32_i32 v117, v117
    v_cvt_f32_i32 v118, v118
    v_cvt_f32_i32 v119, v119
    v_cvt_f32_i32 v120, v120
    v_cvt_f32_i32 v121, v121
    v_cvt_f32_i32 v122, v122
    v_cvt_f32_i32 v123, v123
    v_fmac_f32 v12, v112, v51
    v_fmac_f32 v13, v113, v51
    v_fmac_f32 v14, v114, v51
    v_fmac_f32 v15, v115, v51
    v_fmac_f32 v16, v116, v51
    v_fmac_f32 v17, v117, v51
    v_fmac_f32 v18, v118, v51
    v_fmac_f32 v19, v119, v51
    v_fmac_f32 v20, v120, v51
    v_fmac_f32 v21, v121, v51
    v_fmac_f32 v22, v122, v51
    v_fmac_f32 v23, v123, v51
    buffer_load_dwordx4 v[112:115], v1, s[12:15], s44 offen offset:3072 nt
    buffer_load_dwordx4 v[116:119], v1, s[12:15], s44 offen offset:3328 nt
    buffer_load_dwordx4 v[120:123], v1, s[12:15], s44 offen offset:3584 nt
    s_add_u32 s44, s44, 6144
    s_waitcnt vmcnt(9)
    v_cvt_f32_i32 v76, v76
    v_cvt_f32_i32 v77, v77
    v_cvt_f32_i32 v78, v78
    v_cvt_f32_i32 v79, v79
    v_cvt_f32_i32 v80, v80
    v_cvt_f32_i32 v81, v81
    v_cvt_f32_i32 v82, v82
    v_cvt_f32_i32 v83, v83
    v_cvt_f32_i32 v84, v84
    v_cvt_f32_i32 v85, v85
    v_cvt_f32_i32 v86, v86
    v_cvt_f32_i32 v87, v87
    v_fmac_f32 v12, v76, v52
    v_fmac_f32 v13, v77, v52
    v_fmac_f32 v14, v78, v52
    v_fmac_f32 v15, v79, v52
    v_fmac_f32 v16, v80, v52
    v_fmac_f32 v17, v81, v52
    v_fmac_f32 v18, v82, v52
    v_fmac_f32 v19, v83, v52
    v_fmac_f32 v20, v84, v52
    v_fmac_f32 v21, v85, v52
    v_fmac_f32 v22, v86, v52
    v_fmac_f32 v23, v87, v52
    buffer_load_dwordx4 v[76:79], v1, s[12:15], s44 offen offset:0 nt
    buffer_load_dwordx4 v[80:83], v1, s[12:15], s44 offen offset:256 nt
    buffer_load_dwordx4 v[84:87], v1, s[12:15], s44 offen offset:512 nt
    s_waitcnt vmcnt(9)
    v_cvt_f32_i32 v88, v88
    v_cvt_f32_i32 v89, v89
    v_cvt_f32_i32 v90, v90
    v_cvt_f32_i32 v91, v91
    v_cvt_f32_i32 v92, v92
    v_cvt_f32_i32 v93, v93
    v_cvt_f32_i32 v94, v94
    v_cvt_f32_i32 v95, v95
    v_cvt_f32_i32 v96, v96
    v_cvt_f32_i32 v97, v97
    v_cvt_f32_i32 v98, v98
    v_cvt_f32_i32 v99, v99
    v_fmac_f32 v12, v88, v53
    v_fmac_f32 v13, v89, v53
    v_fmac_f32 v14, v90, v53
    v_fmac_f32 v15, v91, v53
    v_fmac_f32 v16, v92, v53
    v_fmac_f32 v17, v93, v53
    v_fmac_f32 v18, v94, v53
    v_fmac_f32 v19, v95, v53
    v_fmac_f32 v20, v96, v53
    v_fmac_f32 v21, v97, v53
    v_fmac_f32 v22, v98, v53
    v_fmac_f32 v23, v99, v53
    buffer_load_dwordx4 v[88:91], v1, s[12:15], s44 offen offset:3072 nt
    buffer_load_dwordx4 v[92:95], v1, s[12:15], s44 offen offset:3328 nt
    buffer_load_dwordx4 v[96:99], v1, s[12:15], s44 offen offset:3584 nt
    s_add_u32 s44, s44, 6144
    s_waitcnt vmcnt(9)
    v_cvt_f32_i32 v100, v100
    v_cvt_f32_i32 v101, v101
    v_cvt_f32_i32 v102, v102
    v_cvt_f32_i32 v103, v103
    v_cvt_f32_i32 v104, v104
    v_cvt_f32_i32 v105, v105
    v_cvt_f32_i32 v106, v106
    v_cvt_f32_i32 v107, v107
    v_cvt_f32_i32 v108, v108
    v_cvt_f32_i32 v109, v109
    v_cvt_f32_i32 v110, v110
    v_cvt_f32_i32 v111, v111
    v_fmac_f32 v12, v100, v54
    v_fmac_f32 v13, v101, v54
    v_fmac_f32 v14, v102, v54
    v_fmac_f32 v15, v103, v54
    v_fmac_f32 v16, v104, v54
    v_fmac_f32 v17, v105, v54
    v_fmac_f32 v18, v106, v54
    v_fmac_f32 v19, v107, v54
    v_fmac_f32 v20, v108, v54
    v_fmac_f32 v21, v109, v54
    v_fmac_f32 v22, v110, v54
    v_fmac_f32 v23, v111, v54
    buffer_load_dwordx4 v[100:103], v1, s[12:15], s44 offen offset:0 nt
    buffer_load_dwordx4 v[104:107], v1, s[12:15], s44 offen offset:256 nt
    buffer_load_dwordx4 v[108:111], v1, s[12:15], s44 offen offset:512 nt
    s_waitcnt vmcnt(9)
    v_cvt_f32_i32 v112, v112
    v_cvt_f32_i32 v113, v113
    v_cvt_f32_i32 v114, v114
    v_cvt_f32_i32 v115, v115
    v_cvt_f32_i32 v116, v116
    v_cvt_f32_i32 v117, v117
    v_cvt_f32_i32 v118, v118
    v_cvt_f32_i32 v119, v119
    v_cvt_f32_i32 v120, v120
    v_cvt_f32_i32 v121, v121
    v_cvt_f32_i32 v122, v122
    v_cvt_f32_i32 v123, v123
    v_fmac_f32 v12, v112, v55
    v_fmac_f32 v13, v113, v55
    v_fmac_f32 v14, v114, v55
    v_fmac_f32 v15, v115, v55
    v_fmac_f32 v16, v116, v55
    v_fmac_f32 v17, v117, v55
    v_fmac_f32 v18, v118, v55
    v_fmac_f32 v19, v119, v55
    v_fmac_f32 v20, v120, v55
    v_fmac_f32 v21, v121, v55
    v_fmac_f32 v22, v122, v55
    v_fmac_f32 v23, v123, v55
    buffer_load_dwordx4 v[112:115], v1, s[12:15], s44 offen offset:3072 nt
    buffer_load_dwordx4 v[116:119], v1, s[12:15], s44 offen offset:3328 nt
    buffer_load_dwordx4 v[120:123], v1, s[12:15], s44 offen offset:3584 nt
    s_add_u32 s44, s44, 6144
    s_waitcnt vmcnt(9)
    v_cvt_f32_i32 v76, v76
    v_cvt_f32_i32 v77, v77
    v_cvt_f32_i32 v78, v78
    v_cvt_f32_i32 v79, v79
    v_cvt_f32_i32 v80, v80
    v_cvt_f32_i32 v81, v81
    v_cvt_f32_i32 v82, v82
    v_cvt_f32_i32 v83, v83
    v_cvt_f32_i32 v84, v84
    v_cvt_f32_i32 v85, v85
    v_cvt_f32_i32 v86, v86
    v_cvt_f32_i32 v87, v87
    v_fmac_f32 v12, v76, v56
    v_fmac_f32 v13, v77, v56
    v_fmac_f32 v14, v78, v56
    v_fmac_f32 v15, v79, v56
    v_fmac_f32 v16, v80, v56
    v_fmac_f32 v17, v81, v56
    v_fmac_f32 v18, v82, v56
    v_fmac_f32 v19, v83, v56
    v_fmac_f32 v20, v84, v56
    v_fmac_f32 v21, v85, v56
    v_fmac_f32 v22, v86, v56
    v_fmac_f32 v23, v87, v56
    buffer_load_dwordx4 v[76:79], v1, s[12:15], s44 offen offset:0 nt
    buffer_load_dwordx4 v[80:83], v1, s[12:15], s44 offen offset:256 nt
    buffer_load_dwordx4 v[84:87], v1, s[12:15], s44 offen offset:512 nt
    s_waitcnt vmcnt(9)
    v_cvt_f32_i32 v88, v88
    v_cvt_f32_i32 v89, v89
    v_cvt_f32_i32 v90, v90
    v_cvt_f32_i32 v91, v91
    v_cvt_f32_i32 v92, v92
    v_cvt_f32_i32 v93, v93
    v_cvt_f32_i32 v94, v94
    v_cvt_f32_i32 v95, v95
    v_cvt_f32_i32 v96, v96
    v_cvt_f32_i32 v97, v97
    v_cvt_f32_i32 v98, v98
    v_cvt_f32_i32 v99, v99
    v_fmac_f32 v12, v88, v57
    v_fmac_f32 v13, v89, v57
    v_fmac_f32 v14, v90, v57
    v_fmac_f32 v15, v91, v57
    v_fmac_f32 v16, v92, v57
    v_fmac_f32 v17, v93, v57
    v_fmac_f32 v18, v94, v57
    v_fmac_f32 v19, v95, v57
    v_fmac_f32 v20, v96, v57
    v_fmac_f32 v21, v97, v57
    v_fmac_f32 v22, v98, v57
    v_fmac_f32 v23, v99, v57
    buffer_load_dwordx4 v[88:91], v1, s[12:15], s44 offen offset:3072 nt
    buffer_load_dwordx4 v[92:95], v1, s[12:15], s44 offen offset:3328 nt
    buffer_load_dwordx4 v[96:99], v1, s[12:15], s44 offen offset:3584 nt
    s_add_u32 s44, s44, 6144
    s_waitcnt vmcnt(9)
    v_cvt_f32_i32 v100, v100
    v_cvt_f32_i32 v101, v101
    v_cvt_f32_i32 v102, v102
    v_cvt_f32_i32 v103, v103
    v_cvt_f32_i32 v104, v104
    v_cvt_f32_i32 v105, v105
    v_cvt_f32_i32 v106, v106
    v_cvt_f32_i32 v107, v107
    v_cvt_f32_i32 v108, v108
    v_cvt_f32_i32 v109, v109
    v_cvt_f32_i32 v110, v110
    v_cvt_f32_i32 v111, v111
    v_fmac_f32 v12, v100, v58
    v_fmac_f32 v13, v101, v58
    v_fmac_f32 v14, v102, v58
    v_fmac_f32 v15, v103, v58
    v_fmac_f32 v16, v104, v58
    v_fmac_f32 v17, v105, v58
    v_fmac_f32 v18, v106, v58
    v_fmac_f32 v19, v107, v58
    v_fmac_f32 v20, v108, v58
    v_fmac_f32 v21, v109, v58
    v_fmac_f32 v22, v110, v58
    v_fmac_f32 v23, v111, v58
    buffer_load_dwordx4 v[100:103], v1, s[12:15], s44 offen offset:0 nt
    buffer_load_dwordx4 v[104:107], v1, s[12:15], s44 offen offset:256 nt
    buffer_load_dwordx4 v[108:111], v1, s[12:15], s44 offen offset:512 nt
    s_waitcnt vmcnt(9)
    v_cvt_f32_i32 v112, v112
    v_cvt_f32_i32 v113, v113
    v_cvt_f32_i32 v114, v114
    v_cvt_f32_i32 v115, v115
    v_cvt_f32_i32 v116, v116
    v_cvt_f32_i32 v117, v117
    v_cvt_f32_i32 v118, v118
    v_cvt_f32_i32 v119, v119
    v_cvt_f32_i32 v120, v120
    v_cvt_f32_i32 v121, v121
    v_cvt_f32_i32 v122, v122
    v_cvt_f32_i32 v123, v123
    v_fmac_f32 v12, v112, v59
    v_fmac_f32 v13, v113, v59
    v_fmac_f32 v14, v114, v59
    v_fmac_f32 v15, v115, v59
    v_fmac_f32 v16, v116, v59
    v_fmac_f32 v17, v117, v59
    v_fmac_f32 v18, v118, v59
    v_fmac_f32 v19, v119, v59
    v_fmac_f32 v20, v120, v59
    v_fmac_f32 v21, v121, v59
    v_fmac_f32 v22, v122, v59
    v_fmac_f32 v23, v123, v59
    buffer_load_dwordx4 v[112:115], v1, s[12:15], s44 offen offset:3072 nt
    buffer_load_dwordx4 v[116:119], v1, s[12:15], s44 offen offset:3328 nt
    buffer_load_dwordx4 v[120:123], v1, s[12:15], s44 offen offset:3584 nt
    s_add_u32 s44, s44, 153600
    s_waitcnt vmcnt(9)
    v_cvt_f32_i32 v76, v76
    v_cvt_f32_i32 v77, v77
    v_cvt_f32_i32 v78, v78
    v_cvt_f32_i32 v79, v79
    v_cvt_f32_i32 v80, v80
    v_cvt_f32_i32 v81, v81
    v_cvt_f32_i32 v82, v82
    v_cvt_f32_i32 v83, v83
    v_cvt_f32_i32 v84, v84
    v_cvt_f32_i32 v85, v85
    v_cvt_f32_i32 v86, v86
    v_cvt_f32_i32 v87, v87
    v_fmac_f32 v12, v76, v60
    v_fmac_f32 v13, v77, v60
    v_fmac_f32 v14, v78, v60
    v_fmac_f32 v15, v79, v60
    v_fmac_f32 v16, v80, v60
    v_fmac_f32 v17, v81, v60
    v_fmac_f32 v18, v82, v60
    v_fmac_f32 v19, v83, v60
    v_fmac_f32 v20, v84, v60
    v_fmac_f32 v21, v85, v60
    v_fmac_f32 v22, v86, v60
    v_fmac_f32 v23, v87, v60
    buffer_load_dwordx4 v[76:79], v1, s[8:11], s43 offen offset:0 nt
    buffer_load_dwordx4 v[80:83], v1, s[8:11], s43 offen offset:256 nt
    buffer_load_dwordx4 v[84:87], v1, s[8:11], s43 offen offset:512 nt
    s_waitcnt vmcnt(9)
    v_cvt_f32_i32 v88, v88
    v_cvt_f32_i32 v89, v89
    v_cvt_f32_i32 v90, v90
    v_cvt_f32_i32 v91, v91
    v_cvt_f32_i32 v92, v92
    v_cvt_f32_i32 v93, v93
    v_cvt_f32_i32 v94, v94
    v_cvt_f32_i32 v95, v95
    v_cvt_f32_i32 v96, v96
    v_cvt_f32_i32 v97, v97
    v_cvt_f32_i32 v98, v98
    v_cvt_f32_i32 v99, v99
    v_fmac_f32 v12, v88, v61
    v_fmac_f32 v13, v89, v61
    v_fmac_f32 v14, v90, v61
    v_fmac_f32 v15, v91, v61
    v_fmac_f32 v16, v92, v61
    v_fmac_f32 v17, v93, v61
    v_fmac_f32 v18, v94, v61
    v_fmac_f32 v19, v95, v61
    v_fmac_f32 v20, v96, v61
    v_fmac_f32 v21, v97, v61
    v_fmac_f32 v22, v98, v61
    v_fmac_f32 v23, v99, v61
    buffer_load_dwordx4 v[88:91], v1, s[8:11], s43 offen offset:3072 nt
    buffer_load_dwordx4 v[92:95], v1, s[8:11], s43 offen offset:3328 nt
    buffer_load_dwordx4 v[96:99], v1, s[8:11], s43 offen offset:3584 nt
    s_add_u32 s43, s43, 6144
    s_waitcnt vmcnt(9)
    v_cvt_f32_i32 v100, v100
    v_cvt_f32_i32 v101, v101
    v_cvt_f32_i32 v102, v102
    v_cvt_f32_i32 v103, v103
    v_cvt_f32_i32 v104, v104
    v_cvt_f32_i32 v105, v105
    v_cvt_f32_i32 v106, v106
    v_cvt_f32_i32 v107, v107
    v_cvt_f32_i32 v108, v108
    v_cvt_f32_i32 v109, v109
    v_cvt_f32_i32 v110, v110
    v_cvt_f32_i32 v111, v111
    v_fmac_f32 v12, v100, v62
    v_fmac_f32 v13, v101, v62
    v_fmac_f32 v14, v102, v62
    v_fmac_f32 v15, v103, v62
    v_fmac_f32 v16, v104, v62
    v_fmac_f32 v17, v105, v62
    v_fmac_f32 v18, v106, v62
    v_fmac_f32 v19, v107, v62
    v_fmac_f32 v20, v108, v62
    v_fmac_f32 v21, v109, v62
    v_fmac_f32 v22, v110, v62
    v_fmac_f32 v23, v111, v62
    buffer_load_dwordx4 v[100:103], v1, s[8:11], s43 offen offset:0 nt
    buffer_load_dwordx4 v[104:107], v1, s[8:11], s43 offen offset:256 nt
    buffer_load_dwordx4 v[108:111], v1, s[8:11], s43 offen offset:512 nt
    s_waitcnt vmcnt(9)
    v_cvt_f32_i32 v112, v112
    v_cvt_f32_i32 v113, v113
    v_cvt_f32_i32 v114, v114
    v_cvt_f32_i32 v115, v115
    v_cvt_f32_i32 v116, v116
    v_cvt_f32_i32 v117, v117
    v_cvt_f32_i32 v118, v118
    v_cvt_f32_i32 v119, v119
    v_cvt_f32_i32 v120, v120
    v_cvt_f32_i32 v121, v121
    v_cvt_f32_i32 v122, v122
    v_cvt_f32_i32 v123, v123
    v_fmac_f32 v12, v112, v63
    v_fmac_f32 v13, v113, v63
    v_fmac_f32 v14, v114, v63
    v_fmac_f32 v15, v115, v63
    v_fmac_f32 v16, v116, v63
    v_fmac_f32 v17, v117, v63
    v_fmac_f32 v18, v118, v63
    v_fmac_f32 v19, v119, v63
    v_fmac_f32 v20, v120, v63
    v_fmac_f32 v21, v121, v63
    v_fmac_f32 v22, v122, v63
    v_fmac_f32 v23, v123, v63
    buffer_load_dwordx4 v[112:115], v1, s[8:11], s43 offen offset:3072 nt
    buffer_load_dwordx4 v[116:119], v1, s[8:11], s43 offen offset:3328 nt
    buffer_load_dwordx4 v[120:123], v1, s[8:11], s43 offen offset:3584 nt
    s_add_u32 s43, s43, 6144
    v_lshlrev_b32 v36, 16, v64
    v_and_b32 v37, 0xffff0000, v64
    v_lshlrev_b32 v38, 16, v65
    v_and_b32 v39, 0xffff0000, v65
    v_lshlrev_b32 v40, 16, v66
    v_and_b32 v41, 0xffff0000, v66
    v_lshlrev_b32 v42, 16, v67
    v_and_b32 v43, 0xffff0000, v67
    v_lshlrev_b32 v44, 16, v68
    v_and_b32 v45, 0xffff0000, v68
    v_lshlrev_b32 v46, 16, v69
    v_and_b32 v47, 0xffff0000, v69
    v_mul_f32 v36, v36, v24
    v_mul_f32 v37, v37, v25
    v_mul_f32 v38, v38, v26
    v_mul_f32 v39, v39, v27
    v_mul_f32 v40, v40, v28
    v_mul_f32 v41, v41, v29
    v_mul_f32 v42, v42, v30
    v_mul_f32 v43, v43, v31
    v_mul_f32 v44, v44, v32
    v_mul_f32 v45, v45, v33
    v_mul_f32 v46, v46, v34
    v_mul_f32 v47, v47, v35
    v_lshlrev_b32 v10, 16, v70
    v_and_b32 v11, 0xffff0000, v70
    v_mul_f32 v7, v10, v36
    v_fmac_f32 v7, v11, v37
    v_lshlrev_b32 v10, 16, v71
    v_and_b32 v11, 0xffff0000, v71
    v_fmac_f32 v7, v10, v38
    v_fmac_f32 v7, v11, v39
    v_lshlrev_b32 v10, 16, v72
    v_and_b32 v11, 0xffff0000, v72
    v_fmac_f32 v7, v10, v40
    v_fmac_f32 v7, v11, v41
    v_lshlrev_b32 v10, 16, v73
    v_and_b32 v11, 0xffff0000, v73
    v_fmac_f32 v7, v10, v42
    v_fmac_f32 v7, v11, v43
    v_lshlrev_b32 v10, 16, v74
    v_and_b32 v11, 0xffff0000, v74
    v_fmac_f32 v7, v10, v44
    v_fmac_f32 v7, v11, v45
    v_lshlrev_b32 v10, 16, v75
    v_and_b32 v11, 0xffff0000, v75
    v_fmac_f32 v7, v10, v46
    v_fmac_f32 v7, v11, v47
    v_sub_f32 v7, 0, v7
    s_sub_u32 s47, s47, 1
    s_cmp_lg_u32 s47, 0
    s_cbranch_scc1 L_loop
    v_sub_f32 v12, v12, v6
    v_sub_f32 v13, v13, v6
    v_sub_f32 v14, v14, v6
    v_sub_f32 v15, v15, v6
    v_sub_f32 v16, v16, v6
    v_sub_f32 v17, v17, v6
    v_sub_f32 v18, v18, v6
    v_sub_f32 v19, v19, v6
    v_sub_f32 v20, v20, v6
    v_sub_f32 v21, v21, v6
    v_sub_f32 v22, v22, v6
    v_sub_f32 v23, v23, v6
    s_mul_i32 s50, s42, 3072
    v_add_u32 v10, s50, v1
    ds_write_b128 v10, v[12:15] offset:0
    ds_write_b128 v10, v[16:19] offset:256
    ds_write_b128 v10, v[20:23] offset:512
    v_lshrrev_b32 v11, 4, v0
    v_lshlrev_b32 v11, 3, v11
    ds_write_b64 v11, v[4:5] offset:12288
    s_waitcnt lgkmcnt(0)
    s_barrier
    v_cmp_gt_u32 vcc, 192, v0
    s_and_saveexec_b64 s[52:53], vcc
    s_cbranch_execz L_exit1
    s_waitcnt vmcnt(0)
    v_mov_b32 v10, 0
    ds_read_b128 v[12:15], v10 offset:12288
    ds_read_b128 v[16:19], v10 offset:12304
    ds_read_b128 v[20:23], v10 offset:12320
    ds_read_b128 v[24:27], v10 offset:12336
    ds_read_b128 v[28:31], v10 offset:12352
    ds_read_b128 v[32:35], v10 offset:12368
    ds_read_b128 v[36:39], v10 offset:12384
    ds_read_b128 v[40:43], v10 offset:12400
    v_lshlrev_b32 v11, 2, v0
    ds_read_b32 v44, v11 offset:0
    ds_read_b32 v45, v11 offset:768
    ds_read_b32 v46, v11 offset:1536
    ds_read_b32 v47, v11 offset:2304
    ds_read_b32 v48, v11 offset:3072
    ds_read_b32 v49, v11 offset:3840
    ds_read_b32 v50, v11 offset:4608
    ds_read_b32 v51, v11 offset:5376
    ds_read_b32 v52, v11 offset:6144
    ds_read_b32 v53, v11 offset:6912
    ds_read_b32 v54, v11 offset:7680
    ds_read_b32 v55, v11 offset:8448
    ds_read_b32 v56, v11 offset:9216
    ds_read_b32 v57, v11 offset:9984
    ds_read_b32 v58, v11 offset:10752
    ds_read_b32 v59, v11 offset:11520
    s_waitcnt lgkmcnt(0)
    v_mov_b32 v4, v12
    v_max_f32 v4, v4, v14
    v_max_f32 v4, v4, v16
    v_max_f32 v4, v4, v18
    v_max_f32 v4, v4, v20
    v_max_f32 v4, v4, v22
    v_max_f32 v4, v4, v24
    v_max_f32 v4, v4, v26
    v_max_f32 v4, v4, v28
    v_max_f32 v4, v4, v30
    v_max_f32 v4, v4, v32
    v_max_f32 v4, v4, v34
    v_max_f32 v4, v4, v36
    v_max_f32 v4, v4, v38
    v_max_f32 v4, v4, v40
    v_max_f32 v4, v4, v42
    v_sub_f32 v12, v12, v4
    v_sub_f32 v14, v14, v4
    v_sub_f32 v16, v16, v4
    v_sub_f32 v18, v18, v4
    v_sub_f32 v20, v20, v4
    v_sub_f32 v22, v22, v4
    v_sub_f32 v24, v24, v4
    v_sub_f32 v26, v26, v4
    v_sub_f32 v28, v28, v4
    v_sub_f32 v30, v30, v4
    v_sub_f32 v32, v32, v4
    v_sub_f32 v34, v34, v4
    v_sub_f32 v36, v36, v4
    v_sub_f32 v38, v38, v4
    v_sub_f32 v40, v40, v4
    v_sub_f32 v42, v42, v4
    v_exp_f32 v12, v12
    v_exp_f32 v14, v14
    v_exp_f32 v16, v16
    v_exp_f32 v18, v18
    v_exp_f32 v20, v20
    v_exp_f32 v22, v22
    v_exp_f32 v24, v24
    v_exp_f32 v26, v26
    v_exp_f32 v28, v28
    v_exp_f32 v30, v30
    v_exp_f32 v32, v32
    v_exp_f32 v34, v34
    v_exp_f32 v36, v36
    v_exp_f32 v38, v38
    v_exp_f32 v40, v40
    v_exp_f32 v42, v42
    s_nop 0
    v_mul_f32 v5, v12, v13
    v_mul_f32 v6, v12, v44
    v_fmac_f32 v5, v14, v15
    v_fmac_f32 v6, v14, v45
    v_fmac_f32 v5, v16, v17
    v_fmac_f32 v6, v16, v46
    v_fmac_f32 v5, v18, v19
    v_fmac_f32 v6, v18, v47
    v_fmac_f32 v5, v20, v21
    v_fmac_f32 v6, v20, v48
    v_fmac_f32 v5, v22, v23
    v_fmac_f32 v6, v22, v49
    v_fmac_f32 v5, v24, v25
    v_fmac_f32 v6, v24, v50
    v_fmac_f32 v5, v26, v27
    v_fmac_f32 v6, v26, v51
    v_fmac_f32 v5, v28, v29
    v_fmac_f32 v6, v28, v52
    v_fmac_f32 v5, v30, v31
    v_fmac_f32 v6, v30, v53
    v_fmac_f32 v5, v32, v33
    v_fmac_f32 v6, v32, v54
    v_fmac_f32 v5, v34, v35
    v_fmac_f32 v6, v34, v55
    v_fmac_f32 v5, v36, v37
    v_fmac_f32 v6, v36, v56
    v_fmac_f32 v5, v38, v39
    v_fmac_f32 v6, v38, v57
    v_fmac_f32 v5, v40, v41
    v_fmac_f32 v6, v40, v58
    v_fmac_f32 v5, v42, v43
    v_fmac_f32 v6, v42, v59
    s_lshl_b32 s50, s40, 5
    s_add_u32 s50, s50, s41
    s_mul_i32 s50, s50, 1024
    buffer_store_dword v6, v11, s[36:39], s50 offen
    v_cmp_eq_u32 vcc, 0, v0
    s_and_saveexec_b64 s[52:53], vcc
    s_cbranch_execz L_exit1
    buffer_store_dwordx2 v[4:5], v11, s[36:39], s50 offen offset:768
L_exit1:
    s_endpgm
.globl standalone__kv_cache_quant_int4_int2_kv_with_per_channel_or_per_token_scales__decode_kernel
.p2align 8
.type standalone__kv_cache_quant_int4_int2_kv_with_per_channel_or_per_token_scales__decode_kernel,@function
standalone__kv_cache_quant_int4_int2_kv_with_per_channel_or_per_token_scales__decode_kernel:
    s_cmp_ge_u32 s2, 32
    s_cbranch_scc1 L_exit2
    s_load_dwordx2 s[4:5], s[0:1], 56
    s_load_dwordx2 s[6:7], s[0:1], 72
    s_waitcnt lgkmcnt(0)
    s_mov_b32 s8, s6
    s_and_b32 s9, s7, 0xffff
    s_mov_b32 s10, 1048576
    s_mov_b32 s11, 0x00020000
    s_mov_b32 s12, s4
    s_and_b32 s13, s5, 0xffff
    s_mov_b32 s14, 12288
    s_mov_b32 s15, 0x00020000
    s_mul_i32 s16, s2, 32768
    v_lshlrev_b32 v1, 2, v0
    v_mov_b32 v2, 0
    v_mov_b32 v4, 0xff7fffff
    v_mov_b32 v5, 0
    v_mov_b32 v6, 0
    s_add_u32 s17, s16, 0
    buffer_load_dwordx2 v[8:9], v2, s[8:11], s17 offen offset:768
    buffer_load_dword v72, v1, s[8:11], s17 offen offset:0
    buffer_load_dwordx2 v[10:11], v2, s[8:11], s17 offen offset:1792
    buffer_load_dword v73, v1, s[8:11], s17 offen offset:1024
    buffer_load_dwordx2 v[12:13], v2, s[8:11], s17 offen offset:2816
    buffer_load_dword v74, v1, s[8:11], s17 offen offset:2048
    buffer_load_dwordx2 v[14:15], v2, s[8:11], s17 offen offset:3840
    buffer_load_dword v75, v1, s[8:11], s17 offen offset:3072
    s_add_u32 s17, s16, 4096
    buffer_load_dwordx2 v[16:17], v2, s[8:11], s17 offen offset:768
    buffer_load_dword v76, v1, s[8:11], s17 offen offset:0
    buffer_load_dwordx2 v[18:19], v2, s[8:11], s17 offen offset:1792
    buffer_load_dword v77, v1, s[8:11], s17 offen offset:1024
    buffer_load_dwordx2 v[20:21], v2, s[8:11], s17 offen offset:2816
    buffer_load_dword v78, v1, s[8:11], s17 offen offset:2048
    buffer_load_dwordx2 v[22:23], v2, s[8:11], s17 offen offset:3840
    buffer_load_dword v79, v1, s[8:11], s17 offen offset:3072
    s_add_u32 s17, s16, 8192
    buffer_load_dwordx2 v[24:25], v2, s[8:11], s17 offen offset:768
    buffer_load_dword v80, v1, s[8:11], s17 offen offset:0
    buffer_load_dwordx2 v[26:27], v2, s[8:11], s17 offen offset:1792
    buffer_load_dword v81, v1, s[8:11], s17 offen offset:1024
    buffer_load_dwordx2 v[28:29], v2, s[8:11], s17 offen offset:2816
    buffer_load_dword v82, v1, s[8:11], s17 offen offset:2048
    buffer_load_dwordx2 v[30:31], v2, s[8:11], s17 offen offset:3840
    buffer_load_dword v83, v1, s[8:11], s17 offen offset:3072
    s_add_u32 s17, s16, 12288
    buffer_load_dwordx2 v[32:33], v2, s[8:11], s17 offen offset:768
    buffer_load_dword v84, v1, s[8:11], s17 offen offset:0
    buffer_load_dwordx2 v[34:35], v2, s[8:11], s17 offen offset:1792
    buffer_load_dword v85, v1, s[8:11], s17 offen offset:1024
    buffer_load_dwordx2 v[36:37], v2, s[8:11], s17 offen offset:2816
    buffer_load_dword v86, v1, s[8:11], s17 offen offset:2048
    buffer_load_dwordx2 v[38:39], v2, s[8:11], s17 offen offset:3840
    buffer_load_dword v87, v1, s[8:11], s17 offen offset:3072
    s_add_u32 s17, s16, 16384
    buffer_load_dwordx2 v[40:41], v2, s[8:11], s17 offen offset:768
    buffer_load_dword v88, v1, s[8:11], s17 offen offset:0
    buffer_load_dwordx2 v[42:43], v2, s[8:11], s17 offen offset:1792
    buffer_load_dword v89, v1, s[8:11], s17 offen offset:1024
    buffer_load_dwordx2 v[44:45], v2, s[8:11], s17 offen offset:2816
    buffer_load_dword v90, v1, s[8:11], s17 offen offset:2048
    buffer_load_dwordx2 v[46:47], v2, s[8:11], s17 offen offset:3840
    buffer_load_dword v91, v1, s[8:11], s17 offen offset:3072
    s_add_u32 s17, s16, 20480
    buffer_load_dwordx2 v[48:49], v2, s[8:11], s17 offen offset:768
    buffer_load_dword v92, v1, s[8:11], s17 offen offset:0
    buffer_load_dwordx2 v[50:51], v2, s[8:11], s17 offen offset:1792
    buffer_load_dword v93, v1, s[8:11], s17 offen offset:1024
    buffer_load_dwordx2 v[52:53], v2, s[8:11], s17 offen offset:2816
    buffer_load_dword v94, v1, s[8:11], s17 offen offset:2048
    buffer_load_dwordx2 v[54:55], v2, s[8:11], s17 offen offset:3840
    buffer_load_dword v95, v1, s[8:11], s17 offen offset:3072
    s_add_u32 s17, s16, 24576
    buffer_load_dwordx2 v[56:57], v2, s[8:11], s17 offen offset:768
    buffer_load_dword v96, v1, s[8:11], s17 offen offset:0
    buffer_load_dwordx2 v[58:59], v2, s[8:11], s17 offen offset:1792
    buffer_load_dword v97, v1, s[8:11], s17 offen offset:1024
    buffer_load_dwordx2 v[60:61], v2, s[8:11], s17 offen offset:2816
    buffer_load_dword v98, v1, s[8:11], s17 offen offset:2048
    buffer_load_dwordx2 v[62:63], v2, s[8:11], s17 offen offset:3840
    buffer_load_dword v99, v1, s[8:11], s17 offen offset:3072
    s_add_u32 s17, s16, 28672
    buffer_load_dwordx2 v[64:65], v2, s[8:11], s17 offen offset:768
    buffer_load_dword v100, v1, s[8:11], s17 offen offset:0
    buffer_load_dwordx2 v[66:67], v2, s[8:11], s17 offen offset:1792
    buffer_load_dword v101, v1, s[8:11], s17 offen offset:1024
    buffer_load_dwordx2 v[68:69], v2, s[8:11], s17 offen offset:2816
    buffer_load_dword v102, v1, s[8:11], s17 offen offset:2048
    buffer_load_dwordx2 v[70:71], v2, s[8:11], s17 offen offset:3840
    buffer_load_dword v103, v1, s[8:11], s17 offen offset:3072
    s_waitcnt vmcnt(0)
    v_mov_b32 v3, v4
    v_max_f32 v3, v3, v8
    v_max_f32 v3, v3, v10
    v_max_f32 v3, v3, v12
    v_max_f32 v3, v3, v14
    v_max_f32 v3, v3, v16
    v_max_f32 v3, v3, v18
    v_max_f32 v3, v3, v20
    v_max_f32 v3, v3, v22
    v_max_f32 v3, v3, v24
    v_max_f32 v3, v3, v26
    v_max_f32 v3, v3, v28
    v_max_f32 v3, v3, v30
    v_max_f32 v3, v3, v32
    v_max_f32 v3, v3, v34
    v_max_f32 v3, v3, v36
    v_max_f32 v3, v3, v38
    v_max_f32 v3, v3, v40
    v_max_f32 v3, v3, v42
    v_max_f32 v3, v3, v44
    v_max_f32 v3, v3, v46
    v_max_f32 v3, v3, v48
    v_max_f32 v3, v3, v50
    v_max_f32 v3, v3, v52
    v_max_f32 v3, v3, v54
    v_max_f32 v3, v3, v56
    v_max_f32 v3, v3, v58
    v_max_f32 v3, v3, v60
    v_max_f32 v3, v3, v62
    v_max_f32 v3, v3, v64
    v_max_f32 v3, v3, v66
    v_max_f32 v3, v3, v68
    v_max_f32 v3, v3, v70
    v_sub_f32 v7, v4, v3
    v_exp_f32 v7, v7
    v_mov_b32 v4, v3
    v_sub_f32 v8, v8, v3
    v_sub_f32 v10, v10, v3
    v_sub_f32 v12, v12, v3
    v_sub_f32 v14, v14, v3
    v_sub_f32 v16, v16, v3
    v_sub_f32 v18, v18, v3
    v_sub_f32 v20, v20, v3
    v_sub_f32 v22, v22, v3
    v_sub_f32 v24, v24, v3
    v_sub_f32 v26, v26, v3
    v_sub_f32 v28, v28, v3
    v_sub_f32 v30, v30, v3
    v_sub_f32 v32, v32, v3
    v_sub_f32 v34, v34, v3
    v_sub_f32 v36, v36, v3
    v_sub_f32 v38, v38, v3
    v_sub_f32 v40, v40, v3
    v_sub_f32 v42, v42, v3
    v_sub_f32 v44, v44, v3
    v_sub_f32 v46, v46, v3
    v_sub_f32 v48, v48, v3
    v_sub_f32 v50, v50, v3
    v_sub_f32 v52, v52, v3
    v_sub_f32 v54, v54, v3
    v_sub_f32 v56, v56, v3
    v_sub_f32 v58, v58, v3
    v_sub_f32 v60, v60, v3
    v_sub_f32 v62, v62, v3
    v_sub_f32 v64, v64, v3
    v_sub_f32 v66, v66, v3
    v_sub_f32 v68, v68, v3
    v_sub_f32 v70, v70, v3
    v_exp_f32 v8, v8
    v_exp_f32 v10, v10
    v_exp_f32 v12, v12
    v_exp_f32 v14, v14
    v_exp_f32 v16, v16
    v_exp_f32 v18, v18
    v_exp_f32 v20, v20
    v_exp_f32 v22, v22
    v_exp_f32 v24, v24
    v_exp_f32 v26, v26
    v_exp_f32 v28, v28
    v_exp_f32 v30, v30
    v_exp_f32 v32, v32
    v_exp_f32 v34, v34
    v_exp_f32 v36, v36
    v_exp_f32 v38, v38
    v_exp_f32 v40, v40
    v_exp_f32 v42, v42
    v_exp_f32 v44, v44
    v_exp_f32 v46, v46
    v_exp_f32 v48, v48
    v_exp_f32 v50, v50
    v_exp_f32 v52, v52
    v_exp_f32 v54, v54
    v_exp_f32 v56, v56
    v_exp_f32 v58, v58
    v_exp_f32 v60, v60
    v_exp_f32 v62, v62
    v_exp_f32 v64, v64
    v_exp_f32 v66, v66
    v_exp_f32 v68, v68
    v_exp_f32 v70, v70
    v_mul_f32 v5, v5, v7
    v_mul_f32 v6, v6, v7
    v_fmac_f32 v5, v8, v9
    v_fmac_f32 v6, v8, v72
    v_fmac_f32 v5, v10, v11
    v_fmac_f32 v6, v10, v73
    v_fmac_f32 v5, v12, v13
    v_fmac_f32 v6, v12, v74
    v_fmac_f32 v5, v14, v15
    v_fmac_f32 v6, v14, v75
    v_fmac_f32 v5, v16, v17
    v_fmac_f32 v6, v16, v76
    v_fmac_f32 v5, v18, v19
    v_fmac_f32 v6, v18, v77
    v_fmac_f32 v5, v20, v21
    v_fmac_f32 v6, v20, v78
    v_fmac_f32 v5, v22, v23
    v_fmac_f32 v6, v22, v79
    v_fmac_f32 v5, v24, v25
    v_fmac_f32 v6, v24, v80
    v_fmac_f32 v5, v26, v27
    v_fmac_f32 v6, v26, v81
    v_fmac_f32 v5, v28, v29
    v_fmac_f32 v6, v28, v82
    v_fmac_f32 v5, v30, v31
    v_fmac_f32 v6, v30, v83
    v_fmac_f32 v5, v32, v33
    v_fmac_f32 v6, v32, v84
    v_fmac_f32 v5, v34, v35
    v_fmac_f32 v6, v34, v85
    v_fmac_f32 v5, v36, v37
    v_fmac_f32 v6, v36, v86
    v_fmac_f32 v5, v38, v39
    v_fmac_f32 v6, v38, v87
    v_fmac_f32 v5, v40, v41
    v_fmac_f32 v6, v40, v88
    v_fmac_f32 v5, v42, v43
    v_fmac_f32 v6, v42, v89
    v_fmac_f32 v5, v44, v45
    v_fmac_f32 v6, v44, v90
    v_fmac_f32 v5, v46, v47
    v_fmac_f32 v6, v46, v91
    v_fmac_f32 v5, v48, v49
    v_fmac_f32 v6, v48, v92
    v_fmac_f32 v5, v50, v51
    v_fmac_f32 v6, v50, v93
    v_fmac_f32 v5, v52, v53
    v_fmac_f32 v6, v52, v94
    v_fmac_f32 v5, v54, v55
    v_fmac_f32 v6, v54, v95
    v_fmac_f32 v5, v56, v57
    v_fmac_f32 v6, v56, v96
    v_fmac_f32 v5, v58, v59
    v_fmac_f32 v6, v58, v97
    v_fmac_f32 v5, v60, v61
    v_fmac_f32 v6, v60, v98
    v_fmac_f32 v5, v62, v63
    v_fmac_f32 v6, v62, v99
    v_fmac_f32 v5, v64, v65
    v_fmac_f32 v6, v64, v100
    v_fmac_f32 v5, v66, v67
    v_fmac_f32 v6, v66, v101
    v_fmac_f32 v5, v68, v69
    v_fmac_f32 v6, v68, v102
    v_fmac_f32 v5, v70, v71
    v_fmac_f32 v6, v70, v103
    v_rcp_f32 v5, v5
    s_nop 0
    v_mul_f32 v6, v6, v5
    v_cvt_pk_bf16_f32 v6, v6, v6
    s_mul_i32 s16, s2, 384
    v_lshlrev_b32 v1, 1, v0
    buffer_store_short v6, v1, s[12:15], s16 offen
L_exit2:
    s_endpgm
.section .rodata,"a"
.p2align 6
.amdhsa_kernel part_kernel
  .amdhsa_next_free_vgpr 124
  .amdhsa_next_free_sgpr 84
  .amdhsa_accum_offset 124
  .amdhsa_group_segment_fixed_size 0
  .amdhsa_kernarg_size 80
  .amdhsa_user_sgpr_count 2
  .amdhsa_user_sgpr_kernarg_segment_ptr 1
  .amdhsa_system_sgpr_workgroup_id_x 1
.end_amdhsa_kernel
.p2align 6
.amdhsa_kernel standalone__kv_cache_quant_int4_int2_kv_with_per_channel_or_per_token_scales__decode_kernel
  .amdhsa_next_free_vgpr 104
  .amdhsa_next_free_sgpr 24
  .amdhsa_accum_offset 104
  .amdhsa_group_segment_fixed_size 0
  .amdhsa_kernarg_size 80
  .amdhsa_user_sgpr_count 2
  .amdhsa_user_sgpr_kernarg_segment_ptr 1
  .amdhsa_system_sgpr_workgroup_id_x 1
.end_amdhsa_kernel
```

```asm
; @launch kernel=part_kernel grid=(256,1,1) block=(256,1,1) lds=42624
; @launch kernel=standalone__kv_cache_quant_int4_int2_kv_with_per_channel_or_per_token_scales__decode_kernel grid=(96,1,1) block=(256,1,1) lds=1056
.amdgcn_target "amdgcn-amd-amdhsa--gfx950"
.text
.globl part_kernel
.p2align 8
.type part_kernel,@function
part_kernel:
    s_cmp_ge_u32 s2, 256
    s_cbranch_scc1 L_exit1
    s_load_dwordx16 s[64:79], s[0:1], 0
    s_load_dwordx4 s[80:83], s[0:1], 64
    s_mov_b32 s54, s2
    v_lshrrev_b32 v10, 6, v0
    v_and_b32 v11, 63, v0
    v_readfirstlane_b32 s42, v10
    v_lshrrev_b32 v10, 4, v11
    v_and_b32 v11, 15, v11
    v_mul_u32_u24 v64, 768, v10
    v_lshl_add_u32 v64, v11, 4, v64
    v_add_u32 v65, 6144, v64
    v_lshlrev_b32 v1, 3, v11
    v_lshlrev_b32 v58, 2, v10
    v_lshl_add_u32 v58, v11, 4, v58
    v_and_b32 v11, 3, v11
    v_lshl_add_u32 v2, v11, 2, v10
    v_lshlrev_b32 v2, 1, v2
    s_lshr_b32 s40, s2, 3
    s_and_b32 s40, s40, 3
    s_lshr_b32 s41, s2, 5
    s_lshl_b32 s41, s41, 3
    s_and_b32 s50, s2, 7
    s_or_b32 s41, s41, s50
    s_mul_i32 s55, s41, 4
    s_add_u32 s55, s55, s42
    s_mul_i32 s55, s55, 16
    s_lshl_b32 s50, s40, 15
    s_add_u32 s55, s55, s50
    s_mul_i32 s43, s55, 768
    s_lshr_b32 s45, s55, 6
    s_mul_i32 s45, s45, 384
    s_lshr_b32 s47, s55, 15
    s_mul_i32 s47, s47, 384
    s_waitcnt lgkmcnt(0)
    s_mov_b32 s8, s66
    s_and_b32 s9, s67, 0xffff
    s_mov_b32 s10, 805306368
    s_mov_b32 s11, 0x00020000
    buffer_load_dwordx4 v[68:71], v64, s[8:11], s43 offen offset:0 nt
    buffer_load_dwordx4 v[72:75], v64, s[8:11], s43 offen offset:256 nt
    buffer_load_dwordx4 v[76:79], v64, s[8:11], s43 offen offset:512 nt
    buffer_load_dwordx4 v[80:83], v64, s[8:11], s43 offen offset:3072 nt
    buffer_load_dwordx4 v[84:87], v64, s[8:11], s43 offen offset:3328 nt
    buffer_load_dwordx4 v[88:91], v64, s[8:11], s43 offen offset:3584 nt
    s_mov_b32 s32, s64
    s_and_b32 s33, s65, 0xffff
    s_mov_b32 s34, 12288
    s_mov_b32 s35, 0x00020000
    s_mov_b32 s16, s70
    s_and_b32 s17, s71, 0xffff
    s_mov_b32 s18, 6291456
    s_mov_b32 s19, 0x00020000
    s_mov_b32 s20, s72
    s_and_b32 s21, s73, 0xffff
    s_mov_b32 s22, 6291456
    s_mov_b32 s23, 0x00020000
    buffer_load_dwordx2 v[36:37], v1, s[32:35], s47 offen offset:0
    buffer_load_dwordx2 v[38:39], v1, s[32:35], s47 offen offset:128
    buffer_load_dwordx2 v[40:41], v1, s[32:35], s47 offen offset:256
    buffer_load_dwordx2 v[42:43], v1, s[16:19], s45 offen offset:0
    buffer_load_dwordx2 v[44:45], v1, s[16:19], s45 offen offset:128
    buffer_load_dwordx2 v[46:47], v1, s[16:19], s45 offen offset:256
    buffer_load_dwordx2 v[48:49], v1, s[20:23], s45 offen offset:0
    buffer_load_dwordx2 v[50:51], v1, s[20:23], s45 offen offset:128
    buffer_load_dwordx2 v[52:53], v1, s[20:23], s45 offen offset:256
    s_mov_b32 s24, s74
    s_and_b32 s25, s75, 0xffff
    s_mov_b32 s26, 2097152
    s_mov_b32 s27, 0x00020000
    s_mov_b32 s28, s76
    s_and_b32 s29, s77, 0xffff
    s_mov_b32 s30, 2097152
    s_mov_b32 s31, 0x00020000
    s_mov_b32 s12, s68
    s_and_b32 s13, s69, 0xffff
    s_mov_b32 s14, 805306368
    s_mov_b32 s15, 0x00020000
    s_mov_b32 s36, s82
    s_and_b32 s37, s83, 0xffff
    s_mov_b32 s38, 2097152
    s_mov_b32 s39, 0x00020000
    s_mov_b32 s48, 0x3dd53b95
    s_mov_b32 s49, 0xbdd53b95
    s_mov_b32 s44, s55
    s_mov_b32 s56, 0
    s_mov_b32 s58, 0
    s_mov_b32 s61, 63
    s_mul_i32 s59, s42, 768
    s_add_u32 s59, s59, 17024
    s_lshl_b32 s62, s42, 4
    s_add_u32 s62, s62, 128
    s_mul_i32 s60, s40, 64
    s_add_u32 s60, s60, s41
    s_mul_i32 s60, s60, 1024
    s_mul_i32 s50, s42, 4096
    s_add_u32 s50, s50, 640
    v_mul_u32_u24 v3, 16, v10
    v_add_u32 v3, s50, v3
    v_lshl_add_u32 v54, v11, 2, v3
    v_lshlrev_b32 v55, 2, v10
    v_add_u32 v55, s62, v55
    v_lshlrev_b32 v10, 2, v0
    v_mov_b32 v11, 0
    v_cmp_gt_u32 vcc, 8, v0
    s_and_saveexec_b64 s[52:53], vcc
    ds_write_b32 v10, v11 offset:0
    s_mov_b64 exec, s[52:53]
    v_mov_b32 v4, 0xff7fffff
    s_waitcnt lgkmcnt(0)
    s_barrier
    s_waitcnt vmcnt(0)
    v_lshlrev_b32 v10, 16, v36
    v_lshlrev_b32 v24, 16, v42
    v_and_b32 v11, 0xffff0000, v36
    v_and_b32 v25, 0xffff0000, v42
    v_mul_f32 v24, v24, v10
    v_mul_f32 v25, v25, v11
    v_lshlrev_b32 v10, 16, v37
    v_lshlrev_b32 v26, 16, v43
    v_and_b32 v11, 0xffff0000, v37
    v_and_b32 v27, 0xffff0000, v43
    v_mul_f32 v26, v26, v10
    v_mul_f32 v27, v27, v11
    v_lshlrev_b32 v10, 16, v38
    v_lshlrev_b32 v28, 16, v44
    v_and_b32 v11, 0xffff0000, v38
    v_and_b32 v29, 0xffff0000, v44
    v_mul_f32 v28, v28, v10
    v_mul_f32 v29, v29, v11
    v_lshlrev_b32 v10, 16, v39
    v_lshlrev_b32 v30, 16, v45
    v_and_b32 v11, 0xffff0000, v39
    v_and_b32 v31, 0xffff0000, v45
    v_mul_f32 v30, v30, v10
    v_mul_f32 v31, v31, v11
    v_lshlrev_b32 v10, 16, v40
    v_lshlrev_b32 v32, 16, v46
    v_and_b32 v11, 0xffff0000, v40
    v_and_b32 v33, 0xffff0000, v46
    v_mul_f32 v32, v32, v10
    v_mul_f32 v33, v33, v11
    v_lshlrev_b32 v10, 16, v41
    v_lshlrev_b32 v34, 16, v47
    v_and_b32 v11, 0xffff0000, v41
    v_and_b32 v35, 0xffff0000, v47
    v_mul_f32 v34, v34, v10
    v_mul_f32 v35, v35, v11
    v_lshlrev_b32 v10, 16, v48
    v_and_b32 v11, 0xffff0000, v48
    v_mul_f32 v7, v10, v24
    v_fmac_f32 v7, v11, v25
    v_lshlrev_b32 v10, 16, v49
    v_and_b32 v11, 0xffff0000, v49
    v_fmac_f32 v7, v10, v26
    v_fmac_f32 v7, v11, v27
    v_lshlrev_b32 v10, 16, v50
    v_and_b32 v11, 0xffff0000, v50
    v_fmac_f32 v7, v10, v28
    v_fmac_f32 v7, v11, v29
    v_lshlrev_b32 v10, 16, v51
    v_and_b32 v11, 0xffff0000, v51
    v_fmac_f32 v7, v10, v30
    v_fmac_f32 v7, v11, v31
    v_lshlrev_b32 v10, 16, v52
    v_and_b32 v11, 0xffff0000, v52
    v_fmac_f32 v7, v10, v32
    v_fmac_f32 v7, v11, v33
    v_lshlrev_b32 v10, 16, v53
    v_and_b32 v11, 0xffff0000, v53
    v_fmac_f32 v7, v10, v34
    v_fmac_f32 v7, v11, v35
    v_sub_f32 v7, 0, v7
.p2align 6
L_kloop:
    s_nop 1
    s_waitcnt vmcnt(0)
    buffer_load_dwordx4 v[92:95], v65, s[8:11], s43 offen offset:0 nt
    buffer_load_dwordx4 v[96:99], v65, s[8:11], s43 offen offset:256 nt
    buffer_load_dwordx4 v[100:103], v65, s[8:11], s43 offen offset:512 nt
    buffer_load_dwordx4 v[104:107], v65, s[8:11], s43 offen offset:3072 nt
    buffer_load_dwordx4 v[108:111], v65, s[8:11], s43 offen offset:3328 nt
    buffer_load_dwordx4 v[112:115], v65, s[8:11], s43 offen offset:3584 nt
    v_cvt_f32_i32 v68, v68
    v_cvt_f32_i32 v69, v69
    v_cvt_f32_i32 v70, v70
    v_cvt_f32_i32 v71, v71
    v_fma_f32 v60, v68, v24, v7
    v_fmac_f32 v60, v69, v25
    v_fmac_f32 v60, v70, v26
    v_fmac_f32 v60, v71, v27
    v_cvt_f32_i32 v72, v72
    v_cvt_f32_i32 v73, v73
    v_cvt_f32_i32 v74, v74
    v_cvt_f32_i32 v75, v75
    v_fmac_f32 v60, v72, v28
    v_fmac_f32 v60, v73, v29
    v_fmac_f32 v60, v74, v30
    v_fmac_f32 v60, v75, v31
    v_cvt_f32_i32 v76, v76
    v_cvt_f32_i32 v77, v77
    v_cvt_f32_i32 v78, v78
    v_cvt_f32_i32 v79, v79
    v_fmac_f32 v60, v76, v32
    v_fmac_f32 v60, v77, v33
    v_fmac_f32 v60, v78, v34
    v_fmac_f32 v60, v79, v35
    v_cvt_f32_i32 v80, v80
    v_cvt_f32_i32 v81, v81
    v_add_f32_dpp v60, v60, v60 row_ror:8 row_mask:0xf bank_mask:0xf
    v_cvt_f32_i32 v82, v82
    v_cvt_f32_i32 v83, v83
    v_add_f32_dpp v60, v60, v60 row_ror:4 row_mask:0xf bank_mask:0xf
    v_fma_f32 v61, v80, v24, v7
    v_fmac_f32 v61, v81, v25
    v_add_f32_dpp v60, v60, v60 row_ror:2 row_mask:0xf bank_mask:0xf
    v_fmac_f32 v61, v82, v26
    v_fmac_f32 v61, v83, v27
    v_add_f32_dpp v60, v60, v60 row_ror:1 row_mask:0xf bank_mask:0xf
    v_cvt_f32_i32 v84, v84
    v_cvt_f32_i32 v85, v85
    v_cvt_f32_i32 v86, v86
    v_cvt_f32_i32 v87, v87
    v_fmac_f32 v61, v84, v28
    v_fmac_f32 v61, v85, v29
    v_fmac_f32 v61, v86, v30
    v_fmac_f32 v61, v87, v31
    v_cvt_f32_i32 v88, v88
    v_cvt_f32_i32 v89, v89
    v_cvt_f32_i32 v90, v90
    v_cvt_f32_i32 v91, v91
    v_fmac_f32 v61, v88, v32
    v_fmac_f32 v61, v89, v33
    v_fmac_f32 v61, v90, v34
    v_fmac_f32 v61, v91, v35
    s_waitcnt vmcnt(0)
    s_cmp_eq_u32 s56, 7
    v_add_f32_dpp v61, v61, v61 row_ror:8 row_mask:0xf bank_mask:0xf
    s_cselect_b32 s57, 1, 0
    s_cselect_b32 s50, 98304, 0
    v_add_f32_dpp v61, v61, v61 row_ror:4 row_mask:0xf bank_mask:0xf
    s_add_u32 s55, s55, s50
    s_add_u32 s55, s55, 4096
    v_add_f32_dpp v61, v61, v61 row_ror:2 row_mask:0xf bank_mask:0xf
    s_add_u32 s56, s56, 1
    s_and_b32 s56, s56, 7
    v_add_f32_dpp v61, v61, v61 row_ror:1 row_mask:0xf bank_mask:0xf
    s_mul_i32 s43, s55, 768
    s_lshr_b32 s45, s55, 6
    s_mul_i32 s45, s45, 384
    s_lshr_b32 s47, s55, 15
    s_mul_i32 s47, s47, 384
    buffer_load_dwordx2 v[36:37], v1, s[32:35], s47 offen offset:0
    buffer_load_dwordx2 v[38:39], v1, s[32:35], s47 offen offset:128
    buffer_load_dwordx2 v[40:41], v1, s[32:35], s47 offen offset:256
    buffer_load_dwordx2 v[42:43], v1, s[16:19], s45 offen offset:0
    buffer_load_dwordx2 v[44:45], v1, s[16:19], s45 offen offset:128
    buffer_load_dwordx2 v[46:47], v1, s[16:19], s45 offen offset:256
    buffer_load_dwordx2 v[48:49], v1, s[20:23], s45 offen offset:0
    buffer_load_dwordx2 v[50:51], v1, s[20:23], s45 offen offset:128
    buffer_load_dwordx2 v[52:53], v1, s[20:23], s45 offen offset:256
    buffer_load_dwordx4 v[68:71], v64, s[8:11], s43 offen offset:0 nt
    buffer_load_dwordx4 v[72:75], v64, s[8:11], s43 offen offset:256 nt
    buffer_load_dwordx4 v[76:79], v64, s[8:11], s43 offen offset:512 nt
    buffer_load_dwordx4 v[80:83], v64, s[8:11], s43 offen offset:3072 nt
    buffer_load_dwordx4 v[84:87], v64, s[8:11], s43 offen offset:3328 nt
    buffer_load_dwordx4 v[88:91], v64, s[8:11], s43 offen offset:3584 nt
    v_cvt_f32_i32 v92, v92
    v_cvt_f32_i32 v93, v93
    v_cvt_f32_i32 v94, v94
    v_cvt_f32_i32 v95, v95
    v_fma_f32 v62, v92, v24, v7
    v_fmac_f32 v62, v93, v25
    v_fmac_f32 v62, v94, v26
    v_fmac_f32 v62, v95, v27
    v_cvt_f32_i32 v96, v96
    v_cvt_f32_i32 v97, v97
    v_cvt_f32_i32 v98, v98
    v_cvt_f32_i32 v99, v99
    v_fmac_f32 v62, v96, v28
    v_fmac_f32 v62, v97, v29
    v_fmac_f32 v62, v98, v30
    v_fmac_f32 v62, v99, v31
    v_cvt_f32_i32 v100, v100
    v_cvt_f32_i32 v101, v101
    v_cvt_f32_i32 v102, v102
    v_cvt_f32_i32 v103, v103
    v_fmac_f32 v62, v100, v32
    v_fmac_f32 v62, v101, v33
    v_fmac_f32 v62, v102, v34
    v_fmac_f32 v62, v103, v35
    v_cvt_f32_i32 v104, v104
    v_cvt_f32_i32 v105, v105
    v_add_f32_dpp v62, v62, v62 row_ror:8 row_mask:0xf bank_mask:0xf
    v_cvt_f32_i32 v106, v106
    v_cvt_f32_i32 v107, v107
    v_add_f32_dpp v62, v62, v62 row_ror:4 row_mask:0xf bank_mask:0xf
    v_fma_f32 v63, v104, v24, v7
    v_fmac_f32 v63, v105, v25
    v_add_f32_dpp v62, v62, v62 row_ror:2 row_mask:0xf bank_mask:0xf
    v_fmac_f32 v63, v106, v26
    v_fmac_f32 v63, v107, v27
    v_add_f32_dpp v62, v62, v62 row_ror:1 row_mask:0xf bank_mask:0xf
    v_cvt_f32_i32 v108, v108
    v_cvt_f32_i32 v109, v109
    v_cvt_f32_i32 v110, v110
    v_cvt_f32_i32 v111, v111
    v_fmac_f32 v63, v108, v28
    v_fmac_f32 v63, v109, v29
    v_fmac_f32 v63, v110, v30
    v_fmac_f32 v63, v111, v31
    v_cvt_f32_i32 v112, v112
    v_cvt_f32_i32 v113, v113
    v_cvt_f32_i32 v114, v114
    v_cvt_f32_i32 v115, v115
    v_fmac_f32 v63, v112, v32
    v_fmac_f32 v63, v113, v33
    v_fmac_f32 v63, v114, v34
    v_fmac_f32 v63, v115, v35
    s_nop 1
    v_add_f32_dpp v63, v63, v63 row_ror:8 row_mask:0xf bank_mask:0xf
    s_nop 1
    v_add_f32_dpp v63, v63, v63 row_ror:4 row_mask:0xf bank_mask:0xf
    s_nop 1
    v_add_f32_dpp v63, v63, v63 row_ror:2 row_mask:0xf bank_mask:0xf
    s_nop 1
    v_add_f32_dpp v63, v63, v63 row_ror:1 row_mask:0xf bank_mask:0xf
    v_max3_f32 v4, v4, v60, v61
    v_max3_f32 v4, v4, v62, v63
    ds_write_b128 v3, v[60:63] offset:0
    v_add_u32 v3, 64, v3
    s_cmp_lg_u32 s57, 0
    s_cbranch_scc0 L_nomax1
    ds_write_b32 v55, v4
    v_add_u32 v55, 64, v55
    v_mov_b32 v4, 0xff7fffff
L_nomax1:
    s_nop 1
    s_waitcnt vmcnt(6)
    v_lshlrev_b32 v10, 16, v36
    v_lshlrev_b32 v24, 16, v42
    v_and_b32 v11, 0xffff0000, v36
    v_and_b32 v25, 0xffff0000, v42
    v_mul_f32 v24, v24, v10
    v_mul_f32 v25, v25, v11
    v_lshlrev_b32 v10, 16, v37
    v_lshlrev_b32 v26, 16, v43
    v_and_b32 v11, 0xffff0000, v37
    v_and_b32 v27, 0xffff0000, v43
    v_mul_f32 v26, v26, v10
    v_mul_f32 v27, v27, v11
    v_lshlrev_b32 v10, 16, v38
    v_lshlrev_b32 v28, 16, v44
    v_and_b32 v11, 0xffff0000, v38
    v_and_b32 v29, 0xffff0000, v44
    v_mul_f32 v28, v28, v10
    v_mul_f32 v29, v29, v11
    v_lshlrev_b32 v10, 16, v39
    v_lshlrev_b32 v30, 16, v45
    v_and_b32 v11, 0xffff0000, v39
    v_and_b32 v31, 0xffff0000, v45
    v_mul_f32 v30, v30, v10
    v_mul_f32 v31, v31, v11
    v_lshlrev_b32 v10, 16, v40
    v_lshlrev_b32 v32, 16, v46
    v_and_b32 v11, 0xffff0000, v40
    v_and_b32 v33, 0xffff0000, v46
    v_mul_f32 v32, v32, v10
    v_mul_f32 v33, v33, v11
    v_lshlrev_b32 v10, 16, v41
    v_lshlrev_b32 v34, 16, v47
    v_and_b32 v11, 0xffff0000, v41
    v_and_b32 v35, 0xffff0000, v47
    v_mul_f32 v34, v34, v10
    v_mul_f32 v35, v35, v11
    v_lshlrev_b32 v10, 16, v48
    v_and_b32 v11, 0xffff0000, v48
    v_mul_f32 v7, v10, v24
    v_fmac_f32 v7, v11, v25
    v_lshlrev_b32 v10, 16, v49
    v_and_b32 v11, 0xffff0000, v49
    v_fmac_f32 v7, v10, v26
    v_fmac_f32 v7, v11, v27
    v_lshlrev_b32 v10, 16, v50
    v_and_b32 v11, 0xffff0000, v50
    v_fmac_f32 v7, v10, v28
    v_fmac_f32 v7, v11, v29
    v_lshlrev_b32 v10, 16, v51
    v_and_b32 v11, 0xffff0000, v51
    v_fmac_f32 v7, v10, v30
    v_fmac_f32 v7, v11, v31
    v_lshlrev_b32 v10, 16, v52
    v_and_b32 v11, 0xffff0000, v52
    v_fmac_f32 v7, v10, v32
    v_fmac_f32 v7, v11, v33
    v_lshlrev_b32 v10, 16, v53
    v_and_b32 v11, 0xffff0000, v53
    v_fmac_f32 v7, v10, v34
    v_fmac_f32 v7, v11, v35
    v_sub_f32 v7, 0, v7
    s_sub_u32 s61, s61, 1
    s_cmp_lg_u32 s61, 0
    s_cbranch_scc1 L_kloop
    s_waitcnt vmcnt(0)
    buffer_load_dwordx4 v[92:95], v65, s[8:11], s43 offen offset:0 nt
    buffer_load_dwordx4 v[96:99], v65, s[8:11], s43 offen offset:256 nt
    buffer_load_dwordx4 v[100:103], v65, s[8:11], s43 offen offset:512 nt
    buffer_load_dwordx4 v[104:107], v65, s[8:11], s43 offen offset:3072 nt
    buffer_load_dwordx4 v[108:111], v65, s[8:11], s43 offen offset:3328 nt
    buffer_load_dwordx4 v[112:115], v65, s[8:11], s43 offen offset:3584 nt
    v_cvt_f32_i32 v68, v68
    v_cvt_f32_i32 v69, v69
    v_cvt_f32_i32 v70, v70
    v_cvt_f32_i32 v71, v71
    v_fma_f32 v60, v68, v24, v7
    v_fmac_f32 v60, v69, v25
    v_fmac_f32 v60, v70, v26
    v_fmac_f32 v60, v71, v27
    v_cvt_f32_i32 v72, v72
    v_cvt_f32_i32 v73, v73
    v_cvt_f32_i32 v74, v74
    v_cvt_f32_i32 v75, v75
    v_fmac_f32 v60, v72, v28
    v_fmac_f32 v60, v73, v29
    v_fmac_f32 v60, v74, v30
    v_fmac_f32 v60, v75, v31
    v_cvt_f32_i32 v76, v76
    v_cvt_f32_i32 v77, v77
    v_cvt_f32_i32 v78, v78
    v_cvt_f32_i32 v79, v79
    v_fmac_f32 v60, v76, v32
    v_fmac_f32 v60, v77, v33
    v_fmac_f32 v60, v78, v34
    v_fmac_f32 v60, v79, v35
    v_cvt_f32_i32 v80, v80
    v_cvt_f32_i32 v81, v81
    v_add_f32_dpp v60, v60, v60 row_ror:8 row_mask:0xf bank_mask:0xf
    v_cvt_f32_i32 v82, v82
    v_cvt_f32_i32 v83, v83
    v_add_f32_dpp v60, v60, v60 row_ror:4 row_mask:0xf bank_mask:0xf
    v_fma_f32 v61, v80, v24, v7
    v_fmac_f32 v61, v81, v25
    v_add_f32_dpp v60, v60, v60 row_ror:2 row_mask:0xf bank_mask:0xf
    v_fmac_f32 v61, v82, v26
    v_fmac_f32 v61, v83, v27
    v_add_f32_dpp v60, v60, v60 row_ror:1 row_mask:0xf bank_mask:0xf
    v_cvt_f32_i32 v84, v84
    v_cvt_f32_i32 v85, v85
    v_cvt_f32_i32 v86, v86
    v_cvt_f32_i32 v87, v87
    v_fmac_f32 v61, v84, v28
    v_fmac_f32 v61, v85, v29
    v_fmac_f32 v61, v86, v30
    v_fmac_f32 v61, v87, v31
    v_cvt_f32_i32 v88, v88
    v_cvt_f32_i32 v89, v89
    v_cvt_f32_i32 v90, v90
    v_cvt_f32_i32 v91, v91
    v_fmac_f32 v61, v88, v32
    v_fmac_f32 v61, v89, v33
    v_fmac_f32 v61, v90, v34
    v_fmac_f32 v61, v91, v35
    s_waitcnt vmcnt(0)
    s_mov_b32 s55, s44
    v_add_f32_dpp v61, v61, v61 row_ror:8 row_mask:0xf bank_mask:0xf
    s_mov_b32 s56, 0
    s_mul_i32 s43, s55, 768
    v_add_f32_dpp v61, v61, v61 row_ror:4 row_mask:0xf bank_mask:0xf
    s_lshl_b32 s46, s55, 1
    buffer_load_ushort v8, v2, s[24:27], s46 offen
    v_add_f32_dpp v61, v61, v61 row_ror:2 row_mask:0xf bank_mask:0xf
    buffer_load_ushort v9, v2, s[28:31], s46 offen
    buffer_load_dwordx4 v[68:71], v64, s[12:15], s43 offen offset:0 nt
    v_add_f32_dpp v61, v61, v61 row_ror:1 row_mask:0xf bank_mask:0xf
    buffer_load_dwordx4 v[72:75], v64, s[12:15], s43 offen offset:256 nt
    buffer_load_dwordx4 v[76:79], v64, s[12:15], s43 offen offset:512 nt
    buffer_load_dwordx4 v[80:83], v64, s[12:15], s43 offen offset:3072 nt
    buffer_load_dwordx4 v[84:87], v64, s[12:15], s43 offen offset:3328 nt
    buffer_load_dwordx4 v[88:91], v64, s[12:15], s43 offen offset:3584 nt
    v_cvt_f32_i32 v92, v92
    v_cvt_f32_i32 v93, v93
    v_cvt_f32_i32 v94, v94
    v_cvt_f32_i32 v95, v95
    v_fma_f32 v62, v92, v24, v7
    v_fmac_f32 v62, v93, v25
    v_fmac_f32 v62, v94, v26
    v_fmac_f32 v62, v95, v27
    v_cvt_f32_i32 v96, v96
    v_cvt_f32_i32 v97, v97
    v_cvt_f32_i32 v98, v98
    v_cvt_f32_i32 v99, v99
    v_fmac_f32 v62, v96, v28
    v_fmac_f32 v62, v97, v29
    v_fmac_f32 v62, v98, v30
    v_fmac_f32 v62, v99, v31
    v_cvt_f32_i32 v100, v100
    v_cvt_f32_i32 v101, v101
    v_cvt_f32_i32 v102, v102
    v_cvt_f32_i32 v103, v103
    v_fmac_f32 v62, v100, v32
    v_fmac_f32 v62, v101, v33
    v_fmac_f32 v62, v102, v34
    v_fmac_f32 v62, v103, v35
    v_cvt_f32_i32 v104, v104
    v_cvt_f32_i32 v105, v105
    v_add_f32_dpp v62, v62, v62 row_ror:8 row_mask:0xf bank_mask:0xf
    v_cvt_f32_i32 v106, v106
    v_cvt_f32_i32 v107, v107
    v_add_f32_dpp v62, v62, v62 row_ror:4 row_mask:0xf bank_mask:0xf
    v_fma_f32 v63, v104, v24, v7
    v_fmac_f32 v63, v105, v25
    v_add_f32_dpp v62, v62, v62 row_ror:2 row_mask:0xf bank_mask:0xf
    v_fmac_f32 v63, v106, v26
    v_fmac_f32 v63, v107, v27
    v_add_f32_dpp v62, v62, v62 row_ror:1 row_mask:0xf bank_mask:0xf
    v_cvt_f32_i32 v108, v108
    v_cvt_f32_i32 v109, v109
    v_cvt_f32_i32 v110, v110
    v_cvt_f32_i32 v111, v111
    v_fmac_f32 v63, v108, v28
    v_fmac_f32 v63, v109, v29
    v_fmac_f32 v63, v110, v30
    v_fmac_f32 v63, v111, v31
    v_cvt_f32_i32 v112, v112
    v_cvt_f32_i32 v113, v113
    v_cvt_f32_i32 v114, v114
    v_cvt_f32_i32 v115, v115
    v_fmac_f32 v63, v112, v32
    v_fmac_f32 v63, v113, v33
    v_fmac_f32 v63, v114, v34
    v_fmac_f32 v63, v115, v35
    s_nop 1
    v_add_f32_dpp v63, v63, v63 row_ror:8 row_mask:0xf bank_mask:0xf
    s_nop 1
    v_add_f32_dpp v63, v63, v63 row_ror:4 row_mask:0xf bank_mask:0xf
    s_nop 1
    v_add_f32_dpp v63, v63, v63 row_ror:2 row_mask:0xf bank_mask:0xf
    s_nop 1
    v_add_f32_dpp v63, v63, v63 row_ror:1 row_mask:0xf bank_mask:0xf
    v_max3_f32 v4, v4, v60, v61
    v_max3_f32 v4, v4, v62, v63
    ds_write_b128 v3, v[60:63] offset:0
    v_add_u32 v3, 64, v3
    ds_write_b32 v55, v4
    v_add_u32 v55, 64, v55
    v_mov_b32 v4, 0xff7fffff
    s_waitcnt lgkmcnt(0)
    ds_read_b32 v56, v54
    v_add_u32 v54, 64, v54
    v_mov_b32 v10, s62
    ds_read_b128 v[116:119], v10
    s_add_u32 s62, s62, 64
    v_mov_b32 v5, 0
    v_mov_b32 v6, 0
    v_mov_b32 v12, 0
    v_mov_b32 v13, 0
    v_mov_b32 v14, 0
    v_mov_b32 v15, 0
    v_mov_b32 v16, 0
    v_mov_b32 v17, 0
    v_mov_b32 v18, 0
    v_mov_b32 v19, 0
    v_mov_b32 v20, 0
    v_mov_b32 v21, 0
    v_mov_b32 v22, 0
    v_mov_b32 v23, 0
    s_waitcnt lgkmcnt(0)
    v_max3_f32 v10, v116, v117, v118
    v_max_f32 v10, v10, v119
    v_mul_f32 v4, s49, v10
    s_waitcnt vmcnt(6)
    s_waitcnt lgkmcnt(0)
    v_fma_f32 v10, v56, s48, v4
    v_lshlrev_b32 v8, 16, v8
    v_exp_f32 v10, v10
    v_lshlrev_b32 v9, 16, v9
    v_mul_f32 v57, v10, v8
    v_add_f32 v5, v5, v10
    v_fmac_f32 v6, v57, v9
.p2align 6
L_vloop:
    s_nop 1
    s_waitcnt vmcnt(0)
    buffer_load_dwordx4 v[92:95], v65, s[12:15], s43 offen offset:0 nt
    buffer_load_dwordx4 v[96:99], v65, s[12:15], s43 offen offset:256 nt
    buffer_load_dwordx4 v[100:103], v65, s[12:15], s43 offen offset:512 nt
    buffer_load_dwordx4 v[104:107], v65, s[12:15], s43 offen offset:3072 nt
    buffer_load_dwordx4 v[108:111], v65, s[12:15], s43 offen offset:3328 nt
    buffer_load_dwordx4 v[112:115], v65, s[12:15], s43 offen offset:3584 nt
    v_cvt_f32_i32 v68, v68
    v_cvt_f32_i32 v69, v69
    v_cvt_f32_i32 v70, v70
    v_cvt_f32_i32 v71, v71
    v_fmac_f32_dpp v12, v57, v68 row_newbcast:0 row_mask:0xf bank_mask:0xf
    v_fmac_f32_dpp v13, v57, v69 row_newbcast:0 row_mask:0xf bank_mask:0xf
    v_fmac_f32_dpp v14, v57, v70 row_newbcast:0 row_mask:0xf bank_mask:0xf
    v_fmac_f32_dpp v15, v57, v71 row_newbcast:0 row_mask:0xf bank_mask:0xf
    v_cvt_f32_i32 v72, v72
    v_cvt_f32_i32 v73, v73
    v_cvt_f32_i32 v74, v74
    v_cvt_f32_i32 v75, v75
    v_fmac_f32_dpp v16, v57, v72 row_newbcast:0 row_mask:0xf bank_mask:0xf
    v_fmac_f32_dpp v17, v57, v73 row_newbcast:0 row_mask:0xf bank_mask:0xf
    v_fmac_f32_dpp v18, v57, v74 row_newbcast:0 row_mask:0xf bank_mask:0xf
    v_fmac_f32_dpp v19, v57, v75 row_newbcast:0 row_mask:0xf bank_mask:0xf
    v_cvt_f32_i32 v76, v76
    v_cvt_f32_i32 v77, v77
    v_cvt_f32_i32 v78, v78
    v_cvt_f32_i32 v79, v79
    v_fmac_f32_dpp v20, v57, v76 row_newbcast:0 row_mask:0xf bank_mask:0xf
    v_fmac_f32_dpp v21, v57, v77 row_newbcast:0 row_mask:0xf bank_mask:0xf
    v_fmac_f32_dpp v22, v57, v78 row_newbcast:0 row_mask:0xf bank_mask:0xf
    v_fmac_f32_dpp v23, v57, v79 row_newbcast:0 row_mask:0xf bank_mask:0xf
    v_cvt_f32_i32 v80, v80
    v_cvt_f32_i32 v81, v81
    v_cvt_f32_i32 v82, v82
    v_cvt_f32_i32 v83, v83
    v_fmac_f32_dpp v12, v57, v80 row_newbcast:1 row_mask:0xf bank_mask:0xf
    v_fmac_f32_dpp v13, v57, v81 row_newbcast:1 row_mask:0xf bank_mask:0xf
    v_fmac_f32_dpp v14, v57, v82 row_newbcast:1 row_mask:0xf bank_mask:0xf
    v_fmac_f32_dpp v15, v57, v83 row_newbcast:1 row_mask:0xf bank_mask:0xf
    v_cvt_f32_i32 v84, v84
    v_cvt_f32_i32 v85, v85
    v_cvt_f32_i32 v86, v86
    v_cvt_f32_i32 v87, v87
    v_fmac_f32_dpp v16, v57, v84 row_newbcast:1 row_mask:0xf bank_mask:0xf
    v_fmac_f32_dpp v17, v57, v85 row_newbcast:1 row_mask:0xf bank_mask:0xf
    v_fmac_f32_dpp v18, v57, v86 row_newbcast:1 row_mask:0xf bank_mask:0xf
    v_fmac_f32_dpp v19, v57, v87 row_newbcast:1 row_mask:0xf bank_mask:0xf
    v_cvt_f32_i32 v88, v88
    v_cvt_f32_i32 v89, v89
    v_cvt_f32_i32 v90, v90
    v_cvt_f32_i32 v91, v91
    v_fmac_f32_dpp v20, v57, v88 row_newbcast:1 row_mask:0xf bank_mask:0xf
    v_fmac_f32_dpp v21, v57, v89 row_newbcast:1 row_mask:0xf bank_mask:0xf
    v_fmac_f32_dpp v22, v57, v90 row_newbcast:1 row_mask:0xf bank_mask:0xf
    v_fmac_f32_dpp v23, v57, v91 row_newbcast:1 row_mask:0xf bank_mask:0xf
    s_waitcnt vmcnt(0)
    s_cmp_eq_u32 s56, 7
    s_cselect_b32 s57, 1, 0
    s_cselect_b32 s50, 98304, 0
    s_add_u32 s55, s55, s50
    s_add_u32 s55, s55, 4096
    s_add_u32 s56, s56, 1
    s_and_b32 s56, s56, 7
    s_mul_i32 s43, s55, 768
    s_lshl_b32 s46, s55, 1
    buffer_load_ushort v8, v2, s[24:27], s46 offen
    buffer_load_ushort v9, v2, s[28:31], s46 offen
    buffer_load_dwordx4 v[68:71], v64, s[12:15], s43 offen offset:0 nt
    buffer_load_dwordx4 v[72:75], v64, s[12:15], s43 offen offset:256 nt
    buffer_load_dwordx4 v[76:79], v64, s[12:15], s43 offen offset:512 nt
    buffer_load_dwordx4 v[80:83], v64, s[12:15], s43 offen offset:3072 nt
    buffer_load_dwordx4 v[84:87], v64, s[12:15], s43 offen offset:3328 nt
    buffer_load_dwordx4 v[88:91], v64, s[12:15], s43 offen offset:3584 nt
    ds_read_b32 v56, v54
    v_add_u32 v54, 64, v54
    v_cvt_f32_i32 v92, v92
    v_cvt_f32_i32 v93, v93
    v_cvt_f32_i32 v94, v94
    v_cvt_f32_i32 v95, v95
    v_fmac_f32_dpp v12, v57, v92 row_newbcast:2 row_mask:0xf bank_mask:0xf
    v_fmac_f32_dpp v13, v57, v93 row_newbcast:2 row_mask:0xf bank_mask:0xf
    v_fmac_f32_dpp v14, v57, v94 row_newbcast:2 row_mask:0xf bank_mask:0xf
    v_fmac_f32_dpp v15, v57, v95 row_newbcast:2 row_mask:0xf bank_mask:0xf
    v_cvt_f32_i32 v96, v96
    v_cvt_f32_i32 v97, v97
    v_cvt_f32_i32 v98, v98
    v_cvt_f32_i32 v99, v99
    v_fmac_f32_dpp v16, v57, v96 row_newbcast:2 row_mask:0xf bank_mask:0xf
    v_fmac_f32_dpp v17, v57, v97 row_newbcast:2 row_mask:0xf bank_mask:0xf
    v_fmac_f32_dpp v18, v57, v98 row_newbcast:2 row_mask:0xf bank_mask:0xf
    v_fmac_f32_dpp v19, v57, v99 row_newbcast:2 row_mask:0xf bank_mask:0xf
    v_cvt_f32_i32 v100, v100
    v_cvt_f32_i32 v101, v101
    v_cvt_f32_i32 v102, v102
    v_cvt_f32_i32 v103, v103
    v_fmac_f32_dpp v20, v57, v100 row_newbcast:2 row_mask:0xf bank_mask:0xf
    v_fmac_f32_dpp v21, v57, v101 row_newbcast:2 row_mask:0xf bank_mask:0xf
    v_fmac_f32_dpp v22, v57, v102 row_newbcast:2 row_mask:0xf bank_mask:0xf
    v_fmac_f32_dpp v23, v57, v103 row_newbcast:2 row_mask:0xf bank_mask:0xf
    v_cvt_f32_i32 v104, v104
    v_cvt_f32_i32 v105, v105
    v_cvt_f32_i32 v106, v106
    v_cvt_f32_i32 v107, v107
    v_fmac_f32_dpp v12, v57, v104 row_newbcast:3 row_mask:0xf bank_mask:0xf
    v_fmac_f32_dpp v13, v57, v105 row_newbcast:3 row_mask:0xf bank_mask:0xf
    v_fmac_f32_dpp v14, v57, v106 row_newbcast:3 row_mask:0xf bank_mask:0xf
    v_fmac_f32_dpp v15, v57, v107 row_newbcast:3 row_mask:0xf bank_mask:0xf
    v_cvt_f32_i32 v108, v108
    v_cvt_f32_i32 v109, v109
    v_cvt_f32_i32 v110, v110
    v_cvt_f32_i32 v111, v111
    v_fmac_f32_dpp v16, v57, v108 row_newbcast:3 row_mask:0xf bank_mask:0xf
    v_fmac_f32_dpp v17, v57, v109 row_newbcast:3 row_mask:0xf bank_mask:0xf
    v_fmac_f32_dpp v18, v57, v110 row_newbcast:3 row_mask:0xf bank_mask:0xf
    v_fmac_f32_dpp v19, v57, v111 row_newbcast:3 row_mask:0xf bank_mask:0xf
    v_cvt_f32_i32 v112, v112
    v_cvt_f32_i32 v113, v113
    v_cvt_f32_i32 v114, v114
    v_cvt_f32_i32 v115, v115
    v_fmac_f32_dpp v20, v57, v112 row_newbcast:3 row_mask:0xf bank_mask:0xf
    v_fmac_f32_dpp v21, v57, v113 row_newbcast:3 row_mask:0xf bank_mask:0xf
    v_fmac_f32_dpp v22, v57, v114 row_newbcast:3 row_mask:0xf bank_mask:0xf
    v_fmac_f32_dpp v23, v57, v115 row_newbcast:3 row_mask:0xf bank_mask:0xf
    s_cmp_lg_u32 s57, 0
    s_cbranch_scc1 L_dump
L_cont:
    s_nop 1
    s_waitcnt vmcnt(6)
    s_waitcnt lgkmcnt(0)
    v_fma_f32 v10, v56, s48, v4
    v_lshlrev_b32 v8, 16, v8
    v_exp_f32 v10, v10
    v_lshlrev_b32 v9, 16, v9
    v_mul_f32 v57, v10, v8
    v_add_f32 v5, v5, v10
    v_fmac_f32 v6, v57, v9
    s_branch L_vloop
L_dump:
    s_nop 1
    v_mov_b32 v10, s62
    ds_read_b128 v[160:163], v10
    s_add_u32 s62, s62, 64
    v_add_f32_dpp v5, v5, v5 row_ror:8 row_mask:0xf bank_mask:0xf
    v_add_f32_dpp v6, v6, v6 row_ror:8 row_mask:0xf bank_mask:0xf
    s_nop 0
    v_add_f32_dpp v5, v5, v5 row_ror:4 row_mask:0xf bank_mask:0xf
    v_add_f32_dpp v6, v6, v6 row_ror:4 row_mask:0xf bank_mask:0xf
    s_nop 0
    v_add_f32_dpp v5, v5, v5 row_ror:2 row_mask:0xf bank_mask:0xf
    v_add_f32_dpp v6, v6, v6 row_ror:2 row_mask:0xf bank_mask:0xf
    s_nop 0
    v_add_f32_dpp v5, v5, v5 row_ror:1 row_mask:0xf bank_mask:0xf
    v_add_f32_dpp v6, v6, v6 row_ror:1 row_mask:0xf bank_mask:0xf
    v_mul_f32 v5, 0x3e800000, v5
    v_mul_f32 v6, 0x3e800000, v6
    v_sub_f32 v4, 0, v4
    v_sub_f32 v12, v12, v6
    v_sub_f32 v13, v13, v6
    v_sub_f32 v14, v14, v6
    v_sub_f32 v15, v15, v6
    v_sub_f32 v16, v16, v6
    v_sub_f32 v17, v17, v6
    v_sub_f32 v18, v18, v6
    v_sub_f32 v19, v19, v6
    v_sub_f32 v20, v20, v6
    v_sub_f32 v21, v21, v6
    v_sub_f32 v22, v22, v6
    v_sub_f32 v23, v23, v6
    s_mul_i32 s50, s58, 3200
    s_add_u32 s50, s50, 17024
    v_permlane32_swap_b32 v12, v14
    v_permlane32_swap_b32 v13, v15
    v_permlane32_swap_b32 v16, v18
    v_permlane32_swap_b32 v17, v19
    v_permlane32_swap_b32 v20, v22
    v_permlane32_swap_b32 v21, v23
    v_lshrrev_b32 v11, 4, v0
    v_lshlrev_b32 v11, 3, v11
    v_add_f32 v12, v12, v14
    v_add_f32 v13, v13, v15
    v_add_f32 v16, v16, v18
    v_add_f32 v17, v17, v19
    v_add_f32 v20, v20, v22
    v_add_f32 v21, v21, v23
    v_add_u32 v11, s50, v11
    ds_write_b64 v11, v[4:5] offset:3072
    v_permlane16_swap_b32 v12, v13
    v_permlane16_swap_b32 v16, v17
    v_permlane16_swap_b32 v20, v21
    v_add_u32 v10, s59, v58
    s_lshl_b32 s51, s58, 2
    v_add_f32 v12, v12, v13
    ds_write_b32 v10, v12 offset:0
    v_add_f32 v16, v16, v17
    ds_write_b32 v10, v16 offset:256
    v_add_f32 v20, v20, v21
    ds_write_b32 v10, v20 offset:512
    v_mov_b32 v10, s51
    v_mov_b32 v11, 1
    s_mov_b64 exec, 1
    ds_add_rtn_u32 v164, v10, v11 offset:0
    s_mov_b64 exec, -1
    s_sub_u32 s51, s58, 1
    s_cbranch_scc1 L_noduty
    s_and_b32 s52, s51, 3
    s_cmp_lg_u32 s52, s42
    s_cbranch_scc1 L_noduty
    s_sub_u32 s4, s50, 3200
    s_sub_u32 s5, s60, 262144
    s_lshl_b32 s6, s51, 2
    s_mov_b32 s7, 0
L_merge:
    s_nop 1
    v_mov_b32 v10, s6
    ds_read_b32 v7, v10 offset:0
    v_mov_b32 v10, s4
    ds_read_b128 v[116:119], v10 offset:3072
    ds_read_b128 v[120:123], v10 offset:3088
    ds_read_b128 v[124:127], v10 offset:3104
    ds_read_b128 v[128:131], v10 offset:3120
    ds_read_b128 v[132:135], v10 offset:3136
    ds_read_b128 v[136:139], v10 offset:3152
    ds_read_b128 v[140:143], v10 offset:3168
    ds_read_b128 v[144:147], v10 offset:3184
    v_and_b32 v11, 63, v0
    v_lshlrev_b32 v11, 2, v11
    v_add_u32 v10, s4, v11
    s_waitcnt lgkmcnt(4)
    ds_read_b32 v148, v10 offset:0
    ds_read_b32 v149, v10 offset:768
    ds_read_b32 v150, v10 offset:1536
    ds_read_b32 v151, v10 offset:2304
    ds_read_b32 v152, v10 offset:256
    ds_read_b32 v153, v10 offset:1024
    ds_read_b32 v154, v10 offset:1792
    ds_read_b32 v155, v10 offset:2560
    s_waitcnt lgkmcnt(4)
    ds_read_b32 v156, v10 offset:512
    ds_read_b32 v157, v10 offset:1280
    ds_read_b32 v158, v10 offset:2048
    ds_read_b32 v159, v10 offset:2816
    v_readfirstlane_b32 s52, v7
    s_nop 3
    s_cmp_lg_u32 s52, 4
    s_waitcnt lgkmcnt(0)
    s_cbranch_scc1 L_merge
    v_add_f32 v117, v117, v119
    v_add_f32 v121, v121, v123
    v_add_f32 v117, v117, v121
    v_add_f32 v125, v125, v127
    v_add_f32 v129, v129, v131
    v_add_f32 v125, v125, v129
    v_add_f32 v133, v133, v135
    v_add_f32 v137, v137, v139
    v_add_f32 v133, v133, v137
    v_add_f32 v141, v141, v143
    v_add_f32 v145, v145, v147
    v_add_f32 v141, v141, v145
    v_mov_b32 v4, v116
    v_max_f32 v4, v4, v124
    v_max_f32 v4, v4, v132
    v_max_f32 v4, v4, v140
    v_sub_f32 v116, v116, v4
    v_sub_f32 v124, v124, v4
    v_sub_f32 v132, v132, v4
    v_sub_f32 v140, v140, v4
    v_exp_f32 v116, v116
    v_exp_f32 v124, v124
    v_exp_f32 v132, v132
    v_exp_f32 v140, v140
    v_mul_f32 v5, v116, v117
    v_fmac_f32 v5, v124, v125
    v_fmac_f32 v5, v132, v133
    v_fmac_f32 v5, v140, v141
    v_mul_f32 v12, v116, v148
    v_fmac_f32 v12, v124, v149
    v_fmac_f32 v12, v132, v150
    v_fmac_f32 v12, v140, v151
    buffer_store_dword v12, v11, s[36:39], s5 offen offset:0
    v_mul_f32 v13, v116, v152
    v_fmac_f32 v13, v124, v153
    v_fmac_f32 v13, v132, v154
    v_fmac_f32 v13, v140, v155
    buffer_store_dword v13, v11, s[36:39], s5 offen offset:256
    v_mul_f32 v14, v116, v156
    v_fmac_f32 v14, v124, v157
    v_fmac_f32 v14, v132, v158
    v_fmac_f32 v14, v140, v159
    buffer_store_dword v14, v11, s[36:39], s5 offen offset:512
    s_mov_b64 exec, 1
    buffer_store_dwordx2 v[4:5], v11, s[36:39], s5 offen offset:768
    s_mov_b64 exec, -1
    s_cmp_lg_u32 s7, 0
    s_cbranch_scc1 L_done
L_noduty:
    s_nop 1
    s_waitcnt lgkmcnt(0)
    s_add_u32 s58, s58, 1
    s_cmp_ge_u32 s58, 8
    s_cbranch_scc1 L_final
    s_add_u32 s59, s59, 3200
    s_add_u32 s60, s60, 262144
    v_max3_f32 v10, v160, v161, v162
    v_mov_b32 v5, 0
    v_mov_b32 v6, 0
    v_max_f32 v10, v10, v163
    v_mov_b32 v12, 0
    v_mov_b32 v13, 0
    v_mov_b32 v14, 0
    v_mov_b32 v15, 0
    v_mov_b32 v16, 0
    v_mov_b32 v17, 0
    v_mov_b32 v18, 0
    v_mov_b32 v19, 0
    v_mov_b32 v20, 0
    v_mov_b32 v21, 0
    v_mov_b32 v22, 0
    v_mov_b32 v23, 0
    v_mul_f32 v4, s49, v10
    s_branch L_cont
L_final:
    s_nop 1
    v_readfirstlane_b32 s52, v164
    s_mov_b32 s4, 39424
    s_mov_b32 s5, s60
    s_mov_b32 s6, 28
    s_mov_b32 s7, 1
    s_cmp_eq_u32 s52, 3
    s_cbranch_scc1 L_merge
L_done:
    s_nop 1
L_exit1:
    s_endpgm
.globl standalone__kv_cache_quant_int4_int2_kv_with_per_channel_or_per_token_scales__decode_kernel
.p2align 8
.type standalone__kv_cache_quant_int4_int2_kv_with_per_channel_or_per_token_scales__decode_kernel,@function
standalone__kv_cache_quant_int4_int2_kv_with_per_channel_or_per_token_scales__decode_kernel:
    s_cmp_ge_u32 s2, 96
    s_cbranch_scc1 L_exit2
    s_load_dwordx2 s[4:5], s[0:1], 56
    s_load_dwordx2 s[6:7], s[0:1], 72
    v_lshrrev_b32 v3, 6, v0
    v_and_b32 v1, 63, v0
    v_readfirstlane_b32 s18, v3
    v_lshlrev_b32 v1, 2, v1
    v_mov_b32 v2, 0
    s_and_b32 s19, s2, 31
    s_lshr_b32 s20, s2, 5
    s_mul_i32 s16, s19, 64
    s_mul_i32 s17, s18, 16
    s_add_u32 s16, s16, s17
    s_mul_i32 s16, s16, 1024
    s_lshl_b32 s21, s20, 8
    v_add_u32 v4, s21, v1
    s_mov_b32 s10, 2097152
    s_mov_b32 s11, 0x00020000
    s_mov_b32 s14, 12288
    s_mov_b32 s15, 0x00020000
    s_waitcnt lgkmcnt(0)
    s_mov_b32 s8, s6
    s_and_b32 s9, s7, 0xffff
    s_mov_b32 s12, s4
    s_and_b32 s13, s5, 0xffff
    s_add_u32 s17, s16, 0
    buffer_load_dwordx2 v[8:9], v2, s[8:11], s17 offen offset:768
    buffer_load_dword v40, v4, s[8:11], s17 offen offset:0
    buffer_load_dwordx2 v[10:11], v2, s[8:11], s17 offen offset:1792
    buffer_load_dword v41, v4, s[8:11], s17 offen offset:1024
    buffer_load_dwordx2 v[12:13], v2, s[8:11], s17 offen offset:2816
    buffer_load_dword v42, v4, s[8:11], s17 offen offset:2048
    buffer_load_dwordx2 v[14:15], v2, s[8:11], s17 offen offset:3840
    buffer_load_dword v43, v4, s[8:11], s17 offen offset:3072
    s_add_u32 s17, s16, 4096
    buffer_load_dwordx2 v[16:17], v2, s[8:11], s17 offen offset:768
    buffer_load_dword v44, v4, s[8:11], s17 offen offset:0
    buffer_load_dwordx2 v[18:19], v2, s[8:11], s17 offen offset:1792
    buffer_load_dword v45, v4, s[8:11], s17 offen offset:1024
    buffer_load_dwordx2 v[20:21], v2, s[8:11], s17 offen offset:2816
    buffer_load_dword v46, v4, s[8:11], s17 offen offset:2048
    buffer_load_dwordx2 v[22:23], v2, s[8:11], s17 offen offset:3840
    buffer_load_dword v47, v4, s[8:11], s17 offen offset:3072
    s_add_u32 s17, s16, 8192
    buffer_load_dwordx2 v[24:25], v2, s[8:11], s17 offen offset:768
    buffer_load_dword v48, v4, s[8:11], s17 offen offset:0
    buffer_load_dwordx2 v[26:27], v2, s[8:11], s17 offen offset:1792
    buffer_load_dword v49, v4, s[8:11], s17 offen offset:1024
    buffer_load_dwordx2 v[28:29], v2, s[8:11], s17 offen offset:2816
    buffer_load_dword v50, v4, s[8:11], s17 offen offset:2048
    buffer_load_dwordx2 v[30:31], v2, s[8:11], s17 offen offset:3840
    buffer_load_dword v51, v4, s[8:11], s17 offen offset:3072
    s_add_u32 s17, s16, 12288
    buffer_load_dwordx2 v[32:33], v2, s[8:11], s17 offen offset:768
    buffer_load_dword v52, v4, s[8:11], s17 offen offset:0
    buffer_load_dwordx2 v[34:35], v2, s[8:11], s17 offen offset:1792
    buffer_load_dword v53, v4, s[8:11], s17 offen offset:1024
    buffer_load_dwordx2 v[36:37], v2, s[8:11], s17 offen offset:2816
    buffer_load_dword v54, v4, s[8:11], s17 offen offset:2048
    buffer_load_dwordx2 v[38:39], v2, s[8:11], s17 offen offset:3840
    buffer_load_dword v55, v4, s[8:11], s17 offen offset:3072
    s_waitcnt vmcnt(0)
    v_mov_b32 v4, v8
    v_max_f32 v4, v4, v10
    v_max_f32 v4, v4, v12
    v_max_f32 v4, v4, v14
    v_max_f32 v4, v4, v16
    v_max_f32 v4, v4, v18
    v_max_f32 v4, v4, v20
    v_max_f32 v4, v4, v22
    v_max_f32 v4, v4, v24
    v_max_f32 v4, v4, v26
    v_max_f32 v4, v4, v28
    v_max_f32 v4, v4, v30
    v_max_f32 v4, v4, v32
    v_max_f32 v4, v4, v34
    v_max_f32 v4, v4, v36
    v_max_f32 v4, v4, v38
    v_sub_f32 v8, v8, v4
    v_sub_f32 v10, v10, v4
    v_sub_f32 v12, v12, v4
    v_sub_f32 v14, v14, v4
    v_sub_f32 v16, v16, v4
    v_sub_f32 v18, v18, v4
    v_sub_f32 v20, v20, v4
    v_sub_f32 v22, v22, v4
    v_sub_f32 v24, v24, v4
    v_sub_f32 v26, v26, v4
    v_sub_f32 v28, v28, v4
    v_sub_f32 v30, v30, v4
    v_sub_f32 v32, v32, v4
    v_sub_f32 v34, v34, v4
    v_sub_f32 v36, v36, v4
    v_sub_f32 v38, v38, v4
    v_exp_f32 v8, v8
    v_exp_f32 v10, v10
    v_exp_f32 v12, v12
    v_exp_f32 v14, v14
    v_exp_f32 v16, v16
    v_exp_f32 v18, v18
    v_exp_f32 v20, v20
    v_exp_f32 v22, v22
    v_exp_f32 v24, v24
    v_exp_f32 v26, v26
    v_exp_f32 v28, v28
    v_exp_f32 v30, v30
    v_exp_f32 v32, v32
    v_exp_f32 v34, v34
    v_exp_f32 v36, v36
    v_exp_f32 v38, v38
    v_mul_f32 v5, v8, v9
    v_mul_f32 v6, v8, v40
    v_fmac_f32 v5, v10, v11
    v_fmac_f32 v6, v10, v41
    v_fmac_f32 v5, v12, v13
    v_fmac_f32 v6, v12, v42
    v_fmac_f32 v5, v14, v15
    v_fmac_f32 v6, v14, v43
    v_fmac_f32 v5, v16, v17
    v_fmac_f32 v6, v16, v44
    v_fmac_f32 v5, v18, v19
    v_fmac_f32 v6, v18, v45
    v_fmac_f32 v5, v20, v21
    v_fmac_f32 v6, v20, v46
    v_fmac_f32 v5, v22, v23
    v_fmac_f32 v6, v22, v47
    v_fmac_f32 v5, v24, v25
    v_fmac_f32 v6, v24, v48
    v_fmac_f32 v5, v26, v27
    v_fmac_f32 v6, v26, v49
    v_fmac_f32 v5, v28, v29
    v_fmac_f32 v6, v28, v50
    v_fmac_f32 v5, v30, v31
    v_fmac_f32 v6, v30, v51
    v_fmac_f32 v5, v32, v33
    v_fmac_f32 v6, v32, v52
    v_fmac_f32 v5, v34, v35
    v_fmac_f32 v6, v34, v53
    v_fmac_f32 v5, v36, v37
    v_fmac_f32 v6, v36, v54
    v_fmac_f32 v5, v38, v39
    v_fmac_f32 v6, v38, v55
    v_lshlrev_b32 v7, 2, v0
    ds_write_b32 v7, v6
    v_lshlrev_b32 v7, 3, v3
    ds_write_b64 v7, v[4:5] offset:1024
    s_waitcnt lgkmcnt(0)
    s_barrier
    s_cmp_lg_u32 s18, 0
    s_cbranch_scc1 L_exit2
    ds_read_b64 v[8:9], v2 offset:1024
    ds_read_b32 v40, v1 offset:0
    ds_read_b64 v[10:11], v2 offset:1032
    ds_read_b32 v41, v1 offset:256
    ds_read_b64 v[12:13], v2 offset:1040
    ds_read_b32 v42, v1 offset:512
    ds_read_b64 v[14:15], v2 offset:1048
    ds_read_b32 v43, v1 offset:768
    s_waitcnt lgkmcnt(4)
    s_waitcnt lgkmcnt(0)
    v_mov_b32 v4, v8
    v_max_f32 v4, v4, v10
    v_max_f32 v4, v4, v12
    v_max_f32 v4, v4, v14
    v_sub_f32 v8, v8, v4
    v_sub_f32 v10, v10, v4
    v_sub_f32 v12, v12, v4
    v_sub_f32 v14, v14, v4
    v_exp_f32 v8, v8
    v_exp_f32 v10, v10
    v_exp_f32 v12, v12
    v_exp_f32 v14, v14
    v_mul_f32 v5, v8, v9
    v_mul_f32 v6, v8, v40
    v_fmac_f32 v5, v10, v11
    v_fmac_f32 v6, v10, v41
    v_fmac_f32 v5, v12, v13
    v_fmac_f32 v6, v12, v42
    v_fmac_f32 v5, v14, v15
    v_fmac_f32 v6, v14, v43
    v_rcp_f32 v5, v5
    s_nop 0
    v_mul_f32 v6, v6, v5
    v_cvt_pk_bf16_f32 v6, v6, v6
    s_mul_i32 s16, s19, 384
    s_lshl_b32 s21, s20, 7
    s_add_u32 s16, s16, s21
    v_lshrrev_b32 v1, 1, v1
    buffer_store_short v6, v1, s[12:15], s16 offen
L_exit2:
    s_endpgm
.section .rodata,"a"
.p2align 6
.amdhsa_kernel part_kernel
  .amdhsa_next_free_vgpr 165
  .amdhsa_next_free_sgpr 92
  .amdhsa_accum_offset 168
  .amdhsa_group_segment_fixed_size 0
  .amdhsa_kernarg_size 80
  .amdhsa_user_sgpr_count 2
  .amdhsa_user_sgpr_kernarg_segment_ptr 1
  .amdhsa_system_sgpr_workgroup_id_x 1
.end_amdhsa_kernel
.p2align 6
.amdhsa_kernel standalone__kv_cache_quant_int4_int2_kv_with_per_channel_or_per_token_scales__decode_kernel
  .amdhsa_next_free_vgpr 56
  .amdhsa_next_free_sgpr 24
  .amdhsa_accum_offset 56
  .amdhsa_group_segment_fixed_size 0
  .amdhsa_kernarg_size 80
  .amdhsa_user_sgpr_count 2
  .amdhsa_user_sgpr_kernarg_segment_ptr 1
  .amdhsa_system_sgpr_workgroup_id_x 1
.end_amdhsa_kernel
```

```asm
; @launch kernel=part_kernel grid=(256,1,1) block=(448,1,1) lds=58624
; @launch kernel=standalone__kv_cache_quant_int4_int2_kv_with_per_channel_or_per_token_scales__decode_kernel grid=(32,1,1) block=(192,1,1) lds=0
.amdgcn_target "amdgcn-amd-amdhsa--gfx950"
.text
.globl part_kernel
.p2align 8
.type part_kernel,@function
part_kernel:
    s_cmp_ge_u32 s2, 256
    s_cbranch_scc1 L_exit1
    s_load_dwordx16 s[64:79], s[0:1], 0
    s_load_dwordx4 s[80:83], s[0:1], 64
    v_lshrrev_b32 v10, 6, v0
    v_and_b32 v11, 63, v0
    v_readfirstlane_b32 s28, v10
    s_lshr_b32 s3, s2, 3
    s_and_b32 s4, s2, 7
    s_lshr_b32 s32, s2, 6
    s_xor_b32 s32, s32, s4
    s_lshr_b32 s48, s32, 1
    s_and_b32 s32, s32, 1
    s_lshl_b32 s32, s32, 2
    s_or_b32 s48, s48, s32
    s_cmp_ge_u32 s28, 4
    s_cbranch_scc1 L_helper
    v_lshrrev_b32 v1, 4, v11
    v_and_b32 v52, 15, v11
    v_lshlrev_b32 v2, 4, v52
    v_lshlrev_b32 v3, 3, v52
    v_lshlrev_b32 v62, 7, v1
    v_and_b32 v63, 0x70, v0
    v_or_b32 v63, v63, v62
    v_mov_b32 v50, v63
    s_mov_b32 s45, 768
    s_mov_b32 s46, 384
    s_mov_b32 s47, 0xaaaaaaab
    v_mov_b32 v51, 0xc0000000
    s_lshl_b32 s44, s3, 6
    s_mov_b32 s5, s48
    s_mov_b32 s29, s28
    s_lshr_b32 s33, s29, 6
    s_lshl_b32 s33, s33, 11
    s_and_b32 s32, s29, 63
    s_add_u32 s32, s32, s33
    s_add_u32 s32, s32, s44
    s_bfe_u32 s33, s32, 0x20003
    s_and_b32 s34, s32, 4
    s_or_b32 s33, s33, s34
    s_xor_b32 s33, s33, s5
    s_lshl_b32 s50, s32, 5
    s_or_b32 s50, s50, s33
    s_lshl_b32 s50, s50, 4
    s_or_b32 s50, s50, 1
    v_xor_b32 v10, s50, v50
    v_mul_hi_u32 v10, v10, s47
    v_lshrrev_b32 v10, 1, v10
    v_and_b32 v11, 15, v10
    v_cmp_eq_u32 vcc, 5, v11
    v_mad_u32_u24 v48, v10, s45, v2
    v_add_u32 v11, 3840, v48
    v_cndmask_b32 v49, v51, v11, vcc
    v_lshrrev_b32 v10, 6, v10
    v_mad_u32_u24 v9, v10, s46, v3
    s_waitcnt lgkmcnt(0)
    s_mov_b32 s8, s66
    s_and_b32 s9, s67, 0xffff
    s_mov_b32 s10, 805306368
    s_mov_b32 s11, 0x00020000
    buffer_load_dwordx4 v[64:67], v48, s[8:11], 0 offen offset:0 nt
    buffer_load_dwordx4 v[68:71], v48, s[8:11], 0 offen offset:256 nt
    buffer_load_dwordx4 v[72:75], v48, s[8:11], 0 offen offset:512 nt
    buffer_load_dwordx4 v[76:79], v48, s[8:11], 0 offen offset:768 nt
    buffer_load_dwordx4 v[80:83], v48, s[8:11], 0 offen offset:1024 nt
    buffer_load_dwordx4 v[84:87], v48, s[8:11], 0 offen offset:1280 nt
    s_mov_b32 s30, 0
    s_mov_b32 s20, s64
    s_and_b32 s21, s65, 0xffff
    s_mov_b32 s22, 12288
    s_mov_b32 s23, 0x00020000
    s_lshl_b32 s31, s30, 5
    s_add_u32 s31, s31, s3
    s_mul_i32 s31, s31, 171
    s_lshr_b32 s31, s31, 9
    s_mul_i32 s31, s31, 384
    buffer_load_dwordx2 v[36:37], v3, s[20:23], s31 offen offset:0
    buffer_load_dwordx2 v[38:39], v3, s[20:23], s31 offen offset:128
    buffer_load_dwordx2 v[40:41], v3, s[20:23], s31 offen offset:256
    s_mov_b32 s16, s70
    s_and_b32 s17, s71, 0xffff
    s_mov_b32 s18, 6291456
    s_mov_b32 s19, 0x00020000
    buffer_load_dwordx2 v[42:43], v9, s[16:19], 0 offen offset:0
    buffer_load_dwordx2 v[44:45], v9, s[16:19], 0 offen offset:128
    buffer_load_dwordx2 v[46:47], v9, s[16:19], 0 offen offset:256
    s_mov_b32 s12, s68
    s_and_b32 s13, s69, 0xffff
    s_mov_b32 s14, 805306368
    s_mov_b32 s15, 0x00020000
    v_lshlrev_b32 v11, 5, v1
    v_lshrrev_b32 v4, 2, v52
    v_lshl_add_u32 v4, v4, 3, v11
    s_lshl_b32 s32, s28, 7
    s_add_u32 s32, s32, 256
    v_add_u32 v4, s32, v4
    v_and_b32 v5, 7, v52
    v_lshl_add_u32 v5, v5, 2, v11
    v_add_u32 v5, 24832, v5
    v_lshlrev_b32 v8, 2, v1
    v_add_u32 v8, v2, v8
    s_mul_i32 s32, s28, 768
    s_add_u32 s32, s32, 49408
    v_add_u32 v8, s32, v8
    v_mov_b32 v53, 0
    v_mov_b32 v60, 0
    v_mov_b32 v61, 0
    s_mov_b32 s42, 0x11111111
    s_mov_b32 s43, 0x11111111
    s_mov_b32 s40, 0x30418
    s_mov_b32 s41, 0x3
    v_mov_b32 v12, 0
    v_mov_b32 v13, 0
    v_mov_b32 v14, 0
    v_mov_b32 v15, 0
    v_mov_b32 v16, 0
    v_mov_b32 v17, 0
    v_mov_b32 v18, 0
    v_mov_b32 v19, 0
    v_mov_b32 v20, 0
    v_mov_b32 v21, 0
    v_mov_b32 v22, 0
    v_mov_b32 v23, 0
    s_barrier
    s_waitcnt vmcnt(0)
    v_lshlrev_b32 v10, 16, v36
    v_lshlrev_b32 v24, 16, v42
    v_and_b32 v11, 0xffff0000, v36
    v_and_b32 v25, 0xffff0000, v42
    v_mul_f32 v24, v24, v10
    v_mul_f32 v25, v25, v11
    v_lshlrev_b32 v10, 16, v37
    v_lshlrev_b32 v26, 16, v43
    v_and_b32 v11, 0xffff0000, v37
    v_and_b32 v27, 0xffff0000, v43
    v_mul_f32 v26, v26, v10
    v_mul_f32 v27, v27, v11
    v_lshlrev_b32 v10, 16, v38
    v_lshlrev_b32 v28, 16, v44
    v_and_b32 v11, 0xffff0000, v38
    v_and_b32 v29, 0xffff0000, v44
    v_mul_f32 v28, v28, v10
    v_mul_f32 v29, v29, v11
    v_lshlrev_b32 v10, 16, v39
    v_lshlrev_b32 v30, 16, v45
    v_and_b32 v11, 0xffff0000, v39
    v_and_b32 v31, 0xffff0000, v45
    v_mul_f32 v30, v30, v10
    v_mul_f32 v31, v31, v11
    v_lshlrev_b32 v10, 16, v40
    v_lshlrev_b32 v32, 16, v46
    v_and_b32 v11, 0xffff0000, v40
    v_and_b32 v33, 0xffff0000, v46
    v_mul_f32 v32, v32, v10
    v_mul_f32 v33, v33, v11
    v_lshlrev_b32 v10, 16, v41
    v_lshlrev_b32 v34, 16, v47
    v_and_b32 v11, 0xffff0000, v41
    v_and_b32 v35, 0xffff0000, v47
    v_mul_f32 v34, v34, v10
    v_mul_f32 v35, v35, v11
.p2align 6
L_kloop:
    s_nop 1
    s_waitcnt vmcnt(0)
    buffer_load_dwordx4 v[88:91], v48, s[8:11], 0 offen offset:1536 nt
    buffer_load_dwordx4 v[92:95], v48, s[8:11], 0 offen offset:1792 nt
    buffer_load_dwordx4 v[96:99], v48, s[8:11], 0 offen offset:2048 nt
    buffer_load_dwordx4 v[100:103], v48, s[8:11], 0 offen offset:2304 nt
    buffer_load_dwordx4 v[104:107], v48, s[8:11], 0 offen offset:2560 nt
    buffer_load_dwordx4 v[108:111], v48, s[8:11], 0 offen offset:2816 nt
    v_cvt_f32_i32 v64, v64
    v_cvt_f32_i32 v65, v65
    v_cvt_f32_i32 v66, v66
    v_cvt_f32_i32 v67, v67
    v_mul_f32 v54, v64, v24
    v_fmac_f32 v54, v65, v25
    v_fmac_f32 v54, v66, v26
    v_fmac_f32 v54, v67, v27
    v_cvt_f32_i32 v68, v68
    v_cvt_f32_i32 v69, v69
    v_cvt_f32_i32 v70, v70
    v_cvt_f32_i32 v71, v71
    v_fmac_f32 v54, v68, v28
    v_fmac_f32 v54, v69, v29
    v_fmac_f32 v54, v70, v30
    v_fmac_f32 v54, v71, v31
    v_cvt_f32_i32 v72, v72
    v_cvt_f32_i32 v73, v73
    v_cvt_f32_i32 v74, v74
    v_cvt_f32_i32 v75, v75
    v_fmac_f32 v54, v72, v32
    v_fmac_f32 v54, v73, v33
    v_fmac_f32 v54, v74, v34
    v_fmac_f32 v54, v75, v35
    v_cvt_f32_i32 v76, v76
    v_cvt_f32_i32 v77, v77
    v_add_f32_dpp v54, v54, v54 row_ror:8 row_mask:0xf bank_mask:0xf
    v_cvt_f32_i32 v78, v78
    v_cvt_f32_i32 v79, v79
    v_add_f32_dpp v54, v54, v54 row_ror:4 row_mask:0xf bank_mask:0xf
    v_mul_f32 v55, v76, v24
    v_fmac_f32 v55, v77, v25
    v_add_f32_dpp v54, v54, v54 row_ror:2 row_mask:0xf bank_mask:0xf
    v_fmac_f32 v55, v78, v26
    v_fmac_f32 v55, v79, v27
    v_add_f32_dpp v60, v54, v54 row_ror:1 row_mask:0xf bank_mask:0x1
    v_cvt_f32_i32 v80, v80
    v_cvt_f32_i32 v81, v81
    v_cvt_f32_i32 v82, v82
    v_cvt_f32_i32 v83, v83
    v_fmac_f32 v55, v80, v28
    v_fmac_f32 v55, v81, v29
    v_fmac_f32 v55, v82, v30
    v_fmac_f32 v55, v83, v31
    v_cvt_f32_i32 v84, v84
    v_cvt_f32_i32 v85, v85
    v_cvt_f32_i32 v86, v86
    v_cvt_f32_i32 v87, v87
    v_fmac_f32 v55, v84, v32
    v_fmac_f32 v55, v85, v33
    v_fmac_f32 v55, v86, v34
    v_fmac_f32 v55, v87, v35
    s_nop 1
    v_add_f32_dpp v55, v55, v55 row_ror:8 row_mask:0xf bank_mask:0xf
    s_nop 1
    v_add_f32_dpp v55, v55, v55 row_ror:4 row_mask:0xf bank_mask:0xf
    s_nop 1
    v_add_f32_dpp v55, v55, v55 row_ror:2 row_mask:0xf bank_mask:0xf
    s_nop 1
    v_add_f32_dpp v61, v55, v55 row_ror:1 row_mask:0xf bank_mask:0x1
    s_waitcnt vmcnt(0)
    buffer_load_dwordx4 v[112:115], v48, s[8:11], 0 offen offset:3072 nt
    buffer_load_dwordx4 v[116:119], v48, s[8:11], 0 offen offset:3328 nt
    buffer_load_dwordx4 v[120:123], v48, s[8:11], 0 offen offset:3584 nt
    buffer_load_dwordx4 v[124:127], v49, s[8:11], 0 offen offset:0 nt
    buffer_load_dwordx4 v[128:131], v49, s[8:11], 0 offen offset:256 nt
    buffer_load_dwordx4 v[132:135], v49, s[8:11], 0 offen offset:512 nt
    s_add_u32 s29, s29, 4
    s_add_u32 s30, s30, 1
    s_bitcmp1_b64 s[40:41], s30
    s_cbranch_scc1 L_evK
L_evretK:
    s_nop 1
    s_lshr_b32 s33, s29, 6
    s_lshl_b32 s33, s33, 11
    s_and_b32 s32, s29, 63
    s_add_u32 s32, s32, s33
    s_add_u32 s32, s32, s44
    s_bfe_u32 s33, s32, 0x20003
    s_and_b32 s34, s32, 4
    s_or_b32 s33, s33, s34
    s_xor_b32 s33, s33, s5
    s_lshl_b32 s50, s32, 5
    s_or_b32 s50, s50, s33
    s_lshl_b32 s50, s50, 4
    s_or_b32 s50, s50, 1
    v_xor_b32 v10, s50, v50
    v_mul_hi_u32 v10, v10, s47
    v_lshrrev_b32 v10, 1, v10
    v_and_b32 v11, 15, v10
    v_cmp_eq_u32 vcc, 5, v11
    v_mad_u32_u24 v48, v10, s45, v2
    v_add_u32 v11, 3840, v48
    v_cndmask_b32 v49, v51, v11, vcc
    v_lshrrev_b32 v10, 6, v10
    v_mad_u32_u24 v9, v10, s46, v3
    buffer_load_dwordx2 v[42:43], v9, s[16:19], 0 offen offset:0
    buffer_load_dwordx2 v[44:45], v9, s[16:19], 0 offen offset:128
    buffer_load_dwordx2 v[46:47], v9, s[16:19], 0 offen offset:256
    v_cvt_f32_i32 v88, v88
    v_cvt_f32_i32 v89, v89
    v_cvt_f32_i32 v90, v90
    v_cvt_f32_i32 v91, v91
    v_mul_f32 v56, v88, v24
    v_fmac_f32 v56, v89, v25
    v_fmac_f32 v56, v90, v26
    v_fmac_f32 v56, v91, v27
    v_cvt_f32_i32 v92, v92
    v_cvt_f32_i32 v93, v93
    v_cvt_f32_i32 v94, v94
    v_cvt_f32_i32 v95, v95
    v_fmac_f32 v56, v92, v28
    v_fmac_f32 v56, v93, v29
    v_fmac_f32 v56, v94, v30
    v_fmac_f32 v56, v95, v31
    v_cvt_f32_i32 v96, v96
    v_cvt_f32_i32 v97, v97
    v_cvt_f32_i32 v98, v98
    v_cvt_f32_i32 v99, v99
    v_fmac_f32 v56, v96, v32
    v_fmac_f32 v56, v97, v33
    v_fmac_f32 v56, v98, v34
    v_fmac_f32 v56, v99, v35
    v_cvt_f32_i32 v100, v100
    v_cvt_f32_i32 v101, v101
    v_add_f32_dpp v56, v56, v56 row_ror:8 row_mask:0xf bank_mask:0xf
    v_cvt_f32_i32 v102, v102
    v_cvt_f32_i32 v103, v103
    v_add_f32_dpp v56, v56, v56 row_ror:4 row_mask:0xf bank_mask:0xf
    v_mul_f32 v57, v100, v24
    v_fmac_f32 v57, v101, v25
    v_add_f32_dpp v56, v56, v56 row_ror:2 row_mask:0xf bank_mask:0xf
    v_fmac_f32 v57, v102, v26
    v_fmac_f32 v57, v103, v27
    v_add_f32_dpp v60, v56, v56 row_ror:1 row_mask:0xf bank_mask:0x2
    v_cvt_f32_i32 v104, v104
    v_cvt_f32_i32 v105, v105
    v_cvt_f32_i32 v106, v106
    v_cvt_f32_i32 v107, v107
    v_fmac_f32 v57, v104, v28
    v_fmac_f32 v57, v105, v29
    v_fmac_f32 v57, v106, v30
    v_fmac_f32 v57, v107, v31
    v_cvt_f32_i32 v108, v108
    v_cvt_f32_i32 v109, v109
    v_cvt_f32_i32 v110, v110
    v_cvt_f32_i32 v111, v111
    v_fmac_f32 v57, v108, v32
    v_fmac_f32 v57, v109, v33
    v_fmac_f32 v57, v110, v34
    v_fmac_f32 v57, v111, v35
    s_nop 1
    v_add_f32_dpp v57, v57, v57 row_ror:8 row_mask:0xf bank_mask:0xf
    s_nop 1
    v_add_f32_dpp v57, v57, v57 row_ror:4 row_mask:0xf bank_mask:0xf
    s_nop 1
    v_add_f32_dpp v57, v57, v57 row_ror:2 row_mask:0xf bank_mask:0xf
    s_nop 1
    v_add_f32_dpp v61, v57, v57 row_ror:1 row_mask:0xf bank_mask:0x2
    s_waitcnt vmcnt(3)
    buffer_load_dwordx4 v[64:67], v48, s[8:11], 0 offen offset:0 nt
    buffer_load_dwordx4 v[68:71], v48, s[8:11], 0 offen offset:256 nt
    buffer_load_dwordx4 v[72:75], v48, s[8:11], 0 offen offset:512 nt
    buffer_load_dwordx4 v[76:79], v48, s[8:11], 0 offen offset:768 nt
    buffer_load_dwordx4 v[80:83], v48, s[8:11], 0 offen offset:1024 nt
    buffer_load_dwordx4 v[84:87], v48, s[8:11], 0 offen offset:1280 nt
    v_cvt_f32_i32 v112, v112
    v_cvt_f32_i32 v113, v113
    v_cvt_f32_i32 v114, v114
    v_cvt_f32_i32 v115, v115
    v_mul_f32 v58, v112, v24
    v_fmac_f32 v58, v113, v25
    v_fmac_f32 v58, v114, v26
    v_fmac_f32 v58, v115, v27
    v_cvt_f32_i32 v116, v116
    v_cvt_f32_i32 v117, v117
    v_cvt_f32_i32 v118, v118
    v_cvt_f32_i32 v119, v119
    v_fmac_f32 v58, v116, v28
    v_fmac_f32 v58, v117, v29
    v_fmac_f32 v58, v118, v30
    v_fmac_f32 v58, v119, v31
    v_cvt_f32_i32 v120, v120
    v_cvt_f32_i32 v121, v121
    v_cvt_f32_i32 v122, v122
    v_cvt_f32_i32 v123, v123
    v_fmac_f32 v58, v120, v32
    v_fmac_f32 v58, v121, v33
    v_fmac_f32 v58, v122, v34
    v_fmac_f32 v58, v123, v35
    v_cvt_f32_i32 v124, v124
    v_cvt_f32_i32 v125, v125
    v_add_f32_dpp v58, v58, v58 row_ror:8 row_mask:0xf bank_mask:0xf
    v_cvt_f32_i32 v126, v126
    v_cvt_f32_i32 v127, v127
    v_add_f32_dpp v58, v58, v58 row_ror:4 row_mask:0xf bank_mask:0xf
    v_mul_f32 v59, v124, v24
    v_fmac_f32 v59, v125, v25
    v_add_f32_dpp v58, v58, v58 row_ror:2 row_mask:0xf bank_mask:0xf
    v_fmac_f32 v59, v126, v26
    v_fmac_f32 v59, v127, v27
    v_add_f32_dpp v60, v58, v58 row_ror:1 row_mask:0xf bank_mask:0x4
    v_cvt_f32_i32 v128, v128
    v_cvt_f32_i32 v129, v129
    v_cvt_f32_i32 v130, v130
    v_cvt_f32_i32 v131, v131
    v_fmac_f32 v59, v128, v28
    v_fmac_f32 v59, v129, v29
    v_fmac_f32 v59, v130, v30
    v_fmac_f32 v59, v131, v31
    v_cvt_f32_i32 v132, v132
    v_cvt_f32_i32 v133, v133
    v_cvt_f32_i32 v134, v134
    v_cvt_f32_i32 v135, v135
    v_fmac_f32 v59, v132, v32
    v_fmac_f32 v59, v133, v33
    v_fmac_f32 v59, v134, v34
    v_fmac_f32 v59, v135, v35
    s_nop 1
    v_add_f32_dpp v59, v59, v59 row_ror:8 row_mask:0xf bank_mask:0xf
    s_nop 1
    v_add_f32_dpp v59, v59, v59 row_ror:4 row_mask:0xf bank_mask:0xf
    s_nop 1
    v_add_f32_dpp v59, v59, v59 row_ror:2 row_mask:0xf bank_mask:0xf
    s_nop 1
    v_add_f32_dpp v61, v59, v59 row_ror:1 row_mask:0xf bank_mask:0x4
    s_mov_b64 exec, s[42:43]
    ds_write_b64 v4, v[60:61]
    s_mov_b64 exec, -1
    v_add_u32 v4, 512, v4
    s_waitcnt vmcnt(6)
    v_lshlrev_b32 v10, 16, v36
    v_lshlrev_b32 v24, 16, v42
    v_and_b32 v11, 0xffff0000, v36
    v_and_b32 v25, 0xffff0000, v42
    v_mul_f32 v24, v24, v10
    v_mul_f32 v25, v25, v11
    v_lshlrev_b32 v10, 16, v37
    v_lshlrev_b32 v26, 16, v43
    v_and_b32 v11, 0xffff0000, v37
    v_and_b32 v27, 0xffff0000, v43
    v_mul_f32 v26, v26, v10
    v_mul_f32 v27, v27, v11
    v_lshlrev_b32 v10, 16, v38
    v_lshlrev_b32 v28, 16, v44
    v_and_b32 v11, 0xffff0000, v38
    v_and_b32 v29, 0xffff0000, v44
    v_mul_f32 v28, v28, v10
    v_mul_f32 v29, v29, v11
    v_lshlrev_b32 v10, 16, v39
    v_lshlrev_b32 v30, 16, v45
    v_and_b32 v11, 0xffff0000, v39
    v_and_b32 v31, 0xffff0000, v45
    v_mul_f32 v30, v30, v10
    v_mul_f32 v31, v31, v11
    v_lshlrev_b32 v10, 16, v40
    v_lshlrev_b32 v32, 16, v46
    v_and_b32 v11, 0xffff0000, v40
    v_and_b32 v33, 0xffff0000, v46
    v_mul_f32 v32, v32, v10
    v_mul_f32 v33, v33, v11
    v_lshlrev_b32 v10, 16, v41
    v_lshlrev_b32 v34, 16, v47
    v_and_b32 v11, 0xffff0000, v41
    v_and_b32 v35, 0xffff0000, v47
    v_mul_f32 v34, v34, v10
    v_mul_f32 v35, v35, v11
    s_cmp_lg_u32 s30, 47
    s_cbranch_scc1 L_kloop
    s_waitcnt vmcnt(0)
    buffer_load_dwordx4 v[88:91], v48, s[8:11], 0 offen offset:1536 nt
    buffer_load_dwordx4 v[92:95], v48, s[8:11], 0 offen offset:1792 nt
    buffer_load_dwordx4 v[96:99], v48, s[8:11], 0 offen offset:2048 nt
    buffer_load_dwordx4 v[100:103], v48, s[8:11], 0 offen offset:2304 nt
    buffer_load_dwordx4 v[104:107], v48, s[8:11], 0 offen offset:2560 nt
    buffer_load_dwordx4 v[108:111], v48, s[8:11], 0 offen offset:2816 nt
    v_cvt_f32_i32 v64, v64
    v_cvt_f32_i32 v65, v65
    v_cvt_f32_i32 v66, v66
    v_cvt_f32_i32 v67, v67
    v_mul_f32 v54, v64, v24
    v_fmac_f32 v54, v65, v25
    v_fmac_f32 v54, v66, v26
    v_fmac_f32 v54, v67, v27
    v_cvt_f32_i32 v68, v68
    v_cvt_f32_i32 v69, v69
    v_cvt_f32_i32 v70, v70
    v_cvt_f32_i32 v71, v71
    v_fmac_f32 v54, v68, v28
    v_fmac_f32 v54, v69, v29
    v_fmac_f32 v54, v70, v30
    v_fmac_f32 v54, v71, v31
    v_cvt_f32_i32 v72, v72
    v_cvt_f32_i32 v73, v73
    v_cvt_f32_i32 v74, v74
    v_cvt_f32_i32 v75, v75
    v_fmac_f32 v54, v72, v32
    v_fmac_f32 v54, v73, v33
    v_fmac_f32 v54, v74, v34
    v_fmac_f32 v54, v75, v35
    v_cvt_f32_i32 v76, v76
    v_cvt_f32_i32 v77, v77
    v_add_f32_dpp v54, v54, v54 row_ror:8 row_mask:0xf bank_mask:0xf
    v_cvt_f32_i32 v78, v78
    v_cvt_f32_i32 v79, v79
    v_add_f32_dpp v54, v54, v54 row_ror:4 row_mask:0xf bank_mask:0xf
    v_mul_f32 v55, v76, v24
    v_fmac_f32 v55, v77, v25
    v_add_f32_dpp v54, v54, v54 row_ror:2 row_mask:0xf bank_mask:0xf
    v_fmac_f32 v55, v78, v26
    v_fmac_f32 v55, v79, v27
    v_add_f32_dpp v60, v54, v54 row_ror:1 row_mask:0xf bank_mask:0x1
    v_cvt_f32_i32 v80, v80
    v_cvt_f32_i32 v81, v81
    v_cvt_f32_i32 v82, v82
    v_cvt_f32_i32 v83, v83
    v_fmac_f32 v55, v80, v28
    v_fmac_f32 v55, v81, v29
    v_fmac_f32 v55, v82, v30
    v_fmac_f32 v55, v83, v31
    v_cvt_f32_i32 v84, v84
    v_cvt_f32_i32 v85, v85
    v_cvt_f32_i32 v86, v86
    v_cvt_f32_i32 v87, v87
    v_fmac_f32 v55, v84, v32
    v_fmac_f32 v55, v85, v33
    v_fmac_f32 v55, v86, v34
    v_fmac_f32 v55, v87, v35
    s_nop 1
    v_add_f32_dpp v55, v55, v55 row_ror:8 row_mask:0xf bank_mask:0xf
    s_nop 1
    v_add_f32_dpp v55, v55, v55 row_ror:4 row_mask:0xf bank_mask:0xf
    s_nop 1
    v_add_f32_dpp v55, v55, v55 row_ror:2 row_mask:0xf bank_mask:0xf
    s_nop 1
    v_add_f32_dpp v61, v55, v55 row_ror:1 row_mask:0xf bank_mask:0x1
    s_waitcnt vmcnt(0)
    buffer_load_dwordx4 v[112:115], v48, s[8:11], 0 offen offset:3072 nt
    buffer_load_dwordx4 v[116:119], v48, s[8:11], 0 offen offset:3328 nt
    buffer_load_dwordx4 v[120:123], v48, s[8:11], 0 offen offset:3584 nt
    buffer_load_dwordx4 v[124:127], v49, s[8:11], 0 offen offset:0 nt
    buffer_load_dwordx4 v[128:131], v49, s[8:11], 0 offen offset:256 nt
    buffer_load_dwordx4 v[132:135], v49, s[8:11], 0 offen offset:512 nt
    s_mov_b32 s29, s28
    s_mov_b32 s30, 0
    s_lshr_b32 s33, s30, 4
    s_lshl_b32 s34, s33, 2
    v_mov_b32 v11, s34
    s_mov_b32 s6, 0x100000
L_wtv:
    s_nop 1
    ds_read_b32 v10, v11 offset:24
    s_sub_u32 s6, s6, 1
    s_cbranch_scc1 L_exit1
    s_waitcnt lgkmcnt(0)
    v_readfirstlane_b32 s32, v10
    s_cmp_eq_u32 s32, 0
    s_cbranch_scc1 L_wtv
    s_and_b32 s5, s32, 7
    s_xor_b32 s5, s5, s48
    s_bitcmp1_b32 s32, 3
    s_cselect_b64 vcc, -1, 0
    v_cndmask_b32 v50, v62, v63, vcc
    s_mov_b32 s40, 0x10000
    s_mov_b32 s41, 0x1
    s_lshr_b32 s33, s29, 6
    s_lshl_b32 s33, s33, 11
    s_and_b32 s32, s29, 63
    s_add_u32 s32, s32, s33
    s_add_u32 s32, s32, s44
    s_bfe_u32 s33, s32, 0x20003
    s_and_b32 s34, s32, 4
    s_or_b32 s33, s33, s34
    s_xor_b32 s33, s33, s5
    s_lshl_b32 s50, s32, 5
    s_or_b32 s50, s50, s33
    s_lshl_b32 s50, s50, 4
    s_or_b32 s50, s50, 1
    s_lshl_b32 s53, s29, 7
    v_xor_b32 v10, s50, v50
    v_mul_hi_u32 v10, v10, s47
    v_lshrrev_b32 v10, 1, v10
    v_and_b32 v11, 15, v10
    v_cmp_eq_u32 vcc, 5, v11
    v_mad_u32_u24 v48, v10, s45, v2
    v_add_u32 v11, 3840, v48
    v_cndmask_b32 v49, v51, v11, vcc
    v_add_u32 v10, s53, v5
    ds_read_b32 v7, v10
    v_cvt_f32_i32 v88, v88
    v_cvt_f32_i32 v89, v89
    v_cvt_f32_i32 v90, v90
    v_cvt_f32_i32 v91, v91
    v_mul_f32 v56, v88, v24
    v_fmac_f32 v56, v89, v25
    v_fmac_f32 v56, v90, v26
    v_fmac_f32 v56, v91, v27
    v_cvt_f32_i32 v92, v92
    v_cvt_f32_i32 v93, v93
    v_cvt_f32_i32 v94, v94
    v_cvt_f32_i32 v95, v95
    v_fmac_f32 v56, v92, v28
    v_fmac_f32 v56, v93, v29
    v_fmac_f32 v56, v94, v30
    v_fmac_f32 v56, v95, v31
    v_cvt_f32_i32 v96, v96
    v_cvt_f32_i32 v97, v97
    v_cvt_f32_i32 v98, v98
    v_cvt_f32_i32 v99, v99
    v_fmac_f32 v56, v96, v32
    v_fmac_f32 v56, v97, v33
    v_fmac_f32 v56, v98, v34
    v_fmac_f32 v56, v99, v35
    v_cvt_f32_i32 v100, v100
    v_cvt_f32_i32 v101, v101
    v_add_f32_dpp v56, v56, v56 row_ror:8 row_mask:0xf bank_mask:0xf
    v_cvt_f32_i32 v102, v102
    v_cvt_f32_i32 v103, v103
    v_add_f32_dpp v56, v56, v56 row_ror:4 row_mask:0xf bank_mask:0xf
    v_mul_f32 v57, v100, v24
    v_fmac_f32 v57, v101, v25
    v_add_f32_dpp v56, v56, v56 row_ror:2 row_mask:0xf bank_mask:0xf
    v_fmac_f32 v57, v102, v26
    v_fmac_f32 v57, v103, v27
    v_add_f32_dpp v60, v56, v56 row_ror:1 row_mask:0xf bank_mask:0x2
    v_cvt_f32_i32 v104, v104
    v_cvt_f32_i32 v105, v105
    v_cvt_f32_i32 v106, v106
    v_cvt_f32_i32 v107, v107
    v_fmac_f32 v57, v104, v28
    v_fmac_f32 v57, v105, v29
    v_fmac_f32 v57, v106, v30
    v_fmac_f32 v57, v107, v31
    v_cvt_f32_i32 v108, v108
    v_cvt_f32_i32 v109, v109
    v_cvt_f32_i32 v110, v110
    v_cvt_f32_i32 v111, v111
    v_fmac_f32 v57, v108, v32
    v_fmac_f32 v57, v109, v33
    v_fmac_f32 v57, v110, v34
    v_fmac_f32 v57, v111, v35
    s_nop 1
    v_add_f32_dpp v57, v57, v57 row_ror:8 row_mask:0xf bank_mask:0xf
    s_nop 1
    v_add_f32_dpp v57, v57, v57 row_ror:4 row_mask:0xf bank_mask:0xf
    s_nop 1
    v_add_f32_dpp v57, v57, v57 row_ror:2 row_mask:0xf bank_mask:0xf
    s_nop 1
    v_add_f32_dpp v61, v57, v57 row_ror:1 row_mask:0xf bank_mask:0x2
    s_waitcnt vmcnt(0)
    buffer_load_dwordx4 v[64:67], v48, s[12:15], 0 offen offset:0 nt
    buffer_load_dwordx4 v[68:71], v48, s[12:15], 0 offen offset:256 nt
    buffer_load_dwordx4 v[72:75], v48, s[12:15], 0 offen offset:512 nt
    buffer_load_dwordx4 v[76:79], v48, s[12:15], 0 offen offset:768 nt
    buffer_load_dwordx4 v[80:83], v48, s[12:15], 0 offen offset:1024 nt
    buffer_load_dwordx4 v[84:87], v48, s[12:15], 0 offen offset:1280 nt
    v_cvt_f32_i32 v112, v112
    v_cvt_f32_i32 v113, v113
    v_cvt_f32_i32 v114, v114
    v_cvt_f32_i32 v115, v115
    v_mul_f32 v58, v112, v24
    v_fmac_f32 v58, v113, v25
    v_fmac_f32 v58, v114, v26
    v_fmac_f32 v58, v115, v27
    v_cvt_f32_i32 v116, v116
    v_cvt_f32_i32 v117, v117
    v_cvt_f32_i32 v118, v118
    v_cvt_f32_i32 v119, v119
    v_fmac_f32 v58, v116, v28
    v_fmac_f32 v58, v117, v29
    v_fmac_f32 v58, v118, v30
    v_fmac_f32 v58, v119, v31
    v_cvt_f32_i32 v120, v120
    v_cvt_f32_i32 v121, v121
    v_cvt_f32_i32 v122, v122
    v_cvt_f32_i32 v123, v123
    v_fmac_f32 v58, v120, v32
    v_fmac_f32 v58, v121, v33
    v_fmac_f32 v58, v122, v34
    v_fmac_f32 v58, v123, v35
    v_cvt_f32_i32 v124, v124
    v_cvt_f32_i32 v125, v125
    v_add_f32_dpp v58, v58, v58 row_ror:8 row_mask:0xf bank_mask:0xf
    v_cvt_f32_i32 v126, v126
    v_cvt_f32_i32 v127, v127
    v_add_f32_dpp v58, v58, v58 row_ror:4 row_mask:0xf bank_mask:0xf
    v_mul_f32 v59, v124, v24
    v_fmac_f32 v59, v125, v25
    v_add_f32_dpp v58, v58, v58 row_ror:2 row_mask:0xf bank_mask:0xf
    v_fmac_f32 v59, v126, v26
    v_fmac_f32 v59, v127, v27
    v_add_f32_dpp v60, v58, v58 row_ror:1 row_mask:0xf bank_mask:0x4
    v_cvt_f32_i32 v128, v128
    v_cvt_f32_i32 v129, v129
    v_cvt_f32_i32 v130, v130
    v_cvt_f32_i32 v131, v131
    v_fmac_f32 v59, v128, v28
    v_fmac_f32 v59, v129, v29
    v_fmac_f32 v59, v130, v30
    v_fmac_f32 v59, v131, v31
    v_cvt_f32_i32 v132, v132
    v_cvt_f32_i32 v133, v133
    v_cvt_f32_i32 v134, v134
    v_cvt_f32_i32 v135, v135
    v_fmac_f32 v59, v132, v32
    v_fmac_f32 v59, v133, v33
    v_fmac_f32 v59, v134, v34
    v_fmac_f32 v59, v135, v35
    s_nop 1
    v_add_f32_dpp v59, v59, v59 row_ror:8 row_mask:0xf bank_mask:0xf
    s_nop 1
    v_add_f32_dpp v59, v59, v59 row_ror:4 row_mask:0xf bank_mask:0xf
    s_nop 1
    v_add_f32_dpp v59, v59, v59 row_ror:2 row_mask:0xf bank_mask:0xf
    s_nop 1
    v_add_f32_dpp v61, v59, v59 row_ror:1 row_mask:0xf bank_mask:0x4
    s_mov_b64 exec, s[42:43]
    ds_write_b64 v4, v[60:61]
    s_mov_b64 exec, -1
    s_waitcnt lgkmcnt(0)
    v_mov_b32 v6, v7
    v_mov_b32 v11, 1
    s_mov_b64 exec, 1
    ds_add_u32 v53, v11 offset:48
    s_mov_b64 exec, -1
.p2align 6
L_vloop:
    s_nop 1
    s_waitcnt vmcnt(0)
    buffer_load_dwordx4 v[88:91], v48, s[12:15], 0 offen offset:1536 nt
    buffer_load_dwordx4 v[92:95], v48, s[12:15], 0 offen offset:1792 nt
    buffer_load_dwordx4 v[96:99], v48, s[12:15], 0 offen offset:2048 nt
    buffer_load_dwordx4 v[100:103], v48, s[12:15], 0 offen offset:2304 nt
    buffer_load_dwordx4 v[104:107], v48, s[12:15], 0 offen offset:2560 nt
    buffer_load_dwordx4 v[108:111], v48, s[12:15], 0 offen offset:2816 nt
    v_cvt_f32_i32 v64, v64
    v_cvt_f32_i32 v65, v65
    v_cvt_f32_i32 v66, v66
    v_cvt_f32_i32 v67, v67
    v_fmac_f32_dpp v12, v6, v64 row_newbcast:0 row_mask:0xf bank_mask:0xf
    v_fmac_f32_dpp v13, v6, v65 row_newbcast:0 row_mask:0xf bank_mask:0xf
    v_fmac_f32_dpp v14, v6, v66 row_newbcast:0 row_mask:0xf bank_mask:0xf
    v_fmac_f32_dpp v15, v6, v67 row_newbcast:0 row_mask:0xf bank_mask:0xf
    v_cvt_f32_i32 v68, v68
    v_cvt_f32_i32 v69, v69
    v_cvt_f32_i32 v70, v70
    v_cvt_f32_i32 v71, v71
    v_fmac_f32_dpp v16, v6, v68 row_newbcast:0 row_mask:0xf bank_mask:0xf
    v_fmac_f32_dpp v17, v6, v69 row_newbcast:0 row_mask:0xf bank_mask:0xf
    v_fmac_f32_dpp v18, v6, v70 row_newbcast:0 row_mask:0xf bank_mask:0xf
    v_fmac_f32_dpp v19, v6, v71 row_newbcast:0 row_mask:0xf bank_mask:0xf
    v_cvt_f32_i32 v72, v72
    v_cvt_f32_i32 v73, v73
    v_cvt_f32_i32 v74, v74
    v_cvt_f32_i32 v75, v75
    v_fmac_f32_dpp v20, v6, v72 row_newbcast:0 row_mask:0xf bank_mask:0xf
    v_fmac_f32_dpp v21, v6, v73 row_newbcast:0 row_mask:0xf bank_mask:0xf
    v_fmac_f32_dpp v22, v6, v74 row_newbcast:0 row_mask:0xf bank_mask:0xf
    v_fmac_f32_dpp v23, v6, v75 row_newbcast:0 row_mask:0xf bank_mask:0xf
    v_cvt_f32_i32 v76, v76
    v_cvt_f32_i32 v77, v77
    v_cvt_f32_i32 v78, v78
    v_cvt_f32_i32 v79, v79
    v_fmac_f32_dpp v12, v6, v76 row_newbcast:1 row_mask:0xf bank_mask:0xf
    v_fmac_f32_dpp v13, v6, v77 row_newbcast:1 row_mask:0xf bank_mask:0xf
    v_fmac_f32_dpp v14, v6, v78 row_newbcast:1 row_mask:0xf bank_mask:0xf
    v_fmac_f32_dpp v15, v6, v79 row_newbcast:1 row_mask:0xf bank_mask:0xf
    v_cvt_f32_i32 v80, v80
    v_cvt_f32_i32 v81, v81
    v_cvt_f32_i32 v82, v82
    v_cvt_f32_i32 v83, v83
    v_fmac_f32_dpp v16, v6, v80 row_newbcast:1 row_mask:0xf bank_mask:0xf
    v_fmac_f32_dpp v17, v6, v81 row_newbcast:1 row_mask:0xf bank_mask:0xf
    v_fmac_f32_dpp v18, v6, v82 row_newbcast:1 row_mask:0xf bank_mask:0xf
    v_fmac_f32_dpp v19, v6, v83 row_newbcast:1 row_mask:0xf bank_mask:0xf
    v_cvt_f32_i32 v84, v84
    v_cvt_f32_i32 v85, v85
    v_cvt_f32_i32 v86, v86
    v_cvt_f32_i32 v87, v87
    v_fmac_f32_dpp v20, v6, v84 row_newbcast:1 row_mask:0xf bank_mask:0xf
    v_fmac_f32_dpp v21, v6, v85 row_newbcast:1 row_mask:0xf bank_mask:0xf
    v_fmac_f32_dpp v22, v6, v86 row_newbcast:1 row_mask:0xf bank_mask:0xf
    v_fmac_f32_dpp v23, v6, v87 row_newbcast:1 row_mask:0xf bank_mask:0xf
    s_waitcnt vmcnt(0)
    buffer_load_dwordx4 v[112:115], v48, s[12:15], 0 offen offset:3072 nt
    buffer_load_dwordx4 v[116:119], v48, s[12:15], 0 offen offset:3328 nt
    buffer_load_dwordx4 v[120:123], v48, s[12:15], 0 offen offset:3584 nt
    buffer_load_dwordx4 v[124:127], v49, s[12:15], 0 offen offset:0 nt
    buffer_load_dwordx4 v[128:131], v49, s[12:15], 0 offen offset:256 nt
    buffer_load_dwordx4 v[132:135], v49, s[12:15], 0 offen offset:512 nt
    s_add_u32 s29, s29, 4
    s_add_u32 s30, s30, 1
    s_bitcmp1_b64 s[40:41], s30
    s_cbranch_scc1 L_evV
L_evretV:
    s_nop 1
    s_lshr_b32 s33, s29, 6
    s_lshl_b32 s33, s33, 11
    s_and_b32 s32, s29, 63
    s_add_u32 s32, s32, s33
    s_add_u32 s32, s32, s44
    s_bfe_u32 s33, s32, 0x20003
    s_and_b32 s34, s32, 4
    s_or_b32 s33, s33, s34
    s_xor_b32 s33, s33, s5
    s_lshl_b32 s50, s32, 5
    s_or_b32 s50, s50, s33
    s_lshl_b32 s50, s50, 4
    s_or_b32 s50, s50, 1
    s_lshl_b32 s53, s29, 7
    v_xor_b32 v10, s50, v50
    v_mul_hi_u32 v10, v10, s47
    v_lshrrev_b32 v10, 1, v10
    v_and_b32 v11, 15, v10
    v_cmp_eq_u32 vcc, 5, v11
    v_mad_u32_u24 v48, v10, s45, v2
    v_add_u32 v11, 3840, v48
    v_cndmask_b32 v49, v51, v11, vcc
    v_add_u32 v10, s53, v5
    ds_read_b32 v7, v10
    v_cvt_f32_i32 v88, v88
    v_cvt_f32_i32 v89, v89
    v_cvt_f32_i32 v90, v90
    v_cvt_f32_i32 v91, v91
    v_fmac_f32_dpp v12, v6, v88 row_newbcast:2 row_mask:0xf bank_mask:0xf
    v_fmac_f32_dpp v13, v6, v89 row_newbcast:2 row_mask:0xf bank_mask:0xf
    v_fmac_f32_dpp v14, v6, v90 row_newbcast:2 row_mask:0xf bank_mask:0xf
    v_fmac_f32_dpp v15, v6, v91 row_newbcast:2 row_mask:0xf bank_mask:0xf
    v_cvt_f32_i32 v92, v92
    v_cvt_f32_i32 v93, v93
    v_cvt_f32_i32 v94, v94
    v_cvt_f32_i32 v95, v95
    v_fmac_f32_dpp v16, v6, v92 row_newbcast:2 row_mask:0xf bank_mask:0xf
    v_fmac_f32_dpp v17, v6, v93 row_newbcast:2 row_mask:0xf bank_mask:0xf
    v_fmac_f32_dpp v18, v6, v94 row_newbcast:2 row_mask:0xf bank_mask:0xf
    v_fmac_f32_dpp v19, v6, v95 row_newbcast:2 row_mask:0xf bank_mask:0xf
    v_cvt_f32_i32 v96, v96
    v_cvt_f32_i32 v97, v97
    v_cvt_f32_i32 v98, v98
    v_cvt_f32_i32 v99, v99
    v_fmac_f32_dpp v20, v6, v96 row_newbcast:2 row_mask:0xf bank_mask:0xf
    v_fmac_f32_dpp v21, v6, v97 row_newbcast:2 row_mask:0xf bank_mask:0xf
    v_fmac_f32_dpp v22, v6, v98 row_newbcast:2 row_mask:0xf bank_mask:0xf
    v_fmac_f32_dpp v23, v6, v99 row_newbcast:2 row_mask:0xf bank_mask:0xf
    v_cvt_f32_i32 v100, v100
    v_cvt_f32_i32 v101, v101
    v_cvt_f32_i32 v102, v102
    v_cvt_f32_i32 v103, v103
    v_fmac_f32_dpp v12, v6, v100 row_newbcast:3 row_mask:0xf bank_mask:0xf
    v_fmac_f32_dpp v13, v6, v101 row_newbcast:3 row_mask:0xf bank_mask:0xf
    v_fmac_f32_dpp v14, v6, v102 row_newbcast:3 row_mask:0xf bank_mask:0xf
    v_fmac_f32_dpp v15, v6, v103 row_newbcast:3 row_mask:0xf bank_mask:0xf
    v_cvt_f32_i32 v104, v104
    v_cvt_f32_i32 v105, v105
    v_cvt_f32_i32 v106, v106
    v_cvt_f32_i32 v107, v107
    v_fmac_f32_dpp v16, v6, v104 row_newbcast:3 row_mask:0xf bank_mask:0xf
    v_fmac_f32_dpp v17, v6, v105 row_newbcast:3 row_mask:0xf bank_mask:0xf
    v_fmac_f32_dpp v18, v6, v106 row_newbcast:3 row_mask:0xf bank_mask:0xf
    v_fmac_f32_dpp v19, v6, v107 row_newbcast:3 row_mask:0xf bank_mask:0xf
    v_cvt_f32_i32 v108, v108
    v_cvt_f32_i32 v109, v109
    v_cvt_f32_i32 v110, v110
    v_cvt_f32_i32 v111, v111
    v_fmac_f32_dpp v20, v6, v108 row_newbcast:3 row_mask:0xf bank_mask:0xf
    v_fmac_f32_dpp v21, v6, v109 row_newbcast:3 row_mask:0xf bank_mask:0xf
    v_fmac_f32_dpp v22, v6, v110 row_newbcast:3 row_mask:0xf bank_mask:0xf
    v_fmac_f32_dpp v23, v6, v111 row_newbcast:3 row_mask:0xf bank_mask:0xf
    s_waitcnt vmcnt(0)
    buffer_load_dwordx4 v[64:67], v48, s[12:15], 0 offen offset:0 nt
    buffer_load_dwordx4 v[68:71], v48, s[12:15], 0 offen offset:256 nt
    buffer_load_dwordx4 v[72:75], v48, s[12:15], 0 offen offset:512 nt
    buffer_load_dwordx4 v[76:79], v48, s[12:15], 0 offen offset:768 nt
    buffer_load_dwordx4 v[80:83], v48, s[12:15], 0 offen offset:1024 nt
    buffer_load_dwordx4 v[84:87], v48, s[12:15], 0 offen offset:1280 nt
    v_cvt_f32_i32 v112, v112
    v_cvt_f32_i32 v113, v113
    v_cvt_f32_i32 v114, v114
    v_cvt_f32_i32 v115, v115
    v_fmac_f32_dpp v12, v6, v112 row_newbcast:4 row_mask:0xf bank_mask:0xf
    v_fmac_f32_dpp v13, v6, v113 row_newbcast:4 row_mask:0xf bank_mask:0xf
    v_fmac_f32_dpp v14, v6, v114 row_newbcast:4 row_mask:0xf bank_mask:0xf
    v_fmac_f32_dpp v15, v6, v115 row_newbcast:4 row_mask:0xf bank_mask:0xf
    v_cvt_f32_i32 v116, v116
    v_cvt_f32_i32 v117, v117
    v_cvt_f32_i32 v118, v118
    v_cvt_f32_i32 v119, v119
    v_fmac_f32_dpp v16, v6, v116 row_newbcast:4 row_mask:0xf bank_mask:0xf
    v_fmac_f32_dpp v17, v6, v117 row_newbcast:4 row_mask:0xf bank_mask:0xf
    v_fmac_f32_dpp v18, v6, v118 row_newbcast:4 row_mask:0xf bank_mask:0xf
    v_fmac_f32_dpp v19, v6, v119 row_newbcast:4 row_mask:0xf bank_mask:0xf
    v_cvt_f32_i32 v120, v120
    v_cvt_f32_i32 v121, v121
    v_cvt_f32_i32 v122, v122
    v_cvt_f32_i32 v123, v123
    v_fmac_f32_dpp v20, v6, v120 row_newbcast:4 row_mask:0xf bank_mask:0xf
    v_fmac_f32_dpp v21, v6, v121 row_newbcast:4 row_mask:0xf bank_mask:0xf
    v_fmac_f32_dpp v22, v6, v122 row_newbcast:4 row_mask:0xf bank_mask:0xf
    v_fmac_f32_dpp v23, v6, v123 row_newbcast:4 row_mask:0xf bank_mask:0xf
    v_cvt_f32_i32 v124, v124
    v_cvt_f32_i32 v125, v125
    v_cvt_f32_i32 v126, v126
    v_cvt_f32_i32 v127, v127
    v_fmac_f32_dpp v12, v6, v124 row_newbcast:5 row_mask:0xf bank_mask:0xf
    v_fmac_f32_dpp v13, v6, v125 row_newbcast:5 row_mask:0xf bank_mask:0xf
    v_fmac_f32_dpp v14, v6, v126 row_newbcast:5 row_mask:0xf bank_mask:0xf
    v_fmac_f32_dpp v15, v6, v127 row_newbcast:5 row_mask:0xf bank_mask:0xf
    v_cvt_f32_i32 v128, v128
    v_cvt_f32_i32 v129, v129
    v_cvt_f32_i32 v130, v130
    v_cvt_f32_i32 v131, v131
    v_fmac_f32_dpp v16, v6, v128 row_newbcast:5 row_mask:0xf bank_mask:0xf
    v_fmac_f32_dpp v17, v6, v129 row_newbcast:5 row_mask:0xf bank_mask:0xf
    v_fmac_f32_dpp v18, v6, v130 row_newbcast:5 row_mask:0xf bank_mask:0xf
    v_fmac_f32_dpp v19, v6, v131 row_newbcast:5 row_mask:0xf bank_mask:0xf
    v_cvt_f32_i32 v132, v132
    v_cvt_f32_i32 v133, v133
    v_cvt_f32_i32 v134, v134
    v_cvt_f32_i32 v135, v135
    v_fmac_f32_dpp v20, v6, v132 row_newbcast:5 row_mask:0xf bank_mask:0xf
    v_fmac_f32_dpp v21, v6, v133 row_newbcast:5 row_mask:0xf bank_mask:0xf
    v_fmac_f32_dpp v22, v6, v134 row_newbcast:5 row_mask:0xf bank_mask:0xf
    v_fmac_f32_dpp v23, v6, v135 row_newbcast:5 row_mask:0xf bank_mask:0xf
    s_waitcnt lgkmcnt(0)
    v_mov_b32 v6, v7
    s_and_b32 s32, s30, 15
    s_cbranch_scc1 L_vloop
    v_permlane32_swap_b32 v12, v14
    v_permlane32_swap_b32 v13, v15
    v_permlane32_swap_b32 v16, v18
    v_permlane32_swap_b32 v17, v19
    v_permlane32_swap_b32 v20, v22
    v_permlane32_swap_b32 v21, v23
    v_add_f32 v12, v12, v14
    v_add_f32 v13, v13, v15
    v_add_f32 v16, v16, v18
    v_add_f32 v17, v17, v19
    v_add_f32 v20, v20, v22
    v_add_f32 v21, v21, v23
    v_permlane16_swap_b32 v12, v13
    v_permlane16_swap_b32 v16, v17
    v_permlane16_swap_b32 v20, v21
    s_lshr_b32 s32, s30, 2
    v_mov_b32 v10, s32
    v_add_f32 v12, v12, v13
    ds_write_b32 v8, v12 offset:0
    v_add_f32 v16, v16, v17
    ds_write_b32 v8, v16 offset:256
    v_add_f32 v20, v20, v21
    ds_write_b32 v8, v20 offset:512
    v_mov_b32 v11, 1
    s_mov_b64 exec, 1
    ds_add_u32 v10, v11 offset:60
    s_mov_b64 exec, -1
    v_add_u32 v8, 3072, v8
    v_mov_b32 v12, 0
    v_mov_b32 v13, 0
    v_mov_b32 v14, 0
    v_mov_b32 v15, 0
    v_mov_b32 v16, 0
    v_mov_b32 v17, 0
    v_mov_b32 v18, 0
    v_mov_b32 v19, 0
    v_mov_b32 v20, 0
    v_mov_b32 v21, 0
    v_mov_b32 v22, 0
    v_mov_b32 v23, 0
    s_cmp_lg_u32 s30, 48
    s_cbranch_scc1 L_vloop
L_exit1:
    s_endpgm
L_evK:
    s_nop 1
    s_and_b32 s32, s30, 15
    s_cbranch_scc0 L_evK2
    s_cmp_eq_u32 s30, 4
    s_cbranch_scc1 L_evK2
    s_lshr_b32 s32, s30, 2
    s_andn2_b32 s32, s32, 3
    s_add_u32 s32, s32, 36
    s_cmp_eq_u32 s30, 3
    s_cselect_b32 s32, 56, s32
    s_cmp_eq_u32 s30, 10
    s_cselect_b32 s32, 60, s32
    v_mov_b32 v10, s32
    v_mov_b32 v11, 1
    s_mov_b64 exec, 1
    ds_add_u32 v10, v11 offset:0
    s_mov_b64 exec, -1
    s_branch L_evretK
L_evK2:
    s_nop 1
    s_lshr_b32 s33, s30, 4
    s_lshl_b32 s34, s33, 2
    v_mov_b32 v11, s34
    s_lshl_b32 s31, s33, 5
    s_add_u32 s31, s31, s3
    s_mul_i32 s31, s31, 171
    s_lshr_b32 s31, s31, 9
    s_mul_i32 s31, s31, 384
    buffer_load_dwordx2 v[36:37], v3, s[20:23], s31 offen offset:0
    buffer_load_dwordx2 v[38:39], v3, s[20:23], s31 offen offset:128
    buffer_load_dwordx2 v[40:41], v3, s[20:23], s31 offen offset:256
    s_mov_b32 s6, 0x100000
L_wtk:
    s_nop 1
    ds_read_b32 v10, v11 offset:0
    s_sub_u32 s6, s6, 1
    s_cbranch_scc1 L_exit1
    s_waitcnt lgkmcnt(0)
    v_readfirstlane_b32 s32, v10
    s_cmp_eq_u32 s32, 0
    s_cbranch_scc1 L_wtk
    s_and_b32 s5, s32, 7
    s_xor_b32 s5, s5, s48
    s_bitcmp1_b32 s32, 3
    s_cselect_b64 vcc, -1, 0
    v_cndmask_b32 v50, v62, v63, vcc
    s_branch L_evretK
L_evV:
    s_nop 1
    s_lshr_b32 s33, s30, 4
    s_lshl_b32 s34, s33, 2
    v_mov_b32 v11, s34
    s_mov_b32 s6, 0x100000
L_wtv2:
    s_nop 1
    ds_read_b32 v10, v11 offset:24
    s_sub_u32 s6, s6, 1
    s_cbranch_scc1 L_exit1
    s_waitcnt lgkmcnt(0)
    v_readfirstlane_b32 s32, v10
    s_cmp_eq_u32 s32, 0
    s_cbranch_scc1 L_wtv2
    s_and_b32 s5, s32, 7
    s_xor_b32 s5, s5, s48
    s_bitcmp1_b32 s32, 3
    s_cselect_b64 vcc, -1, 0
    v_cndmask_b32 v50, v62, v63, vcc
    s_branch L_evretV
L_helper:
    s_nop 1
    s_sub_u32 s6, s28, 4
    s_mov_b32 s5, s48
    v_mov_b32 v1, v11
    v_mov_b32 v2, 0
    s_lshl_b32 s59, s3, 6
    s_add_u32 s59, s59, 1048576
    s_cmp_lt_u32 s3, 7
    s_cbranch_scc0 L_noprobe1
    s_max_u32 s7, s3, 1
    s_sub_u32 s7, s7, 1
    s_and_b32 s48, s3, 1
    s_mul_i32 s20, s48, 21
    s_mul_i32 s49, s6, 40
    s_add_u32 s20, s20, s49
    s_add_u32 s20, s20, 2
    s_lshl_b32 s20, s20, 21
    s_xor_b32 s21, s4, s6
    s_and_b32 s21, s21, 1
    s_lshr_b32 s49, s4, 2
    s_xor_b32 s48, s48, s49
    s_xor_b32 s48, s48, s21
    s_lshl_b32 s48, s48, 13
    s_xor_b32 s32, s48, 0x0
    s_xor_b32 s33, s48, 0x2000
    s_xor_b32 s34, s48, 0x1000
    s_xor_b32 s35, s48, 0x3000
    s_xor_b32 s36, s48, 0x4000
    s_xor_b32 s37, s48, 0x6000
    s_xor_b32 s38, s48, 0x5000
    s_xor_b32 s39, s48, 0x7000
    v_and_b32 v3, 7, v1
    v_lshlrev_b32 v3, 12, v3
    s_lshl_b32 s48, s4, 8
    v_add_u32 v3, s48, v3
    s_mov_b32 s10, 805306368
    s_mov_b32 s11, 0x00020000
    s_cmp_ge_u32 s7, 3
    s_cselect_b32 s48, 3, 0
    s_sub_u32 s48, s7, s48
    s_lshl_b32 s48, s48, 28
    s_add_u32 s20, s20, s48
    s_cmp_ge_u32 s7, 3
    s_waitcnt lgkmcnt(0)
    s_cselect_b32 s8, s68, s66
    s_cselect_b32 s23, s69, s67
    s_and_b32 s9, s23, 0xffff
    s_mov_b64 exec, 0xff
    buffer_load_dword v4, v3, s[8:11], s20 offen
    s_mov_b64 exec, -1
    s_add_u32 s22, s8, s20
    s_addc_u32 s23, s23, 0
    s_lshl_b32 s48, s4, 8
    s_add_u32 s48, s48, 128
    s_load_dword s45, s[22:23], s48
L_noprobe1:
    s_nop 1
    s_waitcnt lgkmcnt(0)
    s_mov_b32 s12, s82
    s_and_b32 s13, s83, 0xffff
    s_mov_b32 s14, 8388608
    s_mov_b32 s15, 0x00020000
    s_mov_b32 s16, s80
    s_and_b32 s17, s81, 0xffff
    s_mov_b32 s18, 256
    s_mov_b32 s19, 0x00020000
    s_lshl_b32 s48, s2, 2
    s_add_u32 s48, s48, s6
    s_cmp_lg_u32 s48, 1
    s_cbranch_scc1 L_nolead
    v_mov_b32 v16, 0
    v_mov_b32 v17, 0
    v_mov_b32 v18, 0
    v_mov_b32 v19, 0
    v_lshlrev_b32 v5, 4, v1
    s_mov_b32 s48, 1048576
    buffer_store_dwordx4 v[16:19], v5, s[12:15], s48 offen sc1
    buffer_store_dwordx4 v[16:19], v5, s[12:15], s48 offen offset:1024 sc1
L_nolead:
    s_nop 1
    s_cmp_lg_u32 s6, 0
    s_cbranch_scc1 L_hbar
    v_lshlrev_b32 v5, 2, v1
    ds_write_b32 v5, v2
    s_waitcnt lgkmcnt(0)
L_hbar:
    s_nop 1
    s_barrier
    s_cmp_lt_u32 s3, 7
    s_cbranch_scc0 L_role
    s_mov_b32 s46, 1
    s_mov_b32 s58, 0
    s_cmp_lt_u32 s3, 2
    s_cselect_b32 s47, 1, 3
    s_waitcnt vmcnt(0)
L_round:
    s_nop 1
    s_add_u32 s48, s4, s46
    s_and_b32 s48, s48, 7
    s_lshl_b32 s48, s48, 8
    s_add_u32 s56, s22, s48
    s_addc_u32 s57, s23, 0
    s_mov_b32 s44, -1
    s_memtime s[40:41]
    s_waitcnt lgkmcnt(0)
    s_load_dword s45, s[56:57], s32
    s_waitcnt lgkmcnt(0)
    s_memtime s[42:43]
    s_waitcnt lgkmcnt(0)
    s_sub_u32 s24, s42, s40
    s_load_dword s45, s[56:57], s33
    s_waitcnt lgkmcnt(0)
    s_memtime s[40:41]
    s_waitcnt lgkmcnt(0)
    s_sub_u32 s25, s40, s42
    s_load_dword s45, s[56:57], s34
    s_waitcnt lgkmcnt(0)
    s_memtime s[42:43]
    s_waitcnt lgkmcnt(0)
    s_sub_u32 s26, s42, s40
    s_load_dword s45, s[56:57], s35
    s_waitcnt lgkmcnt(0)
    s_memtime s[40:41]
    s_waitcnt lgkmcnt(0)
    s_sub_u32 s27, s40, s42
    s_load_dword s45, s[56:57], s36
    s_waitcnt lgkmcnt(0)
    s_memtime s[42:43]
    s_waitcnt lgkmcnt(0)
    s_sub_u32 s28, s42, s40
    s_load_dword s45, s[56:57], s37
    s_waitcnt lgkmcnt(0)
    s_memtime s[40:41]
    s_waitcnt lgkmcnt(0)
    s_sub_u32 s29, s40, s42
    s_load_dword s45, s[56:57], s38
    s_waitcnt lgkmcnt(0)
    s_memtime s[42:43]
    s_waitcnt lgkmcnt(0)
    s_sub_u32 s30, s42, s40
    s_load_dword s45, s[56:57], s39
    s_waitcnt lgkmcnt(0)
    s_memtime s[40:41]
    s_waitcnt lgkmcnt(0)
    s_sub_u32 s31, s40, s42
    s_min_u32 s24, s24, 1400
    s_min_u32 s44, s44, s24
    s_min_u32 s25, s25, 1400
    s_min_u32 s44, s44, s25
    s_min_u32 s26, s26, 1400
    s_min_u32 s44, s44, s26
    s_min_u32 s27, s27, 1400
    s_min_u32 s44, s44, s27
    s_min_u32 s28, s28, 1400
    s_min_u32 s44, s44, s28
    s_min_u32 s29, s29, 1400
    s_min_u32 s44, s44, s29
    s_min_u32 s30, s30, 1400
    s_min_u32 s44, s44, s30
    s_min_u32 s31, s31, 1400
    s_min_u32 s44, s44, s31
    s_cmp_lt_u32 s44, 290
    s_cbranch_scc1 L_skip
    s_sub_u32 s58, s58, s24
    s_add_u32 s58, s58, s25
    s_sub_u32 s58, s58, s26
    s_add_u32 s58, s58, s27
    s_sub_u32 s58, s58, s28
    s_add_u32 s58, s58, s29
    s_sub_u32 s58, s58, s30
    s_add_u32 s58, s58, s31
L_skip:
    s_nop 1
    s_add_u32 s46, s46, 1
    s_cmp_le_u32 s46, s47
    s_cbranch_scc1 L_round
    s_sub_u32 s48, 0, s58
    s_cmp_eq_u32 s21, 0
    s_cselect_b32 s58, s58, s48
    s_add_u32 s58, s58, 0x1010000
    v_mov_b32 v4, s58
    s_mov_b64 exec, 1
    ds_add_rtn_u32 v5, v2, v4 offset:36
    s_lshl_b32 s48, s7, 2
    s_add_u32 s48, s48, 124
    s_cmp_eq_u32 s7, 0
    s_cselect_b32 s48, 0, s48
    s_waitcnt lgkmcnt(0)
    v_add_u32 v4, v4, v5
    v_subrev_u32 v4, 0x2000000, v4
    v_cmp_le_u32 vcc, 0x2000000, v5
    s_and_b64 exec, exec, vcc
    buffer_atomic_add v4, off, s[16:19], s48
    s_mov_b64 exec, -1
L_role:
    s_nop 1
    s_cmp_eq_u32 s6, 0
    s_cbranch_scc1 L_h0
    s_cmp_eq_u32 s6, 2
    s_cbranch_scc1 L_h2
    v_lshlrev_b32 v5, 2, v1
    s_mov_b32 s60, 0x100000
L_wea:
    s_nop 1
    ds_read_b32 v10, v2 offset:56
    s_sub_u32 s60, s60, 1
    s_cbranch_scc1 L_exit1
    s_waitcnt lgkmcnt(0)
    v_readfirstlane_b32 s48, v10
    s_cmp_eq_u32 s48, 0
    s_cbranch_scc1 L_wea
    s_mov_b64 exec, 0x1
    s_mov_b32 s60, 0x40000
L_polla:
    s_nop 1
    buffer_load_dword v4, v5, s[16:19], 0 offen offset:0 sc1
    s_sub_u32 s60, s60, 1
    s_cbranch_scc1 L_exit1
    s_waitcnt vmcnt(0)
    v_lshrrev_b32 v6, 24, v4
    v_cmp_ne_u32 vcc, 16, v6
    s_cbranch_vccnz L_polla
    v_and_b32 v4, 0xffffff, v4
    v_subrev_u32 v4, 3145728, v4
    v_lshrrev_b32 v6, 30, v4
    v_and_b32 v6, 2, v6
    v_add_u32 v4, 9600, v4
    v_cmp_gt_u32 vcc, 19200, v4
    s_nop 1
    v_cndmask_b32 v6, v6, 8, vcc
    v_or_b32 v6, 16, v6
    ds_write_b32 v5, v6 offset:0
    s_mov_b64 exec, -1
    s_mov_b32 s60, 0x100000
L_web:
    s_nop 1
    ds_read_b32 v10, v2 offset:60
    s_sub_u32 s60, s60, 1
    s_cbranch_scc1 L_exit1
    s_waitcnt lgkmcnt(0)
    v_readfirstlane_b32 s48, v10
    s_cmp_eq_u32 s48, 0
    s_cbranch_scc1 L_web
    s_mov_b64 exec, 0x1f
    s_mov_b32 s60, 0x40000
L_pollb:
    s_nop 1
    buffer_load_dword v4, v5, s[16:19], 0 offen offset:128 sc1
    s_sub_u32 s60, s60, 1
    s_cbranch_scc1 L_exit1
    s_waitcnt vmcnt(0)
    v_lshrrev_b32 v6, 24, v4
    v_cmp_ne_u32 vcc, 8, v6
    s_cbranch_vccnz L_pollb
    v_and_b32 v4, 0xffffff, v4
    v_subrev_u32 v4, 1572864, v4
    v_lshrrev_b32 v6, 30, v4
    v_and_b32 v6, 2, v6
    v_add_u32 v4, 14400, v4
    v_cmp_gt_u32 vcc, 28800, v4
    s_nop 1
    v_cndmask_b32 v6, v6, 8, vcc
    v_or_b32 v6, 16, v6
    ds_write_b32 v5, v6 offset:4
    s_mov_b64 exec, -1
    s_endpgm
L_h0:
    s_nop 1
    s_mov_b32 s8, s64
    s_and_b32 s9, s65, 0xffff
    s_mov_b32 s10, 12288
    s_mov_b32 s11, 0x00020000
    s_mov_b32 s92, s70
    s_and_b32 s93, s71, 0xffff
    s_mov_b32 s94, 6291456
    s_mov_b32 s95, 0x00020000
    s_mov_b32 s96, s72
    s_and_b32 s97, s73, 0xffff
    s_mov_b32 s98, 6291456
    s_mov_b32 s99, 0x00020000
    v_lshrrev_b32 v4, 4, v1
    v_and_b32 v5, 15, v1
    v_lshlrev_b32 v6, 3, v5
    v_mul_u32_u24 v7, 384, v4
    v_add_u32 v7, v7, v6
    v_lshl_add_u32 v13, v5, 2, v4
    v_lshlrev_b32 v13, 2, v13
    s_mov_b32 s61, 0
L_bias:
    s_nop 1
    s_lshl_b32 s62, s61, 5
    s_add_u32 s62, s62, s3
    s_lshl_b32 s63, s62, 15
    s_add_u32 s63, s63, 1
    s_mul_hi_u32 s63, s63, 0xaaaaaaab
    s_lshr_b32 s63, s63, 7
    s_mul_i32 s48, s62, 171
    s_lshr_b32 s48, s48, 9
    s_mul_i32 s48, s48, 384
    s_mul_i32 s49, s4, 24
    s_add_u32 s50, s49, s63
    s_mul_i32 s50, s50, 384
    v_add_u32 v10, s50, v7
    v_add_u32 v11, 3072, v10
    v_add_u32 v12, 6144, v10
    buffer_load_dwordx2 v[100:101], v6, s[8:11], s48 offen offset:0
    buffer_load_dwordx2 v[102:103], v6, s[8:11], s48 offen offset:128
    buffer_load_dwordx2 v[104:105], v6, s[8:11], s48 offen offset:256
    buffer_load_dwordx2 v[28:29], v10, s[92:95], 0 offen offset:0
    buffer_load_dwordx2 v[30:31], v10, s[92:95], 0 offen offset:128
    buffer_load_dwordx2 v[32:33], v10, s[92:95], 0 offen offset:256
    buffer_load_dwordx2 v[64:65], v10, s[96:99], 0 offen offset:0
    buffer_load_dwordx2 v[66:67], v10, s[96:99], 0 offen offset:128
    buffer_load_dwordx2 v[68:69], v10, s[96:99], 0 offen offset:256
    buffer_load_dwordx2 v[34:35], v10, s[92:95], 0 offen offset:1536
    buffer_load_dwordx2 v[36:37], v10, s[92:95], 0 offen offset:1664
    buffer_load_dwordx2 v[38:39], v10, s[92:95], 0 offen offset:1792
    buffer_load_dwordx2 v[70:71], v10, s[96:99], 0 offen offset:1536
    buffer_load_dwordx2 v[72:73], v10, s[96:99], 0 offen offset:1664
    buffer_load_dwordx2 v[74:75], v10, s[96:99], 0 offen offset:1792
    buffer_load_dwordx2 v[40:41], v11, s[92:95], 0 offen offset:0
    buffer_load_dwordx2 v[42:43], v11, s[92:95], 0 offen offset:128
    buffer_load_dwordx2 v[44:45], v11, s[92:95], 0 offen offset:256
    buffer_load_dwordx2 v[76:77], v11, s[96:99], 0 offen offset:0
    buffer_load_dwordx2 v[78:79], v11, s[96:99], 0 offen offset:128
    buffer_load_dwordx2 v[80:81], v11, s[96:99], 0 offen offset:256
    buffer_load_dwordx2 v[46:47], v11, s[92:95], 0 offen offset:1536
    buffer_load_dwordx2 v[48:49], v11, s[92:95], 0 offen offset:1664
    buffer_load_dwordx2 v[50:51], v11, s[92:95], 0 offen offset:1792
    buffer_load_dwordx2 v[82:83], v11, s[96:99], 0 offen offset:1536
    buffer_load_dwordx2 v[84:85], v11, s[96:99], 0 offen offset:1664
    buffer_load_dwordx2 v[86:87], v11, s[96:99], 0 offen offset:1792
    buffer_load_dwordx2 v[52:53], v12, s[92:95], 0 offen offset:0
    buffer_load_dwordx2 v[54:55], v12, s[92:95], 0 offen offset:128
    buffer_load_dwordx2 v[56:57], v12, s[92:95], 0 offen offset:256
    buffer_load_dwordx2 v[88:89], v12, s[96:99], 0 offen offset:0
    buffer_load_dwordx2 v[90:91], v12, s[96:99], 0 offen offset:128
    buffer_load_dwordx2 v[92:93], v12, s[96:99], 0 offen offset:256
    buffer_load_dwordx2 v[58:59], v12, s[92:95], 0 offen offset:1536
    buffer_load_dwordx2 v[60:61], v12, s[92:95], 0 offen offset:1664
    buffer_load_dwordx2 v[62:63], v12, s[92:95], 0 offen offset:1792
    buffer_load_dwordx2 v[94:95], v12, s[96:99], 0 offen offset:1536
    buffer_load_dwordx2 v[96:97], v12, s[96:99], 0 offen offset:1664
    buffer_load_dwordx2 v[98:99], v12, s[96:99], 0 offen offset:1792
    s_waitcnt vmcnt(0)
    v_lshlrev_b32 v16, 16, v100
    v_and_b32 v17, 0xffff0000, v100
    v_lshlrev_b32 v18, 16, v101
    v_and_b32 v19, 0xffff0000, v101
    v_lshlrev_b32 v20, 16, v102
    v_and_b32 v21, 0xffff0000, v102
    v_lshlrev_b32 v22, 16, v103
    v_and_b32 v23, 0xffff0000, v103
    v_lshlrev_b32 v24, 16, v104
    v_and_b32 v25, 0xffff0000, v104
    v_lshlrev_b32 v26, 16, v105
    v_and_b32 v27, 0xffff0000, v105
    v_lshlrev_b32 v10, 16, v28
    v_lshlrev_b32 v11, 16, v64
    v_and_b32 v28, 0xffff0000, v28
    v_and_b32 v64, 0xffff0000, v64
    v_mul_f32 v10, v10, v16
    v_mul_f32 v28, v28, v17
    v_mul_f32 v100, v10, v11
    v_fmac_f32 v100, v28, v64
    v_lshlrev_b32 v10, 16, v29
    v_lshlrev_b32 v11, 16, v65
    v_and_b32 v29, 0xffff0000, v29
    v_and_b32 v65, 0xffff0000, v65
    v_mul_f32 v10, v10, v18
    v_mul_f32 v29, v29, v19
    v_fmac_f32 v100, v10, v11
    v_fmac_f32 v100, v29, v65
    v_lshlrev_b32 v10, 16, v30
    v_lshlrev_b32 v11, 16, v66
    v_and_b32 v30, 0xffff0000, v30
    v_and_b32 v66, 0xffff0000, v66
    v_mul_f32 v10, v10, v20
    v_mul_f32 v30, v30, v21
    v_fmac_f32 v100, v10, v11
    v_fmac_f32 v100, v30, v66
    v_lshlrev_b32 v10, 16, v31
    v_lshlrev_b32 v11, 16, v67
    v_and_b32 v31, 0xffff0000, v31
    v_and_b32 v67, 0xffff0000, v67
    v_mul_f32 v10, v10, v22
    v_mul_f32 v31, v31, v23
    v_fmac_f32 v100, v10, v11
    v_fmac_f32 v100, v31, v67
    v_lshlrev_b32 v10, 16, v32
    v_lshlrev_b32 v11, 16, v68
    v_and_b32 v32, 0xffff0000, v32
    v_and_b32 v68, 0xffff0000, v68
    v_mul_f32 v10, v10, v24
    v_mul_f32 v32, v32, v25
    v_fmac_f32 v100, v10, v11
    v_fmac_f32 v100, v32, v68
    v_lshlrev_b32 v10, 16, v33
    v_lshlrev_b32 v11, 16, v69
    v_and_b32 v33, 0xffff0000, v33
    v_and_b32 v69, 0xffff0000, v69
    v_mul_f32 v10, v10, v26
    v_mul_f32 v33, v33, v27
    v_fmac_f32 v100, v10, v11
    v_fmac_f32 v100, v33, v69
    v_lshlrev_b32 v10, 16, v34
    v_lshlrev_b32 v11, 16, v70
    v_and_b32 v34, 0xffff0000, v34
    v_and_b32 v70, 0xffff0000, v70
    v_mul_f32 v10, v10, v16
    v_mul_f32 v34, v34, v17
    v_mul_f32 v101, v10, v11
    v_fmac_f32 v101, v34, v70
    v_lshlrev_b32 v10, 16, v35
    v_lshlrev_b32 v11, 16, v71
    v_and_b32 v35, 0xffff0000, v35
    v_and_b32 v71, 0xffff0000, v71
    v_mul_f32 v10, v10, v18
    v_mul_f32 v35, v35, v19
    v_fmac_f32 v101, v10, v11
    v_fmac_f32 v101, v35, v71
    v_lshlrev_b32 v10, 16, v36
    v_lshlrev_b32 v11, 16, v72
    v_and_b32 v36, 0xffff0000, v36
    v_and_b32 v72, 0xffff0000, v72
    v_mul_f32 v10, v10, v20
    v_mul_f32 v36, v36, v21
    v_fmac_f32 v101, v10, v11
    v_fmac_f32 v101, v36, v72
    v_lshlrev_b32 v10, 16, v37
    v_lshlrev_b32 v11, 16, v73
    v_and_b32 v37, 0xffff0000, v37
    v_and_b32 v73, 0xffff0000, v73
    v_mul_f32 v10, v10, v22
    v_mul_f32 v37, v37, v23
    v_fmac_f32 v101, v10, v11
    v_fmac_f32 v101, v37, v73
    v_lshlrev_b32 v10, 16, v38
    v_lshlrev_b32 v11, 16, v74
    v_and_b32 v38, 0xffff0000, v38
    v_and_b32 v74, 0xffff0000, v74
    v_mul_f32 v10, v10, v24
    v_mul_f32 v38, v38, v25
    v_fmac_f32 v101, v10, v11
    v_fmac_f32 v101, v38, v74
    v_lshlrev_b32 v10, 16, v39
    v_lshlrev_b32 v11, 16, v75
    v_and_b32 v39, 0xffff0000, v39
    v_and_b32 v75, 0xffff0000, v75
    v_mul_f32 v10, v10, v26
    v_mul_f32 v39, v39, v27
    v_fmac_f32 v101, v10, v11
    v_fmac_f32 v101, v39, v75
    v_lshlrev_b32 v10, 16, v40
    v_lshlrev_b32 v11, 16, v76
    v_and_b32 v40, 0xffff0000, v40
    v_and_b32 v76, 0xffff0000, v76
    v_mul_f32 v10, v10, v16
    v_mul_f32 v40, v40, v17
    v_mul_f32 v102, v10, v11
    v_fmac_f32 v102, v40, v76
    v_lshlrev_b32 v10, 16, v41
    v_lshlrev_b32 v11, 16, v77
    v_and_b32 v41, 0xffff0000, v41
    v_and_b32 v77, 0xffff0000, v77
    v_mul_f32 v10, v10, v18
    v_mul_f32 v41, v41, v19
    v_fmac_f32 v102, v10, v11
    v_fmac_f32 v102, v41, v77
    v_lshlrev_b32 v10, 16, v42
    v_lshlrev_b32 v11, 16, v78
    v_and_b32 v42, 0xffff0000, v42
    v_and_b32 v78, 0xffff0000, v78
    v_mul_f32 v10, v10, v20
    v_mul_f32 v42, v42, v21
    v_fmac_f32 v102, v10, v11
    v_fmac_f32 v102, v42, v78
    v_lshlrev_b32 v10, 16, v43
    v_lshlrev_b32 v11, 16, v79
    v_and_b32 v43, 0xffff0000, v43
    v_and_b32 v79, 0xffff0000, v79
    v_mul_f32 v10, v10, v22
    v_mul_f32 v43, v43, v23
    v_fmac_f32 v102, v10, v11
    v_fmac_f32 v102, v43, v79
    v_lshlrev_b32 v10, 16, v44
    v_lshlrev_b32 v11, 16, v80
    v_and_b32 v44, 0xffff0000, v44
    v_and_b32 v80, 0xffff0000, v80
    v_mul_f32 v10, v10, v24
    v_mul_f32 v44, v44, v25
    v_fmac_f32 v102, v10, v11
    v_fmac_f32 v102, v44, v80
    v_lshlrev_b32 v10, 16, v45
    v_lshlrev_b32 v11, 16, v81
    v_and_b32 v45, 0xffff0000, v45
    v_and_b32 v81, 0xffff0000, v81
    v_mul_f32 v10, v10, v26
    v_mul_f32 v45, v45, v27
    v_fmac_f32 v102, v10, v11
    v_fmac_f32 v102, v45, v81
    v_lshlrev_b32 v10, 16, v46
    v_lshlrev_b32 v11, 16, v82
    v_and_b32 v46, 0xffff0000, v46
    v_and_b32 v82, 0xffff0000, v82
    v_mul_f32 v10, v10, v16
    v_mul_f32 v46, v46, v17
    v_mul_f32 v103, v10, v11
    v_fmac_f32 v103, v46, v82
    v_lshlrev_b32 v10, 16, v47
    v_lshlrev_b32 v11, 16, v83
    v_and_b32 v47, 0xffff0000, v47
    v_and_b32 v83, 0xffff0000, v83
    v_mul_f32 v10, v10, v18
    v_mul_f32 v47, v47, v19
    v_fmac_f32 v103, v10, v11
    v_fmac_f32 v103, v47, v83
    v_lshlrev_b32 v10, 16, v48
    v_lshlrev_b32 v11, 16, v84
    v_and_b32 v48, 0xffff0000, v48
    v_and_b32 v84, 0xffff0000, v84
    v_mul_f32 v10, v10, v20
    v_mul_f32 v48, v48, v21
    v_fmac_f32 v103, v10, v11
    v_fmac_f32 v103, v48, v84
    v_lshlrev_b32 v10, 16, v49
    v_lshlrev_b32 v11, 16, v85
    v_and_b32 v49, 0xffff0000, v49
    v_and_b32 v85, 0xffff0000, v85
    v_mul_f32 v10, v10, v22
    v_mul_f32 v49, v49, v23
    v_fmac_f32 v103, v10, v11
    v_fmac_f32 v103, v49, v85
    v_lshlrev_b32 v10, 16, v50
    v_lshlrev_b32 v11, 16, v86
    v_and_b32 v50, 0xffff0000, v50
    v_and_b32 v86, 0xffff0000, v86
    v_mul_f32 v10, v10, v24
    v_mul_f32 v50, v50, v25
    v_fmac_f32 v103, v10, v11
    v_fmac_f32 v103, v50, v86
    v_lshlrev_b32 v10, 16, v51
    v_lshlrev_b32 v11, 16, v87
    v_and_b32 v51, 0xffff0000, v51
    v_and_b32 v87, 0xffff0000, v87
    v_mul_f32 v10, v10, v26
    v_mul_f32 v51, v51, v27
    v_fmac_f32 v103, v10, v11
    v_fmac_f32 v103, v51, v87
    v_lshlrev_b32 v10, 16, v52
    v_lshlrev_b32 v11, 16, v88
    v_and_b32 v52, 0xffff0000, v52
    v_and_b32 v88, 0xffff0000, v88
    v_mul_f32 v10, v10, v16
    v_mul_f32 v52, v52, v17
    v_mul_f32 v104, v10, v11
    v_fmac_f32 v104, v52, v88
    v_lshlrev_b32 v10, 16, v53
    v_lshlrev_b32 v11, 16, v89
    v_and_b32 v53, 0xffff0000, v53
    v_and_b32 v89, 0xffff0000, v89
    v_mul_f32 v10, v10, v18
    v_mul_f32 v53, v53, v19
    v_fmac_f32 v104, v10, v11
    v_fmac_f32 v104, v53, v89
    v_lshlrev_b32 v10, 16, v54
    v_lshlrev_b32 v11, 16, v90
    v_and_b32 v54, 0xffff0000, v54
    v_and_b32 v90, 0xffff0000, v90
    v_mul_f32 v10, v10, v20
    v_mul_f32 v54, v54, v21
    v_fmac_f32 v104, v10, v11
    v_fmac_f32 v104, v54, v90
    v_lshlrev_b32 v10, 16, v55
    v_lshlrev_b32 v11, 16, v91
    v_and_b32 v55, 0xffff0000, v55
    v_and_b32 v91, 0xffff0000, v91
    v_mul_f32 v10, v10, v22
    v_mul_f32 v55, v55, v23
    v_fmac_f32 v104, v10, v11
    v_fmac_f32 v104, v55, v91
    v_lshlrev_b32 v10, 16, v56
    v_lshlrev_b32 v11, 16, v92
    v_and_b32 v56, 0xffff0000, v56
    v_and_b32 v92, 0xffff0000, v92
    v_mul_f32 v10, v10, v24
    v_mul_f32 v56, v56, v25
    v_fmac_f32 v104, v10, v11
    v_fmac_f32 v104, v56, v92
    v_lshlrev_b32 v10, 16, v57
    v_lshlrev_b32 v11, 16, v93
    v_and_b32 v57, 0xffff0000, v57
    v_and_b32 v93, 0xffff0000, v93
    v_mul_f32 v10, v10, v26
    v_mul_f32 v57, v57, v27
    v_fmac_f32 v104, v10, v11
    v_fmac_f32 v104, v57, v93
    v_lshlrev_b32 v10, 16, v58
    v_lshlrev_b32 v11, 16, v94
    v_and_b32 v58, 0xffff0000, v58
    v_and_b32 v94, 0xffff0000, v94
    v_mul_f32 v10, v10, v16
    v_mul_f32 v58, v58, v17
    v_mul_f32 v105, v10, v11
    v_fmac_f32 v105, v58, v94
    v_lshlrev_b32 v10, 16, v59
    v_lshlrev_b32 v11, 16, v95
    v_and_b32 v59, 0xffff0000, v59
    v_and_b32 v95, 0xffff0000, v95
    v_mul_f32 v10, v10, v18
    v_mul_f32 v59, v59, v19
    v_fmac_f32 v105, v10, v11
    v_fmac_f32 v105, v59, v95
    v_lshlrev_b32 v10, 16, v60
    v_lshlrev_b32 v11, 16, v96
    v_and_b32 v60, 0xffff0000, v60
    v_and_b32 v96, 0xffff0000, v96
    v_mul_f32 v10, v10, v20
    v_mul_f32 v60, v60, v21
    v_fmac_f32 v105, v10, v11
    v_fmac_f32 v105, v60, v96
    v_lshlrev_b32 v10, 16, v61
    v_lshlrev_b32 v11, 16, v97
    v_and_b32 v61, 0xffff0000, v61
    v_and_b32 v97, 0xffff0000, v97
    v_mul_f32 v10, v10, v22
    v_mul_f32 v61, v61, v23
    v_fmac_f32 v105, v10, v11
    v_fmac_f32 v105, v61, v97
    v_lshlrev_b32 v10, 16, v62
    v_lshlrev_b32 v11, 16, v98
    v_and_b32 v62, 0xffff0000, v62
    v_and_b32 v98, 0xffff0000, v98
    v_mul_f32 v10, v10, v24
    v_mul_f32 v62, v62, v25
    v_fmac_f32 v105, v10, v11
    v_fmac_f32 v105, v62, v98
    v_lshlrev_b32 v10, 16, v63
    v_lshlrev_b32 v11, 16, v99
    v_and_b32 v63, 0xffff0000, v63
    v_and_b32 v99, 0xffff0000, v99
    v_mul_f32 v10, v10, v26
    v_mul_f32 v63, v63, v27
    v_fmac_f32 v105, v10, v11
    v_fmac_f32 v105, v63, v99
    v_add_f32_dpp v100, v100, v100 row_ror:8 row_mask:0xf bank_mask:0xf
    v_add_f32_dpp v101, v101, v101 row_ror:8 row_mask:0xf bank_mask:0xf
    v_add_f32_dpp v102, v102, v102 row_ror:8 row_mask:0xf bank_mask:0xf
    v_add_f32_dpp v103, v103, v103 row_ror:8 row_mask:0xf bank_mask:0xf
    v_add_f32_dpp v104, v104, v104 row_ror:8 row_mask:0xf bank_mask:0xf
    v_add_f32_dpp v105, v105, v105 row_ror:8 row_mask:0xf bank_mask:0xf
    v_add_f32_dpp v100, v100, v100 row_ror:4 row_mask:0xf bank_mask:0xf
    v_add_f32_dpp v101, v101, v101 row_ror:4 row_mask:0xf bank_mask:0xf
    v_add_f32_dpp v102, v102, v102 row_ror:4 row_mask:0xf bank_mask:0xf
    v_add_f32_dpp v103, v103, v103 row_ror:4 row_mask:0xf bank_mask:0xf
    v_add_f32_dpp v104, v104, v104 row_ror:4 row_mask:0xf bank_mask:0xf
    v_add_f32_dpp v105, v105, v105 row_ror:4 row_mask:0xf bank_mask:0xf
    v_add_f32_dpp v100, v100, v100 row_ror:2 row_mask:0xf bank_mask:0xf
    v_add_f32_dpp v101, v101, v101 row_ror:2 row_mask:0xf bank_mask:0xf
    v_add_f32_dpp v102, v102, v102 row_ror:2 row_mask:0xf bank_mask:0xf
    v_add_f32_dpp v103, v103, v103 row_ror:2 row_mask:0xf bank_mask:0xf
    v_add_f32_dpp v104, v104, v104 row_ror:2 row_mask:0xf bank_mask:0xf
    v_add_f32_dpp v105, v105, v105 row_ror:2 row_mask:0xf bank_mask:0xf
    v_add_f32_dpp v100, v100, v100 row_ror:1 row_mask:0xf bank_mask:0xf
    v_add_f32_dpp v101, v101, v101 row_ror:1 row_mask:0xf bank_mask:0xf
    v_add_f32_dpp v102, v102, v102 row_ror:1 row_mask:0xf bank_mask:0xf
    v_add_f32_dpp v103, v103, v103 row_ror:1 row_mask:0xf bank_mask:0xf
    v_add_f32_dpp v104, v104, v104 row_ror:1 row_mask:0xf bank_mask:0xf
    v_add_f32_dpp v105, v105, v105 row_ror:1 row_mask:0xf bank_mask:0xf
    v_cmp_eq_u32 vcc, 1, v5
    s_nop 1
    v_cndmask_b32 v100, v100, v101, vcc
    v_cmp_eq_u32 vcc, 2, v5
    s_nop 1
    v_cndmask_b32 v100, v100, v102, vcc
    v_cmp_eq_u32 vcc, 3, v5
    s_nop 1
    v_cndmask_b32 v100, v100, v103, vcc
    v_cmp_eq_u32 vcc, 4, v5
    s_nop 1
    v_cndmask_b32 v100, v100, v104, vcc
    v_cmp_eq_u32 vcc, 5, v5
    s_nop 1
    v_cndmask_b32 v100, v100, v105, vcc
    s_mul_i32 s48, s62, 768
    s_lshl_b32 s49, s49, 2
    s_add_u32 s48, s48, s49
    s_add_u32 s48, s48, 1179648
    s_mov_b32 exec_lo, 0x003f003f
    s_mov_b32 exec_hi, 0x003f003f
    buffer_store_dword v100, v13, s[12:15], s48 offen sc1
    s_mov_b64 exec, -1
    s_add_u32 s61, s61, 1
    s_cmp_lt_u32 s61, 3
    s_cbranch_scc1 L_bias
    v_lshlrev_b32 v4, 4, v1
    s_lshl_b32 s52, s5, 2
    s_add_u32 s52, s52, s59
    s_lshl_b32 s53, s3, 3
    s_add_u32 s53, s53, s5
    s_mul_i32 s53, s53, 24576
    s_add_u32 s53, s53, 2097152
    s_mov_b32 s60, 0x100000
L_wd0:
    s_nop 1
    ds_read_b32 v10, v2 offset:20
    s_sub_u32 s60, s60, 1
    s_cbranch_scc1 L_exit1
    s_waitcnt lgkmcnt(0)
    v_readfirstlane_b32 s48, v10
    s_cmp_eq_u32 s48, 0
    s_cbranch_scc1 L_wd0
    ds_read_b128 v[16:19], v2 offset:0
    ds_read_b64 v[20:21], v2 offset:16
    s_waitcnt lgkmcnt(0)
    v_readfirstlane_b32 s84, v16
    v_readfirstlane_b32 s85, v17
    v_readfirstlane_b32 s86, v18
    v_readfirstlane_b32 s87, v19
    v_readfirstlane_b32 s88, v20
    v_readfirstlane_b32 s89, v21
    s_mov_b32 s60, 0x100000
L_wf0:
    s_nop 1
    ds_read_b32 v10, v2 offset:40
    s_sub_u32 s60, s60, 1
    s_cbranch_scc1 L_exit1
    s_waitcnt lgkmcnt(0)
    v_readfirstlane_b32 s48, v10
    s_cmp_lt_u32 s48, 4
    s_cbranch_scc1 L_wf0
    s_cmp_eq_u32 s84, s87
    ds_read_b128 v[16:19], v4 offset:256
    ds_read_b128 v[20:23], v4 offset:1280
    ds_read_b128 v[24:27], v4 offset:2304
    ds_read_b128 v[28:31], v4 offset:3328
    ds_read_b128 v[32:35], v4 offset:4352
    ds_read_b128 v[36:39], v4 offset:5376
    ds_read_b128 v[40:43], v4 offset:6400
    ds_read_b128 v[44:47], v4 offset:7424
    s_add_u32 s54, s53, 0
    s_add_u32 s55, s53, 4096
    s_cmp_eq_u32 s84, s87
    s_waitcnt lgkmcnt(0)
    buffer_store_dwordx4 v[16:19], v4, s[12:15], s54 offen offset:0 sc1
    buffer_store_dwordx4 v[20:23], v4, s[12:15], s54 offen offset:1024 sc1
    s_cbranch_scc1 L_fl0
    buffer_store_dwordx4 v[24:27], v4, s[12:15], s54 offen offset:2048 sc1
    buffer_store_dwordx4 v[28:31], v4, s[12:15], s54 offen offset:3072 sc1
    buffer_store_dwordx4 v[32:35], v4, s[12:15], s55 offen offset:0 sc1
    buffer_store_dwordx4 v[36:39], v4, s[12:15], s55 offen offset:1024 sc1
    buffer_store_dwordx4 v[40:43], v4, s[12:15], s55 offen offset:2048 sc1
    buffer_store_dwordx4 v[44:47], v4, s[12:15], s55 offen offset:3072 sc1
L_fl0:
    s_nop 1
    v_mov_b32 v10, 1
    s_waitcnt vmcnt(0)
    s_mov_b64 exec, 1
    buffer_store_dword v10, off, s[12:15], s52 sc1
    ds_write_b32 v2, v10 offset:52
    s_mov_b64 exec, -1
    s_mov_b32 s60, 0x100000
L_wf1:
    s_nop 1
    ds_read_b32 v10, v2 offset:44
    s_sub_u32 s60, s60, 1
    s_cbranch_scc1 L_exit1
    s_waitcnt lgkmcnt(0)
    v_readfirstlane_b32 s48, v10
    s_cmp_lt_u32 s48, 4
    s_cbranch_scc1 L_wf1
    s_cmp_eq_u32 s85, s88
    s_cbranch_scc1 L_fl1
    ds_read_b128 v[16:19], v4 offset:8448
    ds_read_b128 v[20:23], v4 offset:9472
    ds_read_b128 v[24:27], v4 offset:10496
    ds_read_b128 v[28:31], v4 offset:11520
    ds_read_b128 v[32:35], v4 offset:12544
    ds_read_b128 v[36:39], v4 offset:13568
    ds_read_b128 v[40:43], v4 offset:14592
    ds_read_b128 v[44:47], v4 offset:15616
    s_add_u32 s54, s53, 8192
    s_add_u32 s55, s53, 12288
    s_cmp_eq_u32 s85, s88
    s_waitcnt lgkmcnt(0)
    buffer_store_dwordx4 v[16:19], v4, s[12:15], s54 offen offset:0 sc1
    buffer_store_dwordx4 v[20:23], v4, s[12:15], s54 offen offset:1024 sc1
    buffer_store_dwordx4 v[24:27], v4, s[12:15], s54 offen offset:2048 sc1
    buffer_store_dwordx4 v[28:31], v4, s[12:15], s54 offen offset:3072 sc1
    buffer_store_dwordx4 v[32:35], v4, s[12:15], s55 offen offset:0 sc1
    buffer_store_dwordx4 v[36:39], v4, s[12:15], s55 offen offset:1024 sc1
    buffer_store_dwordx4 v[40:43], v4, s[12:15], s55 offen offset:2048 sc1
    buffer_store_dwordx4 v[44:47], v4, s[12:15], s55 offen offset:3072 sc1
L_fl1:
    s_nop 1
    v_mov_b32 v10, 2
    s_waitcnt vmcnt(0)
    s_mov_b64 exec, 1
    s_cbranch_scc1 L_fn1
    buffer_store_dword v10, off, s[12:15], s52 sc1
L_fn1:
    s_nop 1
    ds_write_b32 v2, v10 offset:52
    s_mov_b64 exec, -1
    s_mov_b32 s60, 0x100000
L_wf2:
    s_nop 1
    ds_read_b32 v10, v2 offset:48
    s_sub_u32 s60, s60, 1
    s_cbranch_scc1 L_exit1
    s_waitcnt lgkmcnt(0)
    v_readfirstlane_b32 s48, v10
    s_cmp_lt_u32 s48, 4
    s_cbranch_scc1 L_wf2
    s_cmp_eq_u32 s86, s89
    s_cbranch_scc1 L_fl2
    ds_read_b128 v[16:19], v4 offset:16640
    ds_read_b128 v[20:23], v4 offset:17664
    ds_read_b128 v[24:27], v4 offset:18688
    ds_read_b128 v[28:31], v4 offset:19712
    ds_read_b128 v[32:35], v4 offset:20736
    ds_read_b128 v[36:39], v4 offset:21760
    ds_read_b128 v[40:43], v4 offset:22784
    ds_read_b128 v[44:47], v4 offset:23808
    s_add_u32 s54, s53, 16384
    s_add_u32 s55, s53, 20480
    s_cmp_eq_u32 s86, s89
    s_waitcnt lgkmcnt(0)
    buffer_store_dwordx4 v[16:19], v4, s[12:15], s54 offen offset:0 sc1
    buffer_store_dwordx4 v[20:23], v4, s[12:15], s54 offen offset:1024 sc1
    buffer_store_dwordx4 v[24:27], v4, s[12:15], s54 offen offset:2048 sc1
    buffer_store_dwordx4 v[28:31], v4, s[12:15], s54 offen offset:3072 sc1
    buffer_store_dwordx4 v[32:35], v4, s[12:15], s55 offen offset:0 sc1
    buffer_store_dwordx4 v[36:39], v4, s[12:15], s55 offen offset:1024 sc1
    buffer_store_dwordx4 v[40:43], v4, s[12:15], s55 offen offset:2048 sc1
    buffer_store_dwordx4 v[44:47], v4, s[12:15], s55 offen offset:3072 sc1
L_fl2:
    s_nop 1
    v_mov_b32 v10, 3
    s_waitcnt vmcnt(0)
    s_mov_b64 exec, 1
    s_cbranch_scc1 L_fn2
    buffer_store_dword v10, off, s[12:15], s52 sc1
L_fn2:
    s_nop 1
    ds_write_b32 v2, v10 offset:52
    s_mov_b64 exec, -1
    s_endpgm
L_h2:
    s_nop 1
    s_mov_b32 s92, s74
    s_and_b32 s93, s75, 0xffff
    s_mov_b32 s94, 2097152
    s_mov_b32 s95, 0x00020000
    s_mov_b32 s96, s76
    s_and_b32 s97, s77, 0xffff
    s_mov_b32 s98, 2097152
    s_mov_b32 s99, 0x00020000
    v_lshlrev_b32 v4, 4, v1
    s_mul_i32 s49, s4, 2736
    s_add_u32 s48, s3, 0
    s_lshl_b32 s48, s48, 16
    s_mul_hi_u32 s48, s48, 0xaaaaaaab
    s_lshr_b32 s48, s48, 5
    s_lshl_b32 s48, s48, 4
    s_add_u32 s50, s48, s49
    buffer_load_dwordx4 v[24:27], v4, s[92:95], s50 offen offset:0
    buffer_load_dwordx4 v[28:31], v4, s[92:95], s50 offen offset:1024
    buffer_load_dwordx4 v[32:35], v4, s[92:95], s50 offen offset:2048
    buffer_load_dwordx4 v[36:39], v4, s[96:99], s50 offen offset:0
    buffer_load_dwordx4 v[40:43], v4, s[96:99], s50 offen offset:1024
    buffer_load_dwordx4 v[44:47], v4, s[96:99], s50 offen offset:2048
    s_add_u32 s48, s3, 32
    s_lshl_b32 s48, s48, 16
    s_mul_hi_u32 s48, s48, 0xaaaaaaab
    s_lshr_b32 s48, s48, 5
    s_lshl_b32 s48, s48, 4
    s_add_u32 s51, s48, s49
    buffer_load_dwordx4 v[48:51], v4, s[92:95], s51 offen offset:0
    buffer_load_dwordx4 v[52:55], v4, s[92:95], s51 offen offset:1024
    buffer_load_dwordx4 v[56:59], v4, s[92:95], s51 offen offset:2048
    buffer_load_dwordx4 v[60:63], v4, s[96:99], s51 offen offset:0
    buffer_load_dwordx4 v[64:67], v4, s[96:99], s51 offen offset:1024
    buffer_load_dwordx4 v[68:71], v4, s[96:99], s51 offen offset:2048
    s_add_u32 s48, s3, 64
    s_lshl_b32 s48, s48, 16
    s_mul_hi_u32 s48, s48, 0xaaaaaaab
    s_lshr_b32 s48, s48, 5
    s_lshl_b32 s48, s48, 4
    s_add_u32 s52, s48, s49
    buffer_load_dwordx4 v[72:75], v4, s[92:95], s52 offen offset:0
    buffer_load_dwordx4 v[76:79], v4, s[92:95], s52 offen offset:1024
    buffer_load_dwordx4 v[80:83], v4, s[92:95], s52 offen offset:2048
    buffer_load_dwordx4 v[84:87], v4, s[96:99], s52 offen offset:0
    buffer_load_dwordx4 v[88:91], v4, s[96:99], s52 offen offset:1024
    buffer_load_dwordx4 v[92:95], v4, s[96:99], s52 offen offset:2048
    s_mov_b32 s60, 0x100000
L_wd2:
    s_nop 1
    ds_read_b32 v10, v2 offset:20
    s_sub_u32 s60, s60, 1
    s_cbranch_scc1 L_exit1
    s_waitcnt lgkmcnt(0)
    v_readfirstlane_b32 s48, v10
    s_cmp_eq_u32 s48, 0
    s_cbranch_scc1 L_wd2
    ds_read_b128 v[16:19], v2 offset:0
    ds_read_b64 v[20:21], v2 offset:16
    s_waitcnt lgkmcnt(0)
    v_readfirstlane_b32 s84, v16
    v_readfirstlane_b32 s85, v17
    v_readfirstlane_b32 s86, v18
    v_readfirstlane_b32 s87, v19
    v_readfirstlane_b32 s88, v20
    v_readfirstlane_b32 s89, v21
    v_and_b32 v3, 3, v1
    v_and_b32 v15, 7, v1
    v_lshrrev_b32 v12, 2, v1
    s_mov_b32 s37, 0x3dd53b95
    s_mov_b32 s38, 0xaaaaaaab
    s_mov_b32 s61, 0
    s_mul_i32 s35, s3, 196608
    s_add_u32 s35, s35, 2097152
    s_mov_b32 s40, 24576
    v_lshlrev_b32 v14, 5, v1
    s_mov_b32 s34, 4
L_prep:
    s_nop 1
    s_lshl_b32 s62, s61, 5
    s_add_u32 s62, s62, s3
    s_lshl_b32 s63, s62, 15
    s_add_u32 s63, s63, 1
    s_mul_hi_u32 s63, s63, 0xaaaaaaab
    s_lshr_b32 s63, s63, 7
    s_mov_b32 s32, s84
    s_mov_b32 s39, s87
    s_mov_b32 s84, s85
    s_mov_b32 s85, s86
    s_mov_b32 s87, s88
    s_mov_b32 s88, s89
    s_add_u32 s33, s61, 1
    s_mov_b32 s60, 0x100000
L_wfd:
    s_nop 1
    ds_read_b32 v10, v2 offset:52
    s_sub_u32 s60, s60, 1
    s_cbranch_scc1 L_exit1
    s_waitcnt lgkmcnt(0)
    v_readfirstlane_b32 s48, v10
    s_cmp_lt_u32 s48, s33
    s_cbranch_scc1 L_wfd
    s_xor_b32 s48, s32, s39
    s_or_b32 s48, s48, s34
    s_cbranch_scc0 L_noflags
    v_lshlrev_b32 v4, 2, v1
    s_xor_b32 s48, s32, s39
    s_xor_b32 s48, s48, s5
    s_and_b32 s48, s48, 7
    v_mov_b32 v6, s33
    s_lshl_b64 vcc, 1, s48
    s_or_b32 s48, s32, s39
    s_bitcmp1_b32 s48, 3
    s_cselect_b64 vcc, -1, vcc
    v_cndmask_b32 v6, 1, v6, vcc
    s_mov_b64 exec, 0xff
    s_mov_b32 s60, 0x40000
L_flags:
    s_nop 1
    buffer_load_dword v5, v4, s[12:15], s59 offen sc1
    s_sub_u32 s60, s60, 1
    s_cbranch_scc1 L_exit1
    s_waitcnt vmcnt(0)
    v_cmp_gt_u32 vcc, v6, v5
    s_cbranch_vccnz L_flags
    s_mov_b64 exec, -1
L_noflags:
    s_nop 1
    s_and_b32 s48, s32, 7
    v_mov_b32 v8, s48
    s_bitcmp1_b32 s32, 3
    s_cselect_b64 vcc, -1, 0
    v_cndmask_b32 v8, v8, v15, vcc
    s_and_b32 s48, s39, 7
    v_mov_b32 v9, s48
    s_bitcmp1_b32 s39, 3
    s_cselect_b64 vcc, -1, 0
    v_cndmask_b32 v9, v9, v15, vcc
    v_xor_b32 v13, s5, v9
    v_lshl_or_b32 v13, v3, 3, v13
    s_lshl_b32 s36, s62, 6
    s_mul_i32 s49, s62, 768
    s_lshl_b32 s50, s63, 2
    s_sub_u32 s49, s49, s50
    s_add_u32 s49, s49, 1179648
    s_waitcnt vmcnt(0)
    v_add_u32 v4, 0, v12
    v_lshrrev_b32 v5, 2, v4
    v_cmp_gt_u32 vcc, s34, v5
    s_nop 1
    v_cndmask_b32 v7, v8, v15, vcc
    v_cmp_eq_u32 vcc, v7, v9
    v_xor_b32 v7, v7, v13
    v_and_b32 v7, 7, v7
    v_mad_u32_u24 v7, v7, s40, v14
    v_bfe_u32 v5, v4, 3, 2
    v_and_or_b32 v5, v4, 4, v5
    v_xor_b32 v5, v13, v5
    v_add_u32 v4, s36, v4
    v_lshl_add_u32 v6, v4, 5, v5
    v_lshl_add_u32 v6, v6, 4, 1
    v_mul_hi_u32 v6, v6, s38
    v_lshrrev_b32 v6, 1, v6
    s_mov_b64 exec, vcc
    ds_read_b128 v[16:19], v14 offset:256
    ds_read_b64 v[20:21], v14 offset:272
    s_not_b64 exec, vcc
    s_add_u32 s50, s35, 0
    buffer_load_dwordx4 v[16:19], v7, s[12:15], s50 offen sc1
    buffer_load_dwordx2 v[20:21], v7, s[12:15], s50 offen offset:16 sc1
    s_mov_b64 exec, -1
    v_lshrrev_b32 v10, 6, v6
    v_lshl_add_u32 v10, v10, 2, s49
    buffer_load_dword v22, v10, s[12:15], 0 offen sc1
    v_lshrrev_b32 v11, 1, v6
    v_lshlrev_b32 v11, 2, v11
    buffer_load_dwordx3 v[24:26], v11, s[92:95], 0 offen
    buffer_load_dword v27, v11, s[92:95], 0 offen offset:12
    buffer_load_dwordx3 v[28:30], v11, s[96:99], 0 offen
    buffer_load_dword v31, v11, s[96:99], 0 offen offset:12
    v_and_b32 v7, 15, v6
    v_cmp_eq_u32 s[24:25], 5, v7
    v_and_b32 v23, 1, v6
    v_lshlrev_b32 v23, 4, v23
    v_add_u32 v4, 16, v12
    v_cmp_eq_u32 vcc, v8, v9
    v_xor_b32 v7, v8, v13
    v_and_b32 v7, 7, v7
    v_mad_u32_u24 v7, v7, s40, v14
    v_bfe_u32 v5, v4, 3, 2
    v_and_or_b32 v5, v4, 4, v5
    v_xor_b32 v5, v13, v5
    v_add_u32 v4, s36, v4
    v_lshl_add_u32 v6, v4, 5, v5
    v_lshl_add_u32 v6, v6, 4, 1
    v_mul_hi_u32 v6, v6, s38
    v_lshrrev_b32 v6, 1, v6
    s_mov_b64 exec, vcc
    ds_read_b128 v[32:35], v14 offset:2304
    ds_read_b64 v[36:37], v14 offset:2320
    s_not_b64 exec, vcc
    s_add_u32 s50, s35, 2048
    buffer_load_dwordx4 v[32:35], v7, s[12:15], s50 offen sc1
    buffer_load_dwordx2 v[36:37], v7, s[12:15], s50 offen offset:16 sc1
    s_mov_b64 exec, -1
    v_lshrrev_b32 v10, 6, v6
    v_lshl_add_u32 v10, v10, 2, s49
    buffer_load_dword v38, v10, s[12:15], 0 offen sc1
    v_lshrrev_b32 v11, 1, v6
    v_lshlrev_b32 v11, 2, v11
    buffer_load_dwordx3 v[40:42], v11, s[92:95], 0 offen
    buffer_load_dword v43, v11, s[92:95], 0 offen offset:12
    buffer_load_dwordx3 v[44:46], v11, s[96:99], 0 offen
    buffer_load_dword v47, v11, s[96:99], 0 offen offset:12
    v_and_b32 v7, 15, v6
    v_cmp_eq_u32 s[26:27], 5, v7
    v_and_b32 v39, 1, v6
    v_lshlrev_b32 v39, 4, v39
    v_add_u32 v4, 32, v12
    v_cmp_eq_u32 vcc, v8, v9
    v_xor_b32 v7, v8, v13
    v_and_b32 v7, 7, v7
    v_mad_u32_u24 v7, v7, s40, v14
    v_bfe_u32 v5, v4, 3, 2
    v_and_or_b32 v5, v4, 4, v5
    v_xor_b32 v5, v13, v5
    v_add_u32 v4, s36, v4
    v_lshl_add_u32 v6, v4, 5, v5
    v_lshl_add_u32 v6, v6, 4, 1
    v_mul_hi_u32 v6, v6, s38
    v_lshrrev_b32 v6, 1, v6
    s_mov_b64 exec, vcc
    ds_read_b128 v[48:51], v14 offset:4352
    ds_read_b64 v[52:53], v14 offset:4368
    s_not_b64 exec, vcc
    s_add_u32 s50, s35, 4096
    buffer_load_dwordx4 v[48:51], v7, s[12:15], s50 offen sc1
    buffer_load_dwordx2 v[52:53], v7, s[12:15], s50 offen offset:16 sc1
    s_mov_b64 exec, -1
    v_lshrrev_b32 v10, 6, v6
    v_lshl_add_u32 v10, v10, 2, s49
    buffer_load_dword v54, v10, s[12:15], 0 offen sc1
    v_lshrrev_b32 v11, 1, v6
    v_lshlrev_b32 v11, 2, v11
    buffer_load_dwordx3 v[56:58], v11, s[92:95], 0 offen
    buffer_load_dword v59, v11, s[92:95], 0 offen offset:12
    buffer_load_dwordx3 v[60:62], v11, s[96:99], 0 offen
    buffer_load_dword v63, v11, s[96:99], 0 offen offset:12
    v_and_b32 v7, 15, v6
    v_cmp_eq_u32 s[28:29], 5, v7
    v_and_b32 v55, 1, v6
    v_lshlrev_b32 v55, 4, v55
    v_add_u32 v4, 48, v12
    v_cmp_eq_u32 vcc, v8, v9
    v_xor_b32 v7, v8, v13
    v_and_b32 v7, 7, v7
    v_mad_u32_u24 v7, v7, s40, v14
    v_bfe_u32 v5, v4, 3, 2
    v_and_or_b32 v5, v4, 4, v5
    v_xor_b32 v5, v13, v5
    v_add_u32 v4, s36, v4
    v_lshl_add_u32 v6, v4, 5, v5
    v_lshl_add_u32 v6, v6, 4, 1
    v_mul_hi_u32 v6, v6, s38
    v_lshrrev_b32 v6, 1, v6
    s_mov_b64 exec, vcc
    ds_read_b128 v[64:67], v14 offset:6400
    ds_read_b64 v[68:69], v14 offset:6416
    s_not_b64 exec, vcc
    s_add_u32 s50, s35, 6144
    buffer_load_dwordx4 v[64:67], v7, s[12:15], s50 offen sc1
    buffer_load_dwordx2 v[68:69], v7, s[12:15], s50 offen offset:16 sc1
    s_mov_b64 exec, -1
    v_lshrrev_b32 v10, 6, v6
    v_lshl_add_u32 v10, v10, 2, s49
    buffer_load_dword v70, v10, s[12:15], 0 offen sc1
    v_lshrrev_b32 v11, 1, v6
    v_lshlrev_b32 v11, 2, v11
    buffer_load_dwordx3 v[72:74], v11, s[92:95], 0 offen
    buffer_load_dword v75, v11, s[92:95], 0 offen offset:12
    buffer_load_dwordx3 v[76:78], v11, s[96:99], 0 offen
    buffer_load_dword v79, v11, s[96:99], 0 offen offset:12
    v_and_b32 v7, 15, v6
    v_cmp_eq_u32 s[30:31], 5, v7
    v_and_b32 v71, 1, v6
    v_lshlrev_b32 v71, 4, v71
    s_mov_b32 s34, 0
    v_mov_b32 v5, 0xf149f2ca
    v_mov_b32 v4, 0xf149f2ca
    s_waitcnt vmcnt(0) lgkmcnt(0)
    v_sub_f32 v16, v16, v22
    v_sub_f32 v17, v17, v22
    v_sub_f32 v18, v18, v22
    v_sub_f32 v19, v19, v22
    v_sub_f32 v20, v20, v22
    v_sub_f32 v21, v21, v22
    v_mul_f32 v16, s37, v16
    v_mul_f32 v17, s37, v17
    v_mul_f32 v18, s37, v18
    v_mul_f32 v19, s37, v19
    v_mul_f32 v20, s37, v20
    v_mul_f32 v21, s37, v21
    v_cndmask_b32 v21, v5, v21, s[24:25]
    v_max3_f32 v4, v4, v16, v17
    v_max3_f32 v4, v4, v18, v19
    v_max3_f32 v4, v4, v20, v21
    v_alignbit_b32 v24, v25, v24, v23
    v_alignbit_b32 v25, v26, v25, v23
    v_alignbit_b32 v26, v27, v26, v23
    v_alignbit_b32 v28, v29, v28, v23
    v_alignbit_b32 v29, v30, v29, v23
    v_alignbit_b32 v30, v31, v30, v23
    v_sub_f32 v32, v32, v38
    v_sub_f32 v33, v33, v38
    v_sub_f32 v34, v34, v38
    v_sub_f32 v35, v35, v38
    v_sub_f32 v36, v36, v38
    v_sub_f32 v37, v37, v38
    v_mul_f32 v32, s37, v32
    v_mul_f32 v33, s37, v33
    v_mul_f32 v34, s37, v34
    v_mul_f32 v35, s37, v35
    v_mul_f32 v36, s37, v36
    v_mul_f32 v37, s37, v37
    v_cndmask_b32 v37, v5, v37, s[26:27]
    v_max3_f32 v4, v4, v32, v33
    v_max3_f32 v4, v4, v34, v35
    v_max3_f32 v4, v4, v36, v37
    v_alignbit_b32 v40, v41, v40, v39
    v_alignbit_b32 v41, v42, v41, v39
    v_alignbit_b32 v42, v43, v42, v39
    v_alignbit_b32 v44, v45, v44, v39
    v_alignbit_b32 v45, v46, v45, v39
    v_alignbit_b32 v46, v47, v46, v39
    v_sub_f32 v48, v48, v54
    v_sub_f32 v49, v49, v54
    v_sub_f32 v50, v50, v54
    v_sub_f32 v51, v51, v54
    v_sub_f32 v52, v52, v54
    v_sub_f32 v53, v53, v54
    v_mul_f32 v48, s37, v48
    v_mul_f32 v49, s37, v49
    v_mul_f32 v50, s37, v50
    v_mul_f32 v51, s37, v51
    v_mul_f32 v52, s37, v52
    v_mul_f32 v53, s37, v53
    v_cndmask_b32 v53, v5, v53, s[28:29]
    v_max3_f32 v4, v4, v48, v49
    v_max3_f32 v4, v4, v50, v51
    v_max3_f32 v4, v4, v52, v53
    v_alignbit_b32 v56, v57, v56, v55
    v_alignbit_b32 v57, v58, v57, v55
    v_alignbit_b32 v58, v59, v58, v55
    v_alignbit_b32 v60, v61, v60, v55
    v_alignbit_b32 v61, v62, v61, v55
    v_alignbit_b32 v62, v63, v62, v55
    v_sub_f32 v64, v64, v70
    v_sub_f32 v65, v65, v70
    v_sub_f32 v66, v66, v70
    v_sub_f32 v67, v67, v70
    v_sub_f32 v68, v68, v70
    v_sub_f32 v69, v69, v70
    v_mul_f32 v64, s37, v64
    v_mul_f32 v65, s37, v65
    v_mul_f32 v66, s37, v66
    v_mul_f32 v67, s37, v67
    v_mul_f32 v68, s37, v68
    v_mul_f32 v69, s37, v69
    v_cndmask_b32 v69, v5, v69, s[30:31]
    v_max3_f32 v4, v4, v64, v65
    v_max3_f32 v4, v4, v66, v67
    v_max3_f32 v4, v4, v68, v69
    v_alignbit_b32 v72, v73, v72, v71
    v_alignbit_b32 v73, v74, v73, v71
    v_alignbit_b32 v74, v75, v74, v71
    v_alignbit_b32 v76, v77, v76, v71
    v_alignbit_b32 v77, v78, v77, v71
    v_alignbit_b32 v78, v79, v78, v71
    v_max_f32_dpp v4, v4, v4 row_ror:8 row_mask:0xf bank_mask:0xf
    s_nop 1
    v_max_f32_dpp v4, v4, v4 row_ror:4 row_mask:0xf bank_mask:0xf
    s_nop 1
    v_max_f32_dpp v4, v4, v4 row_ror:2 row_mask:0xf bank_mask:0xf
    s_nop 1
    v_max_f32_dpp v4, v4, v4 row_ror:1 row_mask:0xf bank_mask:0xf
    v_mov_b32 v5, v4
    s_nop 1
    v_permlane32_swap_b32 v4, v5
    v_max_f32 v4, v4, v5
    v_mov_b32 v5, v4
    s_nop 1
    v_permlane16_swap_b32 v4, v5
    v_max_f32 v4, v4, v5
    v_mov_b32 v5, 0
    v_mov_b32 v6, 0
    v_sub_f32 v16, v16, v4
    v_sub_f32 v17, v17, v4
    v_sub_f32 v18, v18, v4
    v_sub_f32 v19, v19, v4
    v_sub_f32 v20, v20, v4
    v_sub_f32 v21, v21, v4
    v_exp_f32 v16, v16
    v_exp_f32 v17, v17
    v_exp_f32 v18, v18
    v_exp_f32 v19, v19
    v_exp_f32 v20, v20
    v_exp_f32 v21, v21
    v_add_f32 v5, v5, v16
    v_lshlrev_b32 v10, 16, v24
    v_lshlrev_b32 v11, 16, v28
    v_mul_f32 v16, v16, v10
    v_fmac_f32 v6, v16, v11
    v_add_f32 v5, v5, v17
    v_and_b32 v10, 0xffff0000, v24
    v_and_b32 v11, 0xffff0000, v28
    v_mul_f32 v17, v17, v10
    v_fmac_f32 v6, v17, v11
    v_add_f32 v5, v5, v18
    v_lshlrev_b32 v10, 16, v25
    v_lshlrev_b32 v11, 16, v29
    v_mul_f32 v18, v18, v10
    v_fmac_f32 v6, v18, v11
    v_add_f32 v5, v5, v19
    v_and_b32 v10, 0xffff0000, v25
    v_and_b32 v11, 0xffff0000, v29
    v_mul_f32 v19, v19, v10
    v_fmac_f32 v6, v19, v11
    v_add_f32 v5, v5, v20
    v_lshlrev_b32 v10, 16, v26
    v_lshlrev_b32 v11, 16, v30
    v_mul_f32 v20, v20, v10
    v_fmac_f32 v6, v20, v11
    v_add_f32 v5, v5, v21
    v_and_b32 v10, 0xffff0000, v26
    v_and_b32 v11, 0xffff0000, v30
    v_mul_f32 v21, v21, v10
    v_fmac_f32 v6, v21, v11
    ds_write_b128 v14, v[16:19] offset:24832
    ds_write_b64 v14, v[20:21] offset:24848
    v_sub_f32 v32, v32, v4
    v_sub_f32 v33, v33, v4
    v_sub_f32 v34, v34, v4
    v_sub_f32 v35, v35, v4
    v_sub_f32 v36, v36, v4
    v_sub_f32 v37, v37, v4
    v_exp_f32 v32, v32
    v_exp_f32 v33, v33
    v_exp_f32 v34, v34
    v_exp_f32 v35, v35
    v_exp_f32 v36, v36
    v_exp_f32 v37, v37
    v_add_f32 v5, v5, v32
    v_lshlrev_b32 v10, 16, v40
    v_lshlrev_b32 v11, 16, v44
    v_mul_f32 v32, v32, v10
    v_fmac_f32 v6, v32, v11
    v_add_f32 v5, v5, v33
    v_and_b32 v10, 0xffff0000, v40
    v_and_b32 v11, 0xffff0000, v44
    v_mul_f32 v33, v33, v10
    v_fmac_f32 v6, v33, v11
    v_add_f32 v5, v5, v34
    v_lshlrev_b32 v10, 16, v41
    v_lshlrev_b32 v11, 16, v45
    v_mul_f32 v34, v34, v10
    v_fmac_f32 v6, v34, v11
    v_add_f32 v5, v5, v35
    v_and_b32 v10, 0xffff0000, v41
    v_and_b32 v11, 0xffff0000, v45
    v_mul_f32 v35, v35, v10
    v_fmac_f32 v6, v35, v11
    v_add_f32 v5, v5, v36
    v_lshlrev_b32 v10, 16, v42
    v_lshlrev_b32 v11, 16, v46
    v_mul_f32 v36, v36, v10
    v_fmac_f32 v6, v36, v11
    v_add_f32 v5, v5, v37
    v_and_b32 v10, 0xffff0000, v42
    v_and_b32 v11, 0xffff0000, v46
    v_mul_f32 v37, v37, v10
    v_fmac_f32 v6, v37, v11
    ds_write_b128 v14, v[32:35] offset:26880
    ds_write_b64 v14, v[36:37] offset:26896
    v_sub_f32 v48, v48, v4
    v_sub_f32 v49, v49, v4
    v_sub_f32 v50, v50, v4
    v_sub_f32 v51, v51, v4
    v_sub_f32 v52, v52, v4
    v_sub_f32 v53, v53, v4
    v_exp_f32 v48, v48
    v_exp_f32 v49, v49
    v_exp_f32 v50, v50
    v_exp_f32 v51, v51
    v_exp_f32 v52, v52
    v_exp_f32 v53, v53
    v_add_f32 v5, v5, v48
    v_lshlrev_b32 v10, 16, v56
    v_lshlrev_b32 v11, 16, v60
    v_mul_f32 v48, v48, v10
    v_fmac_f32 v6, v48, v11
    v_add_f32 v5, v5, v49
    v_and_b32 v10, 0xffff0000, v56
    v_and_b32 v11, 0xffff0000, v60
    v_mul_f32 v49, v49, v10
    v_fmac_f32 v6, v49, v11
    v_add_f32 v5, v5, v50
    v_lshlrev_b32 v10, 16, v57
    v_lshlrev_b32 v11, 16, v61
    v_mul_f32 v50, v50, v10
    v_fmac_f32 v6, v50, v11
    v_add_f32 v5, v5, v51
    v_and_b32 v10, 0xffff0000, v57
    v_and_b32 v11, 0xffff0000, v61
    v_mul_f32 v51, v51, v10
    v_fmac_f32 v6, v51, v11
    v_add_f32 v5, v5, v52
    v_lshlrev_b32 v10, 16, v58
    v_lshlrev_b32 v11, 16, v62
    v_mul_f32 v52, v52, v10
    v_fmac_f32 v6, v52, v11
    v_add_f32 v5, v5, v53
    v_and_b32 v10, 0xffff0000, v58
    v_and_b32 v11, 0xffff0000, v62
    v_mul_f32 v53, v53, v10
    v_fmac_f32 v6, v53, v11
    ds_write_b128 v14, v[48:51] offset:28928
    ds_write_b64 v14, v[52:53] offset:28944
    v_sub_f32 v64, v64, v4
    v_sub_f32 v65, v65, v4
    v_sub_f32 v66, v66, v4
    v_sub_f32 v67, v67, v4
    v_sub_f32 v68, v68, v4
    v_sub_f32 v69, v69, v4
    v_exp_f32 v64, v64
    v_exp_f32 v65, v65
    v_exp_f32 v66, v66
    v_exp_f32 v67, v67
    v_exp_f32 v68, v68
    v_exp_f32 v69, v69
    v_add_f32 v5, v5, v64
    v_lshlrev_b32 v10, 16, v72
    v_lshlrev_b32 v11, 16, v76
    v_mul_f32 v64, v64, v10
    v_fmac_f32 v6, v64, v11
    v_add_f32 v5, v5, v65
    v_and_b32 v10, 0xffff0000, v72
    v_and_b32 v11, 0xffff0000, v76
    v_mul_f32 v65, v65, v10
    v_fmac_f32 v6, v65, v11
    v_add_f32 v5, v5, v66
    v_lshlrev_b32 v10, 16, v73
    v_lshlrev_b32 v11, 16, v77
    v_mul_f32 v66, v66, v10
    v_fmac_f32 v6, v66, v11
    v_add_f32 v5, v5, v67
    v_and_b32 v10, 0xffff0000, v73
    v_and_b32 v11, 0xffff0000, v77
    v_mul_f32 v67, v67, v10
    v_fmac_f32 v6, v67, v11
    v_add_f32 v5, v5, v68
    v_lshlrev_b32 v10, 16, v74
    v_lshlrev_b32 v11, 16, v78
    v_mul_f32 v68, v68, v10
    v_fmac_f32 v6, v68, v11
    v_add_f32 v5, v5, v69
    v_and_b32 v10, 0xffff0000, v74
    v_and_b32 v11, 0xffff0000, v78
    v_mul_f32 v69, v69, v10
    v_fmac_f32 v6, v69, v11
    ds_write_b128 v14, v[64:67] offset:30976
    ds_write_b64 v14, v[68:69] offset:30992
    v_add_f32_dpp v5, v5, v5 row_ror:8 row_mask:0xf bank_mask:0xf
    v_add_f32_dpp v6, v6, v6 row_ror:8 row_mask:0xf bank_mask:0xf
    s_nop 0
    v_add_f32_dpp v5, v5, v5 row_ror:4 row_mask:0xf bank_mask:0xf
    v_add_f32_dpp v6, v6, v6 row_ror:4 row_mask:0xf bank_mask:0xf
    s_nop 0
    v_add_f32_dpp v5, v5, v5 row_ror:2 row_mask:0xf bank_mask:0xf
    v_add_f32_dpp v6, v6, v6 row_ror:2 row_mask:0xf bank_mask:0xf
    s_nop 0
    v_add_f32_dpp v5, v5, v5 row_ror:1 row_mask:0xf bank_mask:0xf
    v_add_f32_dpp v6, v6, v6 row_ror:1 row_mask:0xf bank_mask:0xf
    v_mov_b32 v10, v5
    v_mov_b32 v11, v6
    s_nop 0
    v_permlane32_swap_b32 v5, v10
    v_permlane32_swap_b32 v6, v11
    v_add_f32 v5, v5, v10
    v_add_f32 v6, v6, v11
    v_mov_b32 v10, v5
    v_mov_b32 v11, v6
    s_nop 0
    v_permlane16_swap_b32 v5, v10
    v_permlane16_swap_b32 v6, v11
    v_add_f32 v5, v5, v10
    v_add_f32 v6, v6, v11
    s_lshl_b32 s48, s61, 2
    v_mov_b32 v10, s48
    v_lshlrev_b32 v11, 2, v10
    v_mov_b32 v7, s39
    s_mov_b64 exec, 1
    ds_write_b128 v11, v[4:7] offset:80
    ds_write_b32 v10, v7 offset:24
    s_mov_b64 exec, -1
    v_add_u32 v14, 8192, v14
    s_add_u32 s61, s61, 1
    s_cmp_lt_u32 s61, 3
    s_cbranch_scc1 L_prep
    s_mov_b32 s61, 0
    v_lshlrev_b32 v12, 2, v1
    v_add_u32 v13, 49408, v12
L_merge:
    s_nop 1
    s_lshl_b32 s48, s61, 2
    v_mov_b32 v3, s48
    v_lshlrev_b32 v11, 2, v3
    ds_read_b128 v[4:7], v11 offset:80
    s_lshl_b32 s62, s61, 8
    s_add_u32 s62, s62, s2
    s_lshl_b32 s62, s62, 10
    s_mov_b32 s60, 0x100000
L_wm:
    s_nop 1
    ds_read_b32 v10, v3 offset:64
    s_sub_u32 s60, s60, 1
    s_cbranch_scc1 L_exit1
    s_waitcnt lgkmcnt(0)
    v_readfirstlane_b32 s48, v10
    s_cmp_lt_u32 s48, 4
    s_cbranch_scc1 L_wm
    ds_read_b32 v16, v13 offset:0
    ds_read_b32 v17, v13 offset:768
    ds_read_b32 v18, v13 offset:1536
    ds_read_b32 v19, v13 offset:2304
    ds_read_b32 v20, v13 offset:256
    ds_read_b32 v21, v13 offset:1024
    ds_read_b32 v22, v13 offset:1792
    ds_read_b32 v23, v13 offset:2560
    ds_read_b32 v24, v13 offset:512
    ds_read_b32 v25, v13 offset:1280
    ds_read_b32 v26, v13 offset:2048
    ds_read_b32 v27, v13 offset:2816
    s_waitcnt lgkmcnt(8)
    v_add_f32 v16, v16, v17
    v_add_f32 v18, v18, v19
    v_sub_f32 v16, v16, v6
    v_add_f32 v16, v16, v18
    buffer_store_dword v16, v12, s[12:15], s62 offen offset:0
    s_waitcnt lgkmcnt(4)
    v_add_f32 v20, v20, v21
    v_add_f32 v22, v22, v23
    v_sub_f32 v20, v20, v6
    v_add_f32 v20, v20, v22
    buffer_store_dword v20, v12, s[12:15], s62 offen offset:256
    s_waitcnt lgkmcnt(0)
    v_add_f32 v24, v24, v25
    v_add_f32 v26, v26, v27
    v_sub_f32 v24, v24, v6
    v_add_f32 v24, v24, v26
    buffer_store_dword v24, v12, s[12:15], s62 offen offset:512
    s_mov_b64 exec, 1
    buffer_store_dwordx2 v[4:5], off, s[12:15], s62 offset:768
    s_mov_b64 exec, -1
    v_add_u32 v13, 3072, v13
    s_add_u32 s61, s61, 1
    s_cmp_lt_u32 s61, 3
    s_cbranch_scc1 L_merge
    s_endpgm
.globl standalone__kv_cache_quant_int4_int2_kv_with_per_channel_or_per_token_scales__decode_kernel
.p2align 8
.type standalone__kv_cache_quant_int4_int2_kv_with_per_channel_or_per_token_scales__decode_kernel,@function
standalone__kv_cache_quant_int4_int2_kv_with_per_channel_or_per_token_scales__decode_kernel:
    s_cmp_ge_u32 s2, 32
    s_cbranch_scc1 L_exit2
    s_load_dwordx2 s[4:5], s[0:1], 56
    s_load_dwordx2 s[6:7], s[0:1], 72
    v_lshlrev_b32 v1, 2, v0
    v_mov_b32 v2, 0
    s_mul_i32 s16, s2, 24576
    s_mov_b32 s10, 786432
    s_mov_b32 s11, 0x00020000
    s_mov_b32 s14, 12288
    s_mov_b32 s15, 0x00020000
    s_add_u32 s17, s16, 4096
    s_add_u32 s18, s16, 8192
    s_add_u32 s19, s16, 12288
    s_add_u32 s20, s16, 16384
    s_add_u32 s21, s16, 20480
    s_waitcnt lgkmcnt(0)
    s_mov_b32 s8, s6
    s_and_b32 s9, s7, 0xffff
    s_mov_b32 s12, s4
    s_and_b32 s13, s5, 0xffff
    buffer_load_dwordx2 v[8:9], v2, s[8:11], s16 offen offset:768
    buffer_load_dword v56, v1, s[8:11], s16 offen offset:0
    buffer_load_dwordx2 v[10:11], v2, s[8:11], s16 offen offset:1792
    buffer_load_dword v57, v1, s[8:11], s16 offen offset:1024
    buffer_load_dwordx2 v[12:13], v2, s[8:11], s16 offen offset:2816
    buffer_load_dword v58, v1, s[8:11], s16 offen offset:2048
    buffer_load_dwordx2 v[14:15], v2, s[8:11], s16 offen offset:3840
    buffer_load_dword v59, v1, s[8:11], s16 offen offset:3072
    buffer_load_dwordx2 v[16:17], v2, s[8:11], s17 offen offset:768
    buffer_load_dword v60, v1, s[8:11], s17 offen offset:0
    buffer_load_dwordx2 v[18:19], v2, s[8:11], s17 offen offset:1792
    buffer_load_dword v61, v1, s[8:11], s17 offen offset:1024
    buffer_load_dwordx2 v[20:21], v2, s[8:11], s17 offen offset:2816
    buffer_load_dword v62, v1, s[8:11], s17 offen offset:2048
    buffer_load_dwordx2 v[22:23], v2, s[8:11], s17 offen offset:3840
    buffer_load_dword v63, v1, s[8:11], s17 offen offset:3072
    buffer_load_dwordx2 v[24:25], v2, s[8:11], s18 offen offset:768
    buffer_load_dword v64, v1, s[8:11], s18 offen offset:0
    buffer_load_dwordx2 v[26:27], v2, s[8:11], s18 offen offset:1792
    buffer_load_dword v65, v1, s[8:11], s18 offen offset:1024
    buffer_load_dwordx2 v[28:29], v2, s[8:11], s18 offen offset:2816
    buffer_load_dword v66, v1, s[8:11], s18 offen offset:2048
    buffer_load_dwordx2 v[30:31], v2, s[8:11], s18 offen offset:3840
    buffer_load_dword v67, v1, s[8:11], s18 offen offset:3072
    buffer_load_dwordx2 v[32:33], v2, s[8:11], s19 offen offset:768
    buffer_load_dword v68, v1, s[8:11], s19 offen offset:0
    buffer_load_dwordx2 v[34:35], v2, s[8:11], s19 offen offset:1792
    buffer_load_dword v69, v1, s[8:11], s19 offen offset:1024
    buffer_load_dwordx2 v[36:37], v2, s[8:11], s19 offen offset:2816
    buffer_load_dword v70, v1, s[8:11], s19 offen offset:2048
    buffer_load_dwordx2 v[38:39], v2, s[8:11], s19 offen offset:3840
    buffer_load_dword v71, v1, s[8:11], s19 offen offset:3072
    buffer_load_dwordx2 v[40:41], v2, s[8:11], s20 offen offset:768
    buffer_load_dword v72, v1, s[8:11], s20 offen offset:0
    buffer_load_dwordx2 v[42:43], v2, s[8:11], s20 offen offset:1792
    buffer_load_dword v73, v1, s[8:11], s20 offen offset:1024
    buffer_load_dwordx2 v[44:45], v2, s[8:11], s20 offen offset:2816
    buffer_load_dword v74, v1, s[8:11], s20 offen offset:2048
    buffer_load_dwordx2 v[46:47], v2, s[8:11], s20 offen offset:3840
    buffer_load_dword v75, v1, s[8:11], s20 offen offset:3072
    buffer_load_dwordx2 v[48:49], v2, s[8:11], s21 offen offset:768
    buffer_load_dword v76, v1, s[8:11], s21 offen offset:0
    buffer_load_dwordx2 v[50:51], v2, s[8:11], s21 offen offset:1792
    buffer_load_dword v77, v1, s[8:11], s21 offen offset:1024
    buffer_load_dwordx2 v[52:53], v2, s[8:11], s21 offen offset:2816
    buffer_load_dword v78, v1, s[8:11], s21 offen offset:2048
    buffer_load_dwordx2 v[54:55], v2, s[8:11], s21 offen offset:3840
    buffer_load_dword v79, v1, s[8:11], s21 offen offset:3072
    s_waitcnt vmcnt(0)
    v_mov_b32 v4, v8
    v_max_f32 v4, v4, v10
    v_max_f32 v4, v4, v12
    v_max_f32 v4, v4, v14
    v_max_f32 v4, v4, v16
    v_max_f32 v4, v4, v18
    v_max_f32 v4, v4, v20
    v_max_f32 v4, v4, v22
    v_max_f32 v4, v4, v24
    v_max_f32 v4, v4, v26
    v_max_f32 v4, v4, v28
    v_max_f32 v4, v4, v30
    v_max_f32 v4, v4, v32
    v_max_f32 v4, v4, v34
    v_max_f32 v4, v4, v36
    v_max_f32 v4, v4, v38
    v_max_f32 v4, v4, v40
    v_max_f32 v4, v4, v42
    v_max_f32 v4, v4, v44
    v_max_f32 v4, v4, v46
    v_max_f32 v4, v4, v48
    v_max_f32 v4, v4, v50
    v_max_f32 v4, v4, v52
    v_max_f32 v4, v4, v54
    v_sub_f32 v8, v8, v4
    v_sub_f32 v10, v10, v4
    v_sub_f32 v12, v12, v4
    v_sub_f32 v14, v14, v4
    v_sub_f32 v16, v16, v4
    v_sub_f32 v18, v18, v4
    v_sub_f32 v20, v20, v4
    v_sub_f32 v22, v22, v4
    v_sub_f32 v24, v24, v4
    v_sub_f32 v26, v26, v4
    v_sub_f32 v28, v28, v4
    v_sub_f32 v30, v30, v4
    v_sub_f32 v32, v32, v4
    v_sub_f32 v34, v34, v4
    v_sub_f32 v36, v36, v4
    v_sub_f32 v38, v38, v4
    v_sub_f32 v40, v40, v4
    v_sub_f32 v42, v42, v4
    v_sub_f32 v44, v44, v4
    v_sub_f32 v46, v46, v4
    v_sub_f32 v48, v48, v4
    v_sub_f32 v50, v50, v4
    v_sub_f32 v52, v52, v4
    v_sub_f32 v54, v54, v4
    v_exp_f32 v8, v8
    v_exp_f32 v10, v10
    v_exp_f32 v12, v12
    v_exp_f32 v14, v14
    v_exp_f32 v16, v16
    v_exp_f32 v18, v18
    v_exp_f32 v20, v20
    v_exp_f32 v22, v22
    v_exp_f32 v24, v24
    v_exp_f32 v26, v26
    v_exp_f32 v28, v28
    v_exp_f32 v30, v30
    v_exp_f32 v32, v32
    v_exp_f32 v34, v34
    v_exp_f32 v36, v36
    v_exp_f32 v38, v38
    v_exp_f32 v40, v40
    v_exp_f32 v42, v42
    v_exp_f32 v44, v44
    v_exp_f32 v46, v46
    v_exp_f32 v48, v48
    v_exp_f32 v50, v50
    v_exp_f32 v52, v52
    v_exp_f32 v54, v54
    v_mul_f32 v5, v8, v9
    v_mul_f32 v6, v8, v56
    v_fmac_f32 v5, v10, v11
    v_fmac_f32 v6, v10, v57
    v_fmac_f32 v5, v12, v13
    v_fmac_f32 v6, v12, v58
    v_fmac_f32 v5, v14, v15
    v_fmac_f32 v6, v14, v59
    v_fmac_f32 v5, v16, v17
    v_fmac_f32 v6, v16, v60
    v_fmac_f32 v5, v18, v19
    v_fmac_f32 v6, v18, v61
    v_fmac_f32 v5, v20, v21
    v_fmac_f32 v6, v20, v62
    v_fmac_f32 v5, v22, v23
    v_fmac_f32 v6, v22, v63
    v_fmac_f32 v5, v24, v25
    v_fmac_f32 v6, v24, v64
    v_fmac_f32 v5, v26, v27
    v_fmac_f32 v6, v26, v65
    v_fmac_f32 v5, v28, v29
    v_fmac_f32 v6, v28, v66
    v_fmac_f32 v5, v30, v31
    v_fmac_f32 v6, v30, v67
    v_fmac_f32 v5, v32, v33
    v_fmac_f32 v6, v32, v68
    v_fmac_f32 v5, v34, v35
    v_fmac_f32 v6, v34, v69
    v_fmac_f32 v5, v36, v37
    v_fmac_f32 v6, v36, v70
    v_fmac_f32 v5, v38, v39
    v_fmac_f32 v6, v38, v71
    v_fmac_f32 v5, v40, v41
    v_fmac_f32 v6, v40, v72
    v_fmac_f32 v5, v42, v43
    v_fmac_f32 v6, v42, v73
    v_fmac_f32 v5, v44, v45
    v_fmac_f32 v6, v44, v74
    v_fmac_f32 v5, v46, v47
    v_fmac_f32 v6, v46, v75
    v_fmac_f32 v5, v48, v49
    v_fmac_f32 v6, v48, v76
    v_fmac_f32 v5, v50, v51
    v_fmac_f32 v6, v50, v77
    v_fmac_f32 v5, v52, v53
    v_fmac_f32 v6, v52, v78
    v_fmac_f32 v5, v54, v55
    v_fmac_f32 v6, v54, v79
    v_rcp_f32 v5, v5
    s_nop 0
    v_mul_f32 v6, v6, v5
    v_cvt_pk_bf16_f32 v6, v6, v6
    s_mul_i32 s16, s2, 384
    v_lshrrev_b32 v1, 1, v1
    buffer_store_short v6, v1, s[12:15], s16 offen
L_exit2:
    s_endpgm
.section .rodata,"a"
.p2align 6
.amdhsa_kernel part_kernel
  .amdhsa_next_free_vgpr 136
  .amdhsa_next_free_sgpr 102
  .amdhsa_accum_offset 136
  .amdhsa_group_segment_fixed_size 0
  .amdhsa_kernarg_size 80
  .amdhsa_user_sgpr_count 2
  .amdhsa_user_sgpr_kernarg_segment_ptr 1
  .amdhsa_system_sgpr_workgroup_id_x 1
.end_amdhsa_kernel
.p2align 6
.amdhsa_kernel standalone__kv_cache_quant_int4_int2_kv_with_per_channel_or_per_token_scales__decode_kernel
  .amdhsa_next_free_vgpr 80
  .amdhsa_next_free_sgpr 24
  .amdhsa_accum_offset 80
  .amdhsa_group_segment_fixed_size 0
  .amdhsa_kernarg_size 80
  .amdhsa_user_sgpr_count 2
  .amdhsa_user_sgpr_kernarg_segment_ptr 1
  .amdhsa_system_sgpr_workgroup_id_x 1
.end_amdhsa_kernel
```

```asm
; @launch kernel=standalone__kv_cache_quant_int4_int2_kv_with_per_channel_or_per_token_scales__decode_kernel grid=(256,1,1) block=(512,1,1) lds=52480
.amdgcn_target "amdgcn-amd-amdhsa--gfx950"
.text
.globl standalone__kv_cache_quant_int4_int2_kv_with_per_channel_or_per_token_scales__decode_kernel
.p2align 8
.type standalone__kv_cache_quant_int4_int2_kv_with_per_channel_or_per_token_scales__decode_kernel,@function
standalone__kv_cache_quant_int4_int2_kv_with_per_channel_or_per_token_scales__decode_kernel:
    s_cmp_ge_u32 s2, 256
    s_cbranch_scc1 L_exit1
    s_load_dwordx16 s[64:79], s[0:1], 0
    s_load_dwordx4 s[80:83], s[0:1], 64
    v_lshrrev_b32 v10, 6, v0
    v_and_b32 v11, 63, v0
    v_readfirstlane_b32 s28, v10
    s_lshr_b32 s3, s2, 3
    s_and_b32 s4, s2, 7
    s_lshr_b32 s32, s2, 6
    s_xor_b32 s32, s32, s4
    s_lshr_b32 s48, s32, 1
    s_and_b32 s32, s32, 1
    s_lshl_b32 s32, s32, 2
    s_or_b32 s48, s48, s32
    s_cmp_ge_u32 s28, 4
    s_cbranch_scc1 L_helper
    v_lshrrev_b32 v1, 4, v11
    v_and_b32 v52, 15, v11
    v_lshlrev_b32 v2, 4, v52
    v_lshlrev_b32 v3, 3, v52
    v_lshlrev_b32 v62, 7, v1
    v_and_b32 v63, 0x70, v0
    v_or_b32 v63, v63, v62
    v_mov_b32 v50, v63
    s_mov_b32 s45, 768
    s_mov_b32 s46, 384
    s_mov_b32 s47, 0xaaaaaaab
    v_mov_b32 v51, 0xc0000000
    s_lshl_b32 s44, s3, 6
    s_mov_b32 s5, s48
    s_mov_b32 s29, s28
    s_lshr_b32 s33, s29, 6
    s_lshl_b32 s33, s33, 11
    s_and_b32 s32, s29, 63
    s_add_u32 s32, s32, s33
    s_add_u32 s32, s32, s44
    s_bfe_u32 s33, s32, 0x20003
    s_and_b32 s34, s32, 4
    s_or_b32 s33, s33, s34
    s_xor_b32 s33, s33, s5
    s_lshl_b32 s50, s32, 5
    s_or_b32 s50, s50, s33
    s_lshl_b32 s50, s50, 4
    s_or_b32 s50, s50, 1
    v_xor_b32 v10, s50, v50
    v_mul_hi_u32 v10, v10, s47
    v_lshrrev_b32 v10, 1, v10
    v_and_b32 v11, 15, v10
    v_cmp_eq_u32 vcc, 5, v11
    v_mad_u32_u24 v48, v10, s45, v2
    v_add_u32 v11, 3840, v48
    v_cndmask_b32 v49, v51, v11, vcc
    v_lshrrev_b32 v10, 6, v10
    v_mad_u32_u24 v9, v10, s46, v3
    s_waitcnt lgkmcnt(0)
    s_mov_b32 s8, s66
    s_and_b32 s9, s67, 0xffff
    s_mov_b32 s10, 805306368
    s_mov_b32 s11, 0x00020000
    buffer_load_dwordx4 v[64:67], v48, s[8:11], 0 offen offset:0 nt
    buffer_load_dwordx4 v[68:71], v48, s[8:11], 0 offen offset:256 nt
    buffer_load_dwordx4 v[72:75], v48, s[8:11], 0 offen offset:512 nt
    buffer_load_dwordx4 v[76:79], v48, s[8:11], 0 offen offset:768 nt
    buffer_load_dwordx4 v[80:83], v48, s[8:11], 0 offen offset:1024 nt
    buffer_load_dwordx4 v[84:87], v48, s[8:11], 0 offen offset:1280 nt
    s_mov_b32 s30, 0
    s_mov_b32 s20, s64
    s_and_b32 s21, s65, 0xffff
    s_mov_b32 s22, 12288
    s_mov_b32 s23, 0x00020000
    s_lshl_b32 s31, s30, 5
    s_add_u32 s31, s31, s3
    s_mul_i32 s31, s31, 171
    s_lshr_b32 s31, s31, 9
    s_mul_i32 s31, s31, 384
    buffer_load_dwordx2 v[36:37], v3, s[20:23], s31 offen offset:0
    buffer_load_dwordx2 v[38:39], v3, s[20:23], s31 offen offset:128
    buffer_load_dwordx2 v[40:41], v3, s[20:23], s31 offen offset:256
    s_mov_b32 s16, s70
    s_and_b32 s17, s71, 0xffff
    s_mov_b32 s18, 6291456
    s_mov_b32 s19, 0x00020000
    buffer_load_dwordx2 v[42:43], v9, s[16:19], 0 offen offset:0
    buffer_load_dwordx2 v[44:45], v9, s[16:19], 0 offen offset:128
    buffer_load_dwordx2 v[46:47], v9, s[16:19], 0 offen offset:256
    buffer_load_dwordx4 v[88:91], v48, s[8:11], 0 offen offset:1536 nt
    buffer_load_dwordx4 v[92:95], v48, s[8:11], 0 offen offset:1792 nt
    buffer_load_dwordx4 v[96:99], v48, s[8:11], 0 offen offset:2048 nt
    buffer_load_dwordx4 v[100:103], v48, s[8:11], 0 offen offset:2304 nt
    buffer_load_dwordx4 v[104:107], v48, s[8:11], 0 offen offset:2560 nt
    buffer_load_dwordx4 v[108:111], v48, s[8:11], 0 offen offset:2816 nt
    buffer_load_dwordx4 v[112:115], v48, s[8:11], 0 offen offset:3072 nt
    buffer_load_dwordx4 v[116:119], v48, s[8:11], 0 offen offset:3328 nt
    buffer_load_dwordx4 v[120:123], v48, s[8:11], 0 offen offset:3584 nt
    buffer_load_dwordx4 v[124:127], v49, s[8:11], 0 offen offset:0 nt
    buffer_load_dwordx4 v[128:131], v49, s[8:11], 0 offen offset:256 nt
    buffer_load_dwordx4 v[132:135], v49, s[8:11], 0 offen offset:512 nt
    s_mov_b32 s12, s68
    s_and_b32 s13, s69, 0xffff
    s_mov_b32 s14, 805306368
    s_mov_b32 s15, 0x00020000
    v_lshlrev_b32 v11, 5, v1
    v_bfe_u32 v4, v0, 4, 3
    v_mul_u32_u24 v4, s45, v4
    v_lshl_add_u32 v4, v52, 1, v4
    s_lshr_b32 s32, s28, 1
    s_mul_i32 s32, s32, 24
    s_add_u32 s32, s32, 256
    v_add_u32 v4, s32, v4
    v_and_b32 v5, 7, v52
    v_lshl_add_u32 v5, v5, 2, v11
    v_add_u32 v5, 18688, v5
    v_lshlrev_b32 v8, 2, v1
    v_add_u32 v8, v2, v8
    s_mul_i32 s32, s28, 768
    s_add_u32 s32, s32, 43264
    v_add_u32 v8, s32, v8
    v_mov_b32 v53, 0
    v_mov_b32 v60, 0
    v_mov_b32 v61, 0
    s_mov_b32 s42, 0x01110111
    s_mov_b32 s43, 0x01110111
    s_mov_b32 s40, 0x3b2b3b18
    s_mov_b32 s41, 0x3b2b
    s_mov_b32 s64, 0x2020200
    s_mov_b32 s65, 0x202
    s_mov_b32 s66, 0x8080800
    s_mov_b32 s67, 0x808
    s_mov_b32 s68, 0x20202000
    s_mov_b32 s69, 0x2020
    s_mov_b32 s70, 0x11031118
    s_mov_b32 s71, 0x1103
    s_mov_b32 s59, 0
    s_mov_b32 s63, 0
    s_mov_b32 s7, 0
    s_mov_b32 s62, 144
    v_mov_b32 v12, 0
    v_mov_b32 v13, 0
    v_mov_b32 v14, 0
    v_mov_b32 v15, 0
    v_mov_b32 v16, 0
    v_mov_b32 v17, 0
    v_mov_b32 v18, 0
    v_mov_b32 v19, 0
    v_mov_b32 v20, 0
    v_mov_b32 v21, 0
    v_mov_b32 v22, 0
    v_mov_b32 v23, 0
    s_barrier
    s_waitcnt vmcnt(12)
    v_lshlrev_b32 v10, 16, v36
    v_lshlrev_b32 v24, 16, v42
    v_and_b32 v11, 0xffff0000, v36
    v_and_b32 v25, 0xffff0000, v42
    v_mul_f32 v24, v24, v10
    v_mul_f32 v25, v25, v11
    v_lshlrev_b32 v10, 16, v37
    v_lshlrev_b32 v26, 16, v43
    v_and_b32 v11, 0xffff0000, v37
    v_and_b32 v27, 0xffff0000, v43
    v_mul_f32 v26, v26, v10
    v_mul_f32 v27, v27, v11
    v_lshlrev_b32 v10, 16, v38
    v_lshlrev_b32 v28, 16, v44
    v_and_b32 v11, 0xffff0000, v38
    v_and_b32 v29, 0xffff0000, v44
    v_mul_f32 v28, v28, v10
    v_mul_f32 v29, v29, v11
    v_lshlrev_b32 v10, 16, v39
    v_lshlrev_b32 v30, 16, v45
    v_and_b32 v11, 0xffff0000, v39
    v_and_b32 v31, 0xffff0000, v45
    v_mul_f32 v30, v30, v10
    v_mul_f32 v31, v31, v11
    v_lshlrev_b32 v10, 16, v40
    v_lshlrev_b32 v32, 16, v46
    v_and_b32 v11, 0xffff0000, v40
    v_and_b32 v33, 0xffff0000, v46
    v_mul_f32 v32, v32, v10
    v_mul_f32 v33, v33, v11
    v_lshlrev_b32 v10, 16, v41
    v_lshlrev_b32 v34, 16, v47
    v_and_b32 v11, 0xffff0000, v41
    v_and_b32 v35, 0xffff0000, v47
    v_mul_f32 v34, v34, v10
    v_mul_f32 v35, v35, v11
    v_cvt_f32_i32 v64, v64
    v_cvt_f32_i32 v65, v65
    v_cvt_f32_i32 v66, v66
    v_cvt_f32_i32 v67, v67
    v_mul_f32 v54, v64, v24
    v_fmac_f32 v54, v65, v25
    v_fmac_f32 v54, v66, v26
    v_fmac_f32 v54, v67, v27
    v_cvt_f32_i32 v68, v68
    v_cvt_f32_i32 v69, v69
    v_cvt_f32_i32 v70, v70
    v_cvt_f32_i32 v71, v71
    v_fmac_f32 v54, v68, v28
    v_fmac_f32 v54, v69, v29
    v_fmac_f32 v54, v70, v30
    v_fmac_f32 v54, v71, v31
    v_cvt_f32_i32 v72, v72
    v_cvt_f32_i32 v73, v73
    v_cvt_f32_i32 v74, v74
    v_cvt_f32_i32 v75, v75
    v_fmac_f32 v54, v72, v32
    v_fmac_f32 v54, v73, v33
    v_fmac_f32 v54, v74, v34
    v_fmac_f32 v54, v75, v35
    v_cvt_f32_i32 v76, v76
    v_cvt_f32_i32 v77, v77
    v_add_f32_dpp v54, v54, v54 row_ror:8 row_mask:0xf bank_mask:0xf
    v_cvt_f32_i32 v78, v78
    v_cvt_f32_i32 v79, v79
    v_add_f32_dpp v54, v54, v54 row_ror:4 row_mask:0xf bank_mask:0xf
    v_mul_f32 v55, v76, v24
    v_fmac_f32 v55, v77, v25
    v_add_f32_dpp v54, v54, v54 row_ror:2 row_mask:0xf bank_mask:0xf
    v_fmac_f32 v55, v78, v26
    v_fmac_f32 v55, v79, v27
    v_add_f32_dpp v60, v54, v54 row_ror:1 row_mask:0xf bank_mask:0x1
    v_cvt_f32_i32 v80, v80
    v_cvt_f32_i32 v81, v81
    v_cvt_f32_i32 v82, v82
    v_cvt_f32_i32 v83, v83
    v_fmac_f32 v55, v80, v28
    v_fmac_f32 v55, v81, v29
    v_fmac_f32 v55, v82, v30
    v_fmac_f32 v55, v83, v31
    v_cvt_f32_i32 v84, v84
    v_cvt_f32_i32 v85, v85
    v_cvt_f32_i32 v86, v86
    v_cvt_f32_i32 v87, v87
    v_fmac_f32 v55, v84, v32
    v_fmac_f32 v55, v85, v33
    v_fmac_f32 v55, v86, v34
    v_fmac_f32 v55, v87, v35
    s_nop 1
    v_add_f32_dpp v55, v55, v55 row_ror:8 row_mask:0xf bank_mask:0xf
    s_nop 1
    v_add_f32_dpp v55, v55, v55 row_ror:4 row_mask:0xf bank_mask:0xf
    s_nop 1
    v_add_f32_dpp v55, v55, v55 row_ror:2 row_mask:0xf bank_mask:0xf
    s_nop 1
    v_add_f32_dpp v61, v55, v55 row_ror:1 row_mask:0xf bank_mask:0x1
    s_waitcnt vmcnt(6)
    s_add_u32 s29, s29, 4
    s_add_u32 s30, s30, 1
    s_lshr_b32 s33, s29, 6
    s_lshl_b32 s33, s33, 11
    s_and_b32 s32, s29, 63
    s_add_u32 s32, s32, s33
    s_add_u32 s32, s32, s44
    s_bfe_u32 s33, s32, 0x20003
    s_and_b32 s34, s32, 4
    s_or_b32 s33, s33, s34
    s_xor_b32 s33, s33, s5
    s_lshl_b32 s50, s32, 5
    s_or_b32 s50, s50, s33
    s_lshl_b32 s50, s50, 4
    s_or_b32 s50, s50, 1
    v_xor_b32 v10, s50, v50
    v_mul_hi_u32 v10, v10, s47
    v_lshrrev_b32 v10, 1, v10
    v_and_b32 v11, 15, v10
    v_cmp_eq_u32 vcc, 5, v11
    v_mad_u32_u24 v48, v10, s45, v2
    v_add_u32 v11, 3840, v48
    v_cndmask_b32 v49, v51, v11, vcc
    v_lshrrev_b32 v10, 6, v10
    v_mad_u32_u24 v9, v10, s46, v3
    buffer_load_dwordx2 v[42:43], v9, s[16:19], 0 offen offset:0
    buffer_load_dwordx2 v[44:45], v9, s[16:19], 0 offen offset:128
    buffer_load_dwordx2 v[46:47], v9, s[16:19], 0 offen offset:256
    v_cvt_f32_i32 v88, v88
    v_cvt_f32_i32 v89, v89
    v_cvt_f32_i32 v90, v90
    v_cvt_f32_i32 v91, v91
    v_mul_f32 v56, v88, v24
    v_fmac_f32 v56, v89, v25
    v_fmac_f32 v56, v90, v26
    v_fmac_f32 v56, v91, v27
    v_cvt_f32_i32 v92, v92
    v_cvt_f32_i32 v93, v93
    v_cvt_f32_i32 v94, v94
    v_cvt_f32_i32 v95, v95
    v_fmac_f32 v56, v92, v28
    v_fmac_f32 v56, v93, v29
    v_fmac_f32 v56, v94, v30
    v_fmac_f32 v56, v95, v31
    v_cvt_f32_i32 v96, v96
    v_cvt_f32_i32 v97, v97
    v_cvt_f32_i32 v98, v98
    v_cvt_f32_i32 v99, v99
    v_fmac_f32 v56, v96, v32
    v_fmac_f32 v56, v97, v33
    v_fmac_f32 v56, v98, v34
    v_fmac_f32 v56, v99, v35
    v_cvt_f32_i32 v100, v100
    v_cvt_f32_i32 v101, v101
    v_add_f32_dpp v56, v56, v56 row_ror:8 row_mask:0xf bank_mask:0xf
    v_cvt_f32_i32 v102, v102
    v_cvt_f32_i32 v103, v103
    v_add_f32_dpp v56, v56, v56 row_ror:4 row_mask:0xf bank_mask:0xf
    v_mul_f32 v57, v100, v24
    v_fmac_f32 v57, v101, v25
    v_add_f32_dpp v56, v56, v56 row_ror:2 row_mask:0xf bank_mask:0xf
    v_fmac_f32 v57, v102, v26
    v_fmac_f32 v57, v103, v27
    v_add_f32_dpp v60, v56, v56 row_ror:1 row_mask:0xf bank_mask:0x2
    v_cvt_f32_i32 v104, v104
    v_cvt_f32_i32 v105, v105
    v_cvt_f32_i32 v106, v106
    v_cvt_f32_i32 v107, v107
    v_fmac_f32 v57, v104, v28
    v_fmac_f32 v57, v105, v29
    v_fmac_f32 v57, v106, v30
    v_fmac_f32 v57, v107, v31
    v_cvt_f32_i32 v108, v108
    v_cvt_f32_i32 v109, v109
    v_cvt_f32_i32 v110, v110
    v_cvt_f32_i32 v111, v111
    v_fmac_f32 v57, v108, v32
    v_fmac_f32 v57, v109, v33
    v_fmac_f32 v57, v110, v34
    v_fmac_f32 v57, v111, v35
    s_nop 1
    v_add_f32_dpp v57, v57, v57 row_ror:8 row_mask:0xf bank_mask:0xf
    s_nop 1
    v_add_f32_dpp v57, v57, v57 row_ror:4 row_mask:0xf bank_mask:0xf
    s_nop 1
    v_add_f32_dpp v57, v57, v57 row_ror:2 row_mask:0xf bank_mask:0xf
    s_nop 1
    v_add_f32_dpp v61, v57, v57 row_ror:1 row_mask:0xf bank_mask:0x2
    s_waitcnt vmcnt(3)
    buffer_load_dwordx4 v[64:67], v48, s[8:11], 0 offen offset:0 nt
    buffer_load_dwordx4 v[68:71], v48, s[8:11], 0 offen offset:256 nt
    buffer_load_dwordx4 v[72:75], v48, s[8:11], 0 offen offset:512 nt
    buffer_load_dwordx4 v[76:79], v48, s[8:11], 0 offen offset:768 nt
    buffer_load_dwordx4 v[80:83], v48, s[8:11], 0 offen offset:1024 nt
    buffer_load_dwordx4 v[84:87], v48, s[8:11], 0 offen offset:1280 nt
    v_cvt_f32_i32 v112, v112
    v_cvt_f32_i32 v113, v113
    v_cvt_f32_i32 v114, v114
    v_cvt_f32_i32 v115, v115
    v_mul_f32 v58, v112, v24
    v_fmac_f32 v58, v113, v25
    v_fmac_f32 v58, v114, v26
    v_fmac_f32 v58, v115, v27
    v_cvt_f32_i32 v116, v116
    v_cvt_f32_i32 v117, v117
    v_cvt_f32_i32 v118, v118
    v_cvt_f32_i32 v119, v119
    v_fmac_f32 v58, v116, v28
    v_fmac_f32 v58, v117, v29
    v_fmac_f32 v58, v118, v30
    v_fmac_f32 v58, v119, v31
    v_cvt_f32_i32 v120, v120
    v_cvt_f32_i32 v121, v121
    v_cvt_f32_i32 v122, v122
    v_cvt_f32_i32 v123, v123
    v_fmac_f32 v58, v120, v32
    v_fmac_f32 v58, v121, v33
    v_fmac_f32 v58, v122, v34
    v_fmac_f32 v58, v123, v35
    v_cvt_f32_i32 v124, v124
    v_cvt_f32_i32 v125, v125
    v_add_f32_dpp v58, v58, v58 row_ror:8 row_mask:0xf bank_mask:0xf
    v_cvt_f32_i32 v126, v126
    v_cvt_f32_i32 v127, v127
    v_add_f32_dpp v58, v58, v58 row_ror:4 row_mask:0xf bank_mask:0xf
    v_mul_f32 v59, v124, v24
    v_fmac_f32 v59, v125, v25
    v_add_f32_dpp v58, v58, v58 row_ror:2 row_mask:0xf bank_mask:0xf
    v_fmac_f32 v59, v126, v26
    v_fmac_f32 v59, v127, v27
    v_add_f32_dpp v60, v58, v58 row_ror:1 row_mask:0xf bank_mask:0x4
    v_cvt_f32_i32 v128, v128
    v_cvt_f32_i32 v129, v129
    v_cvt_f32_i32 v130, v130
    v_cvt_f32_i32 v131, v131
    v_fmac_f32 v59, v128, v28
    v_fmac_f32 v59, v129, v29
    v_fmac_f32 v59, v130, v30
    v_fmac_f32 v59, v131, v31
    v_cvt_f32_i32 v132, v132
    v_cvt_f32_i32 v133, v133
    v_cvt_f32_i32 v134, v134
    v_cvt_f32_i32 v135, v135
    v_fmac_f32 v59, v132, v32
    v_fmac_f32 v59, v133, v33
    v_fmac_f32 v59, v134, v34
    v_fmac_f32 v59, v135, v35
    s_nop 1
    v_add_f32_dpp v59, v59, v59 row_ror:8 row_mask:0xf bank_mask:0xf
    s_nop 1
    v_add_f32_dpp v59, v59, v59 row_ror:4 row_mask:0xf bank_mask:0xf
    s_nop 1
    v_add_f32_dpp v59, v59, v59 row_ror:2 row_mask:0xf bank_mask:0xf
    s_nop 1
    v_add_f32_dpp v61, v59, v59 row_ror:1 row_mask:0xf bank_mask:0x4
    s_mov_b64 exec, s[42:43]
    ds_write_b64 v4, v[60:61]
    s_mov_b64 exec, -1
    v_add_u32 v4, 48, v4
    s_waitcnt vmcnt(6)
    v_lshlrev_b32 v10, 16, v36
    v_lshlrev_b32 v24, 16, v42
    v_and_b32 v11, 0xffff0000, v36
    v_and_b32 v25, 0xffff0000, v42
    v_mul_f32 v24, v24, v10
    v_mul_f32 v25, v25, v11
    v_lshlrev_b32 v10, 16, v37
    v_lshlrev_b32 v26, 16, v43
    v_and_b32 v11, 0xffff0000, v37
    v_and_b32 v27, 0xffff0000, v43
    v_mul_f32 v26, v26, v10
    v_mul_f32 v27, v27, v11
    v_lshlrev_b32 v10, 16, v38
    v_lshlrev_b32 v28, 16, v44
    v_and_b32 v11, 0xffff0000, v38
    v_and_b32 v29, 0xffff0000, v44
    v_mul_f32 v28, v28, v10
    v_mul_f32 v29, v29, v11
    v_lshlrev_b32 v10, 16, v39
    v_lshlrev_b32 v30, 16, v45
    v_and_b32 v11, 0xffff0000, v39
    v_and_b32 v31, 0xffff0000, v45
    v_mul_f32 v30, v30, v10
    v_mul_f32 v31, v31, v11
    v_lshlrev_b32 v10, 16, v40
    v_lshlrev_b32 v32, 16, v46
    v_and_b32 v11, 0xffff0000, v40
    v_and_b32 v33, 0xffff0000, v46
    v_mul_f32 v32, v32, v10
    v_mul_f32 v33, v33, v11
    v_lshlrev_b32 v10, 16, v41
    v_lshlrev_b32 v34, 16, v47
    v_and_b32 v11, 0xffff0000, v41
    v_and_b32 v35, 0xffff0000, v47
    v_mul_f32 v34, v34, v10
    v_mul_f32 v35, v35, v11
.p2align 6
L_kloop:
    s_nop 1
    s_waitcnt vmcnt(0)
    buffer_load_dwordx4 v[88:91], v48, s[8:11], 0 offen offset:1536 nt
    buffer_load_dwordx4 v[92:95], v48, s[8:11], 0 offen offset:1792 nt
    buffer_load_dwordx4 v[96:99], v48, s[8:11], 0 offen offset:2048 nt
    buffer_load_dwordx4 v[100:103], v48, s[8:11], 0 offen offset:2304 nt
    buffer_load_dwordx4 v[104:107], v48, s[8:11], 0 offen offset:2560 nt
    buffer_load_dwordx4 v[108:111], v48, s[8:11], 0 offen offset:2816 nt
    v_cvt_f32_i32 v64, v64
    v_cvt_f32_i32 v65, v65
    v_cvt_f32_i32 v66, v66
    v_cvt_f32_i32 v67, v67
    v_mul_f32 v54, v64, v24
    v_fmac_f32 v54, v65, v25
    v_fmac_f32 v54, v66, v26
    v_fmac_f32 v54, v67, v27
    v_cvt_f32_i32 v68, v68
    v_cvt_f32_i32 v69, v69
    v_cvt_f32_i32 v70, v70
    v_cvt_f32_i32 v71, v71
    v_fmac_f32 v54, v68, v28
    v_fmac_f32 v54, v69, v29
    v_fmac_f32 v54, v70, v30
    v_fmac_f32 v54, v71, v31
    v_cvt_f32_i32 v72, v72
    v_cvt_f32_i32 v73, v73
    v_cvt_f32_i32 v74, v74
    v_cvt_f32_i32 v75, v75
    v_fmac_f32 v54, v72, v32
    v_fmac_f32 v54, v73, v33
    v_fmac_f32 v54, v74, v34
    v_fmac_f32 v54, v75, v35
    v_cvt_f32_i32 v76, v76
    v_cvt_f32_i32 v77, v77
    v_add_f32_dpp v54, v54, v54 row_ror:8 row_mask:0xf bank_mask:0xf
    v_cvt_f32_i32 v78, v78
    v_cvt_f32_i32 v79, v79
    v_add_f32_dpp v54, v54, v54 row_ror:4 row_mask:0xf bank_mask:0xf
    v_mul_f32 v55, v76, v24
    v_fmac_f32 v55, v77, v25
    v_add_f32_dpp v54, v54, v54 row_ror:2 row_mask:0xf bank_mask:0xf
    v_fmac_f32 v55, v78, v26
    v_fmac_f32 v55, v79, v27
    v_add_f32_dpp v60, v54, v54 row_ror:1 row_mask:0xf bank_mask:0x1
    v_cvt_f32_i32 v80, v80
    v_cvt_f32_i32 v81, v81
    v_cvt_f32_i32 v82, v82
    v_cvt_f32_i32 v83, v83
    v_fmac_f32 v55, v80, v28
    v_fmac_f32 v55, v81, v29
    v_fmac_f32 v55, v82, v30
    v_fmac_f32 v55, v83, v31
    v_cvt_f32_i32 v84, v84
    v_cvt_f32_i32 v85, v85
    v_cvt_f32_i32 v86, v86
    v_cvt_f32_i32 v87, v87
    v_fmac_f32 v55, v84, v32
    v_fmac_f32 v55, v85, v33
    v_fmac_f32 v55, v86, v34
    v_fmac_f32 v55, v87, v35
    s_nop 1
    v_add_f32_dpp v55, v55, v55 row_ror:8 row_mask:0xf bank_mask:0xf
    s_nop 1
    v_add_f32_dpp v55, v55, v55 row_ror:4 row_mask:0xf bank_mask:0xf
    s_nop 1
    v_add_f32_dpp v55, v55, v55 row_ror:2 row_mask:0xf bank_mask:0xf
    s_nop 1
    v_add_f32_dpp v61, v55, v55 row_ror:1 row_mask:0xf bank_mask:0x1
    s_waitcnt vmcnt(0)
    buffer_load_dwordx4 v[112:115], v48, s[8:11], 0 offen offset:3072 nt
    buffer_load_dwordx4 v[116:119], v48, s[8:11], 0 offen offset:3328 nt
    buffer_load_dwordx4 v[120:123], v48, s[8:11], 0 offen offset:3584 nt
    buffer_load_dwordx4 v[124:127], v49, s[8:11], 0 offen offset:0 nt
    buffer_load_dwordx4 v[128:131], v49, s[8:11], 0 offen offset:256 nt
    buffer_load_dwordx4 v[132:135], v49, s[8:11], 0 offen offset:512 nt
    s_add_u32 s29, s29, 4
    s_add_u32 s30, s30, 1
    s_bitcmp1_b64 s[40:41], s30
    s_cbranch_scc1 L_evK
L_evretK:
    s_nop 1
    s_lshr_b32 s33, s29, 6
    s_lshl_b32 s33, s33, 11
    s_and_b32 s32, s29, 63
    s_add_u32 s32, s32, s33
    s_add_u32 s32, s32, s44
    s_bfe_u32 s33, s32, 0x20003
    s_and_b32 s34, s32, 4
    s_or_b32 s33, s33, s34
    s_xor_b32 s33, s33, s5
    s_lshl_b32 s50, s32, 5
    s_or_b32 s50, s50, s33
    s_lshl_b32 s50, s50, 4
    s_or_b32 s50, s50, 1
    v_xor_b32 v10, s50, v50
    v_mul_hi_u32 v10, v10, s47
    v_lshrrev_b32 v10, 1, v10
    v_and_b32 v11, 15, v10
    v_cmp_eq_u32 vcc, 5, v11
    v_mad_u32_u24 v48, v10, s45, v2
    v_add_u32 v11, 3840, v48
    v_cndmask_b32 v49, v51, v11, vcc
    v_lshrrev_b32 v10, 6, v10
    v_mad_u32_u24 v9, v10, s46, v3
    buffer_load_dwordx2 v[42:43], v9, s[16:19], 0 offen offset:0
    buffer_load_dwordx2 v[44:45], v9, s[16:19], 0 offen offset:128
    buffer_load_dwordx2 v[46:47], v9, s[16:19], 0 offen offset:256
    v_cvt_f32_i32 v88, v88
    v_cvt_f32_i32 v89, v89
    v_cvt_f32_i32 v90, v90
    v_cvt_f32_i32 v91, v91
    v_mul_f32 v56, v88, v24
    v_fmac_f32 v56, v89, v25
    v_fmac_f32 v56, v90, v26
    v_fmac_f32 v56, v91, v27
    v_cvt_f32_i32 v92, v92
    v_cvt_f32_i32 v93, v93
    v_cvt_f32_i32 v94, v94
    v_cvt_f32_i32 v95, v95
    v_fmac_f32 v56, v92, v28
    v_fmac_f32 v56, v93, v29
    v_fmac_f32 v56, v94, v30
    v_fmac_f32 v56, v95, v31
    v_cvt_f32_i32 v96, v96
    v_cvt_f32_i32 v97, v97
    v_cvt_f32_i32 v98, v98
    v_cvt_f32_i32 v99, v99
    v_fmac_f32 v56, v96, v32
    v_fmac_f32 v56, v97, v33
    v_fmac_f32 v56, v98, v34
    v_fmac_f32 v56, v99, v35
    v_cvt_f32_i32 v100, v100
    v_cvt_f32_i32 v101, v101
    v_add_f32_dpp v56, v56, v56 row_ror:8 row_mask:0xf bank_mask:0xf
    v_cvt_f32_i32 v102, v102
    v_cvt_f32_i32 v103, v103
    v_add_f32_dpp v56, v56, v56 row_ror:4 row_mask:0xf bank_mask:0xf
    v_mul_f32 v57, v100, v24
    v_fmac_f32 v57, v101, v25
    v_add_f32_dpp v56, v56, v56 row_ror:2 row_mask:0xf bank_mask:0xf
    v_fmac_f32 v57, v102, v26
    v_fmac_f32 v57, v103, v27
    v_add_f32_dpp v60, v56, v56 row_ror:1 row_mask:0xf bank_mask:0x2
    v_cvt_f32_i32 v104, v104
    v_cvt_f32_i32 v105, v105
    v_cvt_f32_i32 v106, v106
    v_cvt_f32_i32 v107, v107
    v_fmac_f32 v57, v104, v28
    v_fmac_f32 v57, v105, v29
    v_fmac_f32 v57, v106, v30
    v_fmac_f32 v57, v107, v31
    v_cvt_f32_i32 v108, v108
    v_cvt_f32_i32 v109, v109
    v_cvt_f32_i32 v110, v110
    v_cvt_f32_i32 v111, v111
    v_fmac_f32 v57, v108, v32
    v_fmac_f32 v57, v109, v33
    v_fmac_f32 v57, v110, v34
    v_fmac_f32 v57, v111, v35
    s_nop 1
    v_add_f32_dpp v57, v57, v57 row_ror:8 row_mask:0xf bank_mask:0xf
    s_nop 1
    v_add_f32_dpp v57, v57, v57 row_ror:4 row_mask:0xf bank_mask:0xf
    s_nop 1
    v_add_f32_dpp v57, v57, v57 row_ror:2 row_mask:0xf bank_mask:0xf
    s_nop 1
    v_add_f32_dpp v61, v57, v57 row_ror:1 row_mask:0xf bank_mask:0x2
    s_waitcnt vmcnt(3)
    buffer_load_dwordx4 v[64:67], v48, s[8:11], 0 offen offset:0 nt
    buffer_load_dwordx4 v[68:71], v48, s[8:11], 0 offen offset:256 nt
    buffer_load_dwordx4 v[72:75], v48, s[8:11], 0 offen offset:512 nt
    buffer_load_dwordx4 v[76:79], v48, s[8:11], 0 offen offset:768 nt
    buffer_load_dwordx4 v[80:83], v48, s[8:11], 0 offen offset:1024 nt
    buffer_load_dwordx4 v[84:87], v48, s[8:11], 0 offen offset:1280 nt
    v_cvt_f32_i32 v112, v112
    v_cvt_f32_i32 v113, v113
    v_cvt_f32_i32 v114, v114
    v_cvt_f32_i32 v115, v115
    v_mul_f32 v58, v112, v24
    v_fmac_f32 v58, v113, v25
    v_fmac_f32 v58, v114, v26
    v_fmac_f32 v58, v115, v27
    v_cvt_f32_i32 v116, v116
    v_cvt_f32_i32 v117, v117
    v_cvt_f32_i32 v118, v118
    v_cvt_f32_i32 v119, v119
    v_fmac_f32 v58, v116, v28
    v_fmac_f32 v58, v117, v29
    v_fmac_f32 v58, v118, v30
    v_fmac_f32 v58, v119, v31
    v_cvt_f32_i32 v120, v120
    v_cvt_f32_i32 v121, v121
    v_cvt_f32_i32 v122, v122
    v_cvt_f32_i32 v123, v123
    v_fmac_f32 v58, v120, v32
    v_fmac_f32 v58, v121, v33
    v_fmac_f32 v58, v122, v34
    v_fmac_f32 v58, v123, v35
    v_cvt_f32_i32 v124, v124
    v_cvt_f32_i32 v125, v125
    v_add_f32_dpp v58, v58, v58 row_ror:8 row_mask:0xf bank_mask:0xf
    v_cvt_f32_i32 v126, v126
    v_cvt_f32_i32 v127, v127
    v_add_f32_dpp v58, v58, v58 row_ror:4 row_mask:0xf bank_mask:0xf
    v_mul_f32 v59, v124, v24
    v_fmac_f32 v59, v125, v25
    v_add_f32_dpp v58, v58, v58 row_ror:2 row_mask:0xf bank_mask:0xf
    v_fmac_f32 v59, v126, v26
    v_fmac_f32 v59, v127, v27
    v_add_f32_dpp v60, v58, v58 row_ror:1 row_mask:0xf bank_mask:0x4
    v_cvt_f32_i32 v128, v128
    v_cvt_f32_i32 v129, v129
    v_cvt_f32_i32 v130, v130
    v_cvt_f32_i32 v131, v131
    v_fmac_f32 v59, v128, v28
    v_fmac_f32 v59, v129, v29
    v_fmac_f32 v59, v130, v30
    v_fmac_f32 v59, v131, v31
    v_cvt_f32_i32 v132, v132
    v_cvt_f32_i32 v133, v133
    v_cvt_f32_i32 v134, v134
    v_cvt_f32_i32 v135, v135
    v_fmac_f32 v59, v132, v32
    v_fmac_f32 v59, v133, v33
    v_fmac_f32 v59, v134, v34
    v_fmac_f32 v59, v135, v35
    s_nop 1
    v_add_f32_dpp v59, v59, v59 row_ror:8 row_mask:0xf bank_mask:0xf
    s_nop 1
    v_add_f32_dpp v59, v59, v59 row_ror:4 row_mask:0xf bank_mask:0xf
    s_nop 1
    v_add_f32_dpp v59, v59, v59 row_ror:2 row_mask:0xf bank_mask:0xf
    s_nop 1
    v_add_f32_dpp v61, v59, v59 row_ror:1 row_mask:0xf bank_mask:0x4
    s_mov_b64 exec, s[42:43]
    ds_write_b64 v4, v[60:61]
    s_mov_b64 exec, -1
    v_add_u32 v4, 48, v4
    s_waitcnt vmcnt(6)
    v_lshlrev_b32 v10, 16, v36
    v_lshlrev_b32 v24, 16, v42
    v_and_b32 v11, 0xffff0000, v36
    v_and_b32 v25, 0xffff0000, v42
    v_mul_f32 v24, v24, v10
    v_mul_f32 v25, v25, v11
    v_lshlrev_b32 v10, 16, v37
    v_lshlrev_b32 v26, 16, v43
    v_and_b32 v11, 0xffff0000, v37
    v_and_b32 v27, 0xffff0000, v43
    v_mul_f32 v26, v26, v10
    v_mul_f32 v27, v27, v11
    v_lshlrev_b32 v10, 16, v38
    v_lshlrev_b32 v28, 16, v44
    v_and_b32 v11, 0xffff0000, v38
    v_and_b32 v29, 0xffff0000, v44
    v_mul_f32 v28, v28, v10
    v_mul_f32 v29, v29, v11
    v_lshlrev_b32 v10, 16, v39
    v_lshlrev_b32 v30, 16, v45
    v_and_b32 v11, 0xffff0000, v39
    v_and_b32 v31, 0xffff0000, v45
    v_mul_f32 v30, v30, v10
    v_mul_f32 v31, v31, v11
    v_lshlrev_b32 v10, 16, v40
    v_lshlrev_b32 v32, 16, v46
    v_and_b32 v11, 0xffff0000, v40
    v_and_b32 v33, 0xffff0000, v46
    v_mul_f32 v32, v32, v10
    v_mul_f32 v33, v33, v11
    v_lshlrev_b32 v10, 16, v41
    v_lshlrev_b32 v34, 16, v47
    v_and_b32 v11, 0xffff0000, v41
    v_and_b32 v35, 0xffff0000, v47
    v_mul_f32 v34, v34, v10
    v_mul_f32 v35, v35, v11
L_kchk:
    s_nop 1
    s_cmp_lg_u32 s59, 0
    s_cbranch_scc1 L_kboost
L_kchk2:
    s_nop 1
    s_cmp_lg_u32 s30, 47
    s_cbranch_scc1 L_kloop
    s_waitcnt vmcnt(0)
    buffer_load_dwordx4 v[88:91], v48, s[8:11], 0 offen offset:1536 nt
    buffer_load_dwordx4 v[92:95], v48, s[8:11], 0 offen offset:1792 nt
    buffer_load_dwordx4 v[96:99], v48, s[8:11], 0 offen offset:2048 nt
    buffer_load_dwordx4 v[100:103], v48, s[8:11], 0 offen offset:2304 nt
    buffer_load_dwordx4 v[104:107], v48, s[8:11], 0 offen offset:2560 nt
    buffer_load_dwordx4 v[108:111], v48, s[8:11], 0 offen offset:2816 nt
    v_cvt_f32_i32 v64, v64
    v_cvt_f32_i32 v65, v65
    v_cvt_f32_i32 v66, v66
    v_cvt_f32_i32 v67, v67
    v_mul_f32 v54, v64, v24
    v_fmac_f32 v54, v65, v25
    v_fmac_f32 v54, v66, v26
    v_fmac_f32 v54, v67, v27
    v_cvt_f32_i32 v68, v68
    v_cvt_f32_i32 v69, v69
    v_cvt_f32_i32 v70, v70
    v_cvt_f32_i32 v71, v71
    v_fmac_f32 v54, v68, v28
    v_fmac_f32 v54, v69, v29
    v_fmac_f32 v54, v70, v30
    v_fmac_f32 v54, v71, v31
    v_cvt_f32_i32 v72, v72
    v_cvt_f32_i32 v73, v73
    v_cvt_f32_i32 v74, v74
    v_cvt_f32_i32 v75, v75
    v_fmac_f32 v54, v72, v32
    v_fmac_f32 v54, v73, v33
    v_fmac_f32 v54, v74, v34
    v_fmac_f32 v54, v75, v35
    v_cvt_f32_i32 v76, v76
    v_cvt_f32_i32 v77, v77
    v_add_f32_dpp v54, v54, v54 row_ror:8 row_mask:0xf bank_mask:0xf
    v_cvt_f32_i32 v78, v78
    v_cvt_f32_i32 v79, v79
    v_add_f32_dpp v54, v54, v54 row_ror:4 row_mask:0xf bank_mask:0xf
    v_mul_f32 v55, v76, v24
    v_fmac_f32 v55, v77, v25
    v_add_f32_dpp v54, v54, v54 row_ror:2 row_mask:0xf bank_mask:0xf
    v_fmac_f32 v55, v78, v26
    v_fmac_f32 v55, v79, v27
    v_add_f32_dpp v60, v54, v54 row_ror:1 row_mask:0xf bank_mask:0x1
    v_cvt_f32_i32 v80, v80
    v_cvt_f32_i32 v81, v81
    v_cvt_f32_i32 v82, v82
    v_cvt_f32_i32 v83, v83
    v_fmac_f32 v55, v80, v28
    v_fmac_f32 v55, v81, v29
    v_fmac_f32 v55, v82, v30
    v_fmac_f32 v55, v83, v31
    v_cvt_f32_i32 v84, v84
    v_cvt_f32_i32 v85, v85
    v_cvt_f32_i32 v86, v86
    v_cvt_f32_i32 v87, v87
    v_fmac_f32 v55, v84, v32
    v_fmac_f32 v55, v85, v33
    v_fmac_f32 v55, v86, v34
    v_fmac_f32 v55, v87, v35
    s_nop 1
    v_add_f32_dpp v55, v55, v55 row_ror:8 row_mask:0xf bank_mask:0xf
    s_nop 1
    v_add_f32_dpp v55, v55, v55 row_ror:4 row_mask:0xf bank_mask:0xf
    s_nop 1
    v_add_f32_dpp v55, v55, v55 row_ror:2 row_mask:0xf bank_mask:0xf
    s_nop 1
    v_add_f32_dpp v61, v55, v55 row_ror:1 row_mask:0xf bank_mask:0x1
    s_waitcnt vmcnt(0)
    buffer_load_dwordx4 v[112:115], v48, s[8:11], 0 offen offset:3072 nt
    buffer_load_dwordx4 v[116:119], v48, s[8:11], 0 offen offset:3328 nt
    buffer_load_dwordx4 v[120:123], v48, s[8:11], 0 offen offset:3584 nt
    buffer_load_dwordx4 v[124:127], v49, s[8:11], 0 offen offset:0 nt
    buffer_load_dwordx4 v[128:131], v49, s[8:11], 0 offen offset:256 nt
    buffer_load_dwordx4 v[132:135], v49, s[8:11], 0 offen offset:512 nt
    s_mov_b32 s29, s28
    s_mov_b32 s30, 0
    s_lshr_b32 s33, s30, 4
    s_lshl_b32 s34, s33, 2
    v_mov_b32 v11, s34
    s_mov_b32 s6, 0x100000
L_wtv:
    s_nop 1
    ds_read_b32 v10, v11 offset:24
    s_sub_u32 s6, s6, 1
    s_cbranch_scc1 L_exit1
    s_waitcnt lgkmcnt(0)
    v_readfirstlane_b32 s32, v10
    s_cmp_eq_u32 s32, 0
    s_cbranch_scc1 L_wtv
    s_and_b32 s5, s32, 7
    s_xor_b32 s5, s5, s48
    s_bitcmp1_b32 s32, 3
    s_cselect_b64 vcc, -1, 0
    v_cndmask_b32 v50, v62, v63, vcc
    s_mov_b32 s49, 45
    s_mov_b32 s40, 0x2a2b2a2a
    s_mov_b32 s41, 0x151
    s_mov_b32 s64, 0x2020202
    s_mov_b32 s65, 0x10
    s_mov_b32 s66, 0x8080808
    s_mov_b32 s67, 0x40
    s_mov_b32 s68, 0x20202020
    s_mov_b32 s69, 0x100
    s_mov_b32 s70, 0x10000
    s_mov_b32 s71, 0x1
    s_lshr_b32 s33, s29, 6
    s_lshl_b32 s33, s33, 11
    s_and_b32 s32, s29, 63
    s_add_u32 s32, s32, s33
    s_add_u32 s32, s32, s44
    s_bfe_u32 s33, s32, 0x20003
    s_and_b32 s34, s32, 4
    s_or_b32 s33, s33, s34
    s_xor_b32 s33, s33, s5
    s_lshl_b32 s50, s32, 5
    s_or_b32 s50, s50, s33
    s_lshl_b32 s50, s50, 4
    s_or_b32 s50, s50, 1
    s_lshl_b32 s53, s29, 7
    v_xor_b32 v10, s50, v50
    v_mul_hi_u32 v10, v10, s47
    v_lshrrev_b32 v10, 1, v10
    v_and_b32 v11, 15, v10
    v_cmp_eq_u32 vcc, 5, v11
    v_mad_u32_u24 v48, v10, s45, v2
    v_add_u32 v11, 3840, v48
    v_cndmask_b32 v49, v51, v11, vcc
    v_add_u32 v10, s53, v5
    ds_read_b32 v7, v10
    v_cvt_f32_i32 v88, v88
    v_cvt_f32_i32 v89, v89
    v_cvt_f32_i32 v90, v90
    v_cvt_f32_i32 v91, v91
    v_mul_f32 v56, v88, v24
    v_fmac_f32 v56, v89, v25
    v_fmac_f32 v56, v90, v26
    v_fmac_f32 v56, v91, v27
    v_cvt_f32_i32 v92, v92
    v_cvt_f32_i32 v93, v93
    v_cvt_f32_i32 v94, v94
    v_cvt_f32_i32 v95, v95
    v_fmac_f32 v56, v92, v28
    v_fmac_f32 v56, v93, v29
    v_fmac_f32 v56, v94, v30
    v_fmac_f32 v56, v95, v31
    v_cvt_f32_i32 v96, v96
    v_cvt_f32_i32 v97, v97
    v_cvt_f32_i32 v98, v98
    v_cvt_f32_i32 v99, v99
    v_fmac_f32 v56, v96, v32
    v_fmac_f32 v56, v97, v33
    v_fmac_f32 v56, v98, v34
    v_fmac_f32 v56, v99, v35
    v_cvt_f32_i32 v100, v100
    v_cvt_f32_i32 v101, v101
    v_add_f32_dpp v56, v56, v56 row_ror:8 row_mask:0xf bank_mask:0xf
    v_cvt_f32_i32 v102, v102
    v_cvt_f32_i32 v103, v103
    v_add_f32_dpp v56, v56, v56 row_ror:4 row_mask:0xf bank_mask:0xf
    v_mul_f32 v57, v100, v24
    v_fmac_f32 v57, v101, v25
    v_add_f32_dpp v56, v56, v56 row_ror:2 row_mask:0xf bank_mask:0xf
    v_fmac_f32 v57, v102, v26
    v_fmac_f32 v57, v103, v27
    v_add_f32_dpp v60, v56, v56 row_ror:1 row_mask:0xf bank_mask:0x2
    v_cvt_f32_i32 v104, v104
    v_cvt_f32_i32 v105, v105
    v_cvt_f32_i32 v106, v106
    v_cvt_f32_i32 v107, v107
    v_fmac_f32 v57, v104, v28
    v_fmac_f32 v57, v105, v29
    v_fmac_f32 v57, v106, v30
    v_fmac_f32 v57, v107, v31
    v_cvt_f32_i32 v108, v108
    v_cvt_f32_i32 v109, v109
    v_cvt_f32_i32 v110, v110
    v_cvt_f32_i32 v111, v111
    v_fmac_f32 v57, v108, v32
    v_fmac_f32 v57, v109, v33
    v_fmac_f32 v57, v110, v34
    v_fmac_f32 v57, v111, v35
    s_nop 1
    v_add_f32_dpp v57, v57, v57 row_ror:8 row_mask:0xf bank_mask:0xf
    s_nop 1
    v_add_f32_dpp v57, v57, v57 row_ror:4 row_mask:0xf bank_mask:0xf
    s_nop 1
    v_add_f32_dpp v57, v57, v57 row_ror:2 row_mask:0xf bank_mask:0xf
    s_nop 1
    v_add_f32_dpp v61, v57, v57 row_ror:1 row_mask:0xf bank_mask:0x2
    s_waitcnt vmcnt(0)
    buffer_load_dwordx4 v[64:67], v48, s[12:15], 0 offen offset:0 nt
    buffer_load_dwordx4 v[68:71], v48, s[12:15], 0 offen offset:256 nt
    buffer_load_dwordx4 v[72:75], v48, s[12:15], 0 offen offset:512 nt
    buffer_load_dwordx4 v[76:79], v48, s[12:15], 0 offen offset:768 nt
    buffer_load_dwordx4 v[80:83], v48, s[12:15], 0 offen offset:1024 nt
    buffer_load_dwordx4 v[84:87], v48, s[12:15], 0 offen offset:1280 nt
    v_cvt_f32_i32 v112, v112
    v_cvt_f32_i32 v113, v113
    v_cvt_f32_i32 v114, v114
    v_cvt_f32_i32 v115, v115
    v_mul_f32 v58, v112, v24
    v_fmac_f32 v58, v113, v25
    v_fmac_f32 v58, v114, v26
    v_fmac_f32 v58, v115, v27
    v_cvt_f32_i32 v116, v116
    v_cvt_f32_i32 v117, v117
    v_cvt_f32_i32 v118, v118
    v_cvt_f32_i32 v119, v119
    v_fmac_f32 v58, v116, v28
    v_fmac_f32 v58, v117, v29
    v_fmac_f32 v58, v118, v30
    v_fmac_f32 v58, v119, v31
    v_cvt_f32_i32 v120, v120
    v_cvt_f32_i32 v121, v121
    v_cvt_f32_i32 v122, v122
    v_cvt_f32_i32 v123, v123
    v_fmac_f32 v58, v120, v32
    v_fmac_f32 v58, v121, v33
    v_fmac_f32 v58, v122, v34
    v_fmac_f32 v58, v123, v35
    v_cvt_f32_i32 v124, v124
    v_cvt_f32_i32 v125, v125
    v_add_f32_dpp v58, v58, v58 row_ror:8 row_mask:0xf bank_mask:0xf
    v_cvt_f32_i32 v126, v126
    v_cvt_f32_i32 v127, v127
    v_add_f32_dpp v58, v58, v58 row_ror:4 row_mask:0xf bank_mask:0xf
    v_mul_f32 v59, v124, v24
    v_fmac_f32 v59, v125, v25
    v_add_f32_dpp v58, v58, v58 row_ror:2 row_mask:0xf bank_mask:0xf
    v_fmac_f32 v59, v126, v26
    v_fmac_f32 v59, v127, v27
    v_add_f32_dpp v60, v58, v58 row_ror:1 row_mask:0xf bank_mask:0x4
    v_cvt_f32_i32 v128, v128
    v_cvt_f32_i32 v129, v129
    v_cvt_f32_i32 v130, v130
    v_cvt_f32_i32 v131, v131
    v_fmac_f32 v59, v128, v28
    v_fmac_f32 v59, v129, v29
    v_fmac_f32 v59, v130, v30
    v_fmac_f32 v59, v131, v31
    v_cvt_f32_i32 v132, v132
    v_cvt_f32_i32 v133, v133
    v_cvt_f32_i32 v134, v134
    v_cvt_f32_i32 v135, v135
    v_fmac_f32 v59, v132, v32
    v_fmac_f32 v59, v133, v33
    v_fmac_f32 v59, v134, v34
    v_fmac_f32 v59, v135, v35
    s_nop 1
    v_add_f32_dpp v59, v59, v59 row_ror:8 row_mask:0xf bank_mask:0xf
    s_nop 1
    v_add_f32_dpp v59, v59, v59 row_ror:4 row_mask:0xf bank_mask:0xf
    s_nop 1
    v_add_f32_dpp v59, v59, v59 row_ror:2 row_mask:0xf bank_mask:0xf
    s_nop 1
    v_add_f32_dpp v61, v59, v59 row_ror:1 row_mask:0xf bank_mask:0x4
    s_mov_b64 exec, s[42:43]
    ds_write_b64 v4, v[60:61]
    s_mov_b64 exec, -1
    s_waitcnt lgkmcnt(0)
    v_mov_b32 v6, v7
    v_mov_b32 v11, 1
    s_mov_b64 exec, 1
    ds_add_u32 v53, v11 offset:48
    s_mov_b64 exec, -1
.p2align 6
L_vloop:
    s_nop 1
    s_waitcnt vmcnt(0)
    buffer_load_dwordx4 v[88:91], v48, s[12:15], 0 offen offset:1536 nt
    buffer_load_dwordx4 v[92:95], v48, s[12:15], 0 offen offset:1792 nt
    buffer_load_dwordx4 v[96:99], v48, s[12:15], 0 offen offset:2048 nt
    buffer_load_dwordx4 v[100:103], v48, s[12:15], 0 offen offset:2304 nt
    buffer_load_dwordx4 v[104:107], v48, s[12:15], 0 offen offset:2560 nt
    buffer_load_dwordx4 v[108:111], v48, s[12:15], 0 offen offset:2816 nt
    v_cvt_f32_i32 v64, v64
    v_cvt_f32_i32 v65, v65
    v_cvt_f32_i32 v66, v66
    v_cvt_f32_i32 v67, v67
    v_fmac_f32_dpp v12, v6, v64 row_newbcast:0 row_mask:0xf bank_mask:0xf
    v_fmac_f32_dpp v13, v6, v65 row_newbcast:0 row_mask:0xf bank_mask:0xf
    v_fmac_f32_dpp v14, v6, v66 row_newbcast:0 row_mask:0xf bank_mask:0xf
    v_fmac_f32_dpp v15, v6, v67 row_newbcast:0 row_mask:0xf bank_mask:0xf
    v_cvt_f32_i32 v68, v68
    v_cvt_f32_i32 v69, v69
    v_cvt_f32_i32 v70, v70
    v_cvt_f32_i32 v71, v71
    v_fmac_f32_dpp v16, v6, v68 row_newbcast:0 row_mask:0xf bank_mask:0xf
    v_fmac_f32_dpp v17, v6, v69 row_newbcast:0 row_mask:0xf bank_mask:0xf
    v_fmac_f32_dpp v18, v6, v70 row_newbcast:0 row_mask:0xf bank_mask:0xf
    v_fmac_f32_dpp v19, v6, v71 row_newbcast:0 row_mask:0xf bank_mask:0xf
    v_cvt_f32_i32 v72, v72
    v_cvt_f32_i32 v73, v73
    v_cvt_f32_i32 v74, v74
    v_cvt_f32_i32 v75, v75
    v_fmac_f32_dpp v20, v6, v72 row_newbcast:0 row_mask:0xf bank_mask:0xf
    v_fmac_f32_dpp v21, v6, v73 row_newbcast:0 row_mask:0xf bank_mask:0xf
    v_fmac_f32_dpp v22, v6, v74 row_newbcast:0 row_mask:0xf bank_mask:0xf
    v_fmac_f32_dpp v23, v6, v75 row_newbcast:0 row_mask:0xf bank_mask:0xf
    v_cvt_f32_i32 v76, v76
    v_cvt_f32_i32 v77, v77
    v_cvt_f32_i32 v78, v78
    v_cvt_f32_i32 v79, v79
    v_fmac_f32_dpp v12, v6, v76 row_newbcast:1 row_mask:0xf bank_mask:0xf
    v_fmac_f32_dpp v13, v6, v77 row_newbcast:1 row_mask:0xf bank_mask:0xf
    v_fmac_f32_dpp v14, v6, v78 row_newbcast:1 row_mask:0xf bank_mask:0xf
    v_fmac_f32_dpp v15, v6, v79 row_newbcast:1 row_mask:0xf bank_mask:0xf
    v_cvt_f32_i32 v80, v80
    v_cvt_f32_i32 v81, v81
    v_cvt_f32_i32 v82, v82
    v_cvt_f32_i32 v83, v83
    v_fmac_f32_dpp v16, v6, v80 row_newbcast:1 row_mask:0xf bank_mask:0xf
    v_fmac_f32_dpp v17, v6, v81 row_newbcast:1 row_mask:0xf bank_mask:0xf
    v_fmac_f32_dpp v18, v6, v82 row_newbcast:1 row_mask:0xf bank_mask:0xf
    v_fmac_f32_dpp v19, v6, v83 row_newbcast:1 row_mask:0xf bank_mask:0xf
    v_cvt_f32_i32 v84, v84
    v_cvt_f32_i32 v85, v85
    v_cvt_f32_i32 v86, v86
    v_cvt_f32_i32 v87, v87
    v_fmac_f32_dpp v20, v6, v84 row_newbcast:1 row_mask:0xf bank_mask:0xf
    v_fmac_f32_dpp v21, v6, v85 row_newbcast:1 row_mask:0xf bank_mask:0xf
    v_fmac_f32_dpp v22, v6, v86 row_newbcast:1 row_mask:0xf bank_mask:0xf
    v_fmac_f32_dpp v23, v6, v87 row_newbcast:1 row_mask:0xf bank_mask:0xf
    s_waitcnt vmcnt(0)
    buffer_load_dwordx4 v[112:115], v48, s[12:15], 0 offen offset:3072 nt
    buffer_load_dwordx4 v[116:119], v48, s[12:15], 0 offen offset:3328 nt
    buffer_load_dwordx4 v[120:123], v48, s[12:15], 0 offen offset:3584 nt
    buffer_load_dwordx4 v[124:127], v49, s[12:15], 0 offen offset:0 nt
    buffer_load_dwordx4 v[128:131], v49, s[12:15], 0 offen offset:256 nt
    buffer_load_dwordx4 v[132:135], v49, s[12:15], 0 offen offset:512 nt
    s_add_u32 s29, s29, 4
    s_add_u32 s30, s30, 1
    s_bitcmp1_b64 s[40:41], s30
    s_cbranch_scc1 L_evV
L_evretV:
    s_nop 1
    s_lshr_b32 s33, s29, 6
    s_lshl_b32 s33, s33, 11
    s_and_b32 s32, s29, 63
    s_add_u32 s32, s32, s33
    s_add_u32 s32, s32, s44
    s_bfe_u32 s33, s32, 0x20003
    s_and_b32 s34, s32, 4
    s_or_b32 s33, s33, s34
    s_xor_b32 s33, s33, s5
    s_lshl_b32 s50, s32, 5
    s_or_b32 s50, s50, s33
    s_lshl_b32 s50, s50, 4
    s_or_b32 s50, s50, 1
    s_lshl_b32 s53, s29, 7
    v_xor_b32 v10, s50, v50
    v_mul_hi_u32 v10, v10, s47
    v_lshrrev_b32 v10, 1, v10
    v_and_b32 v11, 15, v10
    v_cmp_eq_u32 vcc, 5, v11
    v_mad_u32_u24 v48, v10, s45, v2
    v_add_u32 v11, 3840, v48
    v_cndmask_b32 v49, v51, v11, vcc
    v_add_u32 v10, s53, v5
    ds_read_b32 v7, v10
    v_cvt_f32_i32 v88, v88
    v_cvt_f32_i32 v89, v89
    v_cvt_f32_i32 v90, v90
    v_cvt_f32_i32 v91, v91
    v_fmac_f32_dpp v12, v6, v88 row_newbcast:2 row_mask:0xf bank_mask:0xf
    v_fmac_f32_dpp v13, v6, v89 row_newbcast:2 row_mask:0xf bank_mask:0xf
    v_fmac_f32_dpp v14, v6, v90 row_newbcast:2 row_mask:0xf bank_mask:0xf
    v_fmac_f32_dpp v15, v6, v91 row_newbcast:2 row_mask:0xf bank_mask:0xf
    v_cvt_f32_i32 v92, v92
    v_cvt_f32_i32 v93, v93
    v_cvt_f32_i32 v94, v94
    v_cvt_f32_i32 v95, v95
    v_fmac_f32_dpp v16, v6, v92 row_newbcast:2 row_mask:0xf bank_mask:0xf
    v_fmac_f32_dpp v17, v6, v93 row_newbcast:2 row_mask:0xf bank_mask:0xf
    v_fmac_f32_dpp v18, v6, v94 row_newbcast:2 row_mask:0xf bank_mask:0xf
    v_fmac_f32_dpp v19, v6, v95 row_newbcast:2 row_mask:0xf bank_mask:0xf
    v_cvt_f32_i32 v96, v96
    v_cvt_f32_i32 v97, v97
    v_cvt_f32_i32 v98, v98
    v_cvt_f32_i32 v99, v99
    v_fmac_f32_dpp v20, v6, v96 row_newbcast:2 row_mask:0xf bank_mask:0xf
    v_fmac_f32_dpp v21, v6, v97 row_newbcast:2 row_mask:0xf bank_mask:0xf
    v_fmac_f32_dpp v22, v6, v98 row_newbcast:2 row_mask:0xf bank_mask:0xf
    v_fmac_f32_dpp v23, v6, v99 row_newbcast:2 row_mask:0xf bank_mask:0xf
    v_cvt_f32_i32 v100, v100
    v_cvt_f32_i32 v101, v101
    v_cvt_f32_i32 v102, v102
    v_cvt_f32_i32 v103, v103
    v_fmac_f32_dpp v12, v6, v100 row_newbcast:3 row_mask:0xf bank_mask:0xf
    v_fmac_f32_dpp v13, v6, v101 row_newbcast:3 row_mask:0xf bank_mask:0xf
    v_fmac_f32_dpp v14, v6, v102 row_newbcast:3 row_mask:0xf bank_mask:0xf
    v_fmac_f32_dpp v15, v6, v103 row_newbcast:3 row_mask:0xf bank_mask:0xf
    v_cvt_f32_i32 v104, v104
    v_cvt_f32_i32 v105, v105
    v_cvt_f32_i32 v106, v106
    v_cvt_f32_i32 v107, v107
    v_fmac_f32_dpp v16, v6, v104 row_newbcast:3 row_mask:0xf bank_mask:0xf
    v_fmac_f32_dpp v17, v6, v105 row_newbcast:3 row_mask:0xf bank_mask:0xf
    v_fmac_f32_dpp v18, v6, v106 row_newbcast:3 row_mask:0xf bank_mask:0xf
    v_fmac_f32_dpp v19, v6, v107 row_newbcast:3 row_mask:0xf bank_mask:0xf
    v_cvt_f32_i32 v108, v108
    v_cvt_f32_i32 v109, v109
    v_cvt_f32_i32 v110, v110
    v_cvt_f32_i32 v111, v111
    v_fmac_f32_dpp v20, v6, v108 row_newbcast:3 row_mask:0xf bank_mask:0xf
    v_fmac_f32_dpp v21, v6, v109 row_newbcast:3 row_mask:0xf bank_mask:0xf
    v_fmac_f32_dpp v22, v6, v110 row_newbcast:3 row_mask:0xf bank_mask:0xf
    v_fmac_f32_dpp v23, v6, v111 row_newbcast:3 row_mask:0xf bank_mask:0xf
    s_waitcnt vmcnt(0)
    buffer_load_dwordx4 v[64:67], v48, s[12:15], 0 offen offset:0 nt
    buffer_load_dwordx4 v[68:71], v48, s[12:15], 0 offen offset:256 nt
    buffer_load_dwordx4 v[72:75], v48, s[12:15], 0 offen offset:512 nt
    buffer_load_dwordx4 v[76:79], v48, s[12:15], 0 offen offset:768 nt
    buffer_load_dwordx4 v[80:83], v48, s[12:15], 0 offen offset:1024 nt
    buffer_load_dwordx4 v[84:87], v48, s[12:15], 0 offen offset:1280 nt
    v_cvt_f32_i32 v112, v112
    v_cvt_f32_i32 v113, v113
    v_cvt_f32_i32 v114, v114
    v_cvt_f32_i32 v115, v115
    v_fmac_f32_dpp v12, v6, v112 row_newbcast:4 row_mask:0xf bank_mask:0xf
    v_fmac_f32_dpp v13, v6, v113 row_newbcast:4 row_mask:0xf bank_mask:0xf
    v_fmac_f32_dpp v14, v6, v114 row_newbcast:4 row_mask:0xf bank_mask:0xf
    v_fmac_f32_dpp v15, v6, v115 row_newbcast:4 row_mask:0xf bank_mask:0xf
    v_cvt_f32_i32 v116, v116
    v_cvt_f32_i32 v117, v117
    v_cvt_f32_i32 v118, v118
    v_cvt_f32_i32 v119, v119
    v_fmac_f32_dpp v16, v6, v116 row_newbcast:4 row_mask:0xf bank_mask:0xf
    v_fmac_f32_dpp v17, v6, v117 row_newbcast:4 row_mask:0xf bank_mask:0xf
    v_fmac_f32_dpp v18, v6, v118 row_newbcast:4 row_mask:0xf bank_mask:0xf
    v_fmac_f32_dpp v19, v6, v119 row_newbcast:4 row_mask:0xf bank_mask:0xf
    v_cvt_f32_i32 v120, v120
    v_cvt_f32_i32 v121, v121
    v_cvt_f32_i32 v122, v122
    v_cvt_f32_i32 v123, v123
    v_fmac_f32_dpp v20, v6, v120 row_newbcast:4 row_mask:0xf bank_mask:0xf
    v_fmac_f32_dpp v21, v6, v121 row_newbcast:4 row_mask:0xf bank_mask:0xf
    v_fmac_f32_dpp v22, v6, v122 row_newbcast:4 row_mask:0xf bank_mask:0xf
    v_fmac_f32_dpp v23, v6, v123 row_newbcast:4 row_mask:0xf bank_mask:0xf
    v_cvt_f32_i32 v124, v124
    v_cvt_f32_i32 v125, v125
    v_cvt_f32_i32 v126, v126
    v_cvt_f32_i32 v127, v127
    v_fmac_f32_dpp v12, v6, v124 row_newbcast:5 row_mask:0xf bank_mask:0xf
    v_fmac_f32_dpp v13, v6, v125 row_newbcast:5 row_mask:0xf bank_mask:0xf
    v_fmac_f32_dpp v14, v6, v126 row_newbcast:5 row_mask:0xf bank_mask:0xf
    v_fmac_f32_dpp v15, v6, v127 row_newbcast:5 row_mask:0xf bank_mask:0xf
    v_cvt_f32_i32 v128, v128
    v_cvt_f32_i32 v129, v129
    v_cvt_f32_i32 v130, v130
    v_cvt_f32_i32 v131, v131
    v_fmac_f32_dpp v16, v6, v128 row_newbcast:5 row_mask:0xf bank_mask:0xf
    v_fmac_f32_dpp v17, v6, v129 row_newbcast:5 row_mask:0xf bank_mask:0xf
    v_fmac_f32_dpp v18, v6, v130 row_newbcast:5 row_mask:0xf bank_mask:0xf
    v_fmac_f32_dpp v19, v6, v131 row_newbcast:5 row_mask:0xf bank_mask:0xf
    v_cvt_f32_i32 v132, v132
    v_cvt_f32_i32 v133, v133
    v_cvt_f32_i32 v134, v134
    v_cvt_f32_i32 v135, v135
    v_fmac_f32_dpp v20, v6, v132 row_newbcast:5 row_mask:0xf bank_mask:0xf
    v_fmac_f32_dpp v21, v6, v133 row_newbcast:5 row_mask:0xf bank_mask:0xf
    v_fmac_f32_dpp v22, v6, v134 row_newbcast:5 row_mask:0xf bank_mask:0xf
    v_fmac_f32_dpp v23, v6, v135 row_newbcast:5 row_mask:0xf bank_mask:0xf
    s_waitcnt lgkmcnt(0)
    v_mov_b32 v6, v7
L_vchk:
    s_nop 1
    s_cmp_eq_u32 s30, s49
    s_cbranch_scc1 L_deep
    s_cmp_lg_u32 s59, 0
    s_cbranch_scc1 L_vboost
    s_and_b32 s32, s30, 15
    s_cbranch_scc1 L_vloop
L_vend:
    s_nop 1
    v_permlane32_swap_b32 v12, v14
    v_permlane32_swap_b32 v13, v15
    v_permlane32_swap_b32 v16, v18
    v_permlane32_swap_b32 v17, v19
    v_permlane32_swap_b32 v20, v22
    v_permlane32_swap_b32 v21, v23
    v_add_f32 v12, v12, v14
    v_add_f32 v13, v13, v15
    v_add_f32 v16, v16, v18
    v_add_f32 v17, v17, v19
    v_add_f32 v20, v20, v22
    v_add_f32 v21, v21, v23
    v_permlane16_swap_b32 v12, v13
    v_permlane16_swap_b32 v16, v17
    v_permlane16_swap_b32 v20, v21
    s_lshr_b32 s32, s30, 2
    v_mov_b32 v10, s32
    v_add_f32 v12, v12, v13
    ds_write_b32 v8, v12 offset:0
    v_add_f32 v16, v16, v17
    ds_write_b32 v8, v16 offset:256
    v_add_f32 v20, v20, v21
    ds_write_b32 v8, v20 offset:512
    v_mov_b32 v11, 1
    s_mov_b64 exec, 1
    ds_add_u32 v10, v11 offset:60
    s_mov_b64 exec, -1
    v_add_u32 v8, 3072, v8
    v_mov_b32 v12, 0
    v_mov_b32 v13, 0
    v_mov_b32 v14, 0
    v_mov_b32 v15, 0
    v_mov_b32 v16, 0
    v_mov_b32 v17, 0
    v_mov_b32 v18, 0
    v_mov_b32 v19, 0
    v_mov_b32 v20, 0
    v_mov_b32 v21, 0
    v_mov_b32 v22, 0
    v_mov_b32 v23, 0
    s_cmp_lg_u32 s59, 0
    s_cbranch_scc1 L_vboost2
L_vend2:
    s_nop 1
    s_cmp_lg_u32 s30, 48
    s_cbranch_scc1 L_vloop
L_exit1:
    s_endpgm
L_deep:
    s_nop 1
    buffer_load_dwordx4 v[88:91], v48, s[12:15], 0 offen offset:1536 nt
    buffer_load_dwordx4 v[92:95], v48, s[12:15], 0 offen offset:1792 nt
    buffer_load_dwordx4 v[96:99], v48, s[12:15], 0 offen offset:2048 nt
    buffer_load_dwordx4 v[100:103], v48, s[12:15], 0 offen offset:2304 nt
    buffer_load_dwordx4 v[104:107], v48, s[12:15], 0 offen offset:2560 nt
    buffer_load_dwordx4 v[108:111], v48, s[12:15], 0 offen offset:2816 nt
    buffer_load_dwordx4 v[112:115], v48, s[12:15], 0 offen offset:3072 nt
    buffer_load_dwordx4 v[116:119], v48, s[12:15], 0 offen offset:3328 nt
    buffer_load_dwordx4 v[120:123], v48, s[12:15], 0 offen offset:3584 nt
    buffer_load_dwordx4 v[124:127], v49, s[12:15], 0 offen offset:0 nt
    buffer_load_dwordx4 v[128:131], v49, s[12:15], 0 offen offset:256 nt
    buffer_load_dwordx4 v[132:135], v49, s[12:15], 0 offen offset:512 nt
.p2align 6
L_dloop:
    s_nop 1
    s_add_u32 s29, s29, 4
    s_add_u32 s30, s30, 1
    s_lshr_b32 s33, s29, 6
    s_lshl_b32 s33, s33, 11
    s_and_b32 s32, s29, 63
    s_add_u32 s32, s32, s33
    s_add_u32 s32, s32, s44
    s_bfe_u32 s33, s32, 0x20003
    s_and_b32 s34, s32, 4
    s_or_b32 s33, s33, s34
    s_xor_b32 s33, s33, s5
    s_lshl_b32 s50, s32, 5
    s_or_b32 s50, s50, s33
    s_lshl_b32 s50, s50, 4
    s_or_b32 s50, s50, 1
    s_lshl_b32 s53, s29, 7
    v_xor_b32 v10, s50, v50
    v_mul_hi_u32 v10, v10, s47
    v_lshrrev_b32 v10, 1, v10
    v_and_b32 v11, 15, v10
    v_cmp_eq_u32 vcc, 5, v11
    v_mad_u32_u24 v48, v10, s45, v2
    v_add_u32 v11, 3840, v48
    v_cndmask_b32 v49, v51, v11, vcc
    v_add_u32 v10, s53, v5
    ds_read_b32 v7, v10
    s_waitcnt vmcnt(12)
    v_cvt_f32_i32 v64, v64
    v_cvt_f32_i32 v65, v65
    v_cvt_f32_i32 v66, v66
    v_cvt_f32_i32 v67, v67
    v_fmac_f32_dpp v12, v6, v64 row_newbcast:0 row_mask:0xf bank_mask:0xf
    v_fmac_f32_dpp v13, v6, v65 row_newbcast:0 row_mask:0xf bank_mask:0xf
    v_fmac_f32_dpp v14, v6, v66 row_newbcast:0 row_mask:0xf bank_mask:0xf
    v_fmac_f32_dpp v15, v6, v67 row_newbcast:0 row_mask:0xf bank_mask:0xf
    v_cvt_f32_i32 v68, v68
    v_cvt_f32_i32 v69, v69
    v_cvt_f32_i32 v70, v70
    v_cvt_f32_i32 v71, v71
    v_fmac_f32_dpp v16, v6, v68 row_newbcast:0 row_mask:0xf bank_mask:0xf
    v_fmac_f32_dpp v17, v6, v69 row_newbcast:0 row_mask:0xf bank_mask:0xf
    v_fmac_f32_dpp v18, v6, v70 row_newbcast:0 row_mask:0xf bank_mask:0xf
    v_fmac_f32_dpp v19, v6, v71 row_newbcast:0 row_mask:0xf bank_mask:0xf
    v_cvt_f32_i32 v72, v72
    v_cvt_f32_i32 v73, v73
    v_cvt_f32_i32 v74, v74
    v_cvt_f32_i32 v75, v75
    v_fmac_f32_dpp v20, v6, v72 row_newbcast:0 row_mask:0xf bank_mask:0xf
    v_fmac_f32_dpp v21, v6, v73 row_newbcast:0 row_mask:0xf bank_mask:0xf
    v_fmac_f32_dpp v22, v6, v74 row_newbcast:0 row_mask:0xf bank_mask:0xf
    v_fmac_f32_dpp v23, v6, v75 row_newbcast:0 row_mask:0xf bank_mask:0xf
    v_cvt_f32_i32 v76, v76
    v_cvt_f32_i32 v77, v77
    v_cvt_f32_i32 v78, v78
    v_cvt_f32_i32 v79, v79
    v_fmac_f32_dpp v12, v6, v76 row_newbcast:1 row_mask:0xf bank_mask:0xf
    v_fmac_f32_dpp v13, v6, v77 row_newbcast:1 row_mask:0xf bank_mask:0xf
    v_fmac_f32_dpp v14, v6, v78 row_newbcast:1 row_mask:0xf bank_mask:0xf
    v_fmac_f32_dpp v15, v6, v79 row_newbcast:1 row_mask:0xf bank_mask:0xf
    v_cvt_f32_i32 v80, v80
    v_cvt_f32_i32 v81, v81
    v_cvt_f32_i32 v82, v82
    v_cvt_f32_i32 v83, v83
    v_fmac_f32_dpp v16, v6, v80 row_newbcast:1 row_mask:0xf bank_mask:0xf
    v_fmac_f32_dpp v17, v6, v81 row_newbcast:1 row_mask:0xf bank_mask:0xf
    v_fmac_f32_dpp v18, v6, v82 row_newbcast:1 row_mask:0xf bank_mask:0xf
    v_fmac_f32_dpp v19, v6, v83 row_newbcast:1 row_mask:0xf bank_mask:0xf
    v_cvt_f32_i32 v84, v84
    v_cvt_f32_i32 v85, v85
    v_cvt_f32_i32 v86, v86
    v_cvt_f32_i32 v87, v87
    v_fmac_f32_dpp v20, v6, v84 row_newbcast:1 row_mask:0xf bank_mask:0xf
    v_fmac_f32_dpp v21, v6, v85 row_newbcast:1 row_mask:0xf bank_mask:0xf
    v_fmac_f32_dpp v22, v6, v86 row_newbcast:1 row_mask:0xf bank_mask:0xf
    v_fmac_f32_dpp v23, v6, v87 row_newbcast:1 row_mask:0xf bank_mask:0xf
    buffer_load_dwordx4 v[64:67], v48, s[12:15], 0 offen offset:0 nt
    buffer_load_dwordx4 v[68:71], v48, s[12:15], 0 offen offset:256 nt
    buffer_load_dwordx4 v[72:75], v48, s[12:15], 0 offen offset:512 nt
    buffer_load_dwordx4 v[76:79], v48, s[12:15], 0 offen offset:768 nt
    buffer_load_dwordx4 v[80:83], v48, s[12:15], 0 offen offset:1024 nt
    buffer_load_dwordx4 v[84:87], v48, s[12:15], 0 offen offset:1280 nt
    s_waitcnt vmcnt(12)
    v_cvt_f32_i32 v88, v88
    v_cvt_f32_i32 v89, v89
    v_cvt_f32_i32 v90, v90
    v_cvt_f32_i32 v91, v91
    v_fmac_f32_dpp v12, v6, v88 row_newbcast:2 row_mask:0xf bank_mask:0xf
    v_fmac_f32_dpp v13, v6, v89 row_newbcast:2 row_mask:0xf bank_mask:0xf
    v_fmac_f32_dpp v14, v6, v90 row_newbcast:2 row_mask:0xf bank_mask:0xf
    v_fmac_f32_dpp v15, v6, v91 row_newbcast:2 row_mask:0xf bank_mask:0xf
    v_cvt_f32_i32 v92, v92
    v_cvt_f32_i32 v93, v93
    v_cvt_f32_i32 v94, v94
    v_cvt_f32_i32 v95, v95
    v_fmac_f32_dpp v16, v6, v92 row_newbcast:2 row_mask:0xf bank_mask:0xf
    v_fmac_f32_dpp v17, v6, v93 row_newbcast:2 row_mask:0xf bank_mask:0xf
    v_fmac_f32_dpp v18, v6, v94 row_newbcast:2 row_mask:0xf bank_mask:0xf
    v_fmac_f32_dpp v19, v6, v95 row_newbcast:2 row_mask:0xf bank_mask:0xf
    v_cvt_f32_i32 v96, v96
    v_cvt_f32_i32 v97, v97
    v_cvt_f32_i32 v98, v98
    v_cvt_f32_i32 v99, v99
    v_fmac_f32_dpp v20, v6, v96 row_newbcast:2 row_mask:0xf bank_mask:0xf
    v_fmac_f32_dpp v21, v6, v97 row_newbcast:2 row_mask:0xf bank_mask:0xf
    v_fmac_f32_dpp v22, v6, v98 row_newbcast:2 row_mask:0xf bank_mask:0xf
    v_fmac_f32_dpp v23, v6, v99 row_newbcast:2 row_mask:0xf bank_mask:0xf
    v_cvt_f32_i32 v100, v100
    v_cvt_f32_i32 v101, v101
    v_cvt_f32_i32 v102, v102
    v_cvt_f32_i32 v103, v103
    v_fmac_f32_dpp v12, v6, v100 row_newbcast:3 row_mask:0xf bank_mask:0xf
    v_fmac_f32_dpp v13, v6, v101 row_newbcast:3 row_mask:0xf bank_mask:0xf
    v_fmac_f32_dpp v14, v6, v102 row_newbcast:3 row_mask:0xf bank_mask:0xf
    v_fmac_f32_dpp v15, v6, v103 row_newbcast:3 row_mask:0xf bank_mask:0xf
    v_cvt_f32_i32 v104, v104
    v_cvt_f32_i32 v105, v105
    v_cvt_f32_i32 v106, v106
    v_cvt_f32_i32 v107, v107
    v_fmac_f32_dpp v16, v6, v104 row_newbcast:3 row_mask:0xf bank_mask:0xf
    v_fmac_f32_dpp v17, v6, v105 row_newbcast:3 row_mask:0xf bank_mask:0xf
    v_fmac_f32_dpp v18, v6, v106 row_newbcast:3 row_mask:0xf bank_mask:0xf
    v_fmac_f32_dpp v19, v6, v107 row_newbcast:3 row_mask:0xf bank_mask:0xf
    v_cvt_f32_i32 v108, v108
    v_cvt_f32_i32 v109, v109
    v_cvt_f32_i32 v110, v110
    v_cvt_f32_i32 v111, v111
    v_fmac_f32_dpp v20, v6, v108 row_newbcast:3 row_mask:0xf bank_mask:0xf
    v_fmac_f32_dpp v21, v6, v109 row_newbcast:3 row_mask:0xf bank_mask:0xf
    v_fmac_f32_dpp v22, v6, v110 row_newbcast:3 row_mask:0xf bank_mask:0xf
    v_fmac_f32_dpp v23, v6, v111 row_newbcast:3 row_mask:0xf bank_mask:0xf
    buffer_load_dwordx4 v[88:91], v48, s[12:15], 0 offen offset:1536 nt
    buffer_load_dwordx4 v[92:95], v48, s[12:15], 0 offen offset:1792 nt
    buffer_load_dwordx4 v[96:99], v48, s[12:15], 0 offen offset:2048 nt
    buffer_load_dwordx4 v[100:103], v48, s[12:15], 0 offen offset:2304 nt
    buffer_load_dwordx4 v[104:107], v48, s[12:15], 0 offen offset:2560 nt
    buffer_load_dwordx4 v[108:111], v48, s[12:15], 0 offen offset:2816 nt
    s_waitcnt vmcnt(12)
    v_cvt_f32_i32 v112, v112
    v_cvt_f32_i32 v113, v113
    v_cvt_f32_i32 v114, v114
    v_cvt_f32_i32 v115, v115
    v_fmac_f32_dpp v12, v6, v112 row_newbcast:4 row_mask:0xf bank_mask:0xf
    v_fmac_f32_dpp v13, v6, v113 row_newbcast:4 row_mask:0xf bank_mask:0xf
    v_fmac_f32_dpp v14, v6, v114 row_newbcast:4 row_mask:0xf bank_mask:0xf
    v_fmac_f32_dpp v15, v6, v115 row_newbcast:4 row_mask:0xf bank_mask:0xf
    v_cvt_f32_i32 v116, v116
    v_cvt_f32_i32 v117, v117
    v_cvt_f32_i32 v118, v118
    v_cvt_f32_i32 v119, v119
    v_fmac_f32_dpp v16, v6, v116 row_newbcast:4 row_mask:0xf bank_mask:0xf
    v_fmac_f32_dpp v17, v6, v117 row_newbcast:4 row_mask:0xf bank_mask:0xf
    v_fmac_f32_dpp v18, v6, v118 row_newbcast:4 row_mask:0xf bank_mask:0xf
    v_fmac_f32_dpp v19, v6, v119 row_newbcast:4 row_mask:0xf bank_mask:0xf
    v_cvt_f32_i32 v120, v120
    v_cvt_f32_i32 v121, v121
    v_cvt_f32_i32 v122, v122
    v_cvt_f32_i32 v123, v123
    v_fmac_f32_dpp v20, v6, v120 row_newbcast:4 row_mask:0xf bank_mask:0xf
    v_fmac_f32_dpp v21, v6, v121 row_newbcast:4 row_mask:0xf bank_mask:0xf
    v_fmac_f32_dpp v22, v6, v122 row_newbcast:4 row_mask:0xf bank_mask:0xf
    v_fmac_f32_dpp v23, v6, v123 row_newbcast:4 row_mask:0xf bank_mask:0xf
    v_cvt_f32_i32 v124, v124
    v_cvt_f32_i32 v125, v125
    v_cvt_f32_i32 v126, v126
    v_cvt_f32_i32 v127, v127
    v_fmac_f32_dpp v12, v6, v124 row_newbcast:5 row_mask:0xf bank_mask:0xf
    v_fmac_f32_dpp v13, v6, v125 row_newbcast:5 row_mask:0xf bank_mask:0xf
    v_fmac_f32_dpp v14, v6, v126 row_newbcast:5 row_mask:0xf bank_mask:0xf
    v_fmac_f32_dpp v15, v6, v127 row_newbcast:5 row_mask:0xf bank_mask:0xf
    v_cvt_f32_i32 v128, v128
    v_cvt_f32_i32 v129, v129
    v_cvt_f32_i32 v130, v130
    v_cvt_f32_i32 v131, v131
    v_fmac_f32_dpp v16, v6, v128 row_newbcast:5 row_mask:0xf bank_mask:0xf
    v_fmac_f32_dpp v17, v6, v129 row_newbcast:5 row_mask:0xf bank_mask:0xf
    v_fmac_f32_dpp v18, v6, v130 row_newbcast:5 row_mask:0xf bank_mask:0xf
    v_fmac_f32_dpp v19, v6, v131 row_newbcast:5 row_mask:0xf bank_mask:0xf
    v_cvt_f32_i32 v132, v132
    v_cvt_f32_i32 v133, v133
    v_cvt_f32_i32 v134, v134
    v_cvt_f32_i32 v135, v135
    v_fmac_f32_dpp v20, v6, v132 row_newbcast:5 row_mask:0xf bank_mask:0xf
    v_fmac_f32_dpp v21, v6, v133 row_newbcast:5 row_mask:0xf bank_mask:0xf
    v_fmac_f32_dpp v22, v6, v134 row_newbcast:5 row_mask:0xf bank_mask:0xf
    v_fmac_f32_dpp v23, v6, v135 row_newbcast:5 row_mask:0xf bank_mask:0xf
    buffer_load_dwordx4 v[112:115], v48, s[12:15], 0 offen offset:3072 nt
    buffer_load_dwordx4 v[116:119], v48, s[12:15], 0 offen offset:3328 nt
    buffer_load_dwordx4 v[120:123], v48, s[12:15], 0 offen offset:3584 nt
    buffer_load_dwordx4 v[124:127], v49, s[12:15], 0 offen offset:0 nt
    buffer_load_dwordx4 v[128:131], v49, s[12:15], 0 offen offset:256 nt
    buffer_load_dwordx4 v[132:135], v49, s[12:15], 0 offen offset:512 nt
    s_waitcnt lgkmcnt(0)
    v_mov_b32 v6, v7
    s_cmp_lg_u32 s30, 48
    s_cbranch_scc1 L_dloop
    s_branch L_vend
L_kboost:
    s_nop 1
    s_cmp_eq_u32 s30, 47
    s_cbranch_scc1 L_kchk2
    buffer_load_dwordx4 v[88:91], v48, s[8:11], 0 offen offset:1536 nt
    buffer_load_dwordx4 v[92:95], v48, s[8:11], 0 offen offset:1792 nt
    buffer_load_dwordx4 v[96:99], v48, s[8:11], 0 offen offset:2048 nt
    buffer_load_dwordx4 v[100:103], v48, s[8:11], 0 offen offset:2304 nt
    buffer_load_dwordx4 v[104:107], v48, s[8:11], 0 offen offset:2560 nt
    buffer_load_dwordx4 v[108:111], v48, s[8:11], 0 offen offset:2816 nt
    buffer_load_dwordx4 v[112:115], v48, s[8:11], 0 offen offset:3072 nt
    buffer_load_dwordx4 v[116:119], v48, s[8:11], 0 offen offset:3328 nt
    buffer_load_dwordx4 v[120:123], v48, s[8:11], 0 offen offset:3584 nt
    buffer_load_dwordx4 v[124:127], v49, s[8:11], 0 offen offset:0 nt
    buffer_load_dwordx4 v[128:131], v49, s[8:11], 0 offen offset:256 nt
    buffer_load_dwordx4 v[132:135], v49, s[8:11], 0 offen offset:512 nt
    s_sub_u32 s59, s59, 1
    s_add_u32 s29, s29, 4
    s_add_u32 s30, s30, 1
    s_bitcmp1_b64 s[40:41], s30
    s_cbranch_scc1 L_evKB
L_evretKB:
    s_nop 1
    s_lshr_b32 s33, s29, 6
    s_lshl_b32 s33, s33, 11
    s_and_b32 s32, s29, 63
    s_add_u32 s32, s32, s33
    s_add_u32 s32, s32, s44
    s_bfe_u32 s33, s32, 0x20003
    s_and_b32 s34, s32, 4
    s_or_b32 s33, s33, s34
    s_xor_b32 s33, s33, s5
    s_lshl_b32 s50, s32, 5
    s_or_b32 s50, s50, s33
    s_lshl_b32 s50, s50, 4
    s_or_b32 s50, s50, 1
    v_xor_b32 v10, s50, v50
    v_mul_hi_u32 v10, v10, s47
    v_lshrrev_b32 v10, 1, v10
    v_and_b32 v11, 15, v10
    v_cmp_eq_u32 vcc, 5, v11
    v_mad_u32_u24 v48, v10, s45, v2
    v_add_u32 v11, 3840, v48
    v_cndmask_b32 v49, v51, v11, vcc
    v_lshrrev_b32 v10, 6, v10
    v_mad_u32_u24 v9, v10, s46, v3
    buffer_load_dwordx2 v[42:43], v9, s[16:19], 0 offen offset:0
    buffer_load_dwordx2 v[44:45], v9, s[16:19], 0 offen offset:128
    buffer_load_dwordx2 v[46:47], v9, s[16:19], 0 offen offset:256
    s_waitcnt vmcnt(15)
    v_cvt_f32_i32 v64, v64
    v_cvt_f32_i32 v65, v65
    v_cvt_f32_i32 v66, v66
    v_cvt_f32_i32 v67, v67
    v_mul_f32 v54, v64, v24
    v_fmac_f32 v54, v65, v25
    v_fmac_f32 v54, v66, v26
    v_fmac_f32 v54, v67, v27
    v_cvt_f32_i32 v68, v68
    v_cvt_f32_i32 v69, v69
    v_cvt_f32_i32 v70, v70
    v_cvt_f32_i32 v71, v71
    v_fmac_f32 v54, v68, v28
    v_fmac_f32 v54, v69, v29
    v_fmac_f32 v54, v70, v30
    v_fmac_f32 v54, v71, v31
    v_cvt_f32_i32 v72, v72
    v_cvt_f32_i32 v73, v73
    v_cvt_f32_i32 v74, v74
    v_cvt_f32_i32 v75, v75
    v_fmac_f32 v54, v72, v32
    v_fmac_f32 v54, v73, v33
    v_fmac_f32 v54, v74, v34
    v_fmac_f32 v54, v75, v35
    v_cvt_f32_i32 v76, v76
    v_cvt_f32_i32 v77, v77
    v_add_f32_dpp v54, v54, v54 row_ror:8 row_mask:0xf bank_mask:0xf
    v_cvt_f32_i32 v78, v78
    v_cvt_f32_i32 v79, v79
    v_add_f32_dpp v54, v54, v54 row_ror:4 row_mask:0xf bank_mask:0xf
    v_mul_f32 v55, v76, v24
    v_fmac_f32 v55, v77, v25
    v_add_f32_dpp v54, v54, v54 row_ror:2 row_mask:0xf bank_mask:0xf
    v_fmac_f32 v55, v78, v26
    v_fmac_f32 v55, v79, v27
    v_add_f32_dpp v60, v54, v54 row_ror:1 row_mask:0xf bank_mask:0x1
    v_cvt_f32_i32 v80, v80
    v_cvt_f32_i32 v81, v81
    v_cvt_f32_i32 v82, v82
    v_cvt_f32_i32 v83, v83
    v_fmac_f32 v55, v80, v28
    v_fmac_f32 v55, v81, v29
    v_fmac_f32 v55, v82, v30
    v_fmac_f32 v55, v83, v31
    v_cvt_f32_i32 v84, v84
    v_cvt_f32_i32 v85, v85
    v_cvt_f32_i32 v86, v86
    v_cvt_f32_i32 v87, v87
    v_fmac_f32 v55, v84, v32
    v_fmac_f32 v55, v85, v33
    v_fmac_f32 v55, v86, v34
    v_fmac_f32 v55, v87, v35
    s_nop 1
    v_add_f32_dpp v55, v55, v55 row_ror:8 row_mask:0xf bank_mask:0xf
    s_nop 1
    v_add_f32_dpp v55, v55, v55 row_ror:4 row_mask:0xf bank_mask:0xf
    s_nop 1
    v_add_f32_dpp v55, v55, v55 row_ror:2 row_mask:0xf bank_mask:0xf
    s_nop 1
    v_add_f32_dpp v61, v55, v55 row_ror:1 row_mask:0xf bank_mask:0x1
    buffer_load_dwordx4 v[64:67], v48, s[8:11], 0 offen offset:0 nt
    buffer_load_dwordx4 v[68:71], v48, s[8:11], 0 offen offset:256 nt
    buffer_load_dwordx4 v[72:75], v48, s[8:11], 0 offen offset:512 nt
    buffer_load_dwordx4 v[76:79], v48, s[8:11], 0 offen offset:768 nt
    buffer_load_dwordx4 v[80:83], v48, s[8:11], 0 offen offset:1024 nt
    buffer_load_dwordx4 v[84:87], v48, s[8:11], 0 offen offset:1280 nt
    s_waitcnt vmcnt(15)
    v_cvt_f32_i32 v88, v88
    v_cvt_f32_i32 v89, v89
    v_cvt_f32_i32 v90, v90
    v_cvt_f32_i32 v91, v91
    v_mul_f32 v56, v88, v24
    v_fmac_f32 v56, v89, v25
    v_fmac_f32 v56, v90, v26
    v_fmac_f32 v56, v91, v27
    v_cvt_f32_i32 v92, v92
    v_cvt_f32_i32 v93, v93
    v_cvt_f32_i32 v94, v94
    v_cvt_f32_i32 v95, v95
    v_fmac_f32 v56, v92, v28
    v_fmac_f32 v56, v93, v29
    v_fmac_f32 v56, v94, v30
    v_fmac_f32 v56, v95, v31
    v_cvt_f32_i32 v96, v96
    v_cvt_f32_i32 v97, v97
    v_cvt_f32_i32 v98, v98
    v_cvt_f32_i32 v99, v99
    v_fmac_f32 v56, v96, v32
    v_fmac_f32 v56, v97, v33
    v_fmac_f32 v56, v98, v34
    v_fmac_f32 v56, v99, v35
    v_cvt_f32_i32 v100, v100
    v_cvt_f32_i32 v101, v101
    v_add_f32_dpp v56, v56, v56 row_ror:8 row_mask:0xf bank_mask:0xf
    v_cvt_f32_i32 v102, v102
    v_cvt_f32_i32 v103, v103
    v_add_f32_dpp v56, v56, v56 row_ror:4 row_mask:0xf bank_mask:0xf
    v_mul_f32 v57, v100, v24
    v_fmac_f32 v57, v101, v25
    v_add_f32_dpp v56, v56, v56 row_ror:2 row_mask:0xf bank_mask:0xf
    v_fmac_f32 v57, v102, v26
    v_fmac_f32 v57, v103, v27
    v_add_f32_dpp v60, v56, v56 row_ror:1 row_mask:0xf bank_mask:0x2
    v_cvt_f32_i32 v104, v104
    v_cvt_f32_i32 v105, v105
    v_cvt_f32_i32 v106, v106
    v_cvt_f32_i32 v107, v107
    v_fmac_f32 v57, v104, v28
    v_fmac_f32 v57, v105, v29
    v_fmac_f32 v57, v106, v30
    v_fmac_f32 v57, v107, v31
    v_cvt_f32_i32 v108, v108
    v_cvt_f32_i32 v109, v109
    v_cvt_f32_i32 v110, v110
    v_cvt_f32_i32 v111, v111
    v_fmac_f32 v57, v108, v32
    v_fmac_f32 v57, v109, v33
    v_fmac_f32 v57, v110, v34
    v_fmac_f32 v57, v111, v35
    s_nop 1
    v_add_f32_dpp v57, v57, v57 row_ror:8 row_mask:0xf bank_mask:0xf
    s_nop 1
    v_add_f32_dpp v57, v57, v57 row_ror:4 row_mask:0xf bank_mask:0xf
    s_nop 1
    v_add_f32_dpp v57, v57, v57 row_ror:2 row_mask:0xf bank_mask:0xf
    s_nop 1
    v_add_f32_dpp v61, v57, v57 row_ror:1 row_mask:0xf bank_mask:0x2
    s_waitcnt vmcnt(9)
    v_cvt_f32_i32 v112, v112
    v_cvt_f32_i32 v113, v113
    v_cvt_f32_i32 v114, v114
    v_cvt_f32_i32 v115, v115
    v_mul_f32 v58, v112, v24
    v_fmac_f32 v58, v113, v25
    v_fmac_f32 v58, v114, v26
    v_fmac_f32 v58, v115, v27
    v_cvt_f32_i32 v116, v116
    v_cvt_f32_i32 v117, v117
    v_cvt_f32_i32 v118, v118
    v_cvt_f32_i32 v119, v119
    v_fmac_f32 v58, v116, v28
    v_fmac_f32 v58, v117, v29
    v_fmac_f32 v58, v118, v30
    v_fmac_f32 v58, v119, v31
    v_cvt_f32_i32 v120, v120
    v_cvt_f32_i32 v121, v121
    v_cvt_f32_i32 v122, v122
    v_cvt_f32_i32 v123, v123
    v_fmac_f32 v58, v120, v32
    v_fmac_f32 v58, v121, v33
    v_fmac_f32 v58, v122, v34
    v_fmac_f32 v58, v123, v35
    v_cvt_f32_i32 v124, v124
    v_cvt_f32_i32 v125, v125
    v_add_f32_dpp v58, v58, v58 row_ror:8 row_mask:0xf bank_mask:0xf
    v_cvt_f32_i32 v126, v126
    v_cvt_f32_i32 v127, v127
    v_add_f32_dpp v58, v58, v58 row_ror:4 row_mask:0xf bank_mask:0xf
    v_mul_f32 v59, v124, v24
    v_fmac_f32 v59, v125, v25
    v_add_f32_dpp v58, v58, v58 row_ror:2 row_mask:0xf bank_mask:0xf
    v_fmac_f32 v59, v126, v26
    v_fmac_f32 v59, v127, v27
    v_add_f32_dpp v60, v58, v58 row_ror:1 row_mask:0xf bank_mask:0x4
    v_cvt_f32_i32 v128, v128
    v_cvt_f32_i32 v129, v129
    v_cvt_f32_i32 v130, v130
    v_cvt_f32_i32 v131, v131
    v_fmac_f32 v59, v128, v28
    v_fmac_f32 v59, v129, v29
    v_fmac_f32 v59, v130, v30
    v_fmac_f32 v59, v131, v31
    v_cvt_f32_i32 v132, v132
    v_cvt_f32_i32 v133, v133
    v_cvt_f32_i32 v134, v134
    v_cvt_f32_i32 v135, v135
    v_fmac_f32 v59, v132, v32
    v_fmac_f32 v59, v133, v33
    v_fmac_f32 v59, v134, v34
    v_fmac_f32 v59, v135, v35
    s_nop 1
    v_add_f32_dpp v59, v59, v59 row_ror:8 row_mask:0xf bank_mask:0xf
    s_nop 1
    v_add_f32_dpp v59, v59, v59 row_ror:4 row_mask:0xf bank_mask:0xf
    s_nop 1
    v_add_f32_dpp v59, v59, v59 row_ror:2 row_mask:0xf bank_mask:0xf
    s_nop 1
    v_add_f32_dpp v61, v59, v59 row_ror:1 row_mask:0xf bank_mask:0x4
    s_mov_b64 exec, s[42:43]
    ds_write_b64 v4, v[60:61]
    s_mov_b64 exec, -1
    v_add_u32 v4, 48, v4
    s_waitcnt vmcnt(6)
    v_lshlrev_b32 v10, 16, v36
    v_lshlrev_b32 v24, 16, v42
    v_and_b32 v11, 0xffff0000, v36
    v_and_b32 v25, 0xffff0000, v42
    v_mul_f32 v24, v24, v10
    v_mul_f32 v25, v25, v11
    v_lshlrev_b32 v10, 16, v37
    v_lshlrev_b32 v26, 16, v43
    v_and_b32 v11, 0xffff0000, v37
    v_and_b32 v27, 0xffff0000, v43
    v_mul_f32 v26, v26, v10
    v_mul_f32 v27, v27, v11
    v_lshlrev_b32 v10, 16, v38
    v_lshlrev_b32 v28, 16, v44
    v_and_b32 v11, 0xffff0000, v38
    v_and_b32 v29, 0xffff0000, v44
    v_mul_f32 v28, v28, v10
    v_mul_f32 v29, v29, v11
    v_lshlrev_b32 v10, 16, v39
    v_lshlrev_b32 v30, 16, v45
    v_and_b32 v11, 0xffff0000, v39
    v_and_b32 v31, 0xffff0000, v45
    v_mul_f32 v30, v30, v10
    v_mul_f32 v31, v31, v11
    v_lshlrev_b32 v10, 16, v40
    v_lshlrev_b32 v32, 16, v46
    v_and_b32 v11, 0xffff0000, v40
    v_and_b32 v33, 0xffff0000, v46
    v_mul_f32 v32, v32, v10
    v_mul_f32 v33, v33, v11
    v_lshlrev_b32 v10, 16, v41
    v_lshlrev_b32 v34, 16, v47
    v_and_b32 v11, 0xffff0000, v41
    v_and_b32 v35, 0xffff0000, v47
    v_mul_f32 v34, v34, v10
    v_mul_f32 v35, v35, v11
    s_branch L_kchk
L_vboost:
    s_nop 1
    s_and_b32 s32, s30, 15
    s_cbranch_scc0 L_vend
L_vboost2:
    s_nop 1
    s_cmp_eq_u32 s30, 48
    s_cbranch_scc1 L_vend2
    buffer_load_dwordx4 v[88:91], v48, s[12:15], 0 offen offset:1536 nt
    buffer_load_dwordx4 v[92:95], v48, s[12:15], 0 offen offset:1792 nt
    buffer_load_dwordx4 v[96:99], v48, s[12:15], 0 offen offset:2048 nt
    buffer_load_dwordx4 v[100:103], v48, s[12:15], 0 offen offset:2304 nt
    buffer_load_dwordx4 v[104:107], v48, s[12:15], 0 offen offset:2560 nt
    buffer_load_dwordx4 v[108:111], v48, s[12:15], 0 offen offset:2816 nt
    buffer_load_dwordx4 v[112:115], v48, s[12:15], 0 offen offset:3072 nt
    buffer_load_dwordx4 v[116:119], v48, s[12:15], 0 offen offset:3328 nt
    buffer_load_dwordx4 v[120:123], v48, s[12:15], 0 offen offset:3584 nt
    buffer_load_dwordx4 v[124:127], v49, s[12:15], 0 offen offset:0 nt
    buffer_load_dwordx4 v[128:131], v49, s[12:15], 0 offen offset:256 nt
    buffer_load_dwordx4 v[132:135], v49, s[12:15], 0 offen offset:512 nt
    s_sub_u32 s59, s59, 1
    s_add_u32 s29, s29, 4
    s_add_u32 s30, s30, 1
    s_bitcmp1_b64 s[40:41], s30
    s_cbranch_scc1 L_evVB
L_evretVB:
    s_nop 1
    s_lshr_b32 s33, s29, 6
    s_lshl_b32 s33, s33, 11
    s_and_b32 s32, s29, 63
    s_add_u32 s32, s32, s33
    s_add_u32 s32, s32, s44
    s_bfe_u32 s33, s32, 0x20003
    s_and_b32 s34, s32, 4
    s_or_b32 s33, s33, s34
    s_xor_b32 s33, s33, s5
    s_lshl_b32 s50, s32, 5
    s_or_b32 s50, s50, s33
    s_lshl_b32 s50, s50, 4
    s_or_b32 s50, s50, 1
    s_lshl_b32 s53, s29, 7
    v_xor_b32 v10, s50, v50
    v_mul_hi_u32 v10, v10, s47
    v_lshrrev_b32 v10, 1, v10
    v_and_b32 v11, 15, v10
    v_cmp_eq_u32 vcc, 5, v11
    v_mad_u32_u24 v48, v10, s45, v2
    v_add_u32 v11, 3840, v48
    v_cndmask_b32 v49, v51, v11, vcc
    v_add_u32 v10, s53, v5
    ds_read_b32 v7, v10
    s_waitcnt vmcnt(12)
    v_cvt_f32_i32 v64, v64
    v_cvt_f32_i32 v65, v65
    v_cvt_f32_i32 v66, v66
    v_cvt_f32_i32 v67, v67
    v_fmac_f32_dpp v12, v6, v64 row_newbcast:0 row_mask:0xf bank_mask:0xf
    v_fmac_f32_dpp v13, v6, v65 row_newbcast:0 row_mask:0xf bank_mask:0xf
    v_fmac_f32_dpp v14, v6, v66 row_newbcast:0 row_mask:0xf bank_mask:0xf
    v_fmac_f32_dpp v15, v6, v67 row_newbcast:0 row_mask:0xf bank_mask:0xf
    v_cvt_f32_i32 v68, v68
    v_cvt_f32_i32 v69, v69
    v_cvt_f32_i32 v70, v70
    v_cvt_f32_i32 v71, v71
    v_fmac_f32_dpp v16, v6, v68 row_newbcast:0 row_mask:0xf bank_mask:0xf
    v_fmac_f32_dpp v17, v6, v69 row_newbcast:0 row_mask:0xf bank_mask:0xf
    v_fmac_f32_dpp v18, v6, v70 row_newbcast:0 row_mask:0xf bank_mask:0xf
    v_fmac_f32_dpp v19, v6, v71 row_newbcast:0 row_mask:0xf bank_mask:0xf
    v_cvt_f32_i32 v72, v72
    v_cvt_f32_i32 v73, v73
    v_cvt_f32_i32 v74, v74
    v_cvt_f32_i32 v75, v75
    v_fmac_f32_dpp v20, v6, v72 row_newbcast:0 row_mask:0xf bank_mask:0xf
    v_fmac_f32_dpp v21, v6, v73 row_newbcast:0 row_mask:0xf bank_mask:0xf
    v_fmac_f32_dpp v22, v6, v74 row_newbcast:0 row_mask:0xf bank_mask:0xf
    v_fmac_f32_dpp v23, v6, v75 row_newbcast:0 row_mask:0xf bank_mask:0xf
    v_cvt_f32_i32 v76, v76
    v_cvt_f32_i32 v77, v77
    v_cvt_f32_i32 v78, v78
    v_cvt_f32_i32 v79, v79
    v_fmac_f32_dpp v12, v6, v76 row_newbcast:1 row_mask:0xf bank_mask:0xf
    v_fmac_f32_dpp v13, v6, v77 row_newbcast:1 row_mask:0xf bank_mask:0xf
    v_fmac_f32_dpp v14, v6, v78 row_newbcast:1 row_mask:0xf bank_mask:0xf
    v_fmac_f32_dpp v15, v6, v79 row_newbcast:1 row_mask:0xf bank_mask:0xf
    v_cvt_f32_i32 v80, v80
    v_cvt_f32_i32 v81, v81
    v_cvt_f32_i32 v82, v82
    v_cvt_f32_i32 v83, v83
    v_fmac_f32_dpp v16, v6, v80 row_newbcast:1 row_mask:0xf bank_mask:0xf
    v_fmac_f32_dpp v17, v6, v81 row_newbcast:1 row_mask:0xf bank_mask:0xf
    v_fmac_f32_dpp v18, v6, v82 row_newbcast:1 row_mask:0xf bank_mask:0xf
    v_fmac_f32_dpp v19, v6, v83 row_newbcast:1 row_mask:0xf bank_mask:0xf
    v_cvt_f32_i32 v84, v84
    v_cvt_f32_i32 v85, v85
    v_cvt_f32_i32 v86, v86
    v_cvt_f32_i32 v87, v87
    v_fmac_f32_dpp v20, v6, v84 row_newbcast:1 row_mask:0xf bank_mask:0xf
    v_fmac_f32_dpp v21, v6, v85 row_newbcast:1 row_mask:0xf bank_mask:0xf
    v_fmac_f32_dpp v22, v6, v86 row_newbcast:1 row_mask:0xf bank_mask:0xf
    v_fmac_f32_dpp v23, v6, v87 row_newbcast:1 row_mask:0xf bank_mask:0xf
    buffer_load_dwordx4 v[64:67], v48, s[12:15], 0 offen offset:0 nt
    buffer_load_dwordx4 v[68:71], v48, s[12:15], 0 offen offset:256 nt
    buffer_load_dwordx4 v[72:75], v48, s[12:15], 0 offen offset:512 nt
    buffer_load_dwordx4 v[76:79], v48, s[12:15], 0 offen offset:768 nt
    buffer_load_dwordx4 v[80:83], v48, s[12:15], 0 offen offset:1024 nt
    buffer_load_dwordx4 v[84:87], v48, s[12:15], 0 offen offset:1280 nt
    s_waitcnt vmcnt(12)
    v_cvt_f32_i32 v88, v88
    v_cvt_f32_i32 v89, v89
    v_cvt_f32_i32 v90, v90
    v_cvt_f32_i32 v91, v91
    v_fmac_f32_dpp v12, v6, v88 row_newbcast:2 row_mask:0xf bank_mask:0xf
    v_fmac_f32_dpp v13, v6, v89 row_newbcast:2 row_mask:0xf bank_mask:0xf
    v_fmac_f32_dpp v14, v6, v90 row_newbcast:2 row_mask:0xf bank_mask:0xf
    v_fmac_f32_dpp v15, v6, v91 row_newbcast:2 row_mask:0xf bank_mask:0xf
    v_cvt_f32_i32 v92, v92
    v_cvt_f32_i32 v93, v93
    v_cvt_f32_i32 v94, v94
    v_cvt_f32_i32 v95, v95
    v_fmac_f32_dpp v16, v6, v92 row_newbcast:2 row_mask:0xf bank_mask:0xf
    v_fmac_f32_dpp v17, v6, v93 row_newbcast:2 row_mask:0xf bank_mask:0xf
    v_fmac_f32_dpp v18, v6, v94 row_newbcast:2 row_mask:0xf bank_mask:0xf
    v_fmac_f32_dpp v19, v6, v95 row_newbcast:2 row_mask:0xf bank_mask:0xf
    v_cvt_f32_i32 v96, v96
    v_cvt_f32_i32 v97, v97
    v_cvt_f32_i32 v98, v98
    v_cvt_f32_i32 v99, v99
    v_fmac_f32_dpp v20, v6, v96 row_newbcast:2 row_mask:0xf bank_mask:0xf
    v_fmac_f32_dpp v21, v6, v97 row_newbcast:2 row_mask:0xf bank_mask:0xf
    v_fmac_f32_dpp v22, v6, v98 row_newbcast:2 row_mask:0xf bank_mask:0xf
    v_fmac_f32_dpp v23, v6, v99 row_newbcast:2 row_mask:0xf bank_mask:0xf
    v_cvt_f32_i32 v100, v100
    v_cvt_f32_i32 v101, v101
    v_cvt_f32_i32 v102, v102
    v_cvt_f32_i32 v103, v103
    v_fmac_f32_dpp v12, v6, v100 row_newbcast:3 row_mask:0xf bank_mask:0xf
    v_fmac_f32_dpp v13, v6, v101 row_newbcast:3 row_mask:0xf bank_mask:0xf
    v_fmac_f32_dpp v14, v6, v102 row_newbcast:3 row_mask:0xf bank_mask:0xf
    v_fmac_f32_dpp v15, v6, v103 row_newbcast:3 row_mask:0xf bank_mask:0xf
    v_cvt_f32_i32 v104, v104
    v_cvt_f32_i32 v105, v105
    v_cvt_f32_i32 v106, v106
    v_cvt_f32_i32 v107, v107
    v_fmac_f32_dpp v16, v6, v104 row_newbcast:3 row_mask:0xf bank_mask:0xf
    v_fmac_f32_dpp v17, v6, v105 row_newbcast:3 row_mask:0xf bank_mask:0xf
    v_fmac_f32_dpp v18, v6, v106 row_newbcast:3 row_mask:0xf bank_mask:0xf
    v_fmac_f32_dpp v19, v6, v107 row_newbcast:3 row_mask:0xf bank_mask:0xf
    v_cvt_f32_i32 v108, v108
    v_cvt_f32_i32 v109, v109
    v_cvt_f32_i32 v110, v110
    v_cvt_f32_i32 v111, v111
    v_fmac_f32_dpp v20, v6, v108 row_newbcast:3 row_mask:0xf bank_mask:0xf
    v_fmac_f32_dpp v21, v6, v109 row_newbcast:3 row_mask:0xf bank_mask:0xf
    v_fmac_f32_dpp v22, v6, v110 row_newbcast:3 row_mask:0xf bank_mask:0xf
    v_fmac_f32_dpp v23, v6, v111 row_newbcast:3 row_mask:0xf bank_mask:0xf
    s_waitcnt vmcnt(6)
    v_cvt_f32_i32 v112, v112
    v_cvt_f32_i32 v113, v113
    v_cvt_f32_i32 v114, v114
    v_cvt_f32_i32 v115, v115
    v_fmac_f32_dpp v12, v6, v112 row_newbcast:4 row_mask:0xf bank_mask:0xf
    v_fmac_f32_dpp v13, v6, v113 row_newbcast:4 row_mask:0xf bank_mask:0xf
    v_fmac_f32_dpp v14, v6, v114 row_newbcast:4 row_mask:0xf bank_mask:0xf
    v_fmac_f32_dpp v15, v6, v115 row_newbcast:4 row_mask:0xf bank_mask:0xf
    v_cvt_f32_i32 v116, v116
    v_cvt_f32_i32 v117, v117
    v_cvt_f32_i32 v118, v118
    v_cvt_f32_i32 v119, v119
    v_fmac_f32_dpp v16, v6, v116 row_newbcast:4 row_mask:0xf bank_mask:0xf
    v_fmac_f32_dpp v17, v6, v117 row_newbcast:4 row_mask:0xf bank_mask:0xf
    v_fmac_f32_dpp v18, v6, v118 row_newbcast:4 row_mask:0xf bank_mask:0xf
    v_fmac_f32_dpp v19, v6, v119 row_newbcast:4 row_mask:0xf bank_mask:0xf
    v_cvt_f32_i32 v120, v120
    v_cvt_f32_i32 v121, v121
    v_cvt_f32_i32 v122, v122
    v_cvt_f32_i32 v123, v123
    v_fmac_f32_dpp v20, v6, v120 row_newbcast:4 row_mask:0xf bank_mask:0xf
    v_fmac_f32_dpp v21, v6, v121 row_newbcast:4 row_mask:0xf bank_mask:0xf
    v_fmac_f32_dpp v22, v6, v122 row_newbcast:4 row_mask:0xf bank_mask:0xf
    v_fmac_f32_dpp v23, v6, v123 row_newbcast:4 row_mask:0xf bank_mask:0xf
    v_cvt_f32_i32 v124, v124
    v_cvt_f32_i32 v125, v125
    v_cvt_f32_i32 v126, v126
    v_cvt_f32_i32 v127, v127
    v_fmac_f32_dpp v12, v6, v124 row_newbcast:5 row_mask:0xf bank_mask:0xf
    v_fmac_f32_dpp v13, v6, v125 row_newbcast:5 row_mask:0xf bank_mask:0xf
    v_fmac_f32_dpp v14, v6, v126 row_newbcast:5 row_mask:0xf bank_mask:0xf
    v_fmac_f32_dpp v15, v6, v127 row_newbcast:5 row_mask:0xf bank_mask:0xf
    v_cvt_f32_i32 v128, v128
    v_cvt_f32_i32 v129, v129
    v_cvt_f32_i32 v130, v130
    v_cvt_f32_i32 v131, v131
    v_fmac_f32_dpp v16, v6, v128 row_newbcast:5 row_mask:0xf bank_mask:0xf
    v_fmac_f32_dpp v17, v6, v129 row_newbcast:5 row_mask:0xf bank_mask:0xf
    v_fmac_f32_dpp v18, v6, v130 row_newbcast:5 row_mask:0xf bank_mask:0xf
    v_fmac_f32_dpp v19, v6, v131 row_newbcast:5 row_mask:0xf bank_mask:0xf
    v_cvt_f32_i32 v132, v132
    v_cvt_f32_i32 v133, v133
    v_cvt_f32_i32 v134, v134
    v_cvt_f32_i32 v135, v135
    v_fmac_f32_dpp v20, v6, v132 row_newbcast:5 row_mask:0xf bank_mask:0xf
    v_fmac_f32_dpp v21, v6, v133 row_newbcast:5 row_mask:0xf bank_mask:0xf
    v_fmac_f32_dpp v22, v6, v134 row_newbcast:5 row_mask:0xf bank_mask:0xf
    v_fmac_f32_dpp v23, v6, v135 row_newbcast:5 row_mask:0xf bank_mask:0xf
    s_waitcnt lgkmcnt(0)
    v_mov_b32 v6, v7
    s_branch L_vchk
L_evK:
    s_nop 1
    s_bitcmp1_b64 s[64:65], s30
    s_cbranch_scc0 L_paK
    s_memrealtime s[60:61]
    s_mov_b32 s72, s59
    v_mov_b32 v11, 1
    s_mov_b64 exec, 1
    ds_add_u32 v53, v11 offset:128
    s_mov_b64 exec, -1
L_paK:
    s_nop 1
    s_bitcmp1_b64 s[66:67], s30
    s_cbranch_scc0 L_pbK
    v_mov_b32 v11, 1
    s_mov_b64 exec, 1
    ds_add_u32 v53, v11 offset:128
    s_mov_b64 exec, -1
L_pbK:
    s_nop 1
    s_bitcmp1_b64 s[68:69], s30
    s_cbranch_scc0 L_pcK
    v_mov_b32 v11, s62
    ds_read_b32 v10, v11
    s_add_u32 s62, s62, 4
    s_waitcnt lgkmcnt(0)
    v_readfirstlane_b32 s32, v10
    s_cmp_eq_u32 s32, 0
    s_cbranch_scc1 L_pcK
    s_sub_u32 s32, s60, s32
    s_max_i32 s32, s32, -4096
    s_min_i32 s32, s32, 4096
    s_mul_i32 s32, s32, 8
    s_add_u32 s32, s32, 512
    s_ashr_i32 s32, s32, 10
    s_sub_u32 s32, s32, s72
    s_add_u32 s32, s32, s59
    s_max_i32 s32, s32, 0
    s_min_i32 s59, s32, 6
L_pcK:
    s_nop 1
    s_bitcmp1_b64 s[70:71], s30
    s_cbranch_scc0 L_evretK
    s_and_b32 s32, s30, 15
    s_cbranch_scc0 L_evK2
    s_cmp_eq_u32 s30, 4
    s_cbranch_scc1 L_evK2
    s_lshr_b32 s33, s30, 2
    s_andn2_b32 s33, s33, 3
    s_add_u32 s33, s33, 36
    s_cmp_eq_u32 s32, 1
    s_cselect_b32 s32, s33, 60
    s_cselect_b32 s33, 5376, 0
    v_add_u32 v4, s33, v4
    s_cmp_eq_u32 s30, 3
    s_cselect_b32 s32, 56, s32
    v_mov_b32 v10, s32
    v_mov_b32 v11, 1
    s_mov_b64 exec, 1
    ds_add_u32 v10, v11 offset:0
    s_mov_b64 exec, -1
    s_branch L_evretK
L_evK2:
    s_nop 1
    s_lshr_b32 s33, s30, 4
    s_lshl_b32 s34, s33, 2
    v_mov_b32 v11, s34
    s_lshl_b32 s31, s33, 5
    s_add_u32 s31, s31, s3
    s_mul_i32 s31, s31, 171
    s_lshr_b32 s31, s31, 9
    s_mul_i32 s31, s31, 384
    buffer_load_dwordx2 v[36:37], v3, s[20:23], s31 offen offset:0
    buffer_load_dwordx2 v[38:39], v3, s[20:23], s31 offen offset:128
    buffer_load_dwordx2 v[40:41], v3, s[20:23], s31 offen offset:256
    s_mov_b32 s6, 0x100000
L_wtk:
    s_nop 1
    ds_read_b32 v10, v11 offset:0
    s_sub_u32 s6, s6, 1
    s_cbranch_scc1 L_exit1
    s_waitcnt lgkmcnt(0)
    v_readfirstlane_b32 s32, v10
    s_cmp_eq_u32 s32, 0
    s_cbranch_scc1 L_wtk
    s_and_b32 s5, s32, 7
    s_xor_b32 s5, s5, s48
    s_bitcmp1_b32 s32, 3
    s_cselect_b64 vcc, -1, 0
    v_cndmask_b32 v50, v62, v63, vcc
    s_branch L_evretK
L_evV:
    s_nop 1
    s_bitcmp1_b64 s[64:65], s30
    s_cbranch_scc0 L_paV
    s_memrealtime s[60:61]
    s_mov_b32 s72, s59
    v_mov_b32 v11, 1
    s_mov_b64 exec, 1
    ds_add_u32 v53, v11 offset:128
    s_mov_b64 exec, -1
L_paV:
    s_nop 1
    s_bitcmp1_b64 s[66:67], s30
    s_cbranch_scc0 L_pbV
    v_mov_b32 v11, 1
    s_mov_b64 exec, 1
    ds_add_u32 v53, v11 offset:128
    s_mov_b64 exec, -1
L_pbV:
    s_nop 1
    s_bitcmp1_b64 s[68:69], s30
    s_cbranch_scc0 L_pcV
    v_mov_b32 v11, s62
    ds_read_b32 v10, v11
    s_add_u32 s62, s62, 4
    s_waitcnt lgkmcnt(0)
    v_readfirstlane_b32 s32, v10
    s_cmp_eq_u32 s32, 0
    s_cbranch_scc1 L_pcV
    s_sub_u32 s32, s60, s32
    s_max_i32 s32, s32, -4096
    s_min_i32 s32, s32, 4096
    s_cmp_eq_u32 s30, 40
    s_cbranch_scc0 L_pd
    s_mul_i32 s32, s32, 12
    s_add_u32 s32, s32, 3584
    s_ashr_i32 s32, s32, 10
    s_max_i32 s32, s32, 0
    s_min_i32 s32, s32, 8
    s_sub_u32 s49, 48, s32
    s_cmp_eq_u32 s49, 48
    s_cselect_b32 s49, 255, s49
    s_mov_b32 s59, 0
    s_branch L_pcV
L_pd:
    s_nop 1
    s_mul_i32 s32, s32, 8
    s_add_u32 s32, s32, 512
    s_ashr_i32 s32, s32, 10
    s_sub_u32 s32, s32, s72
    s_add_u32 s32, s32, s59
    s_max_i32 s32, s32, 0
    s_min_i32 s59, s32, 6
L_pcV:
    s_nop 1
    s_bitcmp1_b64 s[70:71], s30
    s_cbranch_scc0 L_evretV
    s_lshr_b32 s33, s30, 4
    s_lshl_b32 s34, s33, 2
    v_mov_b32 v11, s34
    s_mov_b32 s6, 0x100000
L_wtv2:
    s_nop 1
    ds_read_b32 v10, v11 offset:24
    s_sub_u32 s6, s6, 1
    s_cbranch_scc1 L_exit1
    s_waitcnt lgkmcnt(0)
    v_readfirstlane_b32 s32, v10
    s_cmp_eq_u32 s32, 0
    s_cbranch_scc1 L_wtv2
    s_and_b32 s5, s32, 7
    s_xor_b32 s5, s5, s48
    s_bitcmp1_b32 s32, 3
    s_cselect_b64 vcc, -1, 0
    v_cndmask_b32 v50, v62, v63, vcc
    s_branch L_evretV
L_evKB:
    s_nop 1
    s_bitcmp1_b64 s[64:65], s30
    s_cbranch_scc0 L_paKB
    s_memrealtime s[60:61]
    s_mov_b32 s72, s59
    v_mov_b32 v11, 1
    s_mov_b64 exec, 1
    ds_add_u32 v53, v11 offset:128
    s_mov_b64 exec, -1
L_paKB:
    s_nop 1
    s_bitcmp1_b64 s[66:67], s30
    s_cbranch_scc0 L_pbKB
    v_mov_b32 v11, 1
    s_mov_b64 exec, 1
    ds_add_u32 v53, v11 offset:128
    s_mov_b64 exec, -1
L_pbKB:
    s_nop 1
    s_bitcmp1_b64 s[68:69], s30
    s_cbranch_scc0 L_pcKB
    v_mov_b32 v11, s62
    ds_read_b32 v10, v11
    s_add_u32 s62, s62, 4
    s_waitcnt lgkmcnt(0)
    v_readfirstlane_b32 s32, v10
    s_cmp_eq_u32 s32, 0
    s_cbranch_scc1 L_pcKB
    s_sub_u32 s32, s60, s32
    s_max_i32 s32, s32, -4096
    s_min_i32 s32, s32, 4096
    s_mul_i32 s32, s32, 8
    s_add_u32 s32, s32, 512
    s_ashr_i32 s32, s32, 10
    s_sub_u32 s32, s32, s72
    s_add_u32 s32, s32, s59
    s_max_i32 s32, s32, 0
    s_min_i32 s59, s32, 6
L_pcKB:
    s_nop 1
    s_bitcmp1_b64 s[70:71], s30
    s_cbranch_scc0 L_evretKB
    s_and_b32 s32, s30, 15
    s_cbranch_scc0 L_evK2B
    s_cmp_eq_u32 s30, 4
    s_cbranch_scc1 L_evK2B
    s_lshr_b32 s33, s30, 2
    s_andn2_b32 s33, s33, 3
    s_add_u32 s33, s33, 36
    s_cmp_eq_u32 s32, 1
    s_cselect_b32 s32, s33, 60
    s_cselect_b32 s33, 5376, 0
    v_add_u32 v4, s33, v4
    s_cmp_eq_u32 s30, 3
    s_cselect_b32 s32, 56, s32
    v_mov_b32 v10, s32
    v_mov_b32 v11, 1
    s_mov_b64 exec, 1
    ds_add_u32 v10, v11 offset:0
    s_mov_b64 exec, -1
    s_branch L_evretKB
L_evK2B:
    s_nop 1
    s_lshr_b32 s33, s30, 4
    s_lshl_b32 s34, s33, 2
    v_mov_b32 v11, s34
    s_lshl_b32 s31, s33, 5
    s_add_u32 s31, s31, s3
    s_mul_i32 s31, s31, 171
    s_lshr_b32 s31, s31, 9
    s_mul_i32 s31, s31, 384
    buffer_load_dwordx2 v[36:37], v3, s[20:23], s31 offen offset:0
    buffer_load_dwordx2 v[38:39], v3, s[20:23], s31 offen offset:128
    buffer_load_dwordx2 v[40:41], v3, s[20:23], s31 offen offset:256
    s_mov_b32 s6, 0x100000
L_wtkB:
    s_nop 1
    ds_read_b32 v10, v11 offset:0
    s_sub_u32 s6, s6, 1
    s_cbranch_scc1 L_exit1
    s_waitcnt lgkmcnt(0)
    v_readfirstlane_b32 s32, v10
    s_cmp_eq_u32 s32, 0
    s_cbranch_scc1 L_wtkB
    s_and_b32 s5, s32, 7
    s_xor_b32 s5, s5, s48
    s_bitcmp1_b32 s32, 3
    s_cselect_b64 vcc, -1, 0
    v_cndmask_b32 v50, v62, v63, vcc
    s_branch L_evretKB
L_evVB:
    s_nop 1
    s_bitcmp1_b64 s[64:65], s30
    s_cbranch_scc0 L_paVB
    s_memrealtime s[60:61]
    s_mov_b32 s72, s59
    v_mov_b32 v11, 1
    s_mov_b64 exec, 1
    ds_add_u32 v53, v11 offset:128
    s_mov_b64 exec, -1
L_paVB:
    s_nop 1
    s_bitcmp1_b64 s[66:67], s30
    s_cbranch_scc0 L_pbVB
    v_mov_b32 v11, 1
    s_mov_b64 exec, 1
    ds_add_u32 v53, v11 offset:128
    s_mov_b64 exec, -1
L_pbVB:
    s_nop 1
    s_bitcmp1_b64 s[68:69], s30
    s_cbranch_scc0 L_pcVB
    v_mov_b32 v11, s62
    ds_read_b32 v10, v11
    s_add_u32 s62, s62, 4
    s_waitcnt lgkmcnt(0)
    v_readfirstlane_b32 s32, v10
    s_cmp_eq_u32 s32, 0
    s_cbranch_scc1 L_pcVB
    s_sub_u32 s32, s60, s32
    s_max_i32 s32, s32, -4096
    s_min_i32 s32, s32, 4096
    s_cmp_eq_u32 s30, 40
    s_cbranch_scc0 L_pdB
    s_mul_i32 s32, s32, 12
    s_add_u32 s32, s32, 3584
    s_ashr_i32 s32, s32, 10
    s_max_i32 s32, s32, 0
    s_min_i32 s32, s32, 8
    s_sub_u32 s49, 48, s32
    s_cmp_eq_u32 s49, 48
    s_cselect_b32 s49, 255, s49
    s_mov_b32 s59, 0
    s_branch L_pcVB
L_pdB:
    s_nop 1
    s_mul_i32 s32, s32, 8
    s_add_u32 s32, s32, 512
    s_ashr_i32 s32, s32, 10
    s_sub_u32 s32, s32, s72
    s_add_u32 s32, s32, s59
    s_max_i32 s32, s32, 0
    s_min_i32 s59, s32, 6
L_pcVB:
    s_nop 1
    s_bitcmp1_b64 s[70:71], s30
    s_cbranch_scc0 L_evretVB
    s_lshr_b32 s33, s30, 4
    s_lshl_b32 s34, s33, 2
    v_mov_b32 v11, s34
    s_mov_b32 s6, 0x100000
L_wtv2B:
    s_nop 1
    ds_read_b32 v10, v11 offset:24
    s_sub_u32 s6, s6, 1
    s_cbranch_scc1 L_exit1
    s_waitcnt lgkmcnt(0)
    v_readfirstlane_b32 s32, v10
    s_cmp_eq_u32 s32, 0
    s_cbranch_scc1 L_wtv2B
    s_and_b32 s5, s32, 7
    s_xor_b32 s5, s5, s48
    s_bitcmp1_b32 s32, 3
    s_cselect_b64 vcc, -1, 0
    v_cndmask_b32 v50, v62, v63, vcc
    s_branch L_evretVB
L_helper:
    s_nop 1
    s_sub_u32 s6, s28, 4
    s_mov_b32 s5, s48
    v_mov_b32 v1, v11
    v_mov_b32 v2, 0
    s_mul_i32 s59, s3, 34816
    s_add_u32 s59, s59, 8388608
    s_cmp_eq_u32 s6, 3
    s_cbranch_scc1 L_h3
    s_mul_i32 s48, s6, 10
    s_sub_u32 s48, s48, 7
    s_cmp_lt_i32 s3, s48
    s_cselect_b32 s90, 1, 0
    s_cbranch_scc0 L_noprobe1
    s_max_u32 s7, s3, 1
    s_sub_u32 s7, s7, 1
    s_lshr_b32 s7, s7, 1
    s_lshl_b32 s49, s3, 1
    s_add_u32 s49, s49, s6
    s_sub_u32 s49, s49, 1
    s_bitcmp1_b32 s3, 0
    s_cselect_b32 s48, 1, 4
    s_cmp_eq_u32 s7, 0
    s_cselect_b32 s49, s49, s48
    s_and_b32 s48, s49, 1
    s_mul_i32 s20, s49, 20
    s_add_u32 s20, s20, s48
    s_add_u32 s20, s20, 2
    s_lshl_b32 s20, s20, 21
    s_xor_b32 s21, s4, s6
    s_and_b32 s21, s21, 1
    s_lshr_b32 s49, s4, 2
    s_xor_b32 s48, s48, s49
    s_xor_b32 s48, s48, s21
    s_lshl_b32 s48, s48, 13
    s_lshl_b32 s49, s6, 14
    s_and_b32 s49, s49, 0x4000
    s_or_b32 s48, s48, s49
    s_xor_b32 s32, s48, 0x0
    s_xor_b32 s33, s48, 0x2000
    s_xor_b32 s34, s48, 0x1000
    s_xor_b32 s35, s48, 0x3000
    s_xor_b32 s36, s48, 0x4000
    s_xor_b32 s37, s48, 0x6000
    s_xor_b32 s38, s48, 0x5000
    s_xor_b32 s39, s48, 0x7000
    v_and_b32 v3, 7, v1
    v_lshlrev_b32 v3, 12, v3
    s_lshl_b32 s48, s4, 8
    v_add_u32 v3, s48, v3
    s_mov_b32 s10, 805306368
    s_mov_b32 s11, 0x00020000
    s_cmp_ge_u32 s7, 3
    s_cselect_b32 s48, 3, 0
    s_sub_u32 s48, s7, s48
    s_lshl_b32 s48, s48, 28
    s_add_u32 s20, s20, s48
    s_cmp_ge_u32 s7, 3
    s_waitcnt lgkmcnt(0)
    s_cselect_b32 s8, s68, s66
    s_cselect_b32 s23, s69, s67
    s_and_b32 s9, s23, 0xffff
    s_mov_b64 exec, 0xff
    buffer_load_dword v4, v3, s[8:11], s20 offen
    s_mov_b64 exec, -1
    s_add_u32 s22, s8, s20
    s_addc_u32 s23, s23, 0
    s_lshl_b32 s48, s4, 8
    s_add_u32 s48, s48, 128
    s_load_dword s45, s[22:23], s48
L_noprobe1:
    s_nop 1
    s_waitcnt lgkmcnt(0)
    s_mov_b32 s12, s82
    s_and_b32 s13, s83, 0xffff
    s_mov_b32 s14, 10485760
    s_mov_b32 s15, 0x00020000
    s_mov_b32 s16, s80
    s_and_b32 s17, s81, 0xffff
    s_mov_b32 s18, 256
    s_mov_b32 s19, 0x00020000
    s_cmp_lg_u32 s6, 0
    s_cbranch_scc1 L_hbar
    v_lshlrev_b32 v5, 2, v1
    ds_write_b32 v5, v2
    s_waitcnt lgkmcnt(0)
L_hbar:
    s_nop 1
    s_barrier
    s_cmp_eq_u32 s90, 0
    s_cbranch_scc1 L_role
    s_mov_b32 s46, 1
    s_mov_b32 s58, 0
    s_cmp_eq_u32 s7, 0
    s_cselect_b32 s47, 1, 3
    s_waitcnt vmcnt(0)
L_round:
    s_nop 1
    s_add_u32 s48, s4, s46
    s_and_b32 s48, s48, 7
    s_lshl_b32 s48, s48, 8
    s_add_u32 s56, s22, s48
    s_addc_u32 s57, s23, 0
    s_mov_b32 s44, -1
    s_memtime s[40:41]
    s_waitcnt lgkmcnt(0)
    s_load_dword s45, s[56:57], s32
    s_waitcnt lgkmcnt(0)
    s_memtime s[42:43]
    s_waitcnt lgkmcnt(0)
    s_sub_u32 s24, s42, s40
    s_load_dword s45, s[56:57], s33
    s_waitcnt lgkmcnt(0)
    s_memtime s[40:41]
    s_waitcnt lgkmcnt(0)
    s_sub_u32 s25, s40, s42
    s_load_dword s45, s[56:57], s34
    s_waitcnt lgkmcnt(0)
    s_memtime s[42:43]
    s_waitcnt lgkmcnt(0)
    s_sub_u32 s26, s42, s40
    s_load_dword s45, s[56:57], s35
    s_waitcnt lgkmcnt(0)
    s_memtime s[40:41]
    s_waitcnt lgkmcnt(0)
    s_sub_u32 s27, s40, s42
    s_load_dword s45, s[56:57], s36
    s_waitcnt lgkmcnt(0)
    s_memtime s[42:43]
    s_waitcnt lgkmcnt(0)
    s_sub_u32 s28, s42, s40
    s_load_dword s45, s[56:57], s37
    s_waitcnt lgkmcnt(0)
    s_memtime s[40:41]
    s_waitcnt lgkmcnt(0)
    s_sub_u32 s29, s40, s42
    s_load_dword s45, s[56:57], s38
    s_waitcnt lgkmcnt(0)
    s_memtime s[42:43]
    s_waitcnt lgkmcnt(0)
    s_sub_u32 s30, s42, s40
    s_load_dword s45, s[56:57], s39
    s_waitcnt lgkmcnt(0)
    s_memtime s[40:41]
    s_waitcnt lgkmcnt(0)
    s_sub_u32 s31, s40, s42
L_few:
    s_nop 1
    s_min_u32 s24, s24, 1400
    s_min_u32 s44, s44, s24
    s_min_u32 s25, s25, 1400
    s_min_u32 s44, s44, s25
    s_min_u32 s26, s26, 1400
    s_min_u32 s44, s44, s26
    s_min_u32 s27, s27, 1400
    s_min_u32 s44, s44, s27
    s_min_u32 s28, s28, 1400
    s_min_u32 s44, s44, s28
    s_min_u32 s29, s29, 1400
    s_min_u32 s44, s44, s29
    s_min_u32 s30, s30, 1400
    s_min_u32 s44, s44, s30
    s_min_u32 s31, s31, 1400
    s_min_u32 s44, s44, s31
    s_cmp_lt_u32 s44, 290
    s_cbranch_scc1 L_skip
    s_sub_u32 s58, s58, s24
    s_add_u32 s58, s58, s25
    s_sub_u32 s58, s58, s26
    s_add_u32 s58, s58, s27
    s_sub_u32 s58, s58, s28
    s_add_u32 s58, s58, s29
    s_sub_u32 s58, s58, s30
    s_add_u32 s58, s58, s31
L_skip:
    s_nop 1
    s_add_u32 s46, s46, 1
    s_cmp_le_u32 s46, s47
    s_cbranch_scc1 L_round
    s_sub_u32 s48, 0, s58
    s_cmp_eq_u32 s21, 0
    s_cselect_b32 s58, s58, s48
    s_add_u32 s58, s58, 0x1010000
    v_mov_b32 v4, s58
    s_mov_b64 exec, 1
    s_lshl_b32 s48, s7, 2
    s_add_u32 s48, s48, 124
    s_cmp_eq_u32 s7, 0
    s_cbranch_scc0 L_post
    ds_add_rtn_u32 v5, v2, v4 offset:36
    s_mov_b32 s48, 0
    s_waitcnt lgkmcnt(0)
    v_add_u32 v4, v4, v5
    v_cmp_ne_u32 vcc, 0, v5
    s_and_b64 exec, exec, vcc
    buffer_atomic_add v4, off, s[16:19], s48
    s_branch L_posted
L_post:
    s_nop 1
    s_mov_b32 s60, 0x100000
L_wvw:
    s_nop 1
    ds_read_b32 v10, v2 offset:0
    s_sub_u32 s60, s60, 1
    s_cbranch_scc1 L_exit1
    s_waitcnt lgkmcnt(0)
    v_readfirstlane_b32 s48, v10
    s_cmp_eq_u32 s48, 0
    s_cbranch_scc1 L_wvw
    s_mul_i32 s48, s3, 4352
    s_add_u32 s48, s48, 9489664
    s_nop 0
    buffer_atomic_add v4, off, s[12:15], s48
L_posted:
    s_nop 1
    s_mov_b64 exec, -1
L_role:
    s_nop 1
    s_cmp_eq_u32 s6, 0
    s_cbranch_scc1 L_h0
    s_cmp_eq_u32 s6, 2
    s_cbranch_scc1 L_h2
    s_cmp_lg_u32 s2, 255
    s_cbranch_scc1 L_nolead
    v_mul_u32_u24 v5, 4352, v1
    v_mov_b32 v3, 0
    s_mov_b32 s48, 8388608
    buffer_store_dwordx2 v[2:3], v5, s[12:15], s48 offen sc1
    s_mov_b32 s49, 8667136
    buffer_store_dwordx2 v[2:3], v5, s[12:15], s49 offen sc1
    s_mov_b32 s50, 8945664
    buffer_store_dwordx2 v[2:3], v5, s[12:15], s50 offen sc1
    s_mov_b32 s51, 9224192
    buffer_store_dwordx2 v[2:3], v5, s[12:15], s51 offen sc1
    s_mov_b32 s52, 9502720
    s_mov_b64 exec, 0x3ff
    buffer_store_dwordx2 v[2:3], v5, s[12:15], s52 offen sc1
    v_mov_b32 v4, 0x1010000
    s_mov_b64 exec, 1
    s_waitcnt vmcnt(0)
    buffer_atomic_add v4, off, s[16:19], 0
    s_mov_b64 exec, -1
L_nolead:
    s_nop 1
    v_lshlrev_b32 v5, 2, v1
    s_mov_b32 s60, 0x100000
L_wea:
    s_nop 1
    ds_read_b32 v10, v2 offset:56
    s_sub_u32 s60, s60, 1
    s_cbranch_scc1 L_exit1
    s_waitcnt lgkmcnt(0)
    v_readfirstlane_b32 s48, v10
    s_cmp_lt_u32 s48, 1
    s_cbranch_scc1 L_wea
    s_mov_b64 exec, 0x1
    s_mov_b32 s60, 0x40000
L_polla:
    s_nop 1
    buffer_load_dword v4, v5, s[16:19], 0 offen offset:0 sc1
    s_sub_u32 s60, s60, 1
    s_cbranch_scc1 L_exit1
    s_waitcnt vmcnt(0)
    v_lshrrev_b32 v6, 24, v4
    v_cmp_ne_u32 vcc, 49, v6
    s_cbranch_vccnz L_polla
    v_and_b32 v4, 0xffffff, v4
    v_subrev_u32 v4, 3211264, v4
    v_lshrrev_b32 v6, 30, v4
    v_and_b32 v6, 2, v6
    v_add_u32 v4, 9800, v4
    v_cmp_gt_u32 vcc, 19600, v4
    s_nop 1
    v_cndmask_b32 v6, v6, 8, vcc
    v_or_b32 v6, 16, v6
    ds_write_b32 v5, v6 offset:0
    s_mov_b64 exec, -1
    s_mov_b32 s60, 0x100000
L_web:
    s_nop 1
    ds_read_b32 v10, v2 offset:60
    s_sub_u32 s60, s60, 1
    s_cbranch_scc1 L_exit1
    s_waitcnt lgkmcnt(0)
    v_readfirstlane_b32 s48, v10
    s_cmp_eq_u32 s48, 0
    s_cbranch_scc1 L_web
    v_mul_u32_u24 v7, 4352, v1
    s_mov_b32 s48, 9502720
    v_lshrrev_b32 v5, 1, v5
    s_mov_b64 exec, 0x3ff
    s_mov_b32 s60, 0x40000
L_pollb:
    s_nop 1
    buffer_load_dword v4, v7, s[12:15], s48 offen sc1
    s_sub_u32 s60, s60, 1
    s_cbranch_scc1 L_exit1
    s_waitcnt vmcnt(0)
    v_lshrrev_b32 v6, 24, v4
    v_cmp_ne_u32 vcc, 8, v6
    s_cbranch_vccnz L_pollb
    v_add_u32_dpp v4, v4, v4 quad_perm:[1,0,3,2] row_mask:0xf bank_mask:0xf
    s_mov_b64 exec, 0x155
    v_and_b32 v4, 0xffffff, v4
    v_subrev_u32 v4, 1048576, v4
    v_lshrrev_b32 v6, 30, v4
    v_and_b32 v6, 2, v6
    v_add_u32 v4, 9600, v4
    v_cmp_gt_u32 vcc, 19200, v4
    s_nop 1
    v_cndmask_b32 v6, v6, 8, vcc
    v_or_b32 v6, 16, v6
    ds_write_b32 v5, v6 offset:4
    s_mov_b64 exec, -1
    s_and_b32 s48, s3, 7
    s_cmp_lg_u32 s48, s4
    s_cbranch_scc1 L_exit1
    s_mul_i32 s48, s3, 3
    s_add_u32 s48, s48, 2
    s_lshr_b32 s48, s48, 5
    s_lshl_b32 s48, s48, 2
    v_mov_b32 v3, s48
    s_mul_i32 s57, s3, 24
    v_add_u32 v13, s57, v1
    v_and_b32 v12, 255, v13
    v_mul_u32_u24 v12, 4352, v12
    v_lshlrev_b32 v13, 6, v13
    s_mov_b32 s49, 8388608
    s_mov_b32 s50, 917504
    v_mov_b32 v4, 0xf149f2ca
    v_mov_b32 v5, 0
    s_mov_b32 s60, 0x100000
L_wcg:
    s_nop 1
    ds_read_b32 v10, v3 offset:24
    s_sub_u32 s60, s60, 1
    s_cbranch_scc1 L_exit1
    s_waitcnt lgkmcnt(0)
    v_readfirstlane_b32 s48, v10
    s_cmp_eq_u32 s48, 0
    s_cbranch_scc1 L_wcg
    s_mov_b64 exec, 0xffffff
    s_mov_b32 s60, 0x40000
L_cpf:
    s_nop 1
    buffer_load_dword v7, v12, s[12:15], s49 offen sc1
    s_sub_u32 s60, s60, 1
    s_cbranch_scc1 L_exit1
    s_waitcnt vmcnt(0)
    v_cmpx_eq_u32 vcc, 0, v7
    s_cbranch_execnz L_cpf
    s_mov_b64 exec, 0xffffff
    s_mov_b32 s60, 0x40000
L_cpm:
    s_nop 1
    buffer_load_dwordx4 v[4:7], v13, s[12:15], s50 offen sc1
    s_sub_u32 s60, s60, 1
    s_cbranch_scc1 L_exit1
    s_waitcnt vmcnt(0)
    v_cmpx_eq_u32 vcc, 0, v7
    s_cbranch_execnz L_cpm
    s_mov_b64 exec, -1
    v_mov_b32 v6, v4
    s_nop 1
    v_max_f32_dpp v6, v6, v6 row_ror:8 row_mask:0xf bank_mask:0xf
    s_nop 1
    v_max_f32_dpp v6, v6, v6 row_ror:4 row_mask:0xf bank_mask:0xf
    s_nop 1
    v_max_f32_dpp v6, v6, v6 row_ror:2 row_mask:0xf bank_mask:0xf
    s_nop 1
    v_max_f32_dpp v6, v6, v6 row_ror:1 row_mask:0xf bank_mask:0xf
    v_mov_b32 v7, v6
    s_nop 1
    v_permlane32_swap_b32 v6, v7
    v_max_f32 v6, v6, v7
    v_mov_b32 v7, v6
    s_nop 1
    v_permlane16_swap_b32 v6, v7
    v_max_f32 v6, v6, v7
    v_sub_f32 v4, v4, v6
    v_exp_f32 v4, v4
    s_nop 0
    v_mul_f32 v5, v5, v4
    s_nop 1
    v_add_f32_dpp v5, v5, v5 row_ror:8 row_mask:0xf bank_mask:0xf
    s_nop 1
    v_add_f32_dpp v5, v5, v5 row_ror:4 row_mask:0xf bank_mask:0xf
    s_nop 1
    v_add_f32_dpp v5, v5, v5 row_ror:2 row_mask:0xf bank_mask:0xf
    s_nop 1
    v_add_f32_dpp v5, v5, v5 row_ror:1 row_mask:0xf bank_mask:0xf
    v_mov_b32 v7, v5
    s_nop 1
    v_permlane32_swap_b32 v5, v7
    v_add_f32 v5, v5, v7
    v_mov_b32 v7, v5
    s_nop 1
    v_permlane16_swap_b32 v5, v7
    v_add_f32 v5, v5, v7
    v_rcp_f32 v5, v5
    s_nop 0
    v_mul_f32 v4, v4, v5
    s_nop 0
    v_readlane_b32 s24, v4, 0
    v_readlane_b32 s25, v4, 1
    v_readlane_b32 s26, v4, 2
    v_readlane_b32 s27, v4, 3
    v_readlane_b32 s28, v4, 4
    v_readlane_b32 s29, v4, 5
    v_readlane_b32 s30, v4, 6
    v_readlane_b32 s31, v4, 7
    v_readlane_b32 s32, v4, 8
    v_readlane_b32 s33, v4, 9
    v_readlane_b32 s34, v4, 10
    v_readlane_b32 s35, v4, 11
    v_readlane_b32 s36, v4, 12
    v_readlane_b32 s37, v4, 13
    v_readlane_b32 s38, v4, 14
    v_readlane_b32 s39, v4, 15
    v_readlane_b32 s40, v4, 16
    v_readlane_b32 s41, v4, 17
    v_readlane_b32 s42, v4, 18
    v_readlane_b32 s43, v4, 19
    v_readlane_b32 s44, v4, 20
    v_readlane_b32 s45, v4, 21
    v_readlane_b32 s46, v4, 22
    v_readlane_b32 s47, v4, 23
    s_mov_b32 s92, s78
    s_and_b32 s93, s79, 0xffff
    s_mov_b32 s94, 12288
    s_mov_b32 s95, 0x00020000
    s_lshl_b32 s57, s57, 10
    v_lshlrev_b32 v13, 4, v1
    v_add_u32 v13, s57, v13
    s_mov_b32 s49, 4096
    s_mov_b32 s50, 8192
    s_mov_b32 s51, 12288
    s_mov_b32 s52, 16384
    s_mov_b32 s53, 20480
    v_mov_b32 v4, 0
    v_mov_b32 v5, 0
    v_mov_b32 v6, 0
    s_mov_b32 s56, 0xffffff
    v_lshlrev_b32 v12, 1, v1
    s_mul_i32 s57, s3, 384
    s_mov_b32 s60, 0x100000
L_wcc:
    s_nop 1
    ds_read_b32 v10, v3 offset:64
    s_sub_u32 s60, s60, 1
    s_cbranch_scc1 L_exit1
    s_waitcnt lgkmcnt(0)
    v_readfirstlane_b32 s48, v10
    s_cmp_lt_u32 s48, 1
    s_cbranch_scc1 L_wcc
    s_mov_b32 s60, 0x40000
L_cr:
    s_nop 1
    s_bitcmp0_b32 s56, 0
    s_cbranch_scc1 L_cl0
    buffer_load_dwordx4 v[16:19], v13, s[12:15], 0 offen offset:0 sc1
L_cl0:
    s_bitcmp0_b32 s56, 1
    s_cbranch_scc1 L_cl1
    buffer_load_dwordx4 v[20:23], v13, s[12:15], 0 offen offset:1024 sc1
L_cl1:
    s_bitcmp0_b32 s56, 2
    s_cbranch_scc1 L_cl2
    buffer_load_dwordx4 v[24:27], v13, s[12:15], 0 offen offset:2048 sc1
L_cl2:
    s_bitcmp0_b32 s56, 3
    s_cbranch_scc1 L_cl3
    buffer_load_dwordx4 v[28:31], v13, s[12:15], 0 offen offset:3072 sc1
L_cl3:
    s_bitcmp0_b32 s56, 4
    s_cbranch_scc1 L_cl4
    buffer_load_dwordx4 v[32:35], v13, s[12:15], s49 offen offset:0 sc1
L_cl4:
    s_bitcmp0_b32 s56, 5
    s_cbranch_scc1 L_cl5
    buffer_load_dwordx4 v[36:39], v13, s[12:15], s49 offen offset:1024 sc1
L_cl5:
    s_bitcmp0_b32 s56, 6
    s_cbranch_scc1 L_cl6
    buffer_load_dwordx4 v[40:43], v13, s[12:15], s49 offen offset:2048 sc1
L_cl6:
    s_bitcmp0_b32 s56, 7
    s_cbranch_scc1 L_cl7
    buffer_load_dwordx4 v[44:47], v13, s[12:15], s49 offen offset:3072 sc1
L_cl7:
    s_bitcmp0_b32 s56, 8
    s_cbranch_scc1 L_cl8
    buffer_load_dwordx4 v[48:51], v13, s[12:15], s50 offen offset:0 sc1
L_cl8:
    s_bitcmp0_b32 s56, 9
    s_cbranch_scc1 L_cl9
    buffer_load_dwordx4 v[52:55], v13, s[12:15], s50 offen offset:1024 sc1
L_cl9:
    s_bitcmp0_b32 s56, 10
    s_cbranch_scc1 L_cl10
    buffer_load_dwordx4 v[56:59], v13, s[12:15], s50 offen offset:2048 sc1
L_cl10:
    s_bitcmp0_b32 s56, 11
    s_cbranch_scc1 L_cl11
    buffer_load_dwordx4 v[60:63], v13, s[12:15], s50 offen offset:3072 sc1
L_cl11:
    s_bitcmp0_b32 s56, 12
    s_cbranch_scc1 L_cl12
    buffer_load_dwordx4 v[64:67], v13, s[12:15], s51 offen offset:0 sc1
L_cl12:
    s_bitcmp0_b32 s56, 13
    s_cbranch_scc1 L_cl13
    buffer_load_dwordx4 v[68:71], v13, s[12:15], s51 offen offset:1024 sc1
L_cl13:
    s_bitcmp0_b32 s56, 14
    s_cbranch_scc1 L_cl14
    buffer_load_dwordx4 v[72:75], v13, s[12:15], s51 offen offset:2048 sc1
L_cl14:
    s_bitcmp0_b32 s56, 15
    s_cbranch_scc1 L_cl15
    buffer_load_dwordx4 v[76:79], v13, s[12:15], s51 offen offset:3072 sc1
L_cl15:
    s_bitcmp0_b32 s56, 16
    s_cbranch_scc1 L_cl16
    buffer_load_dwordx4 v[80:83], v13, s[12:15], s52 offen offset:0 sc1
L_cl16:
    s_bitcmp0_b32 s56, 17
    s_cbranch_scc1 L_cl17
    buffer_load_dwordx4 v[84:87], v13, s[12:15], s52 offen offset:1024 sc1
L_cl17:
    s_bitcmp0_b32 s56, 18
    s_cbranch_scc1 L_cl18
    buffer_load_dwordx4 v[88:91], v13, s[12:15], s52 offen offset:2048 sc1
L_cl18:
    s_bitcmp0_b32 s56, 19
    s_cbranch_scc1 L_cl19
    buffer_load_dwordx4 v[92:95], v13, s[12:15], s52 offen offset:3072 sc1
L_cl19:
    s_bitcmp0_b32 s56, 20
    s_cbranch_scc1 L_cl20
    buffer_load_dwordx4 v[96:99], v13, s[12:15], s53 offen offset:0 sc1
L_cl20:
    s_bitcmp0_b32 s56, 21
    s_cbranch_scc1 L_cl21
    buffer_load_dwordx4 v[100:103], v13, s[12:15], s53 offen offset:1024 sc1
L_cl21:
    s_bitcmp0_b32 s56, 22
    s_cbranch_scc1 L_cl22
    buffer_load_dwordx4 v[104:107], v13, s[12:15], s53 offen offset:2048 sc1
L_cl22:
    s_bitcmp0_b32 s56, 23
    s_cbranch_scc1 L_cl23
    buffer_load_dwordx4 v[108:111], v13, s[12:15], s53 offen offset:3072 sc1
L_cl23:
    s_sub_u32 s60, s60, 1
    s_cbranch_scc1 L_exit1
    s_waitcnt vmcnt(0)
    s_bitcmp0_b32 s56, 0
    s_cbranch_scc1 L_cv0
    v_cmp_eq_u32 vcc, 0, v19
    s_cbranch_vccnz L_cv0
    v_fmac_f32 v4, s24, v16
    v_fmac_f32 v5, s24, v17
    v_fmac_f32 v6, s24, v18
    s_bitset0_b32 s56, 0
L_cv0:
    s_bitcmp0_b32 s56, 1
    s_cbranch_scc1 L_cv1
    v_cmp_eq_u32 vcc, 0, v23
    s_cbranch_vccnz L_cv1
    v_fmac_f32 v4, s25, v20
    v_fmac_f32 v5, s25, v21
    v_fmac_f32 v6, s25, v22
    s_bitset0_b32 s56, 1
L_cv1:
    s_bitcmp0_b32 s56, 2
    s_cbranch_scc1 L_cv2
    v_cmp_eq_u32 vcc, 0, v27
    s_cbranch_vccnz L_cv2
    v_fmac_f32 v4, s26, v24
    v_fmac_f32 v5, s26, v25
    v_fmac_f32 v6, s26, v26
    s_bitset0_b32 s56, 2
L_cv2:
    s_bitcmp0_b32 s56, 3
    s_cbranch_scc1 L_cv3
    v_cmp_eq_u32 vcc, 0, v31
    s_cbranch_vccnz L_cv3
    v_fmac_f32 v4, s27, v28
    v_fmac_f32 v5, s27, v29
    v_fmac_f32 v6, s27, v30
    s_bitset0_b32 s56, 3
L_cv3:
    s_bitcmp0_b32 s56, 4
    s_cbranch_scc1 L_cv4
    v_cmp_eq_u32 vcc, 0, v35
    s_cbranch_vccnz L_cv4
    v_fmac_f32 v4, s28, v32
    v_fmac_f32 v5, s28, v33
    v_fmac_f32 v6, s28, v34
    s_bitset0_b32 s56, 4
L_cv4:
    s_bitcmp0_b32 s56, 5
    s_cbranch_scc1 L_cv5
    v_cmp_eq_u32 vcc, 0, v39
    s_cbranch_vccnz L_cv5
    v_fmac_f32 v4, s29, v36
    v_fmac_f32 v5, s29, v37
    v_fmac_f32 v6, s29, v38
    s_bitset0_b32 s56, 5
L_cv5:
    s_bitcmp0_b32 s56, 6
    s_cbranch_scc1 L_cv6
    v_cmp_eq_u32 vcc, 0, v43
    s_cbranch_vccnz L_cv6
    v_fmac_f32 v4, s30, v40
    v_fmac_f32 v5, s30, v41
    v_fmac_f32 v6, s30, v42
    s_bitset0_b32 s56, 6
L_cv6:
    s_bitcmp0_b32 s56, 7
    s_cbranch_scc1 L_cv7
    v_cmp_eq_u32 vcc, 0, v47
    s_cbranch_vccnz L_cv7
    v_fmac_f32 v4, s31, v44
    v_fmac_f32 v5, s31, v45
    v_fmac_f32 v6, s31, v46
    s_bitset0_b32 s56, 7
L_cv7:
    s_bitcmp0_b32 s56, 8
    s_cbranch_scc1 L_cv8
    v_cmp_eq_u32 vcc, 0, v51
    s_cbranch_vccnz L_cv8
    v_fmac_f32 v4, s32, v48
    v_fmac_f32 v5, s32, v49
    v_fmac_f32 v6, s32, v50
    s_bitset0_b32 s56, 8
L_cv8:
    s_bitcmp0_b32 s56, 9
    s_cbranch_scc1 L_cv9
    v_cmp_eq_u32 vcc, 0, v55
    s_cbranch_vccnz L_cv9
    v_fmac_f32 v4, s33, v52
    v_fmac_f32 v5, s33, v53
    v_fmac_f32 v6, s33, v54
    s_bitset0_b32 s56, 9
L_cv9:
    s_bitcmp0_b32 s56, 10
    s_cbranch_scc1 L_cv10
    v_cmp_eq_u32 vcc, 0, v59
    s_cbranch_vccnz L_cv10
    v_fmac_f32 v4, s34, v56
    v_fmac_f32 v5, s34, v57
    v_fmac_f32 v6, s34, v58
    s_bitset0_b32 s56, 10
L_cv10:
    s_bitcmp0_b32 s56, 11
    s_cbranch_scc1 L_cv11
    v_cmp_eq_u32 vcc, 0, v63
    s_cbranch_vccnz L_cv11
    v_fmac_f32 v4, s35, v60
    v_fmac_f32 v5, s35, v61
    v_fmac_f32 v6, s35, v62
    s_bitset0_b32 s56, 11
L_cv11:
    s_bitcmp0_b32 s56, 12
    s_cbranch_scc1 L_cv12
    v_cmp_eq_u32 vcc, 0, v67
    s_cbranch_vccnz L_cv12
    v_fmac_f32 v4, s36, v64
    v_fmac_f32 v5, s36, v65
    v_fmac_f32 v6, s36, v66
    s_bitset0_b32 s56, 12
L_cv12:
    s_bitcmp0_b32 s56, 13
    s_cbranch_scc1 L_cv13
    v_cmp_eq_u32 vcc, 0, v71
    s_cbranch_vccnz L_cv13
    v_fmac_f32 v4, s37, v68
    v_fmac_f32 v5, s37, v69
    v_fmac_f32 v6, s37, v70
    s_bitset0_b32 s56, 13
L_cv13:
    s_bitcmp0_b32 s56, 14
    s_cbranch_scc1 L_cv14
    v_cmp_eq_u32 vcc, 0, v75
    s_cbranch_vccnz L_cv14
    v_fmac_f32 v4, s38, v72
    v_fmac_f32 v5, s38, v73
    v_fmac_f32 v6, s38, v74
    s_bitset0_b32 s56, 14
L_cv14:
    s_bitcmp0_b32 s56, 15
    s_cbranch_scc1 L_cv15
    v_cmp_eq_u32 vcc, 0, v79
    s_cbranch_vccnz L_cv15
    v_fmac_f32 v4, s39, v76
    v_fmac_f32 v5, s39, v77
    v_fmac_f32 v6, s39, v78
    s_bitset0_b32 s56, 15
L_cv15:
    s_bitcmp0_b32 s56, 16
    s_cbranch_scc1 L_cv16
    v_cmp_eq_u32 vcc, 0, v83
    s_cbranch_vccnz L_cv16
    v_fmac_f32 v4, s40, v80
    v_fmac_f32 v5, s40, v81
    v_fmac_f32 v6, s40, v82
    s_bitset0_b32 s56, 16
L_cv16:
    s_bitcmp0_b32 s56, 17
    s_cbranch_scc1 L_cv17
    v_cmp_eq_u32 vcc, 0, v87
    s_cbranch_vccnz L_cv17
    v_fmac_f32 v4, s41, v84
    v_fmac_f32 v5, s41, v85
    v_fmac_f32 v6, s41, v86
    s_bitset0_b32 s56, 17
L_cv17:
    s_bitcmp0_b32 s56, 18
    s_cbranch_scc1 L_cv18
    v_cmp_eq_u32 vcc, 0, v91
    s_cbranch_vccnz L_cv18
    v_fmac_f32 v4, s42, v88
    v_fmac_f32 v5, s42, v89
    v_fmac_f32 v6, s42, v90
    s_bitset0_b32 s56, 18
L_cv18:
    s_bitcmp0_b32 s56, 19
    s_cbranch_scc1 L_cv19
    v_cmp_eq_u32 vcc, 0, v95
    s_cbranch_vccnz L_cv19
    v_fmac_f32 v4, s43, v92
    v_fmac_f32 v5, s43, v93
    v_fmac_f32 v6, s43, v94
    s_bitset0_b32 s56, 19
L_cv19:
    s_bitcmp0_b32 s56, 20
    s_cbranch_scc1 L_cv20
    v_cmp_eq_u32 vcc, 0, v99
    s_cbranch_vccnz L_cv20
    v_fmac_f32 v4, s44, v96
    v_fmac_f32 v5, s44, v97
    v_fmac_f32 v6, s44, v98
    s_bitset0_b32 s56, 20
L_cv20:
    s_bitcmp0_b32 s56, 21
    s_cbranch_scc1 L_cv21
    v_cmp_eq_u32 vcc, 0, v103
    s_cbranch_vccnz L_cv21
    v_fmac_f32 v4, s45, v100
    v_fmac_f32 v5, s45, v101
    v_fmac_f32 v6, s45, v102
    s_bitset0_b32 s56, 21
L_cv21:
    s_bitcmp0_b32 s56, 22
    s_cbranch_scc1 L_cv22
    v_cmp_eq_u32 vcc, 0, v107
    s_cbranch_vccnz L_cv22
    v_fmac_f32 v4, s46, v104
    v_fmac_f32 v5, s46, v105
    v_fmac_f32 v6, s46, v106
    s_bitset0_b32 s56, 22
L_cv22:
    s_bitcmp0_b32 s56, 23
    s_cbranch_scc1 L_cv23
    v_cmp_eq_u32 vcc, 0, v111
    s_cbranch_vccnz L_cv23
    v_fmac_f32 v4, s47, v108
    v_fmac_f32 v5, s47, v109
    v_fmac_f32 v6, s47, v110
    s_bitset0_b32 s56, 23
L_cv23:
    s_cmp_lg_u32 s56, 0
    s_cbranch_scc1 L_cr
    v_cvt_pk_bf16_f32 v4, v4, v4
    buffer_store_short v4, v12, s[92:95], s57 offen offset:0
    v_cvt_pk_bf16_f32 v5, v5, v5
    buffer_store_short v5, v12, s[92:95], s57 offen offset:128
    v_cvt_pk_bf16_f32 v6, v6, v6
    buffer_store_short v6, v12, s[92:95], s57 offen offset:256
    s_endpgm
L_h0:
    s_nop 1
    s_mov_b32 s8, s64
    s_and_b32 s9, s65, 0xffff
    s_mov_b32 s10, 12288
    s_mov_b32 s11, 0x00020000
    s_mov_b32 s92, s70
    s_and_b32 s93, s71, 0xffff
    s_mov_b32 s94, 6291456
    s_mov_b32 s95, 0x00020000
    s_mov_b32 s96, s72
    s_and_b32 s97, s73, 0xffff
    s_mov_b32 s98, 6291456
    s_mov_b32 s99, 0x00020000
    v_lshrrev_b32 v4, 4, v1
    v_and_b32 v5, 15, v1
    v_lshlrev_b32 v6, 3, v5
    v_mul_u32_u24 v7, 384, v4
    v_add_u32 v7, v7, v6
    v_lshl_add_u32 v13, v5, 2, v4
    v_lshlrev_b32 v13, 2, v13
    v_lshlrev_b32 v4, 4, v1
    s_mul_i32 s32, s5, 4352
    s_add_u32 s32, s32, s59
    s_lshl_b32 s33, s3, 3
    s_add_u32 s33, s33, s5
    s_mul_i32 s33, s33, 18432
    s_add_u32 s33, s33, 2097152
    v_mov_b32 v16, 0
    v_mov_b32 v17, 0
    v_mov_b32 v18, 0
    v_mov_b32 v19, 0
    s_add_u32 s48, s2, 0
    s_lshl_b32 s49, s48, 10
    s_lshl_b32 s48, s48, 6
    s_add_u32 s48, s48, 917504
    buffer_store_dwordx4 v[16:19], v4, s[12:15], s49 offen sc1
    s_mov_b64 exec, 15
    buffer_store_dwordx4 v[16:19], v4, s[12:15], s48 offen sc1
    s_mov_b64 exec, -1
    s_add_u32 s48, s2, 256
    s_lshl_b32 s49, s48, 10
    s_lshl_b32 s48, s48, 6
    s_add_u32 s48, s48, 917504
    buffer_store_dwordx4 v[16:19], v4, s[12:15], s49 offen sc1
    s_mov_b64 exec, 15
    buffer_store_dwordx4 v[16:19], v4, s[12:15], s48 offen sc1
    s_mov_b64 exec, -1
    s_add_u32 s48, s2, 512
    s_lshl_b32 s49, s48, 10
    s_lshl_b32 s48, s48, 6
    s_add_u32 s48, s48, 917504
    buffer_store_dwordx4 v[16:19], v4, s[12:15], s49 offen sc1
    s_mov_b64 exec, 15
    buffer_store_dwordx4 v[16:19], v4, s[12:15], s48 offen sc1
    s_mov_b64 exec, -1
    s_mov_b32 s61, 0
    s_lshl_b32 s62, s61, 5
    s_add_u32 s62, s62, s3
    s_lshl_b32 s63, s62, 15
    s_add_u32 s63, s63, 1
    s_mul_hi_u32 s63, s63, 0xaaaaaaab
    s_lshr_b32 s63, s63, 7
    s_mul_i32 s48, s62, 171
    s_lshr_b32 s48, s48, 9
    s_mul_i32 s48, s48, 384
    s_mul_i32 s49, s4, 24
    s_add_u32 s50, s49, s63
    s_mul_i32 s50, s50, 384
    v_add_u32 v10, s50, v7
    v_add_u32 v11, 3072, v10
    v_add_u32 v12, 6144, v10
    buffer_load_dwordx2 v[100:101], v6, s[8:11], s48 offen offset:0
    buffer_load_dwordx2 v[102:103], v6, s[8:11], s48 offen offset:128
    buffer_load_dwordx2 v[104:105], v6, s[8:11], s48 offen offset:256
    buffer_load_dwordx2 v[28:29], v10, s[92:95], 0 offen offset:0
    buffer_load_dwordx2 v[30:31], v10, s[92:95], 0 offen offset:128
    buffer_load_dwordx2 v[32:33], v10, s[92:95], 0 offen offset:256
    buffer_load_dwordx2 v[64:65], v10, s[96:99], 0 offen offset:0
    buffer_load_dwordx2 v[66:67], v10, s[96:99], 0 offen offset:128
    buffer_load_dwordx2 v[68:69], v10, s[96:99], 0 offen offset:256
    buffer_load_dwordx2 v[34:35], v10, s[92:95], 0 offen offset:1536
    buffer_load_dwordx2 v[36:37], v10, s[92:95], 0 offen offset:1664
    buffer_load_dwordx2 v[38:39], v10, s[92:95], 0 offen offset:1792
    buffer_load_dwordx2 v[70:71], v10, s[96:99], 0 offen offset:1536
    buffer_load_dwordx2 v[72:73], v10, s[96:99], 0 offen offset:1664
    buffer_load_dwordx2 v[74:75], v10, s[96:99], 0 offen offset:1792
    buffer_load_dwordx2 v[40:41], v11, s[92:95], 0 offen offset:0
    buffer_load_dwordx2 v[42:43], v11, s[92:95], 0 offen offset:128
    buffer_load_dwordx2 v[44:45], v11, s[92:95], 0 offen offset:256
    buffer_load_dwordx2 v[76:77], v11, s[96:99], 0 offen offset:0
    buffer_load_dwordx2 v[78:79], v11, s[96:99], 0 offen offset:128
    buffer_load_dwordx2 v[80:81], v11, s[96:99], 0 offen offset:256
    buffer_load_dwordx2 v[46:47], v11, s[92:95], 0 offen offset:1536
    buffer_load_dwordx2 v[48:49], v11, s[92:95], 0 offen offset:1664
    buffer_load_dwordx2 v[50:51], v11, s[92:95], 0 offen offset:1792
    buffer_load_dwordx2 v[82:83], v11, s[96:99], 0 offen offset:1536
    buffer_load_dwordx2 v[84:85], v11, s[96:99], 0 offen offset:1664
    buffer_load_dwordx2 v[86:87], v11, s[96:99], 0 offen offset:1792
    buffer_load_dwordx2 v[52:53], v12, s[92:95], 0 offen offset:0
    buffer_load_dwordx2 v[54:55], v12, s[92:95], 0 offen offset:128
    buffer_load_dwordx2 v[56:57], v12, s[92:95], 0 offen offset:256
    buffer_load_dwordx2 v[88:89], v12, s[96:99], 0 offen offset:0
    buffer_load_dwordx2 v[90:91], v12, s[96:99], 0 offen offset:128
    buffer_load_dwordx2 v[92:93], v12, s[96:99], 0 offen offset:256
    buffer_load_dwordx2 v[58:59], v12, s[92:95], 0 offen offset:1536
    buffer_load_dwordx2 v[60:61], v12, s[92:95], 0 offen offset:1664
    buffer_load_dwordx2 v[62:63], v12, s[92:95], 0 offen offset:1792
    buffer_load_dwordx2 v[94:95], v12, s[96:99], 0 offen offset:1536
    buffer_load_dwordx2 v[96:97], v12, s[96:99], 0 offen offset:1664
    buffer_load_dwordx2 v[98:99], v12, s[96:99], 0 offen offset:1792
    s_waitcnt vmcnt(0)
    v_lshlrev_b32 v16, 16, v100
    v_and_b32 v17, 0xffff0000, v100
    v_lshlrev_b32 v18, 16, v101
    v_and_b32 v19, 0xffff0000, v101
    v_lshlrev_b32 v20, 16, v102
    v_and_b32 v21, 0xffff0000, v102
    v_lshlrev_b32 v22, 16, v103
    v_and_b32 v23, 0xffff0000, v103
    v_lshlrev_b32 v24, 16, v104
    v_and_b32 v25, 0xffff0000, v104
    v_lshlrev_b32 v26, 16, v105
    v_and_b32 v27, 0xffff0000, v105
    v_lshlrev_b32 v10, 16, v28
    v_lshlrev_b32 v11, 16, v64
    v_and_b32 v28, 0xffff0000, v28
    v_and_b32 v64, 0xffff0000, v64
    v_mul_f32 v10, v10, v16
    v_mul_f32 v28, v28, v17
    v_mul_f32 v100, v10, v11
    v_fmac_f32 v100, v28, v64
    v_lshlrev_b32 v10, 16, v29
    v_lshlrev_b32 v11, 16, v65
    v_and_b32 v29, 0xffff0000, v29
    v_and_b32 v65, 0xffff0000, v65
    v_mul_f32 v10, v10, v18
    v_mul_f32 v29, v29, v19
    v_fmac_f32 v100, v10, v11
    v_fmac_f32 v100, v29, v65
    v_lshlrev_b32 v10, 16, v30
    v_lshlrev_b32 v11, 16, v66
    v_and_b32 v30, 0xffff0000, v30
    v_and_b32 v66, 0xffff0000, v66
    v_mul_f32 v10, v10, v20
    v_mul_f32 v30, v30, v21
    v_fmac_f32 v100, v10, v11
    v_fmac_f32 v100, v30, v66
    v_lshlrev_b32 v10, 16, v31
    v_lshlrev_b32 v11, 16, v67
    v_and_b32 v31, 0xffff0000, v31
    v_and_b32 v67, 0xffff0000, v67
    v_mul_f32 v10, v10, v22
    v_mul_f32 v31, v31, v23
    v_fmac_f32 v100, v10, v11
    v_fmac_f32 v100, v31, v67
    v_lshlrev_b32 v10, 16, v32
    v_lshlrev_b32 v11, 16, v68
    v_and_b32 v32, 0xffff0000, v32
    v_and_b32 v68, 0xffff0000, v68
    v_mul_f32 v10, v10, v24
    v_mul_f32 v32, v32, v25
    v_fmac_f32 v100, v10, v11
    v_fmac_f32 v100, v32, v68
    v_lshlrev_b32 v10, 16, v33
    v_lshlrev_b32 v11, 16, v69
    v_and_b32 v33, 0xffff0000, v33
    v_and_b32 v69, 0xffff0000, v69
    v_mul_f32 v10, v10, v26
    v_mul_f32 v33, v33, v27
    v_fmac_f32 v100, v10, v11
    v_fmac_f32 v100, v33, v69
    v_lshlrev_b32 v10, 16, v34
    v_lshlrev_b32 v11, 16, v70
    v_and_b32 v34, 0xffff0000, v34
    v_and_b32 v70, 0xffff0000, v70
    v_mul_f32 v10, v10, v16
    v_mul_f32 v34, v34, v17
    v_mul_f32 v101, v10, v11
    v_fmac_f32 v101, v34, v70
    v_lshlrev_b32 v10, 16, v35
    v_lshlrev_b32 v11, 16, v71
    v_and_b32 v35, 0xffff0000, v35
    v_and_b32 v71, 0xffff0000, v71
    v_mul_f32 v10, v10, v18
    v_mul_f32 v35, v35, v19
    v_fmac_f32 v101, v10, v11
    v_fmac_f32 v101, v35, v71
    v_lshlrev_b32 v10, 16, v36
    v_lshlrev_b32 v11, 16, v72
    v_and_b32 v36, 0xffff0000, v36
    v_and_b32 v72, 0xffff0000, v72
    v_mul_f32 v10, v10, v20
    v_mul_f32 v36, v36, v21
    v_fmac_f32 v101, v10, v11
    v_fmac_f32 v101, v36, v72
    v_lshlrev_b32 v10, 16, v37
    v_lshlrev_b32 v11, 16, v73
    v_and_b32 v37, 0xffff0000, v37
    v_and_b32 v73, 0xffff0000, v73
    v_mul_f32 v10, v10, v22
    v_mul_f32 v37, v37, v23
    v_fmac_f32 v101, v10, v11
    v_fmac_f32 v101, v37, v73
    v_lshlrev_b32 v10, 16, v38
    v_lshlrev_b32 v11, 16, v74
    v_and_b32 v38, 0xffff0000, v38
    v_and_b32 v74, 0xffff0000, v74
    v_mul_f32 v10, v10, v24
    v_mul_f32 v38, v38, v25
    v_fmac_f32 v101, v10, v11
    v_fmac_f32 v101, v38, v74
    v_lshlrev_b32 v10, 16, v39
    v_lshlrev_b32 v11, 16, v75
    v_and_b32 v39, 0xffff0000, v39
    v_and_b32 v75, 0xffff0000, v75
    v_mul_f32 v10, v10, v26
    v_mul_f32 v39, v39, v27
    v_fmac_f32 v101, v10, v11
    v_fmac_f32 v101, v39, v75
    v_lshlrev_b32 v10, 16, v40
    v_lshlrev_b32 v11, 16, v76
    v_and_b32 v40, 0xffff0000, v40
    v_and_b32 v76, 0xffff0000, v76
    v_mul_f32 v10, v10, v16
    v_mul_f32 v40, v40, v17
    v_mul_f32 v102, v10, v11
    v_fmac_f32 v102, v40, v76
    v_lshlrev_b32 v10, 16, v41
    v_lshlrev_b32 v11, 16, v77
    v_and_b32 v41, 0xffff0000, v41
    v_and_b32 v77, 0xffff0000, v77
    v_mul_f32 v10, v10, v18
    v_mul_f32 v41, v41, v19
    v_fmac_f32 v102, v10, v11
    v_fmac_f32 v102, v41, v77
    v_lshlrev_b32 v10, 16, v42
    v_lshlrev_b32 v11, 16, v78
    v_and_b32 v42, 0xffff0000, v42
    v_and_b32 v78, 0xffff0000, v78
    v_mul_f32 v10, v10, v20
    v_mul_f32 v42, v42, v21
    v_fmac_f32 v102, v10, v11
    v_fmac_f32 v102, v42, v78
    v_lshlrev_b32 v10, 16, v43
    v_lshlrev_b32 v11, 16, v79
    v_and_b32 v43, 0xffff0000, v43
    v_and_b32 v79, 0xffff0000, v79
    v_mul_f32 v10, v10, v22
    v_mul_f32 v43, v43, v23
    v_fmac_f32 v102, v10, v11
    v_fmac_f32 v102, v43, v79
    v_lshlrev_b32 v10, 16, v44
    v_lshlrev_b32 v11, 16, v80
    v_and_b32 v44, 0xffff0000, v44
    v_and_b32 v80, 0xffff0000, v80
    v_mul_f32 v10, v10, v24
    v_mul_f32 v44, v44, v25
    v_fmac_f32 v102, v10, v11
    v_fmac_f32 v102, v44, v80
    v_lshlrev_b32 v10, 16, v45
    v_lshlrev_b32 v11, 16, v81
    v_and_b32 v45, 0xffff0000, v45
    v_and_b32 v81, 0xffff0000, v81
    v_mul_f32 v10, v10, v26
    v_mul_f32 v45, v45, v27
    v_fmac_f32 v102, v10, v11
    v_fmac_f32 v102, v45, v81
    v_lshlrev_b32 v10, 16, v46
    v_lshlrev_b32 v11, 16, v82
    v_and_b32 v46, 0xffff0000, v46
    v_and_b32 v82, 0xffff0000, v82
    v_mul_f32 v10, v10, v16
    v_mul_f32 v46, v46, v17
    v_mul_f32 v103, v10, v11
    v_fmac_f32 v103, v46, v82
    v_lshlrev_b32 v10, 16, v47
    v_lshlrev_b32 v11, 16, v83
    v_and_b32 v47, 0xffff0000, v47
    v_and_b32 v83, 0xffff0000, v83
    v_mul_f32 v10, v10, v18
    v_mul_f32 v47, v47, v19
    v_fmac_f32 v103, v10, v11
    v_fmac_f32 v103, v47, v83
    v_lshlrev_b32 v10, 16, v48
    v_lshlrev_b32 v11, 16, v84
    v_and_b32 v48, 0xffff0000, v48
    v_and_b32 v84, 0xffff0000, v84
    v_mul_f32 v10, v10, v20
    v_mul_f32 v48, v48, v21
    v_fmac_f32 v103, v10, v11
    v_fmac_f32 v103, v48, v84
    v_lshlrev_b32 v10, 16, v49
    v_lshlrev_b32 v11, 16, v85
    v_and_b32 v49, 0xffff0000, v49
    v_and_b32 v85, 0xffff0000, v85
    v_mul_f32 v10, v10, v22
    v_mul_f32 v49, v49, v23
    v_fmac_f32 v103, v10, v11
    v_fmac_f32 v103, v49, v85
    v_lshlrev_b32 v10, 16, v50
    v_lshlrev_b32 v11, 16, v86
    v_and_b32 v50, 0xffff0000, v50
    v_and_b32 v86, 0xffff0000, v86
    v_mul_f32 v10, v10, v24
    v_mul_f32 v50, v50, v25
    v_fmac_f32 v103, v10, v11
    v_fmac_f32 v103, v50, v86
    v_lshlrev_b32 v10, 16, v51
    v_lshlrev_b32 v11, 16, v87
    v_and_b32 v51, 0xffff0000, v51
    v_and_b32 v87, 0xffff0000, v87
    v_mul_f32 v10, v10, v26
    v_mul_f32 v51, v51, v27
    v_fmac_f32 v103, v10, v11
    v_fmac_f32 v103, v51, v87
    v_lshlrev_b32 v10, 16, v52
    v_lshlrev_b32 v11, 16, v88
    v_and_b32 v52, 0xffff0000, v52
    v_and_b32 v88, 0xffff0000, v88
    v_mul_f32 v10, v10, v16
    v_mul_f32 v52, v52, v17
    v_mul_f32 v104, v10, v11
    v_fmac_f32 v104, v52, v88
    v_lshlrev_b32 v10, 16, v53
    v_lshlrev_b32 v11, 16, v89
    v_and_b32 v53, 0xffff0000, v53
    v_and_b32 v89, 0xffff0000, v89
    v_mul_f32 v10, v10, v18
    v_mul_f32 v53, v53, v19
    v_fmac_f32 v104, v10, v11
    v_fmac_f32 v104, v53, v89
    v_lshlrev_b32 v10, 16, v54
    v_lshlrev_b32 v11, 16, v90
    v_and_b32 v54, 0xffff0000, v54
    v_and_b32 v90, 0xffff0000, v90
    v_mul_f32 v10, v10, v20
    v_mul_f32 v54, v54, v21
    v_fmac_f32 v104, v10, v11
    v_fmac_f32 v104, v54, v90
    v_lshlrev_b32 v10, 16, v55
    v_lshlrev_b32 v11, 16, v91
    v_and_b32 v55, 0xffff0000, v55
    v_and_b32 v91, 0xffff0000, v91
    v_mul_f32 v10, v10, v22
    v_mul_f32 v55, v55, v23
    v_fmac_f32 v104, v10, v11
    v_fmac_f32 v104, v55, v91
    v_lshlrev_b32 v10, 16, v56
    v_lshlrev_b32 v11, 16, v92
    v_and_b32 v56, 0xffff0000, v56
    v_and_b32 v92, 0xffff0000, v92
    v_mul_f32 v10, v10, v24
    v_mul_f32 v56, v56, v25
    v_fmac_f32 v104, v10, v11
    v_fmac_f32 v104, v56, v92
    v_lshlrev_b32 v10, 16, v57
    v_lshlrev_b32 v11, 16, v93
    v_and_b32 v57, 0xffff0000, v57
    v_and_b32 v93, 0xffff0000, v93
    v_mul_f32 v10, v10, v26
    v_mul_f32 v57, v57, v27
    v_fmac_f32 v104, v10, v11
    v_fmac_f32 v104, v57, v93
    v_lshlrev_b32 v10, 16, v58
    v_lshlrev_b32 v11, 16, v94
    v_and_b32 v58, 0xffff0000, v58
    v_and_b32 v94, 0xffff0000, v94
    v_mul_f32 v10, v10, v16
    v_mul_f32 v58, v58, v17
    v_mul_f32 v105, v10, v11
    v_fmac_f32 v105, v58, v94
    v_lshlrev_b32 v10, 16, v59
    v_lshlrev_b32 v11, 16, v95
    v_and_b32 v59, 0xffff0000, v59
    v_and_b32 v95, 0xffff0000, v95
    v_mul_f32 v10, v10, v18
    v_mul_f32 v59, v59, v19
    v_fmac_f32 v105, v10, v11
    v_fmac_f32 v105, v59, v95
    v_lshlrev_b32 v10, 16, v60
    v_lshlrev_b32 v11, 16, v96
    v_and_b32 v60, 0xffff0000, v60
    v_and_b32 v96, 0xffff0000, v96
    v_mul_f32 v10, v10, v20
    v_mul_f32 v60, v60, v21
    v_fmac_f32 v105, v10, v11
    v_fmac_f32 v105, v60, v96
    v_lshlrev_b32 v10, 16, v61
    v_lshlrev_b32 v11, 16, v97
    v_and_b32 v61, 0xffff0000, v61
    v_and_b32 v97, 0xffff0000, v97
    v_mul_f32 v10, v10, v22
    v_mul_f32 v61, v61, v23
    v_fmac_f32 v105, v10, v11
    v_fmac_f32 v105, v61, v97
    v_lshlrev_b32 v10, 16, v62
    v_lshlrev_b32 v11, 16, v98
    v_and_b32 v62, 0xffff0000, v62
    v_and_b32 v98, 0xffff0000, v98
    v_mul_f32 v10, v10, v24
    v_mul_f32 v62, v62, v25
    v_fmac_f32 v105, v10, v11
    v_fmac_f32 v105, v62, v98
    v_lshlrev_b32 v10, 16, v63
    v_lshlrev_b32 v11, 16, v99
    v_and_b32 v63, 0xffff0000, v63
    v_and_b32 v99, 0xffff0000, v99
    v_mul_f32 v10, v10, v26
    v_mul_f32 v63, v63, v27
    v_fmac_f32 v105, v10, v11
    v_fmac_f32 v105, v63, v99
    v_add_f32_dpp v100, v100, v100 row_ror:8 row_mask:0xf bank_mask:0xf
    v_add_f32_dpp v101, v101, v101 row_ror:8 row_mask:0xf bank_mask:0xf
    v_add_f32_dpp v102, v102, v102 row_ror:8 row_mask:0xf bank_mask:0xf
    v_add_f32_dpp v103, v103, v103 row_ror:8 row_mask:0xf bank_mask:0xf
    v_add_f32_dpp v104, v104, v104 row_ror:8 row_mask:0xf bank_mask:0xf
    v_add_f32_dpp v105, v105, v105 row_ror:8 row_mask:0xf bank_mask:0xf
    v_add_f32_dpp v100, v100, v100 row_ror:4 row_mask:0xf bank_mask:0xf
    v_add_f32_dpp v101, v101, v101 row_ror:4 row_mask:0xf bank_mask:0xf
    v_add_f32_dpp v102, v102, v102 row_ror:4 row_mask:0xf bank_mask:0xf
    v_add_f32_dpp v103, v103, v103 row_ror:4 row_mask:0xf bank_mask:0xf
    v_add_f32_dpp v104, v104, v104 row_ror:4 row_mask:0xf bank_mask:0xf
    v_add_f32_dpp v105, v105, v105 row_ror:4 row_mask:0xf bank_mask:0xf
    v_add_f32_dpp v100, v100, v100 row_ror:2 row_mask:0xf bank_mask:0xf
    v_add_f32_dpp v101, v101, v101 row_ror:2 row_mask:0xf bank_mask:0xf
    v_add_f32_dpp v102, v102, v102 row_ror:2 row_mask:0xf bank_mask:0xf
    v_add_f32_dpp v103, v103, v103 row_ror:2 row_mask:0xf bank_mask:0xf
    v_add_f32_dpp v104, v104, v104 row_ror:2 row_mask:0xf bank_mask:0xf
    v_add_f32_dpp v105, v105, v105 row_ror:2 row_mask:0xf bank_mask:0xf
    v_add_f32_dpp v100, v100, v100 row_ror:1 row_mask:0xf bank_mask:0xf
    v_add_f32_dpp v101, v101, v101 row_ror:1 row_mask:0xf bank_mask:0xf
    v_add_f32_dpp v102, v102, v102 row_ror:1 row_mask:0xf bank_mask:0xf
    v_add_f32_dpp v103, v103, v103 row_ror:1 row_mask:0xf bank_mask:0xf
    v_add_f32_dpp v104, v104, v104 row_ror:1 row_mask:0xf bank_mask:0xf
    v_add_f32_dpp v105, v105, v105 row_ror:1 row_mask:0xf bank_mask:0xf
    v_cmp_eq_u32 vcc, 1, v5
    s_nop 1
    v_cndmask_b32 v100, v100, v101, vcc
    v_cmp_eq_u32 vcc, 2, v5
    s_nop 1
    v_cndmask_b32 v100, v100, v102, vcc
    v_cmp_eq_u32 vcc, 3, v5
    s_nop 1
    v_cndmask_b32 v100, v100, v103, vcc
    v_cmp_eq_u32 vcc, 4, v5
    s_nop 1
    v_cndmask_b32 v100, v100, v104, vcc
    v_cmp_eq_u32 vcc, 5, v5
    s_nop 1
    v_cndmask_b32 v100, v100, v105, vcc
    s_mul_i32 s48, s62, 768
    s_lshl_b32 s49, s49, 2
    s_add_u32 s48, s48, s49
    s_add_u32 s48, s48, 1179648
    s_mov_b32 exec_lo, 0x003f003f
    s_mov_b32 exec_hi, 0x003f003f
    buffer_store_dword v100, v13, s[12:15], s48 offen sc1
    s_mov_b64 exec, -1
    s_mov_b32 s60, 0x100000
L_wb1:
    s_nop 1
    ds_read_b32 v10, v2 offset:60
    s_sub_u32 s60, s60, 1
    s_cbranch_scc1 L_exit1
    s_waitcnt lgkmcnt(0)
    v_readfirstlane_b32 s48, v10
    s_cmp_lt_u32 s48, 1
    s_cbranch_scc1 L_wb1
    s_mov_b32 s61, 1
    s_lshl_b32 s62, s61, 5
    s_add_u32 s62, s62, s3
    s_lshl_b32 s63, s62, 15
    s_add_u32 s63, s63, 1
    s_mul_hi_u32 s63, s63, 0xaaaaaaab
    s_lshr_b32 s63, s63, 7
    s_mul_i32 s48, s62, 171
    s_lshr_b32 s48, s48, 9
    s_mul_i32 s48, s48, 384
    s_mul_i32 s49, s4, 24
    s_add_u32 s50, s49, s63
    s_mul_i32 s50, s50, 384
    v_add_u32 v10, s50, v7
    v_add_u32 v11, 3072, v10
    v_add_u32 v12, 6144, v10
    buffer_load_dwordx2 v[100:101], v6, s[8:11], s48 offen offset:0
    buffer_load_dwordx2 v[102:103], v6, s[8:11], s48 offen offset:128
    buffer_load_dwordx2 v[104:105], v6, s[8:11], s48 offen offset:256
    buffer_load_dwordx2 v[28:29], v10, s[92:95], 0 offen offset:0
    buffer_load_dwordx2 v[30:31], v10, s[92:95], 0 offen offset:128
    buffer_load_dwordx2 v[32:33], v10, s[92:95], 0 offen offset:256
    buffer_load_dwordx2 v[64:65], v10, s[96:99], 0 offen offset:0
    buffer_load_dwordx2 v[66:67], v10, s[96:99], 0 offen offset:128
    buffer_load_dwordx2 v[68:69], v10, s[96:99], 0 offen offset:256
    buffer_load_dwordx2 v[34:35], v10, s[92:95], 0 offen offset:1536
    buffer_load_dwordx2 v[36:37], v10, s[92:95], 0 offen offset:1664
    buffer_load_dwordx2 v[38:39], v10, s[92:95], 0 offen offset:1792
    buffer_load_dwordx2 v[70:71], v10, s[96:99], 0 offen offset:1536
    buffer_load_dwordx2 v[72:73], v10, s[96:99], 0 offen offset:1664
    buffer_load_dwordx2 v[74:75], v10, s[96:99], 0 offen offset:1792
    buffer_load_dwordx2 v[40:41], v11, s[92:95], 0 offen offset:0
    buffer_load_dwordx2 v[42:43], v11, s[92:95], 0 offen offset:128
    buffer_load_dwordx2 v[44:45], v11, s[92:95], 0 offen offset:256
    buffer_load_dwordx2 v[76:77], v11, s[96:99], 0 offen offset:0
    buffer_load_dwordx2 v[78:79], v11, s[96:99], 0 offen offset:128
    buffer_load_dwordx2 v[80:81], v11, s[96:99], 0 offen offset:256
    buffer_load_dwordx2 v[46:47], v11, s[92:95], 0 offen offset:1536
    buffer_load_dwordx2 v[48:49], v11, s[92:95], 0 offen offset:1664
    buffer_load_dwordx2 v[50:51], v11, s[92:95], 0 offen offset:1792
    buffer_load_dwordx2 v[82:83], v11, s[96:99], 0 offen offset:1536
    buffer_load_dwordx2 v[84:85], v11, s[96:99], 0 offen offset:1664
    buffer_load_dwordx2 v[86:87], v11, s[96:99], 0 offen offset:1792
    buffer_load_dwordx2 v[52:53], v12, s[92:95], 0 offen offset:0
    buffer_load_dwordx2 v[54:55], v12, s[92:95], 0 offen offset:128
    buffer_load_dwordx2 v[56:57], v12, s[92:95], 0 offen offset:256
    buffer_load_dwordx2 v[88:89], v12, s[96:99], 0 offen offset:0
    buffer_load_dwordx2 v[90:91], v12, s[96:99], 0 offen offset:128
    buffer_load_dwordx2 v[92:93], v12, s[96:99], 0 offen offset:256
    buffer_load_dwordx2 v[58:59], v12, s[92:95], 0 offen offset:1536
    buffer_load_dwordx2 v[60:61], v12, s[92:95], 0 offen offset:1664
    buffer_load_dwordx2 v[62:63], v12, s[92:95], 0 offen offset:1792
    buffer_load_dwordx2 v[94:95], v12, s[96:99], 0 offen offset:1536
    buffer_load_dwordx2 v[96:97], v12, s[96:99], 0 offen offset:1664
    buffer_load_dwordx2 v[98:99], v12, s[96:99], 0 offen offset:1792
    s_waitcnt vmcnt(0)
    v_lshlrev_b32 v16, 16, v100
    v_and_b32 v17, 0xffff0000, v100
    v_lshlrev_b32 v18, 16, v101
    v_and_b32 v19, 0xffff0000, v101
    v_lshlrev_b32 v20, 16, v102
    v_and_b32 v21, 0xffff0000, v102
    v_lshlrev_b32 v22, 16, v103
    v_and_b32 v23, 0xffff0000, v103
    v_lshlrev_b32 v24, 16, v104
    v_and_b32 v25, 0xffff0000, v104
    v_lshlrev_b32 v26, 16, v105
    v_and_b32 v27, 0xffff0000, v105
    v_lshlrev_b32 v10, 16, v28
    v_lshlrev_b32 v11, 16, v64
    v_and_b32 v28, 0xffff0000, v28
    v_and_b32 v64, 0xffff0000, v64
    v_mul_f32 v10, v10, v16
    v_mul_f32 v28, v28, v17
    v_mul_f32 v100, v10, v11
    v_fmac_f32 v100, v28, v64
    v_lshlrev_b32 v10, 16, v29
    v_lshlrev_b32 v11, 16, v65
    v_and_b32 v29, 0xffff0000, v29
    v_and_b32 v65, 0xffff0000, v65
    v_mul_f32 v10, v10, v18
    v_mul_f32 v29, v29, v19
    v_fmac_f32 v100, v10, v11
    v_fmac_f32 v100, v29, v65
    v_lshlrev_b32 v10, 16, v30
    v_lshlrev_b32 v11, 16, v66
    v_and_b32 v30, 0xffff0000, v30
    v_and_b32 v66, 0xffff0000, v66
    v_mul_f32 v10, v10, v20
    v_mul_f32 v30, v30, v21
    v_fmac_f32 v100, v10, v11
    v_fmac_f32 v100, v30, v66
    v_lshlrev_b32 v10, 16, v31
    v_lshlrev_b32 v11, 16, v67
    v_and_b32 v31, 0xffff0000, v31
    v_and_b32 v67, 0xffff0000, v67
    v_mul_f32 v10, v10, v22
    v_mul_f32 v31, v31, v23
    v_fmac_f32 v100, v10, v11
    v_fmac_f32 v100, v31, v67
    v_lshlrev_b32 v10, 16, v32
    v_lshlrev_b32 v11, 16, v68
    v_and_b32 v32, 0xffff0000, v32
    v_and_b32 v68, 0xffff0000, v68
    v_mul_f32 v10, v10, v24
    v_mul_f32 v32, v32, v25
    v_fmac_f32 v100, v10, v11
    v_fmac_f32 v100, v32, v68
    v_lshlrev_b32 v10, 16, v33
    v_lshlrev_b32 v11, 16, v69
    v_and_b32 v33, 0xffff0000, v33
    v_and_b32 v69, 0xffff0000, v69
    v_mul_f32 v10, v10, v26
    v_mul_f32 v33, v33, v27
    v_fmac_f32 v100, v10, v11
    v_fmac_f32 v100, v33, v69
    v_lshlrev_b32 v10, 16, v34
    v_lshlrev_b32 v11, 16, v70
    v_and_b32 v34, 0xffff0000, v34
    v_and_b32 v70, 0xffff0000, v70
    v_mul_f32 v10, v10, v16
    v_mul_f32 v34, v34, v17
    v_mul_f32 v101, v10, v11
    v_fmac_f32 v101, v34, v70
    v_lshlrev_b32 v10, 16, v35
    v_lshlrev_b32 v11, 16, v71
    v_and_b32 v35, 0xffff0000, v35
    v_and_b32 v71, 0xffff0000, v71
    v_mul_f32 v10, v10, v18
    v_mul_f32 v35, v35, v19
    v_fmac_f32 v101, v10, v11
    v_fmac_f32 v101, v35, v71
    v_lshlrev_b32 v10, 16, v36
    v_lshlrev_b32 v11, 16, v72
    v_and_b32 v36, 0xffff0000, v36
    v_and_b32 v72, 0xffff0000, v72
    v_mul_f32 v10, v10, v20
    v_mul_f32 v36, v36, v21
    v_fmac_f32 v101, v10, v11
    v_fmac_f32 v101, v36, v72
    v_lshlrev_b32 v10, 16, v37
    v_lshlrev_b32 v11, 16, v73
    v_and_b32 v37, 0xffff0000, v37
    v_and_b32 v73, 0xffff0000, v73
    v_mul_f32 v10, v10, v22
    v_mul_f32 v37, v37, v23
    v_fmac_f32 v101, v10, v11
    v_fmac_f32 v101, v37, v73
    v_lshlrev_b32 v10, 16, v38
    v_lshlrev_b32 v11, 16, v74
    v_and_b32 v38, 0xffff0000, v38
    v_and_b32 v74, 0xffff0000, v74
    v_mul_f32 v10, v10, v24
    v_mul_f32 v38, v38, v25
    v_fmac_f32 v101, v10, v11
    v_fmac_f32 v101, v38, v74
    v_lshlrev_b32 v10, 16, v39
    v_lshlrev_b32 v11, 16, v75
    v_and_b32 v39, 0xffff0000, v39
    v_and_b32 v75, 0xffff0000, v75
    v_mul_f32 v10, v10, v26
    v_mul_f32 v39, v39, v27
    v_fmac_f32 v101, v10, v11
    v_fmac_f32 v101, v39, v75
    v_lshlrev_b32 v10, 16, v40
    v_lshlrev_b32 v11, 16, v76
    v_and_b32 v40, 0xffff0000, v40
    v_and_b32 v76, 0xffff0000, v76
    v_mul_f32 v10, v10, v16
    v_mul_f32 v40, v40, v17
    v_mul_f32 v102, v10, v11
    v_fmac_f32 v102, v40, v76
    v_lshlrev_b32 v10, 16, v41
    v_lshlrev_b32 v11, 16, v77
    v_and_b32 v41, 0xffff0000, v41
    v_and_b32 v77, 0xffff0000, v77
    v_mul_f32 v10, v10, v18
    v_mul_f32 v41, v41, v19
    v_fmac_f32 v102, v10, v11
    v_fmac_f32 v102, v41, v77
    v_lshlrev_b32 v10, 16, v42
    v_lshlrev_b32 v11, 16, v78
    v_and_b32 v42, 0xffff0000, v42
    v_and_b32 v78, 0xffff0000, v78
    v_mul_f32 v10, v10, v20
    v_mul_f32 v42, v42, v21
    v_fmac_f32 v102, v10, v11
    v_fmac_f32 v102, v42, v78
    v_lshlrev_b32 v10, 16, v43
    v_lshlrev_b32 v11, 16, v79
    v_and_b32 v43, 0xffff0000, v43
    v_and_b32 v79, 0xffff0000, v79
    v_mul_f32 v10, v10, v22
    v_mul_f32 v43, v43, v23
    v_fmac_f32 v102, v10, v11
    v_fmac_f32 v102, v43, v79
    v_lshlrev_b32 v10, 16, v44
    v_lshlrev_b32 v11, 16, v80
    v_and_b32 v44, 0xffff0000, v44
    v_and_b32 v80, 0xffff0000, v80
    v_mul_f32 v10, v10, v24
    v_mul_f32 v44, v44, v25
    v_fmac_f32 v102, v10, v11
    v_fmac_f32 v102, v44, v80
    v_lshlrev_b32 v10, 16, v45
    v_lshlrev_b32 v11, 16, v81
    v_and_b32 v45, 0xffff0000, v45
    v_and_b32 v81, 0xffff0000, v81
    v_mul_f32 v10, v10, v26
    v_mul_f32 v45, v45, v27
    v_fmac_f32 v102, v10, v11
    v_fmac_f32 v102, v45, v81
    v_lshlrev_b32 v10, 16, v46
    v_lshlrev_b32 v11, 16, v82
    v_and_b32 v46, 0xffff0000, v46
    v_and_b32 v82, 0xffff0000, v82
    v_mul_f32 v10, v10, v16
    v_mul_f32 v46, v46, v17
    v_mul_f32 v103, v10, v11
    v_fmac_f32 v103, v46, v82
    v_lshlrev_b32 v10, 16, v47
    v_lshlrev_b32 v11, 16, v83
    v_and_b32 v47, 0xffff0000, v47
    v_and_b32 v83, 0xffff0000, v83
    v_mul_f32 v10, v10, v18
    v_mul_f32 v47, v47, v19
    v_fmac_f32 v103, v10, v11
    v_fmac_f32 v103, v47, v83
    v_lshlrev_b32 v10, 16, v48
    v_lshlrev_b32 v11, 16, v84
    v_and_b32 v48, 0xffff0000, v48
    v_and_b32 v84, 0xffff0000, v84
    v_mul_f32 v10, v10, v20
    v_mul_f32 v48, v48, v21
    v_fmac_f32 v103, v10, v11
    v_fmac_f32 v103, v48, v84
    v_lshlrev_b32 v10, 16, v49
    v_lshlrev_b32 v11, 16, v85
    v_and_b32 v49, 0xffff0000, v49
    v_and_b32 v85, 0xffff0000, v85
    v_mul_f32 v10, v10, v22
    v_mul_f32 v49, v49, v23
    v_fmac_f32 v103, v10, v11
    v_fmac_f32 v103, v49, v85
    v_lshlrev_b32 v10, 16, v50
    v_lshlrev_b32 v11, 16, v86
    v_and_b32 v50, 0xffff0000, v50
    v_and_b32 v86, 0xffff0000, v86
    v_mul_f32 v10, v10, v24
    v_mul_f32 v50, v50, v25
    v_fmac_f32 v103, v10, v11
    v_fmac_f32 v103, v50, v86
    v_lshlrev_b32 v10, 16, v51
    v_lshlrev_b32 v11, 16, v87
    v_and_b32 v51, 0xffff0000, v51
    v_and_b32 v87, 0xffff0000, v87
    v_mul_f32 v10, v10, v26
    v_mul_f32 v51, v51, v27
    v_fmac_f32 v103, v10, v11
    v_fmac_f32 v103, v51, v87
    v_lshlrev_b32 v10, 16, v52
    v_lshlrev_b32 v11, 16, v88
    v_and_b32 v52, 0xffff0000, v52
    v_and_b32 v88, 0xffff0000, v88
    v_mul_f32 v10, v10, v16
    v_mul_f32 v52, v52, v17
    v_mul_f32 v104, v10, v11
    v_fmac_f32 v104, v52, v88
    v_lshlrev_b32 v10, 16, v53
    v_lshlrev_b32 v11, 16, v89
    v_and_b32 v53, 0xffff0000, v53
    v_and_b32 v89, 0xffff0000, v89
    v_mul_f32 v10, v10, v18
    v_mul_f32 v53, v53, v19
    v_fmac_f32 v104, v10, v11
    v_fmac_f32 v104, v53, v89
    v_lshlrev_b32 v10, 16, v54
    v_lshlrev_b32 v11, 16, v90
    v_and_b32 v54, 0xffff0000, v54
    v_and_b32 v90, 0xffff0000, v90
    v_mul_f32 v10, v10, v20
    v_mul_f32 v54, v54, v21
    v_fmac_f32 v104, v10, v11
    v_fmac_f32 v104, v54, v90
    v_lshlrev_b32 v10, 16, v55
    v_lshlrev_b32 v11, 16, v91
    v_and_b32 v55, 0xffff0000, v55
    v_and_b32 v91, 0xffff0000, v91
    v_mul_f32 v10, v10, v22
    v_mul_f32 v55, v55, v23
    v_fmac_f32 v104, v10, v11
    v_fmac_f32 v104, v55, v91
    v_lshlrev_b32 v10, 16, v56
    v_lshlrev_b32 v11, 16, v92
    v_and_b32 v56, 0xffff0000, v56
    v_and_b32 v92, 0xffff0000, v92
    v_mul_f32 v10, v10, v24
    v_mul_f32 v56, v56, v25
    v_fmac_f32 v104, v10, v11
    v_fmac_f32 v104, v56, v92
    v_lshlrev_b32 v10, 16, v57
    v_lshlrev_b32 v11, 16, v93
    v_and_b32 v57, 0xffff0000, v57
    v_and_b32 v93, 0xffff0000, v93
    v_mul_f32 v10, v10, v26
    v_mul_f32 v57, v57, v27
    v_fmac_f32 v104, v10, v11
    v_fmac_f32 v104, v57, v93
    v_lshlrev_b32 v10, 16, v58
    v_lshlrev_b32 v11, 16, v94
    v_and_b32 v58, 0xffff0000, v58
    v_and_b32 v94, 0xffff0000, v94
    v_mul_f32 v10, v10, v16
    v_mul_f32 v58, v58, v17
    v_mul_f32 v105, v10, v11
    v_fmac_f32 v105, v58, v94
    v_lshlrev_b32 v10, 16, v59
    v_lshlrev_b32 v11, 16, v95
    v_and_b32 v59, 0xffff0000, v59
    v_and_b32 v95, 0xffff0000, v95
    v_mul_f32 v10, v10, v18
    v_mul_f32 v59, v59, v19
    v_fmac_f32 v105, v10, v11
    v_fmac_f32 v105, v59, v95
    v_lshlrev_b32 v10, 16, v60
    v_lshlrev_b32 v11, 16, v96
    v_and_b32 v60, 0xffff0000, v60
    v_and_b32 v96, 0xffff0000, v96
    v_mul_f32 v10, v10, v20
    v_mul_f32 v60, v60, v21
    v_fmac_f32 v105, v10, v11
    v_fmac_f32 v105, v60, v96
    v_lshlrev_b32 v10, 16, v61
    v_lshlrev_b32 v11, 16, v97
    v_and_b32 v61, 0xffff0000, v61
    v_and_b32 v97, 0xffff0000, v97
    v_mul_f32 v10, v10, v22
    v_mul_f32 v61, v61, v23
    v_fmac_f32 v105, v10, v11
    v_fmac_f32 v105, v61, v97
    v_lshlrev_b32 v10, 16, v62
    v_lshlrev_b32 v11, 16, v98
    v_and_b32 v62, 0xffff0000, v62
    v_and_b32 v98, 0xffff0000, v98
    v_mul_f32 v10, v10, v24
    v_mul_f32 v62, v62, v25
    v_fmac_f32 v105, v10, v11
    v_fmac_f32 v105, v62, v98
    v_lshlrev_b32 v10, 16, v63
    v_lshlrev_b32 v11, 16, v99
    v_and_b32 v63, 0xffff0000, v63
    v_and_b32 v99, 0xffff0000, v99
    v_mul_f32 v10, v10, v26
    v_mul_f32 v63, v63, v27
    v_fmac_f32 v105, v10, v11
    v_fmac_f32 v105, v63, v99
    v_add_f32_dpp v100, v100, v100 row_ror:8 row_mask:0xf bank_mask:0xf
    v_add_f32_dpp v101, v101, v101 row_ror:8 row_mask:0xf bank_mask:0xf
    v_add_f32_dpp v102, v102, v102 row_ror:8 row_mask:0xf bank_mask:0xf
    v_add_f32_dpp v103, v103, v103 row_ror:8 row_mask:0xf bank_mask:0xf
    v_add_f32_dpp v104, v104, v104 row_ror:8 row_mask:0xf bank_mask:0xf
    v_add_f32_dpp v105, v105, v105 row_ror:8 row_mask:0xf bank_mask:0xf
    v_add_f32_dpp v100, v100, v100 row_ror:4 row_mask:0xf bank_mask:0xf
    v_add_f32_dpp v101, v101, v101 row_ror:4 row_mask:0xf bank_mask:0xf
    v_add_f32_dpp v102, v102, v102 row_ror:4 row_mask:0xf bank_mask:0xf
    v_add_f32_dpp v103, v103, v103 row_ror:4 row_mask:0xf bank_mask:0xf
    v_add_f32_dpp v104, v104, v104 row_ror:4 row_mask:0xf bank_mask:0xf
    v_add_f32_dpp v105, v105, v105 row_ror:4 row_mask:0xf bank_mask:0xf
    v_add_f32_dpp v100, v100, v100 row_ror:2 row_mask:0xf bank_mask:0xf
    v_add_f32_dpp v101, v101, v101 row_ror:2 row_mask:0xf bank_mask:0xf
    v_add_f32_dpp v102, v102, v102 row_ror:2 row_mask:0xf bank_mask:0xf
    v_add_f32_dpp v103, v103, v103 row_ror:2 row_mask:0xf bank_mask:0xf
    v_add_f32_dpp v104, v104, v104 row_ror:2 row_mask:0xf bank_mask:0xf
    v_add_f32_dpp v105, v105, v105 row_ror:2 row_mask:0xf bank_mask:0xf
    v_add_f32_dpp v100, v100, v100 row_ror:1 row_mask:0xf bank_mask:0xf
    v_add_f32_dpp v101, v101, v101 row_ror:1 row_mask:0xf bank_mask:0xf
    v_add_f32_dpp v102, v102, v102 row_ror:1 row_mask:0xf bank_mask:0xf
    v_add_f32_dpp v103, v103, v103 row_ror:1 row_mask:0xf bank_mask:0xf
    v_add_f32_dpp v104, v104, v104 row_ror:1 row_mask:0xf bank_mask:0xf
    v_add_f32_dpp v105, v105, v105 row_ror:1 row_mask:0xf bank_mask:0xf
    v_cmp_eq_u32 vcc, 1, v5
    s_nop 1
    v_cndmask_b32 v100, v100, v101, vcc
    v_cmp_eq_u32 vcc, 2, v5
    s_nop 1
    v_cndmask_b32 v100, v100, v102, vcc
    v_cmp_eq_u32 vcc, 3, v5
    s_nop 1
    v_cndmask_b32 v100, v100, v103, vcc
    v_cmp_eq_u32 vcc, 4, v5
    s_nop 1
    v_cndmask_b32 v100, v100, v104, vcc
    v_cmp_eq_u32 vcc, 5, v5
    s_nop 1
    v_cndmask_b32 v100, v100, v105, vcc
    s_mul_i32 s48, s62, 768
    s_lshl_b32 s49, s49, 2
    s_add_u32 s48, s48, s49
    s_add_u32 s48, s48, 1179648
    s_mov_b32 exec_lo, 0x003f003f
    s_mov_b32 exec_hi, 0x003f003f
    buffer_store_dword v100, v13, s[12:15], s48 offen sc1
    s_mov_b64 exec, -1
    s_mov_b32 s60, 0x100000
L_wd0:
    s_nop 1
    ds_read_b32 v10, v2 offset:20
    s_sub_u32 s60, s60, 1
    s_cbranch_scc1 L_exit1
    s_waitcnt lgkmcnt(0)
    v_readfirstlane_b32 s48, v10
    s_cmp_eq_u32 s48, 0
    s_cbranch_scc1 L_wd0
    ds_read_b128 v[16:19], v2 offset:0
    ds_read_b64 v[20:21], v2 offset:16
    s_waitcnt lgkmcnt(0)
    v_readfirstlane_b32 s84, v16
    v_readfirstlane_b32 s85, v17
    v_readfirstlane_b32 s86, v18
    v_readfirstlane_b32 s87, v19
    v_readfirstlane_b32 s88, v20
    v_readfirstlane_b32 s89, v21
    s_mov_b32 s60, 0x100000
L_wf0:
    s_nop 1
    ds_read_b32 v10, v2 offset:40
    s_sub_u32 s60, s60, 1
    s_cbranch_scc1 L_exit1
    s_waitcnt lgkmcnt(0)
    v_readfirstlane_b32 s48, v10
    s_cmp_lt_u32 s48, 4
    s_cbranch_scc1 L_wf0
    s_cmp_eq_u32 s84, s87
    ds_read_b128 v[16:19], v4 offset:256
    ds_read_b128 v[20:23], v4 offset:1280
    ds_read_b128 v[24:27], v4 offset:2304
    ds_read_b128 v[28:31], v4 offset:3328
    ds_read_b128 v[32:35], v4 offset:4352
    ds_read_b128 v[36:39], v4 offset:5376
    s_add_u32 s54, s33, 0
    s_add_u32 s55, s33, 4096
    s_cmp_eq_u32 s84, s87
    s_waitcnt lgkmcnt(0)
    s_cselect_b32 exec_lo, 0xffff, -1
    s_cselect_b32 exec_hi, 0xffff0000, -1
    buffer_store_dwordx4 v[16:19], v4, s[12:15], s54 offen offset:0 sc1
    s_cselect_b32 exec_lo, 0x0, -1
    s_cselect_b32 exec_hi, 0xffff, -1
    buffer_store_dwordx4 v[20:23], v4, s[12:15], s54 offen offset:1024 sc1
    s_cselect_b32 exec_lo, 0xffff0000, -1
    s_cselect_b32 exec_hi, 0x0, -1
    buffer_store_dwordx4 v[24:27], v4, s[12:15], s54 offen offset:2048 sc1
    s_cselect_b32 exec_lo, 0xffff, -1
    s_cselect_b32 exec_hi, 0xffff0000, -1
    buffer_store_dwordx4 v[28:31], v4, s[12:15], s54 offen offset:3072 sc1
    s_cselect_b32 exec_lo, 0x0, -1
    s_cselect_b32 exec_hi, 0xffff, -1
    buffer_store_dwordx4 v[32:35], v4, s[12:15], s55 offen offset:0 sc1
    s_cselect_b32 exec_lo, 0xffff0000, -1
    s_cselect_b32 exec_hi, 0x0, -1
    buffer_store_dwordx4 v[36:39], v4, s[12:15], s55 offen offset:1024 sc1
    s_mov_b64 exec, -1
L_fl0:
    s_nop 1
    v_mov_b32 v10, 1
    s_waitcnt vmcnt(0)
    s_mov_b64 exec, 1
    buffer_store_dword v10, off, s[12:15], s32 sc1
    ds_write_b32 v2, v10 offset:52
    s_mov_b64 exec, -1
    s_mov_b32 s60, 0x100000
L_wb2:
    s_nop 1
    ds_read_b32 v10, v2 offset:60
    s_sub_u32 s60, s60, 1
    s_cbranch_scc1 L_exit1
    s_waitcnt lgkmcnt(0)
    v_readfirstlane_b32 s48, v10
    s_cmp_lt_u32 s48, 9
    s_cbranch_scc1 L_wb2
    s_mov_b32 s61, 2
    s_lshl_b32 s62, s61, 5
    s_add_u32 s62, s62, s3
    s_lshl_b32 s63, s62, 15
    s_add_u32 s63, s63, 1
    s_mul_hi_u32 s63, s63, 0xaaaaaaab
    s_lshr_b32 s63, s63, 7
    s_mul_i32 s48, s62, 171
    s_lshr_b32 s48, s48, 9
    s_mul_i32 s48, s48, 384
    s_mul_i32 s49, s4, 24
    s_add_u32 s50, s49, s63
    s_mul_i32 s50, s50, 384
    v_add_u32 v10, s50, v7
    v_add_u32 v11, 3072, v10
    v_add_u32 v12, 6144, v10
    buffer_load_dwordx2 v[100:101], v6, s[8:11], s48 offen offset:0
    buffer_load_dwordx2 v[102:103], v6, s[8:11], s48 offen offset:128
    buffer_load_dwordx2 v[104:105], v6, s[8:11], s48 offen offset:256
    buffer_load_dwordx2 v[28:29], v10, s[92:95], 0 offen offset:0
    buffer_load_dwordx2 v[30:31], v10, s[92:95], 0 offen offset:128
    buffer_load_dwordx2 v[32:33], v10, s[92:95], 0 offen offset:256
    buffer_load_dwordx2 v[64:65], v10, s[96:99], 0 offen offset:0
    buffer_load_dwordx2 v[66:67], v10, s[96:99], 0 offen offset:128
    buffer_load_dwordx2 v[68:69], v10, s[96:99], 0 offen offset:256
    buffer_load_dwordx2 v[34:35], v10, s[92:95], 0 offen offset:1536
    buffer_load_dwordx2 v[36:37], v10, s[92:95], 0 offen offset:1664
    buffer_load_dwordx2 v[38:39], v10, s[92:95], 0 offen offset:1792
    buffer_load_dwordx2 v[70:71], v10, s[96:99], 0 offen offset:1536
    buffer_load_dwordx2 v[72:73], v10, s[96:99], 0 offen offset:1664
    buffer_load_dwordx2 v[74:75], v10, s[96:99], 0 offen offset:1792
    buffer_load_dwordx2 v[40:41], v11, s[92:95], 0 offen offset:0
    buffer_load_dwordx2 v[42:43], v11, s[92:95], 0 offen offset:128
    buffer_load_dwordx2 v[44:45], v11, s[92:95], 0 offen offset:256
    buffer_load_dwordx2 v[76:77], v11, s[96:99], 0 offen offset:0
    buffer_load_dwordx2 v[78:79], v11, s[96:99], 0 offen offset:128
    buffer_load_dwordx2 v[80:81], v11, s[96:99], 0 offen offset:256
    buffer_load_dwordx2 v[46:47], v11, s[92:95], 0 offen offset:1536
    buffer_load_dwordx2 v[48:49], v11, s[92:95], 0 offen offset:1664
    buffer_load_dwordx2 v[50:51], v11, s[92:95], 0 offen offset:1792
    buffer_load_dwordx2 v[82:83], v11, s[96:99], 0 offen offset:1536
    buffer_load_dwordx2 v[84:85], v11, s[96:99], 0 offen offset:1664
    buffer_load_dwordx2 v[86:87], v11, s[96:99], 0 offen offset:1792
    buffer_load_dwordx2 v[52:53], v12, s[92:95], 0 offen offset:0
    buffer_load_dwordx2 v[54:55], v12, s[92:95], 0 offen offset:128
    buffer_load_dwordx2 v[56:57], v12, s[92:95], 0 offen offset:256
    buffer_load_dwordx2 v[88:89], v12, s[96:99], 0 offen offset:0
    buffer_load_dwordx2 v[90:91], v12, s[96:99], 0 offen offset:128
    buffer_load_dwordx2 v[92:93], v12, s[96:99], 0 offen offset:256
    buffer_load_dwordx2 v[58:59], v12, s[92:95], 0 offen offset:1536
    buffer_load_dwordx2 v[60:61], v12, s[92:95], 0 offen offset:1664
    buffer_load_dwordx2 v[62:63], v12, s[92:95], 0 offen offset:1792
    buffer_load_dwordx2 v[94:95], v12, s[96:99], 0 offen offset:1536
    buffer_load_dwordx2 v[96:97], v12, s[96:99], 0 offen offset:1664
    buffer_load_dwordx2 v[98:99], v12, s[96:99], 0 offen offset:1792
    s_waitcnt vmcnt(0)
    v_lshlrev_b32 v16, 16, v100
    v_and_b32 v17, 0xffff0000, v100
    v_lshlrev_b32 v18, 16, v101
    v_and_b32 v19, 0xffff0000, v101
    v_lshlrev_b32 v20, 16, v102
    v_and_b32 v21, 0xffff0000, v102
    v_lshlrev_b32 v22, 16, v103
    v_and_b32 v23, 0xffff0000, v103
    v_lshlrev_b32 v24, 16, v104
    v_and_b32 v25, 0xffff0000, v104
    v_lshlrev_b32 v26, 16, v105
    v_and_b32 v27, 0xffff0000, v105
    v_lshlrev_b32 v10, 16, v28
    v_lshlrev_b32 v11, 16, v64
    v_and_b32 v28, 0xffff0000, v28
    v_and_b32 v64, 0xffff0000, v64
    v_mul_f32 v10, v10, v16
    v_mul_f32 v28, v28, v17
    v_mul_f32 v100, v10, v11
    v_fmac_f32 v100, v28, v64
    v_lshlrev_b32 v10, 16, v29
    v_lshlrev_b32 v11, 16, v65
    v_and_b32 v29, 0xffff0000, v29
    v_and_b32 v65, 0xffff0000, v65
    v_mul_f32 v10, v10, v18
    v_mul_f32 v29, v29, v19
    v_fmac_f32 v100, v10, v11
    v_fmac_f32 v100, v29, v65
    v_lshlrev_b32 v10, 16, v30
    v_lshlrev_b32 v11, 16, v66
    v_and_b32 v30, 0xffff0000, v30
    v_and_b32 v66, 0xffff0000, v66
    v_mul_f32 v10, v10, v20
    v_mul_f32 v30, v30, v21
    v_fmac_f32 v100, v10, v11
    v_fmac_f32 v100, v30, v66
    v_lshlrev_b32 v10, 16, v31
    v_lshlrev_b32 v11, 16, v67
    v_and_b32 v31, 0xffff0000, v31
    v_and_b32 v67, 0xffff0000, v67
    v_mul_f32 v10, v10, v22
    v_mul_f32 v31, v31, v23
    v_fmac_f32 v100, v10, v11
    v_fmac_f32 v100, v31, v67
    v_lshlrev_b32 v10, 16, v32
    v_lshlrev_b32 v11, 16, v68
    v_and_b32 v32, 0xffff0000, v32
    v_and_b32 v68, 0xffff0000, v68
    v_mul_f32 v10, v10, v24
    v_mul_f32 v32, v32, v25
    v_fmac_f32 v100, v10, v11
    v_fmac_f32 v100, v32, v68
    v_lshlrev_b32 v10, 16, v33
    v_lshlrev_b32 v11, 16, v69
    v_and_b32 v33, 0xffff0000, v33
    v_and_b32 v69, 0xffff0000, v69
    v_mul_f32 v10, v10, v26
    v_mul_f32 v33, v33, v27
    v_fmac_f32 v100, v10, v11
    v_fmac_f32 v100, v33, v69
    v_lshlrev_b32 v10, 16, v34
    v_lshlrev_b32 v11, 16, v70
    v_and_b32 v34, 0xffff0000, v34
    v_and_b32 v70, 0xffff0000, v70
    v_mul_f32 v10, v10, v16
    v_mul_f32 v34, v34, v17
    v_mul_f32 v101, v10, v11
    v_fmac_f32 v101, v34, v70
    v_lshlrev_b32 v10, 16, v35
    v_lshlrev_b32 v11, 16, v71
    v_and_b32 v35, 0xffff0000, v35
    v_and_b32 v71, 0xffff0000, v71
    v_mul_f32 v10, v10, v18
    v_mul_f32 v35, v35, v19
    v_fmac_f32 v101, v10, v11
    v_fmac_f32 v101, v35, v71
    v_lshlrev_b32 v10, 16, v36
    v_lshlrev_b32 v11, 16, v72
    v_and_b32 v36, 0xffff0000, v36
    v_and_b32 v72, 0xffff0000, v72
    v_mul_f32 v10, v10, v20
    v_mul_f32 v36, v36, v21
    v_fmac_f32 v101, v10, v11
    v_fmac_f32 v101, v36, v72
    v_lshlrev_b32 v10, 16, v37
    v_lshlrev_b32 v11, 16, v73
    v_and_b32 v37, 0xffff0000, v37
    v_and_b32 v73, 0xffff0000, v73
    v_mul_f32 v10, v10, v22
    v_mul_f32 v37, v37, v23
    v_fmac_f32 v101, v10, v11
    v_fmac_f32 v101, v37, v73
    v_lshlrev_b32 v10, 16, v38
    v_lshlrev_b32 v11, 16, v74
    v_and_b32 v38, 0xffff0000, v38
    v_and_b32 v74, 0xffff0000, v74
    v_mul_f32 v10, v10, v24
    v_mul_f32 v38, v38, v25
    v_fmac_f32 v101, v10, v11
    v_fmac_f32 v101, v38, v74
    v_lshlrev_b32 v10, 16, v39
    v_lshlrev_b32 v11, 16, v75
    v_and_b32 v39, 0xffff0000, v39
    v_and_b32 v75, 0xffff0000, v75
    v_mul_f32 v10, v10, v26
    v_mul_f32 v39, v39, v27
    v_fmac_f32 v101, v10, v11
    v_fmac_f32 v101, v39, v75
    v_lshlrev_b32 v10, 16, v40
    v_lshlrev_b32 v11, 16, v76
    v_and_b32 v40, 0xffff0000, v40
    v_and_b32 v76, 0xffff0000, v76
    v_mul_f32 v10, v10, v16
    v_mul_f32 v40, v40, v17
    v_mul_f32 v102, v10, v11
    v_fmac_f32 v102, v40, v76
    v_lshlrev_b32 v10, 16, v41
    v_lshlrev_b32 v11, 16, v77
    v_and_b32 v41, 0xffff0000, v41
    v_and_b32 v77, 0xffff0000, v77
    v_mul_f32 v10, v10, v18
    v_mul_f32 v41, v41, v19
    v_fmac_f32 v102, v10, v11
    v_fmac_f32 v102, v41, v77
    v_lshlrev_b32 v10, 16, v42
    v_lshlrev_b32 v11, 16, v78
    v_and_b32 v42, 0xffff0000, v42
    v_and_b32 v78, 0xffff0000, v78
    v_mul_f32 v10, v10, v20
    v_mul_f32 v42, v42, v21
    v_fmac_f32 v102, v10, v11
    v_fmac_f32 v102, v42, v78
    v_lshlrev_b32 v10, 16, v43
    v_lshlrev_b32 v11, 16, v79
    v_and_b32 v43, 0xffff0000, v43
    v_and_b32 v79, 0xffff0000, v79
    v_mul_f32 v10, v10, v22
    v_mul_f32 v43, v43, v23
    v_fmac_f32 v102, v10, v11
    v_fmac_f32 v102, v43, v79
    v_lshlrev_b32 v10, 16, v44
    v_lshlrev_b32 v11, 16, v80
    v_and_b32 v44, 0xffff0000, v44
    v_and_b32 v80, 0xffff0000, v80
    v_mul_f32 v10, v10, v24
    v_mul_f32 v44, v44, v25
    v_fmac_f32 v102, v10, v11
    v_fmac_f32 v102, v44, v80
    v_lshlrev_b32 v10, 16, v45
    v_lshlrev_b32 v11, 16, v81
    v_and_b32 v45, 0xffff0000, v45
    v_and_b32 v81, 0xffff0000, v81
    v_mul_f32 v10, v10, v26
    v_mul_f32 v45, v45, v27
    v_fmac_f32 v102, v10, v11
    v_fmac_f32 v102, v45, v81
    v_lshlrev_b32 v10, 16, v46
    v_lshlrev_b32 v11, 16, v82
    v_and_b32 v46, 0xffff0000, v46
    v_and_b32 v82, 0xffff0000, v82
    v_mul_f32 v10, v10, v16
    v_mul_f32 v46, v46, v17
    v_mul_f32 v103, v10, v11
    v_fmac_f32 v103, v46, v82
    v_lshlrev_b32 v10, 16, v47
    v_lshlrev_b32 v11, 16, v83
    v_and_b32 v47, 0xffff0000, v47
    v_and_b32 v83, 0xffff0000, v83
    v_mul_f32 v10, v10, v18
    v_mul_f32 v47, v47, v19
    v_fmac_f32 v103, v10, v11
    v_fmac_f32 v103, v47, v83
    v_lshlrev_b32 v10, 16, v48
    v_lshlrev_b32 v11, 16, v84
    v_and_b32 v48, 0xffff0000, v48
    v_and_b32 v84, 0xffff0000, v84
    v_mul_f32 v10, v10, v20
    v_mul_f32 v48, v48, v21
    v_fmac_f32 v103, v10, v11
    v_fmac_f32 v103, v48, v84
    v_lshlrev_b32 v10, 16, v49
    v_lshlrev_b32 v11, 16, v85
    v_and_b32 v49, 0xffff0000, v49
    v_and_b32 v85, 0xffff0000, v85
    v_mul_f32 v10, v10, v22
    v_mul_f32 v49, v49, v23
    v_fmac_f32 v103, v10, v11
    v_fmac_f32 v103, v49, v85
    v_lshlrev_b32 v10, 16, v50
    v_lshlrev_b32 v11, 16, v86
    v_and_b32 v50, 0xffff0000, v50
    v_and_b32 v86, 0xffff0000, v86
    v_mul_f32 v10, v10, v24
    v_mul_f32 v50, v50, v25
    v_fmac_f32 v103, v10, v11
    v_fmac_f32 v103, v50, v86
    v_lshlrev_b32 v10, 16, v51
    v_lshlrev_b32 v11, 16, v87
    v_and_b32 v51, 0xffff0000, v51
    v_and_b32 v87, 0xffff0000, v87
    v_mul_f32 v10, v10, v26
    v_mul_f32 v51, v51, v27
    v_fmac_f32 v103, v10, v11
    v_fmac_f32 v103, v51, v87
    v_lshlrev_b32 v10, 16, v52
    v_lshlrev_b32 v11, 16, v88
    v_and_b32 v52, 0xffff0000, v52
    v_and_b32 v88, 0xffff0000, v88
    v_mul_f32 v10, v10, v16
    v_mul_f32 v52, v52, v17
    v_mul_f32 v104, v10, v11
    v_fmac_f32 v104, v52, v88
    v_lshlrev_b32 v10, 16, v53
    v_lshlrev_b32 v11, 16, v89
    v_and_b32 v53, 0xffff0000, v53
    v_and_b32 v89, 0xffff0000, v89
    v_mul_f32 v10, v10, v18
    v_mul_f32 v53, v53, v19
    v_fmac_f32 v104, v10, v11
    v_fmac_f32 v104, v53, v89
    v_lshlrev_b32 v10, 16, v54
    v_lshlrev_b32 v11, 16, v90
    v_and_b32 v54, 0xffff0000, v54
    v_and_b32 v90, 0xffff0000, v90
    v_mul_f32 v10, v10, v20
    v_mul_f32 v54, v54, v21
    v_fmac_f32 v104, v10, v11
    v_fmac_f32 v104, v54, v90
    v_lshlrev_b32 v10, 16, v55
    v_lshlrev_b32 v11, 16, v91
    v_and_b32 v55, 0xffff0000, v55
    v_and_b32 v91, 0xffff0000, v91
    v_mul_f32 v10, v10, v22
    v_mul_f32 v55, v55, v23
    v_fmac_f32 v104, v10, v11
    v_fmac_f32 v104, v55, v91
    v_lshlrev_b32 v10, 16, v56
    v_lshlrev_b32 v11, 16, v92
    v_and_b32 v56, 0xffff0000, v56
    v_and_b32 v92, 0xffff0000, v92
    v_mul_f32 v10, v10, v24
    v_mul_f32 v56, v56, v25
    v_fmac_f32 v104, v10, v11
    v_fmac_f32 v104, v56, v92
    v_lshlrev_b32 v10, 16, v57
    v_lshlrev_b32 v11, 16, v93
    v_and_b32 v57, 0xffff0000, v57
    v_and_b32 v93, 0xffff0000, v93
    v_mul_f32 v10, v10, v26
    v_mul_f32 v57, v57, v27
    v_fmac_f32 v104, v10, v11
    v_fmac_f32 v104, v57, v93
    v_lshlrev_b32 v10, 16, v58
    v_lshlrev_b32 v11, 16, v94
    v_and_b32 v58, 0xffff0000, v58
    v_and_b32 v94, 0xffff0000, v94
    v_mul_f32 v10, v10, v16
    v_mul_f32 v58, v58, v17
    v_mul_f32 v105, v10, v11
    v_fmac_f32 v105, v58, v94
    v_lshlrev_b32 v10, 16, v59
    v_lshlrev_b32 v11, 16, v95
    v_and_b32 v59, 0xffff0000, v59
    v_and_b32 v95, 0xffff0000, v95
    v_mul_f32 v10, v10, v18
    v_mul_f32 v59, v59, v19
    v_fmac_f32 v105, v10, v11
    v_fmac_f32 v105, v59, v95
    v_lshlrev_b32 v10, 16, v60
    v_lshlrev_b32 v11, 16, v96
    v_and_b32 v60, 0xffff0000, v60
    v_and_b32 v96, 0xffff0000, v96
    v_mul_f32 v10, v10, v20
    v_mul_f32 v60, v60, v21
    v_fmac_f32 v105, v10, v11
    v_fmac_f32 v105, v60, v96
    v_lshlrev_b32 v10, 16, v61
    v_lshlrev_b32 v11, 16, v97
    v_and_b32 v61, 0xffff0000, v61
    v_and_b32 v97, 0xffff0000, v97
    v_mul_f32 v10, v10, v22
    v_mul_f32 v61, v61, v23
    v_fmac_f32 v105, v10, v11
    v_fmac_f32 v105, v61, v97
    v_lshlrev_b32 v10, 16, v62
    v_lshlrev_b32 v11, 16, v98
    v_and_b32 v62, 0xffff0000, v62
    v_and_b32 v98, 0xffff0000, v98
    v_mul_f32 v10, v10, v24
    v_mul_f32 v62, v62, v25
    v_fmac_f32 v105, v10, v11
    v_fmac_f32 v105, v62, v98
    v_lshlrev_b32 v10, 16, v63
    v_lshlrev_b32 v11, 16, v99
    v_and_b32 v63, 0xffff0000, v63
    v_and_b32 v99, 0xffff0000, v99
    v_mul_f32 v10, v10, v26
    v_mul_f32 v63, v63, v27
    v_fmac_f32 v105, v10, v11
    v_fmac_f32 v105, v63, v99
    v_add_f32_dpp v100, v100, v100 row_ror:8 row_mask:0xf bank_mask:0xf
    v_add_f32_dpp v101, v101, v101 row_ror:8 row_mask:0xf bank_mask:0xf
    v_add_f32_dpp v102, v102, v102 row_ror:8 row_mask:0xf bank_mask:0xf
    v_add_f32_dpp v103, v103, v103 row_ror:8 row_mask:0xf bank_mask:0xf
    v_add_f32_dpp v104, v104, v104 row_ror:8 row_mask:0xf bank_mask:0xf
    v_add_f32_dpp v105, v105, v105 row_ror:8 row_mask:0xf bank_mask:0xf
    v_add_f32_dpp v100, v100, v100 row_ror:4 row_mask:0xf bank_mask:0xf
    v_add_f32_dpp v101, v101, v101 row_ror:4 row_mask:0xf bank_mask:0xf
    v_add_f32_dpp v102, v102, v102 row_ror:4 row_mask:0xf bank_mask:0xf
    v_add_f32_dpp v103, v103, v103 row_ror:4 row_mask:0xf bank_mask:0xf
    v_add_f32_dpp v104, v104, v104 row_ror:4 row_mask:0xf bank_mask:0xf
    v_add_f32_dpp v105, v105, v105 row_ror:4 row_mask:0xf bank_mask:0xf
    v_add_f32_dpp v100, v100, v100 row_ror:2 row_mask:0xf bank_mask:0xf
    v_add_f32_dpp v101, v101, v101 row_ror:2 row_mask:0xf bank_mask:0xf
    v_add_f32_dpp v102, v102, v102 row_ror:2 row_mask:0xf bank_mask:0xf
    v_add_f32_dpp v103, v103, v103 row_ror:2 row_mask:0xf bank_mask:0xf
    v_add_f32_dpp v104, v104, v104 row_ror:2 row_mask:0xf bank_mask:0xf
    v_add_f32_dpp v105, v105, v105 row_ror:2 row_mask:0xf bank_mask:0xf
    v_add_f32_dpp v100, v100, v100 row_ror:1 row_mask:0xf bank_mask:0xf
    v_add_f32_dpp v101, v101, v101 row_ror:1 row_mask:0xf bank_mask:0xf
    v_add_f32_dpp v102, v102, v102 row_ror:1 row_mask:0xf bank_mask:0xf
    v_add_f32_dpp v103, v103, v103 row_ror:1 row_mask:0xf bank_mask:0xf
    v_add_f32_dpp v104, v104, v104 row_ror:1 row_mask:0xf bank_mask:0xf
    v_add_f32_dpp v105, v105, v105 row_ror:1 row_mask:0xf bank_mask:0xf
    v_cmp_eq_u32 vcc, 1, v5
    s_nop 1
    v_cndmask_b32 v100, v100, v101, vcc
    v_cmp_eq_u32 vcc, 2, v5
    s_nop 1
    v_cndmask_b32 v100, v100, v102, vcc
    v_cmp_eq_u32 vcc, 3, v5
    s_nop 1
    v_cndmask_b32 v100, v100, v103, vcc
    v_cmp_eq_u32 vcc, 4, v5
    s_nop 1
    v_cndmask_b32 v100, v100, v104, vcc
    v_cmp_eq_u32 vcc, 5, v5
    s_nop 1
    v_cndmask_b32 v100, v100, v105, vcc
    s_mul_i32 s48, s62, 768
    s_lshl_b32 s49, s49, 2
    s_add_u32 s48, s48, s49
    s_add_u32 s48, s48, 1179648
    s_mov_b32 exec_lo, 0x003f003f
    s_mov_b32 exec_hi, 0x003f003f
    buffer_store_dword v100, v13, s[12:15], s48 offen sc1
    s_mov_b64 exec, -1
    s_mov_b32 s60, 0x100000
L_wf1:
    s_nop 1
    ds_read_b32 v10, v2 offset:44
    s_sub_u32 s60, s60, 1
    s_cbranch_scc1 L_exit1
    s_waitcnt lgkmcnt(0)
    v_readfirstlane_b32 s48, v10
    s_cmp_lt_u32 s48, 4
    s_cbranch_scc1 L_wf1
    s_cmp_eq_u32 s85, s88
    s_cbranch_scc1 L_fl1
    ds_read_b128 v[16:19], v4 offset:6400
    ds_read_b128 v[20:23], v4 offset:7424
    ds_read_b128 v[24:27], v4 offset:8448
    ds_read_b128 v[28:31], v4 offset:9472
    ds_read_b128 v[32:35], v4 offset:10496
    ds_read_b128 v[36:39], v4 offset:11520
    s_add_u32 s54, s33, 6144
    s_add_u32 s55, s33, 10240
    s_cmp_eq_u32 s85, s88
    s_waitcnt lgkmcnt(0)
    buffer_store_dwordx4 v[16:19], v4, s[12:15], s54 offen offset:0 sc1
    buffer_store_dwordx4 v[20:23], v4, s[12:15], s54 offen offset:1024 sc1
    buffer_store_dwordx4 v[24:27], v4, s[12:15], s54 offen offset:2048 sc1
    buffer_store_dwordx4 v[28:31], v4, s[12:15], s54 offen offset:3072 sc1
    buffer_store_dwordx4 v[32:35], v4, s[12:15], s55 offen offset:0 sc1
    buffer_store_dwordx4 v[36:39], v4, s[12:15], s55 offen offset:1024 sc1
L_fl1:
    s_nop 1
    v_mov_b32 v10, 2
    s_waitcnt vmcnt(0)
    s_mov_b64 exec, 1
    buffer_store_dword v10, off, s[12:15], s32 sc1
    ds_write_b32 v2, v10 offset:52
    s_mov_b64 exec, -1
    s_mov_b32 s60, 0x100000
L_wf2:
    s_nop 1
    ds_read_b32 v10, v2 offset:48
    s_sub_u32 s60, s60, 1
    s_cbranch_scc1 L_exit1
    s_waitcnt lgkmcnt(0)
    v_readfirstlane_b32 s48, v10
    s_cmp_lt_u32 s48, 4
    s_cbranch_scc1 L_wf2
    s_cmp_eq_u32 s86, s89
    s_cbranch_scc1 L_fl2
    ds_read_b128 v[16:19], v4 offset:12544
    ds_read_b128 v[20:23], v4 offset:13568
    ds_read_b128 v[24:27], v4 offset:14592
    ds_read_b128 v[28:31], v4 offset:15616
    ds_read_b128 v[32:35], v4 offset:16640
    ds_read_b128 v[36:39], v4 offset:17664
    s_add_u32 s54, s33, 12288
    s_add_u32 s55, s33, 16384
    s_cmp_eq_u32 s86, s89
    s_waitcnt lgkmcnt(0)
    buffer_store_dwordx4 v[16:19], v4, s[12:15], s54 offen offset:0 sc1
    buffer_store_dwordx4 v[20:23], v4, s[12:15], s54 offen offset:1024 sc1
    buffer_store_dwordx4 v[24:27], v4, s[12:15], s54 offen offset:2048 sc1
    buffer_store_dwordx4 v[28:31], v4, s[12:15], s54 offen offset:3072 sc1
    buffer_store_dwordx4 v[32:35], v4, s[12:15], s55 offen offset:0 sc1
    buffer_store_dwordx4 v[36:39], v4, s[12:15], s55 offen offset:1024 sc1
L_fl2:
    s_nop 1
    v_mov_b32 v10, 3
    s_waitcnt vmcnt(0)
    s_mov_b64 exec, 1
    s_cbranch_scc1 L_fn2
    buffer_store_dword v10, off, s[12:15], s32 sc1
L_fn2:
    s_nop 1
    ds_write_b32 v2, v10 offset:52
    s_mov_b64 exec, -1
    s_endpgm
L_h3:
    s_nop 1
    s_waitcnt lgkmcnt(0)
    s_mov_b32 s12, s82
    s_and_b32 s13, s83, 0xffff
    s_mov_b32 s14, 10485760
    s_mov_b32 s15, 0x00020000
    s_barrier
    v_lshlrev_b32 v7, 2, v1
    s_mul_i32 s20, s4, 4352
    s_add_u32 s20, s20, 10223616
    s_lshl_b32 s21, s3, 2
    s_add_u32 s21, s21, s20
    s_mov_b32 s45, 2
    v_mov_b32 v3, 144
    v_bfrev_b32 v6, -2
    s_mov_b32 exec_hi, 0
L_h3loop:
    s_nop 1
    s_mov_b32 s60, 0x100000
L_wp1:
    s_nop 1
    ds_read_b32 v10, v2 offset:128
    s_sub_u32 s60, s60, 1
    s_cbranch_scc1 L_exit1
    s_waitcnt lgkmcnt(0)
    v_readfirstlane_b32 s48, v10
    s_cmp_lt_u32 s48, s45
    s_cbranch_scc1 L_wp1
    s_memrealtime s[40:41]
    s_add_u32 s45, s45, 3
    s_mov_b32 exec_lo, 1
    s_waitcnt lgkmcnt(0)
    v_mov_b32 v5, s40
    buffer_store_dword v5, off, s[12:15], s21
    s_mov_b32 exec_lo, -1
    s_mov_b32 s60, 0x100000
L_wp2:
    s_nop 1
    ds_read_b32 v10, v2 offset:128
    s_sub_u32 s60, s60, 1
    s_cbranch_scc1 L_exit1
    s_waitcnt lgkmcnt(0)
    v_readfirstlane_b32 s48, v10
    s_cmp_lt_u32 s48, s45
    s_cbranch_scc1 L_wp2
    buffer_load_dword v5, v7, s[12:15], s20 offen sc0
    s_add_u32 s45, s45, 5
    s_add_u32 s20, s20, 128
    s_add_u32 s21, s21, 128
    s_sub_u32 s48, s40, 4096
    s_waitcnt vmcnt(0)
    v_subrev_u32 v5, s48, v5
    v_cmp_gt_u32 vcc, 8192, v5
    s_nop 1
    v_cndmask_b32 v5, v6, v5, vcc
    s_mov_b32 s48, 2048
    s_add_u32 s49, s48, 2048
    v_cmp_gt_u32 vcc, s49, v5
    s_bcnt1_i32_b64 s50, vcc
    s_cmp_lt_u32 s50, 16
    s_cselect_b32 s48, s49, s48
    s_add_u32 s49, s48, 1024
    v_cmp_gt_u32 vcc, s49, v5
    s_bcnt1_i32_b64 s50, vcc
    s_cmp_lt_u32 s50, 16
    s_cselect_b32 s48, s49, s48
    s_add_u32 s49, s48, 512
    v_cmp_gt_u32 vcc, s49, v5
    s_bcnt1_i32_b64 s50, vcc
    s_cmp_lt_u32 s50, 16
    s_cselect_b32 s48, s49, s48
    s_add_u32 s49, s48, 256
    v_cmp_gt_u32 vcc, s49, v5
    s_bcnt1_i32_b64 s50, vcc
    s_cmp_lt_u32 s50, 16
    s_cselect_b32 s48, s49, s48
    s_add_u32 s49, s48, 128
    v_cmp_gt_u32 vcc, s49, v5
    s_bcnt1_i32_b64 s50, vcc
    s_cmp_lt_u32 s50, 16
    s_cselect_b32 s48, s49, s48
    s_add_u32 s49, s48, 64
    v_cmp_gt_u32 vcc, s49, v5
    s_bcnt1_i32_b64 s50, vcc
    s_cmp_lt_u32 s50, 16
    s_cselect_b32 s48, s49, s48
    s_add_u32 s49, s48, 32
    v_cmp_gt_u32 vcc, s49, v5
    s_bcnt1_i32_b64 s50, vcc
    s_cmp_lt_u32 s50, 16
    s_cselect_b32 s48, s49, s48
    s_add_u32 s49, s48, 16
    v_cmp_gt_u32 vcc, s49, v5
    s_bcnt1_i32_b64 s50, vcc
    s_cmp_lt_u32 s50, 16
    s_cselect_b32 s48, s49, s48
    s_add_u32 s49, s48, 8
    v_cmp_gt_u32 vcc, s49, v5
    s_bcnt1_i32_b64 s50, vcc
    s_cmp_lt_u32 s50, 16
    s_cselect_b32 s48, s49, s48
    s_add_u32 s48, s48, s40
    s_sub_u32 s48, s48, 4096
    s_or_b32 s48, s48, 1
    v_mov_b32 v5, s48
    ds_write_b32 v3, v5
    v_add_u32 v3, 4, v3
    s_cmp_lt_u32 s45, 80
    s_cbranch_scc1 L_h3loop
    s_endpgm
L_h2:
    s_nop 1
    s_mov_b32 s92, s74
    s_and_b32 s93, s75, 0xffff
    s_mov_b32 s94, 2097152
    s_mov_b32 s95, 0x00020000
    s_mov_b32 s96, s76
    s_and_b32 s97, s77, 0xffff
    s_mov_b32 s98, 2097152
    s_mov_b32 s99, 0x00020000
    s_mov_b32 s60, 0x100000
L_wd2:
    s_nop 1
    ds_read_b32 v10, v2 offset:20
    s_sub_u32 s60, s60, 1
    s_cbranch_scc1 L_exit1
    s_waitcnt lgkmcnt(0)
    v_readfirstlane_b32 s48, v10
    s_cmp_eq_u32 s48, 0
    s_cbranch_scc1 L_wd2
    ds_read_b128 v[16:19], v2 offset:0
    ds_read_b64 v[20:21], v2 offset:16
    s_waitcnt lgkmcnt(0)
    v_readfirstlane_b32 s84, v16
    v_readfirstlane_b32 s85, v17
    v_readfirstlane_b32 s86, v18
    v_readfirstlane_b32 s87, v19
    v_readfirstlane_b32 s88, v20
    v_readfirstlane_b32 s89, v21
    v_and_b32 v3, 3, v1
    v_and_b32 v15, 7, v1
    v_lshrrev_b32 v12, 2, v1
    s_mov_b32 s37, 0x3dd53b95
    s_mov_b32 s38, 0xaaaaaaab
    s_mov_b32 s61, 0
    s_mul_i32 s35, s3, 147456
    s_add_u32 s35, s35, 2097152
    s_mov_b32 s40, 18432
    v_lshlrev_b32 v14, 5, v1
    v_lshrrev_b32 v8, 3, v1
    v_mul_u32_u24 v8, 24, v8
    v_mov_b32 v4, 768
    v_mad_u32_u24 v8, v15, v4, v8
    v_lshlrev_b32 v104, 4, v1
    s_mov_b32 s34, 12
L_prep:
    s_nop 1
    s_lshl_b32 s62, s61, 5
    s_add_u32 s62, s62, s3
    s_lshl_b32 s63, s62, 15
    s_add_u32 s63, s63, 1
    s_mul_hi_u32 s63, s63, 0xaaaaaaab
    s_lshr_b32 s63, s63, 7
    s_mov_b32 s32, s84
    s_mov_b32 s39, s87
    s_mov_b32 s84, s85
    s_mov_b32 s85, s86
    s_mov_b32 s87, s88
    s_mov_b32 s88, s89
    s_lshl_b32 s33, s61, 3
    s_add_u32 s33, s33, 1
    s_mov_b32 s60, 0x100000
L_wpf:
    s_nop 1
    ds_read_b32 v10, v2 offset:60
    s_sub_u32 s60, s60, 1
    s_cbranch_scc1 L_exit1
    s_waitcnt lgkmcnt(0)
    v_readfirstlane_b32 s48, v10
    s_cmp_lt_u32 s48, s33
    s_cbranch_scc1 L_wpf
    v_lshlrev_b32 v4, 4, v1
    s_mul_i32 s49, s4, 2736
    s_lshl_b32 s48, s62, 16
    s_mul_hi_u32 s48, s48, 0xaaaaaaab
    s_lshr_b32 s48, s48, 5
    s_lshl_b32 s48, s48, 4
    s_add_u32 s48, s48, s49
    buffer_load_dwordx4 v[80:83], v4, s[92:95], s48 offen offset:0
    buffer_load_dwordx4 v[84:87], v4, s[92:95], s48 offen offset:1024
    buffer_load_dwordx4 v[88:91], v4, s[92:95], s48 offen offset:2048
    buffer_load_dwordx4 v[92:95], v4, s[96:99], s48 offen offset:0
    buffer_load_dwordx4 v[96:99], v4, s[96:99], s48 offen offset:1024
    buffer_load_dwordx4 v[100:103], v4, s[96:99], s48 offen offset:2048
    s_and_b32 s48, s39, 7
    v_mov_b32 v9, s48
    s_bitcmp1_b32 s39, 3
    s_cselect_b64 vcc, -1, 0
    v_cndmask_b32 v9, v9, v15, vcc
    v_xor_b32 v13, s5, v9
    v_lshl_or_b32 v13, v3, 3, v13
    s_lshl_b32 s36, s62, 6
    s_mul_i32 s49, s62, 768
    s_lshl_b32 s50, s63, 2
    s_sub_u32 s49, s49, s50
    s_add_u32 s49, s49, 1179648
    s_add_u32 s33, s33, 4
    s_mov_b32 s60, 0x100000
L_wga:
    s_nop 1
    ds_read_b32 v10, v2 offset:60
    s_sub_u32 s60, s60, 1
    s_cbranch_scc1 L_exit1
    s_waitcnt lgkmcnt(0)
    v_readfirstlane_b32 s48, v10
    s_cmp_lt_u32 s48, s33
    s_cbranch_scc1 L_wga
    v_add_u32 v4, 0, v12
    v_bfe_u32 v5, v4, 3, 2
    v_and_or_b32 v5, v4, 4, v5
    v_xor_b32 v5, v13, v5
    v_add_u32 v4, s36, v4
    v_lshl_add_u32 v6, v4, 5, v5
    v_lshl_add_u32 v6, v6, 4, 1
    v_mul_hi_u32 v6, v6, s38
    v_lshrrev_b32 v6, 1, v6
    v_lshrrev_b32 v11, 1, v6
    v_lshlrev_b32 v11, 2, v11
    buffer_load_dwordx3 v[24:26], v11, s[92:95], 0 offen
    buffer_load_dword v27, v11, s[92:95], 0 offen offset:12
    buffer_load_dwordx3 v[28:30], v11, s[96:99], 0 offen
    buffer_load_dword v31, v11, s[96:99], 0 offen offset:12
    v_lshrrev_b32 v22, 6, v6
    v_lshl_add_u32 v22, v22, 2, s49
    v_and_b32 v7, 15, v6
    v_cmp_eq_u32 s[24:25], 5, v7
    v_and_b32 v23, 1, v6
    v_lshlrev_b32 v23, 4, v23
    s_waitcnt vmcnt(0)
    v_add_u32 v4, 16, v12
    v_bfe_u32 v5, v4, 3, 2
    v_and_or_b32 v5, v4, 4, v5
    v_xor_b32 v5, v13, v5
    v_add_u32 v4, s36, v4
    v_lshl_add_u32 v6, v4, 5, v5
    v_lshl_add_u32 v6, v6, 4, 1
    v_mul_hi_u32 v6, v6, s38
    v_lshrrev_b32 v6, 1, v6
    v_lshrrev_b32 v11, 1, v6
    v_lshlrev_b32 v11, 2, v11
    buffer_load_dwordx3 v[40:42], v11, s[92:95], 0 offen
    buffer_load_dword v43, v11, s[92:95], 0 offen offset:12
    buffer_load_dwordx3 v[44:46], v11, s[96:99], 0 offen
    buffer_load_dword v47, v11, s[96:99], 0 offen offset:12
    v_lshrrev_b32 v38, 6, v6
    v_lshl_add_u32 v38, v38, 2, s49
    v_and_b32 v7, 15, v6
    v_cmp_eq_u32 s[26:27], 5, v7
    v_and_b32 v39, 1, v6
    v_lshlrev_b32 v39, 4, v39
    s_waitcnt vmcnt(0)
    v_add_u32 v4, 32, v12
    v_bfe_u32 v5, v4, 3, 2
    v_and_or_b32 v5, v4, 4, v5
    v_xor_b32 v5, v13, v5
    v_add_u32 v4, s36, v4
    v_lshl_add_u32 v6, v4, 5, v5
    v_lshl_add_u32 v6, v6, 4, 1
    v_mul_hi_u32 v6, v6, s38
    v_lshrrev_b32 v6, 1, v6
    v_lshrrev_b32 v11, 1, v6
    v_lshlrev_b32 v11, 2, v11
    buffer_load_dwordx3 v[56:58], v11, s[92:95], 0 offen
    buffer_load_dword v59, v11, s[92:95], 0 offen offset:12
    buffer_load_dwordx3 v[60:62], v11, s[96:99], 0 offen
    buffer_load_dword v63, v11, s[96:99], 0 offen offset:12
    v_lshrrev_b32 v54, 6, v6
    v_lshl_add_u32 v54, v54, 2, s49
    v_and_b32 v7, 15, v6
    v_cmp_eq_u32 s[28:29], 5, v7
    v_and_b32 v55, 1, v6
    v_lshlrev_b32 v55, 4, v55
    s_waitcnt vmcnt(0)
    v_add_u32 v4, 48, v12
    v_bfe_u32 v5, v4, 3, 2
    v_and_or_b32 v5, v4, 4, v5
    v_xor_b32 v5, v13, v5
    v_add_u32 v4, s36, v4
    v_lshl_add_u32 v6, v4, 5, v5
    v_lshl_add_u32 v6, v6, 4, 1
    v_mul_hi_u32 v6, v6, s38
    v_lshrrev_b32 v6, 1, v6
    v_lshrrev_b32 v11, 1, v6
    v_lshlrev_b32 v11, 2, v11
    buffer_load_dwordx3 v[72:74], v11, s[92:95], 0 offen
    buffer_load_dword v75, v11, s[92:95], 0 offen offset:12
    buffer_load_dwordx3 v[76:78], v11, s[96:99], 0 offen
    buffer_load_dword v79, v11, s[96:99], 0 offen offset:12
    v_lshrrev_b32 v70, 6, v6
    v_lshl_add_u32 v70, v70, 2, s49
    v_and_b32 v7, 15, v6
    v_cmp_eq_u32 s[30:31], 5, v7
    v_and_b32 v71, 1, v6
    v_lshlrev_b32 v71, 4, v71
    s_waitcnt vmcnt(0)
    s_add_u32 s33, s61, 1
    s_mov_b32 s60, 0x100000
L_wfd:
    s_nop 1
    ds_read_b32 v10, v2 offset:52
    s_sub_u32 s60, s60, 1
    s_cbranch_scc1 L_exit1
    s_waitcnt lgkmcnt(0)
    v_readfirstlane_b32 s48, v10
    s_cmp_lt_u32 s48, s33
    s_cbranch_scc1 L_wfd
    v_mul_u32_u24 v4, 4352, v1
    s_xor_b32 s48, s32, s39
    s_xor_b32 s48, s48, s5
    s_and_b32 s48, s48, 7
    v_mov_b32 v6, s33
    s_lshl_b64 vcc, 1, s48
    s_or_b32 s48, s32, s39
    s_bitcmp1_b32 s48, 3
    s_cselect_b64 vcc, 0xff, vcc
    s_cmp_eq_u32 s32, s39
    s_cselect_b64 vcc, 0, vcc
    s_max_u32 s48, s61, 1
    v_mov_b32 v7, s48
    v_cndmask_b32 v6, v7, v6, vcc
    s_cmp_eq_u32 s61, 1
    s_cselect_b64 exec, vcc, 0xff
    s_mov_b32 s60, 0x40000
    s_cbranch_execz L_noflags
L_flags:
    s_nop 1
    buffer_load_dword v5, v4, s[12:15], s59 offen sc1
    s_sub_u32 s60, s60, 1
    s_cbranch_scc1 L_exit1
    s_waitcnt vmcnt(0)
    v_cmpx_gt_u32 vcc, v6, v5
    s_cbranch_execnz L_flags
L_noflags:
    s_nop 1
    s_mov_b64 exec, -1
    buffer_load_dword v22, v22, s[12:15], 0 offen sc1
    buffer_load_dword v38, v38, s[12:15], 0 offen sc1
    buffer_load_dword v54, v54, s[12:15], 0 offen sc1
    buffer_load_dword v70, v70, s[12:15], 0 offen sc1
    s_bitcmp1_b32 s39, 3
    s_cselect_b32 s49, 0, 7
    s_xor_b32 s50, s32, s39
    s_bitcmp1_b32 s50, 3
    s_cselect_b32 s51, 7, 0
    s_and_b32 s50, s50, 7
    s_and_b32 s52, s39, 7
    s_add_u32 s53, s35, 4096
    v_add_u32 v4, 0, v1
    v_mul_u32_u24 v5, 1366, v4
    v_lshrrev_b32 v5, 16, v5
    v_mul_u32_u24 v6, 48, v5
    v_sub_u32 v4, v4, v6
    v_cmp_gt_u32 vcc, s34, v4
    v_and_b32 v6, s51, v5
    v_xor_b32 v6, s50, v6
    v_and_b32 v5, s49, v5
    v_xor_b32 v5, s52, v5
    v_cndmask_b32 v6, v6, v5, vcc
    v_cmp_ne_u32 s[64:65], 0, v6
    v_xor_b32 v6, s5, v6
    v_mad_u32_u24 v6, v6, s40, v104
    s_mov_b64 exec, s[64:65]
    buffer_load_dwordx4 v[80:83], v6, s[12:15], s35 offen offset:0 sc1
    s_mov_b64 exec, -1
    v_add_u32 v4, 64, v1
    v_mul_u32_u24 v5, 1366, v4
    v_lshrrev_b32 v5, 16, v5
    v_mul_u32_u24 v6, 48, v5
    v_sub_u32 v4, v4, v6
    v_cmp_gt_u32 vcc, s34, v4
    v_and_b32 v6, s51, v5
    v_xor_b32 v6, s50, v6
    v_and_b32 v5, s49, v5
    v_xor_b32 v5, s52, v5
    v_cndmask_b32 v6, v6, v5, vcc
    v_cmp_ne_u32 s[66:67], 0, v6
    v_xor_b32 v6, s5, v6
    v_mad_u32_u24 v6, v6, s40, v104
    s_mov_b64 exec, s[66:67]
    buffer_load_dwordx4 v[84:87], v6, s[12:15], s35 offen offset:1024 sc1
    s_mov_b64 exec, -1
    v_add_u32 v4, 128, v1
    v_mul_u32_u24 v5, 1366, v4
    v_lshrrev_b32 v5, 16, v5
    v_mul_u32_u24 v6, 48, v5
    v_sub_u32 v4, v4, v6
    v_cmp_gt_u32 vcc, s34, v4
    v_and_b32 v6, s51, v5
    v_xor_b32 v6, s50, v6
    v_and_b32 v5, s49, v5
    v_xor_b32 v5, s52, v5
    v_cndmask_b32 v6, v6, v5, vcc
    v_cmp_ne_u32 s[68:69], 0, v6
    v_xor_b32 v6, s5, v6
    v_mad_u32_u24 v6, v6, s40, v104
    s_mov_b64 exec, s[68:69]
    buffer_load_dwordx4 v[88:91], v6, s[12:15], s35 offen offset:2048 sc1
    s_mov_b64 exec, -1
    v_add_u32 v4, 192, v1
    v_mul_u32_u24 v5, 1366, v4
    v_lshrrev_b32 v5, 16, v5
    v_mul_u32_u24 v6, 48, v5
    v_sub_u32 v4, v4, v6
    v_cmp_gt_u32 vcc, s34, v4
    v_and_b32 v6, s51, v5
    v_xor_b32 v6, s50, v6
    v_and_b32 v5, s49, v5
    v_xor_b32 v5, s52, v5
    v_cndmask_b32 v6, v6, v5, vcc
    v_cmp_ne_u32 s[70:71], 0, v6
    v_xor_b32 v6, s5, v6
    v_mad_u32_u24 v6, v6, s40, v104
    s_mov_b64 exec, s[70:71]
    buffer_load_dwordx4 v[92:95], v6, s[12:15], s35 offen offset:3072 sc1
    s_mov_b64 exec, -1
    v_add_u32 v4, 256, v1
    v_mul_u32_u24 v5, 1366, v4
    v_lshrrev_b32 v5, 16, v5
    v_mul_u32_u24 v6, 48, v5
    v_sub_u32 v4, v4, v6
    v_cmp_gt_u32 vcc, s34, v4
    v_and_b32 v6, s51, v5
    v_xor_b32 v6, s50, v6
    v_and_b32 v5, s49, v5
    v_xor_b32 v5, s52, v5
    v_cndmask_b32 v6, v6, v5, vcc
    v_cmp_ne_u32 s[72:73], 0, v6
    v_xor_b32 v6, s5, v6
    v_mad_u32_u24 v6, v6, s40, v104
    s_mov_b64 exec, s[72:73]
    buffer_load_dwordx4 v[96:99], v6, s[12:15], s53 offen offset:0 sc1
    s_mov_b64 exec, -1
    v_add_u32 v4, 320, v1
    v_mul_u32_u24 v5, 1366, v4
    v_lshrrev_b32 v5, 16, v5
    v_mul_u32_u24 v6, 48, v5
    v_sub_u32 v4, v4, v6
    v_cmp_gt_u32 vcc, s34, v4
    v_and_b32 v6, s51, v5
    v_xor_b32 v6, s50, v6
    v_and_b32 v5, s49, v5
    v_xor_b32 v5, s52, v5
    v_cndmask_b32 v6, v6, v5, vcc
    v_cmp_ne_u32 s[74:75], 0, v6
    v_xor_b32 v6, s5, v6
    v_mad_u32_u24 v6, v6, s40, v104
    s_mov_b64 exec, s[74:75]
    buffer_load_dwordx4 v[100:103], v6, s[12:15], s53 offen offset:1024 sc1
    s_mov_b64 exec, -1
    s_waitcnt vmcnt(0)
    s_mov_b64 exec, s[64:65]
    ds_write_b128 v104, v[80:83] offset:256
    s_mov_b64 exec, s[66:67]
    ds_write_b128 v104, v[84:87] offset:1280
    s_mov_b64 exec, s[68:69]
    ds_write_b128 v104, v[88:91] offset:2304
    s_mov_b64 exec, s[70:71]
    ds_write_b128 v104, v[92:95] offset:3328
    s_mov_b64 exec, s[72:73]
    ds_write_b128 v104, v[96:99] offset:4352
    s_mov_b64 exec, s[74:75]
    ds_write_b128 v104, v[100:103] offset:5376
    s_mov_b64 exec, -1
    ds_read_b64 v[16:17], v8 offset:256
    ds_read_b64 v[18:19], v8 offset:264
    ds_read_b64 v[20:21], v8 offset:272
    ds_read_b64 v[32:33], v8 offset:448
    ds_read_b64 v[34:35], v8 offset:456
    ds_read_b64 v[36:37], v8 offset:464
    ds_read_b64 v[48:49], v8 offset:640
    ds_read_b64 v[50:51], v8 offset:648
    ds_read_b64 v[52:53], v8 offset:656
    ds_read_b64 v[64:65], v8 offset:832
    ds_read_b64 v[66:67], v8 offset:840
    ds_read_b64 v[68:69], v8 offset:848
    s_mov_b32 s34, 0
    v_mov_b32 v5, 0xf149f2ca
    v_mov_b32 v4, 0xf149f2ca
    s_waitcnt vmcnt(0) lgkmcnt(0)
    v_sub_f32 v16, v16, v22
    v_sub_f32 v17, v17, v22
    v_sub_f32 v18, v18, v22
    v_sub_f32 v19, v19, v22
    v_sub_f32 v20, v20, v22
    v_sub_f32 v21, v21, v22
    v_mul_f32 v16, s37, v16
    v_mul_f32 v17, s37, v17
    v_mul_f32 v18, s37, v18
    v_mul_f32 v19, s37, v19
    v_mul_f32 v20, s37, v20
    v_mul_f32 v21, s37, v21
    v_cndmask_b32 v21, v5, v21, s[24:25]
    v_max3_f32 v4, v4, v16, v17
    v_max3_f32 v4, v4, v18, v19
    v_max3_f32 v4, v4, v20, v21
    v_alignbit_b32 v24, v25, v24, v23
    v_alignbit_b32 v25, v26, v25, v23
    v_alignbit_b32 v26, v27, v26, v23
    v_alignbit_b32 v28, v29, v28, v23
    v_alignbit_b32 v29, v30, v29, v23
    v_alignbit_b32 v30, v31, v30, v23
    v_sub_f32 v32, v32, v38
    v_sub_f32 v33, v33, v38
    v_sub_f32 v34, v34, v38
    v_sub_f32 v35, v35, v38
    v_sub_f32 v36, v36, v38
    v_sub_f32 v37, v37, v38
    v_mul_f32 v32, s37, v32
    v_mul_f32 v33, s37, v33
    v_mul_f32 v34, s37, v34
    v_mul_f32 v35, s37, v35
    v_mul_f32 v36, s37, v36
    v_mul_f32 v37, s37, v37
    v_cndmask_b32 v37, v5, v37, s[26:27]
    v_max3_f32 v4, v4, v32, v33
    v_max3_f32 v4, v4, v34, v35
    v_max3_f32 v4, v4, v36, v37
    v_alignbit_b32 v40, v41, v40, v39
    v_alignbit_b32 v41, v42, v41, v39
    v_alignbit_b32 v42, v43, v42, v39
    v_alignbit_b32 v44, v45, v44, v39
    v_alignbit_b32 v45, v46, v45, v39
    v_alignbit_b32 v46, v47, v46, v39
    v_sub_f32 v48, v48, v54
    v_sub_f32 v49, v49, v54
    v_sub_f32 v50, v50, v54
    v_sub_f32 v51, v51, v54
    v_sub_f32 v52, v52, v54
    v_sub_f32 v53, v53, v54
    v_mul_f32 v48, s37, v48
    v_mul_f32 v49, s37, v49
    v_mul_f32 v50, s37, v50
    v_mul_f32 v51, s37, v51
    v_mul_f32 v52, s37, v52
    v_mul_f32 v53, s37, v53
    v_cndmask_b32 v53, v5, v53, s[28:29]
    v_max3_f32 v4, v4, v48, v49
    v_max3_f32 v4, v4, v50, v51
    v_max3_f32 v4, v4, v52, v53
    v_alignbit_b32 v56, v57, v56, v55
    v_alignbit_b32 v57, v58, v57, v55
    v_alignbit_b32 v58, v59, v58, v55
    v_alignbit_b32 v60, v61, v60, v55
    v_alignbit_b32 v61, v62, v61, v55
    v_alignbit_b32 v62, v63, v62, v55
    v_sub_f32 v64, v64, v70
    v_sub_f32 v65, v65, v70
    v_sub_f32 v66, v66, v70
    v_sub_f32 v67, v67, v70
    v_sub_f32 v68, v68, v70
    v_sub_f32 v69, v69, v70
    v_mul_f32 v64, s37, v64
    v_mul_f32 v65, s37, v65
    v_mul_f32 v66, s37, v66
    v_mul_f32 v67, s37, v67
    v_mul_f32 v68, s37, v68
    v_mul_f32 v69, s37, v69
    v_cndmask_b32 v69, v5, v69, s[30:31]
    v_max3_f32 v4, v4, v64, v65
    v_max3_f32 v4, v4, v66, v67
    v_max3_f32 v4, v4, v68, v69
    v_alignbit_b32 v72, v73, v72, v71
    v_alignbit_b32 v73, v74, v73, v71
    v_alignbit_b32 v74, v75, v74, v71
    v_alignbit_b32 v76, v77, v76, v71
    v_alignbit_b32 v77, v78, v77, v71
    v_alignbit_b32 v78, v79, v78, v71
    v_max_f32_dpp v4, v4, v4 row_ror:8 row_mask:0xf bank_mask:0xf
    s_nop 1
    v_max_f32_dpp v4, v4, v4 row_ror:4 row_mask:0xf bank_mask:0xf
    s_nop 1
    v_max_f32_dpp v4, v4, v4 row_ror:2 row_mask:0xf bank_mask:0xf
    s_nop 1
    v_max_f32_dpp v4, v4, v4 row_ror:1 row_mask:0xf bank_mask:0xf
    v_mov_b32 v5, v4
    s_nop 1
    v_permlane32_swap_b32 v4, v5
    v_max_f32 v4, v4, v5
    v_mov_b32 v5, v4
    s_nop 1
    v_permlane16_swap_b32 v4, v5
    v_max_f32 v4, v4, v5
    v_mov_b32 v5, 0
    v_mov_b32 v6, 0
    v_sub_f32 v16, v16, v4
    v_sub_f32 v17, v17, v4
    v_sub_f32 v18, v18, v4
    v_sub_f32 v19, v19, v4
    v_sub_f32 v20, v20, v4
    v_sub_f32 v21, v21, v4
    v_exp_f32 v16, v16
    v_exp_f32 v17, v17
    v_exp_f32 v18, v18
    v_exp_f32 v19, v19
    v_exp_f32 v20, v20
    v_exp_f32 v21, v21
    v_add_f32 v5, v5, v16
    v_lshlrev_b32 v10, 16, v24
    v_lshlrev_b32 v11, 16, v28
    v_mul_f32 v16, v16, v10
    v_fmac_f32 v6, v16, v11
    v_add_f32 v5, v5, v17
    v_and_b32 v10, 0xffff0000, v24
    v_and_b32 v11, 0xffff0000, v28
    v_mul_f32 v17, v17, v10
    v_fmac_f32 v6, v17, v11
    v_add_f32 v5, v5, v18
    v_lshlrev_b32 v10, 16, v25
    v_lshlrev_b32 v11, 16, v29
    v_mul_f32 v18, v18, v10
    v_fmac_f32 v6, v18, v11
    v_add_f32 v5, v5, v19
    v_and_b32 v10, 0xffff0000, v25
    v_and_b32 v11, 0xffff0000, v29
    v_mul_f32 v19, v19, v10
    v_fmac_f32 v6, v19, v11
    v_add_f32 v5, v5, v20
    v_lshlrev_b32 v10, 16, v26
    v_lshlrev_b32 v11, 16, v30
    v_mul_f32 v20, v20, v10
    v_fmac_f32 v6, v20, v11
    v_add_f32 v5, v5, v21
    v_and_b32 v10, 0xffff0000, v26
    v_and_b32 v11, 0xffff0000, v30
    v_mul_f32 v21, v21, v10
    v_fmac_f32 v6, v21, v11
    ds_write_b128 v14, v[16:19] offset:18688
    ds_write_b64 v14, v[20:21] offset:18704
    v_sub_f32 v32, v32, v4
    v_sub_f32 v33, v33, v4
    v_sub_f32 v34, v34, v4
    v_sub_f32 v35, v35, v4
    v_sub_f32 v36, v36, v4
    v_sub_f32 v37, v37, v4
    v_exp_f32 v32, v32
    v_exp_f32 v33, v33
    v_exp_f32 v34, v34
    v_exp_f32 v35, v35
    v_exp_f32 v36, v36
    v_exp_f32 v37, v37
    v_add_f32 v5, v5, v32
    v_lshlrev_b32 v10, 16, v40
    v_lshlrev_b32 v11, 16, v44
    v_mul_f32 v32, v32, v10
    v_fmac_f32 v6, v32, v11
    v_add_f32 v5, v5, v33
    v_and_b32 v10, 0xffff0000, v40
    v_and_b32 v11, 0xffff0000, v44
    v_mul_f32 v33, v33, v10
    v_fmac_f32 v6, v33, v11
    v_add_f32 v5, v5, v34
    v_lshlrev_b32 v10, 16, v41
    v_lshlrev_b32 v11, 16, v45
    v_mul_f32 v34, v34, v10
    v_fmac_f32 v6, v34, v11
    v_add_f32 v5, v5, v35
    v_and_b32 v10, 0xffff0000, v41
    v_and_b32 v11, 0xffff0000, v45
    v_mul_f32 v35, v35, v10
    v_fmac_f32 v6, v35, v11
    v_add_f32 v5, v5, v36
    v_lshlrev_b32 v10, 16, v42
    v_lshlrev_b32 v11, 16, v46
    v_mul_f32 v36, v36, v10
    v_fmac_f32 v6, v36, v11
    v_add_f32 v5, v5, v37
    v_and_b32 v10, 0xffff0000, v42
    v_and_b32 v11, 0xffff0000, v46
    v_mul_f32 v37, v37, v10
    v_fmac_f32 v6, v37, v11
    ds_write_b128 v14, v[32:35] offset:20736
    ds_write_b64 v14, v[36:37] offset:20752
    v_sub_f32 v48, v48, v4
    v_sub_f32 v49, v49, v4
    v_sub_f32 v50, v50, v4
    v_sub_f32 v51, v51, v4
    v_sub_f32 v52, v52, v4
    v_sub_f32 v53, v53, v4
    v_exp_f32 v48, v48
    v_exp_f32 v49, v49
    v_exp_f32 v50, v50
    v_exp_f32 v51, v51
    v_exp_f32 v52, v52
    v_exp_f32 v53, v53
    v_add_f32 v5, v5, v48
    v_lshlrev_b32 v10, 16, v56
    v_lshlrev_b32 v11, 16, v60
    v_mul_f32 v48, v48, v10
    v_fmac_f32 v6, v48, v11
    v_add_f32 v5, v5, v49
    v_and_b32 v10, 0xffff0000, v56
    v_and_b32 v11, 0xffff0000, v60
    v_mul_f32 v49, v49, v10
    v_fmac_f32 v6, v49, v11
    v_add_f32 v5, v5, v50
    v_lshlrev_b32 v10, 16, v57
    v_lshlrev_b32 v11, 16, v61
    v_mul_f32 v50, v50, v10
    v_fmac_f32 v6, v50, v11
    v_add_f32 v5, v5, v51
    v_and_b32 v10, 0xffff0000, v57
    v_and_b32 v11, 0xffff0000, v61
    v_mul_f32 v51, v51, v10
    v_fmac_f32 v6, v51, v11
    v_add_f32 v5, v5, v52
    v_lshlrev_b32 v10, 16, v58
    v_lshlrev_b32 v11, 16, v62
    v_mul_f32 v52, v52, v10
    v_fmac_f32 v6, v52, v11
    v_add_f32 v5, v5, v53
    v_and_b32 v10, 0xffff0000, v58
    v_and_b32 v11, 0xffff0000, v62
    v_mul_f32 v53, v53, v10
    v_fmac_f32 v6, v53, v11
    ds_write_b128 v14, v[48:51] offset:22784
    ds_write_b64 v14, v[52:53] offset:22800
    v_sub_f32 v64, v64, v4
    v_sub_f32 v65, v65, v4
    v_sub_f32 v66, v66, v4
    v_sub_f32 v67, v67, v4
    v_sub_f32 v68, v68, v4
    v_sub_f32 v69, v69, v4
    v_exp_f32 v64, v64
    v_exp_f32 v65, v65
    v_exp_f32 v66, v66
    v_exp_f32 v67, v67
    v_exp_f32 v68, v68
    v_exp_f32 v69, v69
    v_add_f32 v5, v5, v64
    v_lshlrev_b32 v10, 16, v72
    v_lshlrev_b32 v11, 16, v76
    v_mul_f32 v64, v64, v10
    v_fmac_f32 v6, v64, v11
    v_add_f32 v5, v5, v65
    v_and_b32 v10, 0xffff0000, v72
    v_and_b32 v11, 0xffff0000, v76
    v_mul_f32 v65, v65, v10
    v_fmac_f32 v6, v65, v11
    v_add_f32 v5, v5, v66
    v_lshlrev_b32 v10, 16, v73
    v_lshlrev_b32 v11, 16, v77
    v_mul_f32 v66, v66, v10
    v_fmac_f32 v6, v66, v11
    v_add_f32 v5, v5, v67
    v_and_b32 v10, 0xffff0000, v73
    v_and_b32 v11, 0xffff0000, v77
    v_mul_f32 v67, v67, v10
    v_fmac_f32 v6, v67, v11
    v_add_f32 v5, v5, v68
    v_lshlrev_b32 v10, 16, v74
    v_lshlrev_b32 v11, 16, v78
    v_mul_f32 v68, v68, v10
    v_fmac_f32 v6, v68, v11
    v_add_f32 v5, v5, v69
    v_and_b32 v10, 0xffff0000, v74
    v_and_b32 v11, 0xffff0000, v78
    v_mul_f32 v69, v69, v10
    v_fmac_f32 v6, v69, v11
    ds_write_b128 v14, v[64:67] offset:24832
    ds_write_b64 v14, v[68:69] offset:24848
    v_add_f32_dpp v5, v5, v5 row_ror:8 row_mask:0xf bank_mask:0xf
    v_add_f32_dpp v6, v6, v6 row_ror:8 row_mask:0xf bank_mask:0xf
    s_nop 0
    v_add_f32_dpp v5, v5, v5 row_ror:4 row_mask:0xf bank_mask:0xf
    v_add_f32_dpp v6, v6, v6 row_ror:4 row_mask:0xf bank_mask:0xf
    s_nop 0
    v_add_f32_dpp v5, v5, v5 row_ror:2 row_mask:0xf bank_mask:0xf
    v_add_f32_dpp v6, v6, v6 row_ror:2 row_mask:0xf bank_mask:0xf
    s_nop 0
    v_add_f32_dpp v5, v5, v5 row_ror:1 row_mask:0xf bank_mask:0xf
    v_add_f32_dpp v6, v6, v6 row_ror:1 row_mask:0xf bank_mask:0xf
    v_mov_b32 v10, v5
    v_mov_b32 v11, v6
    s_nop 0
    v_permlane32_swap_b32 v5, v10
    v_permlane32_swap_b32 v6, v11
    v_add_f32 v5, v5, v10
    v_add_f32 v6, v6, v11
    v_mov_b32 v10, v5
    v_mov_b32 v11, v6
    s_nop 0
    v_permlane16_swap_b32 v5, v10
    v_permlane16_swap_b32 v6, v11
    v_add_f32 v5, v5, v10
    v_add_f32 v6, v6, v11
    s_lshl_b32 s48, s61, 2
    v_mov_b32 v10, s48
    v_lshlrev_b32 v11, 2, v10
    v_mov_b32 v7, s39
    s_mov_b64 exec, 1
    ds_write_b128 v11, v[4:7] offset:80
    ds_write_b32 v10, v7 offset:24
    s_lshl_b32 s48, s61, 8
    s_add_u32 s48, s48, s2
    s_lshl_b32 s48, s48, 6
    s_add_u32 s48, s48, 917504
    buffer_store_dwordx4 v[4:7], off, s[12:15], s48 sc1
    s_mov_b64 exec, -1
    v_add_u32 v14, 8192, v14
    v_add_u32 v8, 6144, v8
    v_add_u32 v104, 6144, v104
    s_add_u32 s61, s61, 1
    s_cmp_lt_u32 s61, 3
    s_cbranch_scc1 L_prep
    s_mov_b32 s61, 0
    v_lshlrev_b32 v12, 2, v1
    v_add_u32 v13, 43264, v12
    v_lshlrev_b32 v8, 4, v1
    v_mov_b32 v31, 1
L_merge:
    s_nop 1
    s_lshl_b32 s48, s61, 2
    v_mov_b32 v3, s48
    v_lshlrev_b32 v11, 2, v3
    ds_read_b128 v[4:7], v11 offset:80
    s_lshl_b32 s62, s61, 8
    s_add_u32 s62, s62, s2
    s_lshl_b32 s62, s62, 10
    s_mov_b32 s60, 0x100000
L_wm:
    s_nop 1
    ds_read_b32 v10, v3 offset:64
    s_sub_u32 s60, s60, 1
    s_cbranch_scc1 L_exit1
    s_waitcnt lgkmcnt(0)
    v_readfirstlane_b32 s48, v10
    s_cmp_lt_u32 s48, 4
    s_cbranch_scc1 L_wm
    ds_read_b32 v16, v13 offset:0
    ds_read_b32 v17, v13 offset:768
    ds_read_b32 v18, v13 offset:1536
    ds_read_b32 v19, v13 offset:2304
    ds_read_b32 v20, v13 offset:256
    ds_read_b32 v21, v13 offset:1024
    ds_read_b32 v22, v13 offset:1792
    ds_read_b32 v23, v13 offset:2560
    ds_read_b32 v24, v13 offset:512
    ds_read_b32 v25, v13 offset:1280
    ds_read_b32 v26, v13 offset:2048
    ds_read_b32 v27, v13 offset:2816
    s_waitcnt lgkmcnt(8)
    v_add_f32 v16, v16, v17
    v_add_f32 v18, v18, v19
    v_sub_f32 v16, v16, v6
    v_add_f32 v28, v16, v18
    s_waitcnt lgkmcnt(4)
    v_add_f32 v20, v20, v21
    v_add_f32 v22, v22, v23
    v_sub_f32 v20, v20, v6
    v_add_f32 v29, v20, v22
    s_waitcnt lgkmcnt(0)
    v_add_f32 v24, v24, v25
    v_add_f32 v26, v26, v27
    v_sub_f32 v24, v24, v6
    v_add_f32 v30, v24, v26
    buffer_store_dwordx4 v[28:31], v8, s[12:15], s62 offen sc1
    v_add_u32 v13, 3072, v13
    s_add_u32 s61, s61, 1
    s_cmp_lt_u32 s61, 3
    s_cbranch_scc1 L_merge
    s_endpgm
.section .rodata,"a"
.p2align 6
.amdhsa_kernel standalone__kv_cache_quant_int4_int2_kv_with_per_channel_or_per_token_scales__decode_kernel
  .amdhsa_next_free_vgpr 136
  .amdhsa_next_free_sgpr 102
  .amdhsa_accum_offset 136
  .amdhsa_group_segment_fixed_size 0
  .amdhsa_kernarg_size 80
  .amdhsa_user_sgpr_count 2
  .amdhsa_user_sgpr_kernarg_segment_ptr 1
  .amdhsa_system_sgpr_workgroup_id_x 1
.end_amdhsa_kernel
```

```asm
; @launch kernel=standalone__kv_cache_quant_int4_int2_kv_with_per_channel_or_per_token_scales__decode_kernel grid=(256,1,1) block=(512,1,1) lds=52480
.amdgcn_target "amdgcn-amd-amdhsa--gfx950"
.text
.globl standalone__kv_cache_quant_int4_int2_kv_with_per_channel_or_per_token_scales__decode_kernel
.p2align 8
.type standalone__kv_cache_quant_int4_int2_kv_with_per_channel_or_per_token_scales__decode_kernel,@function
standalone__kv_cache_quant_int4_int2_kv_with_per_channel_or_per_token_scales__decode_kernel:
    s_cmp_ge_u32 s2, 256
    s_cbranch_scc1 L_exit1
    s_load_dwordx16 s[64:79], s[0:1], 0
    s_load_dwordx4 s[80:83], s[0:1], 64
    v_lshrrev_b32 v10, 6, v0
    v_and_b32 v11, 63, v0
    v_readfirstlane_b32 s28, v10
    s_lshr_b32 s3, s2, 3
    s_and_b32 s4, s2, 7
    s_lshr_b32 s32, s2, 6
    s_xor_b32 s32, s32, s4
    s_lshr_b32 s48, s32, 1
    s_and_b32 s32, s32, 1
    s_lshl_b32 s32, s32, 2
    s_or_b32 s48, s48, s32
    s_cmp_ge_u32 s28, 4
    s_cbranch_scc1 L_helper
    v_lshrrev_b32 v1, 4, v11
    v_and_b32 v52, 15, v11
    v_lshlrev_b32 v2, 4, v52
    v_lshlrev_b32 v3, 3, v52
    v_lshlrev_b32 v62, 7, v1
    v_and_b32 v63, 0x70, v0
    v_or_b32 v63, v63, v62
    v_mov_b32 v50, v63
    s_mov_b32 s45, 768
    s_mov_b32 s46, 384
    s_mov_b32 s47, 0xaaaaaaab
    v_mov_b32 v51, 0xc0000000
    s_lshl_b32 s44, s3, 6
    s_mov_b32 s5, s48
    s_mov_b32 s29, s28
    s_lshr_b32 s33, s29, 6
    s_lshl_b32 s33, s33, 11
    s_and_b32 s32, s29, 63
    s_add_u32 s32, s32, s33
    s_add_u32 s32, s32, s44
    s_bfe_u32 s33, s32, 0x20003
    s_and_b32 s34, s32, 4
    s_or_b32 s33, s33, s34
    s_xor_b32 s33, s33, s5
    s_lshl_b32 s50, s32, 5
    s_or_b32 s50, s50, s33
    s_lshl_b32 s50, s50, 4
    s_or_b32 s50, s50, 1
    v_xor_b32 v10, s50, v50
    v_mul_hi_u32 v10, v10, s47
    v_lshrrev_b32 v10, 1, v10
    v_and_b32 v11, 15, v10
    v_cmp_eq_u32 vcc, 5, v11
    v_mad_u32_u24 v48, v10, s45, v2
    v_add_u32 v11, 3840, v48
    v_cndmask_b32 v49, v51, v11, vcc
    v_lshrrev_b32 v10, 6, v10
    v_mad_u32_u24 v9, v10, s46, v3
    s_waitcnt lgkmcnt(0)
    s_mov_b32 s30, 0
    s_mov_b32 s8, s66
    s_and_b32 s9, s67, 0xffff
    s_mov_b32 s10, 805306368
    s_mov_b32 s11, 0x00020000
    buffer_load_dwordx4 v[64:67], v48, s[8:11], 0 offen offset:0 nt
    buffer_load_dwordx4 v[68:71], v48, s[8:11], 0 offen offset:256 nt
    buffer_load_dwordx4 v[72:75], v48, s[8:11], 0 offen offset:512 nt
    buffer_load_dwordx4 v[76:79], v48, s[8:11], 0 offen offset:768 nt
    buffer_load_dwordx4 v[80:83], v48, s[8:11], 0 offen offset:1024 nt
    buffer_load_dwordx4 v[84:87], v48, s[8:11], 0 offen offset:1280 nt
    s_mov_b32 s20, s64
    s_and_b32 s21, s65, 0xffff
    s_mov_b32 s22, 12288
    s_mov_b32 s23, 0x00020000
    s_lshl_b32 s31, s30, 5
    s_add_u32 s31, s31, s3
    s_mul_i32 s31, s31, 171
    s_lshr_b32 s31, s31, 9
    s_mul_i32 s31, s31, 384
    buffer_load_dwordx2 v[36:37], v3, s[20:23], s31 offen offset:0
    buffer_load_dwordx2 v[38:39], v3, s[20:23], s31 offen offset:128
    buffer_load_dwordx2 v[40:41], v3, s[20:23], s31 offen offset:256
    s_mov_b32 s16, s70
    s_and_b32 s17, s71, 0xffff
    s_mov_b32 s18, 6291456
    s_mov_b32 s19, 0x00020000
    buffer_load_dwordx2 v[42:43], v9, s[16:19], 0 offen offset:0
    buffer_load_dwordx2 v[44:45], v9, s[16:19], 0 offen offset:128
    buffer_load_dwordx2 v[46:47], v9, s[16:19], 0 offen offset:256
    buffer_load_dwordx4 v[88:91], v48, s[8:11], 0 offen offset:1536 nt
    buffer_load_dwordx4 v[92:95], v48, s[8:11], 0 offen offset:1792 nt
    buffer_load_dwordx4 v[96:99], v48, s[8:11], 0 offen offset:2048 nt
    buffer_load_dwordx4 v[100:103], v48, s[8:11], 0 offen offset:2304 nt
    buffer_load_dwordx4 v[104:107], v48, s[8:11], 0 offen offset:2560 nt
    buffer_load_dwordx4 v[108:111], v48, s[8:11], 0 offen offset:2816 nt
    buffer_load_dwordx4 v[112:115], v48, s[8:11], 0 offen offset:3072 nt
    buffer_load_dwordx4 v[116:119], v48, s[8:11], 0 offen offset:3328 nt
    buffer_load_dwordx4 v[120:123], v48, s[8:11], 0 offen offset:3584 nt
    buffer_load_dwordx4 v[124:127], v49, s[8:11], 0 offen offset:0 nt
    buffer_load_dwordx4 v[128:131], v49, s[8:11], 0 offen offset:256 nt
    buffer_load_dwordx4 v[132:135], v49, s[8:11], 0 offen offset:512 nt
    s_mov_b32 s12, s68
    s_and_b32 s13, s69, 0xffff
    s_mov_b32 s14, 805306368
    s_mov_b32 s15, 0x00020000
    v_lshlrev_b32 v11, 5, v1
    v_bfe_u32 v4, v0, 4, 3
    v_mul_u32_u24 v4, s45, v4
    v_lshl_add_u32 v4, v52, 1, v4
    s_lshr_b32 s32, s28, 1
    s_mul_i32 s32, s32, 24
    s_add_u32 s32, s32, 256
    v_add_u32 v4, s32, v4
    v_and_b32 v5, 7, v52
    v_lshl_add_u32 v5, v5, 2, v11
    v_add_u32 v5, 18688, v5
    v_lshlrev_b32 v8, 2, v1
    v_add_u32 v8, v2, v8
    s_mul_i32 s32, s28, 768
    s_add_u32 s32, s32, 43264
    v_add_u32 v8, s32, v8
    v_mov_b32 v53, 0
    v_mov_b32 v60, 0
    v_mov_b32 v61, 0
    s_mov_b32 s42, 0x01110111
    s_mov_b32 s43, 0x01110111
    s_mov_b32 s40, 0x3b2b3b18
    s_mov_b32 s41, 0x3b2b
    s_mov_b32 s64, 0x2020200
    s_mov_b32 s65, 0x202
    s_mov_b32 s66, 0x8080800
    s_mov_b32 s67, 0x808
    s_mov_b32 s68, 0x20202000
    s_mov_b32 s69, 0x2020
    s_mov_b32 s70, 0x11031118
    s_mov_b32 s71, 0x1103
    s_mov_b32 s59, 0
    s_mov_b32 s63, 0
    s_mov_b32 s7, 0
    s_mov_b32 s62, 144
    v_mov_b32 v12, 0
    v_mov_b32 v13, 0
    v_mov_b32 v14, 0
    v_mov_b32 v15, 0
    v_mov_b32 v16, 0
    v_mov_b32 v17, 0
    v_mov_b32 v18, 0
    v_mov_b32 v19, 0
    v_mov_b32 v20, 0
    v_mov_b32 v21, 0
    v_mov_b32 v22, 0
    v_mov_b32 v23, 0
    s_barrier
    s_waitcnt vmcnt(12)
    v_lshlrev_b32 v10, 16, v36
    v_lshlrev_b32 v24, 16, v42
    v_and_b32 v11, 0xffff0000, v36
    v_and_b32 v25, 0xffff0000, v42
    v_mul_f32 v24, v24, v10
    v_mul_f32 v25, v25, v11
    v_lshlrev_b32 v10, 16, v37
    v_lshlrev_b32 v26, 16, v43
    v_and_b32 v11, 0xffff0000, v37
    v_and_b32 v27, 0xffff0000, v43
    v_mul_f32 v26, v26, v10
    v_mul_f32 v27, v27, v11
    v_lshlrev_b32 v10, 16, v38
    v_lshlrev_b32 v28, 16, v44
    v_and_b32 v11, 0xffff0000, v38
    v_and_b32 v29, 0xffff0000, v44
    v_mul_f32 v28, v28, v10
    v_mul_f32 v29, v29, v11
    v_lshlrev_b32 v10, 16, v39
    v_lshlrev_b32 v30, 16, v45
    v_and_b32 v11, 0xffff0000, v39
    v_and_b32 v31, 0xffff0000, v45
    v_mul_f32 v30, v30, v10
    v_mul_f32 v31, v31, v11
    v_lshlrev_b32 v10, 16, v40
    v_lshlrev_b32 v32, 16, v46
    v_and_b32 v11, 0xffff0000, v40
    v_and_b32 v33, 0xffff0000, v46
    v_mul_f32 v32, v32, v10
    v_mul_f32 v33, v33, v11
    v_lshlrev_b32 v10, 16, v41
    v_lshlrev_b32 v34, 16, v47
    v_and_b32 v11, 0xffff0000, v41
    v_and_b32 v35, 0xffff0000, v47
    v_mul_f32 v34, v34, v10
    v_mul_f32 v35, v35, v11
    v_cvt_f32_i32 v64, v64
    v_cvt_f32_i32 v65, v65
    v_cvt_f32_i32 v66, v66
    v_cvt_f32_i32 v67, v67
    v_mul_f32 v54, v64, v24
    v_fmac_f32 v54, v65, v25
    v_fmac_f32 v54, v66, v26
    v_fmac_f32 v54, v67, v27
    v_cvt_f32_i32 v68, v68
    v_cvt_f32_i32 v69, v69
    v_cvt_f32_i32 v70, v70
    v_cvt_f32_i32 v71, v71
    v_fmac_f32 v54, v68, v28
    v_fmac_f32 v54, v69, v29
    v_fmac_f32 v54, v70, v30
    v_fmac_f32 v54, v71, v31
    v_cvt_f32_i32 v72, v72
    v_cvt_f32_i32 v73, v73
    v_cvt_f32_i32 v74, v74
    v_cvt_f32_i32 v75, v75
    v_fmac_f32 v54, v72, v32
    v_fmac_f32 v54, v73, v33
    v_fmac_f32 v54, v74, v34
    v_fmac_f32 v54, v75, v35
    v_cvt_f32_i32 v76, v76
    v_cvt_f32_i32 v77, v77
    v_add_f32_dpp v54, v54, v54 row_ror:8 row_mask:0xf bank_mask:0xf
    v_cvt_f32_i32 v78, v78
    v_cvt_f32_i32 v79, v79
    v_add_f32_dpp v54, v54, v54 row_ror:4 row_mask:0xf bank_mask:0xf
    v_mul_f32 v55, v76, v24
    v_fmac_f32 v55, v77, v25
    v_add_f32_dpp v54, v54, v54 row_ror:2 row_mask:0xf bank_mask:0xf
    v_fmac_f32 v55, v78, v26
    v_fmac_f32 v55, v79, v27
    v_add_f32_dpp v60, v54, v54 row_ror:1 row_mask:0xf bank_mask:0x1
    v_cvt_f32_i32 v80, v80
    v_cvt_f32_i32 v81, v81
    v_cvt_f32_i32 v82, v82
    v_cvt_f32_i32 v83, v83
    v_fmac_f32 v55, v80, v28
    v_fmac_f32 v55, v81, v29
    v_fmac_f32 v55, v82, v30
    v_fmac_f32 v55, v83, v31
    v_cvt_f32_i32 v84, v84
    v_cvt_f32_i32 v85, v85
    v_cvt_f32_i32 v86, v86
    v_cvt_f32_i32 v87, v87
    v_fmac_f32 v55, v84, v32
    v_fmac_f32 v55, v85, v33
    v_fmac_f32 v55, v86, v34
    v_fmac_f32 v55, v87, v35
    s_nop 1
    v_add_f32_dpp v55, v55, v55 row_ror:8 row_mask:0xf bank_mask:0xf
    s_nop 1
    v_add_f32_dpp v55, v55, v55 row_ror:4 row_mask:0xf bank_mask:0xf
    s_nop 1
    v_add_f32_dpp v55, v55, v55 row_ror:2 row_mask:0xf bank_mask:0xf
    s_nop 1
    v_add_f32_dpp v61, v55, v55 row_ror:1 row_mask:0xf bank_mask:0x1
    s_waitcnt vmcnt(6)
    s_add_u32 s29, s29, 4
    s_add_u32 s30, s30, 1
    s_lshr_b32 s33, s29, 6
    s_lshl_b32 s33, s33, 11
    s_and_b32 s32, s29, 63
    s_add_u32 s32, s32, s33
    s_add_u32 s32, s32, s44
    s_bfe_u32 s33, s32, 0x20003
    s_and_b32 s34, s32, 4
    s_or_b32 s33, s33, s34
    s_xor_b32 s33, s33, s5
    s_lshl_b32 s50, s32, 5
    s_or_b32 s50, s50, s33
    s_lshl_b32 s50, s50, 4
    s_or_b32 s50, s50, 1
    v_xor_b32 v10, s50, v50
    v_mul_hi_u32 v10, v10, s47
    v_lshrrev_b32 v10, 1, v10
    v_and_b32 v11, 15, v10
    v_cmp_eq_u32 vcc, 5, v11
    v_mad_u32_u24 v48, v10, s45, v2
    v_add_u32 v11, 3840, v48
    v_cndmask_b32 v49, v51, v11, vcc
    v_lshrrev_b32 v10, 6, v10
    v_mad_u32_u24 v9, v10, s46, v3
    buffer_load_dwordx2 v[42:43], v9, s[16:19], 0 offen offset:0
    buffer_load_dwordx2 v[44:45], v9, s[16:19], 0 offen offset:128
    buffer_load_dwordx2 v[46:47], v9, s[16:19], 0 offen offset:256
    v_cvt_f32_i32 v88, v88
    v_cvt_f32_i32 v89, v89
    v_cvt_f32_i32 v90, v90
    v_cvt_f32_i32 v91, v91
    v_mul_f32 v56, v88, v24
    v_fmac_f32 v56, v89, v25
    v_fmac_f32 v56, v90, v26
    v_fmac_f32 v56, v91, v27
    v_cvt_f32_i32 v92, v92
    v_cvt_f32_i32 v93, v93
    v_cvt_f32_i32 v94, v94
    v_cvt_f32_i32 v95, v95
    v_fmac_f32 v56, v92, v28
    v_fmac_f32 v56, v93, v29
    v_fmac_f32 v56, v94, v30
    v_fmac_f32 v56, v95, v31
    v_cvt_f32_i32 v96, v96
    v_cvt_f32_i32 v97, v97
    v_cvt_f32_i32 v98, v98
    v_cvt_f32_i32 v99, v99
    v_fmac_f32 v56, v96, v32
    v_fmac_f32 v56, v97, v33
    v_fmac_f32 v56, v98, v34
    v_fmac_f32 v56, v99, v35
    v_cvt_f32_i32 v100, v100
    v_cvt_f32_i32 v101, v101
    v_add_f32_dpp v56, v56, v56 row_ror:8 row_mask:0xf bank_mask:0xf
    v_cvt_f32_i32 v102, v102
    v_cvt_f32_i32 v103, v103
    v_add_f32_dpp v56, v56, v56 row_ror:4 row_mask:0xf bank_mask:0xf
    v_mul_f32 v57, v100, v24
    v_fmac_f32 v57, v101, v25
    v_add_f32_dpp v56, v56, v56 row_ror:2 row_mask:0xf bank_mask:0xf
    v_fmac_f32 v57, v102, v26
    v_fmac_f32 v57, v103, v27
    v_add_f32_dpp v60, v56, v56 row_ror:1 row_mask:0xf bank_mask:0x2
    v_cvt_f32_i32 v104, v104
    v_cvt_f32_i32 v105, v105
    v_cvt_f32_i32 v106, v106
    v_cvt_f32_i32 v107, v107
    v_fmac_f32 v57, v104, v28
    v_fmac_f32 v57, v105, v29
    v_fmac_f32 v57, v106, v30
    v_fmac_f32 v57, v107, v31
    v_cvt_f32_i32 v108, v108
    v_cvt_f32_i32 v109, v109
    v_cvt_f32_i32 v110, v110
    v_cvt_f32_i32 v111, v111
    v_fmac_f32 v57, v108, v32
    v_fmac_f32 v57, v109, v33
    v_fmac_f32 v57, v110, v34
    v_fmac_f32 v57, v111, v35
    s_nop 1
    v_add_f32_dpp v57, v57, v57 row_ror:8 row_mask:0xf bank_mask:0xf
    s_nop 1
    v_add_f32_dpp v57, v57, v57 row_ror:4 row_mask:0xf bank_mask:0xf
    s_nop 1
    v_add_f32_dpp v57, v57, v57 row_ror:2 row_mask:0xf bank_mask:0xf
    s_nop 1
    v_add_f32_dpp v61, v57, v57 row_ror:1 row_mask:0xf bank_mask:0x2
    s_waitcnt vmcnt(3)
    buffer_load_dwordx4 v[64:67], v48, s[8:11], 0 offen offset:0 nt
    buffer_load_dwordx4 v[68:71], v48, s[8:11], 0 offen offset:256 nt
    buffer_load_dwordx4 v[72:75], v48, s[8:11], 0 offen offset:512 nt
    buffer_load_dwordx4 v[76:79], v48, s[8:11], 0 offen offset:768 nt
    buffer_load_dwordx4 v[80:83], v48, s[8:11], 0 offen offset:1024 nt
    buffer_load_dwordx4 v[84:87], v48, s[8:11], 0 offen offset:1280 nt
    v_cvt_f32_i32 v112, v112
    v_cvt_f32_i32 v113, v113
    v_cvt_f32_i32 v114, v114
    v_cvt_f32_i32 v115, v115
    v_mul_f32 v58, v112, v24
    v_fmac_f32 v58, v113, v25
    v_fmac_f32 v58, v114, v26
    v_fmac_f32 v58, v115, v27
    v_cvt_f32_i32 v116, v116
    v_cvt_f32_i32 v117, v117
    v_cvt_f32_i32 v118, v118
    v_cvt_f32_i32 v119, v119
    v_fmac_f32 v58, v116, v28
    v_fmac_f32 v58, v117, v29
    v_fmac_f32 v58, v118, v30
    v_fmac_f32 v58, v119, v31
    v_cvt_f32_i32 v120, v120
    v_cvt_f32_i32 v121, v121
    v_cvt_f32_i32 v122, v122
    v_cvt_f32_i32 v123, v123
    v_fmac_f32 v58, v120, v32
    v_fmac_f32 v58, v121, v33
    v_fmac_f32 v58, v122, v34
    v_fmac_f32 v58, v123, v35
    v_cvt_f32_i32 v124, v124
    v_cvt_f32_i32 v125, v125
    v_add_f32_dpp v58, v58, v58 row_ror:8 row_mask:0xf bank_mask:0xf
    v_cvt_f32_i32 v126, v126
    v_cvt_f32_i32 v127, v127
    v_add_f32_dpp v58, v58, v58 row_ror:4 row_mask:0xf bank_mask:0xf
    v_mul_f32 v59, v124, v24
    v_fmac_f32 v59, v125, v25
    v_add_f32_dpp v58, v58, v58 row_ror:2 row_mask:0xf bank_mask:0xf
    v_fmac_f32 v59, v126, v26
    v_fmac_f32 v59, v127, v27
    v_add_f32_dpp v60, v58, v58 row_ror:1 row_mask:0xf bank_mask:0x4
    v_cvt_f32_i32 v128, v128
    v_cvt_f32_i32 v129, v129
    v_cvt_f32_i32 v130, v130
    v_cvt_f32_i32 v131, v131
    v_fmac_f32 v59, v128, v28
    v_fmac_f32 v59, v129, v29
    v_fmac_f32 v59, v130, v30
    v_fmac_f32 v59, v131, v31
    v_cvt_f32_i32 v132, v132
    v_cvt_f32_i32 v133, v133
    v_cvt_f32_i32 v134, v134
    v_cvt_f32_i32 v135, v135
    v_fmac_f32 v59, v132, v32
    v_fmac_f32 v59, v133, v33
    v_fmac_f32 v59, v134, v34
    v_fmac_f32 v59, v135, v35
    s_nop 1
    v_add_f32_dpp v59, v59, v59 row_ror:8 row_mask:0xf bank_mask:0xf
    s_nop 1
    v_add_f32_dpp v59, v59, v59 row_ror:4 row_mask:0xf bank_mask:0xf
    s_nop 1
    v_add_f32_dpp v59, v59, v59 row_ror:2 row_mask:0xf bank_mask:0xf
    s_nop 1
    v_add_f32_dpp v61, v59, v59 row_ror:1 row_mask:0xf bank_mask:0x4
    s_mov_b64 exec, s[42:43]
    ds_write_b64 v4, v[60:61]
    s_mov_b64 exec, -1
    v_add_u32 v4, 48, v4
    s_waitcnt vmcnt(6)
    v_lshlrev_b32 v10, 16, v36
    v_lshlrev_b32 v24, 16, v42
    v_and_b32 v11, 0xffff0000, v36
    v_and_b32 v25, 0xffff0000, v42
    v_mul_f32 v24, v24, v10
    v_mul_f32 v25, v25, v11
    v_lshlrev_b32 v10, 16, v37
    v_lshlrev_b32 v26, 16, v43
    v_and_b32 v11, 0xffff0000, v37
    v_and_b32 v27, 0xffff0000, v43
    v_mul_f32 v26, v26, v10
    v_mul_f32 v27, v27, v11
    v_lshlrev_b32 v10, 16, v38
    v_lshlrev_b32 v28, 16, v44
    v_and_b32 v11, 0xffff0000, v38
    v_and_b32 v29, 0xffff0000, v44
    v_mul_f32 v28, v28, v10
    v_mul_f32 v29, v29, v11
    v_lshlrev_b32 v10, 16, v39
    v_lshlrev_b32 v30, 16, v45
    v_and_b32 v11, 0xffff0000, v39
    v_and_b32 v31, 0xffff0000, v45
    v_mul_f32 v30, v30, v10
    v_mul_f32 v31, v31, v11
    v_lshlrev_b32 v10, 16, v40
    v_lshlrev_b32 v32, 16, v46
    v_and_b32 v11, 0xffff0000, v40
    v_and_b32 v33, 0xffff0000, v46
    v_mul_f32 v32, v32, v10
    v_mul_f32 v33, v33, v11
    v_lshlrev_b32 v10, 16, v41
    v_lshlrev_b32 v34, 16, v47
    v_and_b32 v11, 0xffff0000, v41
    v_and_b32 v35, 0xffff0000, v47
    v_mul_f32 v34, v34, v10
    v_mul_f32 v35, v35, v11
.p2align 6
L_kloop:
    s_nop 1
    s_waitcnt vmcnt(0)
    buffer_load_dwordx4 v[88:91], v48, s[8:11], 0 offen offset:1536 nt
    buffer_load_dwordx4 v[92:95], v48, s[8:11], 0 offen offset:1792 nt
    buffer_load_dwordx4 v[96:99], v48, s[8:11], 0 offen offset:2048 nt
    buffer_load_dwordx4 v[100:103], v48, s[8:11], 0 offen offset:2304 nt
    buffer_load_dwordx4 v[104:107], v48, s[8:11], 0 offen offset:2560 nt
    buffer_load_dwordx4 v[108:111], v48, s[8:11], 0 offen offset:2816 nt
    v_cvt_f32_i32 v64, v64
    v_cvt_f32_i32 v65, v65
    v_cvt_f32_i32 v66, v66
    v_cvt_f32_i32 v67, v67
    v_mul_f32 v54, v64, v24
    v_fmac_f32 v54, v65, v25
    v_fmac_f32 v54, v66, v26
    v_fmac_f32 v54, v67, v27
    v_cvt_f32_i32 v68, v68
    v_cvt_f32_i32 v69, v69
    v_cvt_f32_i32 v70, v70
    v_cvt_f32_i32 v71, v71
    v_fmac_f32 v54, v68, v28
    v_fmac_f32 v54, v69, v29
    v_fmac_f32 v54, v70, v30
    v_fmac_f32 v54, v71, v31
    v_cvt_f32_i32 v72, v72
    v_cvt_f32_i32 v73, v73
    v_cvt_f32_i32 v74, v74
    v_cvt_f32_i32 v75, v75
    v_fmac_f32 v54, v72, v32
    v_fmac_f32 v54, v73, v33
    v_fmac_f32 v54, v74, v34
    v_fmac_f32 v54, v75, v35
    v_cvt_f32_i32 v76, v76
    v_cvt_f32_i32 v77, v77
    v_add_f32_dpp v54, v54, v54 row_ror:8 row_mask:0xf bank_mask:0xf
    v_cvt_f32_i32 v78, v78
    v_cvt_f32_i32 v79, v79
    v_add_f32_dpp v54, v54, v54 row_ror:4 row_mask:0xf bank_mask:0xf
    v_mul_f32 v55, v76, v24
    v_fmac_f32 v55, v77, v25
    v_add_f32_dpp v54, v54, v54 row_ror:2 row_mask:0xf bank_mask:0xf
    v_fmac_f32 v55, v78, v26
    v_fmac_f32 v55, v79, v27
    v_add_f32_dpp v60, v54, v54 row_ror:1 row_mask:0xf bank_mask:0x1
    v_cvt_f32_i32 v80, v80
    v_cvt_f32_i32 v81, v81
    v_cvt_f32_i32 v82, v82
    v_cvt_f32_i32 v83, v83
    v_fmac_f32 v55, v80, v28
    v_fmac_f32 v55, v81, v29
    v_fmac_f32 v55, v82, v30
    v_fmac_f32 v55, v83, v31
    v_cvt_f32_i32 v84, v84
    v_cvt_f32_i32 v85, v85
    v_cvt_f32_i32 v86, v86
    v_cvt_f32_i32 v87, v87
    v_fmac_f32 v55, v84, v32
    v_fmac_f32 v55, v85, v33
    v_fmac_f32 v55, v86, v34
    v_fmac_f32 v55, v87, v35
    s_nop 1
    v_add_f32_dpp v55, v55, v55 row_ror:8 row_mask:0xf bank_mask:0xf
    s_nop 1
    v_add_f32_dpp v55, v55, v55 row_ror:4 row_mask:0xf bank_mask:0xf
    s_nop 1
    v_add_f32_dpp v55, v55, v55 row_ror:2 row_mask:0xf bank_mask:0xf
    s_nop 1
    v_add_f32_dpp v61, v55, v55 row_ror:1 row_mask:0xf bank_mask:0x1
    s_waitcnt vmcnt(0)
    buffer_load_dwordx4 v[112:115], v48, s[8:11], 0 offen offset:3072 nt
    buffer_load_dwordx4 v[116:119], v48, s[8:11], 0 offen offset:3328 nt
    buffer_load_dwordx4 v[120:123], v48, s[8:11], 0 offen offset:3584 nt
    buffer_load_dwordx4 v[124:127], v49, s[8:11], 0 offen offset:0 nt
    buffer_load_dwordx4 v[128:131], v49, s[8:11], 0 offen offset:256 nt
    buffer_load_dwordx4 v[132:135], v49, s[8:11], 0 offen offset:512 nt
    s_add_u32 s29, s29, 4
    s_add_u32 s30, s30, 1
    s_bitcmp1_b64 s[40:41], s30
    s_cbranch_scc1 L_evK
L_evretK:
    s_nop 1
    s_lshr_b32 s33, s29, 6
    s_lshl_b32 s33, s33, 11
    s_and_b32 s32, s29, 63
    s_add_u32 s32, s32, s33
    s_add_u32 s32, s32, s44
    s_bfe_u32 s33, s32, 0x20003
    s_and_b32 s34, s32, 4
    s_or_b32 s33, s33, s34
    s_xor_b32 s33, s33, s5
    s_lshl_b32 s50, s32, 5
    s_or_b32 s50, s50, s33
    s_lshl_b32 s50, s50, 4
    s_or_b32 s50, s50, 1
    v_xor_b32 v10, s50, v50
    v_mul_hi_u32 v10, v10, s47
    v_lshrrev_b32 v10, 1, v10
    v_and_b32 v11, 15, v10
    v_cmp_eq_u32 vcc, 5, v11
    v_mad_u32_u24 v48, v10, s45, v2
    v_add_u32 v11, 3840, v48
    v_cndmask_b32 v49, v51, v11, vcc
    v_lshrrev_b32 v10, 6, v10
    v_mad_u32_u24 v9, v10, s46, v3
    buffer_load_dwordx2 v[42:43], v9, s[16:19], 0 offen offset:0
    buffer_load_dwordx2 v[44:45], v9, s[16:19], 0 offen offset:128
    buffer_load_dwordx2 v[46:47], v9, s[16:19], 0 offen offset:256
    v_cvt_f32_i32 v88, v88
    v_cvt_f32_i32 v89, v89
    v_cvt_f32_i32 v90, v90
    v_cvt_f32_i32 v91, v91
    v_mul_f32 v56, v88, v24
    v_fmac_f32 v56, v89, v25
    v_fmac_f32 v56, v90, v26
    v_fmac_f32 v56, v91, v27
    v_cvt_f32_i32 v92, v92
    v_cvt_f32_i32 v93, v93
    v_cvt_f32_i32 v94, v94
    v_cvt_f32_i32 v95, v95
    v_fmac_f32 v56, v92, v28
    v_fmac_f32 v56, v93, v29
    v_fmac_f32 v56, v94, v30
    v_fmac_f32 v56, v95, v31
    v_cvt_f32_i32 v96, v96
    v_cvt_f32_i32 v97, v97
    v_cvt_f32_i32 v98, v98
    v_cvt_f32_i32 v99, v99
    v_fmac_f32 v56, v96, v32
    v_fmac_f32 v56, v97, v33
    v_fmac_f32 v56, v98, v34
    v_fmac_f32 v56, v99, v35
    v_cvt_f32_i32 v100, v100
    v_cvt_f32_i32 v101, v101
    v_add_f32_dpp v56, v56, v56 row_ror:8 row_mask:0xf bank_mask:0xf
    v_cvt_f32_i32 v102, v102
    v_cvt_f32_i32 v103, v103
    v_add_f32_dpp v56, v56, v56 row_ror:4 row_mask:0xf bank_mask:0xf
    v_mul_f32 v57, v100, v24
    v_fmac_f32 v57, v101, v25
    v_add_f32_dpp v56, v56, v56 row_ror:2 row_mask:0xf bank_mask:0xf
    v_fmac_f32 v57, v102, v26
    v_fmac_f32 v57, v103, v27
    v_add_f32_dpp v60, v56, v56 row_ror:1 row_mask:0xf bank_mask:0x2
    v_cvt_f32_i32 v104, v104
    v_cvt_f32_i32 v105, v105
    v_cvt_f32_i32 v106, v106
    v_cvt_f32_i32 v107, v107
    v_fmac_f32 v57, v104, v28
    v_fmac_f32 v57, v105, v29
    v_fmac_f32 v57, v106, v30
    v_fmac_f32 v57, v107, v31
    v_cvt_f32_i32 v108, v108
    v_cvt_f32_i32 v109, v109
    v_cvt_f32_i32 v110, v110
    v_cvt_f32_i32 v111, v111
    v_fmac_f32 v57, v108, v32
    v_fmac_f32 v57, v109, v33
    v_fmac_f32 v57, v110, v34
    v_fmac_f32 v57, v111, v35
    s_nop 1
    v_add_f32_dpp v57, v57, v57 row_ror:8 row_mask:0xf bank_mask:0xf
    s_nop 1
    v_add_f32_dpp v57, v57, v57 row_ror:4 row_mask:0xf bank_mask:0xf
    s_nop 1
    v_add_f32_dpp v57, v57, v57 row_ror:2 row_mask:0xf bank_mask:0xf
    s_nop 1
    v_add_f32_dpp v61, v57, v57 row_ror:1 row_mask:0xf bank_mask:0x2
    s_waitcnt vmcnt(3)
    buffer_load_dwordx4 v[64:67], v48, s[8:11], 0 offen offset:0 nt
    buffer_load_dwordx4 v[68:71], v48, s[8:11], 0 offen offset:256 nt
    buffer_load_dwordx4 v[72:75], v48, s[8:11], 0 offen offset:512 nt
    buffer_load_dwordx4 v[76:79], v48, s[8:11], 0 offen offset:768 nt
    buffer_load_dwordx4 v[80:83], v48, s[8:11], 0 offen offset:1024 nt
    buffer_load_dwordx4 v[84:87], v48, s[8:11], 0 offen offset:1280 nt
    v_cvt_f32_i32 v112, v112
    v_cvt_f32_i32 v113, v113
    v_cvt_f32_i32 v114, v114
    v_cvt_f32_i32 v115, v115
    v_mul_f32 v58, v112, v24
    v_fmac_f32 v58, v113, v25
    v_fmac_f32 v58, v114, v26
    v_fmac_f32 v58, v115, v27
    v_cvt_f32_i32 v116, v116
    v_cvt_f32_i32 v117, v117
    v_cvt_f32_i32 v118, v118
    v_cvt_f32_i32 v119, v119
    v_fmac_f32 v58, v116, v28
    v_fmac_f32 v58, v117, v29
    v_fmac_f32 v58, v118, v30
    v_fmac_f32 v58, v119, v31
    v_cvt_f32_i32 v120, v120
    v_cvt_f32_i32 v121, v121
    v_cvt_f32_i32 v122, v122
    v_cvt_f32_i32 v123, v123
    v_fmac_f32 v58, v120, v32
    v_fmac_f32 v58, v121, v33
    v_fmac_f32 v58, v122, v34
    v_fmac_f32 v58, v123, v35
    v_cvt_f32_i32 v124, v124
    v_cvt_f32_i32 v125, v125
    v_add_f32_dpp v58, v58, v58 row_ror:8 row_mask:0xf bank_mask:0xf
    v_cvt_f32_i32 v126, v126
    v_cvt_f32_i32 v127, v127
    v_add_f32_dpp v58, v58, v58 row_ror:4 row_mask:0xf bank_mask:0xf
    v_mul_f32 v59, v124, v24
    v_fmac_f32 v59, v125, v25
    v_add_f32_dpp v58, v58, v58 row_ror:2 row_mask:0xf bank_mask:0xf
    v_fmac_f32 v59, v126, v26
    v_fmac_f32 v59, v127, v27
    v_add_f32_dpp v60, v58, v58 row_ror:1 row_mask:0xf bank_mask:0x4
    v_cvt_f32_i32 v128, v128
    v_cvt_f32_i32 v129, v129
    v_cvt_f32_i32 v130, v130
    v_cvt_f32_i32 v131, v131
    v_fmac_f32 v59, v128, v28
    v_fmac_f32 v59, v129, v29
    v_fmac_f32 v59, v130, v30
    v_fmac_f32 v59, v131, v31
    v_cvt_f32_i32 v132, v132
    v_cvt_f32_i32 v133, v133
    v_cvt_f32_i32 v134, v134
    v_cvt_f32_i32 v135, v135
    v_fmac_f32 v59, v132, v32
    v_fmac_f32 v59, v133, v33
    v_fmac_f32 v59, v134, v34
    v_fmac_f32 v59, v135, v35
    s_nop 1
    v_add_f32_dpp v59, v59, v59 row_ror:8 row_mask:0xf bank_mask:0xf
    s_nop 1
    v_add_f32_dpp v59, v59, v59 row_ror:4 row_mask:0xf bank_mask:0xf
    s_nop 1
    v_add_f32_dpp v59, v59, v59 row_ror:2 row_mask:0xf bank_mask:0xf
    s_nop 1
    v_add_f32_dpp v61, v59, v59 row_ror:1 row_mask:0xf bank_mask:0x4
    s_mov_b64 exec, s[42:43]
    ds_write_b64 v4, v[60:61]
    s_mov_b64 exec, -1
    v_add_u32 v4, 48, v4
    s_waitcnt vmcnt(6)
    v_lshlrev_b32 v10, 16, v36
    v_lshlrev_b32 v24, 16, v42
    v_and_b32 v11, 0xffff0000, v36
    v_and_b32 v25, 0xffff0000, v42
    v_mul_f32 v24, v24, v10
    v_mul_f32 v25, v25, v11
    v_lshlrev_b32 v10, 16, v37
    v_lshlrev_b32 v26, 16, v43
    v_and_b32 v11, 0xffff0000, v37
    v_and_b32 v27, 0xffff0000, v43
    v_mul_f32 v26, v26, v10
    v_mul_f32 v27, v27, v11
    v_lshlrev_b32 v10, 16, v38
    v_lshlrev_b32 v28, 16, v44
    v_and_b32 v11, 0xffff0000, v38
    v_and_b32 v29, 0xffff0000, v44
    v_mul_f32 v28, v28, v10
    v_mul_f32 v29, v29, v11
    v_lshlrev_b32 v10, 16, v39
    v_lshlrev_b32 v30, 16, v45
    v_and_b32 v11, 0xffff0000, v39
    v_and_b32 v31, 0xffff0000, v45
    v_mul_f32 v30, v30, v10
    v_mul_f32 v31, v31, v11
    v_lshlrev_b32 v10, 16, v40
    v_lshlrev_b32 v32, 16, v46
    v_and_b32 v11, 0xffff0000, v40
    v_and_b32 v33, 0xffff0000, v46
    v_mul_f32 v32, v32, v10
    v_mul_f32 v33, v33, v11
    v_lshlrev_b32 v10, 16, v41
    v_lshlrev_b32 v34, 16, v47
    v_and_b32 v11, 0xffff0000, v41
    v_and_b32 v35, 0xffff0000, v47
    v_mul_f32 v34, v34, v10
    v_mul_f32 v35, v35, v11
L_kchk:
    s_nop 1
    s_cmp_lg_u32 s59, 0
    s_cbranch_scc1 L_kboost
L_kchk2:
    s_nop 1
    s_cmp_lg_u32 s30, 47
    s_cbranch_scc1 L_kloop
    s_waitcnt vmcnt(0)
    buffer_load_dwordx4 v[88:91], v48, s[8:11], 0 offen offset:1536 nt
    buffer_load_dwordx4 v[92:95], v48, s[8:11], 0 offen offset:1792 nt
    buffer_load_dwordx4 v[96:99], v48, s[8:11], 0 offen offset:2048 nt
    buffer_load_dwordx4 v[100:103], v48, s[8:11], 0 offen offset:2304 nt
    buffer_load_dwordx4 v[104:107], v48, s[8:11], 0 offen offset:2560 nt
    buffer_load_dwordx4 v[108:111], v48, s[8:11], 0 offen offset:2816 nt
    v_cvt_f32_i32 v64, v64
    v_cvt_f32_i32 v65, v65
    v_cvt_f32_i32 v66, v66
    v_cvt_f32_i32 v67, v67
    v_mul_f32 v54, v64, v24
    v_fmac_f32 v54, v65, v25
    v_fmac_f32 v54, v66, v26
    v_fmac_f32 v54, v67, v27
    v_cvt_f32_i32 v68, v68
    v_cvt_f32_i32 v69, v69
    v_cvt_f32_i32 v70, v70
    v_cvt_f32_i32 v71, v71
    v_fmac_f32 v54, v68, v28
    v_fmac_f32 v54, v69, v29
    v_fmac_f32 v54, v70, v30
    v_fmac_f32 v54, v71, v31
    v_cvt_f32_i32 v72, v72
    v_cvt_f32_i32 v73, v73
    v_cvt_f32_i32 v74, v74
    v_cvt_f32_i32 v75, v75
    v_fmac_f32 v54, v72, v32
    v_fmac_f32 v54, v73, v33
    v_fmac_f32 v54, v74, v34
    v_fmac_f32 v54, v75, v35
    v_cvt_f32_i32 v76, v76
    v_cvt_f32_i32 v77, v77
    v_add_f32_dpp v54, v54, v54 row_ror:8 row_mask:0xf bank_mask:0xf
    v_cvt_f32_i32 v78, v78
    v_cvt_f32_i32 v79, v79
    v_add_f32_dpp v54, v54, v54 row_ror:4 row_mask:0xf bank_mask:0xf
    v_mul_f32 v55, v76, v24
    v_fmac_f32 v55, v77, v25
    v_add_f32_dpp v54, v54, v54 row_ror:2 row_mask:0xf bank_mask:0xf
    v_fmac_f32 v55, v78, v26
    v_fmac_f32 v55, v79, v27
    v_add_f32_dpp v60, v54, v54 row_ror:1 row_mask:0xf bank_mask:0x1
    v_cvt_f32_i32 v80, v80
    v_cvt_f32_i32 v81, v81
    v_cvt_f32_i32 v82, v82
    v_cvt_f32_i32 v83, v83
    v_fmac_f32 v55, v80, v28
    v_fmac_f32 v55, v81, v29
    v_fmac_f32 v55, v82, v30
    v_fmac_f32 v55, v83, v31
    v_cvt_f32_i32 v84, v84
    v_cvt_f32_i32 v85, v85
    v_cvt_f32_i32 v86, v86
    v_cvt_f32_i32 v87, v87
    v_fmac_f32 v55, v84, v32
    v_fmac_f32 v55, v85, v33
    v_fmac_f32 v55, v86, v34
    v_fmac_f32 v55, v87, v35
    s_nop 1
    v_add_f32_dpp v55, v55, v55 row_ror:8 row_mask:0xf bank_mask:0xf
    s_nop 1
    v_add_f32_dpp v55, v55, v55 row_ror:4 row_mask:0xf bank_mask:0xf
    s_nop 1
    v_add_f32_dpp v55, v55, v55 row_ror:2 row_mask:0xf bank_mask:0xf
    s_nop 1
    v_add_f32_dpp v61, v55, v55 row_ror:1 row_mask:0xf bank_mask:0x1
    s_waitcnt vmcnt(0)
    buffer_load_dwordx4 v[112:115], v48, s[8:11], 0 offen offset:3072 nt
    buffer_load_dwordx4 v[116:119], v48, s[8:11], 0 offen offset:3328 nt
    buffer_load_dwordx4 v[120:123], v48, s[8:11], 0 offen offset:3584 nt
    buffer_load_dwordx4 v[124:127], v49, s[8:11], 0 offen offset:0 nt
    buffer_load_dwordx4 v[128:131], v49, s[8:11], 0 offen offset:256 nt
    buffer_load_dwordx4 v[132:135], v49, s[8:11], 0 offen offset:512 nt
    s_mov_b32 s29, s28
    s_mov_b32 s30, 0
    s_memrealtime s[36:37]
    s_mov_b32 s6, 0x100000
L_wgtv:
    s_nop 1
    ds_read_b32 v10, v53 offset:216
    s_sub_u32 s6, s6, 1
    s_cbranch_scc1 L_exit1
    s_waitcnt lgkmcnt(0)
    v_readfirstlane_b32 s32, v10
    s_cmp_eq_u32 s32, 0
    s_cbranch_scc1 L_wgtv
    s_and_b32 s32, s32, 0xffff
    s_cbranch_scc0 L_gxtv
    s_add_u32 s32, s32, s36
L_gltv:
    s_nop 1
    s_memrealtime s[36:37]
    s_waitcnt lgkmcnt(0)
    s_sub_u32 s36, s36, s32
    s_cmp_lt_i32 s36, 0
    s_cbranch_scc1 L_gltv
L_gxtv:
    s_nop 1
    s_lshr_b32 s33, s30, 4
    s_lshl_b32 s34, s33, 2
    v_mov_b32 v11, s34
    s_mov_b32 s6, 0x100000
L_wtv:
    s_nop 1
    ds_read_b32 v10, v11 offset:24
    s_sub_u32 s6, s6, 1
    s_cbranch_scc1 L_exit1
    s_waitcnt lgkmcnt(0)
    v_readfirstlane_b32 s32, v10
    s_cmp_eq_u32 s32, 0
    s_cbranch_scc1 L_wtv
    s_and_b32 s5, s32, 7
    s_xor_b32 s5, s5, s48
    s_bitcmp1_b32 s32, 3
    s_cselect_b64 vcc, -1, 0
    v_cndmask_b32 v50, v62, v63, vcc
    s_mov_b32 s49, 45
    s_mov_b32 s40, 0x2a2b2a2a
    s_mov_b32 s41, 0x152b
    s_mov_b32 s64, 0x2020202
    s_mov_b32 s65, 0x102
    s_mov_b32 s66, 0x8080808
    s_mov_b32 s67, 0x408
    s_mov_b32 s68, 0x20202020
    s_mov_b32 s69, 0x1020
    s_mov_b32 s70, 0x10000
    s_mov_b32 s71, 0x1
    s_lshr_b32 s33, s29, 6
    s_lshl_b32 s33, s33, 11
    s_and_b32 s32, s29, 63
    s_add_u32 s32, s32, s33
    s_add_u32 s32, s32, s44
    s_bfe_u32 s33, s32, 0x20003
    s_and_b32 s34, s32, 4
    s_or_b32 s33, s33, s34
    s_xor_b32 s33, s33, s5
    s_lshl_b32 s50, s32, 5
    s_or_b32 s50, s50, s33
    s_lshl_b32 s50, s50, 4
    s_or_b32 s50, s50, 1
    s_lshl_b32 s53, s29, 7
    v_xor_b32 v10, s50, v50
    v_mul_hi_u32 v10, v10, s47
    v_lshrrev_b32 v10, 1, v10
    v_and_b32 v11, 15, v10
    v_cmp_eq_u32 vcc, 5, v11
    v_mad_u32_u24 v48, v10, s45, v2
    v_add_u32 v11, 3840, v48
    v_cndmask_b32 v49, v51, v11, vcc
    v_add_u32 v10, s53, v5
    ds_read_b32 v7, v10
    v_cvt_f32_i32 v88, v88
    v_cvt_f32_i32 v89, v89
    v_cvt_f32_i32 v90, v90
    v_cvt_f32_i32 v91, v91
    v_mul_f32 v56, v88, v24
    v_fmac_f32 v56, v89, v25
    v_fmac_f32 v56, v90, v26
    v_fmac_f32 v56, v91, v27
    v_cvt_f32_i32 v92, v92
    v_cvt_f32_i32 v93, v93
    v_cvt_f32_i32 v94, v94
    v_cvt_f32_i32 v95, v95
    v_fmac_f32 v56, v92, v28
    v_fmac_f32 v56, v93, v29
    v_fmac_f32 v56, v94, v30
    v_fmac_f32 v56, v95, v31
    v_cvt_f32_i32 v96, v96
    v_cvt_f32_i32 v97, v97
    v_cvt_f32_i32 v98, v98
    v_cvt_f32_i32 v99, v99
    v_fmac_f32 v56, v96, v32
    v_fmac_f32 v56, v97, v33
    v_fmac_f32 v56, v98, v34
    v_fmac_f32 v56, v99, v35
    v_cvt_f32_i32 v100, v100
    v_cvt_f32_i32 v101, v101
    v_add_f32_dpp v56, v56, v56 row_ror:8 row_mask:0xf bank_mask:0xf
    v_cvt_f32_i32 v102, v102
    v_cvt_f32_i32 v103, v103
    v_add_f32_dpp v56, v56, v56 row_ror:4 row_mask:0xf bank_mask:0xf
    v_mul_f32 v57, v100, v24
    v_fmac_f32 v57, v101, v25
    v_add_f32_dpp v56, v56, v56 row_ror:2 row_mask:0xf bank_mask:0xf
    v_fmac_f32 v57, v102, v26
    v_fmac_f32 v57, v103, v27
    v_add_f32_dpp v60, v56, v56 row_ror:1 row_mask:0xf bank_mask:0x2
    v_cvt_f32_i32 v104, v104
    v_cvt_f32_i32 v105, v105
    v_cvt_f32_i32 v106, v106
    v_cvt_f32_i32 v107, v107
    v_fmac_f32 v57, v104, v28
    v_fmac_f32 v57, v105, v29
    v_fmac_f32 v57, v106, v30
    v_fmac_f32 v57, v107, v31
    v_cvt_f32_i32 v108, v108
    v_cvt_f32_i32 v109, v109
    v_cvt_f32_i32 v110, v110
    v_cvt_f32_i32 v111, v111
    v_fmac_f32 v57, v108, v32
    v_fmac_f32 v57, v109, v33
    v_fmac_f32 v57, v110, v34
    v_fmac_f32 v57, v111, v35
    s_nop 1
    v_add_f32_dpp v57, v57, v57 row_ror:8 row_mask:0xf bank_mask:0xf
    s_nop 1
    v_add_f32_dpp v57, v57, v57 row_ror:4 row_mask:0xf bank_mask:0xf
    s_nop 1
    v_add_f32_dpp v57, v57, v57 row_ror:2 row_mask:0xf bank_mask:0xf
    s_nop 1
    v_add_f32_dpp v61, v57, v57 row_ror:1 row_mask:0xf bank_mask:0x2
    s_waitcnt vmcnt(0)
    buffer_load_dwordx4 v[64:67], v48, s[12:15], 0 offen offset:0 nt
    buffer_load_dwordx4 v[68:71], v48, s[12:15], 0 offen offset:256 nt
    buffer_load_dwordx4 v[72:75], v48, s[12:15], 0 offen offset:512 nt
    buffer_load_dwordx4 v[76:79], v48, s[12:15], 0 offen offset:768 nt
    buffer_load_dwordx4 v[80:83], v48, s[12:15], 0 offen offset:1024 nt
    buffer_load_dwordx4 v[84:87], v48, s[12:15], 0 offen offset:1280 nt
    v_cvt_f32_i32 v112, v112
    v_cvt_f32_i32 v113, v113
    v_cvt_f32_i32 v114, v114
    v_cvt_f32_i32 v115, v115
    v_mul_f32 v58, v112, v24
    v_fmac_f32 v58, v113, v25
    v_fmac_f32 v58, v114, v26
    v_fmac_f32 v58, v115, v27
    v_cvt_f32_i32 v116, v116
    v_cvt_f32_i32 v117, v117
    v_cvt_f32_i32 v118, v118
    v_cvt_f32_i32 v119, v119
    v_fmac_f32 v58, v116, v28
    v_fmac_f32 v58, v117, v29
    v_fmac_f32 v58, v118, v30
    v_fmac_f32 v58, v119, v31
    v_cvt_f32_i32 v120, v120
    v_cvt_f32_i32 v121, v121
    v_cvt_f32_i32 v122, v122
    v_cvt_f32_i32 v123, v123
    v_fmac_f32 v58, v120, v32
    v_fmac_f32 v58, v121, v33
    v_fmac_f32 v58, v122, v34
    v_fmac_f32 v58, v123, v35
    v_cvt_f32_i32 v124, v124
    v_cvt_f32_i32 v125, v125
    v_add_f32_dpp v58, v58, v58 row_ror:8 row_mask:0xf bank_mask:0xf
    v_cvt_f32_i32 v126, v126
    v_cvt_f32_i32 v127, v127
    v_add_f32_dpp v58, v58, v58 row_ror:4 row_mask:0xf bank_mask:0xf
    v_mul_f32 v59, v124, v24
    v_fmac_f32 v59, v125, v25
    v_add_f32_dpp v58, v58, v58 row_ror:2 row_mask:0xf bank_mask:0xf
    v_fmac_f32 v59, v126, v26
    v_fmac_f32 v59, v127, v27
    v_add_f32_dpp v60, v58, v58 row_ror:1 row_mask:0xf bank_mask:0x4
    v_cvt_f32_i32 v128, v128
    v_cvt_f32_i32 v129, v129
    v_cvt_f32_i32 v130, v130
    v_cvt_f32_i32 v131, v131
    v_fmac_f32 v59, v128, v28
    v_fmac_f32 v59, v129, v29
    v_fmac_f32 v59, v130, v30
    v_fmac_f32 v59, v131, v31
    v_cvt_f32_i32 v132, v132
    v_cvt_f32_i32 v133, v133
    v_cvt_f32_i32 v134, v134
    v_cvt_f32_i32 v135, v135
    v_fmac_f32 v59, v132, v32
    v_fmac_f32 v59, v133, v33
    v_fmac_f32 v59, v134, v34
    v_fmac_f32 v59, v135, v35
    s_nop 1
    v_add_f32_dpp v59, v59, v59 row_ror:8 row_mask:0xf bank_mask:0xf
    s_nop 1
    v_add_f32_dpp v59, v59, v59 row_ror:4 row_mask:0xf bank_mask:0xf
    s_nop 1
    v_add_f32_dpp v59, v59, v59 row_ror:2 row_mask:0xf bank_mask:0xf
    s_nop 1
    v_add_f32_dpp v61, v59, v59 row_ror:1 row_mask:0xf bank_mask:0x4
    s_mov_b64 exec, s[42:43]
    ds_write_b64 v4, v[60:61]
    s_mov_b64 exec, -1
    s_waitcnt lgkmcnt(0)
    v_mov_b32 v6, v7
    v_mov_b32 v11, 1
    s_mov_b64 exec, 1
    ds_add_u32 v53, v11 offset:48
    s_mov_b64 exec, -1
.p2align 6
L_vloop:
    s_nop 1
    s_waitcnt vmcnt(0)
    buffer_load_dwordx4 v[88:91], v48, s[12:15], 0 offen offset:1536 nt
    buffer_load_dwordx4 v[92:95], v48, s[12:15], 0 offen offset:1792 nt
    buffer_load_dwordx4 v[96:99], v48, s[12:15], 0 offen offset:2048 nt
    buffer_load_dwordx4 v[100:103], v48, s[12:15], 0 offen offset:2304 nt
    buffer_load_dwordx4 v[104:107], v48, s[12:15], 0 offen offset:2560 nt
    buffer_load_dwordx4 v[108:111], v48, s[12:15], 0 offen offset:2816 nt
    v_cvt_f32_i32 v64, v64
    v_cvt_f32_i32 v65, v65
    v_cvt_f32_i32 v66, v66
    v_cvt_f32_i32 v67, v67
    v_fmac_f32_dpp v12, v6, v64 row_newbcast:0 row_mask:0xf bank_mask:0xf
    v_fmac_f32_dpp v13, v6, v65 row_newbcast:0 row_mask:0xf bank_mask:0xf
    v_fmac_f32_dpp v14, v6, v66 row_newbcast:0 row_mask:0xf bank_mask:0xf
    v_fmac_f32_dpp v15, v6, v67 row_newbcast:0 row_mask:0xf bank_mask:0xf
    v_cvt_f32_i32 v68, v68
    v_cvt_f32_i32 v69, v69
    v_cvt_f32_i32 v70, v70
    v_cvt_f32_i32 v71, v71
    v_fmac_f32_dpp v16, v6, v68 row_newbcast:0 row_mask:0xf bank_mask:0xf
    v_fmac_f32_dpp v17, v6, v69 row_newbcast:0 row_mask:0xf bank_mask:0xf
    v_fmac_f32_dpp v18, v6, v70 row_newbcast:0 row_mask:0xf bank_mask:0xf
    v_fmac_f32_dpp v19, v6, v71 row_newbcast:0 row_mask:0xf bank_mask:0xf
    v_cvt_f32_i32 v72, v72
    v_cvt_f32_i32 v73, v73
    v_cvt_f32_i32 v74, v74
    v_cvt_f32_i32 v75, v75
    v_fmac_f32_dpp v20, v6, v72 row_newbcast:0 row_mask:0xf bank_mask:0xf
    v_fmac_f32_dpp v21, v6, v73 row_newbcast:0 row_mask:0xf bank_mask:0xf
    v_fmac_f32_dpp v22, v6, v74 row_newbcast:0 row_mask:0xf bank_mask:0xf
    v_fmac_f32_dpp v23, v6, v75 row_newbcast:0 row_mask:0xf bank_mask:0xf
    v_cvt_f32_i32 v76, v76
    v_cvt_f32_i32 v77, v77
    v_cvt_f32_i32 v78, v78
    v_cvt_f32_i32 v79, v79
    v_fmac_f32_dpp v12, v6, v76 row_newbcast:1 row_mask:0xf bank_mask:0xf
    v_fmac_f32_dpp v13, v6, v77 row_newbcast:1 row_mask:0xf bank_mask:0xf
    v_fmac_f32_dpp v14, v6, v78 row_newbcast:1 row_mask:0xf bank_mask:0xf
    v_fmac_f32_dpp v15, v6, v79 row_newbcast:1 row_mask:0xf bank_mask:0xf
    v_cvt_f32_i32 v80, v80
    v_cvt_f32_i32 v81, v81
    v_cvt_f32_i32 v82, v82
    v_cvt_f32_i32 v83, v83
    v_fmac_f32_dpp v16, v6, v80 row_newbcast:1 row_mask:0xf bank_mask:0xf
    v_fmac_f32_dpp v17, v6, v81 row_newbcast:1 row_mask:0xf bank_mask:0xf
    v_fmac_f32_dpp v18, v6, v82 row_newbcast:1 row_mask:0xf bank_mask:0xf
    v_fmac_f32_dpp v19, v6, v83 row_newbcast:1 row_mask:0xf bank_mask:0xf
    v_cvt_f32_i32 v84, v84
    v_cvt_f32_i32 v85, v85
    v_cvt_f32_i32 v86, v86
    v_cvt_f32_i32 v87, v87
    v_fmac_f32_dpp v20, v6, v84 row_newbcast:1 row_mask:0xf bank_mask:0xf
    v_fmac_f32_dpp v21, v6, v85 row_newbcast:1 row_mask:0xf bank_mask:0xf
    v_fmac_f32_dpp v22, v6, v86 row_newbcast:1 row_mask:0xf bank_mask:0xf
    v_fmac_f32_dpp v23, v6, v87 row_newbcast:1 row_mask:0xf bank_mask:0xf
    s_waitcnt vmcnt(0)
    buffer_load_dwordx4 v[112:115], v48, s[12:15], 0 offen offset:3072 nt
    buffer_load_dwordx4 v[116:119], v48, s[12:15], 0 offen offset:3328 nt
    buffer_load_dwordx4 v[120:123], v48, s[12:15], 0 offen offset:3584 nt
    buffer_load_dwordx4 v[124:127], v49, s[12:15], 0 offen offset:0 nt
    buffer_load_dwordx4 v[128:131], v49, s[12:15], 0 offen offset:256 nt
    buffer_load_dwordx4 v[132:135], v49, s[12:15], 0 offen offset:512 nt
    s_add_u32 s29, s29, 4
    s_add_u32 s30, s30, 1
    s_bitcmp1_b64 s[40:41], s30
    s_cbranch_scc1 L_evV
L_evretV:
    s_nop 1
    s_lshr_b32 s33, s29, 6
    s_lshl_b32 s33, s33, 11
    s_and_b32 s32, s29, 63
    s_add_u32 s32, s32, s33
    s_add_u32 s32, s32, s44
    s_bfe_u32 s33, s32, 0x20003
    s_and_b32 s34, s32, 4
    s_or_b32 s33, s33, s34
    s_xor_b32 s33, s33, s5
    s_lshl_b32 s50, s32, 5
    s_or_b32 s50, s50, s33
    s_lshl_b32 s50, s50, 4
    s_or_b32 s50, s50, 1
    s_lshl_b32 s53, s29, 7
    v_xor_b32 v10, s50, v50
    v_mul_hi_u32 v10, v10, s47
    v_lshrrev_b32 v10, 1, v10
    v_and_b32 v11, 15, v10
    v_cmp_eq_u32 vcc, 5, v11
    v_mad_u32_u24 v48, v10, s45, v2
    v_add_u32 v11, 3840, v48
    v_cndmask_b32 v49, v51, v11, vcc
    v_add_u32 v10, s53, v5
    ds_read_b32 v7, v10
    v_cvt_f32_i32 v88, v88
    v_cvt_f32_i32 v89, v89
    v_cvt_f32_i32 v90, v90
    v_cvt_f32_i32 v91, v91
    v_fmac_f32_dpp v12, v6, v88 row_newbcast:2 row_mask:0xf bank_mask:0xf
    v_fmac_f32_dpp v13, v6, v89 row_newbcast:2 row_mask:0xf bank_mask:0xf
    v_fmac_f32_dpp v14, v6, v90 row_newbcast:2 row_mask:0xf bank_mask:0xf
    v_fmac_f32_dpp v15, v6, v91 row_newbcast:2 row_mask:0xf bank_mask:0xf
    v_cvt_f32_i32 v92, v92
    v_cvt_f32_i32 v93, v93
    v_cvt_f32_i32 v94, v94
    v_cvt_f32_i32 v95, v95
    v_fmac_f32_dpp v16, v6, v92 row_newbcast:2 row_mask:0xf bank_mask:0xf
    v_fmac_f32_dpp v17, v6, v93 row_newbcast:2 row_mask:0xf bank_mask:0xf
    v_fmac_f32_dpp v18, v6, v94 row_newbcast:2 row_mask:0xf bank_mask:0xf
    v_fmac_f32_dpp v19, v6, v95 row_newbcast:2 row_mask:0xf bank_mask:0xf
    v_cvt_f32_i32 v96, v96
    v_cvt_f32_i32 v97, v97
    v_cvt_f32_i32 v98, v98
    v_cvt_f32_i32 v99, v99
    v_fmac_f32_dpp v20, v6, v96 row_newbcast:2 row_mask:0xf bank_mask:0xf
    v_fmac_f32_dpp v21, v6, v97 row_newbcast:2 row_mask:0xf bank_mask:0xf
    v_fmac_f32_dpp v22, v6, v98 row_newbcast:2 row_mask:0xf bank_mask:0xf
    v_fmac_f32_dpp v23, v6, v99 row_newbcast:2 row_mask:0xf bank_mask:0xf
    v_cvt_f32_i32 v100, v100
    v_cvt_f32_i32 v101, v101
    v_cvt_f32_i32 v102, v102
    v_cvt_f32_i32 v103, v103
    v_fmac_f32_dpp v12, v6, v100 row_newbcast:3 row_mask:0xf bank_mask:0xf
    v_fmac_f32_dpp v13, v6, v101 row_newbcast:3 row_mask:0xf bank_mask:0xf
    v_fmac_f32_dpp v14, v6, v102 row_newbcast:3 row_mask:0xf bank_mask:0xf
    v_fmac_f32_dpp v15, v6, v103 row_newbcast:3 row_mask:0xf bank_mask:0xf
    v_cvt_f32_i32 v104, v104
    v_cvt_f32_i32 v105, v105
    v_cvt_f32_i32 v106, v106
    v_cvt_f32_i32 v107, v107
    v_fmac_f32_dpp v16, v6, v104 row_newbcast:3 row_mask:0xf bank_mask:0xf
    v_fmac_f32_dpp v17, v6, v105 row_newbcast:3 row_mask:0xf bank_mask:0xf
    v_fmac_f32_dpp v18, v6, v106 row_newbcast:3 row_mask:0xf bank_mask:0xf
    v_fmac_f32_dpp v19, v6, v107 row_newbcast:3 row_mask:0xf bank_mask:0xf
    v_cvt_f32_i32 v108, v108
    v_cvt_f32_i32 v109, v109
    v_cvt_f32_i32 v110, v110
    v_cvt_f32_i32 v111, v111
    v_fmac_f32_dpp v20, v6, v108 row_newbcast:3 row_mask:0xf bank_mask:0xf
    v_fmac_f32_dpp v21, v6, v109 row_newbcast:3 row_mask:0xf bank_mask:0xf
    v_fmac_f32_dpp v22, v6, v110 row_newbcast:3 row_mask:0xf bank_mask:0xf
    v_fmac_f32_dpp v23, v6, v111 row_newbcast:3 row_mask:0xf bank_mask:0xf
    s_waitcnt vmcnt(0)
    buffer_load_dwordx4 v[64:67], v48, s[12:15], 0 offen offset:0 nt
    buffer_load_dwordx4 v[68:71], v48, s[12:15], 0 offen offset:256 nt
    buffer_load_dwordx4 v[72:75], v48, s[12:15], 0 offen offset:512 nt
    buffer_load_dwordx4 v[76:79], v48, s[12:15], 0 offen offset:768 nt
    buffer_load_dwordx4 v[80:83], v48, s[12:15], 0 offen offset:1024 nt
    buffer_load_dwordx4 v[84:87], v48, s[12:15], 0 offen offset:1280 nt
    v_cvt_f32_i32 v112, v112
    v_cvt_f32_i32 v113, v113
    v_cvt_f32_i32 v114, v114
    v_cvt_f32_i32 v115, v115
    v_fmac_f32_dpp v12, v6, v112 row_newbcast:4 row_mask:0xf bank_mask:0xf
    v_fmac_f32_dpp v13, v6, v113 row_newbcast:4 row_mask:0xf bank_mask:0xf
    v_fmac_f32_dpp v14, v6, v114 row_newbcast:4 row_mask:0xf bank_mask:0xf
    v_fmac_f32_dpp v15, v6, v115 row_newbcast:4 row_mask:0xf bank_mask:0xf
    v_cvt_f32_i32 v116, v116
    v_cvt_f32_i32 v117, v117
    v_cvt_f32_i32 v118, v118
    v_cvt_f32_i32 v119, v119
    v_fmac_f32_dpp v16, v6, v116 row_newbcast:4 row_mask:0xf bank_mask:0xf
    v_fmac_f32_dpp v17, v6, v117 row_newbcast:4 row_mask:0xf bank_mask:0xf
    v_fmac_f32_dpp v18, v6, v118 row_newbcast:4 row_mask:0xf bank_mask:0xf
    v_fmac_f32_dpp v19, v6, v119 row_newbcast:4 row_mask:0xf bank_mask:0xf
    v_cvt_f32_i32 v120, v120
    v_cvt_f32_i32 v121, v121
    v_cvt_f32_i32 v122, v122
    v_cvt_f32_i32 v123, v123
    v_fmac_f32_dpp v20, v6, v120 row_newbcast:4 row_mask:0xf bank_mask:0xf
    v_fmac_f32_dpp v21, v6, v121 row_newbcast:4 row_mask:0xf bank_mask:0xf
    v_fmac_f32_dpp v22, v6, v122 row_newbcast:4 row_mask:0xf bank_mask:0xf
    v_fmac_f32_dpp v23, v6, v123 row_newbcast:4 row_mask:0xf bank_mask:0xf
    v_cvt_f32_i32 v124, v124
    v_cvt_f32_i32 v125, v125
    v_cvt_f32_i32 v126, v126
    v_cvt_f32_i32 v127, v127
    v_fmac_f32_dpp v12, v6, v124 row_newbcast:5 row_mask:0xf bank_mask:0xf
    v_fmac_f32_dpp v13, v6, v125 row_newbcast:5 row_mask:0xf bank_mask:0xf
    v_fmac_f32_dpp v14, v6, v126 row_newbcast:5 row_mask:0xf bank_mask:0xf
    v_fmac_f32_dpp v15, v6, v127 row_newbcast:5 row_mask:0xf bank_mask:0xf
    v_cvt_f32_i32 v128, v128
    v_cvt_f32_i32 v129, v129
    v_cvt_f32_i32 v130, v130
    v_cvt_f32_i32 v131, v131
    v_fmac_f32_dpp v16, v6, v128 row_newbcast:5 row_mask:0xf bank_mask:0xf
    v_fmac_f32_dpp v17, v6, v129 row_newbcast:5 row_mask:0xf bank_mask:0xf
    v_fmac_f32_dpp v18, v6, v130 row_newbcast:5 row_mask:0xf bank_mask:0xf
    v_fmac_f32_dpp v19, v6, v131 row_newbcast:5 row_mask:0xf bank_mask:0xf
    v_cvt_f32_i32 v132, v132
    v_cvt_f32_i32 v133, v133
    v_cvt_f32_i32 v134, v134
    v_cvt_f32_i32 v135, v135
    v_fmac_f32_dpp v20, v6, v132 row_newbcast:5 row_mask:0xf bank_mask:0xf
    v_fmac_f32_dpp v21, v6, v133 row_newbcast:5 row_mask:0xf bank_mask:0xf
    v_fmac_f32_dpp v22, v6, v134 row_newbcast:5 row_mask:0xf bank_mask:0xf
    v_fmac_f32_dpp v23, v6, v135 row_newbcast:5 row_mask:0xf bank_mask:0xf
    s_waitcnt lgkmcnt(0)
    v_mov_b32 v6, v7
L_vchk:
    s_nop 1
    s_cmp_eq_u32 s30, s49
    s_cbranch_scc1 L_deep
    s_cmp_lg_u32 s59, 0
    s_cbranch_scc1 L_vboost
    s_and_b32 s32, s30, 15
    s_cbranch_scc1 L_vloop
L_vend:
    s_nop 1
    v_permlane32_swap_b32 v12, v14
    v_permlane32_swap_b32 v13, v15
    v_permlane32_swap_b32 v16, v18
    v_permlane32_swap_b32 v17, v19
    v_permlane32_swap_b32 v20, v22
    v_permlane32_swap_b32 v21, v23
    v_add_f32 v12, v12, v14
    v_add_f32 v13, v13, v15
    v_add_f32 v16, v16, v18
    v_add_f32 v17, v17, v19
    v_add_f32 v20, v20, v22
    v_add_f32 v21, v21, v23
    v_permlane16_swap_b32 v12, v13
    v_permlane16_swap_b32 v16, v17
    v_permlane16_swap_b32 v20, v21
    s_lshr_b32 s32, s30, 2
    v_mov_b32 v10, s32
    v_add_f32 v12, v12, v13
    ds_write_b32 v8, v12 offset:0
    v_add_f32 v16, v16, v17
    ds_write_b32 v8, v16 offset:256
    v_add_f32 v20, v20, v21
    ds_write_b32 v8, v20 offset:512
    v_mov_b32 v11, 1
    s_mov_b64 exec, 1
    ds_add_u32 v10, v11 offset:60
    s_mov_b64 exec, -1
    v_add_u32 v8, 3072, v8
    v_mov_b32 v12, 0
    v_mov_b32 v13, 0
    v_mov_b32 v14, 0
    v_mov_b32 v15, 0
    v_mov_b32 v16, 0
    v_mov_b32 v17, 0
    v_mov_b32 v18, 0
    v_mov_b32 v19, 0
    v_mov_b32 v20, 0
    v_mov_b32 v21, 0
    v_mov_b32 v22, 0
    v_mov_b32 v23, 0
    s_cmp_lg_u32 s59, 0
    s_cbranch_scc1 L_vboost2
L_vend2:
    s_nop 1
    s_cmp_lg_u32 s30, 48
    s_cbranch_scc1 L_vloop
L_exit1:
    s_endpgm
L_deep:
    s_nop 1
    buffer_load_dwordx4 v[88:91], v48, s[12:15], 0 offen offset:1536 nt
    buffer_load_dwordx4 v[92:95], v48, s[12:15], 0 offen offset:1792 nt
    buffer_load_dwordx4 v[96:99], v48, s[12:15], 0 offen offset:2048 nt
    buffer_load_dwordx4 v[100:103], v48, s[12:15], 0 offen offset:2304 nt
    buffer_load_dwordx4 v[104:107], v48, s[12:15], 0 offen offset:2560 nt
    buffer_load_dwordx4 v[108:111], v48, s[12:15], 0 offen offset:2816 nt
    buffer_load_dwordx4 v[112:115], v48, s[12:15], 0 offen offset:3072 nt
    buffer_load_dwordx4 v[116:119], v48, s[12:15], 0 offen offset:3328 nt
    buffer_load_dwordx4 v[120:123], v48, s[12:15], 0 offen offset:3584 nt
    buffer_load_dwordx4 v[124:127], v49, s[12:15], 0 offen offset:0 nt
    buffer_load_dwordx4 v[128:131], v49, s[12:15], 0 offen offset:256 nt
    buffer_load_dwordx4 v[132:135], v49, s[12:15], 0 offen offset:512 nt
.p2align 6
L_dloop:
    s_nop 1
    s_add_u32 s29, s29, 4
    s_add_u32 s30, s30, 1
    s_lshr_b32 s33, s29, 6
    s_lshl_b32 s33, s33, 11
    s_and_b32 s32, s29, 63
    s_add_u32 s32, s32, s33
    s_add_u32 s32, s32, s44
    s_bfe_u32 s33, s32, 0x20003
    s_and_b32 s34, s32, 4
    s_or_b32 s33, s33, s34
    s_xor_b32 s33, s33, s5
    s_lshl_b32 s50, s32, 5
    s_or_b32 s50, s50, s33
    s_lshl_b32 s50, s50, 4
    s_or_b32 s50, s50, 1
    s_lshl_b32 s53, s29, 7
    v_xor_b32 v10, s50, v50
    v_mul_hi_u32 v10, v10, s47
    v_lshrrev_b32 v10, 1, v10
    v_and_b32 v11, 15, v10
    v_cmp_eq_u32 vcc, 5, v11
    v_mad_u32_u24 v48, v10, s45, v2
    v_add_u32 v11, 3840, v48
    v_cndmask_b32 v49, v51, v11, vcc
    v_add_u32 v10, s53, v5
    ds_read_b32 v7, v10
    s_waitcnt vmcnt(12)
    v_cvt_f32_i32 v64, v64
    v_cvt_f32_i32 v65, v65
    v_cvt_f32_i32 v66, v66
    v_cvt_f32_i32 v67, v67
    v_fmac_f32_dpp v12, v6, v64 row_newbcast:0 row_mask:0xf bank_mask:0xf
    v_fmac_f32_dpp v13, v6, v65 row_newbcast:0 row_mask:0xf bank_mask:0xf
    v_fmac_f32_dpp v14, v6, v66 row_newbcast:0 row_mask:0xf bank_mask:0xf
    v_fmac_f32_dpp v15, v6, v67 row_newbcast:0 row_mask:0xf bank_mask:0xf
    v_cvt_f32_i32 v68, v68
    v_cvt_f32_i32 v69, v69
    v_cvt_f32_i32 v70, v70
    v_cvt_f32_i32 v71, v71
    v_fmac_f32_dpp v16, v6, v68 row_newbcast:0 row_mask:0xf bank_mask:0xf
    v_fmac_f32_dpp v17, v6, v69 row_newbcast:0 row_mask:0xf bank_mask:0xf
    v_fmac_f32_dpp v18, v6, v70 row_newbcast:0 row_mask:0xf bank_mask:0xf
    v_fmac_f32_dpp v19, v6, v71 row_newbcast:0 row_mask:0xf bank_mask:0xf
    v_cvt_f32_i32 v72, v72
    v_cvt_f32_i32 v73, v73
    v_cvt_f32_i32 v74, v74
    v_cvt_f32_i32 v75, v75
    v_fmac_f32_dpp v20, v6, v72 row_newbcast:0 row_mask:0xf bank_mask:0xf
    v_fmac_f32_dpp v21, v6, v73 row_newbcast:0 row_mask:0xf bank_mask:0xf
    v_fmac_f32_dpp v22, v6, v74 row_newbcast:0 row_mask:0xf bank_mask:0xf
    v_fmac_f32_dpp v23, v6, v75 row_newbcast:0 row_mask:0xf bank_mask:0xf
    v_cvt_f32_i32 v76, v76
    v_cvt_f32_i32 v77, v77
    v_cvt_f32_i32 v78, v78
    v_cvt_f32_i32 v79, v79
    v_fmac_f32_dpp v12, v6, v76 row_newbcast:1 row_mask:0xf bank_mask:0xf
    v_fmac_f32_dpp v13, v6, v77 row_newbcast:1 row_mask:0xf bank_mask:0xf
    v_fmac_f32_dpp v14, v6, v78 row_newbcast:1 row_mask:0xf bank_mask:0xf
    v_fmac_f32_dpp v15, v6, v79 row_newbcast:1 row_mask:0xf bank_mask:0xf
    v_cvt_f32_i32 v80, v80
    v_cvt_f32_i32 v81, v81
    v_cvt_f32_i32 v82, v82
    v_cvt_f32_i32 v83, v83
    v_fmac_f32_dpp v16, v6, v80 row_newbcast:1 row_mask:0xf bank_mask:0xf
    v_fmac_f32_dpp v17, v6, v81 row_newbcast:1 row_mask:0xf bank_mask:0xf
    v_fmac_f32_dpp v18, v6, v82 row_newbcast:1 row_mask:0xf bank_mask:0xf
    v_fmac_f32_dpp v19, v6, v83 row_newbcast:1 row_mask:0xf bank_mask:0xf
    v_cvt_f32_i32 v84, v84
    v_cvt_f32_i32 v85, v85
    v_cvt_f32_i32 v86, v86
    v_cvt_f32_i32 v87, v87
    v_fmac_f32_dpp v20, v6, v84 row_newbcast:1 row_mask:0xf bank_mask:0xf
    v_fmac_f32_dpp v21, v6, v85 row_newbcast:1 row_mask:0xf bank_mask:0xf
    v_fmac_f32_dpp v22, v6, v86 row_newbcast:1 row_mask:0xf bank_mask:0xf
    v_fmac_f32_dpp v23, v6, v87 row_newbcast:1 row_mask:0xf bank_mask:0xf
    buffer_load_dwordx4 v[64:67], v48, s[12:15], 0 offen offset:0 nt
    buffer_load_dwordx4 v[68:71], v48, s[12:15], 0 offen offset:256 nt
    buffer_load_dwordx4 v[72:75], v48, s[12:15], 0 offen offset:512 nt
    buffer_load_dwordx4 v[76:79], v48, s[12:15], 0 offen offset:768 nt
    buffer_load_dwordx4 v[80:83], v48, s[12:15], 0 offen offset:1024 nt
    buffer_load_dwordx4 v[84:87], v48, s[12:15], 0 offen offset:1280 nt
    s_waitcnt vmcnt(12)
    v_cvt_f32_i32 v88, v88
    v_cvt_f32_i32 v89, v89
    v_cvt_f32_i32 v90, v90
    v_cvt_f32_i32 v91, v91
    v_fmac_f32_dpp v12, v6, v88 row_newbcast:2 row_mask:0xf bank_mask:0xf
    v_fmac_f32_dpp v13, v6, v89 row_newbcast:2 row_mask:0xf bank_mask:0xf
    v_fmac_f32_dpp v14, v6, v90 row_newbcast:2 row_mask:0xf bank_mask:0xf
    v_fmac_f32_dpp v15, v6, v91 row_newbcast:2 row_mask:0xf bank_mask:0xf
    v_cvt_f32_i32 v92, v92
    v_cvt_f32_i32 v93, v93
    v_cvt_f32_i32 v94, v94
    v_cvt_f32_i32 v95, v95
    v_fmac_f32_dpp v16, v6, v92 row_newbcast:2 row_mask:0xf bank_mask:0xf
    v_fmac_f32_dpp v17, v6, v93 row_newbcast:2 row_mask:0xf bank_mask:0xf
    v_fmac_f32_dpp v18, v6, v94 row_newbcast:2 row_mask:0xf bank_mask:0xf
    v_fmac_f32_dpp v19, v6, v95 row_newbcast:2 row_mask:0xf bank_mask:0xf
    v_cvt_f32_i32 v96, v96
    v_cvt_f32_i32 v97, v97
    v_cvt_f32_i32 v98, v98
    v_cvt_f32_i32 v99, v99
    v_fmac_f32_dpp v20, v6, v96 row_newbcast:2 row_mask:0xf bank_mask:0xf
    v_fmac_f32_dpp v21, v6, v97 row_newbcast:2 row_mask:0xf bank_mask:0xf
    v_fmac_f32_dpp v22, v6, v98 row_newbcast:2 row_mask:0xf bank_mask:0xf
    v_fmac_f32_dpp v23, v6, v99 row_newbcast:2 row_mask:0xf bank_mask:0xf
    v_cvt_f32_i32 v100, v100
    v_cvt_f32_i32 v101, v101
    v_cvt_f32_i32 v102, v102
    v_cvt_f32_i32 v103, v103
    v_fmac_f32_dpp v12, v6, v100 row_newbcast:3 row_mask:0xf bank_mask:0xf
    v_fmac_f32_dpp v13, v6, v101 row_newbcast:3 row_mask:0xf bank_mask:0xf
    v_fmac_f32_dpp v14, v6, v102 row_newbcast:3 row_mask:0xf bank_mask:0xf
    v_fmac_f32_dpp v15, v6, v103 row_newbcast:3 row_mask:0xf bank_mask:0xf
    v_cvt_f32_i32 v104, v104
    v_cvt_f32_i32 v105, v105
    v_cvt_f32_i32 v106, v106
    v_cvt_f32_i32 v107, v107
    v_fmac_f32_dpp v16, v6, v104 row_newbcast:3 row_mask:0xf bank_mask:0xf
    v_fmac_f32_dpp v17, v6, v105 row_newbcast:3 row_mask:0xf bank_mask:0xf
    v_fmac_f32_dpp v18, v6, v106 row_newbcast:3 row_mask:0xf bank_mask:0xf
    v_fmac_f32_dpp v19, v6, v107 row_newbcast:3 row_mask:0xf bank_mask:0xf
    v_cvt_f32_i32 v108, v108
    v_cvt_f32_i32 v109, v109
    v_cvt_f32_i32 v110, v110
    v_cvt_f32_i32 v111, v111
    v_fmac_f32_dpp v20, v6, v108 row_newbcast:3 row_mask:0xf bank_mask:0xf
    v_fmac_f32_dpp v21, v6, v109 row_newbcast:3 row_mask:0xf bank_mask:0xf
    v_fmac_f32_dpp v22, v6, v110 row_newbcast:3 row_mask:0xf bank_mask:0xf
    v_fmac_f32_dpp v23, v6, v111 row_newbcast:3 row_mask:0xf bank_mask:0xf
    buffer_load_dwordx4 v[88:91], v48, s[12:15], 0 offen offset:1536 nt
    buffer_load_dwordx4 v[92:95], v48, s[12:15], 0 offen offset:1792 nt
    buffer_load_dwordx4 v[96:99], v48, s[12:15], 0 offen offset:2048 nt
    buffer_load_dwordx4 v[100:103], v48, s[12:15], 0 offen offset:2304 nt
    buffer_load_dwordx4 v[104:107], v48, s[12:15], 0 offen offset:2560 nt
    buffer_load_dwordx4 v[108:111], v48, s[12:15], 0 offen offset:2816 nt
    s_waitcnt vmcnt(12)
    v_cvt_f32_i32 v112, v112
    v_cvt_f32_i32 v113, v113
    v_cvt_f32_i32 v114, v114
    v_cvt_f32_i32 v115, v115
    v_fmac_f32_dpp v12, v6, v112 row_newbcast:4 row_mask:0xf bank_mask:0xf
    v_fmac_f32_dpp v13, v6, v113 row_newbcast:4 row_mask:0xf bank_mask:0xf
    v_fmac_f32_dpp v14, v6, v114 row_newbcast:4 row_mask:0xf bank_mask:0xf
    v_fmac_f32_dpp v15, v6, v115 row_newbcast:4 row_mask:0xf bank_mask:0xf
    v_cvt_f32_i32 v116, v116
    v_cvt_f32_i32 v117, v117
    v_cvt_f32_i32 v118, v118
    v_cvt_f32_i32 v119, v119
    v_fmac_f32_dpp v16, v6, v116 row_newbcast:4 row_mask:0xf bank_mask:0xf
    v_fmac_f32_dpp v17, v6, v117 row_newbcast:4 row_mask:0xf bank_mask:0xf
    v_fmac_f32_dpp v18, v6, v118 row_newbcast:4 row_mask:0xf bank_mask:0xf
    v_fmac_f32_dpp v19, v6, v119 row_newbcast:4 row_mask:0xf bank_mask:0xf
    v_cvt_f32_i32 v120, v120
    v_cvt_f32_i32 v121, v121
    v_cvt_f32_i32 v122, v122
    v_cvt_f32_i32 v123, v123
    v_fmac_f32_dpp v20, v6, v120 row_newbcast:4 row_mask:0xf bank_mask:0xf
    v_fmac_f32_dpp v21, v6, v121 row_newbcast:4 row_mask:0xf bank_mask:0xf
    v_fmac_f32_dpp v22, v6, v122 row_newbcast:4 row_mask:0xf bank_mask:0xf
    v_fmac_f32_dpp v23, v6, v123 row_newbcast:4 row_mask:0xf bank_mask:0xf
    v_cvt_f32_i32 v124, v124
    v_cvt_f32_i32 v125, v125
    v_cvt_f32_i32 v126, v126
    v_cvt_f32_i32 v127, v127
    v_fmac_f32_dpp v12, v6, v124 row_newbcast:5 row_mask:0xf bank_mask:0xf
    v_fmac_f32_dpp v13, v6, v125 row_newbcast:5 row_mask:0xf bank_mask:0xf
    v_fmac_f32_dpp v14, v6, v126 row_newbcast:5 row_mask:0xf bank_mask:0xf
    v_fmac_f32_dpp v15, v6, v127 row_newbcast:5 row_mask:0xf bank_mask:0xf
    v_cvt_f32_i32 v128, v128
    v_cvt_f32_i32 v129, v129
    v_cvt_f32_i32 v130, v130
    v_cvt_f32_i32 v131, v131
    v_fmac_f32_dpp v16, v6, v128 row_newbcast:5 row_mask:0xf bank_mask:0xf
    v_fmac_f32_dpp v17, v6, v129 row_newbcast:5 row_mask:0xf bank_mask:0xf
    v_fmac_f32_dpp v18, v6, v130 row_newbcast:5 row_mask:0xf bank_mask:0xf
    v_fmac_f32_dpp v19, v6, v131 row_newbcast:5 row_mask:0xf bank_mask:0xf
    v_cvt_f32_i32 v132, v132
    v_cvt_f32_i32 v133, v133
    v_cvt_f32_i32 v134, v134
    v_cvt_f32_i32 v135, v135
    v_fmac_f32_dpp v20, v6, v132 row_newbcast:5 row_mask:0xf bank_mask:0xf
    v_fmac_f32_dpp v21, v6, v133 row_newbcast:5 row_mask:0xf bank_mask:0xf
    v_fmac_f32_dpp v22, v6, v134 row_newbcast:5 row_mask:0xf bank_mask:0xf
    v_fmac_f32_dpp v23, v6, v135 row_newbcast:5 row_mask:0xf bank_mask:0xf
    buffer_load_dwordx4 v[112:115], v48, s[12:15], 0 offen offset:3072 nt
    buffer_load_dwordx4 v[116:119], v48, s[12:15], 0 offen offset:3328 nt
    buffer_load_dwordx4 v[120:123], v48, s[12:15], 0 offen offset:3584 nt
    buffer_load_dwordx4 v[124:127], v49, s[12:15], 0 offen offset:0 nt
    buffer_load_dwordx4 v[128:131], v49, s[12:15], 0 offen offset:256 nt
    buffer_load_dwordx4 v[132:135], v49, s[12:15], 0 offen offset:512 nt
    s_waitcnt lgkmcnt(0)
    v_mov_b32 v6, v7
    s_cmp_lg_u32 s30, 48
    s_cbranch_scc1 L_dloop
    s_branch L_vend
L_kboost:
    s_nop 1
    s_cmp_eq_u32 s30, 47
    s_cbranch_scc1 L_kchk2
    buffer_load_dwordx4 v[88:91], v48, s[8:11], 0 offen offset:1536 nt
    buffer_load_dwordx4 v[92:95], v48, s[8:11], 0 offen offset:1792 nt
    buffer_load_dwordx4 v[96:99], v48, s[8:11], 0 offen offset:2048 nt
    buffer_load_dwordx4 v[100:103], v48, s[8:11], 0 offen offset:2304 nt
    buffer_load_dwordx4 v[104:107], v48, s[8:11], 0 offen offset:2560 nt
    buffer_load_dwordx4 v[108:111], v48, s[8:11], 0 offen offset:2816 nt
    buffer_load_dwordx4 v[112:115], v48, s[8:11], 0 offen offset:3072 nt
    buffer_load_dwordx4 v[116:119], v48, s[8:11], 0 offen offset:3328 nt
    buffer_load_dwordx4 v[120:123], v48, s[8:11], 0 offen offset:3584 nt
    buffer_load_dwordx4 v[124:127], v49, s[8:11], 0 offen offset:0 nt
    buffer_load_dwordx4 v[128:131], v49, s[8:11], 0 offen offset:256 nt
    buffer_load_dwordx4 v[132:135], v49, s[8:11], 0 offen offset:512 nt
    s_sub_u32 s59, s59, 1
    s_add_u32 s29, s29, 4
    s_add_u32 s30, s30, 1
    s_bitcmp1_b64 s[40:41], s30
    s_cbranch_scc1 L_evKB
L_evretKB:
    s_nop 1
    s_lshr_b32 s33, s29, 6
    s_lshl_b32 s33, s33, 11
    s_and_b32 s32, s29, 63
    s_add_u32 s32, s32, s33
    s_add_u32 s32, s32, s44
    s_bfe_u32 s33, s32, 0x20003
    s_and_b32 s34, s32, 4
    s_or_b32 s33, s33, s34
    s_xor_b32 s33, s33, s5
    s_lshl_b32 s50, s32, 5
    s_or_b32 s50, s50, s33
    s_lshl_b32 s50, s50, 4
    s_or_b32 s50, s50, 1
    v_xor_b32 v10, s50, v50
    v_mul_hi_u32 v10, v10, s47
    v_lshrrev_b32 v10, 1, v10
    v_and_b32 v11, 15, v10
    v_cmp_eq_u32 vcc, 5, v11
    v_mad_u32_u24 v48, v10, s45, v2
    v_add_u32 v11, 3840, v48
    v_cndmask_b32 v49, v51, v11, vcc
    v_lshrrev_b32 v10, 6, v10
    v_mad_u32_u24 v9, v10, s46, v3
    buffer_load_dwordx2 v[42:43], v9, s[16:19], 0 offen offset:0
    buffer_load_dwordx2 v[44:45], v9, s[16:19], 0 offen offset:128
    buffer_load_dwordx2 v[46:47], v9, s[16:19], 0 offen offset:256
    s_waitcnt vmcnt(15)
    v_cvt_f32_i32 v64, v64
    v_cvt_f32_i32 v65, v65
    v_cvt_f32_i32 v66, v66
    v_cvt_f32_i32 v67, v67
    v_mul_f32 v54, v64, v24
    v_fmac_f32 v54, v65, v25
    v_fmac_f32 v54, v66, v26
    v_fmac_f32 v54, v67, v27
    v_cvt_f32_i32 v68, v68
    v_cvt_f32_i32 v69, v69
    v_cvt_f32_i32 v70, v70
    v_cvt_f32_i32 v71, v71
    v_fmac_f32 v54, v68, v28
    v_fmac_f32 v54, v69, v29
    v_fmac_f32 v54, v70, v30
    v_fmac_f32 v54, v71, v31
    v_cvt_f32_i32 v72, v72
    v_cvt_f32_i32 v73, v73
    v_cvt_f32_i32 v74, v74
    v_cvt_f32_i32 v75, v75
    v_fmac_f32 v54, v72, v32
    v_fmac_f32 v54, v73, v33
    v_fmac_f32 v54, v74, v34
    v_fmac_f32 v54, v75, v35
    v_cvt_f32_i32 v76, v76
    v_cvt_f32_i32 v77, v77
    v_add_f32_dpp v54, v54, v54 row_ror:8 row_mask:0xf bank_mask:0xf
    v_cvt_f32_i32 v78, v78
    v_cvt_f32_i32 v79, v79
    v_add_f32_dpp v54, v54, v54 row_ror:4 row_mask:0xf bank_mask:0xf
    v_mul_f32 v55, v76, v24
    v_fmac_f32 v55, v77, v25
    v_add_f32_dpp v54, v54, v54 row_ror:2 row_mask:0xf bank_mask:0xf
    v_fmac_f32 v55, v78, v26
    v_fmac_f32 v55, v79, v27
    v_add_f32_dpp v60, v54, v54 row_ror:1 row_mask:0xf bank_mask:0x1
    v_cvt_f32_i32 v80, v80
    v_cvt_f32_i32 v81, v81
    v_cvt_f32_i32 v82, v82
    v_cvt_f32_i32 v83, v83
    v_fmac_f32 v55, v80, v28
    v_fmac_f32 v55, v81, v29
    v_fmac_f32 v55, v82, v30
    v_fmac_f32 v55, v83, v31
    v_cvt_f32_i32 v84, v84
    v_cvt_f32_i32 v85, v85
    v_cvt_f32_i32 v86, v86
    v_cvt_f32_i32 v87, v87
    v_fmac_f32 v55, v84, v32
    v_fmac_f32 v55, v85, v33
    v_fmac_f32 v55, v86, v34
    v_fmac_f32 v55, v87, v35
    s_nop 1
    v_add_f32_dpp v55, v55, v55 row_ror:8 row_mask:0xf bank_mask:0xf
    s_nop 1
    v_add_f32_dpp v55, v55, v55 row_ror:4 row_mask:0xf bank_mask:0xf
    s_nop 1
    v_add_f32_dpp v55, v55, v55 row_ror:2 row_mask:0xf bank_mask:0xf
    s_nop 1
    v_add_f32_dpp v61, v55, v55 row_ror:1 row_mask:0xf bank_mask:0x1
    buffer_load_dwordx4 v[64:67], v48, s[8:11], 0 offen offset:0 nt
    buffer_load_dwordx4 v[68:71], v48, s[8:11], 0 offen offset:256 nt
    buffer_load_dwordx4 v[72:75], v48, s[8:11], 0 offen offset:512 nt
    buffer_load_dwordx4 v[76:79], v48, s[8:11], 0 offen offset:768 nt
    buffer_load_dwordx4 v[80:83], v48, s[8:11], 0 offen offset:1024 nt
    buffer_load_dwordx4 v[84:87], v48, s[8:11], 0 offen offset:1280 nt
    s_waitcnt vmcnt(15)
    v_cvt_f32_i32 v88, v88
    v_cvt_f32_i32 v89, v89
    v_cvt_f32_i32 v90, v90
    v_cvt_f32_i32 v91, v91
    v_mul_f32 v56, v88, v24
    v_fmac_f32 v56, v89, v25
    v_fmac_f32 v56, v90, v26
    v_fmac_f32 v56, v91, v27
    v_cvt_f32_i32 v92, v92
    v_cvt_f32_i32 v93, v93
    v_cvt_f32_i32 v94, v94
    v_cvt_f32_i32 v95, v95
    v_fmac_f32 v56, v92, v28
    v_fmac_f32 v56, v93, v29
    v_fmac_f32 v56, v94, v30
    v_fmac_f32 v56, v95, v31
    v_cvt_f32_i32 v96, v96
    v_cvt_f32_i32 v97, v97
    v_cvt_f32_i32 v98, v98
    v_cvt_f32_i32 v99, v99
    v_fmac_f32 v56, v96, v32
    v_fmac_f32 v56, v97, v33
    v_fmac_f32 v56, v98, v34
    v_fmac_f32 v56, v99, v35
    v_cvt_f32_i32 v100, v100
    v_cvt_f32_i32 v101, v101
    v_add_f32_dpp v56, v56, v56 row_ror:8 row_mask:0xf bank_mask:0xf
    v_cvt_f32_i32 v102, v102
    v_cvt_f32_i32 v103, v103
    v_add_f32_dpp v56, v56, v56 row_ror:4 row_mask:0xf bank_mask:0xf
    v_mul_f32 v57, v100, v24
    v_fmac_f32 v57, v101, v25
    v_add_f32_dpp v56, v56, v56 row_ror:2 row_mask:0xf bank_mask:0xf
    v_fmac_f32 v57, v102, v26
    v_fmac_f32 v57, v103, v27
    v_add_f32_dpp v60, v56, v56 row_ror:1 row_mask:0xf bank_mask:0x2
    v_cvt_f32_i32 v104, v104
    v_cvt_f32_i32 v105, v105
    v_cvt_f32_i32 v106, v106
    v_cvt_f32_i32 v107, v107
    v_fmac_f32 v57, v104, v28
    v_fmac_f32 v57, v105, v29
    v_fmac_f32 v57, v106, v30
    v_fmac_f32 v57, v107, v31
    v_cvt_f32_i32 v108, v108
    v_cvt_f32_i32 v109, v109
    v_cvt_f32_i32 v110, v110
    v_cvt_f32_i32 v111, v111
    v_fmac_f32 v57, v108, v32
    v_fmac_f32 v57, v109, v33
    v_fmac_f32 v57, v110, v34
    v_fmac_f32 v57, v111, v35
    s_nop 1
    v_add_f32_dpp v57, v57, v57 row_ror:8 row_mask:0xf bank_mask:0xf
    s_nop 1
    v_add_f32_dpp v57, v57, v57 row_ror:4 row_mask:0xf bank_mask:0xf
    s_nop 1
    v_add_f32_dpp v57, v57, v57 row_ror:2 row_mask:0xf bank_mask:0xf
    s_nop 1
    v_add_f32_dpp v61, v57, v57 row_ror:1 row_mask:0xf bank_mask:0x2
    s_waitcnt vmcnt(9)
    v_cvt_f32_i32 v112, v112
    v_cvt_f32_i32 v113, v113
    v_cvt_f32_i32 v114, v114
    v_cvt_f32_i32 v115, v115
    v_mul_f32 v58, v112, v24
    v_fmac_f32 v58, v113, v25
    v_fmac_f32 v58, v114, v26
    v_fmac_f32 v58, v115, v27
    v_cvt_f32_i32 v116, v116
    v_cvt_f32_i32 v117, v117
    v_cvt_f32_i32 v118, v118
    v_cvt_f32_i32 v119, v119
    v_fmac_f32 v58, v116, v28
    v_fmac_f32 v58, v117, v29
    v_fmac_f32 v58, v118, v30
    v_fmac_f32 v58, v119, v31
    v_cvt_f32_i32 v120, v120
    v_cvt_f32_i32 v121, v121
    v_cvt_f32_i32 v122, v122
    v_cvt_f32_i32 v123, v123
    v_fmac_f32 v58, v120, v32
    v_fmac_f32 v58, v121, v33
    v_fmac_f32 v58, v122, v34
    v_fmac_f32 v58, v123, v35
    v_cvt_f32_i32 v124, v124
    v_cvt_f32_i32 v125, v125
    v_add_f32_dpp v58, v58, v58 row_ror:8 row_mask:0xf bank_mask:0xf
    v_cvt_f32_i32 v126, v126
    v_cvt_f32_i32 v127, v127
    v_add_f32_dpp v58, v58, v58 row_ror:4 row_mask:0xf bank_mask:0xf
    v_mul_f32 v59, v124, v24
    v_fmac_f32 v59, v125, v25
    v_add_f32_dpp v58, v58, v58 row_ror:2 row_mask:0xf bank_mask:0xf
    v_fmac_f32 v59, v126, v26
    v_fmac_f32 v59, v127, v27
    v_add_f32_dpp v60, v58, v58 row_ror:1 row_mask:0xf bank_mask:0x4
    v_cvt_f32_i32 v128, v128
    v_cvt_f32_i32 v129, v129
    v_cvt_f32_i32 v130, v130
    v_cvt_f32_i32 v131, v131
    v_fmac_f32 v59, v128, v28
    v_fmac_f32 v59, v129, v29
    v_fmac_f32 v59, v130, v30
    v_fmac_f32 v59, v131, v31
    v_cvt_f32_i32 v132, v132
    v_cvt_f32_i32 v133, v133
    v_cvt_f32_i32 v134, v134
    v_cvt_f32_i32 v135, v135
    v_fmac_f32 v59, v132, v32
    v_fmac_f32 v59, v133, v33
    v_fmac_f32 v59, v134, v34
    v_fmac_f32 v59, v135, v35
    s_nop 1
    v_add_f32_dpp v59, v59, v59 row_ror:8 row_mask:0xf bank_mask:0xf
    s_nop 1
    v_add_f32_dpp v59, v59, v59 row_ror:4 row_mask:0xf bank_mask:0xf
    s_nop 1
    v_add_f32_dpp v59, v59, v59 row_ror:2 row_mask:0xf bank_mask:0xf
    s_nop 1
    v_add_f32_dpp v61, v59, v59 row_ror:1 row_mask:0xf bank_mask:0x4
    s_mov_b64 exec, s[42:43]
    ds_write_b64 v4, v[60:61]
    s_mov_b64 exec, -1
    v_add_u32 v4, 48, v4
    s_waitcnt vmcnt(6)
    v_lshlrev_b32 v10, 16, v36
    v_lshlrev_b32 v24, 16, v42
    v_and_b32 v11, 0xffff0000, v36
    v_and_b32 v25, 0xffff0000, v42
    v_mul_f32 v24, v24, v10
    v_mul_f32 v25, v25, v11
    v_lshlrev_b32 v10, 16, v37
    v_lshlrev_b32 v26, 16, v43
    v_and_b32 v11, 0xffff0000, v37
    v_and_b32 v27, 0xffff0000, v43
    v_mul_f32 v26, v26, v10
    v_mul_f32 v27, v27, v11
    v_lshlrev_b32 v10, 16, v38
    v_lshlrev_b32 v28, 16, v44
    v_and_b32 v11, 0xffff0000, v38
    v_and_b32 v29, 0xffff0000, v44
    v_mul_f32 v28, v28, v10
    v_mul_f32 v29, v29, v11
    v_lshlrev_b32 v10, 16, v39
    v_lshlrev_b32 v30, 16, v45
    v_and_b32 v11, 0xffff0000, v39
    v_and_b32 v31, 0xffff0000, v45
    v_mul_f32 v30, v30, v10
    v_mul_f32 v31, v31, v11
    v_lshlrev_b32 v10, 16, v40
    v_lshlrev_b32 v32, 16, v46
    v_and_b32 v11, 0xffff0000, v40
    v_and_b32 v33, 0xffff0000, v46
    v_mul_f32 v32, v32, v10
    v_mul_f32 v33, v33, v11
    v_lshlrev_b32 v10, 16, v41
    v_lshlrev_b32 v34, 16, v47
    v_and_b32 v11, 0xffff0000, v41
    v_and_b32 v35, 0xffff0000, v47
    v_mul_f32 v34, v34, v10
    v_mul_f32 v35, v35, v11
    s_branch L_kchk
L_vboost:
    s_nop 1
    s_and_b32 s32, s30, 15
    s_cbranch_scc0 L_vend
L_vboost2:
    s_nop 1
    s_cmp_eq_u32 s30, 48
    s_cbranch_scc1 L_vend2
    buffer_load_dwordx4 v[88:91], v48, s[12:15], 0 offen offset:1536 nt
    buffer_load_dwordx4 v[92:95], v48, s[12:15], 0 offen offset:1792 nt
    buffer_load_dwordx4 v[96:99], v48, s[12:15], 0 offen offset:2048 nt
    buffer_load_dwordx4 v[100:103], v48, s[12:15], 0 offen offset:2304 nt
    buffer_load_dwordx4 v[104:107], v48, s[12:15], 0 offen offset:2560 nt
    buffer_load_dwordx4 v[108:111], v48, s[12:15], 0 offen offset:2816 nt
    buffer_load_dwordx4 v[112:115], v48, s[12:15], 0 offen offset:3072 nt
    buffer_load_dwordx4 v[116:119], v48, s[12:15], 0 offen offset:3328 nt
    buffer_load_dwordx4 v[120:123], v48, s[12:15], 0 offen offset:3584 nt
    buffer_load_dwordx4 v[124:127], v49, s[12:15], 0 offen offset:0 nt
    buffer_load_dwordx4 v[128:131], v49, s[12:15], 0 offen offset:256 nt
    buffer_load_dwordx4 v[132:135], v49, s[12:15], 0 offen offset:512 nt
    s_sub_u32 s59, s59, 1
    s_add_u32 s29, s29, 4
    s_add_u32 s30, s30, 1
    s_bitcmp1_b64 s[40:41], s30
    s_cbranch_scc1 L_evVB
L_evretVB:
    s_nop 1
    s_lshr_b32 s33, s29, 6
    s_lshl_b32 s33, s33, 11
    s_and_b32 s32, s29, 63
    s_add_u32 s32, s32, s33
    s_add_u32 s32, s32, s44
    s_bfe_u32 s33, s32, 0x20003
    s_and_b32 s34, s32, 4
    s_or_b32 s33, s33, s34
    s_xor_b32 s33, s33, s5
    s_lshl_b32 s50, s32, 5
    s_or_b32 s50, s50, s33
    s_lshl_b32 s50, s50, 4
    s_or_b32 s50, s50, 1
    s_lshl_b32 s53, s29, 7
    v_xor_b32 v10, s50, v50
    v_mul_hi_u32 v10, v10, s47
    v_lshrrev_b32 v10, 1, v10
    v_and_b32 v11, 15, v10
    v_cmp_eq_u32 vcc, 5, v11
    v_mad_u32_u24 v48, v10, s45, v2
    v_add_u32 v11, 3840, v48
    v_cndmask_b32 v49, v51, v11, vcc
    v_add_u32 v10, s53, v5
    ds_read_b32 v7, v10
    s_waitcnt vmcnt(12)
    v_cvt_f32_i32 v64, v64
    v_cvt_f32_i32 v65, v65
    v_cvt_f32_i32 v66, v66
    v_cvt_f32_i32 v67, v67
    v_fmac_f32_dpp v12, v6, v64 row_newbcast:0 row_mask:0xf bank_mask:0xf
    v_fmac_f32_dpp v13, v6, v65 row_newbcast:0 row_mask:0xf bank_mask:0xf
    v_fmac_f32_dpp v14, v6, v66 row_newbcast:0 row_mask:0xf bank_mask:0xf
    v_fmac_f32_dpp v15, v6, v67 row_newbcast:0 row_mask:0xf bank_mask:0xf
    v_cvt_f32_i32 v68, v68
    v_cvt_f32_i32 v69, v69
    v_cvt_f32_i32 v70, v70
    v_cvt_f32_i32 v71, v71
    v_fmac_f32_dpp v16, v6, v68 row_newbcast:0 row_mask:0xf bank_mask:0xf
    v_fmac_f32_dpp v17, v6, v69 row_newbcast:0 row_mask:0xf bank_mask:0xf
    v_fmac_f32_dpp v18, v6, v70 row_newbcast:0 row_mask:0xf bank_mask:0xf
    v_fmac_f32_dpp v19, v6, v71 row_newbcast:0 row_mask:0xf bank_mask:0xf
    v_cvt_f32_i32 v72, v72
    v_cvt_f32_i32 v73, v73
    v_cvt_f32_i32 v74, v74
    v_cvt_f32_i32 v75, v75
    v_fmac_f32_dpp v20, v6, v72 row_newbcast:0 row_mask:0xf bank_mask:0xf
    v_fmac_f32_dpp v21, v6, v73 row_newbcast:0 row_mask:0xf bank_mask:0xf
    v_fmac_f32_dpp v22, v6, v74 row_newbcast:0 row_mask:0xf bank_mask:0xf
    v_fmac_f32_dpp v23, v6, v75 row_newbcast:0 row_mask:0xf bank_mask:0xf
    v_cvt_f32_i32 v76, v76
    v_cvt_f32_i32 v77, v77
    v_cvt_f32_i32 v78, v78
    v_cvt_f32_i32 v79, v79
    v_fmac_f32_dpp v12, v6, v76 row_newbcast:1 row_mask:0xf bank_mask:0xf
    v_fmac_f32_dpp v13, v6, v77 row_newbcast:1 row_mask:0xf bank_mask:0xf
    v_fmac_f32_dpp v14, v6, v78 row_newbcast:1 row_mask:0xf bank_mask:0xf
    v_fmac_f32_dpp v15, v6, v79 row_newbcast:1 row_mask:0xf bank_mask:0xf
    v_cvt_f32_i32 v80, v80
    v_cvt_f32_i32 v81, v81
    v_cvt_f32_i32 v82, v82
    v_cvt_f32_i32 v83, v83
    v_fmac_f32_dpp v16, v6, v80 row_newbcast:1 row_mask:0xf bank_mask:0xf
    v_fmac_f32_dpp v17, v6, v81 row_newbcast:1 row_mask:0xf bank_mask:0xf
    v_fmac_f32_dpp v18, v6, v82 row_newbcast:1 row_mask:0xf bank_mask:0xf
    v_fmac_f32_dpp v19, v6, v83 row_newbcast:1 row_mask:0xf bank_mask:0xf
    v_cvt_f32_i32 v84, v84
    v_cvt_f32_i32 v85, v85
    v_cvt_f32_i32 v86, v86
    v_cvt_f32_i32 v87, v87
    v_fmac_f32_dpp v20, v6, v84 row_newbcast:1 row_mask:0xf bank_mask:0xf
    v_fmac_f32_dpp v21, v6, v85 row_newbcast:1 row_mask:0xf bank_mask:0xf
    v_fmac_f32_dpp v22, v6, v86 row_newbcast:1 row_mask:0xf bank_mask:0xf
    v_fmac_f32_dpp v23, v6, v87 row_newbcast:1 row_mask:0xf bank_mask:0xf
    buffer_load_dwordx4 v[64:67], v48, s[12:15], 0 offen offset:0 nt
    buffer_load_dwordx4 v[68:71], v48, s[12:15], 0 offen offset:256 nt
    buffer_load_dwordx4 v[72:75], v48, s[12:15], 0 offen offset:512 nt
    buffer_load_dwordx4 v[76:79], v48, s[12:15], 0 offen offset:768 nt
    buffer_load_dwordx4 v[80:83], v48, s[12:15], 0 offen offset:1024 nt
    buffer_load_dwordx4 v[84:87], v48, s[12:15], 0 offen offset:1280 nt
    s_waitcnt vmcnt(12)
    v_cvt_f32_i32 v88, v88
    v_cvt_f32_i32 v89, v89
    v_cvt_f32_i32 v90, v90
    v_cvt_f32_i32 v91, v91
    v_fmac_f32_dpp v12, v6, v88 row_newbcast:2 row_mask:0xf bank_mask:0xf
    v_fmac_f32_dpp v13, v6, v89 row_newbcast:2 row_mask:0xf bank_mask:0xf
    v_fmac_f32_dpp v14, v6, v90 row_newbcast:2 row_mask:0xf bank_mask:0xf
    v_fmac_f32_dpp v15, v6, v91 row_newbcast:2 row_mask:0xf bank_mask:0xf
    v_cvt_f32_i32 v92, v92
    v_cvt_f32_i32 v93, v93
    v_cvt_f32_i32 v94, v94
    v_cvt_f32_i32 v95, v95
    v_fmac_f32_dpp v16, v6, v92 row_newbcast:2 row_mask:0xf bank_mask:0xf
    v_fmac_f32_dpp v17, v6, v93 row_newbcast:2 row_mask:0xf bank_mask:0xf
    v_fmac_f32_dpp v18, v6, v94 row_newbcast:2 row_mask:0xf bank_mask:0xf
    v_fmac_f32_dpp v19, v6, v95 row_newbcast:2 row_mask:0xf bank_mask:0xf
    v_cvt_f32_i32 v96, v96
    v_cvt_f32_i32 v97, v97
    v_cvt_f32_i32 v98, v98
    v_cvt_f32_i32 v99, v99
    v_fmac_f32_dpp v20, v6, v96 row_newbcast:2 row_mask:0xf bank_mask:0xf
    v_fmac_f32_dpp v21, v6, v97 row_newbcast:2 row_mask:0xf bank_mask:0xf
    v_fmac_f32_dpp v22, v6, v98 row_newbcast:2 row_mask:0xf bank_mask:0xf
    v_fmac_f32_dpp v23, v6, v99 row_newbcast:2 row_mask:0xf bank_mask:0xf
    v_cvt_f32_i32 v100, v100
    v_cvt_f32_i32 v101, v101
    v_cvt_f32_i32 v102, v102
    v_cvt_f32_i32 v103, v103
    v_fmac_f32_dpp v12, v6, v100 row_newbcast:3 row_mask:0xf bank_mask:0xf
    v_fmac_f32_dpp v13, v6, v101 row_newbcast:3 row_mask:0xf bank_mask:0xf
    v_fmac_f32_dpp v14, v6, v102 row_newbcast:3 row_mask:0xf bank_mask:0xf
    v_fmac_f32_dpp v15, v6, v103 row_newbcast:3 row_mask:0xf bank_mask:0xf
    v_cvt_f32_i32 v104, v104
    v_cvt_f32_i32 v105, v105
    v_cvt_f32_i32 v106, v106
    v_cvt_f32_i32 v107, v107
    v_fmac_f32_dpp v16, v6, v104 row_newbcast:3 row_mask:0xf bank_mask:0xf
    v_fmac_f32_dpp v17, v6, v105 row_newbcast:3 row_mask:0xf bank_mask:0xf
    v_fmac_f32_dpp v18, v6, v106 row_newbcast:3 row_mask:0xf bank_mask:0xf
    v_fmac_f32_dpp v19, v6, v107 row_newbcast:3 row_mask:0xf bank_mask:0xf
    v_cvt_f32_i32 v108, v108
    v_cvt_f32_i32 v109, v109
    v_cvt_f32_i32 v110, v110
    v_cvt_f32_i32 v111, v111
    v_fmac_f32_dpp v20, v6, v108 row_newbcast:3 row_mask:0xf bank_mask:0xf
    v_fmac_f32_dpp v21, v6, v109 row_newbcast:3 row_mask:0xf bank_mask:0xf
    v_fmac_f32_dpp v22, v6, v110 row_newbcast:3 row_mask:0xf bank_mask:0xf
    v_fmac_f32_dpp v23, v6, v111 row_newbcast:3 row_mask:0xf bank_mask:0xf
    s_waitcnt vmcnt(6)
    v_cvt_f32_i32 v112, v112
    v_cvt_f32_i32 v113, v113
    v_cvt_f32_i32 v114, v114
    v_cvt_f32_i32 v115, v115
    v_fmac_f32_dpp v12, v6, v112 row_newbcast:4 row_mask:0xf bank_mask:0xf
    v_fmac_f32_dpp v13, v6, v113 row_newbcast:4 row_mask:0xf bank_mask:0xf
    v_fmac_f32_dpp v14, v6, v114 row_newbcast:4 row_mask:0xf bank_mask:0xf
    v_fmac_f32_dpp v15, v6, v115 row_newbcast:4 row_mask:0xf bank_mask:0xf
    v_cvt_f32_i32 v116, v116
    v_cvt_f32_i32 v117, v117
    v_cvt_f32_i32 v118, v118
    v_cvt_f32_i32 v119, v119
    v_fmac_f32_dpp v16, v6, v116 row_newbcast:4 row_mask:0xf bank_mask:0xf
    v_fmac_f32_dpp v17, v6, v117 row_newbcast:4 row_mask:0xf bank_mask:0xf
    v_fmac_f32_dpp v18, v6, v118 row_newbcast:4 row_mask:0xf bank_mask:0xf
    v_fmac_f32_dpp v19, v6, v119 row_newbcast:4 row_mask:0xf bank_mask:0xf
    v_cvt_f32_i32 v120, v120
    v_cvt_f32_i32 v121, v121
    v_cvt_f32_i32 v122, v122
    v_cvt_f32_i32 v123, v123
    v_fmac_f32_dpp v20, v6, v120 row_newbcast:4 row_mask:0xf bank_mask:0xf
    v_fmac_f32_dpp v21, v6, v121 row_newbcast:4 row_mask:0xf bank_mask:0xf
    v_fmac_f32_dpp v22, v6, v122 row_newbcast:4 row_mask:0xf bank_mask:0xf
    v_fmac_f32_dpp v23, v6, v123 row_newbcast:4 row_mask:0xf bank_mask:0xf
    v_cvt_f32_i32 v124, v124
    v_cvt_f32_i32 v125, v125
    v_cvt_f32_i32 v126, v126
    v_cvt_f32_i32 v127, v127
    v_fmac_f32_dpp v12, v6, v124 row_newbcast:5 row_mask:0xf bank_mask:0xf
    v_fmac_f32_dpp v13, v6, v125 row_newbcast:5 row_mask:0xf bank_mask:0xf
    v_fmac_f32_dpp v14, v6, v126 row_newbcast:5 row_mask:0xf bank_mask:0xf
    v_fmac_f32_dpp v15, v6, v127 row_newbcast:5 row_mask:0xf bank_mask:0xf
    v_cvt_f32_i32 v128, v128
    v_cvt_f32_i32 v129, v129
    v_cvt_f32_i32 v130, v130
    v_cvt_f32_i32 v131, v131
    v_fmac_f32_dpp v16, v6, v128 row_newbcast:5 row_mask:0xf bank_mask:0xf
    v_fmac_f32_dpp v17, v6, v129 row_newbcast:5 row_mask:0xf bank_mask:0xf
    v_fmac_f32_dpp v18, v6, v130 row_newbcast:5 row_mask:0xf bank_mask:0xf
    v_fmac_f32_dpp v19, v6, v131 row_newbcast:5 row_mask:0xf bank_mask:0xf
    v_cvt_f32_i32 v132, v132
    v_cvt_f32_i32 v133, v133
    v_cvt_f32_i32 v134, v134
    v_cvt_f32_i32 v135, v135
    v_fmac_f32_dpp v20, v6, v132 row_newbcast:5 row_mask:0xf bank_mask:0xf
    v_fmac_f32_dpp v21, v6, v133 row_newbcast:5 row_mask:0xf bank_mask:0xf
    v_fmac_f32_dpp v22, v6, v134 row_newbcast:5 row_mask:0xf bank_mask:0xf
    v_fmac_f32_dpp v23, v6, v135 row_newbcast:5 row_mask:0xf bank_mask:0xf
    s_waitcnt lgkmcnt(0)
    v_mov_b32 v6, v7
    s_branch L_vchk
L_evK:
    s_nop 1
    s_bitcmp1_b64 s[64:65], s30
    s_cbranch_scc0 L_paK
    s_memrealtime s[60:61]
    s_mov_b32 s72, s59
    v_mov_b32 v11, 1
    s_mov_b64 exec, 1
    ds_add_u32 v53, v11 offset:128
    s_mov_b64 exec, -1
L_paK:
    s_nop 1
    s_bitcmp1_b64 s[66:67], s30
    s_cbranch_scc0 L_pbK
    v_mov_b32 v11, 1
    s_mov_b64 exec, 1
    ds_add_u32 v53, v11 offset:128
    s_mov_b64 exec, -1
L_pbK:
    s_nop 1
    s_bitcmp1_b64 s[68:69], s30
    s_cbranch_scc0 L_pcK
    v_mov_b32 v11, s62
    ds_read_b32 v10, v11
    v_mov_b32 v11, 1
    s_mov_b64 exec, 1
    ds_add_u32 v53, v11 offset:128
    s_mov_b64 exec, -1
    s_add_u32 s62, s62, 4
    s_waitcnt lgkmcnt(0)
    v_readfirstlane_b32 s32, v10
    s_cmp_eq_u32 s32, 0
    s_cbranch_scc1 L_pcK
    s_sub_u32 s32, s60, s32
    s_max_i32 s32, s32, -4096
    s_min_i32 s32, s32, 4096
    s_mul_i32 s32, s32, 8
    s_add_u32 s32, s32, 512
    s_ashr_i32 s32, s32, 10
    s_sub_u32 s32, s32, s72
    s_add_u32 s32, s32, s59
    s_max_i32 s32, s32, 0
    s_min_i32 s59, s32, 6
L_pcK:
    s_nop 1
    s_bitcmp1_b64 s[70:71], s30
    s_cbranch_scc0 L_evretK
    s_and_b32 s32, s30, 15
    s_cbranch_scc0 L_evK2
    s_cmp_eq_u32 s30, 4
    s_cbranch_scc1 L_evK2
    s_lshr_b32 s33, s30, 2
    s_andn2_b32 s33, s33, 3
    s_add_u32 s33, s33, 36
    s_cmp_eq_u32 s32, 1
    s_cselect_b32 s32, s33, 60
    s_cselect_b32 s33, 5376, 0
    v_add_u32 v4, s33, v4
    s_cmp_eq_u32 s30, 3
    s_cselect_b32 s32, 56, s32
    v_mov_b32 v10, s32
    v_mov_b32 v11, 1
    s_mov_b64 exec, 1
    ds_add_u32 v10, v11 offset:0
    s_mov_b64 exec, -1
    s_branch L_evretK
L_evK2:
    s_nop 1
    s_cmp_eq_u32 s30, 16
    s_cbranch_scc0 L_gxtk16
    s_memrealtime s[36:37]
    s_mov_b32 s6, 0x100000
L_wgtk16:
    s_nop 1
    ds_read_b32 v10, v53 offset:208
    s_sub_u32 s6, s6, 1
    s_cbranch_scc1 L_exit1
    s_waitcnt lgkmcnt(0)
    v_readfirstlane_b32 s32, v10
    s_cmp_eq_u32 s32, 0
    s_cbranch_scc1 L_wgtk16
    s_and_b32 s32, s32, 0xffff
    s_cbranch_scc0 L_gxtk16
    s_add_u32 s32, s32, s36
L_gltk16:
    s_nop 1
    s_memrealtime s[36:37]
    s_waitcnt lgkmcnt(0)
    s_sub_u32 s36, s36, s32
    s_cmp_lt_i32 s36, 0
    s_cbranch_scc1 L_gltk16
L_gxtk16:
    s_nop 1
    s_cmp_eq_u32 s30, 32
    s_cbranch_scc0 L_gxtk32
    s_memrealtime s[36:37]
    s_mov_b32 s6, 0x100000
L_wgtk32:
    s_nop 1
    ds_read_b32 v10, v53 offset:212
    s_sub_u32 s6, s6, 1
    s_cbranch_scc1 L_exit1
    s_waitcnt lgkmcnt(0)
    v_readfirstlane_b32 s32, v10
    s_cmp_eq_u32 s32, 0
    s_cbranch_scc1 L_wgtk32
    s_and_b32 s32, s32, 0xffff
    s_cbranch_scc0 L_gxtk32
    s_add_u32 s32, s32, s36
L_gltk32:
    s_nop 1
    s_memrealtime s[36:37]
    s_waitcnt lgkmcnt(0)
    s_sub_u32 s36, s36, s32
    s_cmp_lt_i32 s36, 0
    s_cbranch_scc1 L_gltk32
L_gxtk32:
    s_nop 1
    s_lshr_b32 s33, s30, 4
    s_lshl_b32 s34, s33, 2
    v_mov_b32 v11, s34
    s_lshl_b32 s31, s33, 5
    s_add_u32 s31, s31, s3
    s_mul_i32 s31, s31, 171
    s_lshr_b32 s31, s31, 9
    s_mul_i32 s31, s31, 384
    buffer_load_dwordx2 v[36:37], v3, s[20:23], s31 offen offset:0
    buffer_load_dwordx2 v[38:39], v3, s[20:23], s31 offen offset:128
    buffer_load_dwordx2 v[40:41], v3, s[20:23], s31 offen offset:256
    s_mov_b32 s6, 0x100000
L_wtk:
    s_nop 1
    ds_read_b32 v10, v11 offset:0
    s_sub_u32 s6, s6, 1
    s_cbranch_scc1 L_exit1
    s_waitcnt lgkmcnt(0)
    v_readfirstlane_b32 s32, v10
    s_cmp_eq_u32 s32, 0
    s_cbranch_scc1 L_wtk
    s_and_b32 s5, s32, 7
    s_xor_b32 s5, s5, s48
    s_bitcmp1_b32 s32, 3
    s_cselect_b64 vcc, -1, 0
    v_cndmask_b32 v50, v62, v63, vcc
    s_branch L_evretK
L_evV:
    s_nop 1
    s_bitcmp1_b64 s[64:65], s30
    s_cbranch_scc0 L_paV
    s_memrealtime s[60:61]
    s_mov_b32 s72, s59
    v_mov_b32 v11, 1
    s_mov_b64 exec, 1
    ds_add_u32 v53, v11 offset:128
    s_mov_b64 exec, -1
L_paV:
    s_nop 1
    s_bitcmp1_b64 s[66:67], s30
    s_cbranch_scc0 L_pbV
    v_mov_b32 v11, 1
    s_mov_b64 exec, 1
    ds_add_u32 v53, v11 offset:128
    s_mov_b64 exec, -1
L_pbV:
    s_nop 1
    s_bitcmp1_b64 s[68:69], s30
    s_cbranch_scc0 L_pcV
    v_mov_b32 v11, s62
    ds_read_b32 v10, v11
    v_mov_b32 v11, 1
    s_mov_b64 exec, 1
    ds_add_u32 v53, v11 offset:128
    s_mov_b64 exec, -1
    s_add_u32 s62, s62, 4
    s_waitcnt lgkmcnt(0)
    v_readfirstlane_b32 s32, v10
    s_cmp_eq_u32 s32, 0
    s_cbranch_scc1 L_pcV
    s_sub_u32 s32, s60, s32
    s_max_i32 s32, s32, -4096
    s_min_i32 s32, s32, 4096
    s_cmp_eq_u32 s30, 44
    s_cbranch_scc0 L_pd
    s_mul_i32 s32, s32, 9
    s_add_u32 s32, s32, 2048
    s_ashr_i32 s32, s32, 10
    s_max_i32 s32, s32, 0
    s_min_i32 s32, s32, 4
    s_sub_u32 s49, 48, s32
    s_cmp_eq_u32 s49, 48
    s_cselect_b32 s49, 255, s49
    s_mov_b32 s59, 0
    s_branch L_pcV
L_pd:
    s_nop 1
    s_mul_i32 s32, s32, 8
    s_add_u32 s32, s32, 512
    s_ashr_i32 s32, s32, 10
    s_sub_u32 s32, s32, s72
    s_add_u32 s32, s32, s59
    s_max_i32 s32, s32, 0
    s_min_i32 s59, s32, 6
L_pcV:
    s_nop 1
    s_bitcmp1_b64 s[70:71], s30
    s_cbranch_scc0 L_evretV
    s_cmp_eq_u32 s30, 16
    s_cbranch_scc0 L_gxtv264
    s_memrealtime s[36:37]
    s_mov_b32 s6, 0x100000
L_wgtv264:
    s_nop 1
    ds_read_b32 v10, v53 offset:220
    s_sub_u32 s6, s6, 1
    s_cbranch_scc1 L_exit1
    s_waitcnt lgkmcnt(0)
    v_readfirstlane_b32 s32, v10
    s_cmp_eq_u32 s32, 0
    s_cbranch_scc1 L_wgtv264
    s_and_b32 s32, s32, 0xffff
    s_cbranch_scc0 L_gxtv264
    s_add_u32 s32, s32, s36
L_gltv264:
    s_nop 1
    s_memrealtime s[36:37]
    s_waitcnt lgkmcnt(0)
    s_sub_u32 s36, s36, s32
    s_cmp_lt_i32 s36, 0
    s_cbranch_scc1 L_gltv264
L_gxtv264:
    s_nop 1
    s_cmp_eq_u32 s30, 32
    s_cbranch_scc0 L_gxtv280
    s_memrealtime s[36:37]
    s_mov_b32 s6, 0x100000
L_wgtv280:
    s_nop 1
    ds_read_b32 v10, v53 offset:224
    s_sub_u32 s6, s6, 1
    s_cbranch_scc1 L_exit1
    s_waitcnt lgkmcnt(0)
    v_readfirstlane_b32 s32, v10
    s_cmp_eq_u32 s32, 0
    s_cbranch_scc1 L_wgtv280
    s_and_b32 s32, s32, 0xffff
    s_cbranch_scc0 L_gxtv280
    s_add_u32 s32, s32, s36
L_gltv280:
    s_nop 1
    s_memrealtime s[36:37]
    s_waitcnt lgkmcnt(0)
    s_sub_u32 s36, s36, s32
    s_cmp_lt_i32 s36, 0
    s_cbranch_scc1 L_gltv280
L_gxtv280:
    s_nop 1
    s_lshr_b32 s33, s30, 4
    s_lshl_b32 s34, s33, 2
    v_mov_b32 v11, s34
    s_mov_b32 s6, 0x100000
L_wtv2:
    s_nop 1
    ds_read_b32 v10, v11 offset:24
    s_sub_u32 s6, s6, 1
    s_cbranch_scc1 L_exit1
    s_waitcnt lgkmcnt(0)
    v_readfirstlane_b32 s32, v10
    s_cmp_eq_u32 s32, 0
    s_cbranch_scc1 L_wtv2
    s_and_b32 s5, s32, 7
    s_xor_b32 s5, s5, s48
    s_bitcmp1_b32 s32, 3
    s_cselect_b64 vcc, -1, 0
    v_cndmask_b32 v50, v62, v63, vcc
    s_branch L_evretV
L_evKB:
    s_nop 1
    s_bitcmp1_b64 s[64:65], s30
    s_cbranch_scc0 L_paKB
    s_memrealtime s[60:61]
    s_mov_b32 s72, s59
    v_mov_b32 v11, 1
    s_mov_b64 exec, 1
    ds_add_u32 v53, v11 offset:128
    s_mov_b64 exec, -1
L_paKB:
    s_nop 1
    s_bitcmp1_b64 s[66:67], s30
    s_cbranch_scc0 L_pbKB
    v_mov_b32 v11, 1
    s_mov_b64 exec, 1
    ds_add_u32 v53, v11 offset:128
    s_mov_b64 exec, -1
L_pbKB:
    s_nop 1
    s_bitcmp1_b64 s[68:69], s30
    s_cbranch_scc0 L_pcKB
    v_mov_b32 v11, s62
    ds_read_b32 v10, v11
    v_mov_b32 v11, 1
    s_mov_b64 exec, 1
    ds_add_u32 v53, v11 offset:128
    s_mov_b64 exec, -1
    s_add_u32 s62, s62, 4
    s_waitcnt lgkmcnt(0)
    v_readfirstlane_b32 s32, v10
    s_cmp_eq_u32 s32, 0
    s_cbranch_scc1 L_pcKB
    s_sub_u32 s32, s60, s32
    s_max_i32 s32, s32, -4096
    s_min_i32 s32, s32, 4096
    s_mul_i32 s32, s32, 8
    s_add_u32 s32, s32, 512
    s_ashr_i32 s32, s32, 10
    s_sub_u32 s32, s32, s72
    s_add_u32 s32, s32, s59
    s_max_i32 s32, s32, 0
    s_min_i32 s59, s32, 6
L_pcKB:
    s_nop 1
    s_bitcmp1_b64 s[70:71], s30
    s_cbranch_scc0 L_evretKB
    s_and_b32 s32, s30, 15
    s_cbranch_scc0 L_evK2B
    s_cmp_eq_u32 s30, 4
    s_cbranch_scc1 L_evK2B
    s_lshr_b32 s33, s30, 2
    s_andn2_b32 s33, s33, 3
    s_add_u32 s33, s33, 36
    s_cmp_eq_u32 s32, 1
    s_cselect_b32 s32, s33, 60
    s_cselect_b32 s33, 5376, 0
    v_add_u32 v4, s33, v4
    s_cmp_eq_u32 s30, 3
    s_cselect_b32 s32, 56, s32
    v_mov_b32 v10, s32
    v_mov_b32 v11, 1
    s_mov_b64 exec, 1
    ds_add_u32 v10, v11 offset:0
    s_mov_b64 exec, -1
    s_branch L_evretKB
L_evK2B:
    s_nop 1
    s_cmp_eq_u32 s30, 16
    s_cbranch_scc0 L_gxtkB16
    s_memrealtime s[36:37]
    s_mov_b32 s6, 0x100000
L_wgtkB16:
    s_nop 1
    ds_read_b32 v10, v53 offset:208
    s_sub_u32 s6, s6, 1
    s_cbranch_scc1 L_exit1
    s_waitcnt lgkmcnt(0)
    v_readfirstlane_b32 s32, v10
    s_cmp_eq_u32 s32, 0
    s_cbranch_scc1 L_wgtkB16
    s_and_b32 s32, s32, 0xffff
    s_cbranch_scc0 L_gxtkB16
    s_add_u32 s32, s32, s36
L_gltkB16:
    s_nop 1
    s_memrealtime s[36:37]
    s_waitcnt lgkmcnt(0)
    s_sub_u32 s36, s36, s32
    s_cmp_lt_i32 s36, 0
    s_cbranch_scc1 L_gltkB16
L_gxtkB16:
    s_nop 1
    s_cmp_eq_u32 s30, 32
    s_cbranch_scc0 L_gxtkB32
    s_memrealtime s[36:37]
    s_mov_b32 s6, 0x100000
L_wgtkB32:
    s_nop 1
    ds_read_b32 v10, v53 offset:212
    s_sub_u32 s6, s6, 1
    s_cbranch_scc1 L_exit1
    s_waitcnt lgkmcnt(0)
    v_readfirstlane_b32 s32, v10
    s_cmp_eq_u32 s32, 0
    s_cbranch_scc1 L_wgtkB32
    s_and_b32 s32, s32, 0xffff
    s_cbranch_scc0 L_gxtkB32
    s_add_u32 s32, s32, s36
L_gltkB32:
    s_nop 1
    s_memrealtime s[36:37]
    s_waitcnt lgkmcnt(0)
    s_sub_u32 s36, s36, s32
    s_cmp_lt_i32 s36, 0
    s_cbranch_scc1 L_gltkB32
L_gxtkB32:
    s_nop 1
    s_lshr_b32 s33, s30, 4
    s_lshl_b32 s34, s33, 2
    v_mov_b32 v11, s34
    s_lshl_b32 s31, s33, 5
    s_add_u32 s31, s31, s3
    s_mul_i32 s31, s31, 171
    s_lshr_b32 s31, s31, 9
    s_mul_i32 s31, s31, 384
    buffer_load_dwordx2 v[36:37], v3, s[20:23], s31 offen offset:0
    buffer_load_dwordx2 v[38:39], v3, s[20:23], s31 offen offset:128
    buffer_load_dwordx2 v[40:41], v3, s[20:23], s31 offen offset:256
    s_mov_b32 s6, 0x100000
L_wtkB:
    s_nop 1
    ds_read_b32 v10, v11 offset:0
    s_sub_u32 s6, s6, 1
    s_cbranch_scc1 L_exit1
    s_waitcnt lgkmcnt(0)
    v_readfirstlane_b32 s32, v10
    s_cmp_eq_u32 s32, 0
    s_cbranch_scc1 L_wtkB
    s_and_b32 s5, s32, 7
    s_xor_b32 s5, s5, s48
    s_bitcmp1_b32 s32, 3
    s_cselect_b64 vcc, -1, 0
    v_cndmask_b32 v50, v62, v63, vcc
    s_branch L_evretKB
L_evVB:
    s_nop 1
    s_bitcmp1_b64 s[64:65], s30
    s_cbranch_scc0 L_paVB
    s_memrealtime s[60:61]
    s_mov_b32 s72, s59
    v_mov_b32 v11, 1
    s_mov_b64 exec, 1
    ds_add_u32 v53, v11 offset:128
    s_mov_b64 exec, -1
L_paVB:
    s_nop 1
    s_bitcmp1_b64 s[66:67], s30
    s_cbranch_scc0 L_pbVB
    v_mov_b32 v11, 1
    s_mov_b64 exec, 1
    ds_add_u32 v53, v11 offset:128
    s_mov_b64 exec, -1
L_pbVB:
    s_nop 1
    s_bitcmp1_b64 s[68:69], s30
    s_cbranch_scc0 L_pcVB
    v_mov_b32 v11, s62
    ds_read_b32 v10, v11
    v_mov_b32 v11, 1
    s_mov_b64 exec, 1
    ds_add_u32 v53, v11 offset:128
    s_mov_b64 exec, -1
    s_add_u32 s62, s62, 4
    s_waitcnt lgkmcnt(0)
    v_readfirstlane_b32 s32, v10
    s_cmp_eq_u32 s32, 0
    s_cbranch_scc1 L_pcVB
    s_sub_u32 s32, s60, s32
    s_max_i32 s32, s32, -4096
    s_min_i32 s32, s32, 4096
    s_cmp_eq_u32 s30, 44
    s_cbranch_scc0 L_pdB
    s_mul_i32 s32, s32, 9
    s_add_u32 s32, s32, 2048
    s_ashr_i32 s32, s32, 10
    s_max_i32 s32, s32, 0
    s_min_i32 s32, s32, 4
    s_sub_u32 s49, 48, s32
    s_cmp_eq_u32 s49, 48
    s_cselect_b32 s49, 255, s49
    s_mov_b32 s59, 0
    s_branch L_pcVB
L_pdB:
    s_nop 1
    s_mul_i32 s32, s32, 8
    s_add_u32 s32, s32, 512
    s_ashr_i32 s32, s32, 10
    s_sub_u32 s32, s32, s72
    s_add_u32 s32, s32, s59
    s_max_i32 s32, s32, 0
    s_min_i32 s59, s32, 6
L_pcVB:
    s_nop 1
    s_bitcmp1_b64 s[70:71], s30
    s_cbranch_scc0 L_evretVB
    s_cmp_eq_u32 s30, 16
    s_cbranch_scc0 L_gxtv2B64
    s_memrealtime s[36:37]
    s_mov_b32 s6, 0x100000
L_wgtv2B64:
    s_nop 1
    ds_read_b32 v10, v53 offset:220
    s_sub_u32 s6, s6, 1
    s_cbranch_scc1 L_exit1
    s_waitcnt lgkmcnt(0)
    v_readfirstlane_b32 s32, v10
    s_cmp_eq_u32 s32, 0
    s_cbranch_scc1 L_wgtv2B64
    s_and_b32 s32, s32, 0xffff
    s_cbranch_scc0 L_gxtv2B64
    s_add_u32 s32, s32, s36
L_gltv2B64:
    s_nop 1
    s_memrealtime s[36:37]
    s_waitcnt lgkmcnt(0)
    s_sub_u32 s36, s36, s32
    s_cmp_lt_i32 s36, 0
    s_cbranch_scc1 L_gltv2B64
L_gxtv2B64:
    s_nop 1
    s_cmp_eq_u32 s30, 32
    s_cbranch_scc0 L_gxtv2B80
    s_memrealtime s[36:37]
    s_mov_b32 s6, 0x100000
L_wgtv2B80:
    s_nop 1
    ds_read_b32 v10, v53 offset:224
    s_sub_u32 s6, s6, 1
    s_cbranch_scc1 L_exit1
    s_waitcnt lgkmcnt(0)
    v_readfirstlane_b32 s32, v10
    s_cmp_eq_u32 s32, 0
    s_cbranch_scc1 L_wgtv2B80
    s_and_b32 s32, s32, 0xffff
    s_cbranch_scc0 L_gxtv2B80
    s_add_u32 s32, s32, s36
L_gltv2B80:
    s_nop 1
    s_memrealtime s[36:37]
    s_waitcnt lgkmcnt(0)
    s_sub_u32 s36, s36, s32
    s_cmp_lt_i32 s36, 0
    s_cbranch_scc1 L_gltv2B80
L_gxtv2B80:
    s_nop 1
    s_lshr_b32 s33, s30, 4
    s_lshl_b32 s34, s33, 2
    v_mov_b32 v11, s34
    s_mov_b32 s6, 0x100000
L_wtv2B:
    s_nop 1
    ds_read_b32 v10, v11 offset:24
    s_sub_u32 s6, s6, 1
    s_cbranch_scc1 L_exit1
    s_waitcnt lgkmcnt(0)
    v_readfirstlane_b32 s32, v10
    s_cmp_eq_u32 s32, 0
    s_cbranch_scc1 L_wtv2B
    s_and_b32 s5, s32, 7
    s_xor_b32 s5, s5, s48
    s_bitcmp1_b32 s32, 3
    s_cselect_b64 vcc, -1, 0
    v_cndmask_b32 v50, v62, v63, vcc
    s_branch L_evretVB
L_helper:
    s_nop 1
    s_sub_u32 s6, s28, 4
    s_mov_b32 s5, s48
    v_mov_b32 v1, v11
    v_mov_b32 v2, 0
    s_mul_i32 s59, s3, 34816
    s_add_u32 s59, s59, 8388608
    s_cmp_eq_u32 s6, 3
    s_cbranch_scc1 L_h3
    s_mul_i32 s48, s6, 10
    s_sub_u32 s48, s48, 7
    s_cmp_lt_i32 s3, s48
    s_cselect_b32 s90, 1, 0
    s_cbranch_scc0 L_noprobe1
    s_max_u32 s7, s3, 1
    s_sub_u32 s7, s7, 1
    s_lshr_b32 s7, s7, 1
    s_lshl_b32 s49, s3, 1
    s_add_u32 s49, s49, s6
    s_sub_u32 s49, s49, 1
    s_bitcmp1_b32 s3, 0
    s_cselect_b32 s48, 1, 4
    s_cmp_eq_u32 s7, 0
    s_cselect_b32 s49, s49, s48
    s_and_b32 s48, s49, 1
    s_mul_i32 s20, s49, 20
    s_add_u32 s20, s20, s48
    s_add_u32 s20, s20, 2
    s_lshl_b32 s20, s20, 21
    s_xor_b32 s21, s4, s6
    s_and_b32 s21, s21, 1
    s_lshr_b32 s49, s4, 2
    s_xor_b32 s48, s48, s49
    s_xor_b32 s48, s48, s21
    s_lshl_b32 s48, s48, 13
    s_lshl_b32 s49, s6, 14
    s_and_b32 s49, s49, 0x4000
    s_or_b32 s48, s48, s49
    s_xor_b32 s32, s48, 0x0
    s_xor_b32 s33, s48, 0x2000
    s_xor_b32 s34, s48, 0x1000
    s_xor_b32 s35, s48, 0x3000
    s_xor_b32 s36, s48, 0x4000
    s_xor_b32 s37, s48, 0x6000
    s_xor_b32 s38, s48, 0x5000
    s_xor_b32 s39, s48, 0x7000
    v_and_b32 v3, 7, v1
    v_lshlrev_b32 v3, 12, v3
    s_lshl_b32 s48, s4, 8
    v_add_u32 v3, s48, v3
    s_mov_b32 s10, 805306368
    s_mov_b32 s11, 0x00020000
    s_cmp_ge_u32 s7, 3
    s_cselect_b32 s48, 3, 0
    s_sub_u32 s48, s7, s48
    s_lshl_b32 s48, s48, 28
    s_add_u32 s20, s20, s48
    s_cmp_ge_u32 s7, 3
    s_waitcnt lgkmcnt(0)
    s_cselect_b32 s8, s68, s66
    s_cselect_b32 s23, s69, s67
    s_and_b32 s9, s23, 0xffff
    s_mov_b64 exec, 0xff
    buffer_load_dword v4, v3, s[8:11], s20 offen
    s_mov_b64 exec, -1
    s_add_u32 s22, s8, s20
    s_addc_u32 s23, s23, 0
    s_lshl_b32 s48, s4, 8
    s_add_u32 s48, s48, 128
    s_load_dword s45, s[22:23], s48
L_noprobe1:
    s_nop 1
    s_waitcnt lgkmcnt(0)
    s_mov_b32 s12, s82
    s_and_b32 s13, s83, 0xffff
    s_mov_b32 s14, 10485760
    s_mov_b32 s15, 0x00020000
    s_mov_b32 s16, s80
    s_and_b32 s17, s81, 0xffff
    s_mov_b32 s18, 256
    s_mov_b32 s19, 0x00020000
    s_cmp_lg_u32 s6, 0
    s_cbranch_scc1 L_hbar
    v_lshlrev_b32 v5, 2, v1
    ds_write_b32 v5, v2
    s_waitcnt lgkmcnt(0)
L_hbar:
    s_nop 1
    s_barrier
    s_cmp_eq_u32 s90, 0
    s_cbranch_scc1 L_role
    s_mov_b32 s46, 1
    s_mov_b32 s58, 0
    s_cmp_eq_u32 s7, 0
    s_cselect_b32 s47, 1, 3
    s_waitcnt vmcnt(0)
L_round:
    s_nop 1
    s_add_u32 s48, s4, s46
    s_and_b32 s48, s48, 7
    s_lshl_b32 s48, s48, 8
    s_add_u32 s56, s22, s48
    s_addc_u32 s57, s23, 0
    s_mov_b32 s44, -1
    s_memtime s[40:41]
    s_waitcnt lgkmcnt(0)
    s_load_dword s45, s[56:57], s32
    s_waitcnt lgkmcnt(0)
    s_memtime s[42:43]
    s_waitcnt lgkmcnt(0)
    s_sub_u32 s24, s42, s40
    s_load_dword s45, s[56:57], s33
    s_waitcnt lgkmcnt(0)
    s_memtime s[40:41]
    s_waitcnt lgkmcnt(0)
    s_sub_u32 s25, s40, s42
    s_load_dword s45, s[56:57], s34
    s_waitcnt lgkmcnt(0)
    s_memtime s[42:43]
    s_waitcnt lgkmcnt(0)
    s_sub_u32 s26, s42, s40
    s_load_dword s45, s[56:57], s35
    s_waitcnt lgkmcnt(0)
    s_memtime s[40:41]
    s_waitcnt lgkmcnt(0)
    s_sub_u32 s27, s40, s42
    s_load_dword s45, s[56:57], s36
    s_waitcnt lgkmcnt(0)
    s_memtime s[42:43]
    s_waitcnt lgkmcnt(0)
    s_sub_u32 s28, s42, s40
    s_load_dword s45, s[56:57], s37
    s_waitcnt lgkmcnt(0)
    s_memtime s[40:41]
    s_waitcnt lgkmcnt(0)
    s_sub_u32 s29, s40, s42
    s_load_dword s45, s[56:57], s38
    s_waitcnt lgkmcnt(0)
    s_memtime s[42:43]
    s_waitcnt lgkmcnt(0)
    s_sub_u32 s30, s42, s40
    s_load_dword s45, s[56:57], s39
    s_waitcnt lgkmcnt(0)
    s_memtime s[40:41]
    s_waitcnt lgkmcnt(0)
    s_sub_u32 s31, s40, s42
L_few:
    s_nop 1
    s_min_u32 s24, s24, 1400
    s_min_u32 s44, s44, s24
    s_min_u32 s25, s25, 1400
    s_min_u32 s44, s44, s25
    s_min_u32 s26, s26, 1400
    s_min_u32 s44, s44, s26
    s_min_u32 s27, s27, 1400
    s_min_u32 s44, s44, s27
    s_min_u32 s28, s28, 1400
    s_min_u32 s44, s44, s28
    s_min_u32 s29, s29, 1400
    s_min_u32 s44, s44, s29
    s_min_u32 s30, s30, 1400
    s_min_u32 s44, s44, s30
    s_min_u32 s31, s31, 1400
    s_min_u32 s44, s44, s31
    s_cmp_lt_u32 s44, 290
    s_cbranch_scc1 L_skip
    s_sub_u32 s58, s58, s24
    s_add_u32 s58, s58, s25
    s_sub_u32 s58, s58, s26
    s_add_u32 s58, s58, s27
    s_sub_u32 s58, s58, s28
    s_add_u32 s58, s58, s29
    s_sub_u32 s58, s58, s30
    s_add_u32 s58, s58, s31
L_skip:
    s_nop 1
    s_add_u32 s46, s46, 1
    s_cmp_le_u32 s46, s47
    s_cbranch_scc1 L_round
    s_sub_u32 s48, 0, s58
    s_cmp_eq_u32 s21, 0
    s_cselect_b32 s58, s58, s48
    s_add_u32 s58, s58, 0x1010000
    v_mov_b32 v4, s58
    s_mov_b64 exec, 1
    s_lshl_b32 s48, s7, 2
    s_add_u32 s48, s48, 124
    s_cmp_eq_u32 s7, 0
    s_cbranch_scc0 L_post
    ds_add_rtn_u32 v5, v2, v4 offset:36
    s_mov_b32 s48, 0
    s_waitcnt lgkmcnt(0)
    v_add_u32 v4, v4, v5
    v_cmp_ne_u32 vcc, 0, v5
    s_and_b64 exec, exec, vcc
    buffer_atomic_add v4, off, s[16:19], s48
    s_branch L_posted
L_post:
    s_nop 1
    s_mov_b32 s60, 0x100000
L_wvw:
    s_nop 1
    ds_read_b32 v10, v2 offset:0
    s_sub_u32 s60, s60, 1
    s_cbranch_scc1 L_exit1
    s_waitcnt lgkmcnt(0)
    v_readfirstlane_b32 s48, v10
    s_cmp_eq_u32 s48, 0
    s_cbranch_scc1 L_wvw
    s_mul_i32 s48, s3, 4352
    s_add_u32 s48, s48, 9489664
    s_nop 0
    buffer_atomic_add v4, off, s[12:15], s48
L_posted:
    s_nop 1
    s_mov_b64 exec, -1
L_role:
    s_nop 1
    s_cmp_eq_u32 s6, 0
    s_cbranch_scc1 L_h0
    s_cmp_eq_u32 s6, 2
    s_cbranch_scc1 L_h2
    s_cmp_lg_u32 s2, 255
    s_cbranch_scc1 L_nolead
    v_mul_u32_u24 v5, 4352, v1
    v_mov_b32 v3, 0
    s_mov_b32 s48, 8388608
    buffer_store_dwordx2 v[2:3], v5, s[12:15], s48 offen sc1
    s_mov_b32 s49, 8667136
    buffer_store_dwordx2 v[2:3], v5, s[12:15], s49 offen sc1
    s_mov_b32 s50, 8945664
    buffer_store_dwordx2 v[2:3], v5, s[12:15], s50 offen sc1
    s_mov_b32 s51, 9224192
    buffer_store_dwordx2 v[2:3], v5, s[12:15], s51 offen sc1
    s_mov_b32 s52, 9502720
    s_mov_b64 exec, 0x3ff
    buffer_store_dwordx2 v[2:3], v5, s[12:15], s52 offen sc1
    v_mov_b32 v4, 0x1010000
    s_mov_b64 exec, 1
    s_waitcnt vmcnt(0)
    buffer_atomic_add v4, off, s[16:19], 0
    s_mov_b64 exec, -1
L_nolead:
    s_nop 1
    v_lshlrev_b32 v5, 2, v1
    s_mov_b32 s60, 0x100000
L_wea:
    s_nop 1
    ds_read_b32 v10, v2 offset:56
    s_sub_u32 s60, s60, 1
    s_cbranch_scc1 L_exit1
    s_waitcnt lgkmcnt(0)
    v_readfirstlane_b32 s48, v10
    s_cmp_lt_u32 s48, 1
    s_cbranch_scc1 L_wea
    s_mov_b64 exec, 0x1
    s_mov_b32 s60, 0x40000
L_polla:
    s_nop 1
    buffer_load_dword v4, v5, s[16:19], 0 offen offset:0 sc1
    s_sub_u32 s60, s60, 1
    s_cbranch_scc1 L_exit1
L_pollwa:
    s_waitcnt vmcnt(0)
    v_lshrrev_b32 v6, 24, v4
    v_cmp_ne_u32 vcc, 49, v6
    s_cbranch_vccnz L_polla
    v_and_b32 v4, 0xffffff, v4
    v_subrev_u32 v4, 3211264, v4
    v_lshrrev_b32 v6, 30, v4
    v_and_b32 v6, 2, v6
    v_add_u32 v4, 9800, v4
    v_cmp_gt_u32 vcc, 19600, v4
    s_nop 1
    v_cndmask_b32 v6, v6, 8, vcc
    v_or_b32 v6, 16, v6
    ds_write_b32 v5, v6 offset:0
    s_mov_b64 exec, -1
    s_mov_b32 s60, 0x100000
L_web:
    s_nop 1
    ds_read_b32 v10, v2 offset:60
    s_sub_u32 s60, s60, 1
    s_cbranch_scc1 L_exit1
    s_waitcnt lgkmcnt(0)
    v_readfirstlane_b32 s48, v10
    s_cmp_eq_u32 s48, 0
    s_cbranch_scc1 L_web
    v_mul_u32_u24 v7, 4352, v1
    s_mov_b32 s48, 9502720
    v_lshrrev_b32 v5, 1, v5
    s_mov_b64 exec, 0x3ff
    s_mov_b32 s60, 0x40000
L_pollb:
    s_nop 1
    buffer_load_dword v4, v7, s[12:15], s48 offen sc1
    s_sub_u32 s60, s60, 1
    s_cbranch_scc1 L_exit1
L_pollwb:
    s_waitcnt vmcnt(0)
    v_lshrrev_b32 v6, 24, v4
    v_cmp_ne_u32 vcc, 8, v6
    s_cbranch_vccnz L_pollb
    v_add_u32_dpp v4, v4, v4 quad_perm:[1,0,3,2] row_mask:0xf bank_mask:0xf
    s_mov_b64 exec, 0x155
    v_and_b32 v4, 0xffffff, v4
    v_subrev_u32 v4, 1048576, v4
    v_lshrrev_b32 v6, 30, v4
    v_and_b32 v6, 2, v6
    v_add_u32 v4, 9600, v4
    v_cmp_gt_u32 vcc, 19200, v4
    s_nop 1
    v_cndmask_b32 v6, v6, 8, vcc
    v_or_b32 v6, 16, v6
    ds_write_b32 v5, v6 offset:4
    s_mov_b64 exec, -1
    s_and_b32 s48, s3, 7
    s_cmp_lg_u32 s48, s4
    s_cbranch_scc1 L_exit1
    s_mul_i32 s48, s3, 3
    s_add_u32 s48, s48, 2
    s_lshr_b32 s48, s48, 5
    s_lshl_b32 s48, s48, 2
    v_mov_b32 v3, s48
    s_mul_i32 s57, s3, 24
    v_add_u32 v13, s57, v1
    v_and_b32 v12, 255, v13
    v_mul_u32_u24 v12, 4352, v12
    v_lshlrev_b32 v13, 6, v13
    s_mov_b32 s49, 8388608
    s_mov_b32 s50, 917504
    v_mov_b32 v4, 0xf149f2ca
    v_mov_b32 v5, 0
    s_mov_b32 s60, 0x100000
L_wcg:
    s_nop 1
    ds_read_b32 v10, v3 offset:24
    s_sub_u32 s60, s60, 1
    s_cbranch_scc1 L_exit1
    s_waitcnt lgkmcnt(0)
    v_readfirstlane_b32 s48, v10
    s_cmp_eq_u32 s48, 0
    s_cbranch_scc1 L_wcg
    s_mov_b64 exec, 0xffffff
    s_mov_b32 s60, 0x40000
L_cpf:
    s_nop 1
    buffer_load_dword v7, v12, s[12:15], s49 offen sc1
    s_sub_u32 s60, s60, 1
    s_cbranch_scc1 L_exit1
    s_waitcnt vmcnt(0)
    v_cmpx_eq_u32 vcc, 0, v7
    s_cbranch_execnz L_cpf
    s_mov_b64 exec, 0xffffff
    s_mov_b32 s60, 0x40000
L_cpm:
    s_nop 1
    buffer_load_dwordx4 v[4:7], v13, s[12:15], s50 offen sc1
    s_sub_u32 s60, s60, 1
    s_cbranch_scc1 L_exit1
    s_waitcnt vmcnt(0)
    v_cmpx_eq_u32 vcc, 0, v7
    s_cbranch_execnz L_cpm
    s_mov_b64 exec, -1
    v_mov_b32 v6, v4
    s_nop 1
    v_max_f32_dpp v6, v6, v6 row_ror:8 row_mask:0xf bank_mask:0xf
    s_nop 1
    v_max_f32_dpp v6, v6, v6 row_ror:4 row_mask:0xf bank_mask:0xf
    s_nop 1
    v_max_f32_dpp v6, v6, v6 row_ror:2 row_mask:0xf bank_mask:0xf
    s_nop 1
    v_max_f32_dpp v6, v6, v6 row_ror:1 row_mask:0xf bank_mask:0xf
    v_mov_b32 v7, v6
    s_nop 1
    v_permlane32_swap_b32 v6, v7
    v_max_f32 v6, v6, v7
    v_mov_b32 v7, v6
    s_nop 1
    v_permlane16_swap_b32 v6, v7
    v_max_f32 v6, v6, v7
    v_sub_f32 v4, v4, v6
    v_exp_f32 v4, v4
    s_nop 0
    v_mul_f32 v5, v5, v4
    s_nop 1
    v_add_f32_dpp v5, v5, v5 row_ror:8 row_mask:0xf bank_mask:0xf
    s_nop 1
    v_add_f32_dpp v5, v5, v5 row_ror:4 row_mask:0xf bank_mask:0xf
    s_nop 1
    v_add_f32_dpp v5, v5, v5 row_ror:2 row_mask:0xf bank_mask:0xf
    s_nop 1
    v_add_f32_dpp v5, v5, v5 row_ror:1 row_mask:0xf bank_mask:0xf
    v_mov_b32 v7, v5
    s_nop 1
    v_permlane32_swap_b32 v5, v7
    v_add_f32 v5, v5, v7
    v_mov_b32 v7, v5
    s_nop 1
    v_permlane16_swap_b32 v5, v7
    v_add_f32 v5, v5, v7
    v_rcp_f32 v5, v5
    s_nop 0
    v_mul_f32 v4, v4, v5
    s_nop 0
    v_readlane_b32 s24, v4, 0
    v_readlane_b32 s25, v4, 1
    v_readlane_b32 s26, v4, 2
    v_readlane_b32 s27, v4, 3
    v_readlane_b32 s28, v4, 4
    v_readlane_b32 s29, v4, 5
    v_readlane_b32 s30, v4, 6
    v_readlane_b32 s31, v4, 7
    v_readlane_b32 s32, v4, 8
    v_readlane_b32 s33, v4, 9
    v_readlane_b32 s34, v4, 10
    v_readlane_b32 s35, v4, 11
    v_readlane_b32 s36, v4, 12
    v_readlane_b32 s37, v4, 13
    v_readlane_b32 s38, v4, 14
    v_readlane_b32 s39, v4, 15
    v_readlane_b32 s40, v4, 16
    v_readlane_b32 s41, v4, 17
    v_readlane_b32 s42, v4, 18
    v_readlane_b32 s43, v4, 19
    v_readlane_b32 s44, v4, 20
    v_readlane_b32 s45, v4, 21
    v_readlane_b32 s46, v4, 22
    v_readlane_b32 s47, v4, 23
    s_mov_b32 s92, s78
    s_and_b32 s93, s79, 0xffff
    s_mov_b32 s94, 12288
    s_mov_b32 s95, 0x00020000
    s_lshl_b32 s57, s57, 10
    v_lshlrev_b32 v13, 4, v1
    v_add_u32 v13, s57, v13
    s_mov_b32 s49, 4096
    s_mov_b32 s50, 8192
    s_mov_b32 s51, 12288
    s_mov_b32 s52, 16384
    s_mov_b32 s53, 20480
    v_mov_b32 v4, 0
    v_mov_b32 v5, 0
    v_mov_b32 v6, 0
    s_mov_b32 s56, 0xffffff
    v_lshlrev_b32 v12, 1, v1
    s_mul_i32 s57, s3, 384
    s_mov_b32 s60, 0x100000
L_wcc:
    s_nop 1
    ds_read_b32 v10, v3 offset:64
    s_sub_u32 s60, s60, 1
    s_cbranch_scc1 L_exit1
    s_waitcnt lgkmcnt(0)
    v_readfirstlane_b32 s48, v10
    s_cmp_lt_u32 s48, 1
    s_cbranch_scc1 L_wcc
    s_mov_b32 s60, 0x40000
L_cr:
    s_nop 1
    s_bitcmp0_b32 s56, 0
    s_cbranch_scc1 L_cl0
    buffer_load_dwordx4 v[16:19], v13, s[12:15], 0 offen offset:0 sc1
L_cl0:
    s_bitcmp0_b32 s56, 1
    s_cbranch_scc1 L_cl1
    buffer_load_dwordx4 v[20:23], v13, s[12:15], 0 offen offset:1024 sc1
L_cl1:
    s_bitcmp0_b32 s56, 2
    s_cbranch_scc1 L_cl2
    buffer_load_dwordx4 v[24:27], v13, s[12:15], 0 offen offset:2048 sc1
L_cl2:
    s_bitcmp0_b32 s56, 3
    s_cbranch_scc1 L_cl3
    buffer_load_dwordx4 v[28:31], v13, s[12:15], 0 offen offset:3072 sc1
L_cl3:
    s_bitcmp0_b32 s56, 4
    s_cbranch_scc1 L_cl4
    buffer_load_dwordx4 v[32:35], v13, s[12:15], s49 offen offset:0 sc1
L_cl4:
    s_bitcmp0_b32 s56, 5
    s_cbranch_scc1 L_cl5
    buffer_load_dwordx4 v[36:39], v13, s[12:15], s49 offen offset:1024 sc1
L_cl5:
    s_bitcmp0_b32 s56, 6
    s_cbranch_scc1 L_cl6
    buffer_load_dwordx4 v[40:43], v13, s[12:15], s49 offen offset:2048 sc1
L_cl6:
    s_bitcmp0_b32 s56, 7
    s_cbranch_scc1 L_cl7
    buffer_load_dwordx4 v[44:47], v13, s[12:15], s49 offen offset:3072 sc1
L_cl7:
    s_bitcmp0_b32 s56, 8
    s_cbranch_scc1 L_cl8
    buffer_load_dwordx4 v[48:51], v13, s[12:15], s50 offen offset:0 sc1
L_cl8:
    s_bitcmp0_b32 s56, 9
    s_cbranch_scc1 L_cl9
    buffer_load_dwordx4 v[52:55], v13, s[12:15], s50 offen offset:1024 sc1
L_cl9:
    s_bitcmp0_b32 s56, 10
    s_cbranch_scc1 L_cl10
    buffer_load_dwordx4 v[56:59], v13, s[12:15], s50 offen offset:2048 sc1
L_cl10:
    s_bitcmp0_b32 s56, 11
    s_cbranch_scc1 L_cl11
    buffer_load_dwordx4 v[60:63], v13, s[12:15], s50 offen offset:3072 sc1
L_cl11:
    s_bitcmp0_b32 s56, 12
    s_cbranch_scc1 L_cl12
    buffer_load_dwordx4 v[64:67], v13, s[12:15], s51 offen offset:0 sc1
L_cl12:
    s_bitcmp0_b32 s56, 13
    s_cbranch_scc1 L_cl13
    buffer_load_dwordx4 v[68:71], v13, s[12:15], s51 offen offset:1024 sc1
L_cl13:
    s_bitcmp0_b32 s56, 14
    s_cbranch_scc1 L_cl14
    buffer_load_dwordx4 v[72:75], v13, s[12:15], s51 offen offset:2048 sc1
L_cl14:
    s_bitcmp0_b32 s56, 15
    s_cbranch_scc1 L_cl15
    buffer_load_dwordx4 v[76:79], v13, s[12:15], s51 offen offset:3072 sc1
L_cl15:
    s_bitcmp0_b32 s56, 16
    s_cbranch_scc1 L_cl16
    buffer_load_dwordx4 v[80:83], v13, s[12:15], s52 offen offset:0 sc1
L_cl16:
    s_bitcmp0_b32 s56, 17
    s_cbranch_scc1 L_cl17
    buffer_load_dwordx4 v[84:87], v13, s[12:15], s52 offen offset:1024 sc1
L_cl17:
    s_bitcmp0_b32 s56, 18
    s_cbranch_scc1 L_cl18
    buffer_load_dwordx4 v[88:91], v13, s[12:15], s52 offen offset:2048 sc1
L_cl18:
    s_bitcmp0_b32 s56, 19
    s_cbranch_scc1 L_cl19
    buffer_load_dwordx4 v[92:95], v13, s[12:15], s52 offen offset:3072 sc1
L_cl19:
    s_bitcmp0_b32 s56, 20
    s_cbranch_scc1 L_cl20
    buffer_load_dwordx4 v[96:99], v13, s[12:15], s53 offen offset:0 sc1
L_cl20:
    s_bitcmp0_b32 s56, 21
    s_cbranch_scc1 L_cl21
    buffer_load_dwordx4 v[100:103], v13, s[12:15], s53 offen offset:1024 sc1
L_cl21:
    s_bitcmp0_b32 s56, 22
    s_cbranch_scc1 L_cl22
    buffer_load_dwordx4 v[104:107], v13, s[12:15], s53 offen offset:2048 sc1
L_cl22:
    s_bitcmp0_b32 s56, 23
    s_cbranch_scc1 L_cl23
    buffer_load_dwordx4 v[108:111], v13, s[12:15], s53 offen offset:3072 sc1
L_cl23:
    s_sub_u32 s60, s60, 1
    s_cbranch_scc1 L_exit1
    s_waitcnt vmcnt(0)
    s_bitcmp0_b32 s56, 0
    s_cbranch_scc1 L_cv0
    v_cmp_eq_u32 vcc, 0, v19
    s_cbranch_vccnz L_cv0
    v_fmac_f32 v4, s24, v16
    v_fmac_f32 v5, s24, v17
    v_fmac_f32 v6, s24, v18
    s_bitset0_b32 s56, 0
L_cv0:
    s_bitcmp0_b32 s56, 1
    s_cbranch_scc1 L_cv1
    v_cmp_eq_u32 vcc, 0, v23
    s_cbranch_vccnz L_cv1
    v_fmac_f32 v4, s25, v20
    v_fmac_f32 v5, s25, v21
    v_fmac_f32 v6, s25, v22
    s_bitset0_b32 s56, 1
L_cv1:
    s_bitcmp0_b32 s56, 2
    s_cbranch_scc1 L_cv2
    v_cmp_eq_u32 vcc, 0, v27
    s_cbranch_vccnz L_cv2
    v_fmac_f32 v4, s26, v24
    v_fmac_f32 v5, s26, v25
    v_fmac_f32 v6, s26, v26
    s_bitset0_b32 s56, 2
L_cv2:
    s_bitcmp0_b32 s56, 3
    s_cbranch_scc1 L_cv3
    v_cmp_eq_u32 vcc, 0, v31
    s_cbranch_vccnz L_cv3
    v_fmac_f32 v4, s27, v28
    v_fmac_f32 v5, s27, v29
    v_fmac_f32 v6, s27, v30
    s_bitset0_b32 s56, 3
L_cv3:
    s_bitcmp0_b32 s56, 4
    s_cbranch_scc1 L_cv4
    v_cmp_eq_u32 vcc, 0, v35
    s_cbranch_vccnz L_cv4
    v_fmac_f32 v4, s28, v32
    v_fmac_f32 v5, s28, v33
    v_fmac_f32 v6, s28, v34
    s_bitset0_b32 s56, 4
L_cv4:
    s_bitcmp0_b32 s56, 5
    s_cbranch_scc1 L_cv5
    v_cmp_eq_u32 vcc, 0, v39
    s_cbranch_vccnz L_cv5
    v_fmac_f32 v4, s29, v36
    v_fmac_f32 v5, s29, v37
    v_fmac_f32 v6, s29, v38
    s_bitset0_b32 s56, 5
L_cv5:
    s_bitcmp0_b32 s56, 6
    s_cbranch_scc1 L_cv6
    v_cmp_eq_u32 vcc, 0, v43
    s_cbranch_vccnz L_cv6
    v_fmac_f32 v4, s30, v40
    v_fmac_f32 v5, s30, v41
    v_fmac_f32 v6, s30, v42
    s_bitset0_b32 s56, 6
L_cv6:
    s_bitcmp0_b32 s56, 7
    s_cbranch_scc1 L_cv7
    v_cmp_eq_u32 vcc, 0, v47
    s_cbranch_vccnz L_cv7
    v_fmac_f32 v4, s31, v44
    v_fmac_f32 v5, s31, v45
    v_fmac_f32 v6, s31, v46
    s_bitset0_b32 s56, 7
L_cv7:
    s_bitcmp0_b32 s56, 8
    s_cbranch_scc1 L_cv8
    v_cmp_eq_u32 vcc, 0, v51
    s_cbranch_vccnz L_cv8
    v_fmac_f32 v4, s32, v48
    v_fmac_f32 v5, s32, v49
    v_fmac_f32 v6, s32, v50
    s_bitset0_b32 s56, 8
L_cv8:
    s_bitcmp0_b32 s56, 9
    s_cbranch_scc1 L_cv9
    v_cmp_eq_u32 vcc, 0, v55
    s_cbranch_vccnz L_cv9
    v_fmac_f32 v4, s33, v52
    v_fmac_f32 v5, s33, v53
    v_fmac_f32 v6, s33, v54
    s_bitset0_b32 s56, 9
L_cv9:
    s_bitcmp0_b32 s56, 10
    s_cbranch_scc1 L_cv10
    v_cmp_eq_u32 vcc, 0, v59
    s_cbranch_vccnz L_cv10
    v_fmac_f32 v4, s34, v56
    v_fmac_f32 v5, s34, v57
    v_fmac_f32 v6, s34, v58
    s_bitset0_b32 s56, 10
L_cv10:
    s_bitcmp0_b32 s56, 11
    s_cbranch_scc1 L_cv11
    v_cmp_eq_u32 vcc, 0, v63
    s_cbranch_vccnz L_cv11
    v_fmac_f32 v4, s35, v60
    v_fmac_f32 v5, s35, v61
    v_fmac_f32 v6, s35, v62
    s_bitset0_b32 s56, 11
L_cv11:
    s_bitcmp0_b32 s56, 12
    s_cbranch_scc1 L_cv12
    v_cmp_eq_u32 vcc, 0, v67
    s_cbranch_vccnz L_cv12
    v_fmac_f32 v4, s36, v64
    v_fmac_f32 v5, s36, v65
    v_fmac_f32 v6, s36, v66
    s_bitset0_b32 s56, 12
L_cv12:
    s_bitcmp0_b32 s56, 13
    s_cbranch_scc1 L_cv13
    v_cmp_eq_u32 vcc, 0, v71
    s_cbranch_vccnz L_cv13
    v_fmac_f32 v4, s37, v68
    v_fmac_f32 v5, s37, v69
    v_fmac_f32 v6, s37, v70
    s_bitset0_b32 s56, 13
L_cv13:
    s_bitcmp0_b32 s56, 14
    s_cbranch_scc1 L_cv14
    v_cmp_eq_u32 vcc, 0, v75
    s_cbranch_vccnz L_cv14
    v_fmac_f32 v4, s38, v72
    v_fmac_f32 v5, s38, v73
    v_fmac_f32 v6, s38, v74
    s_bitset0_b32 s56, 14
L_cv14:
    s_bitcmp0_b32 s56, 15
    s_cbranch_scc1 L_cv15
    v_cmp_eq_u32 vcc, 0, v79
    s_cbranch_vccnz L_cv15
    v_fmac_f32 v4, s39, v76
    v_fmac_f32 v5, s39, v77
    v_fmac_f32 v6, s39, v78
    s_bitset0_b32 s56, 15
L_cv15:
    s_bitcmp0_b32 s56, 16
    s_cbranch_scc1 L_cv16
    v_cmp_eq_u32 vcc, 0, v83
    s_cbranch_vccnz L_cv16
    v_fmac_f32 v4, s40, v80
    v_fmac_f32 v5, s40, v81
    v_fmac_f32 v6, s40, v82
    s_bitset0_b32 s56, 16
L_cv16:
    s_bitcmp0_b32 s56, 17
    s_cbranch_scc1 L_cv17
    v_cmp_eq_u32 vcc, 0, v87
    s_cbranch_vccnz L_cv17
    v_fmac_f32 v4, s41, v84
    v_fmac_f32 v5, s41, v85
    v_fmac_f32 v6, s41, v86
    s_bitset0_b32 s56, 17
L_cv17:
    s_bitcmp0_b32 s56, 18
    s_cbranch_scc1 L_cv18
    v_cmp_eq_u32 vcc, 0, v91
    s_cbranch_vccnz L_cv18
    v_fmac_f32 v4, s42, v88
    v_fmac_f32 v5, s42, v89
    v_fmac_f32 v6, s42, v90
    s_bitset0_b32 s56, 18
L_cv18:
    s_bitcmp0_b32 s56, 19
    s_cbranch_scc1 L_cv19
    v_cmp_eq_u32 vcc, 0, v95
    s_cbranch_vccnz L_cv19
    v_fmac_f32 v4, s43, v92
    v_fmac_f32 v5, s43, v93
    v_fmac_f32 v6, s43, v94
    s_bitset0_b32 s56, 19
L_cv19:
    s_bitcmp0_b32 s56, 20
    s_cbranch_scc1 L_cv20
    v_cmp_eq_u32 vcc, 0, v99
    s_cbranch_vccnz L_cv20
    v_fmac_f32 v4, s44, v96
    v_fmac_f32 v5, s44, v97
    v_fmac_f32 v6, s44, v98
    s_bitset0_b32 s56, 20
L_cv20:
    s_bitcmp0_b32 s56, 21
    s_cbranch_scc1 L_cv21
    v_cmp_eq_u32 vcc, 0, v103
    s_cbranch_vccnz L_cv21
    v_fmac_f32 v4, s45, v100
    v_fmac_f32 v5, s45, v101
    v_fmac_f32 v6, s45, v102
    s_bitset0_b32 s56, 21
L_cv21:
    s_bitcmp0_b32 s56, 22
    s_cbranch_scc1 L_cv22
    v_cmp_eq_u32 vcc, 0, v107
    s_cbranch_vccnz L_cv22
    v_fmac_f32 v4, s46, v104
    v_fmac_f32 v5, s46, v105
    v_fmac_f32 v6, s46, v106
    s_bitset0_b32 s56, 22
L_cv22:
    s_bitcmp0_b32 s56, 23
    s_cbranch_scc1 L_cv23
    v_cmp_eq_u32 vcc, 0, v111
    s_cbranch_vccnz L_cv23
    v_fmac_f32 v4, s47, v108
    v_fmac_f32 v5, s47, v109
    v_fmac_f32 v6, s47, v110
    s_bitset0_b32 s56, 23
L_cv23:
    s_cmp_lg_u32 s56, 0
    s_cbranch_scc1 L_cr
    v_cvt_pk_bf16_f32 v4, v4, v4
    buffer_store_short v4, v12, s[92:95], s57 offen offset:0
    v_cvt_pk_bf16_f32 v5, v5, v5
    buffer_store_short v5, v12, s[92:95], s57 offen offset:128
    v_cvt_pk_bf16_f32 v6, v6, v6
    buffer_store_short v6, v12, s[92:95], s57 offen offset:256
    s_endpgm
L_h0:
    s_nop 1
    s_mov_b32 s8, s64
    s_and_b32 s9, s65, 0xffff
    s_mov_b32 s10, 12288
    s_mov_b32 s11, 0x00020000
    s_mov_b32 s92, s70
    s_and_b32 s93, s71, 0xffff
    s_mov_b32 s94, 6291456
    s_mov_b32 s95, 0x00020000
    s_mov_b32 s96, s72
    s_and_b32 s97, s73, 0xffff
    s_mov_b32 s98, 6291456
    s_mov_b32 s99, 0x00020000
    v_lshrrev_b32 v4, 4, v1
    v_and_b32 v5, 15, v1
    v_lshlrev_b32 v6, 3, v5
    v_mul_u32_u24 v7, 384, v4
    v_add_u32 v7, v7, v6
    v_lshl_add_u32 v13, v5, 2, v4
    v_lshlrev_b32 v13, 2, v13
    v_lshlrev_b32 v4, 4, v1
    s_mul_i32 s32, s5, 4352
    s_add_u32 s32, s32, s59
    s_lshl_b32 s33, s3, 3
    s_add_u32 s33, s33, s5
    s_mul_i32 s33, s33, 6144
    s_add_u32 s33, s33, 2097152
    v_mov_b32 v16, 0
    v_mov_b32 v17, 0
    v_mov_b32 v18, 0
    v_mov_b32 v19, 0
    s_add_u32 s48, s2, 0
    s_lshl_b32 s49, s48, 10
    s_lshl_b32 s48, s48, 6
    s_add_u32 s48, s48, 917504
    buffer_store_dwordx4 v[16:19], v4, s[12:15], s49 offen sc1
    s_mov_b64 exec, 15
    buffer_store_dwordx4 v[16:19], v4, s[12:15], s48 offen sc1
    s_mov_b64 exec, -1
    s_add_u32 s48, s2, 256
    s_lshl_b32 s49, s48, 10
    s_lshl_b32 s48, s48, 6
    s_add_u32 s48, s48, 917504
    buffer_store_dwordx4 v[16:19], v4, s[12:15], s49 offen sc1
    s_mov_b64 exec, 15
    buffer_store_dwordx4 v[16:19], v4, s[12:15], s48 offen sc1
    s_mov_b64 exec, -1
    s_add_u32 s48, s2, 512
    s_lshl_b32 s49, s48, 10
    s_lshl_b32 s48, s48, 6
    s_add_u32 s48, s48, 917504
    buffer_store_dwordx4 v[16:19], v4, s[12:15], s49 offen sc1
    s_mov_b64 exec, 15
    buffer_store_dwordx4 v[16:19], v4, s[12:15], s48 offen sc1
    s_mov_b64 exec, -1
    s_mov_b32 s61, 0
    s_lshl_b32 s62, s61, 5
    s_add_u32 s62, s62, s3
    s_lshl_b32 s63, s62, 15
    s_add_u32 s63, s63, 1
    s_mul_hi_u32 s63, s63, 0xaaaaaaab
    s_lshr_b32 s63, s63, 7
    s_mul_i32 s48, s62, 171
    s_lshr_b32 s48, s48, 9
    s_mul_i32 s48, s48, 384
    s_mul_i32 s49, s4, 24
    s_add_u32 s50, s49, s63
    s_mul_i32 s50, s50, 384
    v_add_u32 v10, s50, v7
    v_add_u32 v11, 3072, v10
    v_add_u32 v12, 6144, v10
    buffer_load_dwordx2 v[100:101], v6, s[8:11], s48 offen offset:0
    buffer_load_dwordx2 v[102:103], v6, s[8:11], s48 offen offset:128
    buffer_load_dwordx2 v[104:105], v6, s[8:11], s48 offen offset:256
    buffer_load_dwordx2 v[28:29], v10, s[92:95], 0 offen offset:0
    buffer_load_dwordx2 v[30:31], v10, s[92:95], 0 offen offset:128
    buffer_load_dwordx2 v[32:33], v10, s[92:95], 0 offen offset:256
    buffer_load_dwordx2 v[64:65], v10, s[96:99], 0 offen offset:0
    buffer_load_dwordx2 v[66:67], v10, s[96:99], 0 offen offset:128
    buffer_load_dwordx2 v[68:69], v10, s[96:99], 0 offen offset:256
    buffer_load_dwordx2 v[34:35], v10, s[92:95], 0 offen offset:1536
    buffer_load_dwordx2 v[36:37], v10, s[92:95], 0 offen offset:1664
    buffer_load_dwordx2 v[38:39], v10, s[92:95], 0 offen offset:1792
    buffer_load_dwordx2 v[70:71], v10, s[96:99], 0 offen offset:1536
    buffer_load_dwordx2 v[72:73], v10, s[96:99], 0 offen offset:1664
    buffer_load_dwordx2 v[74:75], v10, s[96:99], 0 offen offset:1792
    buffer_load_dwordx2 v[40:41], v11, s[92:95], 0 offen offset:0
    buffer_load_dwordx2 v[42:43], v11, s[92:95], 0 offen offset:128
    buffer_load_dwordx2 v[44:45], v11, s[92:95], 0 offen offset:256
    buffer_load_dwordx2 v[76:77], v11, s[96:99], 0 offen offset:0
    buffer_load_dwordx2 v[78:79], v11, s[96:99], 0 offen offset:128
    buffer_load_dwordx2 v[80:81], v11, s[96:99], 0 offen offset:256
    buffer_load_dwordx2 v[46:47], v11, s[92:95], 0 offen offset:1536
    buffer_load_dwordx2 v[48:49], v11, s[92:95], 0 offen offset:1664
    buffer_load_dwordx2 v[50:51], v11, s[92:95], 0 offen offset:1792
    buffer_load_dwordx2 v[82:83], v11, s[96:99], 0 offen offset:1536
    buffer_load_dwordx2 v[84:85], v11, s[96:99], 0 offen offset:1664
    buffer_load_dwordx2 v[86:87], v11, s[96:99], 0 offen offset:1792
    buffer_load_dwordx2 v[52:53], v12, s[92:95], 0 offen offset:0
    buffer_load_dwordx2 v[54:55], v12, s[92:95], 0 offen offset:128
    buffer_load_dwordx2 v[56:57], v12, s[92:95], 0 offen offset:256
    buffer_load_dwordx2 v[88:89], v12, s[96:99], 0 offen offset:0
    buffer_load_dwordx2 v[90:91], v12, s[96:99], 0 offen offset:128
    buffer_load_dwordx2 v[92:93], v12, s[96:99], 0 offen offset:256
    buffer_load_dwordx2 v[58:59], v12, s[92:95], 0 offen offset:1536
    buffer_load_dwordx2 v[60:61], v12, s[92:95], 0 offen offset:1664
    buffer_load_dwordx2 v[62:63], v12, s[92:95], 0 offen offset:1792
    buffer_load_dwordx2 v[94:95], v12, s[96:99], 0 offen offset:1536
    buffer_load_dwordx2 v[96:97], v12, s[96:99], 0 offen offset:1664
    buffer_load_dwordx2 v[98:99], v12, s[96:99], 0 offen offset:1792
    s_waitcnt vmcnt(0)
    v_lshlrev_b32 v16, 16, v100
    v_and_b32 v17, 0xffff0000, v100
    v_lshlrev_b32 v18, 16, v101
    v_and_b32 v19, 0xffff0000, v101
    v_lshlrev_b32 v20, 16, v102
    v_and_b32 v21, 0xffff0000, v102
    v_lshlrev_b32 v22, 16, v103
    v_and_b32 v23, 0xffff0000, v103
    v_lshlrev_b32 v24, 16, v104
    v_and_b32 v25, 0xffff0000, v104
    v_lshlrev_b32 v26, 16, v105
    v_and_b32 v27, 0xffff0000, v105
    v_lshlrev_b32 v10, 16, v28
    v_lshlrev_b32 v11, 16, v64
    v_and_b32 v28, 0xffff0000, v28
    v_and_b32 v64, 0xffff0000, v64
    v_mul_f32 v10, v10, v16
    v_mul_f32 v28, v28, v17
    v_mul_f32 v100, v10, v11
    v_fmac_f32 v100, v28, v64
    v_lshlrev_b32 v10, 16, v29
    v_lshlrev_b32 v11, 16, v65
    v_and_b32 v29, 0xffff0000, v29
    v_and_b32 v65, 0xffff0000, v65
    v_mul_f32 v10, v10, v18
    v_mul_f32 v29, v29, v19
    v_fmac_f32 v100, v10, v11
    v_fmac_f32 v100, v29, v65
    v_lshlrev_b32 v10, 16, v30
    v_lshlrev_b32 v11, 16, v66
    v_and_b32 v30, 0xffff0000, v30
    v_and_b32 v66, 0xffff0000, v66
    v_mul_f32 v10, v10, v20
    v_mul_f32 v30, v30, v21
    v_fmac_f32 v100, v10, v11
    v_fmac_f32 v100, v30, v66
    v_lshlrev_b32 v10, 16, v31
    v_lshlrev_b32 v11, 16, v67
    v_and_b32 v31, 0xffff0000, v31
    v_and_b32 v67, 0xffff0000, v67
    v_mul_f32 v10, v10, v22
    v_mul_f32 v31, v31, v23
    v_fmac_f32 v100, v10, v11
    v_fmac_f32 v100, v31, v67
    v_lshlrev_b32 v10, 16, v32
    v_lshlrev_b32 v11, 16, v68
    v_and_b32 v32, 0xffff0000, v32
    v_and_b32 v68, 0xffff0000, v68
    v_mul_f32 v10, v10, v24
    v_mul_f32 v32, v32, v25
    v_fmac_f32 v100, v10, v11
    v_fmac_f32 v100, v32, v68
    v_lshlrev_b32 v10, 16, v33
    v_lshlrev_b32 v11, 16, v69
    v_and_b32 v33, 0xffff0000, v33
    v_and_b32 v69, 0xffff0000, v69
    v_mul_f32 v10, v10, v26
    v_mul_f32 v33, v33, v27
    v_fmac_f32 v100, v10, v11
    v_fmac_f32 v100, v33, v69
    v_lshlrev_b32 v10, 16, v34
    v_lshlrev_b32 v11, 16, v70
    v_and_b32 v34, 0xffff0000, v34
    v_and_b32 v70, 0xffff0000, v70
    v_mul_f32 v10, v10, v16
    v_mul_f32 v34, v34, v17
    v_mul_f32 v101, v10, v11
    v_fmac_f32 v101, v34, v70
    v_lshlrev_b32 v10, 16, v35
    v_lshlrev_b32 v11, 16, v71
    v_and_b32 v35, 0xffff0000, v35
    v_and_b32 v71, 0xffff0000, v71
    v_mul_f32 v10, v10, v18
    v_mul_f32 v35, v35, v19
    v_fmac_f32 v101, v10, v11
    v_fmac_f32 v101, v35, v71
    v_lshlrev_b32 v10, 16, v36
    v_lshlrev_b32 v11, 16, v72
    v_and_b32 v36, 0xffff0000, v36
    v_and_b32 v72, 0xffff0000, v72
    v_mul_f32 v10, v10, v20
    v_mul_f32 v36, v36, v21
    v_fmac_f32 v101, v10, v11
    v_fmac_f32 v101, v36, v72
    v_lshlrev_b32 v10, 16, v37
    v_lshlrev_b32 v11, 16, v73
    v_and_b32 v37, 0xffff0000, v37
    v_and_b32 v73, 0xffff0000, v73
    v_mul_f32 v10, v10, v22
    v_mul_f32 v37, v37, v23
    v_fmac_f32 v101, v10, v11
    v_fmac_f32 v101, v37, v73
    v_lshlrev_b32 v10, 16, v38
    v_lshlrev_b32 v11, 16, v74
    v_and_b32 v38, 0xffff0000, v38
    v_and_b32 v74, 0xffff0000, v74
    v_mul_f32 v10, v10, v24
    v_mul_f32 v38, v38, v25
    v_fmac_f32 v101, v10, v11
    v_fmac_f32 v101, v38, v74
    v_lshlrev_b32 v10, 16, v39
    v_lshlrev_b32 v11, 16, v75
    v_and_b32 v39, 0xffff0000, v39
    v_and_b32 v75, 0xffff0000, v75
    v_mul_f32 v10, v10, v26
    v_mul_f32 v39, v39, v27
    v_fmac_f32 v101, v10, v11
    v_fmac_f32 v101, v39, v75
    v_lshlrev_b32 v10, 16, v40
    v_lshlrev_b32 v11, 16, v76
    v_and_b32 v40, 0xffff0000, v40
    v_and_b32 v76, 0xffff0000, v76
    v_mul_f32 v10, v10, v16
    v_mul_f32 v40, v40, v17
    v_mul_f32 v102, v10, v11
    v_fmac_f32 v102, v40, v76
    v_lshlrev_b32 v10, 16, v41
    v_lshlrev_b32 v11, 16, v77
    v_and_b32 v41, 0xffff0000, v41
    v_and_b32 v77, 0xffff0000, v77
    v_mul_f32 v10, v10, v18
    v_mul_f32 v41, v41, v19
    v_fmac_f32 v102, v10, v11
    v_fmac_f32 v102, v41, v77
    v_lshlrev_b32 v10, 16, v42
    v_lshlrev_b32 v11, 16, v78
    v_and_b32 v42, 0xffff0000, v42
    v_and_b32 v78, 0xffff0000, v78
    v_mul_f32 v10, v10, v20
    v_mul_f32 v42, v42, v21
    v_fmac_f32 v102, v10, v11
    v_fmac_f32 v102, v42, v78
    v_lshlrev_b32 v10, 16, v43
    v_lshlrev_b32 v11, 16, v79
    v_and_b32 v43, 0xffff0000, v43
    v_and_b32 v79, 0xffff0000, v79
    v_mul_f32 v10, v10, v22
    v_mul_f32 v43, v43, v23
    v_fmac_f32 v102, v10, v11
    v_fmac_f32 v102, v43, v79
    v_lshlrev_b32 v10, 16, v44
    v_lshlrev_b32 v11, 16, v80
    v_and_b32 v44, 0xffff0000, v44
    v_and_b32 v80, 0xffff0000, v80
    v_mul_f32 v10, v10, v24
    v_mul_f32 v44, v44, v25
    v_fmac_f32 v102, v10, v11
    v_fmac_f32 v102, v44, v80
    v_lshlrev_b32 v10, 16, v45
    v_lshlrev_b32 v11, 16, v81
    v_and_b32 v45, 0xffff0000, v45
    v_and_b32 v81, 0xffff0000, v81
    v_mul_f32 v10, v10, v26
    v_mul_f32 v45, v45, v27
    v_fmac_f32 v102, v10, v11
    v_fmac_f32 v102, v45, v81
    v_lshlrev_b32 v10, 16, v46
    v_lshlrev_b32 v11, 16, v82
    v_and_b32 v46, 0xffff0000, v46
    v_and_b32 v82, 0xffff0000, v82
    v_mul_f32 v10, v10, v16
    v_mul_f32 v46, v46, v17
    v_mul_f32 v103, v10, v11
    v_fmac_f32 v103, v46, v82
    v_lshlrev_b32 v10, 16, v47
    v_lshlrev_b32 v11, 16, v83
    v_and_b32 v47, 0xffff0000, v47
    v_and_b32 v83, 0xffff0000, v83
    v_mul_f32 v10, v10, v18
    v_mul_f32 v47, v47, v19
    v_fmac_f32 v103, v10, v11
    v_fmac_f32 v103, v47, v83
    v_lshlrev_b32 v10, 16, v48
    v_lshlrev_b32 v11, 16, v84
    v_and_b32 v48, 0xffff0000, v48
    v_and_b32 v84, 0xffff0000, v84
    v_mul_f32 v10, v10, v20
    v_mul_f32 v48, v48, v21
    v_fmac_f32 v103, v10, v11
    v_fmac_f32 v103, v48, v84
    v_lshlrev_b32 v10, 16, v49
    v_lshlrev_b32 v11, 16, v85
    v_and_b32 v49, 0xffff0000, v49
    v_and_b32 v85, 0xffff0000, v85
    v_mul_f32 v10, v10, v22
    v_mul_f32 v49, v49, v23
    v_fmac_f32 v103, v10, v11
    v_fmac_f32 v103, v49, v85
    v_lshlrev_b32 v10, 16, v50
    v_lshlrev_b32 v11, 16, v86
    v_and_b32 v50, 0xffff0000, v50
    v_and_b32 v86, 0xffff0000, v86
    v_mul_f32 v10, v10, v24
    v_mul_f32 v50, v50, v25
    v_fmac_f32 v103, v10, v11
    v_fmac_f32 v103, v50, v86
    v_lshlrev_b32 v10, 16, v51
    v_lshlrev_b32 v11, 16, v87
    v_and_b32 v51, 0xffff0000, v51
    v_and_b32 v87, 0xffff0000, v87
    v_mul_f32 v10, v10, v26
    v_mul_f32 v51, v51, v27
    v_fmac_f32 v103, v10, v11
    v_fmac_f32 v103, v51, v87
    v_lshlrev_b32 v10, 16, v52
    v_lshlrev_b32 v11, 16, v88
    v_and_b32 v52, 0xffff0000, v52
    v_and_b32 v88, 0xffff0000, v88
    v_mul_f32 v10, v10, v16
    v_mul_f32 v52, v52, v17
    v_mul_f32 v104, v10, v11
    v_fmac_f32 v104, v52, v88
    v_lshlrev_b32 v10, 16, v53
    v_lshlrev_b32 v11, 16, v89
    v_and_b32 v53, 0xffff0000, v53
    v_and_b32 v89, 0xffff0000, v89
    v_mul_f32 v10, v10, v18
    v_mul_f32 v53, v53, v19
    v_fmac_f32 v104, v10, v11
    v_fmac_f32 v104, v53, v89
    v_lshlrev_b32 v10, 16, v54
    v_lshlrev_b32 v11, 16, v90
    v_and_b32 v54, 0xffff0000, v54
    v_and_b32 v90, 0xffff0000, v90
    v_mul_f32 v10, v10, v20
    v_mul_f32 v54, v54, v21
    v_fmac_f32 v104, v10, v11
    v_fmac_f32 v104, v54, v90
    v_lshlrev_b32 v10, 16, v55
    v_lshlrev_b32 v11, 16, v91
    v_and_b32 v55, 0xffff0000, v55
    v_and_b32 v91, 0xffff0000, v91
    v_mul_f32 v10, v10, v22
    v_mul_f32 v55, v55, v23
    v_fmac_f32 v104, v10, v11
    v_fmac_f32 v104, v55, v91
    v_lshlrev_b32 v10, 16, v56
    v_lshlrev_b32 v11, 16, v92
    v_and_b32 v56, 0xffff0000, v56
    v_and_b32 v92, 0xffff0000, v92
    v_mul_f32 v10, v10, v24
    v_mul_f32 v56, v56, v25
    v_fmac_f32 v104, v10, v11
    v_fmac_f32 v104, v56, v92
    v_lshlrev_b32 v10, 16, v57
    v_lshlrev_b32 v11, 16, v93
    v_and_b32 v57, 0xffff0000, v57
    v_and_b32 v93, 0xffff0000, v93
    v_mul_f32 v10, v10, v26
    v_mul_f32 v57, v57, v27
    v_fmac_f32 v104, v10, v11
    v_fmac_f32 v104, v57, v93
    v_lshlrev_b32 v10, 16, v58
    v_lshlrev_b32 v11, 16, v94
    v_and_b32 v58, 0xffff0000, v58
    v_and_b32 v94, 0xffff0000, v94
    v_mul_f32 v10, v10, v16
    v_mul_f32 v58, v58, v17
    v_mul_f32 v105, v10, v11
    v_fmac_f32 v105, v58, v94
    v_lshlrev_b32 v10, 16, v59
    v_lshlrev_b32 v11, 16, v95
    v_and_b32 v59, 0xffff0000, v59
    v_and_b32 v95, 0xffff0000, v95
    v_mul_f32 v10, v10, v18
    v_mul_f32 v59, v59, v19
    v_fmac_f32 v105, v10, v11
    v_fmac_f32 v105, v59, v95
    v_lshlrev_b32 v10, 16, v60
    v_lshlrev_b32 v11, 16, v96
    v_and_b32 v60, 0xffff0000, v60
    v_and_b32 v96, 0xffff0000, v96
    v_mul_f32 v10, v10, v20
    v_mul_f32 v60, v60, v21
    v_fmac_f32 v105, v10, v11
    v_fmac_f32 v105, v60, v96
    v_lshlrev_b32 v10, 16, v61
    v_lshlrev_b32 v11, 16, v97
    v_and_b32 v61, 0xffff0000, v61
    v_and_b32 v97, 0xffff0000, v97
    v_mul_f32 v10, v10, v22
    v_mul_f32 v61, v61, v23
    v_fmac_f32 v105, v10, v11
    v_fmac_f32 v105, v61, v97
    v_lshlrev_b32 v10, 16, v62
    v_lshlrev_b32 v11, 16, v98
    v_and_b32 v62, 0xffff0000, v62
    v_and_b32 v98, 0xffff0000, v98
    v_mul_f32 v10, v10, v24
    v_mul_f32 v62, v62, v25
    v_fmac_f32 v105, v10, v11
    v_fmac_f32 v105, v62, v98
    v_lshlrev_b32 v10, 16, v63
    v_lshlrev_b32 v11, 16, v99
    v_and_b32 v63, 0xffff0000, v63
    v_and_b32 v99, 0xffff0000, v99
    v_mul_f32 v10, v10, v26
    v_mul_f32 v63, v63, v27
    v_fmac_f32 v105, v10, v11
    v_fmac_f32 v105, v63, v99
    v_add_f32_dpp v100, v100, v100 row_ror:8 row_mask:0xf bank_mask:0xf
    v_add_f32_dpp v101, v101, v101 row_ror:8 row_mask:0xf bank_mask:0xf
    v_add_f32_dpp v102, v102, v102 row_ror:8 row_mask:0xf bank_mask:0xf
    v_add_f32_dpp v103, v103, v103 row_ror:8 row_mask:0xf bank_mask:0xf
    v_add_f32_dpp v104, v104, v104 row_ror:8 row_mask:0xf bank_mask:0xf
    v_add_f32_dpp v105, v105, v105 row_ror:8 row_mask:0xf bank_mask:0xf
    v_add_f32_dpp v100, v100, v100 row_ror:4 row_mask:0xf bank_mask:0xf
    v_add_f32_dpp v101, v101, v101 row_ror:4 row_mask:0xf bank_mask:0xf
    v_add_f32_dpp v102, v102, v102 row_ror:4 row_mask:0xf bank_mask:0xf
    v_add_f32_dpp v103, v103, v103 row_ror:4 row_mask:0xf bank_mask:0xf
    v_add_f32_dpp v104, v104, v104 row_ror:4 row_mask:0xf bank_mask:0xf
    v_add_f32_dpp v105, v105, v105 row_ror:4 row_mask:0xf bank_mask:0xf
    v_add_f32_dpp v100, v100, v100 row_ror:2 row_mask:0xf bank_mask:0xf
    v_add_f32_dpp v101, v101, v101 row_ror:2 row_mask:0xf bank_mask:0xf
    v_add_f32_dpp v102, v102, v102 row_ror:2 row_mask:0xf bank_mask:0xf
    v_add_f32_dpp v103, v103, v103 row_ror:2 row_mask:0xf bank_mask:0xf
    v_add_f32_dpp v104, v104, v104 row_ror:2 row_mask:0xf bank_mask:0xf
    v_add_f32_dpp v105, v105, v105 row_ror:2 row_mask:0xf bank_mask:0xf
    v_add_f32_dpp v100, v100, v100 row_ror:1 row_mask:0xf bank_mask:0xf
    v_add_f32_dpp v101, v101, v101 row_ror:1 row_mask:0xf bank_mask:0xf
    v_add_f32_dpp v102, v102, v102 row_ror:1 row_mask:0xf bank_mask:0xf
    v_add_f32_dpp v103, v103, v103 row_ror:1 row_mask:0xf bank_mask:0xf
    v_add_f32_dpp v104, v104, v104 row_ror:1 row_mask:0xf bank_mask:0xf
    v_add_f32_dpp v105, v105, v105 row_ror:1 row_mask:0xf bank_mask:0xf
    v_cmp_eq_u32 vcc, 1, v5
    s_nop 1
    v_cndmask_b32 v100, v100, v101, vcc
    v_cmp_eq_u32 vcc, 2, v5
    s_nop 1
    v_cndmask_b32 v100, v100, v102, vcc
    v_cmp_eq_u32 vcc, 3, v5
    s_nop 1
    v_cndmask_b32 v100, v100, v103, vcc
    v_cmp_eq_u32 vcc, 4, v5
    s_nop 1
    v_cndmask_b32 v100, v100, v104, vcc
    v_cmp_eq_u32 vcc, 5, v5
    s_nop 1
    v_cndmask_b32 v100, v100, v105, vcc
    s_mul_i32 s48, s62, 768
    s_lshl_b32 s49, s49, 2
    s_add_u32 s48, s48, s49
    s_add_u32 s48, s48, 1179648
    s_mov_b32 exec_lo, 0x003f003f
    s_mov_b32 exec_hi, 0x003f003f
    buffer_store_dword v100, v13, s[12:15], s48 offen sc1
    s_mov_b64 exec, -1
    s_mov_b32 s60, 0x100000
L_wb1:
    s_nop 1
    ds_read_b32 v10, v2 offset:60
    s_sub_u32 s60, s60, 1
    s_cbranch_scc1 L_exit1
    s_waitcnt lgkmcnt(0)
    v_readfirstlane_b32 s48, v10
    s_cmp_lt_u32 s48, 1
    s_cbranch_scc1 L_wb1
    s_mov_b32 s61, 1
    s_lshl_b32 s62, s61, 5
    s_add_u32 s62, s62, s3
    s_lshl_b32 s63, s62, 15
    s_add_u32 s63, s63, 1
    s_mul_hi_u32 s63, s63, 0xaaaaaaab
    s_lshr_b32 s63, s63, 7
    s_mul_i32 s48, s62, 171
    s_lshr_b32 s48, s48, 9
    s_mul_i32 s48, s48, 384
    s_mul_i32 s49, s4, 24
    s_add_u32 s50, s49, s63
    s_mul_i32 s50, s50, 384
    v_add_u32 v10, s50, v7
    v_add_u32 v11, 3072, v10
    v_add_u32 v12, 6144, v10
    buffer_load_dwordx2 v[100:101], v6, s[8:11], s48 offen offset:0
    buffer_load_dwordx2 v[102:103], v6, s[8:11], s48 offen offset:128
    buffer_load_dwordx2 v[104:105], v6, s[8:11], s48 offen offset:256
    buffer_load_dwordx2 v[28:29], v10, s[92:95], 0 offen offset:0
    buffer_load_dwordx2 v[30:31], v10, s[92:95], 0 offen offset:128
    buffer_load_dwordx2 v[32:33], v10, s[92:95], 0 offen offset:256
    buffer_load_dwordx2 v[64:65], v10, s[96:99], 0 offen offset:0
    buffer_load_dwordx2 v[66:67], v10, s[96:99], 0 offen offset:128
    buffer_load_dwordx2 v[68:69], v10, s[96:99], 0 offen offset:256
    buffer_load_dwordx2 v[34:35], v10, s[92:95], 0 offen offset:1536
    buffer_load_dwordx2 v[36:37], v10, s[92:95], 0 offen offset:1664
    buffer_load_dwordx2 v[38:39], v10, s[92:95], 0 offen offset:1792
    buffer_load_dwordx2 v[70:71], v10, s[96:99], 0 offen offset:1536
    buffer_load_dwordx2 v[72:73], v10, s[96:99], 0 offen offset:1664
    buffer_load_dwordx2 v[74:75], v10, s[96:99], 0 offen offset:1792
    buffer_load_dwordx2 v[40:41], v11, s[92:95], 0 offen offset:0
    buffer_load_dwordx2 v[42:43], v11, s[92:95], 0 offen offset:128
    buffer_load_dwordx2 v[44:45], v11, s[92:95], 0 offen offset:256
    buffer_load_dwordx2 v[76:77], v11, s[96:99], 0 offen offset:0
    buffer_load_dwordx2 v[78:79], v11, s[96:99], 0 offen offset:128
    buffer_load_dwordx2 v[80:81], v11, s[96:99], 0 offen offset:256
    buffer_load_dwordx2 v[46:47], v11, s[92:95], 0 offen offset:1536
    buffer_load_dwordx2 v[48:49], v11, s[92:95], 0 offen offset:1664
    buffer_load_dwordx2 v[50:51], v11, s[92:95], 0 offen offset:1792
    buffer_load_dwordx2 v[82:83], v11, s[96:99], 0 offen offset:1536
    buffer_load_dwordx2 v[84:85], v11, s[96:99], 0 offen offset:1664
    buffer_load_dwordx2 v[86:87], v11, s[96:99], 0 offen offset:1792
    buffer_load_dwordx2 v[52:53], v12, s[92:95], 0 offen offset:0
    buffer_load_dwordx2 v[54:55], v12, s[92:95], 0 offen offset:128
    buffer_load_dwordx2 v[56:57], v12, s[92:95], 0 offen offset:256
    buffer_load_dwordx2 v[88:89], v12, s[96:99], 0 offen offset:0
    buffer_load_dwordx2 v[90:91], v12, s[96:99], 0 offen offset:128
    buffer_load_dwordx2 v[92:93], v12, s[96:99], 0 offen offset:256
    buffer_load_dwordx2 v[58:59], v12, s[92:95], 0 offen offset:1536
    buffer_load_dwordx2 v[60:61], v12, s[92:95], 0 offen offset:1664
    buffer_load_dwordx2 v[62:63], v12, s[92:95], 0 offen offset:1792
    buffer_load_dwordx2 v[94:95], v12, s[96:99], 0 offen offset:1536
    buffer_load_dwordx2 v[96:97], v12, s[96:99], 0 offen offset:1664
    buffer_load_dwordx2 v[98:99], v12, s[96:99], 0 offen offset:1792
    s_waitcnt vmcnt(0)
    v_lshlrev_b32 v16, 16, v100
    v_and_b32 v17, 0xffff0000, v100
    v_lshlrev_b32 v18, 16, v101
    v_and_b32 v19, 0xffff0000, v101
    v_lshlrev_b32 v20, 16, v102
    v_and_b32 v21, 0xffff0000, v102
    v_lshlrev_b32 v22, 16, v103
    v_and_b32 v23, 0xffff0000, v103
    v_lshlrev_b32 v24, 16, v104
    v_and_b32 v25, 0xffff0000, v104
    v_lshlrev_b32 v26, 16, v105
    v_and_b32 v27, 0xffff0000, v105
    v_lshlrev_b32 v10, 16, v28
    v_lshlrev_b32 v11, 16, v64
    v_and_b32 v28, 0xffff0000, v28
    v_and_b32 v64, 0xffff0000, v64
    v_mul_f32 v10, v10, v16
    v_mul_f32 v28, v28, v17
    v_mul_f32 v100, v10, v11
    v_fmac_f32 v100, v28, v64
    v_lshlrev_b32 v10, 16, v29
    v_lshlrev_b32 v11, 16, v65
    v_and_b32 v29, 0xffff0000, v29
    v_and_b32 v65, 0xffff0000, v65
    v_mul_f32 v10, v10, v18
    v_mul_f32 v29, v29, v19
    v_fmac_f32 v100, v10, v11
    v_fmac_f32 v100, v29, v65
    v_lshlrev_b32 v10, 16, v30
    v_lshlrev_b32 v11, 16, v66
    v_and_b32 v30, 0xffff0000, v30
    v_and_b32 v66, 0xffff0000, v66
    v_mul_f32 v10, v10, v20
    v_mul_f32 v30, v30, v21
    v_fmac_f32 v100, v10, v11
    v_fmac_f32 v100, v30, v66
    v_lshlrev_b32 v10, 16, v31
    v_lshlrev_b32 v11, 16, v67
    v_and_b32 v31, 0xffff0000, v31
    v_and_b32 v67, 0xffff0000, v67
    v_mul_f32 v10, v10, v22
    v_mul_f32 v31, v31, v23
    v_fmac_f32 v100, v10, v11
    v_fmac_f32 v100, v31, v67
    v_lshlrev_b32 v10, 16, v32
    v_lshlrev_b32 v11, 16, v68
    v_and_b32 v32, 0xffff0000, v32
    v_and_b32 v68, 0xffff0000, v68
    v_mul_f32 v10, v10, v24
    v_mul_f32 v32, v32, v25
    v_fmac_f32 v100, v10, v11
    v_fmac_f32 v100, v32, v68
    v_lshlrev_b32 v10, 16, v33
    v_lshlrev_b32 v11, 16, v69
    v_and_b32 v33, 0xffff0000, v33
    v_and_b32 v69, 0xffff0000, v69
    v_mul_f32 v10, v10, v26
    v_mul_f32 v33, v33, v27
    v_fmac_f32 v100, v10, v11
    v_fmac_f32 v100, v33, v69
    v_lshlrev_b32 v10, 16, v34
    v_lshlrev_b32 v11, 16, v70
    v_and_b32 v34, 0xffff0000, v34
    v_and_b32 v70, 0xffff0000, v70
    v_mul_f32 v10, v10, v16
    v_mul_f32 v34, v34, v17
    v_mul_f32 v101, v10, v11
    v_fmac_f32 v101, v34, v70
    v_lshlrev_b32 v10, 16, v35
    v_lshlrev_b32 v11, 16, v71
    v_and_b32 v35, 0xffff0000, v35
    v_and_b32 v71, 0xffff0000, v71
    v_mul_f32 v10, v10, v18
    v_mul_f32 v35, v35, v19
    v_fmac_f32 v101, v10, v11
    v_fmac_f32 v101, v35, v71
    v_lshlrev_b32 v10, 16, v36
    v_lshlrev_b32 v11, 16, v72
    v_and_b32 v36, 0xffff0000, v36
    v_and_b32 v72, 0xffff0000, v72
    v_mul_f32 v10, v10, v20
    v_mul_f32 v36, v36, v21
    v_fmac_f32 v101, v10, v11
    v_fmac_f32 v101, v36, v72
    v_lshlrev_b32 v10, 16, v37
    v_lshlrev_b32 v11, 16, v73
    v_and_b32 v37, 0xffff0000, v37
    v_and_b32 v73, 0xffff0000, v73
    v_mul_f32 v10, v10, v22
    v_mul_f32 v37, v37, v23
    v_fmac_f32 v101, v10, v11
    v_fmac_f32 v101, v37, v73
    v_lshlrev_b32 v10, 16, v38
    v_lshlrev_b32 v11, 16, v74
    v_and_b32 v38, 0xffff0000, v38
    v_and_b32 v74, 0xffff0000, v74
    v_mul_f32 v10, v10, v24
    v_mul_f32 v38, v38, v25
    v_fmac_f32 v101, v10, v11
    v_fmac_f32 v101, v38, v74
    v_lshlrev_b32 v10, 16, v39
    v_lshlrev_b32 v11, 16, v75
    v_and_b32 v39, 0xffff0000, v39
    v_and_b32 v75, 0xffff0000, v75
    v_mul_f32 v10, v10, v26
    v_mul_f32 v39, v39, v27
    v_fmac_f32 v101, v10, v11
    v_fmac_f32 v101, v39, v75
    v_lshlrev_b32 v10, 16, v40
    v_lshlrev_b32 v11, 16, v76
    v_and_b32 v40, 0xffff0000, v40
    v_and_b32 v76, 0xffff0000, v76
    v_mul_f32 v10, v10, v16
    v_mul_f32 v40, v40, v17
    v_mul_f32 v102, v10, v11
    v_fmac_f32 v102, v40, v76
    v_lshlrev_b32 v10, 16, v41
    v_lshlrev_b32 v11, 16, v77
    v_and_b32 v41, 0xffff0000, v41
    v_and_b32 v77, 0xffff0000, v77
    v_mul_f32 v10, v10, v18
    v_mul_f32 v41, v41, v19
    v_fmac_f32 v102, v10, v11
    v_fmac_f32 v102, v41, v77
    v_lshlrev_b32 v10, 16, v42
    v_lshlrev_b32 v11, 16, v78
    v_and_b32 v42, 0xffff0000, v42
    v_and_b32 v78, 0xffff0000, v78
    v_mul_f32 v10, v10, v20
    v_mul_f32 v42, v42, v21
    v_fmac_f32 v102, v10, v11
    v_fmac_f32 v102, v42, v78
    v_lshlrev_b32 v10, 16, v43
    v_lshlrev_b32 v11, 16, v79
    v_and_b32 v43, 0xffff0000, v43
    v_and_b32 v79, 0xffff0000, v79
    v_mul_f32 v10, v10, v22
    v_mul_f32 v43, v43, v23
    v_fmac_f32 v102, v10, v11
    v_fmac_f32 v102, v43, v79
    v_lshlrev_b32 v10, 16, v44
    v_lshlrev_b32 v11, 16, v80
    v_and_b32 v44, 0xffff0000, v44
    v_and_b32 v80, 0xffff0000, v80
    v_mul_f32 v10, v10, v24
    v_mul_f32 v44, v44, v25
    v_fmac_f32 v102, v10, v11
    v_fmac_f32 v102, v44, v80
    v_lshlrev_b32 v10, 16, v45
    v_lshlrev_b32 v11, 16, v81
    v_and_b32 v45, 0xffff0000, v45
    v_and_b32 v81, 0xffff0000, v81
    v_mul_f32 v10, v10, v26
    v_mul_f32 v45, v45, v27
    v_fmac_f32 v102, v10, v11
    v_fmac_f32 v102, v45, v81
    v_lshlrev_b32 v10, 16, v46
    v_lshlrev_b32 v11, 16, v82
    v_and_b32 v46, 0xffff0000, v46
    v_and_b32 v82, 0xffff0000, v82
    v_mul_f32 v10, v10, v16
    v_mul_f32 v46, v46, v17
    v_mul_f32 v103, v10, v11
    v_fmac_f32 v103, v46, v82
    v_lshlrev_b32 v10, 16, v47
    v_lshlrev_b32 v11, 16, v83
    v_and_b32 v47, 0xffff0000, v47
    v_and_b32 v83, 0xffff0000, v83
    v_mul_f32 v10, v10, v18
    v_mul_f32 v47, v47, v19
    v_fmac_f32 v103, v10, v11
    v_fmac_f32 v103, v47, v83
    v_lshlrev_b32 v10, 16, v48
    v_lshlrev_b32 v11, 16, v84
    v_and_b32 v48, 0xffff0000, v48
    v_and_b32 v84, 0xffff0000, v84
    v_mul_f32 v10, v10, v20
    v_mul_f32 v48, v48, v21
    v_fmac_f32 v103, v10, v11
    v_fmac_f32 v103, v48, v84
    v_lshlrev_b32 v10, 16, v49
    v_lshlrev_b32 v11, 16, v85
    v_and_b32 v49, 0xffff0000, v49
    v_and_b32 v85, 0xffff0000, v85
    v_mul_f32 v10, v10, v22
    v_mul_f32 v49, v49, v23
    v_fmac_f32 v103, v10, v11
    v_fmac_f32 v103, v49, v85
    v_lshlrev_b32 v10, 16, v50
    v_lshlrev_b32 v11, 16, v86
    v_and_b32 v50, 0xffff0000, v50
    v_and_b32 v86, 0xffff0000, v86
    v_mul_f32 v10, v10, v24
    v_mul_f32 v50, v50, v25
    v_fmac_f32 v103, v10, v11
    v_fmac_f32 v103, v50, v86
    v_lshlrev_b32 v10, 16, v51
    v_lshlrev_b32 v11, 16, v87
    v_and_b32 v51, 0xffff0000, v51
    v_and_b32 v87, 0xffff0000, v87
    v_mul_f32 v10, v10, v26
    v_mul_f32 v51, v51, v27
    v_fmac_f32 v103, v10, v11
    v_fmac_f32 v103, v51, v87
    v_lshlrev_b32 v10, 16, v52
    v_lshlrev_b32 v11, 16, v88
    v_and_b32 v52, 0xffff0000, v52
    v_and_b32 v88, 0xffff0000, v88
    v_mul_f32 v10, v10, v16
    v_mul_f32 v52, v52, v17
    v_mul_f32 v104, v10, v11
    v_fmac_f32 v104, v52, v88
    v_lshlrev_b32 v10, 16, v53
    v_lshlrev_b32 v11, 16, v89
    v_and_b32 v53, 0xffff0000, v53
    v_and_b32 v89, 0xffff0000, v89
    v_mul_f32 v10, v10, v18
    v_mul_f32 v53, v53, v19
    v_fmac_f32 v104, v10, v11
    v_fmac_f32 v104, v53, v89
    v_lshlrev_b32 v10, 16, v54
    v_lshlrev_b32 v11, 16, v90
    v_and_b32 v54, 0xffff0000, v54
    v_and_b32 v90, 0xffff0000, v90
    v_mul_f32 v10, v10, v20
    v_mul_f32 v54, v54, v21
    v_fmac_f32 v104, v10, v11
    v_fmac_f32 v104, v54, v90
    v_lshlrev_b32 v10, 16, v55
    v_lshlrev_b32 v11, 16, v91
    v_and_b32 v55, 0xffff0000, v55
    v_and_b32 v91, 0xffff0000, v91
    v_mul_f32 v10, v10, v22
    v_mul_f32 v55, v55, v23
    v_fmac_f32 v104, v10, v11
    v_fmac_f32 v104, v55, v91
    v_lshlrev_b32 v10, 16, v56
    v_lshlrev_b32 v11, 16, v92
    v_and_b32 v56, 0xffff0000, v56
    v_and_b32 v92, 0xffff0000, v92
    v_mul_f32 v10, v10, v24
    v_mul_f32 v56, v56, v25
    v_fmac_f32 v104, v10, v11
    v_fmac_f32 v104, v56, v92
    v_lshlrev_b32 v10, 16, v57
    v_lshlrev_b32 v11, 16, v93
    v_and_b32 v57, 0xffff0000, v57
    v_and_b32 v93, 0xffff0000, v93
    v_mul_f32 v10, v10, v26
    v_mul_f32 v57, v57, v27
    v_fmac_f32 v104, v10, v11
    v_fmac_f32 v104, v57, v93
    v_lshlrev_b32 v10, 16, v58
    v_lshlrev_b32 v11, 16, v94
    v_and_b32 v58, 0xffff0000, v58
    v_and_b32 v94, 0xffff0000, v94
    v_mul_f32 v10, v10, v16
    v_mul_f32 v58, v58, v17
    v_mul_f32 v105, v10, v11
    v_fmac_f32 v105, v58, v94
    v_lshlrev_b32 v10, 16, v59
    v_lshlrev_b32 v11, 16, v95
    v_and_b32 v59, 0xffff0000, v59
    v_and_b32 v95, 0xffff0000, v95
    v_mul_f32 v10, v10, v18
    v_mul_f32 v59, v59, v19
    v_fmac_f32 v105, v10, v11
    v_fmac_f32 v105, v59, v95
    v_lshlrev_b32 v10, 16, v60
    v_lshlrev_b32 v11, 16, v96
    v_and_b32 v60, 0xffff0000, v60
    v_and_b32 v96, 0xffff0000, v96
    v_mul_f32 v10, v10, v20
    v_mul_f32 v60, v60, v21
    v_fmac_f32 v105, v10, v11
    v_fmac_f32 v105, v60, v96
    v_lshlrev_b32 v10, 16, v61
    v_lshlrev_b32 v11, 16, v97
    v_and_b32 v61, 0xffff0000, v61
    v_and_b32 v97, 0xffff0000, v97
    v_mul_f32 v10, v10, v22
    v_mul_f32 v61, v61, v23
    v_fmac_f32 v105, v10, v11
    v_fmac_f32 v105, v61, v97
    v_lshlrev_b32 v10, 16, v62
    v_lshlrev_b32 v11, 16, v98
    v_and_b32 v62, 0xffff0000, v62
    v_and_b32 v98, 0xffff0000, v98
    v_mul_f32 v10, v10, v24
    v_mul_f32 v62, v62, v25
    v_fmac_f32 v105, v10, v11
    v_fmac_f32 v105, v62, v98
    v_lshlrev_b32 v10, 16, v63
    v_lshlrev_b32 v11, 16, v99
    v_and_b32 v63, 0xffff0000, v63
    v_and_b32 v99, 0xffff0000, v99
    v_mul_f32 v10, v10, v26
    v_mul_f32 v63, v63, v27
    v_fmac_f32 v105, v10, v11
    v_fmac_f32 v105, v63, v99
    v_add_f32_dpp v100, v100, v100 row_ror:8 row_mask:0xf bank_mask:0xf
    v_add_f32_dpp v101, v101, v101 row_ror:8 row_mask:0xf bank_mask:0xf
    v_add_f32_dpp v102, v102, v102 row_ror:8 row_mask:0xf bank_mask:0xf
    v_add_f32_dpp v103, v103, v103 row_ror:8 row_mask:0xf bank_mask:0xf
    v_add_f32_dpp v104, v104, v104 row_ror:8 row_mask:0xf bank_mask:0xf
    v_add_f32_dpp v105, v105, v105 row_ror:8 row_mask:0xf bank_mask:0xf
    v_add_f32_dpp v100, v100, v100 row_ror:4 row_mask:0xf bank_mask:0xf
    v_add_f32_dpp v101, v101, v101 row_ror:4 row_mask:0xf bank_mask:0xf
    v_add_f32_dpp v102, v102, v102 row_ror:4 row_mask:0xf bank_mask:0xf
    v_add_f32_dpp v103, v103, v103 row_ror:4 row_mask:0xf bank_mask:0xf
    v_add_f32_dpp v104, v104, v104 row_ror:4 row_mask:0xf bank_mask:0xf
    v_add_f32_dpp v105, v105, v105 row_ror:4 row_mask:0xf bank_mask:0xf
    v_add_f32_dpp v100, v100, v100 row_ror:2 row_mask:0xf bank_mask:0xf
    v_add_f32_dpp v101, v101, v101 row_ror:2 row_mask:0xf bank_mask:0xf
    v_add_f32_dpp v102, v102, v102 row_ror:2 row_mask:0xf bank_mask:0xf
    v_add_f32_dpp v103, v103, v103 row_ror:2 row_mask:0xf bank_mask:0xf
    v_add_f32_dpp v104, v104, v104 row_ror:2 row_mask:0xf bank_mask:0xf
    v_add_f32_dpp v105, v105, v105 row_ror:2 row_mask:0xf bank_mask:0xf
    v_add_f32_dpp v100, v100, v100 row_ror:1 row_mask:0xf bank_mask:0xf
    v_add_f32_dpp v101, v101, v101 row_ror:1 row_mask:0xf bank_mask:0xf
    v_add_f32_dpp v102, v102, v102 row_ror:1 row_mask:0xf bank_mask:0xf
    v_add_f32_dpp v103, v103, v103 row_ror:1 row_mask:0xf bank_mask:0xf
    v_add_f32_dpp v104, v104, v104 row_ror:1 row_mask:0xf bank_mask:0xf
    v_add_f32_dpp v105, v105, v105 row_ror:1 row_mask:0xf bank_mask:0xf
    v_cmp_eq_u32 vcc, 1, v5
    s_nop 1
    v_cndmask_b32 v100, v100, v101, vcc
    v_cmp_eq_u32 vcc, 2, v5
    s_nop 1
    v_cndmask_b32 v100, v100, v102, vcc
    v_cmp_eq_u32 vcc, 3, v5
    s_nop 1
    v_cndmask_b32 v100, v100, v103, vcc
    v_cmp_eq_u32 vcc, 4, v5
    s_nop 1
    v_cndmask_b32 v100, v100, v104, vcc
    v_cmp_eq_u32 vcc, 5, v5
    s_nop 1
    v_cndmask_b32 v100, v100, v105, vcc
    s_mul_i32 s48, s62, 768
    s_lshl_b32 s49, s49, 2
    s_add_u32 s48, s48, s49
    s_add_u32 s48, s48, 1179648
    s_mov_b32 exec_lo, 0x003f003f
    s_mov_b32 exec_hi, 0x003f003f
    buffer_store_dword v100, v13, s[12:15], s48 offen sc1
    s_mov_b64 exec, -1
    s_mov_b32 s60, 0x100000
L_wd0:
    s_nop 1
    ds_read_b32 v10, v2 offset:20
    s_sub_u32 s60, s60, 1
    s_cbranch_scc1 L_exit1
    s_waitcnt lgkmcnt(0)
    v_readfirstlane_b32 s48, v10
    s_cmp_eq_u32 s48, 0
    s_cbranch_scc1 L_wd0
    ds_read_b128 v[16:19], v2 offset:0
    ds_read_b64 v[20:21], v2 offset:16
    s_waitcnt lgkmcnt(0)
    v_readfirstlane_b32 s84, v16
    v_readfirstlane_b32 s85, v17
    v_readfirstlane_b32 s86, v18
    v_readfirstlane_b32 s87, v19
    v_readfirstlane_b32 s88, v20
    v_readfirstlane_b32 s89, v21
    s_mov_b32 s60, 0x100000
L_wf0:
    s_nop 1
    ds_read_b32 v10, v2 offset:40
    s_sub_u32 s60, s60, 1
    s_cbranch_scc1 L_exit1
    s_waitcnt lgkmcnt(0)
    v_readfirstlane_b32 s48, v10
    s_cmp_lt_u32 s48, 4
    s_cbranch_scc1 L_wf0
    s_cmp_eq_u32 s84, s87
    ds_read_b128 v[16:19], v4 offset:256
    ds_read_b128 v[20:23], v4 offset:1280
    ds_read_b128 v[24:27], v4 offset:2304
    ds_read_b128 v[28:31], v4 offset:3328
    ds_read_b128 v[32:35], v4 offset:4352
    ds_read_b128 v[36:39], v4 offset:5376
    s_add_u32 s54, s33, 0
    s_add_u32 s55, s33, 4096
    s_cmp_eq_u32 s84, s87
    s_waitcnt lgkmcnt(0)
    s_cselect_b32 exec_lo, 0xffff, -1
    s_cselect_b32 exec_hi, 0xffff0000, -1
    buffer_store_dwordx4 v[16:19], v4, s[12:15], s54 offen offset:0 sc1
    s_cselect_b32 exec_lo, 0x0, -1
    s_cselect_b32 exec_hi, 0xffff, -1
    buffer_store_dwordx4 v[20:23], v4, s[12:15], s54 offen offset:1024 sc1
    s_cselect_b32 exec_lo, 0xffff0000, -1
    s_cselect_b32 exec_hi, 0x0, -1
    buffer_store_dwordx4 v[24:27], v4, s[12:15], s54 offen offset:2048 sc1
    s_cselect_b32 exec_lo, 0xffff, -1
    s_cselect_b32 exec_hi, 0xffff0000, -1
    buffer_store_dwordx4 v[28:31], v4, s[12:15], s54 offen offset:3072 sc1
    s_cselect_b32 exec_lo, 0x0, -1
    s_cselect_b32 exec_hi, 0xffff, -1
    buffer_store_dwordx4 v[32:35], v4, s[12:15], s55 offen offset:0 sc1
    s_cselect_b32 exec_lo, 0xffff0000, -1
    s_cselect_b32 exec_hi, 0x0, -1
    buffer_store_dwordx4 v[36:39], v4, s[12:15], s55 offen offset:1024 sc1
    s_mov_b64 exec, -1
L_fl0:
    s_nop 1
    v_mov_b32 v10, 1
    s_waitcnt vmcnt(0)
    s_mov_b64 exec, 1
    buffer_store_dword v10, off, s[12:15], s32 sc1
    ds_write_b32 v2, v10 offset:52
    s_mov_b64 exec, -1
    s_mov_b32 s60, 0x100000
L_wb2:
    s_nop 1
    ds_read_b32 v10, v2 offset:60
    s_sub_u32 s60, s60, 1
    s_cbranch_scc1 L_exit1
    s_waitcnt lgkmcnt(0)
    v_readfirstlane_b32 s48, v10
    s_cmp_lt_u32 s48, 9
    s_cbranch_scc1 L_wb2
    s_mov_b32 s61, 2
    s_lshl_b32 s62, s61, 5
    s_add_u32 s62, s62, s3
    s_lshl_b32 s63, s62, 15
    s_add_u32 s63, s63, 1
    s_mul_hi_u32 s63, s63, 0xaaaaaaab
    s_lshr_b32 s63, s63, 7
    s_mul_i32 s48, s62, 171
    s_lshr_b32 s48, s48, 9
    s_mul_i32 s48, s48, 384
    s_mul_i32 s49, s4, 24
    s_add_u32 s50, s49, s63
    s_mul_i32 s50, s50, 384
    v_add_u32 v10, s50, v7
    v_add_u32 v11, 3072, v10
    v_add_u32 v12, 6144, v10
    buffer_load_dwordx2 v[100:101], v6, s[8:11], s48 offen offset:0
    buffer_load_dwordx2 v[102:103], v6, s[8:11], s48 offen offset:128
    buffer_load_dwordx2 v[104:105], v6, s[8:11], s48 offen offset:256
    buffer_load_dwordx2 v[28:29], v10, s[92:95], 0 offen offset:0
    buffer_load_dwordx2 v[30:31], v10, s[92:95], 0 offen offset:128
    buffer_load_dwordx2 v[32:33], v10, s[92:95], 0 offen offset:256
    buffer_load_dwordx2 v[64:65], v10, s[96:99], 0 offen offset:0
    buffer_load_dwordx2 v[66:67], v10, s[96:99], 0 offen offset:128
    buffer_load_dwordx2 v[68:69], v10, s[96:99], 0 offen offset:256
    buffer_load_dwordx2 v[34:35], v10, s[92:95], 0 offen offset:1536
    buffer_load_dwordx2 v[36:37], v10, s[92:95], 0 offen offset:1664
    buffer_load_dwordx2 v[38:39], v10, s[92:95], 0 offen offset:1792
    buffer_load_dwordx2 v[70:71], v10, s[96:99], 0 offen offset:1536
    buffer_load_dwordx2 v[72:73], v10, s[96:99], 0 offen offset:1664
    buffer_load_dwordx2 v[74:75], v10, s[96:99], 0 offen offset:1792
    buffer_load_dwordx2 v[40:41], v11, s[92:95], 0 offen offset:0
    buffer_load_dwordx2 v[42:43], v11, s[92:95], 0 offen offset:128
    buffer_load_dwordx2 v[44:45], v11, s[92:95], 0 offen offset:256
    buffer_load_dwordx2 v[76:77], v11, s[96:99], 0 offen offset:0
    buffer_load_dwordx2 v[78:79], v11, s[96:99], 0 offen offset:128
    buffer_load_dwordx2 v[80:81], v11, s[96:99], 0 offen offset:256
    buffer_load_dwordx2 v[46:47], v11, s[92:95], 0 offen offset:1536
    buffer_load_dwordx2 v[48:49], v11, s[92:95], 0 offen offset:1664
    buffer_load_dwordx2 v[50:51], v11, s[92:95], 0 offen offset:1792
    buffer_load_dwordx2 v[82:83], v11, s[96:99], 0 offen offset:1536
    buffer_load_dwordx2 v[84:85], v11, s[96:99], 0 offen offset:1664
    buffer_load_dwordx2 v[86:87], v11, s[96:99], 0 offen offset:1792
    buffer_load_dwordx2 v[52:53], v12, s[92:95], 0 offen offset:0
    buffer_load_dwordx2 v[54:55], v12, s[92:95], 0 offen offset:128
    buffer_load_dwordx2 v[56:57], v12, s[92:95], 0 offen offset:256
    buffer_load_dwordx2 v[88:89], v12, s[96:99], 0 offen offset:0
    buffer_load_dwordx2 v[90:91], v12, s[96:99], 0 offen offset:128
    buffer_load_dwordx2 v[92:93], v12, s[96:99], 0 offen offset:256
    buffer_load_dwordx2 v[58:59], v12, s[92:95], 0 offen offset:1536
    buffer_load_dwordx2 v[60:61], v12, s[92:95], 0 offen offset:1664
    buffer_load_dwordx2 v[62:63], v12, s[92:95], 0 offen offset:1792
    buffer_load_dwordx2 v[94:95], v12, s[96:99], 0 offen offset:1536
    buffer_load_dwordx2 v[96:97], v12, s[96:99], 0 offen offset:1664
    buffer_load_dwordx2 v[98:99], v12, s[96:99], 0 offen offset:1792
    s_waitcnt vmcnt(0)
    v_lshlrev_b32 v16, 16, v100
    v_and_b32 v17, 0xffff0000, v100
    v_lshlrev_b32 v18, 16, v101
    v_and_b32 v19, 0xffff0000, v101
    v_lshlrev_b32 v20, 16, v102
    v_and_b32 v21, 0xffff0000, v102
    v_lshlrev_b32 v22, 16, v103
    v_and_b32 v23, 0xffff0000, v103
    v_lshlrev_b32 v24, 16, v104
    v_and_b32 v25, 0xffff0000, v104
    v_lshlrev_b32 v26, 16, v105
    v_and_b32 v27, 0xffff0000, v105
    v_lshlrev_b32 v10, 16, v28
    v_lshlrev_b32 v11, 16, v64
    v_and_b32 v28, 0xffff0000, v28
    v_and_b32 v64, 0xffff0000, v64
    v_mul_f32 v10, v10, v16
    v_mul_f32 v28, v28, v17
    v_mul_f32 v100, v10, v11
    v_fmac_f32 v100, v28, v64
    v_lshlrev_b32 v10, 16, v29
    v_lshlrev_b32 v11, 16, v65
    v_and_b32 v29, 0xffff0000, v29
    v_and_b32 v65, 0xffff0000, v65
    v_mul_f32 v10, v10, v18
    v_mul_f32 v29, v29, v19
    v_fmac_f32 v100, v10, v11
    v_fmac_f32 v100, v29, v65
    v_lshlrev_b32 v10, 16, v30
    v_lshlrev_b32 v11, 16, v66
    v_and_b32 v30, 0xffff0000, v30
    v_and_b32 v66, 0xffff0000, v66
    v_mul_f32 v10, v10, v20
    v_mul_f32 v30, v30, v21
    v_fmac_f32 v100, v10, v11
    v_fmac_f32 v100, v30, v66
    v_lshlrev_b32 v10, 16, v31
    v_lshlrev_b32 v11, 16, v67
    v_and_b32 v31, 0xffff0000, v31
    v_and_b32 v67, 0xffff0000, v67
    v_mul_f32 v10, v10, v22
    v_mul_f32 v31, v31, v23
    v_fmac_f32 v100, v10, v11
    v_fmac_f32 v100, v31, v67
    v_lshlrev_b32 v10, 16, v32
    v_lshlrev_b32 v11, 16, v68
    v_and_b32 v32, 0xffff0000, v32
    v_and_b32 v68, 0xffff0000, v68
    v_mul_f32 v10, v10, v24
    v_mul_f32 v32, v32, v25
    v_fmac_f32 v100, v10, v11
    v_fmac_f32 v100, v32, v68
    v_lshlrev_b32 v10, 16, v33
    v_lshlrev_b32 v11, 16, v69
    v_and_b32 v33, 0xffff0000, v33
    v_and_b32 v69, 0xffff0000, v69
    v_mul_f32 v10, v10, v26
    v_mul_f32 v33, v33, v27
    v_fmac_f32 v100, v10, v11
    v_fmac_f32 v100, v33, v69
    v_lshlrev_b32 v10, 16, v34
    v_lshlrev_b32 v11, 16, v70
    v_and_b32 v34, 0xffff0000, v34
    v_and_b32 v70, 0xffff0000, v70
    v_mul_f32 v10, v10, v16
    v_mul_f32 v34, v34, v17
    v_mul_f32 v101, v10, v11
    v_fmac_f32 v101, v34, v70
    v_lshlrev_b32 v10, 16, v35
    v_lshlrev_b32 v11, 16, v71
    v_and_b32 v35, 0xffff0000, v35
    v_and_b32 v71, 0xffff0000, v71
    v_mul_f32 v10, v10, v18
    v_mul_f32 v35, v35, v19
    v_fmac_f32 v101, v10, v11
    v_fmac_f32 v101, v35, v71
    v_lshlrev_b32 v10, 16, v36
    v_lshlrev_b32 v11, 16, v72
    v_and_b32 v36, 0xffff0000, v36
    v_and_b32 v72, 0xffff0000, v72
    v_mul_f32 v10, v10, v20
    v_mul_f32 v36, v36, v21
    v_fmac_f32 v101, v10, v11
    v_fmac_f32 v101, v36, v72
    v_lshlrev_b32 v10, 16, v37
    v_lshlrev_b32 v11, 16, v73
    v_and_b32 v37, 0xffff0000, v37
    v_and_b32 v73, 0xffff0000, v73
    v_mul_f32 v10, v10, v22
    v_mul_f32 v37, v37, v23
    v_fmac_f32 v101, v10, v11
    v_fmac_f32 v101, v37, v73
    v_lshlrev_b32 v10, 16, v38
    v_lshlrev_b32 v11, 16, v74
    v_and_b32 v38, 0xffff0000, v38
    v_and_b32 v74, 0xffff0000, v74
    v_mul_f32 v10, v10, v24
    v_mul_f32 v38, v38, v25
    v_fmac_f32 v101, v10, v11
    v_fmac_f32 v101, v38, v74
    v_lshlrev_b32 v10, 16, v39
    v_lshlrev_b32 v11, 16, v75
    v_and_b32 v39, 0xffff0000, v39
    v_and_b32 v75, 0xffff0000, v75
    v_mul_f32 v10, v10, v26
    v_mul_f32 v39, v39, v27
    v_fmac_f32 v101, v10, v11
    v_fmac_f32 v101, v39, v75
    v_lshlrev_b32 v10, 16, v40
    v_lshlrev_b32 v11, 16, v76
    v_and_b32 v40, 0xffff0000, v40
    v_and_b32 v76, 0xffff0000, v76
    v_mul_f32 v10, v10, v16
    v_mul_f32 v40, v40, v17
    v_mul_f32 v102, v10, v11
    v_fmac_f32 v102, v40, v76
    v_lshlrev_b32 v10, 16, v41
    v_lshlrev_b32 v11, 16, v77
    v_and_b32 v41, 0xffff0000, v41
    v_and_b32 v77, 0xffff0000, v77
    v_mul_f32 v10, v10, v18
    v_mul_f32 v41, v41, v19
    v_fmac_f32 v102, v10, v11
    v_fmac_f32 v102, v41, v77
    v_lshlrev_b32 v10, 16, v42
    v_lshlrev_b32 v11, 16, v78
    v_and_b32 v42, 0xffff0000, v42
    v_and_b32 v78, 0xffff0000, v78
    v_mul_f32 v10, v10, v20
    v_mul_f32 v42, v42, v21
    v_fmac_f32 v102, v10, v11
    v_fmac_f32 v102, v42, v78
    v_lshlrev_b32 v10, 16, v43
    v_lshlrev_b32 v11, 16, v79
    v_and_b32 v43, 0xffff0000, v43
    v_and_b32 v79, 0xffff0000, v79
    v_mul_f32 v10, v10, v22
    v_mul_f32 v43, v43, v23
    v_fmac_f32 v102, v10, v11
    v_fmac_f32 v102, v43, v79
    v_lshlrev_b32 v10, 16, v44
    v_lshlrev_b32 v11, 16, v80
    v_and_b32 v44, 0xffff0000, v44
    v_and_b32 v80, 0xffff0000, v80
    v_mul_f32 v10, v10, v24
    v_mul_f32 v44, v44, v25
    v_fmac_f32 v102, v10, v11
    v_fmac_f32 v102, v44, v80
    v_lshlrev_b32 v10, 16, v45
    v_lshlrev_b32 v11, 16, v81
    v_and_b32 v45, 0xffff0000, v45
    v_and_b32 v81, 0xffff0000, v81
    v_mul_f32 v10, v10, v26
    v_mul_f32 v45, v45, v27
    v_fmac_f32 v102, v10, v11
    v_fmac_f32 v102, v45, v81
    v_lshlrev_b32 v10, 16, v46
    v_lshlrev_b32 v11, 16, v82
    v_and_b32 v46, 0xffff0000, v46
    v_and_b32 v82, 0xffff0000, v82
    v_mul_f32 v10, v10, v16
    v_mul_f32 v46, v46, v17
    v_mul_f32 v103, v10, v11
    v_fmac_f32 v103, v46, v82
    v_lshlrev_b32 v10, 16, v47
    v_lshlrev_b32 v11, 16, v83
    v_and_b32 v47, 0xffff0000, v47
    v_and_b32 v83, 0xffff0000, v83
    v_mul_f32 v10, v10, v18
    v_mul_f32 v47, v47, v19
    v_fmac_f32 v103, v10, v11
    v_fmac_f32 v103, v47, v83
    v_lshlrev_b32 v10, 16, v48
    v_lshlrev_b32 v11, 16, v84
    v_and_b32 v48, 0xffff0000, v48
    v_and_b32 v84, 0xffff0000, v84
    v_mul_f32 v10, v10, v20
    v_mul_f32 v48, v48, v21
    v_fmac_f32 v103, v10, v11
    v_fmac_f32 v103, v48, v84
    v_lshlrev_b32 v10, 16, v49
    v_lshlrev_b32 v11, 16, v85
    v_and_b32 v49, 0xffff0000, v49
    v_and_b32 v85, 0xffff0000, v85
    v_mul_f32 v10, v10, v22
    v_mul_f32 v49, v49, v23
    v_fmac_f32 v103, v10, v11
    v_fmac_f32 v103, v49, v85
    v_lshlrev_b32 v10, 16, v50
    v_lshlrev_b32 v11, 16, v86
    v_and_b32 v50, 0xffff0000, v50
    v_and_b32 v86, 0xffff0000, v86
    v_mul_f32 v10, v10, v24
    v_mul_f32 v50, v50, v25
    v_fmac_f32 v103, v10, v11
    v_fmac_f32 v103, v50, v86
    v_lshlrev_b32 v10, 16, v51
    v_lshlrev_b32 v11, 16, v87
    v_and_b32 v51, 0xffff0000, v51
    v_and_b32 v87, 0xffff0000, v87
    v_mul_f32 v10, v10, v26
    v_mul_f32 v51, v51, v27
    v_fmac_f32 v103, v10, v11
    v_fmac_f32 v103, v51, v87
    v_lshlrev_b32 v10, 16, v52
    v_lshlrev_b32 v11, 16, v88
    v_and_b32 v52, 0xffff0000, v52
    v_and_b32 v88, 0xffff0000, v88
    v_mul_f32 v10, v10, v16
    v_mul_f32 v52, v52, v17
    v_mul_f32 v104, v10, v11
    v_fmac_f32 v104, v52, v88
    v_lshlrev_b32 v10, 16, v53
    v_lshlrev_b32 v11, 16, v89
    v_and_b32 v53, 0xffff0000, v53
    v_and_b32 v89, 0xffff0000, v89
    v_mul_f32 v10, v10, v18
    v_mul_f32 v53, v53, v19
    v_fmac_f32 v104, v10, v11
    v_fmac_f32 v104, v53, v89
    v_lshlrev_b32 v10, 16, v54
    v_lshlrev_b32 v11, 16, v90
    v_and_b32 v54, 0xffff0000, v54
    v_and_b32 v90, 0xffff0000, v90
    v_mul_f32 v10, v10, v20
    v_mul_f32 v54, v54, v21
    v_fmac_f32 v104, v10, v11
    v_fmac_f32 v104, v54, v90
    v_lshlrev_b32 v10, 16, v55
    v_lshlrev_b32 v11, 16, v91
    v_and_b32 v55, 0xffff0000, v55
    v_and_b32 v91, 0xffff0000, v91
    v_mul_f32 v10, v10, v22
    v_mul_f32 v55, v55, v23
    v_fmac_f32 v104, v10, v11
    v_fmac_f32 v104, v55, v91
    v_lshlrev_b32 v10, 16, v56
    v_lshlrev_b32 v11, 16, v92
    v_and_b32 v56, 0xffff0000, v56
    v_and_b32 v92, 0xffff0000, v92
    v_mul_f32 v10, v10, v24
    v_mul_f32 v56, v56, v25
    v_fmac_f32 v104, v10, v11
    v_fmac_f32 v104, v56, v92
    v_lshlrev_b32 v10, 16, v57
    v_lshlrev_b32 v11, 16, v93
    v_and_b32 v57, 0xffff0000, v57
    v_and_b32 v93, 0xffff0000, v93
    v_mul_f32 v10, v10, v26
    v_mul_f32 v57, v57, v27
    v_fmac_f32 v104, v10, v11
    v_fmac_f32 v104, v57, v93
    v_lshlrev_b32 v10, 16, v58
    v_lshlrev_b32 v11, 16, v94
    v_and_b32 v58, 0xffff0000, v58
    v_and_b32 v94, 0xffff0000, v94
    v_mul_f32 v10, v10, v16
    v_mul_f32 v58, v58, v17
    v_mul_f32 v105, v10, v11
    v_fmac_f32 v105, v58, v94
    v_lshlrev_b32 v10, 16, v59
    v_lshlrev_b32 v11, 16, v95
    v_and_b32 v59, 0xffff0000, v59
    v_and_b32 v95, 0xffff0000, v95
    v_mul_f32 v10, v10, v18
    v_mul_f32 v59, v59, v19
    v_fmac_f32 v105, v10, v11
    v_fmac_f32 v105, v59, v95
    v_lshlrev_b32 v10, 16, v60
    v_lshlrev_b32 v11, 16, v96
    v_and_b32 v60, 0xffff0000, v60
    v_and_b32 v96, 0xffff0000, v96
    v_mul_f32 v10, v10, v20
    v_mul_f32 v60, v60, v21
    v_fmac_f32 v105, v10, v11
    v_fmac_f32 v105, v60, v96
    v_lshlrev_b32 v10, 16, v61
    v_lshlrev_b32 v11, 16, v97
    v_and_b32 v61, 0xffff0000, v61
    v_and_b32 v97, 0xffff0000, v97
    v_mul_f32 v10, v10, v22
    v_mul_f32 v61, v61, v23
    v_fmac_f32 v105, v10, v11
    v_fmac_f32 v105, v61, v97
    v_lshlrev_b32 v10, 16, v62
    v_lshlrev_b32 v11, 16, v98
    v_and_b32 v62, 0xffff0000, v62
    v_and_b32 v98, 0xffff0000, v98
    v_mul_f32 v10, v10, v24
    v_mul_f32 v62, v62, v25
    v_fmac_f32 v105, v10, v11
    v_fmac_f32 v105, v62, v98
    v_lshlrev_b32 v10, 16, v63
    v_lshlrev_b32 v11, 16, v99
    v_and_b32 v63, 0xffff0000, v63
    v_and_b32 v99, 0xffff0000, v99
    v_mul_f32 v10, v10, v26
    v_mul_f32 v63, v63, v27
    v_fmac_f32 v105, v10, v11
    v_fmac_f32 v105, v63, v99
    v_add_f32_dpp v100, v100, v100 row_ror:8 row_mask:0xf bank_mask:0xf
    v_add_f32_dpp v101, v101, v101 row_ror:8 row_mask:0xf bank_mask:0xf
    v_add_f32_dpp v102, v102, v102 row_ror:8 row_mask:0xf bank_mask:0xf
    v_add_f32_dpp v103, v103, v103 row_ror:8 row_mask:0xf bank_mask:0xf
    v_add_f32_dpp v104, v104, v104 row_ror:8 row_mask:0xf bank_mask:0xf
    v_add_f32_dpp v105, v105, v105 row_ror:8 row_mask:0xf bank_mask:0xf
    v_add_f32_dpp v100, v100, v100 row_ror:4 row_mask:0xf bank_mask:0xf
    v_add_f32_dpp v101, v101, v101 row_ror:4 row_mask:0xf bank_mask:0xf
    v_add_f32_dpp v102, v102, v102 row_ror:4 row_mask:0xf bank_mask:0xf
    v_add_f32_dpp v103, v103, v103 row_ror:4 row_mask:0xf bank_mask:0xf
    v_add_f32_dpp v104, v104, v104 row_ror:4 row_mask:0xf bank_mask:0xf
    v_add_f32_dpp v105, v105, v105 row_ror:4 row_mask:0xf bank_mask:0xf
    v_add_f32_dpp v100, v100, v100 row_ror:2 row_mask:0xf bank_mask:0xf
    v_add_f32_dpp v101, v101, v101 row_ror:2 row_mask:0xf bank_mask:0xf
    v_add_f32_dpp v102, v102, v102 row_ror:2 row_mask:0xf bank_mask:0xf
    v_add_f32_dpp v103, v103, v103 row_ror:2 row_mask:0xf bank_mask:0xf
    v_add_f32_dpp v104, v104, v104 row_ror:2 row_mask:0xf bank_mask:0xf
    v_add_f32_dpp v105, v105, v105 row_ror:2 row_mask:0xf bank_mask:0xf
    v_add_f32_dpp v100, v100, v100 row_ror:1 row_mask:0xf bank_mask:0xf
    v_add_f32_dpp v101, v101, v101 row_ror:1 row_mask:0xf bank_mask:0xf
    v_add_f32_dpp v102, v102, v102 row_ror:1 row_mask:0xf bank_mask:0xf
    v_add_f32_dpp v103, v103, v103 row_ror:1 row_mask:0xf bank_mask:0xf
    v_add_f32_dpp v104, v104, v104 row_ror:1 row_mask:0xf bank_mask:0xf
    v_add_f32_dpp v105, v105, v105 row_ror:1 row_mask:0xf bank_mask:0xf
    v_cmp_eq_u32 vcc, 1, v5
    s_nop 1
    v_cndmask_b32 v100, v100, v101, vcc
    v_cmp_eq_u32 vcc, 2, v5
    s_nop 1
    v_cndmask_b32 v100, v100, v102, vcc
    v_cmp_eq_u32 vcc, 3, v5
    s_nop 1
    v_cndmask_b32 v100, v100, v103, vcc
    v_cmp_eq_u32 vcc, 4, v5
    s_nop 1
    v_cndmask_b32 v100, v100, v104, vcc
    v_cmp_eq_u32 vcc, 5, v5
    s_nop 1
    v_cndmask_b32 v100, v100, v105, vcc
    s_mul_i32 s48, s62, 768
    s_lshl_b32 s49, s49, 2
    s_add_u32 s48, s48, s49
    s_add_u32 s48, s48, 1179648
    s_mov_b32 exec_lo, 0x003f003f
    s_mov_b32 exec_hi, 0x003f003f
    buffer_store_dword v100, v13, s[12:15], s48 offen sc1
    s_mov_b64 exec, -1
    s_mov_b32 s60, 0x100000
L_wf1:
    s_nop 1
    ds_read_b32 v10, v2 offset:44
    s_sub_u32 s60, s60, 1
    s_cbranch_scc1 L_exit1
    s_waitcnt lgkmcnt(0)
    v_readfirstlane_b32 s48, v10
    s_cmp_lt_u32 s48, 4
    s_cbranch_scc1 L_wf1
    s_cmp_eq_u32 s85, s88
    s_cbranch_scc1 L_fl1
    ds_read_b128 v[16:19], v4 offset:6400
    ds_read_b128 v[20:23], v4 offset:7424
    ds_read_b128 v[24:27], v4 offset:8448
    ds_read_b128 v[28:31], v4 offset:9472
    ds_read_b128 v[32:35], v4 offset:10496
    ds_read_b128 v[36:39], v4 offset:11520
    s_add_u32 s54, s33, 1572864
    s_add_u32 s55, s33, 1576960
    s_cmp_eq_u32 s85, s88
    s_waitcnt lgkmcnt(0)
    buffer_store_dwordx4 v[16:19], v4, s[12:15], s54 offen offset:0 sc1
    buffer_store_dwordx4 v[20:23], v4, s[12:15], s54 offen offset:1024 sc1
    buffer_store_dwordx4 v[24:27], v4, s[12:15], s54 offen offset:2048 sc1
    buffer_store_dwordx4 v[28:31], v4, s[12:15], s54 offen offset:3072 sc1
    buffer_store_dwordx4 v[32:35], v4, s[12:15], s55 offen offset:0 sc1
    buffer_store_dwordx4 v[36:39], v4, s[12:15], s55 offen offset:1024 sc1
L_fl1:
    s_nop 1
    v_mov_b32 v10, 2
    s_waitcnt vmcnt(0)
    s_mov_b64 exec, 1
    buffer_store_dword v10, off, s[12:15], s32 sc1
    ds_write_b32 v2, v10 offset:52
    s_mov_b64 exec, -1
    s_mov_b32 s60, 0x100000
L_wf2:
    s_nop 1
    ds_read_b32 v10, v2 offset:48
    s_sub_u32 s60, s60, 1
    s_cbranch_scc1 L_exit1
    s_waitcnt lgkmcnt(0)
    v_readfirstlane_b32 s48, v10
    s_cmp_lt_u32 s48, 4
    s_cbranch_scc1 L_wf2
    s_cmp_eq_u32 s86, s89
    s_cbranch_scc1 L_fl2
    ds_read_b128 v[16:19], v4 offset:12544
    ds_read_b128 v[20:23], v4 offset:13568
    ds_read_b128 v[24:27], v4 offset:14592
    ds_read_b128 v[28:31], v4 offset:15616
    ds_read_b128 v[32:35], v4 offset:16640
    ds_read_b128 v[36:39], v4 offset:17664
    s_add_u32 s54, s33, 3145728
    s_add_u32 s55, s33, 3149824
    s_cmp_eq_u32 s86, s89
    s_waitcnt lgkmcnt(0)
    buffer_store_dwordx4 v[16:19], v4, s[12:15], s54 offen offset:0 sc1
    buffer_store_dwordx4 v[20:23], v4, s[12:15], s54 offen offset:1024 sc1
    buffer_store_dwordx4 v[24:27], v4, s[12:15], s54 offen offset:2048 sc1
    buffer_store_dwordx4 v[28:31], v4, s[12:15], s54 offen offset:3072 sc1
    buffer_store_dwordx4 v[32:35], v4, s[12:15], s55 offen offset:0 sc1
    buffer_store_dwordx4 v[36:39], v4, s[12:15], s55 offen offset:1024 sc1
L_fl2:
    s_nop 1
    v_mov_b32 v10, 3
    s_waitcnt vmcnt(0)
    s_mov_b64 exec, 1
    s_cbranch_scc1 L_fn2
    buffer_store_dword v10, off, s[12:15], s32 sc1
L_fn2:
    s_nop 1
    ds_write_b32 v2, v10 offset:52
    s_mov_b64 exec, -1
    s_endpgm
L_h3:
    s_nop 1
    s_waitcnt lgkmcnt(0)
    s_mov_b32 s12, s82
    s_and_b32 s13, s83, 0xffff
    s_mov_b32 s14, 10485760
    s_mov_b32 s15, 0x00020000
    s_barrier
    v_lshlrev_b32 v7, 2, v1
    s_mul_i32 s20, s4, 4352
    s_add_u32 s20, s20, 10223616
    s_lshl_b32 s21, s3, 2
    s_add_u32 s21, s21, s20
    s_mov_b32 s46, 0x155
    v_lshrrev_b32 v13, 2, v1
    v_mul_u32_u24 v13, 4352, v13
    v_and_or_b32 v13, v7, 12, v13
    s_and_b32 s7, s4, 3
    s_mul_i32 s47, s7, 4352
    s_lshl_b32 s7, s7, 2
    v_mov_b32 v8, 208
    s_mov_b32 s45, 2
    v_mov_b32 v3, 144
    v_bfrev_b32 v6, -2
    s_mov_b32 exec_hi, 0
L_h3loop:
    s_nop 1
    s_mov_b32 s60, 0x100000
L_wp1:
    s_nop 1
    ds_read_b32 v10, v2 offset:128
    s_sub_u32 s60, s60, 1
    s_cbranch_scc1 L_exit1
    s_waitcnt lgkmcnt(0)
    v_readfirstlane_b32 s48, v10
    s_cmp_lt_u32 s48, s45
    s_cbranch_scc1 L_wp1
    s_memrealtime s[40:41]
    s_add_u32 s45, s45, 3
    s_mov_b32 exec_lo, 1
    s_waitcnt lgkmcnt(0)
    v_mov_b32 v5, s40
    buffer_store_dword v5, off, s[12:15], s21
    s_mov_b32 exec_lo, -1
    s_mov_b32 s60, 0x100000
L_wp2:
    s_nop 1
    ds_read_b32 v10, v2 offset:128
    s_sub_u32 s60, s60, 1
    s_cbranch_scc1 L_exit1
    s_waitcnt lgkmcnt(0)
    v_readfirstlane_b32 s48, v10
    s_cmp_lt_u32 s48, s45
    s_cbranch_scc1 L_wp2
    buffer_load_dword v5, v7, s[12:15], s20 offen sc0
    s_add_u32 s45, s45, 4
    s_sub_u32 s40, s40, 4096
    s_waitcnt vmcnt(0)
    v_subrev_u32 v5, s40, v5
    v_cmp_gt_u32 vcc, 8192, v5
    s_nop 1
    v_cndmask_b32 v5, v6, v5, vcc
    s_mov_b32 s48, 2048
    s_add_u32 s49, s48, 2048
    v_cmp_gt_u32 vcc, s49, v5
    s_bcnt1_i32_b64 s50, vcc
    s_cmp_lt_u32 s50, 16
    s_cselect_b32 s48, s49, s48
    s_add_u32 s49, s48, 1024
    v_cmp_gt_u32 vcc, s49, v5
    s_bcnt1_i32_b64 s50, vcc
    s_cmp_lt_u32 s50, 16
    s_cselect_b32 s48, s49, s48
    s_add_u32 s49, s48, 512
    v_cmp_gt_u32 vcc, s49, v5
    s_bcnt1_i32_b64 s50, vcc
    s_cmp_lt_u32 s50, 16
    s_cselect_b32 s48, s49, s48
    s_add_u32 s49, s48, 256
    v_cmp_gt_u32 vcc, s49, v5
    s_bcnt1_i32_b64 s50, vcc
    s_cmp_lt_u32 s50, 16
    s_cselect_b32 s48, s49, s48
    s_add_u32 s49, s48, 128
    v_cmp_gt_u32 vcc, s49, v5
    s_bcnt1_i32_b64 s50, vcc
    s_cmp_lt_u32 s50, 16
    s_cselect_b32 s48, s49, s48
    s_add_u32 s49, s48, 64
    v_cmp_gt_u32 vcc, s49, v5
    s_bcnt1_i32_b64 s50, vcc
    s_cmp_lt_u32 s50, 16
    s_cselect_b32 s48, s49, s48
    s_add_u32 s49, s48, 32
    v_cmp_gt_u32 vcc, s49, v5
    s_bcnt1_i32_b64 s50, vcc
    s_cmp_lt_u32 s50, 16
    s_cselect_b32 s48, s49, s48
    s_add_u32 s49, s48, 16
    v_cmp_gt_u32 vcc, s49, v5
    s_bcnt1_i32_b64 s50, vcc
    s_cmp_lt_u32 s50, 16
    s_cselect_b32 s48, s49, s48
    s_add_u32 s49, s48, 8
    v_cmp_gt_u32 vcc, s49, v5
    s_bcnt1_i32_b64 s50, vcc
    s_cmp_lt_u32 s50, 16
    s_cselect_b32 s48, s49, s48
    s_add_u32 s49, s48, s40
    s_or_b32 s49, s49, 1
    v_mov_b32 v5, s49
    ds_write_b32 v3, v5
    v_add_u32 v3, 4, v3
    s_bitcmp1_b32 s46, 0
    s_cbranch_scc0 L_h3ng
    s_cmp_lt_u32 s48, 6136
    s_cselect_b32 exec_lo, 1, 0
    s_cmp_lt_u32 s3, 4
    s_cselect_b32 exec_lo, exec_lo, 0
    buffer_store_dword v5, off, s[12:15], s21 offset:2048 sc1
    s_mov_b32 exec_lo, 0xffff
    s_add_u32 s51, s45, 0
    s_mov_b32 s60, 0x100000
L_wp3:
    s_nop 1
    ds_read_b32 v10, v2 offset:128
    s_sub_u32 s60, s60, 1
    s_cbranch_scc1 L_exit1
    s_waitcnt lgkmcnt(0)
    v_readfirstlane_b32 s48, v10
    s_cmp_lt_u32 s48, s51
    s_cbranch_scc1 L_wp3
    s_sub_u32 s51, s20, s47
    s_mov_b32 s60, 8
    s_mov_b32 s48, 0
L_h3gp:
    s_nop 1
    buffer_load_dword v4, v13, s[12:15], s51 offen offset:2048 sc1
    s_sub_u32 s60, s60, 1
    s_cbranch_scc1 L_h3gw
L_h3gq:
    s_waitcnt vmcnt(0)
    v_subrev_u32 v4, s40, v4
    v_cmp_gt_u32 vcc, 8192, v4
    s_nop 1
    v_cndmask_b32 v4, v6, v4, vcc
    s_nop 1
    v_min_u32_dpp v4, v4, v4 quad_perm:[1,0,3,2] row_mask:0xf bank_mask:0xf
    s_nop 1
    v_min_u32_dpp v4, v4, v4 quad_perm:[2,3,0,1] row_mask:0xf bank_mask:0xf
    v_cmp_eq_u32 vcc, v6, v4
    s_cbranch_vccnz L_h3gp
    v_readlane_b32 s52, v4, 0
    v_readlane_b32 s53, v4, 4
    v_readlane_b32 s54, v4, 8
    v_readlane_b32 s55, v4, 12
    v_readlane_b32 s49, v4, s7
    s_max_u32 s52, s52, s53
    s_max_u32 s54, s54, s55
    s_max_u32 s48, s52, s54
    s_sub_u32 s48, s48, s49
    s_sub_u32 s48, s48, 25
    s_max_i32 s48, s48, 0
    s_min_i32 s48, s48, 1000
L_h3gw:
    s_nop 1
    s_or_b32 s48, s48, 0x10000
    v_mov_b32 v5, s48
    ds_write_b32 v8, v5
    s_mov_b32 exec_lo, -1
    v_add_u32 v8, 4, v8
    s_waitcnt vmcnt(0)
L_h3ng:
    s_nop 1
    s_lshr_b32 s46, s46, 1
    s_add_u32 s45, s45, 5
    s_add_u32 s20, s20, 128
    s_add_u32 s21, s21, 128
    s_cmp_lt_u32 s45, 132
    s_cbranch_scc1 L_h3loop
    s_endpgm
L_h2:
    s_nop 1
    s_mov_b32 s92, s74
    s_and_b32 s93, s75, 0xffff
    s_mov_b32 s94, 2097152
    s_mov_b32 s95, 0x00020000
    s_mov_b32 s96, s76
    s_and_b32 s97, s77, 0xffff
    s_mov_b32 s98, 2097152
    s_mov_b32 s99, 0x00020000
    s_mov_b32 s60, 0x100000
L_wd2:
    s_nop 1
    ds_read_b32 v10, v2 offset:20
    s_sub_u32 s60, s60, 1
    s_cbranch_scc1 L_exit1
    s_waitcnt lgkmcnt(0)
    v_readfirstlane_b32 s48, v10
    s_cmp_eq_u32 s48, 0
    s_cbranch_scc1 L_wd2
    ds_read_b128 v[16:19], v2 offset:0
    ds_read_b64 v[20:21], v2 offset:16
    s_waitcnt lgkmcnt(0)
    v_readfirstlane_b32 s84, v16
    v_readfirstlane_b32 s85, v17
    v_readfirstlane_b32 s86, v18
    v_readfirstlane_b32 s87, v19
    v_readfirstlane_b32 s88, v20
    v_readfirstlane_b32 s89, v21
    v_and_b32 v3, 3, v1
    v_and_b32 v15, 7, v1
    v_lshrrev_b32 v12, 2, v1
    s_mov_b32 s37, 0x3dd53b95
    s_mov_b32 s38, 0xaaaaaaab
    s_mov_b32 s61, 0
    s_mul_i32 s35, s3, 49152
    s_add_u32 s35, s35, 2097152
    s_mov_b32 s40, 6144
    v_lshlrev_b32 v14, 5, v1
    v_lshrrev_b32 v8, 3, v1
    v_mul_u32_u24 v8, 24, v8
    v_mov_b32 v4, 768
    v_mad_u32_u24 v8, v15, v4, v8
    v_lshlrev_b32 v104, 4, v1
    s_mov_b32 s34, 12
L_prep:
    s_nop 1
    s_lshl_b32 s62, s61, 5
    s_add_u32 s62, s62, s3
    s_lshl_b32 s63, s62, 15
    s_add_u32 s63, s63, 1
    s_mul_hi_u32 s63, s63, 0xaaaaaaab
    s_lshr_b32 s63, s63, 7
    s_mov_b32 s32, s84
    s_mov_b32 s39, s87
    s_mov_b32 s84, s85
    s_mov_b32 s85, s86
    s_mov_b32 s87, s88
    s_mov_b32 s88, s89
    s_lshl_b32 s33, s61, 3
    s_add_u32 s33, s33, 1
    s_mov_b32 s60, 0x100000
L_wpf:
    s_nop 1
    ds_read_b32 v10, v2 offset:60
    s_sub_u32 s60, s60, 1
    s_cbranch_scc1 L_exit1
    s_waitcnt lgkmcnt(0)
    v_readfirstlane_b32 s48, v10
    s_cmp_lt_u32 s48, s33
    s_cbranch_scc1 L_wpf
    v_lshlrev_b32 v4, 4, v1
    s_mul_i32 s49, s4, 2736
    s_lshl_b32 s48, s62, 16
    s_mul_hi_u32 s48, s48, 0xaaaaaaab
    s_lshr_b32 s48, s48, 5
    s_lshl_b32 s48, s48, 4
    s_add_u32 s48, s48, s49
    buffer_load_dwordx4 v[80:83], v4, s[92:95], s48 offen offset:0
    buffer_load_dwordx4 v[84:87], v4, s[92:95], s48 offen offset:1024
    buffer_load_dwordx4 v[88:91], v4, s[92:95], s48 offen offset:2048
    buffer_load_dwordx4 v[92:95], v4, s[96:99], s48 offen offset:0
    buffer_load_dwordx4 v[96:99], v4, s[96:99], s48 offen offset:1024
    buffer_load_dwordx4 v[100:103], v4, s[96:99], s48 offen offset:2048
    s_and_b32 s48, s39, 7
    v_mov_b32 v9, s48
    s_bitcmp1_b32 s39, 3
    s_cselect_b64 vcc, -1, 0
    v_cndmask_b32 v9, v9, v15, vcc
    v_xor_b32 v13, s5, v9
    v_lshl_or_b32 v13, v3, 3, v13
    s_lshl_b32 s36, s62, 6
    s_mul_i32 s49, s62, 768
    s_lshl_b32 s50, s63, 2
    s_sub_u32 s49, s49, s50
    s_add_u32 s49, s49, 1179648
    s_add_u32 s33, s33, 4
    s_mov_b32 s60, 0x100000
L_wga:
    s_nop 1
    ds_read_b32 v10, v2 offset:60
    s_sub_u32 s60, s60, 1
    s_cbranch_scc1 L_exit1
    s_waitcnt lgkmcnt(0)
    v_readfirstlane_b32 s48, v10
    s_cmp_lt_u32 s48, s33
    s_cbranch_scc1 L_wga
    v_add_u32 v4, 0, v12
    v_bfe_u32 v5, v4, 3, 2
    v_and_or_b32 v5, v4, 4, v5
    v_xor_b32 v5, v13, v5
    v_add_u32 v4, s36, v4
    v_lshl_add_u32 v6, v4, 5, v5
    v_lshl_add_u32 v6, v6, 4, 1
    v_mul_hi_u32 v6, v6, s38
    v_lshrrev_b32 v6, 1, v6
    v_lshrrev_b32 v11, 1, v6
    v_lshlrev_b32 v11, 2, v11
    buffer_load_dwordx3 v[24:26], v11, s[92:95], 0 offen
    buffer_load_dword v27, v11, s[92:95], 0 offen offset:12
    buffer_load_dwordx3 v[28:30], v11, s[96:99], 0 offen
    buffer_load_dword v31, v11, s[96:99], 0 offen offset:12
    v_lshrrev_b32 v22, 6, v6
    v_lshl_add_u32 v22, v22, 2, s49
    v_and_b32 v7, 15, v6
    v_cmp_eq_u32 s[24:25], 5, v7
    v_and_b32 v23, 1, v6
    v_lshlrev_b32 v23, 4, v23
    s_waitcnt vmcnt(0)
    v_add_u32 v4, 16, v12
    v_bfe_u32 v5, v4, 3, 2
    v_and_or_b32 v5, v4, 4, v5
    v_xor_b32 v5, v13, v5
    v_add_u32 v4, s36, v4
    v_lshl_add_u32 v6, v4, 5, v5
    v_lshl_add_u32 v6, v6, 4, 1
    v_mul_hi_u32 v6, v6, s38
    v_lshrrev_b32 v6, 1, v6
    v_lshrrev_b32 v11, 1, v6
    v_lshlrev_b32 v11, 2, v11
    buffer_load_dwordx3 v[40:42], v11, s[92:95], 0 offen
    buffer_load_dword v43, v11, s[92:95], 0 offen offset:12
    buffer_load_dwordx3 v[44:46], v11, s[96:99], 0 offen
    buffer_load_dword v47, v11, s[96:99], 0 offen offset:12
    v_lshrrev_b32 v38, 6, v6
    v_lshl_add_u32 v38, v38, 2, s49
    v_and_b32 v7, 15, v6
    v_cmp_eq_u32 s[26:27], 5, v7
    v_and_b32 v39, 1, v6
    v_lshlrev_b32 v39, 4, v39
    s_waitcnt vmcnt(0)
    v_add_u32 v4, 32, v12
    v_bfe_u32 v5, v4, 3, 2
    v_and_or_b32 v5, v4, 4, v5
    v_xor_b32 v5, v13, v5
    v_add_u32 v4, s36, v4
    v_lshl_add_u32 v6, v4, 5, v5
    v_lshl_add_u32 v6, v6, 4, 1
    v_mul_hi_u32 v6, v6, s38
    v_lshrrev_b32 v6, 1, v6
    v_lshrrev_b32 v11, 1, v6
    v_lshlrev_b32 v11, 2, v11
    buffer_load_dwordx3 v[56:58], v11, s[92:95], 0 offen
    buffer_load_dword v59, v11, s[92:95], 0 offen offset:12
    buffer_load_dwordx3 v[60:62], v11, s[96:99], 0 offen
    buffer_load_dword v63, v11, s[96:99], 0 offen offset:12
    v_lshrrev_b32 v54, 6, v6
    v_lshl_add_u32 v54, v54, 2, s49
    v_and_b32 v7, 15, v6
    v_cmp_eq_u32 s[28:29], 5, v7
    v_and_b32 v55, 1, v6
    v_lshlrev_b32 v55, 4, v55
    s_waitcnt vmcnt(0)
    v_add_u32 v4, 48, v12
    v_bfe_u32 v5, v4, 3, 2
    v_and_or_b32 v5, v4, 4, v5
    v_xor_b32 v5, v13, v5
    v_add_u32 v4, s36, v4
    v_lshl_add_u32 v6, v4, 5, v5
    v_lshl_add_u32 v6, v6, 4, 1
    v_mul_hi_u32 v6, v6, s38
    v_lshrrev_b32 v6, 1, v6
    v_lshrrev_b32 v11, 1, v6
    v_lshlrev_b32 v11, 2, v11
    buffer_load_dwordx3 v[72:74], v11, s[92:95], 0 offen
    buffer_load_dword v75, v11, s[92:95], 0 offen offset:12
    buffer_load_dwordx3 v[76:78], v11, s[96:99], 0 offen
    buffer_load_dword v79, v11, s[96:99], 0 offen offset:12
    v_lshrrev_b32 v70, 6, v6
    v_lshl_add_u32 v70, v70, 2, s49
    v_and_b32 v7, 15, v6
    v_cmp_eq_u32 s[30:31], 5, v7
    v_and_b32 v71, 1, v6
    v_lshlrev_b32 v71, 4, v71
    s_waitcnt vmcnt(0)
    s_add_u32 s33, s61, 1
    s_mov_b32 s60, 0x100000
L_wfd:
    s_nop 1
    ds_read_b32 v10, v2 offset:52
    s_sub_u32 s60, s60, 1
    s_cbranch_scc1 L_exit1
    s_waitcnt lgkmcnt(0)
    v_readfirstlane_b32 s48, v10
    s_cmp_lt_u32 s48, s33
    s_cbranch_scc1 L_wfd
    v_mul_u32_u24 v4, 4352, v1
    s_xor_b32 s48, s32, s39
    s_xor_b32 s48, s48, s5
    s_and_b32 s48, s48, 7
    v_mov_b32 v6, s33
    s_lshl_b64 vcc, 1, s48
    s_or_b32 s48, s32, s39
    s_bitcmp1_b32 s48, 3
    s_cselect_b64 vcc, 0xff, vcc
    s_cmp_eq_u32 s32, s39
    s_cselect_b64 vcc, 0, vcc
    s_max_u32 s48, s61, 1
    v_mov_b32 v7, s48
    v_cndmask_b32 v6, v7, v6, vcc
    s_cmp_eq_u32 s61, 1
    s_cselect_b64 exec, vcc, 0xff
    s_mov_b32 s60, 0x40000
    s_cbranch_execz L_noflags
L_flags:
    s_nop 1
    buffer_load_dword v5, v4, s[12:15], s59 offen sc1
    s_sub_u32 s60, s60, 1
    s_cbranch_scc1 L_exit1
    s_waitcnt vmcnt(0)
    v_cmpx_gt_u32 vcc, v6, v5
    s_cbranch_execnz L_flags
L_noflags:
    s_nop 1
    s_mov_b64 exec, -1
    buffer_load_dword v22, v22, s[12:15], 0 offen sc1
    buffer_load_dword v38, v38, s[12:15], 0 offen sc1
    buffer_load_dword v54, v54, s[12:15], 0 offen sc1
    buffer_load_dword v70, v70, s[12:15], 0 offen sc1
    s_bitcmp1_b32 s39, 3
    s_cselect_b32 s49, 0, 7
    s_xor_b32 s50, s32, s39
    s_bitcmp1_b32 s50, 3
    s_cselect_b32 s51, 7, 0
    s_and_b32 s50, s50, 7
    s_and_b32 s52, s39, 7
    s_add_u32 s53, s35, 4096
    v_add_u32 v4, 0, v1
    v_mul_u32_u24 v5, 1366, v4
    v_lshrrev_b32 v5, 16, v5
    v_mul_u32_u24 v6, 48, v5
    v_sub_u32 v4, v4, v6
    v_cmp_gt_u32 vcc, s34, v4
    v_and_b32 v6, s51, v5
    v_xor_b32 v6, s50, v6
    v_and_b32 v5, s49, v5
    v_xor_b32 v5, s52, v5
    v_cndmask_b32 v6, v6, v5, vcc
    v_cmp_ne_u32 s[64:65], 0, v6
    v_xor_b32 v6, s5, v6
    v_mad_u32_u24 v6, v6, s40, v104
    s_mov_b64 exec, s[64:65]
    buffer_load_dwordx4 v[80:83], v6, s[12:15], s35 offen offset:0 sc1
    s_mov_b64 exec, -1
    v_add_u32 v4, 64, v1
    v_mul_u32_u24 v5, 1366, v4
    v_lshrrev_b32 v5, 16, v5
    v_mul_u32_u24 v6, 48, v5
    v_sub_u32 v4, v4, v6
    v_cmp_gt_u32 vcc, s34, v4
    v_and_b32 v6, s51, v5
    v_xor_b32 v6, s50, v6
    v_and_b32 v5, s49, v5
    v_xor_b32 v5, s52, v5
    v_cndmask_b32 v6, v6, v5, vcc
    v_cmp_ne_u32 s[66:67], 0, v6
    v_xor_b32 v6, s5, v6
    v_mad_u32_u24 v6, v6, s40, v104
    s_mov_b64 exec, s[66:67]
    buffer_load_dwordx4 v[84:87], v6, s[12:15], s35 offen offset:1024 sc1
    s_mov_b64 exec, -1
    v_add_u32 v4, 128, v1
    v_mul_u32_u24 v5, 1366, v4
    v_lshrrev_b32 v5, 16, v5
    v_mul_u32_u24 v6, 48, v5
    v_sub_u32 v4, v4, v6
    v_cmp_gt_u32 vcc, s34, v4
    v_and_b32 v6, s51, v5
    v_xor_b32 v6, s50, v6
    v_and_b32 v5, s49, v5
    v_xor_b32 v5, s52, v5
    v_cndmask_b32 v6, v6, v5, vcc
    v_cmp_ne_u32 s[68:69], 0, v6
    v_xor_b32 v6, s5, v6
    v_mad_u32_u24 v6, v6, s40, v104
    s_mov_b64 exec, s[68:69]
    buffer_load_dwordx4 v[88:91], v6, s[12:15], s35 offen offset:2048 sc1
    s_mov_b64 exec, -1
    v_add_u32 v4, 192, v1
    v_mul_u32_u24 v5, 1366, v4
    v_lshrrev_b32 v5, 16, v5
    v_mul_u32_u24 v6, 48, v5
    v_sub_u32 v4, v4, v6
    v_cmp_gt_u32 vcc, s34, v4
    v_and_b32 v6, s51, v5
    v_xor_b32 v6, s50, v6
    v_and_b32 v5, s49, v5
    v_xor_b32 v5, s52, v5
    v_cndmask_b32 v6, v6, v5, vcc
    v_cmp_ne_u32 s[70:71], 0, v6
    v_xor_b32 v6, s5, v6
    v_mad_u32_u24 v6, v6, s40, v104
    s_mov_b64 exec, s[70:71]
    buffer_load_dwordx4 v[92:95], v6, s[12:15], s35 offen offset:3072 sc1
    s_mov_b64 exec, -1
    v_add_u32 v4, 256, v1
    v_mul_u32_u24 v5, 1366, v4
    v_lshrrev_b32 v5, 16, v5
    v_mul_u32_u24 v6, 48, v5
    v_sub_u32 v4, v4, v6
    v_cmp_gt_u32 vcc, s34, v4
    v_and_b32 v6, s51, v5
    v_xor_b32 v6, s50, v6
    v_and_b32 v5, s49, v5
    v_xor_b32 v5, s52, v5
    v_cndmask_b32 v6, v6, v5, vcc
    v_cmp_ne_u32 s[72:73], 0, v6
    v_xor_b32 v6, s5, v6
    v_mad_u32_u24 v6, v6, s40, v104
    s_mov_b64 exec, s[72:73]
    buffer_load_dwordx4 v[96:99], v6, s[12:15], s53 offen offset:0 sc1
    s_mov_b64 exec, -1
    v_add_u32 v4, 320, v1
    v_mul_u32_u24 v5, 1366, v4
    v_lshrrev_b32 v5, 16, v5
    v_mul_u32_u24 v6, 48, v5
    v_sub_u32 v4, v4, v6
    v_cmp_gt_u32 vcc, s34, v4
    v_and_b32 v6, s51, v5
    v_xor_b32 v6, s50, v6
    v_and_b32 v5, s49, v5
    v_xor_b32 v5, s52, v5
    v_cndmask_b32 v6, v6, v5, vcc
    v_cmp_ne_u32 s[74:75], 0, v6
    v_xor_b32 v6, s5, v6
    v_mad_u32_u24 v6, v6, s40, v104
    s_mov_b64 exec, s[74:75]
    buffer_load_dwordx4 v[100:103], v6, s[12:15], s53 offen offset:1024 sc1
    s_mov_b64 exec, -1
    s_waitcnt vmcnt(0)
    s_mov_b64 exec, s[64:65]
    ds_write_b128 v104, v[80:83] offset:256
    s_mov_b64 exec, s[66:67]
    ds_write_b128 v104, v[84:87] offset:1280
    s_mov_b64 exec, s[68:69]
    ds_write_b128 v104, v[88:91] offset:2304
    s_mov_b64 exec, s[70:71]
    ds_write_b128 v104, v[92:95] offset:3328
    s_mov_b64 exec, s[72:73]
    ds_write_b128 v104, v[96:99] offset:4352
    s_mov_b64 exec, s[74:75]
    ds_write_b128 v104, v[100:103] offset:5376
    s_mov_b64 exec, -1
    ds_read_b64 v[16:17], v8 offset:256
    ds_read_b64 v[18:19], v8 offset:264
    ds_read_b64 v[20:21], v8 offset:272
    ds_read_b64 v[32:33], v8 offset:448
    ds_read_b64 v[34:35], v8 offset:456
    ds_read_b64 v[36:37], v8 offset:464
    ds_read_b64 v[48:49], v8 offset:640
    ds_read_b64 v[50:51], v8 offset:648
    ds_read_b64 v[52:53], v8 offset:656
    ds_read_b64 v[64:65], v8 offset:832
    ds_read_b64 v[66:67], v8 offset:840
    ds_read_b64 v[68:69], v8 offset:848
    s_mov_b32 s34, 0
    v_mov_b32 v5, 0xf149f2ca
    v_mov_b32 v4, 0xf149f2ca
    s_waitcnt vmcnt(0) lgkmcnt(0)
    v_sub_f32 v16, v16, v22
    v_sub_f32 v17, v17, v22
    v_sub_f32 v18, v18, v22
    v_sub_f32 v19, v19, v22
    v_sub_f32 v20, v20, v22
    v_sub_f32 v21, v21, v22
    v_mul_f32 v16, s37, v16
    v_mul_f32 v17, s37, v17
    v_mul_f32 v18, s37, v18
    v_mul_f32 v19, s37, v19
    v_mul_f32 v20, s37, v20
    v_mul_f32 v21, s37, v21
    v_cndmask_b32 v21, v5, v21, s[24:25]
    v_max3_f32 v4, v4, v16, v17
    v_max3_f32 v4, v4, v18, v19
    v_max3_f32 v4, v4, v20, v21
    v_alignbit_b32 v24, v25, v24, v23
    v_alignbit_b32 v25, v26, v25, v23
    v_alignbit_b32 v26, v27, v26, v23
    v_alignbit_b32 v28, v29, v28, v23
    v_alignbit_b32 v29, v30, v29, v23
    v_alignbit_b32 v30, v31, v30, v23
    v_sub_f32 v32, v32, v38
    v_sub_f32 v33, v33, v38
    v_sub_f32 v34, v34, v38
    v_sub_f32 v35, v35, v38
    v_sub_f32 v36, v36, v38
    v_sub_f32 v37, v37, v38
    v_mul_f32 v32, s37, v32
    v_mul_f32 v33, s37, v33
    v_mul_f32 v34, s37, v34
    v_mul_f32 v35, s37, v35
    v_mul_f32 v36, s37, v36
    v_mul_f32 v37, s37, v37
    v_cndmask_b32 v37, v5, v37, s[26:27]
    v_max3_f32 v4, v4, v32, v33
    v_max3_f32 v4, v4, v34, v35
    v_max3_f32 v4, v4, v36, v37
    v_alignbit_b32 v40, v41, v40, v39
    v_alignbit_b32 v41, v42, v41, v39
    v_alignbit_b32 v42, v43, v42, v39
    v_alignbit_b32 v44, v45, v44, v39
    v_alignbit_b32 v45, v46, v45, v39
    v_alignbit_b32 v46, v47, v46, v39
    v_sub_f32 v48, v48, v54
    v_sub_f32 v49, v49, v54
    v_sub_f32 v50, v50, v54
    v_sub_f32 v51, v51, v54
    v_sub_f32 v52, v52, v54
    v_sub_f32 v53, v53, v54
    v_mul_f32 v48, s37, v48
    v_mul_f32 v49, s37, v49
    v_mul_f32 v50, s37, v50
    v_mul_f32 v51, s37, v51
    v_mul_f32 v52, s37, v52
    v_mul_f32 v53, s37, v53
    v_cndmask_b32 v53, v5, v53, s[28:29]
    v_max3_f32 v4, v4, v48, v49
    v_max3_f32 v4, v4, v50, v51
    v_max3_f32 v4, v4, v52, v53
    v_alignbit_b32 v56, v57, v56, v55
    v_alignbit_b32 v57, v58, v57, v55
    v_alignbit_b32 v58, v59, v58, v55
    v_alignbit_b32 v60, v61, v60, v55
    v_alignbit_b32 v61, v62, v61, v55
    v_alignbit_b32 v62, v63, v62, v55
    v_sub_f32 v64, v64, v70
    v_sub_f32 v65, v65, v70
    v_sub_f32 v66, v66, v70
    v_sub_f32 v67, v67, v70
    v_sub_f32 v68, v68, v70
    v_sub_f32 v69, v69, v70
    v_mul_f32 v64, s37, v64
    v_mul_f32 v65, s37, v65
    v_mul_f32 v66, s37, v66
    v_mul_f32 v67, s37, v67
    v_mul_f32 v68, s37, v68
    v_mul_f32 v69, s37, v69
    v_cndmask_b32 v69, v5, v69, s[30:31]
    v_max3_f32 v4, v4, v64, v65
    v_max3_f32 v4, v4, v66, v67
    v_max3_f32 v4, v4, v68, v69
    v_alignbit_b32 v72, v73, v72, v71
    v_alignbit_b32 v73, v74, v73, v71
    v_alignbit_b32 v74, v75, v74, v71
    v_alignbit_b32 v76, v77, v76, v71
    v_alignbit_b32 v77, v78, v77, v71
    v_alignbit_b32 v78, v79, v78, v71
    v_max_f32_dpp v4, v4, v4 row_ror:8 row_mask:0xf bank_mask:0xf
    s_nop 1
    v_max_f32_dpp v4, v4, v4 row_ror:4 row_mask:0xf bank_mask:0xf
    s_nop 1
    v_max_f32_dpp v4, v4, v4 row_ror:2 row_mask:0xf bank_mask:0xf
    s_nop 1
    v_max_f32_dpp v4, v4, v4 row_ror:1 row_mask:0xf bank_mask:0xf
    v_mov_b32 v5, v4
    s_nop 1
    v_permlane32_swap_b32 v4, v5
    v_max_f32 v4, v4, v5
    v_mov_b32 v5, v4
    s_nop 1
    v_permlane16_swap_b32 v4, v5
    v_max_f32 v4, v4, v5
    v_mov_b32 v5, 0
    v_mov_b32 v6, 0
    v_sub_f32 v16, v16, v4
    v_sub_f32 v17, v17, v4
    v_sub_f32 v18, v18, v4
    v_sub_f32 v19, v19, v4
    v_sub_f32 v20, v20, v4
    v_sub_f32 v21, v21, v4
    v_exp_f32 v16, v16
    v_exp_f32 v17, v17
    v_exp_f32 v18, v18
    v_exp_f32 v19, v19
    v_exp_f32 v20, v20
    v_exp_f32 v21, v21
    v_add_f32 v5, v5, v16
    v_lshlrev_b32 v10, 16, v24
    v_lshlrev_b32 v11, 16, v28
    v_mul_f32 v16, v16, v10
    v_fmac_f32 v6, v16, v11
    v_add_f32 v5, v5, v17
    v_and_b32 v10, 0xffff0000, v24
    v_and_b32 v11, 0xffff0000, v28
    v_mul_f32 v17, v17, v10
    v_fmac_f32 v6, v17, v11
    v_add_f32 v5, v5, v18
    v_lshlrev_b32 v10, 16, v25
    v_lshlrev_b32 v11, 16, v29
    v_mul_f32 v18, v18, v10
    v_fmac_f32 v6, v18, v11
    v_add_f32 v5, v5, v19
    v_and_b32 v10, 0xffff0000, v25
    v_and_b32 v11, 0xffff0000, v29
    v_mul_f32 v19, v19, v10
    v_fmac_f32 v6, v19, v11
    v_add_f32 v5, v5, v20
    v_lshlrev_b32 v10, 16, v26
    v_lshlrev_b32 v11, 16, v30
    v_mul_f32 v20, v20, v10
    v_fmac_f32 v6, v20, v11
    v_add_f32 v5, v5, v21
    v_and_b32 v10, 0xffff0000, v26
    v_and_b32 v11, 0xffff0000, v30
    v_mul_f32 v21, v21, v10
    v_fmac_f32 v6, v21, v11
    ds_write_b128 v14, v[16:19] offset:18688
    ds_write_b64 v14, v[20:21] offset:18704
    v_sub_f32 v32, v32, v4
    v_sub_f32 v33, v33, v4
    v_sub_f32 v34, v34, v4
    v_sub_f32 v35, v35, v4
    v_sub_f32 v36, v36, v4
    v_sub_f32 v37, v37, v4
    v_exp_f32 v32, v32
    v_exp_f32 v33, v33
    v_exp_f32 v34, v34
    v_exp_f32 v35, v35
    v_exp_f32 v36, v36
    v_exp_f32 v37, v37
    v_add_f32 v5, v5, v32
    v_lshlrev_b32 v10, 16, v40
    v_lshlrev_b32 v11, 16, v44
    v_mul_f32 v32, v32, v10
    v_fmac_f32 v6, v32, v11
    v_add_f32 v5, v5, v33
    v_and_b32 v10, 0xffff0000, v40
    v_and_b32 v11, 0xffff0000, v44
    v_mul_f32 v33, v33, v10
    v_fmac_f32 v6, v33, v11
    v_add_f32 v5, v5, v34
    v_lshlrev_b32 v10, 16, v41
    v_lshlrev_b32 v11, 16, v45
    v_mul_f32 v34, v34, v10
    v_fmac_f32 v6, v34, v11
    v_add_f32 v5, v5, v35
    v_and_b32 v10, 0xffff0000, v41
    v_and_b32 v11, 0xffff0000, v45
    v_mul_f32 v35, v35, v10
    v_fmac_f32 v6, v35, v11
    v_add_f32 v5, v5, v36
    v_lshlrev_b32 v10, 16, v42
    v_lshlrev_b32 v11, 16, v46
    v_mul_f32 v36, v36, v10
    v_fmac_f32 v6, v36, v11
    v_add_f32 v5, v5, v37
    v_and_b32 v10, 0xffff0000, v42
    v_and_b32 v11, 0xffff0000, v46
    v_mul_f32 v37, v37, v10
    v_fmac_f32 v6, v37, v11
    ds_write_b128 v14, v[32:35] offset:20736
    ds_write_b64 v14, v[36:37] offset:20752
    v_sub_f32 v48, v48, v4
    v_sub_f32 v49, v49, v4
    v_sub_f32 v50, v50, v4
    v_sub_f32 v51, v51, v4
    v_sub_f32 v52, v52, v4
    v_sub_f32 v53, v53, v4
    v_exp_f32 v48, v48
    v_exp_f32 v49, v49
    v_exp_f32 v50, v50
    v_exp_f32 v51, v51
    v_exp_f32 v52, v52
    v_exp_f32 v53, v53
    v_add_f32 v5, v5, v48
    v_lshlrev_b32 v10, 16, v56
    v_lshlrev_b32 v11, 16, v60
    v_mul_f32 v48, v48, v10
    v_fmac_f32 v6, v48, v11
    v_add_f32 v5, v5, v49
    v_and_b32 v10, 0xffff0000, v56
    v_and_b32 v11, 0xffff0000, v60
    v_mul_f32 v49, v49, v10
    v_fmac_f32 v6, v49, v11
    v_add_f32 v5, v5, v50
    v_lshlrev_b32 v10, 16, v57
    v_lshlrev_b32 v11, 16, v61
    v_mul_f32 v50, v50, v10
    v_fmac_f32 v6, v50, v11
    v_add_f32 v5, v5, v51
    v_and_b32 v10, 0xffff0000, v57
    v_and_b32 v11, 0xffff0000, v61
    v_mul_f32 v51, v51, v10
    v_fmac_f32 v6, v51, v11
    v_add_f32 v5, v5, v52
    v_lshlrev_b32 v10, 16, v58
    v_lshlrev_b32 v11, 16, v62
    v_mul_f32 v52, v52, v10
    v_fmac_f32 v6, v52, v11
    v_add_f32 v5, v5, v53
    v_and_b32 v10, 0xffff0000, v58
    v_and_b32 v11, 0xffff0000, v62
    v_mul_f32 v53, v53, v10
    v_fmac_f32 v6, v53, v11
    ds_write_b128 v14, v[48:51] offset:22784
    ds_write_b64 v14, v[52:53] offset:22800
    v_sub_f32 v64, v64, v4
    v_sub_f32 v65, v65, v4
    v_sub_f32 v66, v66, v4
    v_sub_f32 v67, v67, v4
    v_sub_f32 v68, v68, v4
    v_sub_f32 v69, v69, v4
    v_exp_f32 v64, v64
    v_exp_f32 v65, v65
    v_exp_f32 v66, v66
    v_exp_f32 v67, v67
    v_exp_f32 v68, v68
    v_exp_f32 v69, v69
    v_add_f32 v5, v5, v64
    v_lshlrev_b32 v10, 16, v72
    v_lshlrev_b32 v11, 16, v76
    v_mul_f32 v64, v64, v10
    v_fmac_f32 v6, v64, v11
    v_add_f32 v5, v5, v65
    v_and_b32 v10, 0xffff0000, v72
    v_and_b32 v11, 0xffff0000, v76
    v_mul_f32 v65, v65, v10
    v_fmac_f32 v6, v65, v11
    v_add_f32 v5, v5, v66
    v_lshlrev_b32 v10, 16, v73
    v_lshlrev_b32 v11, 16, v77
    v_mul_f32 v66, v66, v10
    v_fmac_f32 v6, v66, v11
    v_add_f32 v5, v5, v67
    v_and_b32 v10, 0xffff0000, v73
    v_and_b32 v11, 0xffff0000, v77
    v_mul_f32 v67, v67, v10
    v_fmac_f32 v6, v67, v11
    v_add_f32 v5, v5, v68
    v_lshlrev_b32 v10, 16, v74
    v_lshlrev_b32 v11, 16, v78
    v_mul_f32 v68, v68, v10
    v_fmac_f32 v6, v68, v11
    v_add_f32 v5, v5, v69
    v_and_b32 v10, 0xffff0000, v74
    v_and_b32 v11, 0xffff0000, v78
    v_mul_f32 v69, v69, v10
    v_fmac_f32 v6, v69, v11
    ds_write_b128 v14, v[64:67] offset:24832
    ds_write_b64 v14, v[68:69] offset:24848
    v_add_f32_dpp v5, v5, v5 row_ror:8 row_mask:0xf bank_mask:0xf
    v_add_f32_dpp v6, v6, v6 row_ror:8 row_mask:0xf bank_mask:0xf
    s_nop 0
    v_add_f32_dpp v5, v5, v5 row_ror:4 row_mask:0xf bank_mask:0xf
    v_add_f32_dpp v6, v6, v6 row_ror:4 row_mask:0xf bank_mask:0xf
    s_nop 0
    v_add_f32_dpp v5, v5, v5 row_ror:2 row_mask:0xf bank_mask:0xf
    v_add_f32_dpp v6, v6, v6 row_ror:2 row_mask:0xf bank_mask:0xf
    s_nop 0
    v_add_f32_dpp v5, v5, v5 row_ror:1 row_mask:0xf bank_mask:0xf
    v_add_f32_dpp v6, v6, v6 row_ror:1 row_mask:0xf bank_mask:0xf
    v_mov_b32 v10, v5
    v_mov_b32 v11, v6
    s_nop 0
    v_permlane32_swap_b32 v5, v10
    v_permlane32_swap_b32 v6, v11
    v_add_f32 v5, v5, v10
    v_add_f32 v6, v6, v11
    v_mov_b32 v10, v5
    v_mov_b32 v11, v6
    s_nop 0
    v_permlane16_swap_b32 v5, v10
    v_permlane16_swap_b32 v6, v11
    v_add_f32 v5, v5, v10
    v_add_f32 v6, v6, v11
    s_lshl_b32 s48, s61, 2
    v_mov_b32 v10, s48
    v_lshlrev_b32 v11, 2, v10
    v_mov_b32 v7, s39
    s_mov_b64 exec, 1
    ds_write_b128 v11, v[4:7] offset:80
    ds_write_b32 v10, v7 offset:24
    s_lshl_b32 s48, s61, 8
    s_add_u32 s48, s48, s2
    s_lshl_b32 s48, s48, 6
    s_add_u32 s48, s48, 917504
    buffer_store_dwordx4 v[4:7], off, s[12:15], s48 sc1
    s_mov_b64 exec, -1
    v_add_u32 v14, 8192, v14
    v_add_u32 v8, 6144, v8
    v_add_u32 v104, 6144, v104
    s_add_u32 s35, s35, 1566720
    s_add_u32 s61, s61, 1
    s_cmp_lt_u32 s61, 3
    s_cbranch_scc1 L_prep
    s_mov_b32 s61, 0
    v_lshlrev_b32 v12, 2, v1
    v_add_u32 v13, 43264, v12
    v_lshlrev_b32 v8, 4, v1
    v_mov_b32 v31, 1
L_merge:
    s_nop 1
    s_lshl_b32 s48, s61, 2
    v_mov_b32 v3, s48
    v_lshlrev_b32 v11, 2, v3
    ds_read_b128 v[4:7], v11 offset:80
    s_lshl_b32 s62, s61, 8
    s_add_u32 s62, s62, s2
    s_lshl_b32 s62, s62, 10
    s_mov_b32 s60, 0x100000
L_wm:
    s_nop 1
    ds_read_b32 v10, v3 offset:64
    s_sub_u32 s60, s60, 1
    s_cbranch_scc1 L_exit1
    s_waitcnt lgkmcnt(0)
    v_readfirstlane_b32 s48, v10
    s_cmp_lt_u32 s48, 4
    s_cbranch_scc1 L_wm
    ds_read_b32 v16, v13 offset:0
    ds_read_b32 v17, v13 offset:768
    ds_read_b32 v18, v13 offset:1536
    ds_read_b32 v19, v13 offset:2304
    ds_read_b32 v20, v13 offset:256
    ds_read_b32 v21, v13 offset:1024
    ds_read_b32 v22, v13 offset:1792
    ds_read_b32 v23, v13 offset:2560
    ds_read_b32 v24, v13 offset:512
    ds_read_b32 v25, v13 offset:1280
    ds_read_b32 v26, v13 offset:2048
    ds_read_b32 v27, v13 offset:2816
    s_waitcnt lgkmcnt(8)
    v_add_f32 v16, v16, v17
    v_add_f32 v18, v18, v19
    v_sub_f32 v16, v16, v6
    v_add_f32 v28, v16, v18
    s_waitcnt lgkmcnt(4)
    v_add_f32 v20, v20, v21
    v_add_f32 v22, v22, v23
    v_sub_f32 v20, v20, v6
    v_add_f32 v29, v20, v22
    s_waitcnt lgkmcnt(0)
    v_add_f32 v24, v24, v25
    v_add_f32 v26, v26, v27
    v_sub_f32 v24, v24, v6
    v_add_f32 v30, v24, v26
    buffer_store_dwordx4 v[28:31], v8, s[12:15], s62 offen sc1
    v_add_u32 v13, 3072, v13
    s_add_u32 s61, s61, 1
    s_cmp_lt_u32 s61, 3
    s_cbranch_scc1 L_merge
    s_endpgm
.section .rodata,"a"
.p2align 6
.amdhsa_kernel standalone__kv_cache_quant_int4_int2_kv_with_per_channel_or_per_token_scales__decode_kernel
  .amdhsa_next_free_vgpr 136
  .amdhsa_next_free_sgpr 102
  .amdhsa_accum_offset 136
  .amdhsa_group_segment_fixed_size 0
  .amdhsa_kernarg_size 80
  .amdhsa_user_sgpr_count 2
  .amdhsa_user_sgpr_kernarg_segment_ptr 1
  .amdhsa_system_sgpr_workgroup_id_x 1
.end_amdhsa_kernel
```

```asm
; @launch kernel=standalone__kv_cache_quant_int4_int2_kv_with_per_channel_or_per_token_scales__decode_kernel grid=(256,1,1) block=(512,1,1) lds=52480
.amdgcn_target "amdgcn-amd-amdhsa--gfx950"
.text
.globl standalone__kv_cache_quant_int4_int2_kv_with_per_channel_or_per_token_scales__decode_kernel
.p2align 8
.type standalone__kv_cache_quant_int4_int2_kv_with_per_channel_or_per_token_scales__decode_kernel,@function
standalone__kv_cache_quant_int4_int2_kv_with_per_channel_or_per_token_scales__decode_kernel:
    s_cmp_ge_u32 s2, 256
    s_cbranch_scc1 L_exit1
    s_load_dwordx16 s[64:79], s[0:1], 0
    s_load_dwordx4 s[80:83], s[0:1], 64
    v_lshrrev_b32 v10, 6, v0
    v_and_b32 v11, 63, v0
    v_readfirstlane_b32 s28, v10
    s_lshr_b32 s3, s2, 3
    s_and_b32 s4, s2, 7
    s_lshr_b32 s32, s2, 6
    s_xor_b32 s32, s32, s4
    s_lshr_b32 s48, s32, 1
    s_and_b32 s32, s32, 1
    s_lshl_b32 s32, s32, 2
    s_or_b32 s48, s48, s32
    s_cmp_ge_u32 s28, 4
    s_cbranch_scc1 L_helper
    v_lshrrev_b32 v1, 4, v11
    v_and_b32 v52, 15, v11
    v_lshlrev_b32 v2, 4, v52
    v_lshlrev_b32 v3, 3, v52
    v_lshlrev_b32 v62, 7, v1
    v_and_b32 v63, 0x70, v0
    v_or_b32 v63, v63, v62
    v_mov_b32 v50, v63
    s_mov_b32 s45, 768
    s_mov_b32 s46, 384
    s_mov_b32 s47, 0xaaaaaaab
    v_mov_b32 v51, 0xc0000000
    s_lshl_b32 s44, s3, 6
    s_mov_b32 s5, s48
    s_mov_b32 s29, s28
    s_lshr_b32 s33, s29, 6
    s_lshl_b32 s33, s33, 11
    s_and_b32 s32, s29, 63
    s_add_u32 s32, s32, s33
    s_add_u32 s32, s32, s44
    s_bfe_u32 s33, s32, 0x20003
    s_and_b32 s34, s32, 4
    s_or_b32 s33, s33, s34
    s_xor_b32 s33, s33, s5
    s_lshl_b32 s50, s32, 5
    s_or_b32 s50, s50, s33
    s_lshl_b32 s50, s50, 4
    s_or_b32 s50, s50, 1
    v_xor_b32 v10, s50, v50
    v_mul_hi_u32 v10, v10, s47
    v_lshrrev_b32 v10, 1, v10
    v_and_b32 v11, 15, v10
    v_cmp_eq_u32 vcc, 5, v11
    v_mad_u32_u24 v48, v10, s45, v2
    v_add_u32 v11, 3840, v48
    v_cndmask_b32 v49, v51, v11, vcc
    v_lshrrev_b32 v10, 6, v10
    v_mad_u32_u24 v9, v10, s46, v3
    s_waitcnt lgkmcnt(0)
    s_mov_b32 s30, 0
    s_mov_b32 s8, s66
    s_and_b32 s9, s67, 0xffff
    s_mov_b32 s10, 805306368
    s_mov_b32 s11, 0x00020000
    buffer_load_dwordx4 v[64:67], v48, s[8:11], 0 offen offset:0 nt
    buffer_load_dwordx4 v[68:71], v48, s[8:11], 0 offen offset:256 nt
    buffer_load_dwordx4 v[72:75], v48, s[8:11], 0 offen offset:512 nt
    buffer_load_dwordx4 v[76:79], v48, s[8:11], 0 offen offset:768 nt
    buffer_load_dwordx4 v[80:83], v48, s[8:11], 0 offen offset:1024 nt
    buffer_load_dwordx4 v[84:87], v48, s[8:11], 0 offen offset:1280 nt
    s_mov_b32 s20, s64
    s_and_b32 s21, s65, 0xffff
    s_mov_b32 s22, 12288
    s_mov_b32 s23, 0x00020000
    s_lshl_b32 s31, s30, 5
    s_add_u32 s31, s31, s3
    s_mul_i32 s31, s31, 171
    s_lshr_b32 s31, s31, 9
    s_mul_i32 s31, s31, 384
    buffer_load_dwordx2 v[36:37], v3, s[20:23], s31 offen offset:0
    buffer_load_dwordx2 v[38:39], v3, s[20:23], s31 offen offset:128
    buffer_load_dwordx2 v[40:41], v3, s[20:23], s31 offen offset:256
    s_mov_b32 s16, s70
    s_and_b32 s17, s71, 0xffff
    s_mov_b32 s18, 6291456
    s_mov_b32 s19, 0x00020000
    buffer_load_dwordx2 v[42:43], v9, s[16:19], 0 offen offset:0
    buffer_load_dwordx2 v[44:45], v9, s[16:19], 0 offen offset:128
    buffer_load_dwordx2 v[46:47], v9, s[16:19], 0 offen offset:256
    buffer_load_dwordx4 v[88:91], v48, s[8:11], 0 offen offset:1536 nt
    buffer_load_dwordx4 v[92:95], v48, s[8:11], 0 offen offset:1792 nt
    buffer_load_dwordx4 v[96:99], v48, s[8:11], 0 offen offset:2048 nt
    buffer_load_dwordx4 v[100:103], v48, s[8:11], 0 offen offset:2304 nt
    buffer_load_dwordx4 v[104:107], v48, s[8:11], 0 offen offset:2560 nt
    buffer_load_dwordx4 v[108:111], v48, s[8:11], 0 offen offset:2816 nt
    buffer_load_dwordx4 v[112:115], v48, s[8:11], 0 offen offset:3072 nt
    buffer_load_dwordx4 v[116:119], v48, s[8:11], 0 offen offset:3328 nt
    buffer_load_dwordx4 v[120:123], v48, s[8:11], 0 offen offset:3584 nt
    buffer_load_dwordx4 v[124:127], v49, s[8:11], 0 offen offset:0 nt
    buffer_load_dwordx4 v[128:131], v49, s[8:11], 0 offen offset:256 nt
    buffer_load_dwordx4 v[132:135], v49, s[8:11], 0 offen offset:512 nt
    s_mov_b32 s12, s68
    s_and_b32 s13, s69, 0xffff
    s_mov_b32 s14, 805306368
    s_mov_b32 s15, 0x00020000
    v_lshlrev_b32 v11, 5, v1
    v_bfe_u32 v4, v0, 4, 3
    v_mul_u32_u24 v4, s45, v4
    v_lshl_add_u32 v4, v52, 1, v4
    s_lshr_b32 s32, s28, 1
    s_mul_i32 s32, s32, 24
    s_add_u32 s32, s32, 256
    v_add_u32 v4, s32, v4
    v_and_b32 v5, 7, v52
    v_lshl_add_u32 v5, v5, 2, v11
    v_add_u32 v5, 18688, v5
    v_lshlrev_b32 v8, 2, v1
    v_add_u32 v8, v2, v8
    s_mul_i32 s32, s28, 768
    s_add_u32 s32, s32, 43264
    v_add_u32 v8, s32, v8
    v_mov_b32 v53, 0
    v_mov_b32 v60, 0
    v_mov_b32 v61, 0
    s_mov_b32 s42, 0x01110111
    s_mov_b32 s43, 0x01110111
    s_mov_b32 s40, 0x3b2b3b18
    s_mov_b32 s41, 0x3b2b
    s_mov_b32 s64, 0x2020200
    s_mov_b32 s65, 0x202
    s_mov_b32 s66, 0x8080800
    s_mov_b32 s67, 0x808
    s_mov_b32 s68, 0x20202000
    s_mov_b32 s69, 0x2020
    s_mov_b32 s70, 0x11031118
    s_mov_b32 s71, 0x1103
    s_mov_b32 s59, 0
    s_mov_b32 s63, 0
    s_mov_b32 s7, 0
    s_mov_b32 s62, 144
    v_mov_b32 v12, 0
    v_mov_b32 v13, 0
    v_mov_b32 v14, 0
    v_mov_b32 v15, 0
    v_mov_b32 v16, 0
    v_mov_b32 v17, 0
    v_mov_b32 v18, 0
    v_mov_b32 v19, 0
    v_mov_b32 v20, 0
    v_mov_b32 v21, 0
    v_mov_b32 v22, 0
    v_mov_b32 v23, 0
    s_barrier
    s_waitcnt vmcnt(12)
    v_lshlrev_b32 v10, 16, v36
    v_lshlrev_b32 v24, 16, v42
    v_and_b32 v11, 0xffff0000, v36
    v_and_b32 v25, 0xffff0000, v42
    v_mul_f32 v24, v24, v10
    v_mul_f32 v25, v25, v11
    v_lshlrev_b32 v10, 16, v37
    v_lshlrev_b32 v26, 16, v43
    v_and_b32 v11, 0xffff0000, v37
    v_and_b32 v27, 0xffff0000, v43
    v_mul_f32 v26, v26, v10
    v_mul_f32 v27, v27, v11
    v_lshlrev_b32 v10, 16, v38
    v_lshlrev_b32 v28, 16, v44
    v_and_b32 v11, 0xffff0000, v38
    v_and_b32 v29, 0xffff0000, v44
    v_mul_f32 v28, v28, v10
    v_mul_f32 v29, v29, v11
    v_lshlrev_b32 v10, 16, v39
    v_lshlrev_b32 v30, 16, v45
    v_and_b32 v11, 0xffff0000, v39
    v_and_b32 v31, 0xffff0000, v45
    v_mul_f32 v30, v30, v10
    v_mul_f32 v31, v31, v11
    v_lshlrev_b32 v10, 16, v40
    v_lshlrev_b32 v32, 16, v46
    v_and_b32 v11, 0xffff0000, v40
    v_and_b32 v33, 0xffff0000, v46
    v_mul_f32 v32, v32, v10
    v_mul_f32 v33, v33, v11
    v_lshlrev_b32 v10, 16, v41
    v_lshlrev_b32 v34, 16, v47
    v_and_b32 v11, 0xffff0000, v41
    v_and_b32 v35, 0xffff0000, v47
    v_mul_f32 v34, v34, v10
    v_mul_f32 v35, v35, v11
    v_cvt_f32_i32 v64, v64
    v_cvt_f32_i32 v65, v65
    v_cvt_f32_i32 v66, v66
    v_cvt_f32_i32 v67, v67
    v_mul_f32 v54, v64, v24
    v_fmac_f32 v54, v65, v25
    v_fmac_f32 v54, v66, v26
    v_fmac_f32 v54, v67, v27
    v_cvt_f32_i32 v68, v68
    v_cvt_f32_i32 v69, v69
    v_cvt_f32_i32 v70, v70
    v_cvt_f32_i32 v71, v71
    v_fmac_f32 v54, v68, v28
    v_fmac_f32 v54, v69, v29
    v_fmac_f32 v54, v70, v30
    v_fmac_f32 v54, v71, v31
    v_cvt_f32_i32 v72, v72
    v_cvt_f32_i32 v73, v73
    v_cvt_f32_i32 v74, v74
    v_cvt_f32_i32 v75, v75
    v_fmac_f32 v54, v72, v32
    v_fmac_f32 v54, v73, v33
    v_fmac_f32 v54, v74, v34
    v_fmac_f32 v54, v75, v35
    v_cvt_f32_i32 v76, v76
    v_cvt_f32_i32 v77, v77
    v_add_f32_dpp v54, v54, v54 row_ror:8 row_mask:0xf bank_mask:0xf
    v_cvt_f32_i32 v78, v78
    v_cvt_f32_i32 v79, v79
    v_add_f32_dpp v54, v54, v54 row_ror:4 row_mask:0xf bank_mask:0xf
    v_mul_f32 v55, v76, v24
    v_fmac_f32 v55, v77, v25
    v_add_f32_dpp v54, v54, v54 row_ror:2 row_mask:0xf bank_mask:0xf
    v_fmac_f32 v55, v78, v26
    v_fmac_f32 v55, v79, v27
    v_add_f32_dpp v60, v54, v54 row_ror:1 row_mask:0xf bank_mask:0x1
    v_cvt_f32_i32 v80, v80
    v_cvt_f32_i32 v81, v81
    v_cvt_f32_i32 v82, v82
    v_cvt_f32_i32 v83, v83
    v_fmac_f32 v55, v80, v28
    v_fmac_f32 v55, v81, v29
    v_fmac_f32 v55, v82, v30
    v_fmac_f32 v55, v83, v31
    v_cvt_f32_i32 v84, v84
    v_cvt_f32_i32 v85, v85
    v_cvt_f32_i32 v86, v86
    v_cvt_f32_i32 v87, v87
    v_fmac_f32 v55, v84, v32
    v_fmac_f32 v55, v85, v33
    v_fmac_f32 v55, v86, v34
    v_fmac_f32 v55, v87, v35
    s_nop 1
    v_add_f32_dpp v55, v55, v55 row_ror:8 row_mask:0xf bank_mask:0xf
    s_nop 1
    v_add_f32_dpp v55, v55, v55 row_ror:4 row_mask:0xf bank_mask:0xf
    s_nop 1
    v_add_f32_dpp v55, v55, v55 row_ror:2 row_mask:0xf bank_mask:0xf
    s_nop 1
    v_add_f32_dpp v61, v55, v55 row_ror:1 row_mask:0xf bank_mask:0x1
    s_waitcnt vmcnt(6)
    s_add_u32 s29, s29, 4
    s_add_u32 s30, s30, 1
    s_lshr_b32 s33, s29, 6
    s_lshl_b32 s33, s33, 11
    s_and_b32 s32, s29, 63
    s_add_u32 s32, s32, s33
    s_add_u32 s32, s32, s44
    s_bfe_u32 s33, s32, 0x20003
    s_and_b32 s34, s32, 4
    s_or_b32 s33, s33, s34
    s_xor_b32 s33, s33, s5
    s_lshl_b32 s50, s32, 5
    s_or_b32 s50, s50, s33
    s_lshl_b32 s50, s50, 4
    s_or_b32 s50, s50, 1
    v_xor_b32 v10, s50, v50
    v_mul_hi_u32 v10, v10, s47
    v_lshrrev_b32 v10, 1, v10
    v_and_b32 v11, 15, v10
    v_cmp_eq_u32 vcc, 5, v11
    v_mad_u32_u24 v48, v10, s45, v2
    v_add_u32 v11, 3840, v48
    v_cndmask_b32 v49, v51, v11, vcc
    v_lshrrev_b32 v10, 6, v10
    v_mad_u32_u24 v9, v10, s46, v3
    buffer_load_dwordx2 v[42:43], v9, s[16:19], 0 offen offset:0
    buffer_load_dwordx2 v[44:45], v9, s[16:19], 0 offen offset:128
    buffer_load_dwordx2 v[46:47], v9, s[16:19], 0 offen offset:256
    v_cvt_f32_i32 v88, v88
    v_cvt_f32_i32 v89, v89
    v_cvt_f32_i32 v90, v90
    v_cvt_f32_i32 v91, v91
    v_mul_f32 v56, v88, v24
    v_fmac_f32 v56, v89, v25
    v_fmac_f32 v56, v90, v26
    v_fmac_f32 v56, v91, v27
    v_cvt_f32_i32 v92, v92
    v_cvt_f32_i32 v93, v93
    v_cvt_f32_i32 v94, v94
    v_cvt_f32_i32 v95, v95
    v_fmac_f32 v56, v92, v28
    v_fmac_f32 v56, v93, v29
    v_fmac_f32 v56, v94, v30
    v_fmac_f32 v56, v95, v31
    v_cvt_f32_i32 v96, v96
    v_cvt_f32_i32 v97, v97
    v_cvt_f32_i32 v98, v98
    v_cvt_f32_i32 v99, v99
    v_fmac_f32 v56, v96, v32
    v_fmac_f32 v56, v97, v33
    v_fmac_f32 v56, v98, v34
    v_fmac_f32 v56, v99, v35
    v_cvt_f32_i32 v100, v100
    v_cvt_f32_i32 v101, v101
    v_add_f32_dpp v56, v56, v56 row_ror:8 row_mask:0xf bank_mask:0xf
    v_cvt_f32_i32 v102, v102
    v_cvt_f32_i32 v103, v103
    v_add_f32_dpp v56, v56, v56 row_ror:4 row_mask:0xf bank_mask:0xf
    v_mul_f32 v57, v100, v24
    v_fmac_f32 v57, v101, v25
    v_add_f32_dpp v56, v56, v56 row_ror:2 row_mask:0xf bank_mask:0xf
    v_fmac_f32 v57, v102, v26
    v_fmac_f32 v57, v103, v27
    v_add_f32_dpp v60, v56, v56 row_ror:1 row_mask:0xf bank_mask:0x2
    v_cvt_f32_i32 v104, v104
    v_cvt_f32_i32 v105, v105
    v_cvt_f32_i32 v106, v106
    v_cvt_f32_i32 v107, v107
    v_fmac_f32 v57, v104, v28
    v_fmac_f32 v57, v105, v29
    v_fmac_f32 v57, v106, v30
    v_fmac_f32 v57, v107, v31
    v_cvt_f32_i32 v108, v108
    v_cvt_f32_i32 v109, v109
    v_cvt_f32_i32 v110, v110
    v_cvt_f32_i32 v111, v111
    v_fmac_f32 v57, v108, v32
    v_fmac_f32 v57, v109, v33
    v_fmac_f32 v57, v110, v34
    v_fmac_f32 v57, v111, v35
    s_nop 1
    v_add_f32_dpp v57, v57, v57 row_ror:8 row_mask:0xf bank_mask:0xf
    s_nop 1
    v_add_f32_dpp v57, v57, v57 row_ror:4 row_mask:0xf bank_mask:0xf
    s_nop 1
    v_add_f32_dpp v57, v57, v57 row_ror:2 row_mask:0xf bank_mask:0xf
    s_nop 1
    v_add_f32_dpp v61, v57, v57 row_ror:1 row_mask:0xf bank_mask:0x2
    s_waitcnt vmcnt(3)
    buffer_load_dwordx4 v[64:67], v48, s[8:11], 0 offen offset:0 nt
    buffer_load_dwordx4 v[68:71], v48, s[8:11], 0 offen offset:256 nt
    buffer_load_dwordx4 v[72:75], v48, s[8:11], 0 offen offset:512 nt
    buffer_load_dwordx4 v[76:79], v48, s[8:11], 0 offen offset:768 nt
    buffer_load_dwordx4 v[80:83], v48, s[8:11], 0 offen offset:1024 nt
    buffer_load_dwordx4 v[84:87], v48, s[8:11], 0 offen offset:1280 nt
    v_cvt_f32_i32 v112, v112
    v_cvt_f32_i32 v113, v113
    v_cvt_f32_i32 v114, v114
    v_cvt_f32_i32 v115, v115
    v_mul_f32 v58, v112, v24
    v_fmac_f32 v58, v113, v25
    v_fmac_f32 v58, v114, v26
    v_fmac_f32 v58, v115, v27
    v_cvt_f32_i32 v116, v116
    v_cvt_f32_i32 v117, v117
    v_cvt_f32_i32 v118, v118
    v_cvt_f32_i32 v119, v119
    v_fmac_f32 v58, v116, v28
    v_fmac_f32 v58, v117, v29
    v_fmac_f32 v58, v118, v30
    v_fmac_f32 v58, v119, v31
    v_cvt_f32_i32 v120, v120
    v_cvt_f32_i32 v121, v121
    v_cvt_f32_i32 v122, v122
    v_cvt_f32_i32 v123, v123
    v_fmac_f32 v58, v120, v32
    v_fmac_f32 v58, v121, v33
    v_fmac_f32 v58, v122, v34
    v_fmac_f32 v58, v123, v35
    v_cvt_f32_i32 v124, v124
    v_cvt_f32_i32 v125, v125
    v_add_f32_dpp v58, v58, v58 row_ror:8 row_mask:0xf bank_mask:0xf
    v_cvt_f32_i32 v126, v126
    v_cvt_f32_i32 v127, v127
    v_add_f32_dpp v58, v58, v58 row_ror:4 row_mask:0xf bank_mask:0xf
    v_mul_f32 v59, v124, v24
    v_fmac_f32 v59, v125, v25
    v_add_f32_dpp v58, v58, v58 row_ror:2 row_mask:0xf bank_mask:0xf
    v_fmac_f32 v59, v126, v26
    v_fmac_f32 v59, v127, v27
    v_add_f32_dpp v60, v58, v58 row_ror:1 row_mask:0xf bank_mask:0x4
    v_cvt_f32_i32 v128, v128
    v_cvt_f32_i32 v129, v129
    v_cvt_f32_i32 v130, v130
    v_cvt_f32_i32 v131, v131
    v_fmac_f32 v59, v128, v28
    v_fmac_f32 v59, v129, v29
    v_fmac_f32 v59, v130, v30
    v_fmac_f32 v59, v131, v31
    v_cvt_f32_i32 v132, v132
    v_cvt_f32_i32 v133, v133
    v_cvt_f32_i32 v134, v134
    v_cvt_f32_i32 v135, v135
    v_fmac_f32 v59, v132, v32
    v_fmac_f32 v59, v133, v33
    v_fmac_f32 v59, v134, v34
    v_fmac_f32 v59, v135, v35
    s_nop 1
    v_add_f32_dpp v59, v59, v59 row_ror:8 row_mask:0xf bank_mask:0xf
    s_nop 1
    v_add_f32_dpp v59, v59, v59 row_ror:4 row_mask:0xf bank_mask:0xf
    s_nop 1
    v_add_f32_dpp v59, v59, v59 row_ror:2 row_mask:0xf bank_mask:0xf
    s_nop 1
    v_add_f32_dpp v61, v59, v59 row_ror:1 row_mask:0xf bank_mask:0x4
    s_mov_b64 exec, s[42:43]
    ds_write_b64 v4, v[60:61]
    s_mov_b64 exec, -1
    v_add_u32 v4, 48, v4
    s_waitcnt vmcnt(6)
    v_lshlrev_b32 v10, 16, v36
    v_lshlrev_b32 v24, 16, v42
    v_and_b32 v11, 0xffff0000, v36
    v_and_b32 v25, 0xffff0000, v42
    v_mul_f32 v24, v24, v10
    v_mul_f32 v25, v25, v11
    v_lshlrev_b32 v10, 16, v37
    v_lshlrev_b32 v26, 16, v43
    v_and_b32 v11, 0xffff0000, v37
    v_and_b32 v27, 0xffff0000, v43
    v_mul_f32 v26, v26, v10
    v_mul_f32 v27, v27, v11
    v_lshlrev_b32 v10, 16, v38
    v_lshlrev_b32 v28, 16, v44
    v_and_b32 v11, 0xffff0000, v38
    v_and_b32 v29, 0xffff0000, v44
    v_mul_f32 v28, v28, v10
    v_mul_f32 v29, v29, v11
    v_lshlrev_b32 v10, 16, v39
    v_lshlrev_b32 v30, 16, v45
    v_and_b32 v11, 0xffff0000, v39
    v_and_b32 v31, 0xffff0000, v45
    v_mul_f32 v30, v30, v10
    v_mul_f32 v31, v31, v11
    v_lshlrev_b32 v10, 16, v40
    v_lshlrev_b32 v32, 16, v46
    v_and_b32 v11, 0xffff0000, v40
    v_and_b32 v33, 0xffff0000, v46
    v_mul_f32 v32, v32, v10
    v_mul_f32 v33, v33, v11
    v_lshlrev_b32 v10, 16, v41
    v_lshlrev_b32 v34, 16, v47
    v_and_b32 v11, 0xffff0000, v41
    v_and_b32 v35, 0xffff0000, v47
    v_mul_f32 v34, v34, v10
    v_mul_f32 v35, v35, v11
.p2align 6
L_kloop:
    s_nop 1
    s_waitcnt vmcnt(0)
    buffer_load_dwordx4 v[88:91], v48, s[8:11], 0 offen offset:1536 nt
    buffer_load_dwordx4 v[92:95], v48, s[8:11], 0 offen offset:1792 nt
    buffer_load_dwordx4 v[96:99], v48, s[8:11], 0 offen offset:2048 nt
    buffer_load_dwordx4 v[100:103], v48, s[8:11], 0 offen offset:2304 nt
    buffer_load_dwordx4 v[104:107], v48, s[8:11], 0 offen offset:2560 nt
    buffer_load_dwordx4 v[108:111], v48, s[8:11], 0 offen offset:2816 nt
    v_cvt_f32_i32 v64, v64
    v_cvt_f32_i32 v65, v65
    v_cvt_f32_i32 v66, v66
    v_cvt_f32_i32 v67, v67
    v_mul_f32 v54, v64, v24
    v_fmac_f32 v54, v65, v25
    v_fmac_f32 v54, v66, v26
    v_fmac_f32 v54, v67, v27
    v_cvt_f32_i32 v68, v68
    v_cvt_f32_i32 v69, v69
    v_cvt_f32_i32 v70, v70
    v_cvt_f32_i32 v71, v71
    v_fmac_f32 v54, v68, v28
    v_fmac_f32 v54, v69, v29
    v_fmac_f32 v54, v70, v30
    v_fmac_f32 v54, v71, v31
    v_cvt_f32_i32 v72, v72
    v_cvt_f32_i32 v73, v73
    v_cvt_f32_i32 v74, v74
    v_cvt_f32_i32 v75, v75
    v_fmac_f32 v54, v72, v32
    v_fmac_f32 v54, v73, v33
    v_fmac_f32 v54, v74, v34
    v_fmac_f32 v54, v75, v35
    v_cvt_f32_i32 v76, v76
    v_cvt_f32_i32 v77, v77
    v_add_f32_dpp v54, v54, v54 row_ror:8 row_mask:0xf bank_mask:0xf
    v_cvt_f32_i32 v78, v78
    v_cvt_f32_i32 v79, v79
    v_add_f32_dpp v54, v54, v54 row_ror:4 row_mask:0xf bank_mask:0xf
    v_mul_f32 v55, v76, v24
    v_fmac_f32 v55, v77, v25
    v_add_f32_dpp v54, v54, v54 row_ror:2 row_mask:0xf bank_mask:0xf
    v_fmac_f32 v55, v78, v26
    v_fmac_f32 v55, v79, v27
    v_add_f32_dpp v60, v54, v54 row_ror:1 row_mask:0xf bank_mask:0x1
    v_cvt_f32_i32 v80, v80
    v_cvt_f32_i32 v81, v81
    v_cvt_f32_i32 v82, v82
    v_cvt_f32_i32 v83, v83
    v_fmac_f32 v55, v80, v28
    v_fmac_f32 v55, v81, v29
    v_fmac_f32 v55, v82, v30
    v_fmac_f32 v55, v83, v31
    v_cvt_f32_i32 v84, v84
    v_cvt_f32_i32 v85, v85
    v_cvt_f32_i32 v86, v86
    v_cvt_f32_i32 v87, v87
    v_fmac_f32 v55, v84, v32
    v_fmac_f32 v55, v85, v33
    v_fmac_f32 v55, v86, v34
    v_fmac_f32 v55, v87, v35
    s_nop 1
    v_add_f32_dpp v55, v55, v55 row_ror:8 row_mask:0xf bank_mask:0xf
    s_nop 1
    v_add_f32_dpp v55, v55, v55 row_ror:4 row_mask:0xf bank_mask:0xf
    s_nop 1
    v_add_f32_dpp v55, v55, v55 row_ror:2 row_mask:0xf bank_mask:0xf
    s_nop 1
    v_add_f32_dpp v61, v55, v55 row_ror:1 row_mask:0xf bank_mask:0x1
    s_waitcnt vmcnt(0)
    buffer_load_dwordx4 v[112:115], v48, s[8:11], 0 offen offset:3072 nt
    buffer_load_dwordx4 v[116:119], v48, s[8:11], 0 offen offset:3328 nt
    buffer_load_dwordx4 v[120:123], v48, s[8:11], 0 offen offset:3584 nt
    buffer_load_dwordx4 v[124:127], v49, s[8:11], 0 offen offset:0 nt
    buffer_load_dwordx4 v[128:131], v49, s[8:11], 0 offen offset:256 nt
    buffer_load_dwordx4 v[132:135], v49, s[8:11], 0 offen offset:512 nt
    s_add_u32 s29, s29, 4
    s_add_u32 s30, s30, 1
    s_bitcmp1_b64 s[40:41], s30
    s_cbranch_scc1 L_evK
L_evretK:
    s_nop 1
    s_lshr_b32 s33, s29, 6
    s_lshl_b32 s33, s33, 11
    s_and_b32 s32, s29, 63
    s_add_u32 s32, s32, s33
    s_add_u32 s32, s32, s44
    s_bfe_u32 s33, s32, 0x20003
    s_and_b32 s34, s32, 4
    s_or_b32 s33, s33, s34
    s_xor_b32 s33, s33, s5
    s_lshl_b32 s50, s32, 5
    s_or_b32 s50, s50, s33
    s_lshl_b32 s50, s50, 4
    s_or_b32 s50, s50, 1
    v_xor_b32 v10, s50, v50
    v_mul_hi_u32 v10, v10, s47
    v_lshrrev_b32 v10, 1, v10
    v_and_b32 v11, 15, v10
    v_cmp_eq_u32 vcc, 5, v11
    v_mad_u32_u24 v48, v10, s45, v2
    v_add_u32 v11, 3840, v48
    v_cndmask_b32 v49, v51, v11, vcc
    v_lshrrev_b32 v10, 6, v10
    v_mad_u32_u24 v9, v10, s46, v3
    buffer_load_dwordx2 v[42:43], v9, s[16:19], 0 offen offset:0
    buffer_load_dwordx2 v[44:45], v9, s[16:19], 0 offen offset:128
    buffer_load_dwordx2 v[46:47], v9, s[16:19], 0 offen offset:256
    v_cvt_f32_i32 v88, v88
    v_cvt_f32_i32 v89, v89
    v_cvt_f32_i32 v90, v90
    v_cvt_f32_i32 v91, v91
    v_mul_f32 v56, v88, v24
    v_fmac_f32 v56, v89, v25
    v_fmac_f32 v56, v90, v26
    v_fmac_f32 v56, v91, v27
    v_cvt_f32_i32 v92, v92
    v_cvt_f32_i32 v93, v93
    v_cvt_f32_i32 v94, v94
    v_cvt_f32_i32 v95, v95
    v_fmac_f32 v56, v92, v28
    v_fmac_f32 v56, v93, v29
    v_fmac_f32 v56, v94, v30
    v_fmac_f32 v56, v95, v31
    v_cvt_f32_i32 v96, v96
    v_cvt_f32_i32 v97, v97
    v_cvt_f32_i32 v98, v98
    v_cvt_f32_i32 v99, v99
    v_fmac_f32 v56, v96, v32
    v_fmac_f32 v56, v97, v33
    v_fmac_f32 v56, v98, v34
    v_fmac_f32 v56, v99, v35
    v_cvt_f32_i32 v100, v100
    v_cvt_f32_i32 v101, v101
    v_add_f32_dpp v56, v56, v56 row_ror:8 row_mask:0xf bank_mask:0xf
    v_cvt_f32_i32 v102, v102
    v_cvt_f32_i32 v103, v103
    v_add_f32_dpp v56, v56, v56 row_ror:4 row_mask:0xf bank_mask:0xf
    v_mul_f32 v57, v100, v24
    v_fmac_f32 v57, v101, v25
    v_add_f32_dpp v56, v56, v56 row_ror:2 row_mask:0xf bank_mask:0xf
    v_fmac_f32 v57, v102, v26
    v_fmac_f32 v57, v103, v27
    v_add_f32_dpp v60, v56, v56 row_ror:1 row_mask:0xf bank_mask:0x2
    v_cvt_f32_i32 v104, v104
    v_cvt_f32_i32 v105, v105
    v_cvt_f32_i32 v106, v106
    v_cvt_f32_i32 v107, v107
    v_fmac_f32 v57, v104, v28
    v_fmac_f32 v57, v105, v29
    v_fmac_f32 v57, v106, v30
    v_fmac_f32 v57, v107, v31
    v_cvt_f32_i32 v108, v108
    v_cvt_f32_i32 v109, v109
    v_cvt_f32_i32 v110, v110
    v_cvt_f32_i32 v111, v111
    v_fmac_f32 v57, v108, v32
    v_fmac_f32 v57, v109, v33
    v_fmac_f32 v57, v110, v34
    v_fmac_f32 v57, v111, v35
    s_nop 1
    v_add_f32_dpp v57, v57, v57 row_ror:8 row_mask:0xf bank_mask:0xf
    s_nop 1
    v_add_f32_dpp v57, v57, v57 row_ror:4 row_mask:0xf bank_mask:0xf
    s_nop 1
    v_add_f32_dpp v57, v57, v57 row_ror:2 row_mask:0xf bank_mask:0xf
    s_nop 1
    v_add_f32_dpp v61, v57, v57 row_ror:1 row_mask:0xf bank_mask:0x2
    s_waitcnt vmcnt(3)
    buffer_load_dwordx4 v[64:67], v48, s[8:11], 0 offen offset:0 nt
    buffer_load_dwordx4 v[68:71], v48, s[8:11], 0 offen offset:256 nt
    buffer_load_dwordx4 v[72:75], v48, s[8:11], 0 offen offset:512 nt
    buffer_load_dwordx4 v[76:79], v48, s[8:11], 0 offen offset:768 nt
    buffer_load_dwordx4 v[80:83], v48, s[8:11], 0 offen offset:1024 nt
    buffer_load_dwordx4 v[84:87], v48, s[8:11], 0 offen offset:1280 nt
    v_cvt_f32_i32 v112, v112
    v_cvt_f32_i32 v113, v113
    v_cvt_f32_i32 v114, v114
    v_cvt_f32_i32 v115, v115
    v_mul_f32 v58, v112, v24
    v_fmac_f32 v58, v113, v25
    v_fmac_f32 v58, v114, v26
    v_fmac_f32 v58, v115, v27
    v_cvt_f32_i32 v116, v116
    v_cvt_f32_i32 v117, v117
    v_cvt_f32_i32 v118, v118
    v_cvt_f32_i32 v119, v119
    v_fmac_f32 v58, v116, v28
    v_fmac_f32 v58, v117, v29
    v_fmac_f32 v58, v118, v30
    v_fmac_f32 v58, v119, v31
    v_cvt_f32_i32 v120, v120
    v_cvt_f32_i32 v121, v121
    v_cvt_f32_i32 v122, v122
    v_cvt_f32_i32 v123, v123
    v_fmac_f32 v58, v120, v32
    v_fmac_f32 v58, v121, v33
    v_fmac_f32 v58, v122, v34
    v_fmac_f32 v58, v123, v35
    v_cvt_f32_i32 v124, v124
    v_cvt_f32_i32 v125, v125
    v_add_f32_dpp v58, v58, v58 row_ror:8 row_mask:0xf bank_mask:0xf
    v_cvt_f32_i32 v126, v126
    v_cvt_f32_i32 v127, v127
    v_add_f32_dpp v58, v58, v58 row_ror:4 row_mask:0xf bank_mask:0xf
    v_mul_f32 v59, v124, v24
    v_fmac_f32 v59, v125, v25
    v_add_f32_dpp v58, v58, v58 row_ror:2 row_mask:0xf bank_mask:0xf
    v_fmac_f32 v59, v126, v26
    v_fmac_f32 v59, v127, v27
    v_add_f32_dpp v60, v58, v58 row_ror:1 row_mask:0xf bank_mask:0x4
    v_cvt_f32_i32 v128, v128
    v_cvt_f32_i32 v129, v129
    v_cvt_f32_i32 v130, v130
    v_cvt_f32_i32 v131, v131
    v_fmac_f32 v59, v128, v28
    v_fmac_f32 v59, v129, v29
    v_fmac_f32 v59, v130, v30
    v_fmac_f32 v59, v131, v31
    v_cvt_f32_i32 v132, v132
    v_cvt_f32_i32 v133, v133
    v_cvt_f32_i32 v134, v134
    v_cvt_f32_i32 v135, v135
    v_fmac_f32 v59, v132, v32
    v_fmac_f32 v59, v133, v33
    v_fmac_f32 v59, v134, v34
    v_fmac_f32 v59, v135, v35
    s_nop 1
    v_add_f32_dpp v59, v59, v59 row_ror:8 row_mask:0xf bank_mask:0xf
    s_nop 1
    v_add_f32_dpp v59, v59, v59 row_ror:4 row_mask:0xf bank_mask:0xf
    s_nop 1
    v_add_f32_dpp v59, v59, v59 row_ror:2 row_mask:0xf bank_mask:0xf
    s_nop 1
    v_add_f32_dpp v61, v59, v59 row_ror:1 row_mask:0xf bank_mask:0x4
    s_mov_b64 exec, s[42:43]
    ds_write_b64 v4, v[60:61]
    s_mov_b64 exec, -1
    v_add_u32 v4, 48, v4
    s_waitcnt vmcnt(6)
    v_lshlrev_b32 v10, 16, v36
    v_lshlrev_b32 v24, 16, v42
    v_and_b32 v11, 0xffff0000, v36
    v_and_b32 v25, 0xffff0000, v42
    v_mul_f32 v24, v24, v10
    v_mul_f32 v25, v25, v11
    v_lshlrev_b32 v10, 16, v37
    v_lshlrev_b32 v26, 16, v43
    v_and_b32 v11, 0xffff0000, v37
    v_and_b32 v27, 0xffff0000, v43
    v_mul_f32 v26, v26, v10
    v_mul_f32 v27, v27, v11
    v_lshlrev_b32 v10, 16, v38
    v_lshlrev_b32 v28, 16, v44
    v_and_b32 v11, 0xffff0000, v38
    v_and_b32 v29, 0xffff0000, v44
    v_mul_f32 v28, v28, v10
    v_mul_f32 v29, v29, v11
    v_lshlrev_b32 v10, 16, v39
    v_lshlrev_b32 v30, 16, v45
    v_and_b32 v11, 0xffff0000, v39
    v_and_b32 v31, 0xffff0000, v45
    v_mul_f32 v30, v30, v10
    v_mul_f32 v31, v31, v11
    v_lshlrev_b32 v10, 16, v40
    v_lshlrev_b32 v32, 16, v46
    v_and_b32 v11, 0xffff0000, v40
    v_and_b32 v33, 0xffff0000, v46
    v_mul_f32 v32, v32, v10
    v_mul_f32 v33, v33, v11
    v_lshlrev_b32 v10, 16, v41
    v_lshlrev_b32 v34, 16, v47
    v_and_b32 v11, 0xffff0000, v41
    v_and_b32 v35, 0xffff0000, v47
    v_mul_f32 v34, v34, v10
    v_mul_f32 v35, v35, v11
L_kchk:
    s_nop 1
    s_cmp_lg_u32 s59, 0
    s_cbranch_scc1 L_kboost
L_kchk2:
    s_nop 1
    s_cmp_lg_u32 s30, 47
    s_cbranch_scc1 L_kloop
    s_waitcnt vmcnt(0)
    buffer_load_dwordx4 v[88:91], v48, s[8:11], 0 offen offset:1536 nt
    buffer_load_dwordx4 v[92:95], v48, s[8:11], 0 offen offset:1792 nt
    buffer_load_dwordx4 v[96:99], v48, s[8:11], 0 offen offset:2048 nt
    buffer_load_dwordx4 v[100:103], v48, s[8:11], 0 offen offset:2304 nt
    buffer_load_dwordx4 v[104:107], v48, s[8:11], 0 offen offset:2560 nt
    buffer_load_dwordx4 v[108:111], v48, s[8:11], 0 offen offset:2816 nt
    v_cvt_f32_i32 v64, v64
    v_cvt_f32_i32 v65, v65
    v_cvt_f32_i32 v66, v66
    v_cvt_f32_i32 v67, v67
    v_mul_f32 v54, v64, v24
    v_fmac_f32 v54, v65, v25
    v_fmac_f32 v54, v66, v26
    v_fmac_f32 v54, v67, v27
    v_cvt_f32_i32 v68, v68
    v_cvt_f32_i32 v69, v69
    v_cvt_f32_i32 v70, v70
    v_cvt_f32_i32 v71, v71
    v_fmac_f32 v54, v68, v28
    v_fmac_f32 v54, v69, v29
    v_fmac_f32 v54, v70, v30
    v_fmac_f32 v54, v71, v31
    v_cvt_f32_i32 v72, v72
    v_cvt_f32_i32 v73, v73
    v_cvt_f32_i32 v74, v74
    v_cvt_f32_i32 v75, v75
    v_fmac_f32 v54, v72, v32
    v_fmac_f32 v54, v73, v33
    v_fmac_f32 v54, v74, v34
    v_fmac_f32 v54, v75, v35
    v_cvt_f32_i32 v76, v76
    v_cvt_f32_i32 v77, v77
    v_add_f32_dpp v54, v54, v54 row_ror:8 row_mask:0xf bank_mask:0xf
    v_cvt_f32_i32 v78, v78
    v_cvt_f32_i32 v79, v79
    v_add_f32_dpp v54, v54, v54 row_ror:4 row_mask:0xf bank_mask:0xf
    v_mul_f32 v55, v76, v24
    v_fmac_f32 v55, v77, v25
    v_add_f32_dpp v54, v54, v54 row_ror:2 row_mask:0xf bank_mask:0xf
    v_fmac_f32 v55, v78, v26
    v_fmac_f32 v55, v79, v27
    v_add_f32_dpp v60, v54, v54 row_ror:1 row_mask:0xf bank_mask:0x1
    v_cvt_f32_i32 v80, v80
    v_cvt_f32_i32 v81, v81
    v_cvt_f32_i32 v82, v82
    v_cvt_f32_i32 v83, v83
    v_fmac_f32 v55, v80, v28
    v_fmac_f32 v55, v81, v29
    v_fmac_f32 v55, v82, v30
    v_fmac_f32 v55, v83, v31
    v_cvt_f32_i32 v84, v84
    v_cvt_f32_i32 v85, v85
    v_cvt_f32_i32 v86, v86
    v_cvt_f32_i32 v87, v87
    v_fmac_f32 v55, v84, v32
    v_fmac_f32 v55, v85, v33
    v_fmac_f32 v55, v86, v34
    v_fmac_f32 v55, v87, v35
    s_nop 1
    v_add_f32_dpp v55, v55, v55 row_ror:8 row_mask:0xf bank_mask:0xf
    s_nop 1
    v_add_f32_dpp v55, v55, v55 row_ror:4 row_mask:0xf bank_mask:0xf
    s_nop 1
    v_add_f32_dpp v55, v55, v55 row_ror:2 row_mask:0xf bank_mask:0xf
    s_nop 1
    v_add_f32_dpp v61, v55, v55 row_ror:1 row_mask:0xf bank_mask:0x1
    s_waitcnt vmcnt(0)
    buffer_load_dwordx4 v[112:115], v48, s[8:11], 0 offen offset:3072 nt
    buffer_load_dwordx4 v[116:119], v48, s[8:11], 0 offen offset:3328 nt
    buffer_load_dwordx4 v[120:123], v48, s[8:11], 0 offen offset:3584 nt
    buffer_load_dwordx4 v[124:127], v49, s[8:11], 0 offen offset:0 nt
    buffer_load_dwordx4 v[128:131], v49, s[8:11], 0 offen offset:256 nt
    buffer_load_dwordx4 v[132:135], v49, s[8:11], 0 offen offset:512 nt
    s_mov_b32 s29, s28
    s_mov_b32 s30, 0
    s_memrealtime s[36:37]
    s_mov_b32 s6, 0x100000
L_wgtv:
    s_nop 1
    ds_read_b32 v10, v53 offset:216
    s_sub_u32 s6, s6, 1
    s_cbranch_scc1 L_exit1
    s_waitcnt lgkmcnt(0)
    v_readfirstlane_b32 s32, v10
    s_cmp_eq_u32 s32, 0
    s_cbranch_scc1 L_wgtv
    s_and_b32 s32, s32, 0xffff
    s_cbranch_scc0 L_gxtv
    s_add_u32 s32, s32, s36
L_gltv:
    s_nop 1
    s_memrealtime s[36:37]
    s_waitcnt lgkmcnt(0)
    s_sub_u32 s36, s36, s32
    s_cmp_lt_i32 s36, 0
    s_cbranch_scc1 L_gltv
L_gxtv:
    s_nop 1
    s_lshr_b32 s33, s30, 4
    s_lshl_b32 s34, s33, 2
    v_mov_b32 v11, s34
    s_mov_b32 s6, 0x100000
L_wtv:
    s_nop 1
    ds_read_b32 v10, v11 offset:24
    s_sub_u32 s6, s6, 1
    s_cbranch_scc1 L_exit1
    s_waitcnt lgkmcnt(0)
    v_readfirstlane_b32 s32, v10
    s_cmp_eq_u32 s32, 0
    s_cbranch_scc1 L_wtv
    s_and_b32 s5, s32, 7
    s_xor_b32 s5, s5, s48
    s_bitcmp1_b32 s32, 3
    s_cselect_b64 vcc, -1, 0
    v_cndmask_b32 v50, v62, v63, vcc
    s_mov_b32 s49, 45
    s_mov_b32 s40, 0x2a2b2a2a
    s_mov_b32 s41, 0x152b
    s_mov_b32 s64, 0x2020202
    s_mov_b32 s65, 0x102
    s_mov_b32 s66, 0x8080808
    s_mov_b32 s67, 0x408
    s_mov_b32 s68, 0x20202020
    s_mov_b32 s69, 0x1020
    s_mov_b32 s70, 0x10000
    s_mov_b32 s71, 0x1
    s_lshr_b32 s33, s29, 6
    s_lshl_b32 s33, s33, 11
    s_and_b32 s32, s29, 63
    s_add_u32 s32, s32, s33
    s_add_u32 s32, s32, s44
    s_bfe_u32 s33, s32, 0x20003
    s_and_b32 s34, s32, 4
    s_or_b32 s33, s33, s34
    s_xor_b32 s33, s33, s5
    s_lshl_b32 s50, s32, 5
    s_or_b32 s50, s50, s33
    s_lshl_b32 s50, s50, 4
    s_or_b32 s50, s50, 1
    s_lshl_b32 s53, s29, 7
    v_xor_b32 v10, s50, v50
    v_mul_hi_u32 v10, v10, s47
    v_lshrrev_b32 v10, 1, v10
    v_and_b32 v11, 15, v10
    v_cmp_eq_u32 vcc, 5, v11
    v_mad_u32_u24 v48, v10, s45, v2
    v_add_u32 v11, 3840, v48
    v_cndmask_b32 v49, v51, v11, vcc
    v_add_u32 v10, s53, v5
    ds_read_b32 v7, v10
    v_cvt_f32_i32 v88, v88
    v_cvt_f32_i32 v89, v89
    v_cvt_f32_i32 v90, v90
    v_cvt_f32_i32 v91, v91
    v_mul_f32 v56, v88, v24
    v_fmac_f32 v56, v89, v25
    v_fmac_f32 v56, v90, v26
    v_fmac_f32 v56, v91, v27
    v_cvt_f32_i32 v92, v92
    v_cvt_f32_i32 v93, v93
    v_cvt_f32_i32 v94, v94
    v_cvt_f32_i32 v95, v95
    v_fmac_f32 v56, v92, v28
    v_fmac_f32 v56, v93, v29
    v_fmac_f32 v56, v94, v30
    v_fmac_f32 v56, v95, v31
    v_cvt_f32_i32 v96, v96
    v_cvt_f32_i32 v97, v97
    v_cvt_f32_i32 v98, v98
    v_cvt_f32_i32 v99, v99
    v_fmac_f32 v56, v96, v32
    v_fmac_f32 v56, v97, v33
    v_fmac_f32 v56, v98, v34
    v_fmac_f32 v56, v99, v35
    v_cvt_f32_i32 v100, v100
    v_cvt_f32_i32 v101, v101
    v_add_f32_dpp v56, v56, v56 row_ror:8 row_mask:0xf bank_mask:0xf
    v_cvt_f32_i32 v102, v102
    v_cvt_f32_i32 v103, v103
    v_add_f32_dpp v56, v56, v56 row_ror:4 row_mask:0xf bank_mask:0xf
    v_mul_f32 v57, v100, v24
    v_fmac_f32 v57, v101, v25
    v_add_f32_dpp v56, v56, v56 row_ror:2 row_mask:0xf bank_mask:0xf
    v_fmac_f32 v57, v102, v26
    v_fmac_f32 v57, v103, v27
    v_add_f32_dpp v60, v56, v56 row_ror:1 row_mask:0xf bank_mask:0x2
    v_cvt_f32_i32 v104, v104
    v_cvt_f32_i32 v105, v105
    v_cvt_f32_i32 v106, v106
    v_cvt_f32_i32 v107, v107
    v_fmac_f32 v57, v104, v28
    v_fmac_f32 v57, v105, v29
    v_fmac_f32 v57, v106, v30
    v_fmac_f32 v57, v107, v31
    v_cvt_f32_i32 v108, v108
    v_cvt_f32_i32 v109, v109
    v_cvt_f32_i32 v110, v110
    v_cvt_f32_i32 v111, v111
    v_fmac_f32 v57, v108, v32
    v_fmac_f32 v57, v109, v33
    v_fmac_f32 v57, v110, v34
    v_fmac_f32 v57, v111, v35
    s_nop 1
    v_add_f32_dpp v57, v57, v57 row_ror:8 row_mask:0xf bank_mask:0xf
    s_nop 1
    v_add_f32_dpp v57, v57, v57 row_ror:4 row_mask:0xf bank_mask:0xf
    s_nop 1
    v_add_f32_dpp v57, v57, v57 row_ror:2 row_mask:0xf bank_mask:0xf
    s_nop 1
    v_add_f32_dpp v61, v57, v57 row_ror:1 row_mask:0xf bank_mask:0x2
    s_waitcnt vmcnt(0)
    buffer_load_dwordx4 v[64:67], v48, s[12:15], 0 offen offset:0 nt
    buffer_load_dwordx4 v[68:71], v48, s[12:15], 0 offen offset:256 nt
    buffer_load_dwordx4 v[72:75], v48, s[12:15], 0 offen offset:512 nt
    buffer_load_dwordx4 v[76:79], v48, s[12:15], 0 offen offset:768 nt
    buffer_load_dwordx4 v[80:83], v48, s[12:15], 0 offen offset:1024 nt
    buffer_load_dwordx4 v[84:87], v48, s[12:15], 0 offen offset:1280 nt
    v_cvt_f32_i32 v112, v112
    v_cvt_f32_i32 v113, v113
    v_cvt_f32_i32 v114, v114
    v_cvt_f32_i32 v115, v115
    v_mul_f32 v58, v112, v24
    v_fmac_f32 v58, v113, v25
    v_fmac_f32 v58, v114, v26
    v_fmac_f32 v58, v115, v27
    v_cvt_f32_i32 v116, v116
    v_cvt_f32_i32 v117, v117
    v_cvt_f32_i32 v118, v118
    v_cvt_f32_i32 v119, v119
    v_fmac_f32 v58, v116, v28
    v_fmac_f32 v58, v117, v29
    v_fmac_f32 v58, v118, v30
    v_fmac_f32 v58, v119, v31
    v_cvt_f32_i32 v120, v120
    v_cvt_f32_i32 v121, v121
    v_cvt_f32_i32 v122, v122
    v_cvt_f32_i32 v123, v123
    v_fmac_f32 v58, v120, v32
    v_fmac_f32 v58, v121, v33
    v_fmac_f32 v58, v122, v34
    v_fmac_f32 v58, v123, v35
    v_cvt_f32_i32 v124, v124
    v_cvt_f32_i32 v125, v125
    v_add_f32_dpp v58, v58, v58 row_ror:8 row_mask:0xf bank_mask:0xf
    v_cvt_f32_i32 v126, v126
    v_cvt_f32_i32 v127, v127
    v_add_f32_dpp v58, v58, v58 row_ror:4 row_mask:0xf bank_mask:0xf
    v_mul_f32 v59, v124, v24
    v_fmac_f32 v59, v125, v25
    v_add_f32_dpp v58, v58, v58 row_ror:2 row_mask:0xf bank_mask:0xf
    v_fmac_f32 v59, v126, v26
    v_fmac_f32 v59, v127, v27
    v_add_f32_dpp v60, v58, v58 row_ror:1 row_mask:0xf bank_mask:0x4
    v_cvt_f32_i32 v128, v128
    v_cvt_f32_i32 v129, v129
    v_cvt_f32_i32 v130, v130
    v_cvt_f32_i32 v131, v131
    v_fmac_f32 v59, v128, v28
    v_fmac_f32 v59, v129, v29
    v_fmac_f32 v59, v130, v30
    v_fmac_f32 v59, v131, v31
    v_cvt_f32_i32 v132, v132
    v_cvt_f32_i32 v133, v133
    v_cvt_f32_i32 v134, v134
    v_cvt_f32_i32 v135, v135
    v_fmac_f32 v59, v132, v32
    v_fmac_f32 v59, v133, v33
    v_fmac_f32 v59, v134, v34
    v_fmac_f32 v59, v135, v35
    s_nop 1
    v_add_f32_dpp v59, v59, v59 row_ror:8 row_mask:0xf bank_mask:0xf
    s_nop 1
    v_add_f32_dpp v59, v59, v59 row_ror:4 row_mask:0xf bank_mask:0xf
    s_nop 1
    v_add_f32_dpp v59, v59, v59 row_ror:2 row_mask:0xf bank_mask:0xf
    s_nop 1
    v_add_f32_dpp v61, v59, v59 row_ror:1 row_mask:0xf bank_mask:0x4
    s_mov_b64 exec, s[42:43]
    ds_write_b64 v4, v[60:61]
    s_mov_b64 exec, -1
    s_waitcnt lgkmcnt(0)
    v_mov_b32 v6, v7
    v_mov_b32 v11, 1
    s_mov_b64 exec, 1
    ds_add_u32 v53, v11 offset:48
    s_mov_b64 exec, -1
.p2align 6
L_vloop:
    s_nop 1
    s_waitcnt vmcnt(0)
    buffer_load_dwordx4 v[88:91], v48, s[12:15], 0 offen offset:1536 nt
    buffer_load_dwordx4 v[92:95], v48, s[12:15], 0 offen offset:1792 nt
    buffer_load_dwordx4 v[96:99], v48, s[12:15], 0 offen offset:2048 nt
    buffer_load_dwordx4 v[100:103], v48, s[12:15], 0 offen offset:2304 nt
    buffer_load_dwordx4 v[104:107], v48, s[12:15], 0 offen offset:2560 nt
    buffer_load_dwordx4 v[108:111], v48, s[12:15], 0 offen offset:2816 nt
    v_cvt_f32_i32 v64, v64
    v_cvt_f32_i32 v65, v65
    v_cvt_f32_i32 v66, v66
    v_cvt_f32_i32 v67, v67
    v_fmac_f32_dpp v12, v6, v64 row_newbcast:0 row_mask:0xf bank_mask:0xf
    v_fmac_f32_dpp v13, v6, v65 row_newbcast:0 row_mask:0xf bank_mask:0xf
    v_fmac_f32_dpp v14, v6, v66 row_newbcast:0 row_mask:0xf bank_mask:0xf
    v_fmac_f32_dpp v15, v6, v67 row_newbcast:0 row_mask:0xf bank_mask:0xf
    v_cvt_f32_i32 v68, v68
    v_cvt_f32_i32 v69, v69
    v_cvt_f32_i32 v70, v70
    v_cvt_f32_i32 v71, v71
    v_fmac_f32_dpp v16, v6, v68 row_newbcast:0 row_mask:0xf bank_mask:0xf
    v_fmac_f32_dpp v17, v6, v69 row_newbcast:0 row_mask:0xf bank_mask:0xf
    v_fmac_f32_dpp v18, v6, v70 row_newbcast:0 row_mask:0xf bank_mask:0xf
    v_fmac_f32_dpp v19, v6, v71 row_newbcast:0 row_mask:0xf bank_mask:0xf
    v_cvt_f32_i32 v72, v72
    v_cvt_f32_i32 v73, v73
    v_cvt_f32_i32 v74, v74
    v_cvt_f32_i32 v75, v75
    v_fmac_f32_dpp v20, v6, v72 row_newbcast:0 row_mask:0xf bank_mask:0xf
    v_fmac_f32_dpp v21, v6, v73 row_newbcast:0 row_mask:0xf bank_mask:0xf
    v_fmac_f32_dpp v22, v6, v74 row_newbcast:0 row_mask:0xf bank_mask:0xf
    v_fmac_f32_dpp v23, v6, v75 row_newbcast:0 row_mask:0xf bank_mask:0xf
    v_cvt_f32_i32 v76, v76
    v_cvt_f32_i32 v77, v77
    v_cvt_f32_i32 v78, v78
    v_cvt_f32_i32 v79, v79
    v_fmac_f32_dpp v12, v6, v76 row_newbcast:1 row_mask:0xf bank_mask:0xf
    v_fmac_f32_dpp v13, v6, v77 row_newbcast:1 row_mask:0xf bank_mask:0xf
    v_fmac_f32_dpp v14, v6, v78 row_newbcast:1 row_mask:0xf bank_mask:0xf
    v_fmac_f32_dpp v15, v6, v79 row_newbcast:1 row_mask:0xf bank_mask:0xf
    v_cvt_f32_i32 v80, v80
    v_cvt_f32_i32 v81, v81
    v_cvt_f32_i32 v82, v82
    v_cvt_f32_i32 v83, v83
    v_fmac_f32_dpp v16, v6, v80 row_newbcast:1 row_mask:0xf bank_mask:0xf
    v_fmac_f32_dpp v17, v6, v81 row_newbcast:1 row_mask:0xf bank_mask:0xf
    v_fmac_f32_dpp v18, v6, v82 row_newbcast:1 row_mask:0xf bank_mask:0xf
    v_fmac_f32_dpp v19, v6, v83 row_newbcast:1 row_mask:0xf bank_mask:0xf
    v_cvt_f32_i32 v84, v84
    v_cvt_f32_i32 v85, v85
    v_cvt_f32_i32 v86, v86
    v_cvt_f32_i32 v87, v87
    v_fmac_f32_dpp v20, v6, v84 row_newbcast:1 row_mask:0xf bank_mask:0xf
    v_fmac_f32_dpp v21, v6, v85 row_newbcast:1 row_mask:0xf bank_mask:0xf
    v_fmac_f32_dpp v22, v6, v86 row_newbcast:1 row_mask:0xf bank_mask:0xf
    v_fmac_f32_dpp v23, v6, v87 row_newbcast:1 row_mask:0xf bank_mask:0xf
    s_waitcnt vmcnt(0)
    buffer_load_dwordx4 v[112:115], v48, s[12:15], 0 offen offset:3072 nt
    buffer_load_dwordx4 v[116:119], v48, s[12:15], 0 offen offset:3328 nt
    buffer_load_dwordx4 v[120:123], v48, s[12:15], 0 offen offset:3584 nt
    buffer_load_dwordx4 v[124:127], v49, s[12:15], 0 offen offset:0 nt
    buffer_load_dwordx4 v[128:131], v49, s[12:15], 0 offen offset:256 nt
    buffer_load_dwordx4 v[132:135], v49, s[12:15], 0 offen offset:512 nt
    s_add_u32 s29, s29, 4
    s_add_u32 s30, s30, 1
    s_bitcmp1_b64 s[40:41], s30
    s_cbranch_scc1 L_evV
L_evretV:
    s_nop 1
    s_lshr_b32 s33, s29, 6
    s_lshl_b32 s33, s33, 11
    s_and_b32 s32, s29, 63
    s_add_u32 s32, s32, s33
    s_add_u32 s32, s32, s44
    s_bfe_u32 s33, s32, 0x20003
    s_and_b32 s34, s32, 4
    s_or_b32 s33, s33, s34
    s_xor_b32 s33, s33, s5
    s_lshl_b32 s50, s32, 5
    s_or_b32 s50, s50, s33
    s_lshl_b32 s50, s50, 4
    s_or_b32 s50, s50, 1
    s_lshl_b32 s53, s29, 7
    v_xor_b32 v10, s50, v50
    v_mul_hi_u32 v10, v10, s47
    v_lshrrev_b32 v10, 1, v10
    v_and_b32 v11, 15, v10
    v_cmp_eq_u32 vcc, 5, v11
    v_mad_u32_u24 v48, v10, s45, v2
    v_add_u32 v11, 3840, v48
    v_cndmask_b32 v49, v51, v11, vcc
    v_add_u32 v10, s53, v5
    ds_read_b32 v7, v10
    s_cmp_eq_u32 s30, 48
    s_cbranch_scc1 L_el0
L_el0r:
    v_cvt_f32_i32 v88, v88
    v_cvt_f32_i32 v89, v89
    v_cvt_f32_i32 v90, v90
    v_cvt_f32_i32 v91, v91
    v_fmac_f32_dpp v12, v6, v88 row_newbcast:2 row_mask:0xf bank_mask:0xf
    v_fmac_f32_dpp v13, v6, v89 row_newbcast:2 row_mask:0xf bank_mask:0xf
    v_fmac_f32_dpp v14, v6, v90 row_newbcast:2 row_mask:0xf bank_mask:0xf
    v_fmac_f32_dpp v15, v6, v91 row_newbcast:2 row_mask:0xf bank_mask:0xf
    v_cvt_f32_i32 v92, v92
    v_cvt_f32_i32 v93, v93
    v_cvt_f32_i32 v94, v94
    v_cvt_f32_i32 v95, v95
    v_fmac_f32_dpp v16, v6, v92 row_newbcast:2 row_mask:0xf bank_mask:0xf
    v_fmac_f32_dpp v17, v6, v93 row_newbcast:2 row_mask:0xf bank_mask:0xf
    v_fmac_f32_dpp v18, v6, v94 row_newbcast:2 row_mask:0xf bank_mask:0xf
    v_fmac_f32_dpp v19, v6, v95 row_newbcast:2 row_mask:0xf bank_mask:0xf
    v_cvt_f32_i32 v96, v96
    v_cvt_f32_i32 v97, v97
    v_cvt_f32_i32 v98, v98
    v_cvt_f32_i32 v99, v99
    v_fmac_f32_dpp v20, v6, v96 row_newbcast:2 row_mask:0xf bank_mask:0xf
    v_fmac_f32_dpp v21, v6, v97 row_newbcast:2 row_mask:0xf bank_mask:0xf
    v_fmac_f32_dpp v22, v6, v98 row_newbcast:2 row_mask:0xf bank_mask:0xf
    v_fmac_f32_dpp v23, v6, v99 row_newbcast:2 row_mask:0xf bank_mask:0xf
    v_cvt_f32_i32 v100, v100
    v_cvt_f32_i32 v101, v101
    v_cvt_f32_i32 v102, v102
    v_cvt_f32_i32 v103, v103
    v_fmac_f32_dpp v12, v6, v100 row_newbcast:3 row_mask:0xf bank_mask:0xf
    v_fmac_f32_dpp v13, v6, v101 row_newbcast:3 row_mask:0xf bank_mask:0xf
    v_fmac_f32_dpp v14, v6, v102 row_newbcast:3 row_mask:0xf bank_mask:0xf
    v_fmac_f32_dpp v15, v6, v103 row_newbcast:3 row_mask:0xf bank_mask:0xf
    v_cvt_f32_i32 v104, v104
    v_cvt_f32_i32 v105, v105
    v_cvt_f32_i32 v106, v106
    v_cvt_f32_i32 v107, v107
    v_fmac_f32_dpp v16, v6, v104 row_newbcast:3 row_mask:0xf bank_mask:0xf
    v_fmac_f32_dpp v17, v6, v105 row_newbcast:3 row_mask:0xf bank_mask:0xf
    v_fmac_f32_dpp v18, v6, v106 row_newbcast:3 row_mask:0xf bank_mask:0xf
    v_fmac_f32_dpp v19, v6, v107 row_newbcast:3 row_mask:0xf bank_mask:0xf
    v_cvt_f32_i32 v108, v108
    v_cvt_f32_i32 v109, v109
    v_cvt_f32_i32 v110, v110
    v_cvt_f32_i32 v111, v111
    v_fmac_f32_dpp v20, v6, v108 row_newbcast:3 row_mask:0xf bank_mask:0xf
    v_fmac_f32_dpp v21, v6, v109 row_newbcast:3 row_mask:0xf bank_mask:0xf
    v_fmac_f32_dpp v22, v6, v110 row_newbcast:3 row_mask:0xf bank_mask:0xf
    v_fmac_f32_dpp v23, v6, v111 row_newbcast:3 row_mask:0xf bank_mask:0xf
    s_waitcnt vmcnt(0)
    buffer_load_dwordx4 v[64:67], v48, s[12:15], 0 offen offset:0 nt
    buffer_load_dwordx4 v[68:71], v48, s[12:15], 0 offen offset:256 nt
    buffer_load_dwordx4 v[72:75], v48, s[12:15], 0 offen offset:512 nt
    buffer_load_dwordx4 v[76:79], v48, s[12:15], 0 offen offset:768 nt
    buffer_load_dwordx4 v[80:83], v48, s[12:15], 0 offen offset:1024 nt
    buffer_load_dwordx4 v[84:87], v48, s[12:15], 0 offen offset:1280 nt
    v_cvt_f32_i32 v112, v112
    v_cvt_f32_i32 v113, v113
    v_cvt_f32_i32 v114, v114
    v_cvt_f32_i32 v115, v115
    v_fmac_f32_dpp v12, v6, v112 row_newbcast:4 row_mask:0xf bank_mask:0xf
    v_fmac_f32_dpp v13, v6, v113 row_newbcast:4 row_mask:0xf bank_mask:0xf
    v_fmac_f32_dpp v14, v6, v114 row_newbcast:4 row_mask:0xf bank_mask:0xf
    v_fmac_f32_dpp v15, v6, v115 row_newbcast:4 row_mask:0xf bank_mask:0xf
    v_cvt_f32_i32 v116, v116
    v_cvt_f32_i32 v117, v117
    v_cvt_f32_i32 v118, v118
    v_cvt_f32_i32 v119, v119
    v_fmac_f32_dpp v16, v6, v116 row_newbcast:4 row_mask:0xf bank_mask:0xf
    v_fmac_f32_dpp v17, v6, v117 row_newbcast:4 row_mask:0xf bank_mask:0xf
    v_fmac_f32_dpp v18, v6, v118 row_newbcast:4 row_mask:0xf bank_mask:0xf
    v_fmac_f32_dpp v19, v6, v119 row_newbcast:4 row_mask:0xf bank_mask:0xf
    v_cvt_f32_i32 v120, v120
    v_cvt_f32_i32 v121, v121
    v_cvt_f32_i32 v122, v122
    v_cvt_f32_i32 v123, v123
    v_fmac_f32_dpp v20, v6, v120 row_newbcast:4 row_mask:0xf bank_mask:0xf
    v_fmac_f32_dpp v21, v6, v121 row_newbcast:4 row_mask:0xf bank_mask:0xf
    v_fmac_f32_dpp v22, v6, v122 row_newbcast:4 row_mask:0xf bank_mask:0xf
    v_fmac_f32_dpp v23, v6, v123 row_newbcast:4 row_mask:0xf bank_mask:0xf
    v_cvt_f32_i32 v124, v124
    v_cvt_f32_i32 v125, v125
    v_cvt_f32_i32 v126, v126
    v_cvt_f32_i32 v127, v127
    v_fmac_f32_dpp v12, v6, v124 row_newbcast:5 row_mask:0xf bank_mask:0xf
    v_fmac_f32_dpp v13, v6, v125 row_newbcast:5 row_mask:0xf bank_mask:0xf
    v_fmac_f32_dpp v14, v6, v126 row_newbcast:5 row_mask:0xf bank_mask:0xf
    v_fmac_f32_dpp v15, v6, v127 row_newbcast:5 row_mask:0xf bank_mask:0xf
    v_cvt_f32_i32 v128, v128
    v_cvt_f32_i32 v129, v129
    v_cvt_f32_i32 v130, v130
    v_cvt_f32_i32 v131, v131
    v_fmac_f32_dpp v16, v6, v128 row_newbcast:5 row_mask:0xf bank_mask:0xf
    v_fmac_f32_dpp v17, v6, v129 row_newbcast:5 row_mask:0xf bank_mask:0xf
    v_fmac_f32_dpp v18, v6, v130 row_newbcast:5 row_mask:0xf bank_mask:0xf
    v_fmac_f32_dpp v19, v6, v131 row_newbcast:5 row_mask:0xf bank_mask:0xf
    v_cvt_f32_i32 v132, v132
    v_cvt_f32_i32 v133, v133
    v_cvt_f32_i32 v134, v134
    v_cvt_f32_i32 v135, v135
    v_fmac_f32_dpp v20, v6, v132 row_newbcast:5 row_mask:0xf bank_mask:0xf
    v_fmac_f32_dpp v21, v6, v133 row_newbcast:5 row_mask:0xf bank_mask:0xf
    v_fmac_f32_dpp v22, v6, v134 row_newbcast:5 row_mask:0xf bank_mask:0xf
    v_fmac_f32_dpp v23, v6, v135 row_newbcast:5 row_mask:0xf bank_mask:0xf
    s_waitcnt lgkmcnt(0)
    v_mov_b32 v6, v7
L_vchk:
    s_nop 1
    s_cmp_eq_u32 s30, s49
    s_cbranch_scc1 L_deep
    s_cmp_lg_u32 s59, 0
    s_cbranch_scc1 L_vboost
    s_and_b32 s32, s30, 15
    s_cbranch_scc1 L_vloop
L_vend:
    s_nop 1
    v_permlane32_swap_b32 v12, v14
    v_permlane32_swap_b32 v13, v15
    v_permlane32_swap_b32 v16, v18
    v_permlane32_swap_b32 v17, v19
    v_permlane32_swap_b32 v20, v22
    v_permlane32_swap_b32 v21, v23
    v_add_f32 v12, v12, v14
    v_add_f32 v13, v13, v15
    v_add_f32 v16, v16, v18
    v_add_f32 v17, v17, v19
    v_add_f32 v20, v20, v22
    v_add_f32 v21, v21, v23
    v_permlane16_swap_b32 v12, v13
    v_permlane16_swap_b32 v16, v17
    v_permlane16_swap_b32 v20, v21
    s_lshr_b32 s32, s30, 2
    v_mov_b32 v10, s32
    v_add_f32 v12, v12, v13
    ds_write_b32 v8, v12 offset:0
    v_add_f32 v16, v16, v17
    ds_write_b32 v8, v16 offset:256
    v_add_f32 v20, v20, v21
    ds_write_b32 v8, v20 offset:512
    v_mov_b32 v11, 1
    s_mov_b64 exec, 1
    ds_add_u32 v10, v11 offset:60
    s_mov_b64 exec, -1
    v_add_u32 v8, 3072, v8
    v_mov_b32 v12, 0
    v_mov_b32 v13, 0
    v_mov_b32 v14, 0
    v_mov_b32 v15, 0
    v_mov_b32 v16, 0
    v_mov_b32 v17, 0
    v_mov_b32 v18, 0
    v_mov_b32 v19, 0
    v_mov_b32 v20, 0
    v_mov_b32 v21, 0
    v_mov_b32 v22, 0
    v_mov_b32 v23, 0
    s_cmp_lg_u32 s59, 0
    s_cbranch_scc1 L_vboost2
L_vend2:
    s_nop 1
    s_cmp_lg_u32 s30, 48
    s_cbranch_scc1 L_vloop
L_exit1:
    s_endpgm
L_deep:
    s_nop 1
    buffer_load_dwordx4 v[88:91], v48, s[12:15], 0 offen offset:1536 nt
    buffer_load_dwordx4 v[92:95], v48, s[12:15], 0 offen offset:1792 nt
    buffer_load_dwordx4 v[96:99], v48, s[12:15], 0 offen offset:2048 nt
    buffer_load_dwordx4 v[100:103], v48, s[12:15], 0 offen offset:2304 nt
    buffer_load_dwordx4 v[104:107], v48, s[12:15], 0 offen offset:2560 nt
    buffer_load_dwordx4 v[108:111], v48, s[12:15], 0 offen offset:2816 nt
    buffer_load_dwordx4 v[112:115], v48, s[12:15], 0 offen offset:3072 nt
    buffer_load_dwordx4 v[116:119], v48, s[12:15], 0 offen offset:3328 nt
    buffer_load_dwordx4 v[120:123], v48, s[12:15], 0 offen offset:3584 nt
    buffer_load_dwordx4 v[124:127], v49, s[12:15], 0 offen offset:0 nt
    buffer_load_dwordx4 v[128:131], v49, s[12:15], 0 offen offset:256 nt
    buffer_load_dwordx4 v[132:135], v49, s[12:15], 0 offen offset:512 nt
.p2align 6
L_dloop:
    s_nop 1
    s_add_u32 s29, s29, 4
    s_add_u32 s30, s30, 1
    s_lshr_b32 s33, s29, 6
    s_lshl_b32 s33, s33, 11
    s_and_b32 s32, s29, 63
    s_add_u32 s32, s32, s33
    s_add_u32 s32, s32, s44
    s_bfe_u32 s33, s32, 0x20003
    s_and_b32 s34, s32, 4
    s_or_b32 s33, s33, s34
    s_xor_b32 s33, s33, s5
    s_lshl_b32 s50, s32, 5
    s_or_b32 s50, s50, s33
    s_lshl_b32 s50, s50, 4
    s_or_b32 s50, s50, 1
    s_lshl_b32 s53, s29, 7
    v_xor_b32 v10, s50, v50
    v_mul_hi_u32 v10, v10, s47
    v_lshrrev_b32 v10, 1, v10
    v_and_b32 v11, 15, v10
    v_cmp_eq_u32 vcc, 5, v11
    v_mad_u32_u24 v48, v10, s45, v2
    v_add_u32 v11, 3840, v48
    v_cndmask_b32 v49, v51, v11, vcc
    v_add_u32 v10, s53, v5
    ds_read_b32 v7, v10
    s_waitcnt vmcnt(12)
    v_cvt_f32_i32 v64, v64
    v_cvt_f32_i32 v65, v65
    v_cvt_f32_i32 v66, v66
    v_cvt_f32_i32 v67, v67
    v_fmac_f32_dpp v12, v6, v64 row_newbcast:0 row_mask:0xf bank_mask:0xf
    v_fmac_f32_dpp v13, v6, v65 row_newbcast:0 row_mask:0xf bank_mask:0xf
    v_fmac_f32_dpp v14, v6, v66 row_newbcast:0 row_mask:0xf bank_mask:0xf
    v_fmac_f32_dpp v15, v6, v67 row_newbcast:0 row_mask:0xf bank_mask:0xf
    v_cvt_f32_i32 v68, v68
    v_cvt_f32_i32 v69, v69
    v_cvt_f32_i32 v70, v70
    v_cvt_f32_i32 v71, v71
    v_fmac_f32_dpp v16, v6, v68 row_newbcast:0 row_mask:0xf bank_mask:0xf
    v_fmac_f32_dpp v17, v6, v69 row_newbcast:0 row_mask:0xf bank_mask:0xf
    v_fmac_f32_dpp v18, v6, v70 row_newbcast:0 row_mask:0xf bank_mask:0xf
    v_fmac_f32_dpp v19, v6, v71 row_newbcast:0 row_mask:0xf bank_mask:0xf
    v_cvt_f32_i32 v72, v72
    v_cvt_f32_i32 v73, v73
    v_cvt_f32_i32 v74, v74
    v_cvt_f32_i32 v75, v75
    v_fmac_f32_dpp v20, v6, v72 row_newbcast:0 row_mask:0xf bank_mask:0xf
    v_fmac_f32_dpp v21, v6, v73 row_newbcast:0 row_mask:0xf bank_mask:0xf
    v_fmac_f32_dpp v22, v6, v74 row_newbcast:0 row_mask:0xf bank_mask:0xf
    v_fmac_f32_dpp v23, v6, v75 row_newbcast:0 row_mask:0xf bank_mask:0xf
    v_cvt_f32_i32 v76, v76
    v_cvt_f32_i32 v77, v77
    v_cvt_f32_i32 v78, v78
    v_cvt_f32_i32 v79, v79
    v_fmac_f32_dpp v12, v6, v76 row_newbcast:1 row_mask:0xf bank_mask:0xf
    v_fmac_f32_dpp v13, v6, v77 row_newbcast:1 row_mask:0xf bank_mask:0xf
    v_fmac_f32_dpp v14, v6, v78 row_newbcast:1 row_mask:0xf bank_mask:0xf
    v_fmac_f32_dpp v15, v6, v79 row_newbcast:1 row_mask:0xf bank_mask:0xf
    v_cvt_f32_i32 v80, v80
    v_cvt_f32_i32 v81, v81
    v_cvt_f32_i32 v82, v82
    v_cvt_f32_i32 v83, v83
    v_fmac_f32_dpp v16, v6, v80 row_newbcast:1 row_mask:0xf bank_mask:0xf
    v_fmac_f32_dpp v17, v6, v81 row_newbcast:1 row_mask:0xf bank_mask:0xf
    v_fmac_f32_dpp v18, v6, v82 row_newbcast:1 row_mask:0xf bank_mask:0xf
    v_fmac_f32_dpp v19, v6, v83 row_newbcast:1 row_mask:0xf bank_mask:0xf
    v_cvt_f32_i32 v84, v84
    v_cvt_f32_i32 v85, v85
    v_cvt_f32_i32 v86, v86
    v_cvt_f32_i32 v87, v87
    v_fmac_f32_dpp v20, v6, v84 row_newbcast:1 row_mask:0xf bank_mask:0xf
    v_fmac_f32_dpp v21, v6, v85 row_newbcast:1 row_mask:0xf bank_mask:0xf
    v_fmac_f32_dpp v22, v6, v86 row_newbcast:1 row_mask:0xf bank_mask:0xf
    v_fmac_f32_dpp v23, v6, v87 row_newbcast:1 row_mask:0xf bank_mask:0xf
    buffer_load_dwordx4 v[64:67], v48, s[12:15], 0 offen offset:0 nt
    buffer_load_dwordx4 v[68:71], v48, s[12:15], 0 offen offset:256 nt
    buffer_load_dwordx4 v[72:75], v48, s[12:15], 0 offen offset:512 nt
    buffer_load_dwordx4 v[76:79], v48, s[12:15], 0 offen offset:768 nt
    buffer_load_dwordx4 v[80:83], v48, s[12:15], 0 offen offset:1024 nt
    buffer_load_dwordx4 v[84:87], v48, s[12:15], 0 offen offset:1280 nt
    s_waitcnt vmcnt(12)
    s_cmp_eq_u32 s30, 48
    s_cbranch_scc1 L_el1
L_el1r:
    v_cvt_f32_i32 v88, v88
    v_cvt_f32_i32 v89, v89
    v_cvt_f32_i32 v90, v90
    v_cvt_f32_i32 v91, v91
    v_fmac_f32_dpp v12, v6, v88 row_newbcast:2 row_mask:0xf bank_mask:0xf
    v_fmac_f32_dpp v13, v6, v89 row_newbcast:2 row_mask:0xf bank_mask:0xf
    v_fmac_f32_dpp v14, v6, v90 row_newbcast:2 row_mask:0xf bank_mask:0xf
    v_fmac_f32_dpp v15, v6, v91 row_newbcast:2 row_mask:0xf bank_mask:0xf
    v_cvt_f32_i32 v92, v92
    v_cvt_f32_i32 v93, v93
    v_cvt_f32_i32 v94, v94
    v_cvt_f32_i32 v95, v95
    v_fmac_f32_dpp v16, v6, v92 row_newbcast:2 row_mask:0xf bank_mask:0xf
    v_fmac_f32_dpp v17, v6, v93 row_newbcast:2 row_mask:0xf bank_mask:0xf
    v_fmac_f32_dpp v18, v6, v94 row_newbcast:2 row_mask:0xf bank_mask:0xf
    v_fmac_f32_dpp v19, v6, v95 row_newbcast:2 row_mask:0xf bank_mask:0xf
    v_cvt_f32_i32 v96, v96
    v_cvt_f32_i32 v97, v97
    v_cvt_f32_i32 v98, v98
    v_cvt_f32_i32 v99, v99
    v_fmac_f32_dpp v20, v6, v96 row_newbcast:2 row_mask:0xf bank_mask:0xf
    v_fmac_f32_dpp v21, v6, v97 row_newbcast:2 row_mask:0xf bank_mask:0xf
    v_fmac_f32_dpp v22, v6, v98 row_newbcast:2 row_mask:0xf bank_mask:0xf
    v_fmac_f32_dpp v23, v6, v99 row_newbcast:2 row_mask:0xf bank_mask:0xf
    v_cvt_f32_i32 v100, v100
    v_cvt_f32_i32 v101, v101
    v_cvt_f32_i32 v102, v102
    v_cvt_f32_i32 v103, v103
    v_fmac_f32_dpp v12, v6, v100 row_newbcast:3 row_mask:0xf bank_mask:0xf
    v_fmac_f32_dpp v13, v6, v101 row_newbcast:3 row_mask:0xf bank_mask:0xf
    v_fmac_f32_dpp v14, v6, v102 row_newbcast:3 row_mask:0xf bank_mask:0xf
    v_fmac_f32_dpp v15, v6, v103 row_newbcast:3 row_mask:0xf bank_mask:0xf
    v_cvt_f32_i32 v104, v104
    v_cvt_f32_i32 v105, v105
    v_cvt_f32_i32 v106, v106
    v_cvt_f32_i32 v107, v107
    v_fmac_f32_dpp v16, v6, v104 row_newbcast:3 row_mask:0xf bank_mask:0xf
    v_fmac_f32_dpp v17, v6, v105 row_newbcast:3 row_mask:0xf bank_mask:0xf
    v_fmac_f32_dpp v18, v6, v106 row_newbcast:3 row_mask:0xf bank_mask:0xf
    v_fmac_f32_dpp v19, v6, v107 row_newbcast:3 row_mask:0xf bank_mask:0xf
    v_cvt_f32_i32 v108, v108
    v_cvt_f32_i32 v109, v109
    v_cvt_f32_i32 v110, v110
    v_cvt_f32_i32 v111, v111
    v_fmac_f32_dpp v20, v6, v108 row_newbcast:3 row_mask:0xf bank_mask:0xf
    v_fmac_f32_dpp v21, v6, v109 row_newbcast:3 row_mask:0xf bank_mask:0xf
    v_fmac_f32_dpp v22, v6, v110 row_newbcast:3 row_mask:0xf bank_mask:0xf
    v_fmac_f32_dpp v23, v6, v111 row_newbcast:3 row_mask:0xf bank_mask:0xf
    buffer_load_dwordx4 v[88:91], v48, s[12:15], 0 offen offset:1536 nt
    buffer_load_dwordx4 v[92:95], v48, s[12:15], 0 offen offset:1792 nt
    buffer_load_dwordx4 v[96:99], v48, s[12:15], 0 offen offset:2048 nt
    buffer_load_dwordx4 v[100:103], v48, s[12:15], 0 offen offset:2304 nt
    buffer_load_dwordx4 v[104:107], v48, s[12:15], 0 offen offset:2560 nt
    buffer_load_dwordx4 v[108:111], v48, s[12:15], 0 offen offset:2816 nt
    s_waitcnt vmcnt(12)
    v_cvt_f32_i32 v112, v112
    v_cvt_f32_i32 v113, v113
    v_cvt_f32_i32 v114, v114
    v_cvt_f32_i32 v115, v115
    v_fmac_f32_dpp v12, v6, v112 row_newbcast:4 row_mask:0xf bank_mask:0xf
    v_fmac_f32_dpp v13, v6, v113 row_newbcast:4 row_mask:0xf bank_mask:0xf
    v_fmac_f32_dpp v14, v6, v114 row_newbcast:4 row_mask:0xf bank_mask:0xf
    v_fmac_f32_dpp v15, v6, v115 row_newbcast:4 row_mask:0xf bank_mask:0xf
    v_cvt_f32_i32 v116, v116
    v_cvt_f32_i32 v117, v117
    v_cvt_f32_i32 v118, v118
    v_cvt_f32_i32 v119, v119
    v_fmac_f32_dpp v16, v6, v116 row_newbcast:4 row_mask:0xf bank_mask:0xf
    v_fmac_f32_dpp v17, v6, v117 row_newbcast:4 row_mask:0xf bank_mask:0xf
    v_fmac_f32_dpp v18, v6, v118 row_newbcast:4 row_mask:0xf bank_mask:0xf
    v_fmac_f32_dpp v19, v6, v119 row_newbcast:4 row_mask:0xf bank_mask:0xf
    v_cvt_f32_i32 v120, v120
    v_cvt_f32_i32 v121, v121
    v_cvt_f32_i32 v122, v122
    v_cvt_f32_i32 v123, v123
    v_fmac_f32_dpp v20, v6, v120 row_newbcast:4 row_mask:0xf bank_mask:0xf
    v_fmac_f32_dpp v21, v6, v121 row_newbcast:4 row_mask:0xf bank_mask:0xf
    v_fmac_f32_dpp v22, v6, v122 row_newbcast:4 row_mask:0xf bank_mask:0xf
    v_fmac_f32_dpp v23, v6, v123 row_newbcast:4 row_mask:0xf bank_mask:0xf
    v_cvt_f32_i32 v124, v124
    v_cvt_f32_i32 v125, v125
    v_cvt_f32_i32 v126, v126
    v_cvt_f32_i32 v127, v127
    v_fmac_f32_dpp v12, v6, v124 row_newbcast:5 row_mask:0xf bank_mask:0xf
    v_fmac_f32_dpp v13, v6, v125 row_newbcast:5 row_mask:0xf bank_mask:0xf
    v_fmac_f32_dpp v14, v6, v126 row_newbcast:5 row_mask:0xf bank_mask:0xf
    v_fmac_f32_dpp v15, v6, v127 row_newbcast:5 row_mask:0xf bank_mask:0xf
    v_cvt_f32_i32 v128, v128
    v_cvt_f32_i32 v129, v129
    v_cvt_f32_i32 v130, v130
    v_cvt_f32_i32 v131, v131
    v_fmac_f32_dpp v16, v6, v128 row_newbcast:5 row_mask:0xf bank_mask:0xf
    v_fmac_f32_dpp v17, v6, v129 row_newbcast:5 row_mask:0xf bank_mask:0xf
    v_fmac_f32_dpp v18, v6, v130 row_newbcast:5 row_mask:0xf bank_mask:0xf
    v_fmac_f32_dpp v19, v6, v131 row_newbcast:5 row_mask:0xf bank_mask:0xf
    v_cvt_f32_i32 v132, v132
    v_cvt_f32_i32 v133, v133
    v_cvt_f32_i32 v134, v134
    v_cvt_f32_i32 v135, v135
    v_fmac_f32_dpp v20, v6, v132 row_newbcast:5 row_mask:0xf bank_mask:0xf
    v_fmac_f32_dpp v21, v6, v133 row_newbcast:5 row_mask:0xf bank_mask:0xf
    v_fmac_f32_dpp v22, v6, v134 row_newbcast:5 row_mask:0xf bank_mask:0xf
    v_fmac_f32_dpp v23, v6, v135 row_newbcast:5 row_mask:0xf bank_mask:0xf
    buffer_load_dwordx4 v[112:115], v48, s[12:15], 0 offen offset:3072 nt
    buffer_load_dwordx4 v[116:119], v48, s[12:15], 0 offen offset:3328 nt
    buffer_load_dwordx4 v[120:123], v48, s[12:15], 0 offen offset:3584 nt
    buffer_load_dwordx4 v[124:127], v49, s[12:15], 0 offen offset:0 nt
    buffer_load_dwordx4 v[128:131], v49, s[12:15], 0 offen offset:256 nt
    buffer_load_dwordx4 v[132:135], v49, s[12:15], 0 offen offset:512 nt
    s_waitcnt lgkmcnt(0)
    v_mov_b32 v6, v7
    s_cmp_lg_u32 s30, 48
    s_cbranch_scc1 L_dloop
    s_branch L_vend
L_kboost:
    s_nop 1
    s_cmp_eq_u32 s30, 47
    s_cbranch_scc1 L_kchk2
    buffer_load_dwordx4 v[88:91], v48, s[8:11], 0 offen offset:1536 nt
    buffer_load_dwordx4 v[92:95], v48, s[8:11], 0 offen offset:1792 nt
    buffer_load_dwordx4 v[96:99], v48, s[8:11], 0 offen offset:2048 nt
    buffer_load_dwordx4 v[100:103], v48, s[8:11], 0 offen offset:2304 nt
    buffer_load_dwordx4 v[104:107], v48, s[8:11], 0 offen offset:2560 nt
    buffer_load_dwordx4 v[108:111], v48, s[8:11], 0 offen offset:2816 nt
    buffer_load_dwordx4 v[112:115], v48, s[8:11], 0 offen offset:3072 nt
    buffer_load_dwordx4 v[116:119], v48, s[8:11], 0 offen offset:3328 nt
    buffer_load_dwordx4 v[120:123], v48, s[8:11], 0 offen offset:3584 nt
    buffer_load_dwordx4 v[124:127], v49, s[8:11], 0 offen offset:0 nt
    buffer_load_dwordx4 v[128:131], v49, s[8:11], 0 offen offset:256 nt
    buffer_load_dwordx4 v[132:135], v49, s[8:11], 0 offen offset:512 nt
    s_sub_u32 s59, s59, 1
    s_add_u32 s29, s29, 4
    s_add_u32 s30, s30, 1
    s_bitcmp1_b64 s[40:41], s30
    s_cbranch_scc1 L_evKB
L_evretKB:
    s_nop 1
    s_lshr_b32 s33, s29, 6
    s_lshl_b32 s33, s33, 11
    s_and_b32 s32, s29, 63
    s_add_u32 s32, s32, s33
    s_add_u32 s32, s32, s44
    s_bfe_u32 s33, s32, 0x20003
    s_and_b32 s34, s32, 4
    s_or_b32 s33, s33, s34
    s_xor_b32 s33, s33, s5
    s_lshl_b32 s50, s32, 5
    s_or_b32 s50, s50, s33
    s_lshl_b32 s50, s50, 4
    s_or_b32 s50, s50, 1
    v_xor_b32 v10, s50, v50
    v_mul_hi_u32 v10, v10, s47
    v_lshrrev_b32 v10, 1, v10
    v_and_b32 v11, 15, v10
    v_cmp_eq_u32 vcc, 5, v11
    v_mad_u32_u24 v48, v10, s45, v2
    v_add_u32 v11, 3840, v48
    v_cndmask_b32 v49, v51, v11, vcc
    v_lshrrev_b32 v10, 6, v10
    v_mad_u32_u24 v9, v10, s46, v3
    buffer_load_dwordx2 v[42:43], v9, s[16:19], 0 offen offset:0
    buffer_load_dwordx2 v[44:45], v9, s[16:19], 0 offen offset:128
    buffer_load_dwordx2 v[46:47], v9, s[16:19], 0 offen offset:256
    s_waitcnt vmcnt(15)
    v_cvt_f32_i32 v64, v64
    v_cvt_f32_i32 v65, v65
    v_cvt_f32_i32 v66, v66
    v_cvt_f32_i32 v67, v67
    v_mul_f32 v54, v64, v24
    v_fmac_f32 v54, v65, v25
    v_fmac_f32 v54, v66, v26
    v_fmac_f32 v54, v67, v27
    v_cvt_f32_i32 v68, v68
    v_cvt_f32_i32 v69, v69
    v_cvt_f32_i32 v70, v70
    v_cvt_f32_i32 v71, v71
    v_fmac_f32 v54, v68, v28
    v_fmac_f32 v54, v69, v29
    v_fmac_f32 v54, v70, v30
    v_fmac_f32 v54, v71, v31
    v_cvt_f32_i32 v72, v72
    v_cvt_f32_i32 v73, v73
    v_cvt_f32_i32 v74, v74
    v_cvt_f32_i32 v75, v75
    v_fmac_f32 v54, v72, v32
    v_fmac_f32 v54, v73, v33
    v_fmac_f32 v54, v74, v34
    v_fmac_f32 v54, v75, v35
    v_cvt_f32_i32 v76, v76
    v_cvt_f32_i32 v77, v77
    v_add_f32_dpp v54, v54, v54 row_ror:8 row_mask:0xf bank_mask:0xf
    v_cvt_f32_i32 v78, v78
    v_cvt_f32_i32 v79, v79
    v_add_f32_dpp v54, v54, v54 row_ror:4 row_mask:0xf bank_mask:0xf
    v_mul_f32 v55, v76, v24
    v_fmac_f32 v55, v77, v25
    v_add_f32_dpp v54, v54, v54 row_ror:2 row_mask:0xf bank_mask:0xf
    v_fmac_f32 v55, v78, v26
    v_fmac_f32 v55, v79, v27
    v_add_f32_dpp v60, v54, v54 row_ror:1 row_mask:0xf bank_mask:0x1
    v_cvt_f32_i32 v80, v80
    v_cvt_f32_i32 v81, v81
    v_cvt_f32_i32 v82, v82
    v_cvt_f32_i32 v83, v83
    v_fmac_f32 v55, v80, v28
    v_fmac_f32 v55, v81, v29
    v_fmac_f32 v55, v82, v30
    v_fmac_f32 v55, v83, v31
    v_cvt_f32_i32 v84, v84
    v_cvt_f32_i32 v85, v85
    v_cvt_f32_i32 v86, v86
    v_cvt_f32_i32 v87, v87
    v_fmac_f32 v55, v84, v32
    v_fmac_f32 v55, v85, v33
    v_fmac_f32 v55, v86, v34
    v_fmac_f32 v55, v87, v35
    s_nop 1
    v_add_f32_dpp v55, v55, v55 row_ror:8 row_mask:0xf bank_mask:0xf
    s_nop 1
    v_add_f32_dpp v55, v55, v55 row_ror:4 row_mask:0xf bank_mask:0xf
    s_nop 1
    v_add_f32_dpp v55, v55, v55 row_ror:2 row_mask:0xf bank_mask:0xf
    s_nop 1
    v_add_f32_dpp v61, v55, v55 row_ror:1 row_mask:0xf bank_mask:0x1
    buffer_load_dwordx4 v[64:67], v48, s[8:11], 0 offen offset:0 nt
    buffer_load_dwordx4 v[68:71], v48, s[8:11], 0 offen offset:256 nt
    buffer_load_dwordx4 v[72:75], v48, s[8:11], 0 offen offset:512 nt
    buffer_load_dwordx4 v[76:79], v48, s[8:11], 0 offen offset:768 nt
    buffer_load_dwordx4 v[80:83], v48, s[8:11], 0 offen offset:1024 nt
    buffer_load_dwordx4 v[84:87], v48, s[8:11], 0 offen offset:1280 nt
    s_waitcnt vmcnt(15)
    v_cvt_f32_i32 v88, v88
    v_cvt_f32_i32 v89, v89
    v_cvt_f32_i32 v90, v90
    v_cvt_f32_i32 v91, v91
    v_mul_f32 v56, v88, v24
    v_fmac_f32 v56, v89, v25
    v_fmac_f32 v56, v90, v26
    v_fmac_f32 v56, v91, v27
    v_cvt_f32_i32 v92, v92
    v_cvt_f32_i32 v93, v93
    v_cvt_f32_i32 v94, v94
    v_cvt_f32_i32 v95, v95
    v_fmac_f32 v56, v92, v28
    v_fmac_f32 v56, v93, v29
    v_fmac_f32 v56, v94, v30
    v_fmac_f32 v56, v95, v31
    v_cvt_f32_i32 v96, v96
    v_cvt_f32_i32 v97, v97
    v_cvt_f32_i32 v98, v98
    v_cvt_f32_i32 v99, v99
    v_fmac_f32 v56, v96, v32
    v_fmac_f32 v56, v97, v33
    v_fmac_f32 v56, v98, v34
    v_fmac_f32 v56, v99, v35
    v_cvt_f32_i32 v100, v100
    v_cvt_f32_i32 v101, v101
    v_add_f32_dpp v56, v56, v56 row_ror:8 row_mask:0xf bank_mask:0xf
    v_cvt_f32_i32 v102, v102
    v_cvt_f32_i32 v103, v103
    v_add_f32_dpp v56, v56, v56 row_ror:4 row_mask:0xf bank_mask:0xf
    v_mul_f32 v57, v100, v24
    v_fmac_f32 v57, v101, v25
    v_add_f32_dpp v56, v56, v56 row_ror:2 row_mask:0xf bank_mask:0xf
    v_fmac_f32 v57, v102, v26
    v_fmac_f32 v57, v103, v27
    v_add_f32_dpp v60, v56, v56 row_ror:1 row_mask:0xf bank_mask:0x2
    v_cvt_f32_i32 v104, v104
    v_cvt_f32_i32 v105, v105
    v_cvt_f32_i32 v106, v106
    v_cvt_f32_i32 v107, v107
    v_fmac_f32 v57, v104, v28
    v_fmac_f32 v57, v105, v29
    v_fmac_f32 v57, v106, v30
    v_fmac_f32 v57, v107, v31
    v_cvt_f32_i32 v108, v108
    v_cvt_f32_i32 v109, v109
    v_cvt_f32_i32 v110, v110
    v_cvt_f32_i32 v111, v111
    v_fmac_f32 v57, v108, v32
    v_fmac_f32 v57, v109, v33
    v_fmac_f32 v57, v110, v34
    v_fmac_f32 v57, v111, v35
    s_nop 1
    v_add_f32_dpp v57, v57, v57 row_ror:8 row_mask:0xf bank_mask:0xf
    s_nop 1
    v_add_f32_dpp v57, v57, v57 row_ror:4 row_mask:0xf bank_mask:0xf
    s_nop 1
    v_add_f32_dpp v57, v57, v57 row_ror:2 row_mask:0xf bank_mask:0xf
    s_nop 1
    v_add_f32_dpp v61, v57, v57 row_ror:1 row_mask:0xf bank_mask:0x2
    s_waitcnt vmcnt(9)
    v_cvt_f32_i32 v112, v112
    v_cvt_f32_i32 v113, v113
    v_cvt_f32_i32 v114, v114
    v_cvt_f32_i32 v115, v115
    v_mul_f32 v58, v112, v24
    v_fmac_f32 v58, v113, v25
    v_fmac_f32 v58, v114, v26
    v_fmac_f32 v58, v115, v27
    v_cvt_f32_i32 v116, v116
    v_cvt_f32_i32 v117, v117
    v_cvt_f32_i32 v118, v118
    v_cvt_f32_i32 v119, v119
    v_fmac_f32 v58, v116, v28
    v_fmac_f32 v58, v117, v29
    v_fmac_f32 v58, v118, v30
    v_fmac_f32 v58, v119, v31
    v_cvt_f32_i32 v120, v120
    v_cvt_f32_i32 v121, v121
    v_cvt_f32_i32 v122, v122
    v_cvt_f32_i32 v123, v123
    v_fmac_f32 v58, v120, v32
    v_fmac_f32 v58, v121, v33
    v_fmac_f32 v58, v122, v34
    v_fmac_f32 v58, v123, v35
    v_cvt_f32_i32 v124, v124
    v_cvt_f32_i32 v125, v125
    v_add_f32_dpp v58, v58, v58 row_ror:8 row_mask:0xf bank_mask:0xf
    v_cvt_f32_i32 v126, v126
    v_cvt_f32_i32 v127, v127
    v_add_f32_dpp v58, v58, v58 row_ror:4 row_mask:0xf bank_mask:0xf
    v_mul_f32 v59, v124, v24
    v_fmac_f32 v59, v125, v25
    v_add_f32_dpp v58, v58, v58 row_ror:2 row_mask:0xf bank_mask:0xf
    v_fmac_f32 v59, v126, v26
    v_fmac_f32 v59, v127, v27
    v_add_f32_dpp v60, v58, v58 row_ror:1 row_mask:0xf bank_mask:0x4
    v_cvt_f32_i32 v128, v128
    v_cvt_f32_i32 v129, v129
    v_cvt_f32_i32 v130, v130
    v_cvt_f32_i32 v131, v131
    v_fmac_f32 v59, v128, v28
    v_fmac_f32 v59, v129, v29
    v_fmac_f32 v59, v130, v30
    v_fmac_f32 v59, v131, v31
    v_cvt_f32_i32 v132, v132
    v_cvt_f32_i32 v133, v133
    v_cvt_f32_i32 v134, v134
    v_cvt_f32_i32 v135, v135
    v_fmac_f32 v59, v132, v32
    v_fmac_f32 v59, v133, v33
    v_fmac_f32 v59, v134, v34
    v_fmac_f32 v59, v135, v35
    s_nop 1
    v_add_f32_dpp v59, v59, v59 row_ror:8 row_mask:0xf bank_mask:0xf
    s_nop 1
    v_add_f32_dpp v59, v59, v59 row_ror:4 row_mask:0xf bank_mask:0xf
    s_nop 1
    v_add_f32_dpp v59, v59, v59 row_ror:2 row_mask:0xf bank_mask:0xf
    s_nop 1
    v_add_f32_dpp v61, v59, v59 row_ror:1 row_mask:0xf bank_mask:0x4
    s_mov_b64 exec, s[42:43]
    ds_write_b64 v4, v[60:61]
    s_mov_b64 exec, -1
    v_add_u32 v4, 48, v4
    s_waitcnt vmcnt(6)
    v_lshlrev_b32 v10, 16, v36
    v_lshlrev_b32 v24, 16, v42
    v_and_b32 v11, 0xffff0000, v36
    v_and_b32 v25, 0xffff0000, v42
    v_mul_f32 v24, v24, v10
    v_mul_f32 v25, v25, v11
    v_lshlrev_b32 v10, 16, v37
    v_lshlrev_b32 v26, 16, v43
    v_and_b32 v11, 0xffff0000, v37
    v_and_b32 v27, 0xffff0000, v43
    v_mul_f32 v26, v26, v10
    v_mul_f32 v27, v27, v11
    v_lshlrev_b32 v10, 16, v38
    v_lshlrev_b32 v28, 16, v44
    v_and_b32 v11, 0xffff0000, v38
    v_and_b32 v29, 0xffff0000, v44
    v_mul_f32 v28, v28, v10
    v_mul_f32 v29, v29, v11
    v_lshlrev_b32 v10, 16, v39
    v_lshlrev_b32 v30, 16, v45
    v_and_b32 v11, 0xffff0000, v39
    v_and_b32 v31, 0xffff0000, v45
    v_mul_f32 v30, v30, v10
    v_mul_f32 v31, v31, v11
    v_lshlrev_b32 v10, 16, v40
    v_lshlrev_b32 v32, 16, v46
    v_and_b32 v11, 0xffff0000, v40
    v_and_b32 v33, 0xffff0000, v46
    v_mul_f32 v32, v32, v10
    v_mul_f32 v33, v33, v11
    v_lshlrev_b32 v10, 16, v41
    v_lshlrev_b32 v34, 16, v47
    v_and_b32 v11, 0xffff0000, v41
    v_and_b32 v35, 0xffff0000, v47
    v_mul_f32 v34, v34, v10
    v_mul_f32 v35, v35, v11
    s_branch L_kchk
L_vboost:
    s_nop 1
    s_and_b32 s32, s30, 15
    s_cbranch_scc0 L_vend
L_vboost2:
    s_nop 1
    s_cmp_eq_u32 s30, 48
    s_cbranch_scc1 L_vend2
    buffer_load_dwordx4 v[88:91], v48, s[12:15], 0 offen offset:1536 nt
    buffer_load_dwordx4 v[92:95], v48, s[12:15], 0 offen offset:1792 nt
    buffer_load_dwordx4 v[96:99], v48, s[12:15], 0 offen offset:2048 nt
    buffer_load_dwordx4 v[100:103], v48, s[12:15], 0 offen offset:2304 nt
    buffer_load_dwordx4 v[104:107], v48, s[12:15], 0 offen offset:2560 nt
    buffer_load_dwordx4 v[108:111], v48, s[12:15], 0 offen offset:2816 nt
    buffer_load_dwordx4 v[112:115], v48, s[12:15], 0 offen offset:3072 nt
    buffer_load_dwordx4 v[116:119], v48, s[12:15], 0 offen offset:3328 nt
    buffer_load_dwordx4 v[120:123], v48, s[12:15], 0 offen offset:3584 nt
    buffer_load_dwordx4 v[124:127], v49, s[12:15], 0 offen offset:0 nt
    buffer_load_dwordx4 v[128:131], v49, s[12:15], 0 offen offset:256 nt
    buffer_load_dwordx4 v[132:135], v49, s[12:15], 0 offen offset:512 nt
    s_sub_u32 s59, s59, 1
    s_add_u32 s29, s29, 4
    s_add_u32 s30, s30, 1
    s_bitcmp1_b64 s[40:41], s30
    s_cbranch_scc1 L_evVB
L_evretVB:
    s_nop 1
    s_lshr_b32 s33, s29, 6
    s_lshl_b32 s33, s33, 11
    s_and_b32 s32, s29, 63
    s_add_u32 s32, s32, s33
    s_add_u32 s32, s32, s44
    s_bfe_u32 s33, s32, 0x20003
    s_and_b32 s34, s32, 4
    s_or_b32 s33, s33, s34
    s_xor_b32 s33, s33, s5
    s_lshl_b32 s50, s32, 5
    s_or_b32 s50, s50, s33
    s_lshl_b32 s50, s50, 4
    s_or_b32 s50, s50, 1
    s_lshl_b32 s53, s29, 7
    v_xor_b32 v10, s50, v50
    v_mul_hi_u32 v10, v10, s47
    v_lshrrev_b32 v10, 1, v10
    v_and_b32 v11, 15, v10
    v_cmp_eq_u32 vcc, 5, v11
    v_mad_u32_u24 v48, v10, s45, v2
    v_add_u32 v11, 3840, v48
    v_cndmask_b32 v49, v51, v11, vcc
    v_add_u32 v10, s53, v5
    ds_read_b32 v7, v10
    s_waitcnt vmcnt(12)
    v_cvt_f32_i32 v64, v64
    v_cvt_f32_i32 v65, v65
    v_cvt_f32_i32 v66, v66
    v_cvt_f32_i32 v67, v67
    v_fmac_f32_dpp v12, v6, v64 row_newbcast:0 row_mask:0xf bank_mask:0xf
    v_fmac_f32_dpp v13, v6, v65 row_newbcast:0 row_mask:0xf bank_mask:0xf
    v_fmac_f32_dpp v14, v6, v66 row_newbcast:0 row_mask:0xf bank_mask:0xf
    v_fmac_f32_dpp v15, v6, v67 row_newbcast:0 row_mask:0xf bank_mask:0xf
    v_cvt_f32_i32 v68, v68
    v_cvt_f32_i32 v69, v69
    v_cvt_f32_i32 v70, v70
    v_cvt_f32_i32 v71, v71
    v_fmac_f32_dpp v16, v6, v68 row_newbcast:0 row_mask:0xf bank_mask:0xf
    v_fmac_f32_dpp v17, v6, v69 row_newbcast:0 row_mask:0xf bank_mask:0xf
    v_fmac_f32_dpp v18, v6, v70 row_newbcast:0 row_mask:0xf bank_mask:0xf
    v_fmac_f32_dpp v19, v6, v71 row_newbcast:0 row_mask:0xf bank_mask:0xf
    v_cvt_f32_i32 v72, v72
    v_cvt_f32_i32 v73, v73
    v_cvt_f32_i32 v74, v74
    v_cvt_f32_i32 v75, v75
    v_fmac_f32_dpp v20, v6, v72 row_newbcast:0 row_mask:0xf bank_mask:0xf
    v_fmac_f32_dpp v21, v6, v73 row_newbcast:0 row_mask:0xf bank_mask:0xf
    v_fmac_f32_dpp v22, v6, v74 row_newbcast:0 row_mask:0xf bank_mask:0xf
    v_fmac_f32_dpp v23, v6, v75 row_newbcast:0 row_mask:0xf bank_mask:0xf
    v_cvt_f32_i32 v76, v76
    v_cvt_f32_i32 v77, v77
    v_cvt_f32_i32 v78, v78
    v_cvt_f32_i32 v79, v79
    v_fmac_f32_dpp v12, v6, v76 row_newbcast:1 row_mask:0xf bank_mask:0xf
    v_fmac_f32_dpp v13, v6, v77 row_newbcast:1 row_mask:0xf bank_mask:0xf
    v_fmac_f32_dpp v14, v6, v78 row_newbcast:1 row_mask:0xf bank_mask:0xf
    v_fmac_f32_dpp v15, v6, v79 row_newbcast:1 row_mask:0xf bank_mask:0xf
    v_cvt_f32_i32 v80, v80
    v_cvt_f32_i32 v81, v81
    v_cvt_f32_i32 v82, v82
    v_cvt_f32_i32 v83, v83
    v_fmac_f32_dpp v16, v6, v80 row_newbcast:1 row_mask:0xf bank_mask:0xf
    v_fmac_f32_dpp v17, v6, v81 row_newbcast:1 row_mask:0xf bank_mask:0xf
    v_fmac_f32_dpp v18, v6, v82 row_newbcast:1 row_mask:0xf bank_mask:0xf
    v_fmac_f32_dpp v19, v6, v83 row_newbcast:1 row_mask:0xf bank_mask:0xf
    v_cvt_f32_i32 v84, v84
    v_cvt_f32_i32 v85, v85
    v_cvt_f32_i32 v86, v86
    v_cvt_f32_i32 v87, v87
    v_fmac_f32_dpp v20, v6, v84 row_newbcast:1 row_mask:0xf bank_mask:0xf
    v_fmac_f32_dpp v21, v6, v85 row_newbcast:1 row_mask:0xf bank_mask:0xf
    v_fmac_f32_dpp v22, v6, v86 row_newbcast:1 row_mask:0xf bank_mask:0xf
    v_fmac_f32_dpp v23, v6, v87 row_newbcast:1 row_mask:0xf bank_mask:0xf
    buffer_load_dwordx4 v[64:67], v48, s[12:15], 0 offen offset:0 nt
    buffer_load_dwordx4 v[68:71], v48, s[12:15], 0 offen offset:256 nt
    buffer_load_dwordx4 v[72:75], v48, s[12:15], 0 offen offset:512 nt
    buffer_load_dwordx4 v[76:79], v48, s[12:15], 0 offen offset:768 nt
    buffer_load_dwordx4 v[80:83], v48, s[12:15], 0 offen offset:1024 nt
    buffer_load_dwordx4 v[84:87], v48, s[12:15], 0 offen offset:1280 nt
    s_waitcnt vmcnt(12)
    s_cmp_eq_u32 s30, 48
    s_cbranch_scc1 L_el2
L_el2r:
    v_cvt_f32_i32 v88, v88
    v_cvt_f32_i32 v89, v89
    v_cvt_f32_i32 v90, v90
    v_cvt_f32_i32 v91, v91
    v_fmac_f32_dpp v12, v6, v88 row_newbcast:2 row_mask:0xf bank_mask:0xf
    v_fmac_f32_dpp v13, v6, v89 row_newbcast:2 row_mask:0xf bank_mask:0xf
    v_fmac_f32_dpp v14, v6, v90 row_newbcast:2 row_mask:0xf bank_mask:0xf
    v_fmac_f32_dpp v15, v6, v91 row_newbcast:2 row_mask:0xf bank_mask:0xf
    v_cvt_f32_i32 v92, v92
    v_cvt_f32_i32 v93, v93
    v_cvt_f32_i32 v94, v94
    v_cvt_f32_i32 v95, v95
    v_fmac_f32_dpp v16, v6, v92 row_newbcast:2 row_mask:0xf bank_mask:0xf
    v_fmac_f32_dpp v17, v6, v93 row_newbcast:2 row_mask:0xf bank_mask:0xf
    v_fmac_f32_dpp v18, v6, v94 row_newbcast:2 row_mask:0xf bank_mask:0xf
    v_fmac_f32_dpp v19, v6, v95 row_newbcast:2 row_mask:0xf bank_mask:0xf
    v_cvt_f32_i32 v96, v96
    v_cvt_f32_i32 v97, v97
    v_cvt_f32_i32 v98, v98
    v_cvt_f32_i32 v99, v99
    v_fmac_f32_dpp v20, v6, v96 row_newbcast:2 row_mask:0xf bank_mask:0xf
    v_fmac_f32_dpp v21, v6, v97 row_newbcast:2 row_mask:0xf bank_mask:0xf
    v_fmac_f32_dpp v22, v6, v98 row_newbcast:2 row_mask:0xf bank_mask:0xf
    v_fmac_f32_dpp v23, v6, v99 row_newbcast:2 row_mask:0xf bank_mask:0xf
    v_cvt_f32_i32 v100, v100
    v_cvt_f32_i32 v101, v101
    v_cvt_f32_i32 v102, v102
    v_cvt_f32_i32 v103, v103
    v_fmac_f32_dpp v12, v6, v100 row_newbcast:3 row_mask:0xf bank_mask:0xf
    v_fmac_f32_dpp v13, v6, v101 row_newbcast:3 row_mask:0xf bank_mask:0xf
    v_fmac_f32_dpp v14, v6, v102 row_newbcast:3 row_mask:0xf bank_mask:0xf
    v_fmac_f32_dpp v15, v6, v103 row_newbcast:3 row_mask:0xf bank_mask:0xf
    v_cvt_f32_i32 v104, v104
    v_cvt_f32_i32 v105, v105
    v_cvt_f32_i32 v106, v106
    v_cvt_f32_i32 v107, v107
    v_fmac_f32_dpp v16, v6, v104 row_newbcast:3 row_mask:0xf bank_mask:0xf
    v_fmac_f32_dpp v17, v6, v105 row_newbcast:3 row_mask:0xf bank_mask:0xf
    v_fmac_f32_dpp v18, v6, v106 row_newbcast:3 row_mask:0xf bank_mask:0xf
    v_fmac_f32_dpp v19, v6, v107 row_newbcast:3 row_mask:0xf bank_mask:0xf
    v_cvt_f32_i32 v108, v108
    v_cvt_f32_i32 v109, v109
    v_cvt_f32_i32 v110, v110
    v_cvt_f32_i32 v111, v111
    v_fmac_f32_dpp v20, v6, v108 row_newbcast:3 row_mask:0xf bank_mask:0xf
    v_fmac_f32_dpp v21, v6, v109 row_newbcast:3 row_mask:0xf bank_mask:0xf
    v_fmac_f32_dpp v22, v6, v110 row_newbcast:3 row_mask:0xf bank_mask:0xf
    v_fmac_f32_dpp v23, v6, v111 row_newbcast:3 row_mask:0xf bank_mask:0xf
    s_waitcnt vmcnt(6)
    v_cvt_f32_i32 v112, v112
    v_cvt_f32_i32 v113, v113
    v_cvt_f32_i32 v114, v114
    v_cvt_f32_i32 v115, v115
    v_fmac_f32_dpp v12, v6, v112 row_newbcast:4 row_mask:0xf bank_mask:0xf
    v_fmac_f32_dpp v13, v6, v113 row_newbcast:4 row_mask:0xf bank_mask:0xf
    v_fmac_f32_dpp v14, v6, v114 row_newbcast:4 row_mask:0xf bank_mask:0xf
    v_fmac_f32_dpp v15, v6, v115 row_newbcast:4 row_mask:0xf bank_mask:0xf
    v_cvt_f32_i32 v116, v116
    v_cvt_f32_i32 v117, v117
    v_cvt_f32_i32 v118, v118
    v_cvt_f32_i32 v119, v119
    v_fmac_f32_dpp v16, v6, v116 row_newbcast:4 row_mask:0xf bank_mask:0xf
    v_fmac_f32_dpp v17, v6, v117 row_newbcast:4 row_mask:0xf bank_mask:0xf
    v_fmac_f32_dpp v18, v6, v118 row_newbcast:4 row_mask:0xf bank_mask:0xf
    v_fmac_f32_dpp v19, v6, v119 row_newbcast:4 row_mask:0xf bank_mask:0xf
    v_cvt_f32_i32 v120, v120
    v_cvt_f32_i32 v121, v121
    v_cvt_f32_i32 v122, v122
    v_cvt_f32_i32 v123, v123
    v_fmac_f32_dpp v20, v6, v120 row_newbcast:4 row_mask:0xf bank_mask:0xf
    v_fmac_f32_dpp v21, v6, v121 row_newbcast:4 row_mask:0xf bank_mask:0xf
    v_fmac_f32_dpp v22, v6, v122 row_newbcast:4 row_mask:0xf bank_mask:0xf
    v_fmac_f32_dpp v23, v6, v123 row_newbcast:4 row_mask:0xf bank_mask:0xf
    v_cvt_f32_i32 v124, v124
    v_cvt_f32_i32 v125, v125
    v_cvt_f32_i32 v126, v126
    v_cvt_f32_i32 v127, v127
    v_fmac_f32_dpp v12, v6, v124 row_newbcast:5 row_mask:0xf bank_mask:0xf
    v_fmac_f32_dpp v13, v6, v125 row_newbcast:5 row_mask:0xf bank_mask:0xf
    v_fmac_f32_dpp v14, v6, v126 row_newbcast:5 row_mask:0xf bank_mask:0xf
    v_fmac_f32_dpp v15, v6, v127 row_newbcast:5 row_mask:0xf bank_mask:0xf
    v_cvt_f32_i32 v128, v128
    v_cvt_f32_i32 v129, v129
    v_cvt_f32_i32 v130, v130
    v_cvt_f32_i32 v131, v131
    v_fmac_f32_dpp v16, v6, v128 row_newbcast:5 row_mask:0xf bank_mask:0xf
    v_fmac_f32_dpp v17, v6, v129 row_newbcast:5 row_mask:0xf bank_mask:0xf
    v_fmac_f32_dpp v18, v6, v130 row_newbcast:5 row_mask:0xf bank_mask:0xf
    v_fmac_f32_dpp v19, v6, v131 row_newbcast:5 row_mask:0xf bank_mask:0xf
    v_cvt_f32_i32 v132, v132
    v_cvt_f32_i32 v133, v133
    v_cvt_f32_i32 v134, v134
    v_cvt_f32_i32 v135, v135
    v_fmac_f32_dpp v20, v6, v132 row_newbcast:5 row_mask:0xf bank_mask:0xf
    v_fmac_f32_dpp v21, v6, v133 row_newbcast:5 row_mask:0xf bank_mask:0xf
    v_fmac_f32_dpp v22, v6, v134 row_newbcast:5 row_mask:0xf bank_mask:0xf
    v_fmac_f32_dpp v23, v6, v135 row_newbcast:5 row_mask:0xf bank_mask:0xf
    s_waitcnt lgkmcnt(0)
    v_mov_b32 v6, v7
    s_branch L_vchk
L_el0:
    s_nop 1
    v_mov_b32 v11, 1
    s_mov_b64 exec, 1
    ds_add_u32 v53, v11 offset:136
    s_mov_b64 exec, -1
    s_branch L_el0r
L_el1:
    s_nop 1
    v_mov_b32 v11, 1
    s_mov_b64 exec, 1
    ds_add_u32 v53, v11 offset:136
    s_mov_b64 exec, -1
    s_branch L_el1r
L_el2:
    s_nop 1
    v_mov_b32 v11, 1
    s_mov_b64 exec, 1
    ds_add_u32 v53, v11 offset:136
    s_mov_b64 exec, -1
    s_branch L_el2r
L_evK:
    s_nop 1
    s_bitcmp1_b64 s[64:65], s30
    s_cbranch_scc0 L_paK
    s_memrealtime s[60:61]
    s_mov_b32 s72, s59
    v_mov_b32 v11, 1
    s_mov_b64 exec, 1
    ds_add_u32 v53, v11 offset:128
    s_mov_b64 exec, -1
L_paK:
    s_nop 1
    s_bitcmp1_b64 s[66:67], s30
    s_cbranch_scc0 L_pbK
    v_mov_b32 v11, 1
    s_mov_b64 exec, 1
    ds_add_u32 v53, v11 offset:128
    s_mov_b64 exec, -1
L_pbK:
    s_nop 1
    s_bitcmp1_b64 s[68:69], s30
    s_cbranch_scc0 L_pcK
    v_mov_b32 v11, s62
    ds_read_b32 v10, v11
    v_mov_b32 v11, 1
    s_mov_b64 exec, 1
    ds_add_u32 v53, v11 offset:128
    s_mov_b64 exec, -1
    s_add_u32 s62, s62, 4
    s_waitcnt lgkmcnt(0)
    v_readfirstlane_b32 s32, v10
    s_cmp_eq_u32 s32, 0
    s_cbranch_scc1 L_pcK
    s_sub_u32 s32, s60, s32
    s_max_i32 s32, s32, -4096
    s_min_i32 s32, s32, 4096
    s_mul_i32 s32, s32, 8
    s_add_u32 s32, s32, 512
    s_ashr_i32 s32, s32, 10
    s_sub_u32 s32, s32, s72
    s_add_u32 s32, s32, s59
    s_max_i32 s32, s32, 0
    s_min_i32 s59, s32, 6
L_pcK:
    s_nop 1
    s_bitcmp1_b64 s[70:71], s30
    s_cbranch_scc0 L_evretK
    s_and_b32 s32, s30, 15
    s_cbranch_scc0 L_evK2
    s_cmp_eq_u32 s30, 4
    s_cbranch_scc1 L_evK2
    s_lshr_b32 s33, s30, 2
    s_andn2_b32 s33, s33, 3
    s_add_u32 s33, s33, 36
    s_cmp_eq_u32 s32, 1
    s_cselect_b32 s32, s33, 60
    s_cselect_b32 s33, 5376, 0
    v_add_u32 v4, s33, v4
    s_cmp_eq_u32 s30, 3
    s_cselect_b32 s32, 56, s32
    v_mov_b32 v10, s32
    v_mov_b32 v11, 1
    s_mov_b64 exec, 1
    ds_add_u32 v10, v11 offset:0
    s_mov_b64 exec, -1
    s_branch L_evretK
L_evK2:
    s_nop 1
    s_cmp_eq_u32 s30, 16
    s_cbranch_scc0 L_gxtk16
    s_memrealtime s[36:37]
    s_mov_b32 s6, 0x100000
L_wgtk16:
    s_nop 1
    ds_read_b32 v10, v53 offset:208
    s_sub_u32 s6, s6, 1
    s_cbranch_scc1 L_exit1
    s_waitcnt lgkmcnt(0)
    v_readfirstlane_b32 s32, v10
    s_cmp_eq_u32 s32, 0
    s_cbranch_scc1 L_wgtk16
    s_and_b32 s32, s32, 0xffff
    s_cbranch_scc0 L_gxtk16
    s_add_u32 s32, s32, s36
L_gltk16:
    s_nop 1
    s_memrealtime s[36:37]
    s_waitcnt lgkmcnt(0)
    s_sub_u32 s36, s36, s32
    s_cmp_lt_i32 s36, 0
    s_cbranch_scc1 L_gltk16
L_gxtk16:
    s_nop 1
    s_cmp_eq_u32 s30, 32
    s_cbranch_scc0 L_gxtk32
    s_memrealtime s[36:37]
    s_mov_b32 s6, 0x100000
L_wgtk32:
    s_nop 1
    ds_read_b32 v10, v53 offset:212
    s_sub_u32 s6, s6, 1
    s_cbranch_scc1 L_exit1
    s_waitcnt lgkmcnt(0)
    v_readfirstlane_b32 s32, v10
    s_cmp_eq_u32 s32, 0
    s_cbranch_scc1 L_wgtk32
    s_and_b32 s32, s32, 0xffff
    s_cbranch_scc0 L_gxtk32
    s_add_u32 s32, s32, s36
L_gltk32:
    s_nop 1
    s_memrealtime s[36:37]
    s_waitcnt lgkmcnt(0)
    s_sub_u32 s36, s36, s32
    s_cmp_lt_i32 s36, 0
    s_cbranch_scc1 L_gltk32
L_gxtk32:
    s_nop 1
    s_lshr_b32 s33, s30, 4
    s_lshl_b32 s34, s33, 2
    v_mov_b32 v11, s34
    s_lshl_b32 s31, s33, 5
    s_add_u32 s31, s31, s3
    s_mul_i32 s31, s31, 171
    s_lshr_b32 s31, s31, 9
    s_mul_i32 s31, s31, 384
    buffer_load_dwordx2 v[36:37], v3, s[20:23], s31 offen offset:0
    buffer_load_dwordx2 v[38:39], v3, s[20:23], s31 offen offset:128
    buffer_load_dwordx2 v[40:41], v3, s[20:23], s31 offen offset:256
    s_mov_b32 s6, 0x100000
L_wtk:
    s_nop 1
    ds_read_b32 v10, v11 offset:0
    s_sub_u32 s6, s6, 1
    s_cbranch_scc1 L_exit1
    s_waitcnt lgkmcnt(0)
    v_readfirstlane_b32 s32, v10
    s_cmp_eq_u32 s32, 0
    s_cbranch_scc1 L_wtk
    s_and_b32 s5, s32, 7
    s_xor_b32 s5, s5, s48
    s_bitcmp1_b32 s32, 3
    s_cselect_b64 vcc, -1, 0
    v_cndmask_b32 v50, v62, v63, vcc
    s_branch L_evretK
L_evV:
    s_nop 1
    s_bitcmp1_b64 s[64:65], s30
    s_cbranch_scc0 L_paV
    s_memrealtime s[60:61]
    s_mov_b32 s72, s59
    v_mov_b32 v11, 1
    s_mov_b64 exec, 1
    ds_add_u32 v53, v11 offset:128
    s_mov_b64 exec, -1
L_paV:
    s_nop 1
    s_bitcmp1_b64 s[66:67], s30
    s_cbranch_scc0 L_pbV
    v_mov_b32 v11, 1
    s_mov_b64 exec, 1
    ds_add_u32 v53, v11 offset:128
    s_mov_b64 exec, -1
L_pbV:
    s_nop 1
    s_bitcmp1_b64 s[68:69], s30
    s_cbranch_scc0 L_pcV
    v_mov_b32 v11, s62
    ds_read_b32 v10, v11
    v_mov_b32 v11, 1
    s_mov_b64 exec, 1
    ds_add_u32 v53, v11 offset:128
    s_mov_b64 exec, -1
    s_add_u32 s62, s62, 4
    s_waitcnt lgkmcnt(0)
    v_readfirstlane_b32 s32, v10
    s_cmp_eq_u32 s32, 0
    s_cbranch_scc1 L_pcV
    s_sub_u32 s32, s60, s32
    s_max_i32 s32, s32, -4096
    s_min_i32 s32, s32, 4096
    s_cmp_eq_u32 s30, 44
    s_cbranch_scc0 L_pd
    s_mul_i32 s32, s32, 9
    s_add_u32 s32, s32, 2048
    s_ashr_i32 s32, s32, 10
    s_max_i32 s32, s32, 0
    s_min_i32 s32, s32, 4
    s_sub_u32 s49, 48, s32
    s_cmp_eq_u32 s49, 48
    s_cselect_b32 s49, 255, s49
    s_mov_b32 s59, 0
    s_branch L_pcV
L_pd:
    s_nop 1
    s_mul_i32 s32, s32, 8
    s_add_u32 s32, s32, 512
    s_ashr_i32 s32, s32, 10
    s_sub_u32 s32, s32, s72
    s_add_u32 s32, s32, s59
    s_max_i32 s32, s32, 0
    s_min_i32 s59, s32, 6
L_pcV:
    s_nop 1
    s_bitcmp1_b64 s[70:71], s30
    s_cbranch_scc0 L_evretV
    s_cmp_eq_u32 s30, 16
    s_cbranch_scc0 L_gxtv264
    s_memrealtime s[36:37]
    s_mov_b32 s6, 0x100000
L_wgtv264:
    s_nop 1
    ds_read_b32 v10, v53 offset:220
    s_sub_u32 s6, s6, 1
    s_cbranch_scc1 L_exit1
    s_waitcnt lgkmcnt(0)
    v_readfirstlane_b32 s32, v10
    s_cmp_eq_u32 s32, 0
    s_cbranch_scc1 L_wgtv264
    s_and_b32 s32, s32, 0xffff
    s_cbranch_scc0 L_gxtv264
    s_add_u32 s32, s32, s36
L_gltv264:
    s_nop 1
    s_memrealtime s[36:37]
    s_waitcnt lgkmcnt(0)
    s_sub_u32 s36, s36, s32
    s_cmp_lt_i32 s36, 0
    s_cbranch_scc1 L_gltv264
L_gxtv264:
    s_nop 1
    s_cmp_eq_u32 s30, 32
    s_cbranch_scc0 L_gxtv280
    s_memrealtime s[36:37]
    s_mov_b32 s6, 0x100000
L_wgtv280:
    s_nop 1
    ds_read_b32 v10, v53 offset:224
    s_sub_u32 s6, s6, 1
    s_cbranch_scc1 L_exit1
    s_waitcnt lgkmcnt(0)
    v_readfirstlane_b32 s32, v10
    s_cmp_eq_u32 s32, 0
    s_cbranch_scc1 L_wgtv280
    s_and_b32 s32, s32, 0xffff
    s_cbranch_scc0 L_gxtv280
    s_add_u32 s32, s32, s36
L_gltv280:
    s_nop 1
    s_memrealtime s[36:37]
    s_waitcnt lgkmcnt(0)
    s_sub_u32 s36, s36, s32
    s_cmp_lt_i32 s36, 0
    s_cbranch_scc1 L_gltv280
L_gxtv280:
    s_nop 1
    s_lshr_b32 s33, s30, 4
    s_lshl_b32 s34, s33, 2
    v_mov_b32 v11, s34
    s_mov_b32 s6, 0x100000
L_wtv2:
    s_nop 1
    ds_read_b32 v10, v11 offset:24
    s_sub_u32 s6, s6, 1
    s_cbranch_scc1 L_exit1
    s_waitcnt lgkmcnt(0)
    v_readfirstlane_b32 s32, v10
    s_cmp_eq_u32 s32, 0
    s_cbranch_scc1 L_wtv2
    s_and_b32 s5, s32, 7
    s_xor_b32 s5, s5, s48
    s_bitcmp1_b32 s32, 3
    s_cselect_b64 vcc, -1, 0
    v_cndmask_b32 v50, v62, v63, vcc
    s_branch L_evretV
L_evKB:
    s_nop 1
    s_bitcmp1_b64 s[64:65], s30
    s_cbranch_scc0 L_paKB
    s_memrealtime s[60:61]
    s_mov_b32 s72, s59
    v_mov_b32 v11, 1
    s_mov_b64 exec, 1
    ds_add_u32 v53, v11 offset:128
    s_mov_b64 exec, -1
L_paKB:
    s_nop 1
    s_bitcmp1_b64 s[66:67], s30
    s_cbranch_scc0 L_pbKB
    v_mov_b32 v11, 1
    s_mov_b64 exec, 1
    ds_add_u32 v53, v11 offset:128
    s_mov_b64 exec, -1
L_pbKB:
    s_nop 1
    s_bitcmp1_b64 s[68:69], s30
    s_cbranch_scc0 L_pcKB
    v_mov_b32 v11, s62
    ds_read_b32 v10, v11
    v_mov_b32 v11, 1
    s_mov_b64 exec, 1
    ds_add_u32 v53, v11 offset:128
    s_mov_b64 exec, -1
    s_add_u32 s62, s62, 4
    s_waitcnt lgkmcnt(0)
    v_readfirstlane_b32 s32, v10
    s_cmp_eq_u32 s32, 0
    s_cbranch_scc1 L_pcKB
    s_sub_u32 s32, s60, s32
    s_max_i32 s32, s32, -4096
    s_min_i32 s32, s32, 4096
    s_mul_i32 s32, s32, 8
    s_add_u32 s32, s32, 512
    s_ashr_i32 s32, s32, 10
    s_sub_u32 s32, s32, s72
    s_add_u32 s32, s32, s59
    s_max_i32 s32, s32, 0
    s_min_i32 s59, s32, 6
L_pcKB:
    s_nop 1
    s_bitcmp1_b64 s[70:71], s30
    s_cbranch_scc0 L_evretKB
    s_and_b32 s32, s30, 15
    s_cbranch_scc0 L_evK2B
    s_cmp_eq_u32 s30, 4
    s_cbranch_scc1 L_evK2B
    s_lshr_b32 s33, s30, 2
    s_andn2_b32 s33, s33, 3
    s_add_u32 s33, s33, 36
    s_cmp_eq_u32 s32, 1
    s_cselect_b32 s32, s33, 60
    s_cselect_b32 s33, 5376, 0
    v_add_u32 v4, s33, v4
    s_cmp_eq_u32 s30, 3
    s_cselect_b32 s32, 56, s32
    v_mov_b32 v10, s32
    v_mov_b32 v11, 1
    s_mov_b64 exec, 1
    ds_add_u32 v10, v11 offset:0
    s_mov_b64 exec, -1
    s_branch L_evretKB
L_evK2B:
    s_nop 1
    s_cmp_eq_u32 s30, 16
    s_cbranch_scc0 L_gxtkB16
    s_memrealtime s[36:37]
    s_mov_b32 s6, 0x100000
L_wgtkB16:
    s_nop 1
    ds_read_b32 v10, v53 offset:208
    s_sub_u32 s6, s6, 1
    s_cbranch_scc1 L_exit1
    s_waitcnt lgkmcnt(0)
    v_readfirstlane_b32 s32, v10
    s_cmp_eq_u32 s32, 0
    s_cbranch_scc1 L_wgtkB16
    s_and_b32 s32, s32, 0xffff
    s_cbranch_scc0 L_gxtkB16
    s_add_u32 s32, s32, s36
L_gltkB16:
    s_nop 1
    s_memrealtime s[36:37]
    s_waitcnt lgkmcnt(0)
    s_sub_u32 s36, s36, s32
    s_cmp_lt_i32 s36, 0
    s_cbranch_scc1 L_gltkB16
L_gxtkB16:
    s_nop 1
    s_cmp_eq_u32 s30, 32
    s_cbranch_scc0 L_gxtkB32
    s_memrealtime s[36:37]
    s_mov_b32 s6, 0x100000
L_wgtkB32:
    s_nop 1
    ds_read_b32 v10, v53 offset:212
    s_sub_u32 s6, s6, 1
    s_cbranch_scc1 L_exit1
    s_waitcnt lgkmcnt(0)
    v_readfirstlane_b32 s32, v10
    s_cmp_eq_u32 s32, 0
    s_cbranch_scc1 L_wgtkB32
    s_and_b32 s32, s32, 0xffff
    s_cbranch_scc0 L_gxtkB32
    s_add_u32 s32, s32, s36
L_gltkB32:
    s_nop 1
    s_memrealtime s[36:37]
    s_waitcnt lgkmcnt(0)
    s_sub_u32 s36, s36, s32
    s_cmp_lt_i32 s36, 0
    s_cbranch_scc1 L_gltkB32
L_gxtkB32:
    s_nop 1
    s_lshr_b32 s33, s30, 4
    s_lshl_b32 s34, s33, 2
    v_mov_b32 v11, s34
    s_lshl_b32 s31, s33, 5
    s_add_u32 s31, s31, s3
    s_mul_i32 s31, s31, 171
    s_lshr_b32 s31, s31, 9
    s_mul_i32 s31, s31, 384
    buffer_load_dwordx2 v[36:37], v3, s[20:23], s31 offen offset:0
    buffer_load_dwordx2 v[38:39], v3, s[20:23], s31 offen offset:128
    buffer_load_dwordx2 v[40:41], v3, s[20:23], s31 offen offset:256
    s_mov_b32 s6, 0x100000
L_wtkB:
    s_nop 1
    ds_read_b32 v10, v11 offset:0
    s_sub_u32 s6, s6, 1
    s_cbranch_scc1 L_exit1
    s_waitcnt lgkmcnt(0)
    v_readfirstlane_b32 s32, v10
    s_cmp_eq_u32 s32, 0
    s_cbranch_scc1 L_wtkB
    s_and_b32 s5, s32, 7
    s_xor_b32 s5, s5, s48
    s_bitcmp1_b32 s32, 3
    s_cselect_b64 vcc, -1, 0
    v_cndmask_b32 v50, v62, v63, vcc
    s_branch L_evretKB
L_evVB:
    s_nop 1
    s_bitcmp1_b64 s[64:65], s30
    s_cbranch_scc0 L_paVB
    s_memrealtime s[60:61]
    s_mov_b32 s72, s59
    v_mov_b32 v11, 1
    s_mov_b64 exec, 1
    ds_add_u32 v53, v11 offset:128
    s_mov_b64 exec, -1
L_paVB:
    s_nop 1
    s_bitcmp1_b64 s[66:67], s30
    s_cbranch_scc0 L_pbVB
    v_mov_b32 v11, 1
    s_mov_b64 exec, 1
    ds_add_u32 v53, v11 offset:128
    s_mov_b64 exec, -1
L_pbVB:
    s_nop 1
    s_bitcmp1_b64 s[68:69], s30
    s_cbranch_scc0 L_pcVB
    v_mov_b32 v11, s62
    ds_read_b32 v10, v11
    v_mov_b32 v11, 1
    s_mov_b64 exec, 1
    ds_add_u32 v53, v11 offset:128
    s_mov_b64 exec, -1
    s_add_u32 s62, s62, 4
    s_waitcnt lgkmcnt(0)
    v_readfirstlane_b32 s32, v10
    s_cmp_eq_u32 s32, 0
    s_cbranch_scc1 L_pcVB
    s_sub_u32 s32, s60, s32
    s_max_i32 s32, s32, -4096
    s_min_i32 s32, s32, 4096
    s_cmp_eq_u32 s30, 44
    s_cbranch_scc0 L_pdB
    s_mul_i32 s32, s32, 9
    s_add_u32 s32, s32, 2048
    s_ashr_i32 s32, s32, 10
    s_max_i32 s32, s32, 0
    s_min_i32 s32, s32, 4
    s_sub_u32 s49, 48, s32
    s_cmp_eq_u32 s49, 48
    s_cselect_b32 s49, 255, s49
    s_mov_b32 s59, 0
    s_branch L_pcVB
L_pdB:
    s_nop 1
    s_mul_i32 s32, s32, 8
    s_add_u32 s32, s32, 512
    s_ashr_i32 s32, s32, 10
    s_sub_u32 s32, s32, s72
    s_add_u32 s32, s32, s59
    s_max_i32 s32, s32, 0
    s_min_i32 s59, s32, 6
L_pcVB:
    s_nop 1
    s_bitcmp1_b64 s[70:71], s30
    s_cbranch_scc0 L_evretVB
    s_cmp_eq_u32 s30, 16
    s_cbranch_scc0 L_gxtv2B64
    s_memrealtime s[36:37]
    s_mov_b32 s6, 0x100000
L_wgtv2B64:
    s_nop 1
    ds_read_b32 v10, v53 offset:220
    s_sub_u32 s6, s6, 1
    s_cbranch_scc1 L_exit1
    s_waitcnt lgkmcnt(0)
    v_readfirstlane_b32 s32, v10
    s_cmp_eq_u32 s32, 0
    s_cbranch_scc1 L_wgtv2B64
    s_and_b32 s32, s32, 0xffff
    s_cbranch_scc0 L_gxtv2B64
    s_add_u32 s32, s32, s36
L_gltv2B64:
    s_nop 1
    s_memrealtime s[36:37]
    s_waitcnt lgkmcnt(0)
    s_sub_u32 s36, s36, s32
    s_cmp_lt_i32 s36, 0
    s_cbranch_scc1 L_gltv2B64
L_gxtv2B64:
    s_nop 1
    s_cmp_eq_u32 s30, 32
    s_cbranch_scc0 L_gxtv2B80
    s_memrealtime s[36:37]
    s_mov_b32 s6, 0x100000
L_wgtv2B80:
    s_nop 1
    ds_read_b32 v10, v53 offset:224
    s_sub_u32 s6, s6, 1
    s_cbranch_scc1 L_exit1
    s_waitcnt lgkmcnt(0)
    v_readfirstlane_b32 s32, v10
    s_cmp_eq_u32 s32, 0
    s_cbranch_scc1 L_wgtv2B80
    s_and_b32 s32, s32, 0xffff
    s_cbranch_scc0 L_gxtv2B80
    s_add_u32 s32, s32, s36
L_gltv2B80:
    s_nop 1
    s_memrealtime s[36:37]
    s_waitcnt lgkmcnt(0)
    s_sub_u32 s36, s36, s32
    s_cmp_lt_i32 s36, 0
    s_cbranch_scc1 L_gltv2B80
L_gxtv2B80:
    s_nop 1
    s_lshr_b32 s33, s30, 4
    s_lshl_b32 s34, s33, 2
    v_mov_b32 v11, s34
    s_mov_b32 s6, 0x100000
L_wtv2B:
    s_nop 1
    ds_read_b32 v10, v11 offset:24
    s_sub_u32 s6, s6, 1
    s_cbranch_scc1 L_exit1
    s_waitcnt lgkmcnt(0)
    v_readfirstlane_b32 s32, v10
    s_cmp_eq_u32 s32, 0
    s_cbranch_scc1 L_wtv2B
    s_and_b32 s5, s32, 7
    s_xor_b32 s5, s5, s48
    s_bitcmp1_b32 s32, 3
    s_cselect_b64 vcc, -1, 0
    v_cndmask_b32 v50, v62, v63, vcc
    s_branch L_evretVB
L_helper:
    s_nop 1
    s_sub_u32 s6, s28, 4
    s_mov_b32 s5, s48
    v_mov_b32 v1, v11
    v_mov_b32 v2, 0
    s_mul_i32 s59, s3, 34816
    s_add_u32 s59, s59, 8388608
    s_cmp_eq_u32 s6, 3
    s_cbranch_scc1 L_h3
    s_mul_i32 s48, s6, 10
    s_sub_u32 s48, s48, 7
    s_cmp_lt_i32 s3, s48
    s_cselect_b32 s90, 1, 0
    s_cbranch_scc0 L_noprobe1
    s_max_u32 s7, s3, 1
    s_sub_u32 s7, s7, 1
    s_lshr_b32 s7, s7, 1
    s_lshl_b32 s49, s3, 1
    s_add_u32 s49, s49, s6
    s_sub_u32 s49, s49, 1
    s_bitcmp1_b32 s3, 0
    s_cselect_b32 s48, 1, 4
    s_cmp_eq_u32 s7, 0
    s_cselect_b32 s49, s49, s48
    s_and_b32 s48, s49, 1
    s_mul_i32 s20, s49, 20
    s_add_u32 s20, s20, s48
    s_add_u32 s20, s20, 2
    s_lshl_b32 s20, s20, 21
    s_xor_b32 s21, s4, s6
    s_and_b32 s21, s21, 1
    s_lshr_b32 s49, s4, 2
    s_xor_b32 s48, s48, s49
    s_xor_b32 s48, s48, s21
    s_lshl_b32 s48, s48, 13
    s_lshl_b32 s49, s6, 14
    s_and_b32 s49, s49, 0x4000
    s_or_b32 s48, s48, s49
    s_xor_b32 s32, s48, 0x0
    s_xor_b32 s33, s48, 0x2000
    s_xor_b32 s34, s48, 0x1000
    s_xor_b32 s35, s48, 0x3000
    s_xor_b32 s36, s48, 0x4000
    s_xor_b32 s37, s48, 0x6000
    s_xor_b32 s38, s48, 0x5000
    s_xor_b32 s39, s48, 0x7000
    v_and_b32 v3, 7, v1
    v_lshlrev_b32 v3, 12, v3
    s_lshl_b32 s48, s4, 8
    v_add_u32 v3, s48, v3
    s_mov_b32 s10, 805306368
    s_mov_b32 s11, 0x00020000
    s_cmp_ge_u32 s7, 3
    s_cselect_b32 s48, 3, 0
    s_sub_u32 s48, s7, s48
    s_lshl_b32 s48, s48, 28
    s_add_u32 s20, s20, s48
    s_cmp_ge_u32 s7, 3
    s_waitcnt lgkmcnt(0)
    s_cselect_b32 s8, s68, s66
    s_cselect_b32 s23, s69, s67
    s_and_b32 s9, s23, 0xffff
    s_mov_b64 exec, 0xff
    buffer_load_dword v4, v3, s[8:11], s20 offen
    s_mov_b64 exec, -1
    s_add_u32 s22, s8, s20
    s_addc_u32 s23, s23, 0
    s_lshl_b32 s48, s4, 8
    s_add_u32 s48, s48, 128
    s_load_dword s45, s[22:23], s48
L_noprobe1:
    s_nop 1
    s_waitcnt lgkmcnt(0)
    s_mov_b32 s12, s82
    s_and_b32 s13, s83, 0xffff
    s_mov_b32 s14, 10485760
    s_mov_b32 s15, 0x00020000
    s_mov_b32 s16, s80
    s_and_b32 s17, s81, 0xffff
    s_mov_b32 s18, 256
    s_mov_b32 s19, 0x00020000
    s_cmp_lg_u32 s6, 0
    s_cbranch_scc1 L_hbar
    v_lshlrev_b32 v5, 2, v1
    ds_write_b32 v5, v2
    s_waitcnt lgkmcnt(0)
L_hbar:
    s_nop 1
    s_barrier
    s_cmp_eq_u32 s90, 0
    s_cbranch_scc1 L_role
    s_mov_b32 s46, 1
    s_mov_b32 s58, 0
    s_cmp_eq_u32 s7, 0
    s_cselect_b32 s47, 1, 3
    s_waitcnt vmcnt(0)
L_round:
    s_nop 1
    s_add_u32 s48, s4, s46
    s_and_b32 s48, s48, 7
    s_lshl_b32 s48, s48, 8
    s_add_u32 s56, s22, s48
    s_addc_u32 s57, s23, 0
    s_mov_b32 s44, -1
    s_memtime s[40:41]
    s_waitcnt lgkmcnt(0)
    s_load_dword s45, s[56:57], s32
    s_waitcnt lgkmcnt(0)
    s_memtime s[42:43]
    s_waitcnt lgkmcnt(0)
    s_sub_u32 s24, s42, s40
    s_load_dword s45, s[56:57], s33
    s_waitcnt lgkmcnt(0)
    s_memtime s[40:41]
    s_waitcnt lgkmcnt(0)
    s_sub_u32 s25, s40, s42
    s_load_dword s45, s[56:57], s34
    s_waitcnt lgkmcnt(0)
    s_memtime s[42:43]
    s_waitcnt lgkmcnt(0)
    s_sub_u32 s26, s42, s40
    s_load_dword s45, s[56:57], s35
    s_waitcnt lgkmcnt(0)
    s_memtime s[40:41]
    s_waitcnt lgkmcnt(0)
    s_sub_u32 s27, s40, s42
    s_load_dword s45, s[56:57], s36
    s_waitcnt lgkmcnt(0)
    s_memtime s[42:43]
    s_waitcnt lgkmcnt(0)
    s_sub_u32 s28, s42, s40
    s_load_dword s45, s[56:57], s37
    s_waitcnt lgkmcnt(0)
    s_memtime s[40:41]
    s_waitcnt lgkmcnt(0)
    s_sub_u32 s29, s40, s42
    s_load_dword s45, s[56:57], s38
    s_waitcnt lgkmcnt(0)
    s_memtime s[42:43]
    s_waitcnt lgkmcnt(0)
    s_sub_u32 s30, s42, s40
    s_load_dword s45, s[56:57], s39
    s_waitcnt lgkmcnt(0)
    s_memtime s[40:41]
    s_waitcnt lgkmcnt(0)
    s_sub_u32 s31, s40, s42
L_few:
    s_nop 1
    s_min_u32 s24, s24, 1400
    s_min_u32 s44, s44, s24
    s_min_u32 s25, s25, 1400
    s_min_u32 s44, s44, s25
    s_min_u32 s26, s26, 1400
    s_min_u32 s44, s44, s26
    s_min_u32 s27, s27, 1400
    s_min_u32 s44, s44, s27
    s_min_u32 s28, s28, 1400
    s_min_u32 s44, s44, s28
    s_min_u32 s29, s29, 1400
    s_min_u32 s44, s44, s29
    s_min_u32 s30, s30, 1400
    s_min_u32 s44, s44, s30
    s_min_u32 s31, s31, 1400
    s_min_u32 s44, s44, s31
    s_cmp_lt_u32 s44, 290
    s_cbranch_scc1 L_skip
    s_sub_u32 s58, s58, s24
    s_add_u32 s58, s58, s25
    s_sub_u32 s58, s58, s26
    s_add_u32 s58, s58, s27
    s_sub_u32 s58, s58, s28
    s_add_u32 s58, s58, s29
    s_sub_u32 s58, s58, s30
    s_add_u32 s58, s58, s31
L_skip:
    s_nop 1
    s_add_u32 s46, s46, 1
    s_cmp_le_u32 s46, s47
    s_cbranch_scc1 L_round
    s_sub_u32 s48, 0, s58
    s_cmp_eq_u32 s21, 0
    s_cselect_b32 s58, s58, s48
    s_add_u32 s58, s58, 0x1010000
    v_mov_b32 v4, s58
    s_mov_b64 exec, 1
    s_lshl_b32 s48, s7, 2
    s_add_u32 s48, s48, 124
    s_cmp_eq_u32 s7, 0
    s_cbranch_scc0 L_post
    ds_add_rtn_u32 v5, v2, v4 offset:36
    s_mov_b32 s48, 0
    s_waitcnt lgkmcnt(0)
    v_add_u32 v4, v4, v5
    v_cmp_ne_u32 vcc, 0, v5
    s_and_b64 exec, exec, vcc
    buffer_atomic_add v4, off, s[16:19], s48
    s_branch L_posted
L_post:
    s_nop 1
    s_mov_b32 s60, 0x100000
L_wvw:
    s_nop 1
    ds_read_b32 v10, v2 offset:0
    s_sub_u32 s60, s60, 1
    s_cbranch_scc1 L_exit1
    s_waitcnt lgkmcnt(0)
    v_readfirstlane_b32 s48, v10
    s_cmp_eq_u32 s48, 0
    s_cbranch_scc1 L_wvw
    s_mul_i32 s48, s3, 4352
    s_add_u32 s48, s48, 9489664
    s_nop 0
    buffer_atomic_add v4, off, s[12:15], s48
L_posted:
    s_nop 1
    s_mov_b64 exec, -1
L_role:
    s_nop 1
    s_cmp_eq_u32 s6, 0
    s_cbranch_scc1 L_h0
    s_cmp_eq_u32 s6, 2
    s_cbranch_scc1 L_h2
    s_cmp_lg_u32 s2, 255
    s_cbranch_scc1 L_nolead
    v_mul_u32_u24 v5, 4352, v1
    v_mov_b32 v3, 0
    s_mov_b32 s48, 8388608
    buffer_store_dwordx2 v[2:3], v5, s[12:15], s48 offen sc1
    s_mov_b32 s49, 8667136
    buffer_store_dwordx2 v[2:3], v5, s[12:15], s49 offen sc1
    s_mov_b32 s50, 8945664
    buffer_store_dwordx2 v[2:3], v5, s[12:15], s50 offen sc1
    s_mov_b32 s51, 9224192
    buffer_store_dwordx2 v[2:3], v5, s[12:15], s51 offen sc1
    s_mov_b32 s52, 9502720
    s_mov_b64 exec, 0x1fffff
    buffer_store_dwordx2 v[2:3], v5, s[12:15], s52 offen sc1
    v_mov_b32 v4, 0x1010000
    s_mov_b64 exec, 1
    s_waitcnt vmcnt(0)
    buffer_atomic_add v4, off, s[16:19], 0
    s_mov_b64 exec, -1
L_nolead:
    s_nop 1
    v_lshlrev_b32 v5, 2, v1
    s_mov_b32 s60, 0x100000
L_wea:
    s_nop 1
    ds_read_b32 v10, v2 offset:56
    s_sub_u32 s60, s60, 1
    s_cbranch_scc1 L_exit1
    s_waitcnt lgkmcnt(0)
    v_readfirstlane_b32 s48, v10
    s_cmp_lt_u32 s48, 1
    s_cbranch_scc1 L_wea
    s_mov_b64 exec, 0x1
    s_mov_b32 s60, 0x40000
L_polla:
    s_nop 1
    buffer_load_dword v4, v5, s[16:19], 0 offen offset:0 sc1
    s_sub_u32 s60, s60, 1
    s_cbranch_scc1 L_exit1
L_pollwa:
    s_waitcnt vmcnt(0)
    v_lshrrev_b32 v6, 24, v4
    v_cmp_ne_u32 vcc, 49, v6
    s_cbranch_vccnz L_polla
    v_and_b32 v4, 0xffffff, v4
    v_subrev_u32 v4, 3211264, v4
    v_lshrrev_b32 v6, 30, v4
    v_and_b32 v6, 2, v6
    v_add_u32 v4, 9800, v4
    v_cmp_gt_u32 vcc, 19600, v4
    s_nop 1
    v_cndmask_b32 v6, v6, 8, vcc
    v_or_b32 v6, 16, v6
    ds_write_b32 v5, v6 offset:0
    s_mov_b64 exec, -1
    s_mov_b32 s60, 0x100000
L_web:
    s_nop 1
    ds_read_b32 v10, v2 offset:60
    s_sub_u32 s60, s60, 1
    s_cbranch_scc1 L_exit1
    s_waitcnt lgkmcnt(0)
    v_readfirstlane_b32 s48, v10
    s_cmp_eq_u32 s48, 0
    s_cbranch_scc1 L_web
    v_mul_u32_u24 v7, 4352, v1
    s_mov_b32 s48, 9502720
    v_lshrrev_b32 v5, 1, v5
    s_mov_b64 exec, 0x3ff
    s_mov_b32 s60, 0x40000
L_pollb:
    s_nop 1
    buffer_load_dword v4, v7, s[12:15], s48 offen sc1
    s_sub_u32 s60, s60, 1
    s_cbranch_scc1 L_exit1
L_pollwb:
    s_waitcnt vmcnt(0)
    v_lshrrev_b32 v6, 24, v4
    v_cmp_ne_u32 vcc, 8, v6
    s_cbranch_vccnz L_pollb
    v_add_u32_dpp v4, v4, v4 quad_perm:[1,0,3,2] row_mask:0xf bank_mask:0xf
    s_mov_b64 exec, 0x155
    v_and_b32 v4, 0xffffff, v4
    v_subrev_u32 v4, 1048576, v4
    v_lshrrev_b32 v6, 30, v4
    v_and_b32 v6, 2, v6
    v_add_u32 v4, 9600, v4
    v_cmp_gt_u32 vcc, 19200, v4
    s_nop 1
    v_cndmask_b32 v6, v6, 8, vcc
    v_or_b32 v6, 16, v6
    ds_write_b32 v5, v6 offset:4
    s_mov_b64 exec, -1
    s_and_b32 s48, s3, 7
    s_cmp_lg_u32 s48, s4
    s_cbranch_scc1 L_exit1
    s_mul_i32 s48, s3, 3
    s_add_u32 s48, s48, 2
    s_lshr_b32 s48, s48, 5
    s_lshl_b32 s48, s48, 2
    v_mov_b32 v3, s48
    s_mul_i32 s57, s3, 24
    v_add_u32 v13, s57, v1
    v_and_b32 v12, 255, v13
    v_mul_u32_u24 v12, 4352, v12
    v_lshlrev_b32 v13, 6, v13
    s_mov_b32 s49, 8388608
    s_mov_b32 s50, 917504
    v_mov_b32 v4, 0xf149f2ca
    v_mov_b32 v5, 0
    s_mov_b32 s60, 0x100000
L_wcg:
    s_nop 1
    ds_read_b32 v10, v3 offset:24
    s_sub_u32 s60, s60, 1
    s_cbranch_scc1 L_exit1
    s_waitcnt lgkmcnt(0)
    v_readfirstlane_b32 s48, v10
    s_cmp_eq_u32 s48, 0
    s_cbranch_scc1 L_wcg
    s_mov_b64 exec, 0xffffff
    s_mov_b32 s60, 0x40000
L_cpf:
    s_nop 1
    buffer_load_dword v7, v12, s[12:15], s49 offen sc1
    s_sub_u32 s60, s60, 1
    s_cbranch_scc1 L_exit1
    s_waitcnt vmcnt(0)
    v_cmpx_eq_u32 vcc, 0, v7
    s_cbranch_execnz L_cpf
    s_mov_b64 exec, 0xffffff
    s_mov_b32 s60, 0x40000
L_cpm:
    s_nop 1
    buffer_load_dwordx4 v[4:7], v13, s[12:15], s50 offen sc1
    s_sub_u32 s60, s60, 1
    s_cbranch_scc1 L_exit1
    s_waitcnt vmcnt(0)
    v_cmpx_eq_u32 vcc, 0, v7
    s_cbranch_execnz L_cpm
    s_mov_b64 exec, -1
    v_mov_b32 v6, v4
    s_nop 1
    v_max_f32_dpp v6, v6, v6 row_ror:8 row_mask:0xf bank_mask:0xf
    s_nop 1
    v_max_f32_dpp v6, v6, v6 row_ror:4 row_mask:0xf bank_mask:0xf
    s_nop 1
    v_max_f32_dpp v6, v6, v6 row_ror:2 row_mask:0xf bank_mask:0xf
    s_nop 1
    v_max_f32_dpp v6, v6, v6 row_ror:1 row_mask:0xf bank_mask:0xf
    v_mov_b32 v7, v6
    s_nop 1
    v_permlane32_swap_b32 v6, v7
    v_max_f32 v6, v6, v7
    v_mov_b32 v7, v6
    s_nop 1
    v_permlane16_swap_b32 v6, v7
    v_max_f32 v6, v6, v7
    v_sub_f32 v4, v4, v6
    v_exp_f32 v4, v4
    s_nop 0
    v_mul_f32 v5, v5, v4
    s_nop 1
    v_add_f32_dpp v5, v5, v5 row_ror:8 row_mask:0xf bank_mask:0xf
    s_nop 1
    v_add_f32_dpp v5, v5, v5 row_ror:4 row_mask:0xf bank_mask:0xf
    s_nop 1
    v_add_f32_dpp v5, v5, v5 row_ror:2 row_mask:0xf bank_mask:0xf
    s_nop 1
    v_add_f32_dpp v5, v5, v5 row_ror:1 row_mask:0xf bank_mask:0xf
    v_mov_b32 v7, v5
    s_nop 1
    v_permlane32_swap_b32 v5, v7
    v_add_f32 v5, v5, v7
    v_mov_b32 v7, v5
    s_nop 1
    v_permlane16_swap_b32 v5, v7
    v_add_f32 v5, v5, v7
    v_rcp_f32 v5, v5
    s_nop 0
    v_mul_f32 v4, v4, v5
    s_cmp_lt_u32 s3, 21
    s_cbranch_scc1 L_cown
    s_mul_i32 s48, s3, 4352
    s_add_u32 s48, s48, 9454848
    v_lshlrev_b32 v12, 2, v1
    v_mov_b32 v5, 1
    s_mov_b64 exec, 0xffffff
    buffer_store_dword v4, v12, s[12:15], s48 offen offset:128 sc1
    s_mov_b64 exec, 1
    s_waitcnt vmcnt(0)
    buffer_store_dword v5, off, s[12:15], s48 offset:4 sc1
    s_endpgm
L_cown:
    s_nop 1
    v_readlane_b32 s24, v4, 0
    v_readlane_b32 s25, v4, 1
    v_readlane_b32 s26, v4, 2
    v_readlane_b32 s27, v4, 3
    v_readlane_b32 s28, v4, 4
    v_readlane_b32 s29, v4, 5
    v_readlane_b32 s30, v4, 6
    v_readlane_b32 s31, v4, 7
    v_readlane_b32 s32, v4, 8
    v_readlane_b32 s33, v4, 9
    v_readlane_b32 s34, v4, 10
    v_readlane_b32 s35, v4, 11
    v_readlane_b32 s36, v4, 12
    v_readlane_b32 s37, v4, 13
    v_readlane_b32 s38, v4, 14
    v_readlane_b32 s39, v4, 15
    v_readlane_b32 s40, v4, 16
    v_readlane_b32 s41, v4, 17
    v_readlane_b32 s42, v4, 18
    v_readlane_b32 s43, v4, 19
    v_readlane_b32 s44, v4, 20
    v_readlane_b32 s45, v4, 21
    v_readlane_b32 s46, v4, 22
    v_readlane_b32 s47, v4, 23
    s_mov_b32 s92, s78
    s_and_b32 s93, s79, 0xffff
    s_mov_b32 s94, 12288
    s_mov_b32 s95, 0x00020000
    s_lshl_b32 s57, s57, 10
    v_lshlrev_b32 v13, 4, v1
    v_add_u32 v13, s57, v13
    s_mov_b32 s49, 4096
    s_mov_b32 s50, 8192
    s_mov_b32 s51, 12288
    s_mov_b32 s52, 16384
    s_mov_b32 s53, 20480
    v_mov_b32 v4, 0
    v_mov_b32 v5, 0
    v_mov_b32 v6, 0
    s_mov_b32 s56, 0xffffff
    v_lshlrev_b32 v12, 1, v1
    s_mul_i32 s57, s3, 384
    s_mov_b32 s60, 0x100000
L_wcc:
    s_nop 1
    ds_read_b32 v10, v3 offset:64
    s_sub_u32 s60, s60, 1
    s_cbranch_scc1 L_exit1
    s_waitcnt lgkmcnt(0)
    v_readfirstlane_b32 s48, v10
    s_cmp_lt_u32 s48, 1
    s_cbranch_scc1 L_wcc
    s_mov_b32 s60, 0x40000
L_cr:
    s_nop 1
    s_bitcmp0_b32 s56, 0
    s_cbranch_scc1 L_cl0
    buffer_load_dwordx4 v[16:19], v13, s[12:15], 0 offen offset:0 sc1
L_cl0:
    s_bitcmp0_b32 s56, 1
    s_cbranch_scc1 L_cl1
    buffer_load_dwordx4 v[20:23], v13, s[12:15], 0 offen offset:1024 sc1
L_cl1:
    s_bitcmp0_b32 s56, 2
    s_cbranch_scc1 L_cl2
    buffer_load_dwordx4 v[24:27], v13, s[12:15], 0 offen offset:2048 sc1
L_cl2:
    s_bitcmp0_b32 s56, 3
    s_cbranch_scc1 L_cl3
    buffer_load_dwordx4 v[28:31], v13, s[12:15], 0 offen offset:3072 sc1
L_cl3:
    s_bitcmp0_b32 s56, 4
    s_cbranch_scc1 L_cl4
    buffer_load_dwordx4 v[32:35], v13, s[12:15], s49 offen offset:0 sc1
L_cl4:
    s_bitcmp0_b32 s56, 5
    s_cbranch_scc1 L_cl5
    buffer_load_dwordx4 v[36:39], v13, s[12:15], s49 offen offset:1024 sc1
L_cl5:
    s_bitcmp0_b32 s56, 6
    s_cbranch_scc1 L_cl6
    buffer_load_dwordx4 v[40:43], v13, s[12:15], s49 offen offset:2048 sc1
L_cl6:
    s_bitcmp0_b32 s56, 7
    s_cbranch_scc1 L_cl7
    buffer_load_dwordx4 v[44:47], v13, s[12:15], s49 offen offset:3072 sc1
L_cl7:
    s_bitcmp0_b32 s56, 8
    s_cbranch_scc1 L_cl8
    buffer_load_dwordx4 v[48:51], v13, s[12:15], s50 offen offset:0 sc1
L_cl8:
    s_bitcmp0_b32 s56, 9
    s_cbranch_scc1 L_cl9
    buffer_load_dwordx4 v[52:55], v13, s[12:15], s50 offen offset:1024 sc1
L_cl9:
    s_bitcmp0_b32 s56, 10
    s_cbranch_scc1 L_cl10
    buffer_load_dwordx4 v[56:59], v13, s[12:15], s50 offen offset:2048 sc1
L_cl10:
    s_bitcmp0_b32 s56, 11
    s_cbranch_scc1 L_cl11
    buffer_load_dwordx4 v[60:63], v13, s[12:15], s50 offen offset:3072 sc1
L_cl11:
    s_bitcmp0_b32 s56, 12
    s_cbranch_scc1 L_cl12
    buffer_load_dwordx4 v[64:67], v13, s[12:15], s51 offen offset:0 sc1
L_cl12:
    s_bitcmp0_b32 s56, 13
    s_cbranch_scc1 L_cl13
    buffer_load_dwordx4 v[68:71], v13, s[12:15], s51 offen offset:1024 sc1
L_cl13:
    s_bitcmp0_b32 s56, 14
    s_cbranch_scc1 L_cl14
    buffer_load_dwordx4 v[72:75], v13, s[12:15], s51 offen offset:2048 sc1
L_cl14:
    s_bitcmp0_b32 s56, 15
    s_cbranch_scc1 L_cl15
    buffer_load_dwordx4 v[76:79], v13, s[12:15], s51 offen offset:3072 sc1
L_cl15:
    s_bitcmp0_b32 s56, 16
    s_cbranch_scc1 L_cl16
    buffer_load_dwordx4 v[80:83], v13, s[12:15], s52 offen offset:0 sc1
L_cl16:
    s_bitcmp0_b32 s56, 17
    s_cbranch_scc1 L_cl17
    buffer_load_dwordx4 v[84:87], v13, s[12:15], s52 offen offset:1024 sc1
L_cl17:
    s_bitcmp0_b32 s56, 18
    s_cbranch_scc1 L_cl18
    buffer_load_dwordx4 v[88:91], v13, s[12:15], s52 offen offset:2048 sc1
L_cl18:
    s_bitcmp0_b32 s56, 19
    s_cbranch_scc1 L_cl19
    buffer_load_dwordx4 v[92:95], v13, s[12:15], s52 offen offset:3072 sc1
L_cl19:
    s_bitcmp0_b32 s56, 20
    s_cbranch_scc1 L_cl20
    buffer_load_dwordx4 v[96:99], v13, s[12:15], s53 offen offset:0 sc1
L_cl20:
    s_bitcmp0_b32 s56, 21
    s_cbranch_scc1 L_cl21
    buffer_load_dwordx4 v[100:103], v13, s[12:15], s53 offen offset:1024 sc1
L_cl21:
    s_bitcmp0_b32 s56, 22
    s_cbranch_scc1 L_cl22
    buffer_load_dwordx4 v[104:107], v13, s[12:15], s53 offen offset:2048 sc1
L_cl22:
    s_bitcmp0_b32 s56, 23
    s_cbranch_scc1 L_cl23
    buffer_load_dwordx4 v[108:111], v13, s[12:15], s53 offen offset:3072 sc1
L_cl23:
    s_sub_u32 s60, s60, 1
    s_cbranch_scc1 L_exit1
    s_waitcnt vmcnt(0)
    s_bitcmp0_b32 s56, 0
    s_cbranch_scc1 L_cv0
    v_cmp_eq_u32 vcc, 0, v19
    s_cbranch_vccnz L_cv0
    v_fmac_f32 v4, s24, v16
    v_fmac_f32 v5, s24, v17
    v_fmac_f32 v6, s24, v18
    s_bitset0_b32 s56, 0
L_cv0:
    s_bitcmp0_b32 s56, 1
    s_cbranch_scc1 L_cv1
    v_cmp_eq_u32 vcc, 0, v23
    s_cbranch_vccnz L_cv1
    v_fmac_f32 v4, s25, v20
    v_fmac_f32 v5, s25, v21
    v_fmac_f32 v6, s25, v22
    s_bitset0_b32 s56, 1
L_cv1:
    s_bitcmp0_b32 s56, 2
    s_cbranch_scc1 L_cv2
    v_cmp_eq_u32 vcc, 0, v27
    s_cbranch_vccnz L_cv2
    v_fmac_f32 v4, s26, v24
    v_fmac_f32 v5, s26, v25
    v_fmac_f32 v6, s26, v26
    s_bitset0_b32 s56, 2
L_cv2:
    s_bitcmp0_b32 s56, 3
    s_cbranch_scc1 L_cv3
    v_cmp_eq_u32 vcc, 0, v31
    s_cbranch_vccnz L_cv3
    v_fmac_f32 v4, s27, v28
    v_fmac_f32 v5, s27, v29
    v_fmac_f32 v6, s27, v30
    s_bitset0_b32 s56, 3
L_cv3:
    s_bitcmp0_b32 s56, 4
    s_cbranch_scc1 L_cv4
    v_cmp_eq_u32 vcc, 0, v35
    s_cbranch_vccnz L_cv4
    v_fmac_f32 v4, s28, v32
    v_fmac_f32 v5, s28, v33
    v_fmac_f32 v6, s28, v34
    s_bitset0_b32 s56, 4
L_cv4:
    s_bitcmp0_b32 s56, 5
    s_cbranch_scc1 L_cv5
    v_cmp_eq_u32 vcc, 0, v39
    s_cbranch_vccnz L_cv5
    v_fmac_f32 v4, s29, v36
    v_fmac_f32 v5, s29, v37
    v_fmac_f32 v6, s29, v38
    s_bitset0_b32 s56, 5
L_cv5:
    s_bitcmp0_b32 s56, 6
    s_cbranch_scc1 L_cv6
    v_cmp_eq_u32 vcc, 0, v43
    s_cbranch_vccnz L_cv6
    v_fmac_f32 v4, s30, v40
    v_fmac_f32 v5, s30, v41
    v_fmac_f32 v6, s30, v42
    s_bitset0_b32 s56, 6
L_cv6:
    s_bitcmp0_b32 s56, 7
    s_cbranch_scc1 L_cv7
    v_cmp_eq_u32 vcc, 0, v47
    s_cbranch_vccnz L_cv7
    v_fmac_f32 v4, s31, v44
    v_fmac_f32 v5, s31, v45
    v_fmac_f32 v6, s31, v46
    s_bitset0_b32 s56, 7
L_cv7:
    s_bitcmp0_b32 s56, 8
    s_cbranch_scc1 L_cv8
    v_cmp_eq_u32 vcc, 0, v51
    s_cbranch_vccnz L_cv8
    v_fmac_f32 v4, s32, v48
    v_fmac_f32 v5, s32, v49
    v_fmac_f32 v6, s32, v50
    s_bitset0_b32 s56, 8
L_cv8:
    s_bitcmp0_b32 s56, 9
    s_cbranch_scc1 L_cv9
    v_cmp_eq_u32 vcc, 0, v55
    s_cbranch_vccnz L_cv9
    v_fmac_f32 v4, s33, v52
    v_fmac_f32 v5, s33, v53
    v_fmac_f32 v6, s33, v54
    s_bitset0_b32 s56, 9
L_cv9:
    s_bitcmp0_b32 s56, 10
    s_cbranch_scc1 L_cv10
    v_cmp_eq_u32 vcc, 0, v59
    s_cbranch_vccnz L_cv10
    v_fmac_f32 v4, s34, v56
    v_fmac_f32 v5, s34, v57
    v_fmac_f32 v6, s34, v58
    s_bitset0_b32 s56, 10
L_cv10:
    s_bitcmp0_b32 s56, 11
    s_cbranch_scc1 L_cv11
    v_cmp_eq_u32 vcc, 0, v63
    s_cbranch_vccnz L_cv11
    v_fmac_f32 v4, s35, v60
    v_fmac_f32 v5, s35, v61
    v_fmac_f32 v6, s35, v62
    s_bitset0_b32 s56, 11
L_cv11:
    s_bitcmp0_b32 s56, 12
    s_cbranch_scc1 L_cv12
    v_cmp_eq_u32 vcc, 0, v67
    s_cbranch_vccnz L_cv12
    v_fmac_f32 v4, s36, v64
    v_fmac_f32 v5, s36, v65
    v_fmac_f32 v6, s36, v66
    s_bitset0_b32 s56, 12
L_cv12:
    s_bitcmp0_b32 s56, 13
    s_cbranch_scc1 L_cv13
    v_cmp_eq_u32 vcc, 0, v71
    s_cbranch_vccnz L_cv13
    v_fmac_f32 v4, s37, v68
    v_fmac_f32 v5, s37, v69
    v_fmac_f32 v6, s37, v70
    s_bitset0_b32 s56, 13
L_cv13:
    s_bitcmp0_b32 s56, 14
    s_cbranch_scc1 L_cv14
    v_cmp_eq_u32 vcc, 0, v75
    s_cbranch_vccnz L_cv14
    v_fmac_f32 v4, s38, v72
    v_fmac_f32 v5, s38, v73
    v_fmac_f32 v6, s38, v74
    s_bitset0_b32 s56, 14
L_cv14:
    s_bitcmp0_b32 s56, 15
    s_cbranch_scc1 L_cv15
    v_cmp_eq_u32 vcc, 0, v79
    s_cbranch_vccnz L_cv15
    v_fmac_f32 v4, s39, v76
    v_fmac_f32 v5, s39, v77
    v_fmac_f32 v6, s39, v78
    s_bitset0_b32 s56, 15
L_cv15:
    s_bitcmp0_b32 s56, 16
    s_cbranch_scc1 L_cv16
    v_cmp_eq_u32 vcc, 0, v83
    s_cbranch_vccnz L_cv16
    v_fmac_f32 v4, s40, v80
    v_fmac_f32 v5, s40, v81
    v_fmac_f32 v6, s40, v82
    s_bitset0_b32 s56, 16
L_cv16:
    s_bitcmp0_b32 s56, 17
    s_cbranch_scc1 L_cv17
    v_cmp_eq_u32 vcc, 0, v87
    s_cbranch_vccnz L_cv17
    v_fmac_f32 v4, s41, v84
    v_fmac_f32 v5, s41, v85
    v_fmac_f32 v6, s41, v86
    s_bitset0_b32 s56, 17
L_cv17:
    s_bitcmp0_b32 s56, 18
    s_cbranch_scc1 L_cv18
    v_cmp_eq_u32 vcc, 0, v91
    s_cbranch_vccnz L_cv18
    v_fmac_f32 v4, s42, v88
    v_fmac_f32 v5, s42, v89
    v_fmac_f32 v6, s42, v90
    s_bitset0_b32 s56, 18
L_cv18:
    s_bitcmp0_b32 s56, 19
    s_cbranch_scc1 L_cv19
    v_cmp_eq_u32 vcc, 0, v95
    s_cbranch_vccnz L_cv19
    v_fmac_f32 v4, s43, v92
    v_fmac_f32 v5, s43, v93
    v_fmac_f32 v6, s43, v94
    s_bitset0_b32 s56, 19
L_cv19:
    s_bitcmp0_b32 s56, 20
    s_cbranch_scc1 L_cv20
    v_cmp_eq_u32 vcc, 0, v99
    s_cbranch_vccnz L_cv20
    v_fmac_f32 v4, s44, v96
    v_fmac_f32 v5, s44, v97
    v_fmac_f32 v6, s44, v98
    s_bitset0_b32 s56, 20
L_cv20:
    s_bitcmp0_b32 s56, 21
    s_cbranch_scc1 L_cv21
    v_cmp_eq_u32 vcc, 0, v103
    s_cbranch_vccnz L_cv21
    v_fmac_f32 v4, s45, v100
    v_fmac_f32 v5, s45, v101
    v_fmac_f32 v6, s45, v102
    s_bitset0_b32 s56, 21
L_cv21:
    s_bitcmp0_b32 s56, 22
    s_cbranch_scc1 L_cv22
    v_cmp_eq_u32 vcc, 0, v107
    s_cbranch_vccnz L_cv22
    v_fmac_f32 v4, s46, v104
    v_fmac_f32 v5, s46, v105
    v_fmac_f32 v6, s46, v106
    s_bitset0_b32 s56, 22
L_cv22:
    s_bitcmp0_b32 s56, 23
    s_cbranch_scc1 L_cv23
    v_cmp_eq_u32 vcc, 0, v111
    s_cbranch_vccnz L_cv23
    v_fmac_f32 v4, s47, v108
    v_fmac_f32 v5, s47, v109
    v_fmac_f32 v6, s47, v110
    s_bitset0_b32 s56, 23
L_cv23:
    s_cmp_lg_u32 s56, 0
    s_cbranch_scc1 L_cr
    v_cvt_pk_bf16_f32 v4, v4, v4
    buffer_store_short v4, v12, s[92:95], s57 offen offset:0
    v_cvt_pk_bf16_f32 v5, v5, v5
    buffer_store_short v5, v12, s[92:95], s57 offen offset:128
    v_cvt_pk_bf16_f32 v6, v6, v6
    buffer_store_short v6, v12, s[92:95], s57 offen offset:256
    s_endpgm
L_h0:
    s_nop 1
    s_mov_b32 s8, s64
    s_and_b32 s9, s65, 0xffff
    s_mov_b32 s10, 12288
    s_mov_b32 s11, 0x00020000
    s_mov_b32 s92, s70
    s_and_b32 s93, s71, 0xffff
    s_mov_b32 s94, 6291456
    s_mov_b32 s95, 0x00020000
    s_mov_b32 s96, s72
    s_and_b32 s97, s73, 0xffff
    s_mov_b32 s98, 6291456
    s_mov_b32 s99, 0x00020000
    v_lshrrev_b32 v4, 4, v1
    v_and_b32 v5, 15, v1
    v_lshlrev_b32 v6, 3, v5
    v_mul_u32_u24 v7, 384, v4
    v_add_u32 v7, v7, v6
    v_lshl_add_u32 v13, v5, 2, v4
    v_lshlrev_b32 v13, 2, v13
    v_lshlrev_b32 v4, 4, v1
    s_mul_i32 s32, s5, 4352
    s_add_u32 s32, s32, s59
    s_lshl_b32 s33, s3, 3
    s_add_u32 s33, s33, s5
    s_mul_i32 s33, s33, 6144
    s_add_u32 s33, s33, 2097152
    v_mov_b32 v16, 0
    v_mov_b32 v17, 0
    v_mov_b32 v18, 0
    v_mov_b32 v19, 0
    s_add_u32 s48, s2, 0
    s_lshl_b32 s49, s48, 10
    s_lshl_b32 s48, s48, 6
    s_add_u32 s48, s48, 917504
    buffer_store_dwordx4 v[16:19], v4, s[12:15], s49 offen sc1
    s_mov_b64 exec, 15
    buffer_store_dwordx4 v[16:19], v4, s[12:15], s48 offen sc1
    s_mov_b64 exec, -1
    s_add_u32 s48, s2, 256
    s_lshl_b32 s49, s48, 10
    s_lshl_b32 s48, s48, 6
    s_add_u32 s48, s48, 917504
    buffer_store_dwordx4 v[16:19], v4, s[12:15], s49 offen sc1
    s_mov_b64 exec, 15
    buffer_store_dwordx4 v[16:19], v4, s[12:15], s48 offen sc1
    s_mov_b64 exec, -1
    s_add_u32 s48, s2, 512
    s_lshl_b32 s49, s48, 10
    s_lshl_b32 s48, s48, 6
    s_add_u32 s48, s48, 917504
    buffer_store_dwordx4 v[16:19], v4, s[12:15], s49 offen sc1
    s_mov_b64 exec, 15
    buffer_store_dwordx4 v[16:19], v4, s[12:15], s48 offen sc1
    s_mov_b64 exec, -1
    s_mov_b32 s61, 0
    s_lshl_b32 s62, s61, 5
    s_add_u32 s62, s62, s3
    s_lshl_b32 s63, s62, 15
    s_add_u32 s63, s63, 1
    s_mul_hi_u32 s63, s63, 0xaaaaaaab
    s_lshr_b32 s63, s63, 7
    s_mul_i32 s48, s62, 171
    s_lshr_b32 s48, s48, 9
    s_mul_i32 s48, s48, 384
    s_mul_i32 s49, s4, 24
    s_add_u32 s50, s49, s63
    s_mul_i32 s50, s50, 384
    v_add_u32 v10, s50, v7
    v_add_u32 v11, 3072, v10
    v_add_u32 v12, 6144, v10
    buffer_load_dwordx2 v[100:101], v6, s[8:11], s48 offen offset:0
    buffer_load_dwordx2 v[102:103], v6, s[8:11], s48 offen offset:128
    buffer_load_dwordx2 v[104:105], v6, s[8:11], s48 offen offset:256
    buffer_load_dwordx2 v[28:29], v10, s[92:95], 0 offen offset:0
    buffer_load_dwordx2 v[30:31], v10, s[92:95], 0 offen offset:128
    buffer_load_dwordx2 v[32:33], v10, s[92:95], 0 offen offset:256
    buffer_load_dwordx2 v[64:65], v10, s[96:99], 0 offen offset:0
    buffer_load_dwordx2 v[66:67], v10, s[96:99], 0 offen offset:128
    buffer_load_dwordx2 v[68:69], v10, s[96:99], 0 offen offset:256
    buffer_load_dwordx2 v[34:35], v10, s[92:95], 0 offen offset:1536
    buffer_load_dwordx2 v[36:37], v10, s[92:95], 0 offen offset:1664
    buffer_load_dwordx2 v[38:39], v10, s[92:95], 0 offen offset:1792
    buffer_load_dwordx2 v[70:71], v10, s[96:99], 0 offen offset:1536
    buffer_load_dwordx2 v[72:73], v10, s[96:99], 0 offen offset:1664
    buffer_load_dwordx2 v[74:75], v10, s[96:99], 0 offen offset:1792
    buffer_load_dwordx2 v[40:41], v11, s[92:95], 0 offen offset:0
    buffer_load_dwordx2 v[42:43], v11, s[92:95], 0 offen offset:128
    buffer_load_dwordx2 v[44:45], v11, s[92:95], 0 offen offset:256
    buffer_load_dwordx2 v[76:77], v11, s[96:99], 0 offen offset:0
    buffer_load_dwordx2 v[78:79], v11, s[96:99], 0 offen offset:128
    buffer_load_dwordx2 v[80:81], v11, s[96:99], 0 offen offset:256
    buffer_load_dwordx2 v[46:47], v11, s[92:95], 0 offen offset:1536
    buffer_load_dwordx2 v[48:49], v11, s[92:95], 0 offen offset:1664
    buffer_load_dwordx2 v[50:51], v11, s[92:95], 0 offen offset:1792
    buffer_load_dwordx2 v[82:83], v11, s[96:99], 0 offen offset:1536
    buffer_load_dwordx2 v[84:85], v11, s[96:99], 0 offen offset:1664
    buffer_load_dwordx2 v[86:87], v11, s[96:99], 0 offen offset:1792
    buffer_load_dwordx2 v[52:53], v12, s[92:95], 0 offen offset:0
    buffer_load_dwordx2 v[54:55], v12, s[92:95], 0 offen offset:128
    buffer_load_dwordx2 v[56:57], v12, s[92:95], 0 offen offset:256
    buffer_load_dwordx2 v[88:89], v12, s[96:99], 0 offen offset:0
    buffer_load_dwordx2 v[90:91], v12, s[96:99], 0 offen offset:128
    buffer_load_dwordx2 v[92:93], v12, s[96:99], 0 offen offset:256
    buffer_load_dwordx2 v[58:59], v12, s[92:95], 0 offen offset:1536
    buffer_load_dwordx2 v[60:61], v12, s[92:95], 0 offen offset:1664
    buffer_load_dwordx2 v[62:63], v12, s[92:95], 0 offen offset:1792
    buffer_load_dwordx2 v[94:95], v12, s[96:99], 0 offen offset:1536
    buffer_load_dwordx2 v[96:97], v12, s[96:99], 0 offen offset:1664
    buffer_load_dwordx2 v[98:99], v12, s[96:99], 0 offen offset:1792
    s_waitcnt vmcnt(0)
    v_lshlrev_b32 v16, 16, v100
    v_and_b32 v17, 0xffff0000, v100
    v_lshlrev_b32 v18, 16, v101
    v_and_b32 v19, 0xffff0000, v101
    v_lshlrev_b32 v20, 16, v102
    v_and_b32 v21, 0xffff0000, v102
    v_lshlrev_b32 v22, 16, v103
    v_and_b32 v23, 0xffff0000, v103
    v_lshlrev_b32 v24, 16, v104
    v_and_b32 v25, 0xffff0000, v104
    v_lshlrev_b32 v26, 16, v105
    v_and_b32 v27, 0xffff0000, v105
    v_lshlrev_b32 v10, 16, v28
    v_lshlrev_b32 v11, 16, v64
    v_and_b32 v28, 0xffff0000, v28
    v_and_b32 v64, 0xffff0000, v64
    v_mul_f32 v10, v10, v16
    v_mul_f32 v28, v28, v17
    v_mul_f32 v100, v10, v11
    v_fmac_f32 v100, v28, v64
    v_lshlrev_b32 v10, 16, v29
    v_lshlrev_b32 v11, 16, v65
    v_and_b32 v29, 0xffff0000, v29
    v_and_b32 v65, 0xffff0000, v65
    v_mul_f32 v10, v10, v18
    v_mul_f32 v29, v29, v19
    v_fmac_f32 v100, v10, v11
    v_fmac_f32 v100, v29, v65
    v_lshlrev_b32 v10, 16, v30
    v_lshlrev_b32 v11, 16, v66
    v_and_b32 v30, 0xffff0000, v30
    v_and_b32 v66, 0xffff0000, v66
    v_mul_f32 v10, v10, v20
    v_mul_f32 v30, v30, v21
    v_fmac_f32 v100, v10, v11
    v_fmac_f32 v100, v30, v66
    v_lshlrev_b32 v10, 16, v31
    v_lshlrev_b32 v11, 16, v67
    v_and_b32 v31, 0xffff0000, v31
    v_and_b32 v67, 0xffff0000, v67
    v_mul_f32 v10, v10, v22
    v_mul_f32 v31, v31, v23
    v_fmac_f32 v100, v10, v11
    v_fmac_f32 v100, v31, v67
    v_lshlrev_b32 v10, 16, v32
    v_lshlrev_b32 v11, 16, v68
    v_and_b32 v32, 0xffff0000, v32
    v_and_b32 v68, 0xffff0000, v68
    v_mul_f32 v10, v10, v24
    v_mul_f32 v32, v32, v25
    v_fmac_f32 v100, v10, v11
    v_fmac_f32 v100, v32, v68
    v_lshlrev_b32 v10, 16, v33
    v_lshlrev_b32 v11, 16, v69
    v_and_b32 v33, 0xffff0000, v33
    v_and_b32 v69, 0xffff0000, v69
    v_mul_f32 v10, v10, v26
    v_mul_f32 v33, v33, v27
    v_fmac_f32 v100, v10, v11
    v_fmac_f32 v100, v33, v69
    v_lshlrev_b32 v10, 16, v34
    v_lshlrev_b32 v11, 16, v70
    v_and_b32 v34, 0xffff0000, v34
    v_and_b32 v70, 0xffff0000, v70
    v_mul_f32 v10, v10, v16
    v_mul_f32 v34, v34, v17
    v_mul_f32 v101, v10, v11
    v_fmac_f32 v101, v34, v70
    v_lshlrev_b32 v10, 16, v35
    v_lshlrev_b32 v11, 16, v71
    v_and_b32 v35, 0xffff0000, v35
    v_and_b32 v71, 0xffff0000, v71
    v_mul_f32 v10, v10, v18
    v_mul_f32 v35, v35, v19
    v_fmac_f32 v101, v10, v11
    v_fmac_f32 v101, v35, v71
    v_lshlrev_b32 v10, 16, v36
    v_lshlrev_b32 v11, 16, v72
    v_and_b32 v36, 0xffff0000, v36
    v_and_b32 v72, 0xffff0000, v72
    v_mul_f32 v10, v10, v20
    v_mul_f32 v36, v36, v21
    v_fmac_f32 v101, v10, v11
    v_fmac_f32 v101, v36, v72
    v_lshlrev_b32 v10, 16, v37
    v_lshlrev_b32 v11, 16, v73
    v_and_b32 v37, 0xffff0000, v37
    v_and_b32 v73, 0xffff0000, v73
    v_mul_f32 v10, v10, v22
    v_mul_f32 v37, v37, v23
    v_fmac_f32 v101, v10, v11
    v_fmac_f32 v101, v37, v73
    v_lshlrev_b32 v10, 16, v38
    v_lshlrev_b32 v11, 16, v74
    v_and_b32 v38, 0xffff0000, v38
    v_and_b32 v74, 0xffff0000, v74
    v_mul_f32 v10, v10, v24
    v_mul_f32 v38, v38, v25
    v_fmac_f32 v101, v10, v11
    v_fmac_f32 v101, v38, v74
    v_lshlrev_b32 v10, 16, v39
    v_lshlrev_b32 v11, 16, v75
    v_and_b32 v39, 0xffff0000, v39
    v_and_b32 v75, 0xffff0000, v75
    v_mul_f32 v10, v10, v26
    v_mul_f32 v39, v39, v27
    v_fmac_f32 v101, v10, v11
    v_fmac_f32 v101, v39, v75
    v_lshlrev_b32 v10, 16, v40
    v_lshlrev_b32 v11, 16, v76
    v_and_b32 v40, 0xffff0000, v40
    v_and_b32 v76, 0xffff0000, v76
    v_mul_f32 v10, v10, v16
    v_mul_f32 v40, v40, v17
    v_mul_f32 v102, v10, v11
    v_fmac_f32 v102, v40, v76
    v_lshlrev_b32 v10, 16, v41
    v_lshlrev_b32 v11, 16, v77
    v_and_b32 v41, 0xffff0000, v41
    v_and_b32 v77, 0xffff0000, v77
    v_mul_f32 v10, v10, v18
    v_mul_f32 v41, v41, v19
    v_fmac_f32 v102, v10, v11
    v_fmac_f32 v102, v41, v77
    v_lshlrev_b32 v10, 16, v42
    v_lshlrev_b32 v11, 16, v78
    v_and_b32 v42, 0xffff0000, v42
    v_and_b32 v78, 0xffff0000, v78
    v_mul_f32 v10, v10, v20
    v_mul_f32 v42, v42, v21
    v_fmac_f32 v102, v10, v11
    v_fmac_f32 v102, v42, v78
    v_lshlrev_b32 v10, 16, v43
    v_lshlrev_b32 v11, 16, v79
    v_and_b32 v43, 0xffff0000, v43
    v_and_b32 v79, 0xffff0000, v79
    v_mul_f32 v10, v10, v22
    v_mul_f32 v43, v43, v23
    v_fmac_f32 v102, v10, v11
    v_fmac_f32 v102, v43, v79
    v_lshlrev_b32 v10, 16, v44
    v_lshlrev_b32 v11, 16, v80
    v_and_b32 v44, 0xffff0000, v44
    v_and_b32 v80, 0xffff0000, v80
    v_mul_f32 v10, v10, v24
    v_mul_f32 v44, v44, v25
    v_fmac_f32 v102, v10, v11
    v_fmac_f32 v102, v44, v80
    v_lshlrev_b32 v10, 16, v45
    v_lshlrev_b32 v11, 16, v81
    v_and_b32 v45, 0xffff0000, v45
    v_and_b32 v81, 0xffff0000, v81
    v_mul_f32 v10, v10, v26
    v_mul_f32 v45, v45, v27
    v_fmac_f32 v102, v10, v11
    v_fmac_f32 v102, v45, v81
    v_lshlrev_b32 v10, 16, v46
    v_lshlrev_b32 v11, 16, v82
    v_and_b32 v46, 0xffff0000, v46
    v_and_b32 v82, 0xffff0000, v82
    v_mul_f32 v10, v10, v16
    v_mul_f32 v46, v46, v17
    v_mul_f32 v103, v10, v11
    v_fmac_f32 v103, v46, v82
    v_lshlrev_b32 v10, 16, v47
    v_lshlrev_b32 v11, 16, v83
    v_and_b32 v47, 0xffff0000, v47
    v_and_b32 v83, 0xffff0000, v83
    v_mul_f32 v10, v10, v18
    v_mul_f32 v47, v47, v19
    v_fmac_f32 v103, v10, v11
    v_fmac_f32 v103, v47, v83
    v_lshlrev_b32 v10, 16, v48
    v_lshlrev_b32 v11, 16, v84
    v_and_b32 v48, 0xffff0000, v48
    v_and_b32 v84, 0xffff0000, v84
    v_mul_f32 v10, v10, v20
    v_mul_f32 v48, v48, v21
    v_fmac_f32 v103, v10, v11
    v_fmac_f32 v103, v48, v84
    v_lshlrev_b32 v10, 16, v49
    v_lshlrev_b32 v11, 16, v85
    v_and_b32 v49, 0xffff0000, v49
    v_and_b32 v85, 0xffff0000, v85
    v_mul_f32 v10, v10, v22
    v_mul_f32 v49, v49, v23
    v_fmac_f32 v103, v10, v11
    v_fmac_f32 v103, v49, v85
    v_lshlrev_b32 v10, 16, v50
    v_lshlrev_b32 v11, 16, v86
    v_and_b32 v50, 0xffff0000, v50
    v_and_b32 v86, 0xffff0000, v86
    v_mul_f32 v10, v10, v24
    v_mul_f32 v50, v50, v25
    v_fmac_f32 v103, v10, v11
    v_fmac_f32 v103, v50, v86
    v_lshlrev_b32 v10, 16, v51
    v_lshlrev_b32 v11, 16, v87
    v_and_b32 v51, 0xffff0000, v51
    v_and_b32 v87, 0xffff0000, v87
    v_mul_f32 v10, v10, v26
    v_mul_f32 v51, v51, v27
    v_fmac_f32 v103, v10, v11
    v_fmac_f32 v103, v51, v87
    v_lshlrev_b32 v10, 16, v52
    v_lshlrev_b32 v11, 16, v88
    v_and_b32 v52, 0xffff0000, v52
    v_and_b32 v88, 0xffff0000, v88
    v_mul_f32 v10, v10, v16
    v_mul_f32 v52, v52, v17
    v_mul_f32 v104, v10, v11
    v_fmac_f32 v104, v52, v88
    v_lshlrev_b32 v10, 16, v53
    v_lshlrev_b32 v11, 16, v89
    v_and_b32 v53, 0xffff0000, v53
    v_and_b32 v89, 0xffff0000, v89
    v_mul_f32 v10, v10, v18
    v_mul_f32 v53, v53, v19
    v_fmac_f32 v104, v10, v11
    v_fmac_f32 v104, v53, v89
    v_lshlrev_b32 v10, 16, v54
    v_lshlrev_b32 v11, 16, v90
    v_and_b32 v54, 0xffff0000, v54
    v_and_b32 v90, 0xffff0000, v90
    v_mul_f32 v10, v10, v20
    v_mul_f32 v54, v54, v21
    v_fmac_f32 v104, v10, v11
    v_fmac_f32 v104, v54, v90
    v_lshlrev_b32 v10, 16, v55
    v_lshlrev_b32 v11, 16, v91
    v_and_b32 v55, 0xffff0000, v55
    v_and_b32 v91, 0xffff0000, v91
    v_mul_f32 v10, v10, v22
    v_mul_f32 v55, v55, v23
    v_fmac_f32 v104, v10, v11
    v_fmac_f32 v104, v55, v91
    v_lshlrev_b32 v10, 16, v56
    v_lshlrev_b32 v11, 16, v92
    v_and_b32 v56, 0xffff0000, v56
    v_and_b32 v92, 0xffff0000, v92
    v_mul_f32 v10, v10, v24
    v_mul_f32 v56, v56, v25
    v_fmac_f32 v104, v10, v11
    v_fmac_f32 v104, v56, v92
    v_lshlrev_b32 v10, 16, v57
    v_lshlrev_b32 v11, 16, v93
    v_and_b32 v57, 0xffff0000, v57
    v_and_b32 v93, 0xffff0000, v93
    v_mul_f32 v10, v10, v26
    v_mul_f32 v57, v57, v27
    v_fmac_f32 v104, v10, v11
    v_fmac_f32 v104, v57, v93
    v_lshlrev_b32 v10, 16, v58
    v_lshlrev_b32 v11, 16, v94
    v_and_b32 v58, 0xffff0000, v58
    v_and_b32 v94, 0xffff0000, v94
    v_mul_f32 v10, v10, v16
    v_mul_f32 v58, v58, v17
    v_mul_f32 v105, v10, v11
    v_fmac_f32 v105, v58, v94
    v_lshlrev_b32 v10, 16, v59
    v_lshlrev_b32 v11, 16, v95
    v_and_b32 v59, 0xffff0000, v59
    v_and_b32 v95, 0xffff0000, v95
    v_mul_f32 v10, v10, v18
    v_mul_f32 v59, v59, v19
    v_fmac_f32 v105, v10, v11
    v_fmac_f32 v105, v59, v95
    v_lshlrev_b32 v10, 16, v60
    v_lshlrev_b32 v11, 16, v96
    v_and_b32 v60, 0xffff0000, v60
    v_and_b32 v96, 0xffff0000, v96
    v_mul_f32 v10, v10, v20
    v_mul_f32 v60, v60, v21
    v_fmac_f32 v105, v10, v11
    v_fmac_f32 v105, v60, v96
    v_lshlrev_b32 v10, 16, v61
    v_lshlrev_b32 v11, 16, v97
    v_and_b32 v61, 0xffff0000, v61
    v_and_b32 v97, 0xffff0000, v97
    v_mul_f32 v10, v10, v22
    v_mul_f32 v61, v61, v23
    v_fmac_f32 v105, v10, v11
    v_fmac_f32 v105, v61, v97
    v_lshlrev_b32 v10, 16, v62
    v_lshlrev_b32 v11, 16, v98
    v_and_b32 v62, 0xffff0000, v62
    v_and_b32 v98, 0xffff0000, v98
    v_mul_f32 v10, v10, v24
    v_mul_f32 v62, v62, v25
    v_fmac_f32 v105, v10, v11
    v_fmac_f32 v105, v62, v98
    v_lshlrev_b32 v10, 16, v63
    v_lshlrev_b32 v11, 16, v99
    v_and_b32 v63, 0xffff0000, v63
    v_and_b32 v99, 0xffff0000, v99
    v_mul_f32 v10, v10, v26
    v_mul_f32 v63, v63, v27
    v_fmac_f32 v105, v10, v11
    v_fmac_f32 v105, v63, v99
    v_add_f32_dpp v100, v100, v100 row_ror:8 row_mask:0xf bank_mask:0xf
    v_add_f32_dpp v101, v101, v101 row_ror:8 row_mask:0xf bank_mask:0xf
    v_add_f32_dpp v102, v102, v102 row_ror:8 row_mask:0xf bank_mask:0xf
    v_add_f32_dpp v103, v103, v103 row_ror:8 row_mask:0xf bank_mask:0xf
    v_add_f32_dpp v104, v104, v104 row_ror:8 row_mask:0xf bank_mask:0xf
    v_add_f32_dpp v105, v105, v105 row_ror:8 row_mask:0xf bank_mask:0xf
    v_add_f32_dpp v100, v100, v100 row_ror:4 row_mask:0xf bank_mask:0xf
    v_add_f32_dpp v101, v101, v101 row_ror:4 row_mask:0xf bank_mask:0xf
    v_add_f32_dpp v102, v102, v102 row_ror:4 row_mask:0xf bank_mask:0xf
    v_add_f32_dpp v103, v103, v103 row_ror:4 row_mask:0xf bank_mask:0xf
    v_add_f32_dpp v104, v104, v104 row_ror:4 row_mask:0xf bank_mask:0xf
    v_add_f32_dpp v105, v105, v105 row_ror:4 row_mask:0xf bank_mask:0xf
    v_add_f32_dpp v100, v100, v100 row_ror:2 row_mask:0xf bank_mask:0xf
    v_add_f32_dpp v101, v101, v101 row_ror:2 row_mask:0xf bank_mask:0xf
    v_add_f32_dpp v102, v102, v102 row_ror:2 row_mask:0xf bank_mask:0xf
    v_add_f32_dpp v103, v103, v103 row_ror:2 row_mask:0xf bank_mask:0xf
    v_add_f32_dpp v104, v104, v104 row_ror:2 row_mask:0xf bank_mask:0xf
    v_add_f32_dpp v105, v105, v105 row_ror:2 row_mask:0xf bank_mask:0xf
    v_add_f32_dpp v100, v100, v100 row_ror:1 row_mask:0xf bank_mask:0xf
    v_add_f32_dpp v101, v101, v101 row_ror:1 row_mask:0xf bank_mask:0xf
    v_add_f32_dpp v102, v102, v102 row_ror:1 row_mask:0xf bank_mask:0xf
    v_add_f32_dpp v103, v103, v103 row_ror:1 row_mask:0xf bank_mask:0xf
    v_add_f32_dpp v104, v104, v104 row_ror:1 row_mask:0xf bank_mask:0xf
    v_add_f32_dpp v105, v105, v105 row_ror:1 row_mask:0xf bank_mask:0xf
    v_cmp_eq_u32 vcc, 1, v5
    s_nop 1
    v_cndmask_b32 v100, v100, v101, vcc
    v_cmp_eq_u32 vcc, 2, v5
    s_nop 1
    v_cndmask_b32 v100, v100, v102, vcc
    v_cmp_eq_u32 vcc, 3, v5
    s_nop 1
    v_cndmask_b32 v100, v100, v103, vcc
    v_cmp_eq_u32 vcc, 4, v5
    s_nop 1
    v_cndmask_b32 v100, v100, v104, vcc
    v_cmp_eq_u32 vcc, 5, v5
    s_nop 1
    v_cndmask_b32 v100, v100, v105, vcc
    s_mul_i32 s48, s62, 768
    s_lshl_b32 s49, s49, 2
    s_add_u32 s48, s48, s49
    s_add_u32 s48, s48, 1179648
    s_mov_b32 exec_lo, 0x003f003f
    s_mov_b32 exec_hi, 0x003f003f
    buffer_store_dword v100, v13, s[12:15], s48 offen sc1
    s_mov_b64 exec, -1
    s_mov_b32 s60, 0x100000
L_wb1:
    s_nop 1
    ds_read_b32 v10, v2 offset:60
    s_sub_u32 s60, s60, 1
    s_cbranch_scc1 L_exit1
    s_waitcnt lgkmcnt(0)
    v_readfirstlane_b32 s48, v10
    s_cmp_lt_u32 s48, 1
    s_cbranch_scc1 L_wb1
    s_mov_b32 s61, 1
    s_lshl_b32 s62, s61, 5
    s_add_u32 s62, s62, s3
    s_lshl_b32 s63, s62, 15
    s_add_u32 s63, s63, 1
    s_mul_hi_u32 s63, s63, 0xaaaaaaab
    s_lshr_b32 s63, s63, 7
    s_mul_i32 s48, s62, 171
    s_lshr_b32 s48, s48, 9
    s_mul_i32 s48, s48, 384
    s_mul_i32 s49, s4, 24
    s_add_u32 s50, s49, s63
    s_mul_i32 s50, s50, 384
    v_add_u32 v10, s50, v7
    v_add_u32 v11, 3072, v10
    v_add_u32 v12, 6144, v10
    buffer_load_dwordx2 v[100:101], v6, s[8:11], s48 offen offset:0
    buffer_load_dwordx2 v[102:103], v6, s[8:11], s48 offen offset:128
    buffer_load_dwordx2 v[104:105], v6, s[8:11], s48 offen offset:256
    buffer_load_dwordx2 v[28:29], v10, s[92:95], 0 offen offset:0
    buffer_load_dwordx2 v[30:31], v10, s[92:95], 0 offen offset:128
    buffer_load_dwordx2 v[32:33], v10, s[92:95], 0 offen offset:256
    buffer_load_dwordx2 v[64:65], v10, s[96:99], 0 offen offset:0
    buffer_load_dwordx2 v[66:67], v10, s[96:99], 0 offen offset:128
    buffer_load_dwordx2 v[68:69], v10, s[96:99], 0 offen offset:256
    buffer_load_dwordx2 v[34:35], v10, s[92:95], 0 offen offset:1536
    buffer_load_dwordx2 v[36:37], v10, s[92:95], 0 offen offset:1664
    buffer_load_dwordx2 v[38:39], v10, s[92:95], 0 offen offset:1792
    buffer_load_dwordx2 v[70:71], v10, s[96:99], 0 offen offset:1536
    buffer_load_dwordx2 v[72:73], v10, s[96:99], 0 offen offset:1664
    buffer_load_dwordx2 v[74:75], v10, s[96:99], 0 offen offset:1792
    buffer_load_dwordx2 v[40:41], v11, s[92:95], 0 offen offset:0
    buffer_load_dwordx2 v[42:43], v11, s[92:95], 0 offen offset:128
    buffer_load_dwordx2 v[44:45], v11, s[92:95], 0 offen offset:256
    buffer_load_dwordx2 v[76:77], v11, s[96:99], 0 offen offset:0
    buffer_load_dwordx2 v[78:79], v11, s[96:99], 0 offen offset:128
    buffer_load_dwordx2 v[80:81], v11, s[96:99], 0 offen offset:256
    buffer_load_dwordx2 v[46:47], v11, s[92:95], 0 offen offset:1536
    buffer_load_dwordx2 v[48:49], v11, s[92:95], 0 offen offset:1664
    buffer_load_dwordx2 v[50:51], v11, s[92:95], 0 offen offset:1792
    buffer_load_dwordx2 v[82:83], v11, s[96:99], 0 offen offset:1536
    buffer_load_dwordx2 v[84:85], v11, s[96:99], 0 offen offset:1664
    buffer_load_dwordx2 v[86:87], v11, s[96:99], 0 offen offset:1792
    buffer_load_dwordx2 v[52:53], v12, s[92:95], 0 offen offset:0
    buffer_load_dwordx2 v[54:55], v12, s[92:95], 0 offen offset:128
    buffer_load_dwordx2 v[56:57], v12, s[92:95], 0 offen offset:256
    buffer_load_dwordx2 v[88:89], v12, s[96:99], 0 offen offset:0
    buffer_load_dwordx2 v[90:91], v12, s[96:99], 0 offen offset:128
    buffer_load_dwordx2 v[92:93], v12, s[96:99], 0 offen offset:256
    buffer_load_dwordx2 v[58:59], v12, s[92:95], 0 offen offset:1536
    buffer_load_dwordx2 v[60:61], v12, s[92:95], 0 offen offset:1664
    buffer_load_dwordx2 v[62:63], v12, s[92:95], 0 offen offset:1792
    buffer_load_dwordx2 v[94:95], v12, s[96:99], 0 offen offset:1536
    buffer_load_dwordx2 v[96:97], v12, s[96:99], 0 offen offset:1664
    buffer_load_dwordx2 v[98:99], v12, s[96:99], 0 offen offset:1792
    s_waitcnt vmcnt(0)
    v_lshlrev_b32 v16, 16, v100
    v_and_b32 v17, 0xffff0000, v100
    v_lshlrev_b32 v18, 16, v101
    v_and_b32 v19, 0xffff0000, v101
    v_lshlrev_b32 v20, 16, v102
    v_and_b32 v21, 0xffff0000, v102
    v_lshlrev_b32 v22, 16, v103
    v_and_b32 v23, 0xffff0000, v103
    v_lshlrev_b32 v24, 16, v104
    v_and_b32 v25, 0xffff0000, v104
    v_lshlrev_b32 v26, 16, v105
    v_and_b32 v27, 0xffff0000, v105
    v_lshlrev_b32 v10, 16, v28
    v_lshlrev_b32 v11, 16, v64
    v_and_b32 v28, 0xffff0000, v28
    v_and_b32 v64, 0xffff0000, v64
    v_mul_f32 v10, v10, v16
    v_mul_f32 v28, v28, v17
    v_mul_f32 v100, v10, v11
    v_fmac_f32 v100, v28, v64
    v_lshlrev_b32 v10, 16, v29
    v_lshlrev_b32 v11, 16, v65
    v_and_b32 v29, 0xffff0000, v29
    v_and_b32 v65, 0xffff0000, v65
    v_mul_f32 v10, v10, v18
    v_mul_f32 v29, v29, v19
    v_fmac_f32 v100, v10, v11
    v_fmac_f32 v100, v29, v65
    v_lshlrev_b32 v10, 16, v30
    v_lshlrev_b32 v11, 16, v66
    v_and_b32 v30, 0xffff0000, v30
    v_and_b32 v66, 0xffff0000, v66
    v_mul_f32 v10, v10, v20
    v_mul_f32 v30, v30, v21
    v_fmac_f32 v100, v10, v11
    v_fmac_f32 v100, v30, v66
    v_lshlrev_b32 v10, 16, v31
    v_lshlrev_b32 v11, 16, v67
    v_and_b32 v31, 0xffff0000, v31
    v_and_b32 v67, 0xffff0000, v67
    v_mul_f32 v10, v10, v22
    v_mul_f32 v31, v31, v23
    v_fmac_f32 v100, v10, v11
    v_fmac_f32 v100, v31, v67
    v_lshlrev_b32 v10, 16, v32
    v_lshlrev_b32 v11, 16, v68
    v_and_b32 v32, 0xffff0000, v32
    v_and_b32 v68, 0xffff0000, v68
    v_mul_f32 v10, v10, v24
    v_mul_f32 v32, v32, v25
    v_fmac_f32 v100, v10, v11
    v_fmac_f32 v100, v32, v68
    v_lshlrev_b32 v10, 16, v33
    v_lshlrev_b32 v11, 16, v69
    v_and_b32 v33, 0xffff0000, v33
    v_and_b32 v69, 0xffff0000, v69
    v_mul_f32 v10, v10, v26
    v_mul_f32 v33, v33, v27
    v_fmac_f32 v100, v10, v11
    v_fmac_f32 v100, v33, v69
    v_lshlrev_b32 v10, 16, v34
    v_lshlrev_b32 v11, 16, v70
    v_and_b32 v34, 0xffff0000, v34
    v_and_b32 v70, 0xffff0000, v70
    v_mul_f32 v10, v10, v16
    v_mul_f32 v34, v34, v17
    v_mul_f32 v101, v10, v11
    v_fmac_f32 v101, v34, v70
    v_lshlrev_b32 v10, 16, v35
    v_lshlrev_b32 v11, 16, v71
    v_and_b32 v35, 0xffff0000, v35
    v_and_b32 v71, 0xffff0000, v71
    v_mul_f32 v10, v10, v18
    v_mul_f32 v35, v35, v19
    v_fmac_f32 v101, v10, v11
    v_fmac_f32 v101, v35, v71
    v_lshlrev_b32 v10, 16, v36
    v_lshlrev_b32 v11, 16, v72
    v_and_b32 v36, 0xffff0000, v36
    v_and_b32 v72, 0xffff0000, v72
    v_mul_f32 v10, v10, v20
    v_mul_f32 v36, v36, v21
    v_fmac_f32 v101, v10, v11
    v_fmac_f32 v101, v36, v72
    v_lshlrev_b32 v10, 16, v37
    v_lshlrev_b32 v11, 16, v73
    v_and_b32 v37, 0xffff0000, v37
    v_and_b32 v73, 0xffff0000, v73
    v_mul_f32 v10, v10, v22
    v_mul_f32 v37, v37, v23
    v_fmac_f32 v101, v10, v11
    v_fmac_f32 v101, v37, v73
    v_lshlrev_b32 v10, 16, v38
    v_lshlrev_b32 v11, 16, v74
    v_and_b32 v38, 0xffff0000, v38
    v_and_b32 v74, 0xffff0000, v74
    v_mul_f32 v10, v10, v24
    v_mul_f32 v38, v38, v25
    v_fmac_f32 v101, v10, v11
    v_fmac_f32 v101, v38, v74
    v_lshlrev_b32 v10, 16, v39
    v_lshlrev_b32 v11, 16, v75
    v_and_b32 v39, 0xffff0000, v39
    v_and_b32 v75, 0xffff0000, v75
    v_mul_f32 v10, v10, v26
    v_mul_f32 v39, v39, v27
    v_fmac_f32 v101, v10, v11
    v_fmac_f32 v101, v39, v75
    v_lshlrev_b32 v10, 16, v40
    v_lshlrev_b32 v11, 16, v76
    v_and_b32 v40, 0xffff0000, v40
    v_and_b32 v76, 0xffff0000, v76
    v_mul_f32 v10, v10, v16
    v_mul_f32 v40, v40, v17
    v_mul_f32 v102, v10, v11
    v_fmac_f32 v102, v40, v76
    v_lshlrev_b32 v10, 16, v41
    v_lshlrev_b32 v11, 16, v77
    v_and_b32 v41, 0xffff0000, v41
    v_and_b32 v77, 0xffff0000, v77
    v_mul_f32 v10, v10, v18
    v_mul_f32 v41, v41, v19
    v_fmac_f32 v102, v10, v11
    v_fmac_f32 v102, v41, v77
    v_lshlrev_b32 v10, 16, v42
    v_lshlrev_b32 v11, 16, v78
    v_and_b32 v42, 0xffff0000, v42
    v_and_b32 v78, 0xffff0000, v78
    v_mul_f32 v10, v10, v20
    v_mul_f32 v42, v42, v21
    v_fmac_f32 v102, v10, v11
    v_fmac_f32 v102, v42, v78
    v_lshlrev_b32 v10, 16, v43
    v_lshlrev_b32 v11, 16, v79
    v_and_b32 v43, 0xffff0000, v43
    v_and_b32 v79, 0xffff0000, v79
    v_mul_f32 v10, v10, v22
    v_mul_f32 v43, v43, v23
    v_fmac_f32 v102, v10, v11
    v_fmac_f32 v102, v43, v79
    v_lshlrev_b32 v10, 16, v44
    v_lshlrev_b32 v11, 16, v80
    v_and_b32 v44, 0xffff0000, v44
    v_and_b32 v80, 0xffff0000, v80
    v_mul_f32 v10, v10, v24
    v_mul_f32 v44, v44, v25
    v_fmac_f32 v102, v10, v11
    v_fmac_f32 v102, v44, v80
    v_lshlrev_b32 v10, 16, v45
    v_lshlrev_b32 v11, 16, v81
    v_and_b32 v45, 0xffff0000, v45
    v_and_b32 v81, 0xffff0000, v81
    v_mul_f32 v10, v10, v26
    v_mul_f32 v45, v45, v27
    v_fmac_f32 v102, v10, v11
    v_fmac_f32 v102, v45, v81
    v_lshlrev_b32 v10, 16, v46
    v_lshlrev_b32 v11, 16, v82
    v_and_b32 v46, 0xffff0000, v46
    v_and_b32 v82, 0xffff0000, v82
    v_mul_f32 v10, v10, v16
    v_mul_f32 v46, v46, v17
    v_mul_f32 v103, v10, v11
    v_fmac_f32 v103, v46, v82
    v_lshlrev_b32 v10, 16, v47
    v_lshlrev_b32 v11, 16, v83
    v_and_b32 v47, 0xffff0000, v47
    v_and_b32 v83, 0xffff0000, v83
    v_mul_f32 v10, v10, v18
    v_mul_f32 v47, v47, v19
    v_fmac_f32 v103, v10, v11
    v_fmac_f32 v103, v47, v83
    v_lshlrev_b32 v10, 16, v48
    v_lshlrev_b32 v11, 16, v84
    v_and_b32 v48, 0xffff0000, v48
    v_and_b32 v84, 0xffff0000, v84
    v_mul_f32 v10, v10, v20
    v_mul_f32 v48, v48, v21
    v_fmac_f32 v103, v10, v11
    v_fmac_f32 v103, v48, v84
    v_lshlrev_b32 v10, 16, v49
    v_lshlrev_b32 v11, 16, v85
    v_and_b32 v49, 0xffff0000, v49
    v_and_b32 v85, 0xffff0000, v85
    v_mul_f32 v10, v10, v22
    v_mul_f32 v49, v49, v23
    v_fmac_f32 v103, v10, v11
    v_fmac_f32 v103, v49, v85
    v_lshlrev_b32 v10, 16, v50
    v_lshlrev_b32 v11, 16, v86
    v_and_b32 v50, 0xffff0000, v50
    v_and_b32 v86, 0xffff0000, v86
    v_mul_f32 v10, v10, v24
    v_mul_f32 v50, v50, v25
    v_fmac_f32 v103, v10, v11
    v_fmac_f32 v103, v50, v86
    v_lshlrev_b32 v10, 16, v51
    v_lshlrev_b32 v11, 16, v87
    v_and_b32 v51, 0xffff0000, v51
    v_and_b32 v87, 0xffff0000, v87
    v_mul_f32 v10, v10, v26
    v_mul_f32 v51, v51, v27
    v_fmac_f32 v103, v10, v11
    v_fmac_f32 v103, v51, v87
    v_lshlrev_b32 v10, 16, v52
    v_lshlrev_b32 v11, 16, v88
    v_and_b32 v52, 0xffff0000, v52
    v_and_b32 v88, 0xffff0000, v88
    v_mul_f32 v10, v10, v16
    v_mul_f32 v52, v52, v17
    v_mul_f32 v104, v10, v11
    v_fmac_f32 v104, v52, v88
    v_lshlrev_b32 v10, 16, v53
    v_lshlrev_b32 v11, 16, v89
    v_and_b32 v53, 0xffff0000, v53
    v_and_b32 v89, 0xffff0000, v89
    v_mul_f32 v10, v10, v18
    v_mul_f32 v53, v53, v19
    v_fmac_f32 v104, v10, v11
    v_fmac_f32 v104, v53, v89
    v_lshlrev_b32 v10, 16, v54
    v_lshlrev_b32 v11, 16, v90
    v_and_b32 v54, 0xffff0000, v54
    v_and_b32 v90, 0xffff0000, v90
    v_mul_f32 v10, v10, v20
    v_mul_f32 v54, v54, v21
    v_fmac_f32 v104, v10, v11
    v_fmac_f32 v104, v54, v90
    v_lshlrev_b32 v10, 16, v55
    v_lshlrev_b32 v11, 16, v91
    v_and_b32 v55, 0xffff0000, v55
    v_and_b32 v91, 0xffff0000, v91
    v_mul_f32 v10, v10, v22
    v_mul_f32 v55, v55, v23
    v_fmac_f32 v104, v10, v11
    v_fmac_f32 v104, v55, v91
    v_lshlrev_b32 v10, 16, v56
    v_lshlrev_b32 v11, 16, v92
    v_and_b32 v56, 0xffff0000, v56
    v_and_b32 v92, 0xffff0000, v92
    v_mul_f32 v10, v10, v24
    v_mul_f32 v56, v56, v25
    v_fmac_f32 v104, v10, v11
    v_fmac_f32 v104, v56, v92
    v_lshlrev_b32 v10, 16, v57
    v_lshlrev_b32 v11, 16, v93
    v_and_b32 v57, 0xffff0000, v57
    v_and_b32 v93, 0xffff0000, v93
    v_mul_f32 v10, v10, v26
    v_mul_f32 v57, v57, v27
    v_fmac_f32 v104, v10, v11
    v_fmac_f32 v104, v57, v93
    v_lshlrev_b32 v10, 16, v58
    v_lshlrev_b32 v11, 16, v94
    v_and_b32 v58, 0xffff0000, v58
    v_and_b32 v94, 0xffff0000, v94
    v_mul_f32 v10, v10, v16
    v_mul_f32 v58, v58, v17
    v_mul_f32 v105, v10, v11
    v_fmac_f32 v105, v58, v94
    v_lshlrev_b32 v10, 16, v59
    v_lshlrev_b32 v11, 16, v95
    v_and_b32 v59, 0xffff0000, v59
    v_and_b32 v95, 0xffff0000, v95
    v_mul_f32 v10, v10, v18
    v_mul_f32 v59, v59, v19
    v_fmac_f32 v105, v10, v11
    v_fmac_f32 v105, v59, v95
    v_lshlrev_b32 v10, 16, v60
    v_lshlrev_b32 v11, 16, v96
    v_and_b32 v60, 0xffff0000, v60
    v_and_b32 v96, 0xffff0000, v96
    v_mul_f32 v10, v10, v20
    v_mul_f32 v60, v60, v21
    v_fmac_f32 v105, v10, v11
    v_fmac_f32 v105, v60, v96
    v_lshlrev_b32 v10, 16, v61
    v_lshlrev_b32 v11, 16, v97
    v_and_b32 v61, 0xffff0000, v61
    v_and_b32 v97, 0xffff0000, v97
    v_mul_f32 v10, v10, v22
    v_mul_f32 v61, v61, v23
    v_fmac_f32 v105, v10, v11
    v_fmac_f32 v105, v61, v97
    v_lshlrev_b32 v10, 16, v62
    v_lshlrev_b32 v11, 16, v98
    v_and_b32 v62, 0xffff0000, v62
    v_and_b32 v98, 0xffff0000, v98
    v_mul_f32 v10, v10, v24
    v_mul_f32 v62, v62, v25
    v_fmac_f32 v105, v10, v11
    v_fmac_f32 v105, v62, v98
    v_lshlrev_b32 v10, 16, v63
    v_lshlrev_b32 v11, 16, v99
    v_and_b32 v63, 0xffff0000, v63
    v_and_b32 v99, 0xffff0000, v99
    v_mul_f32 v10, v10, v26
    v_mul_f32 v63, v63, v27
    v_fmac_f32 v105, v10, v11
    v_fmac_f32 v105, v63, v99
    v_add_f32_dpp v100, v100, v100 row_ror:8 row_mask:0xf bank_mask:0xf
    v_add_f32_dpp v101, v101, v101 row_ror:8 row_mask:0xf bank_mask:0xf
    v_add_f32_dpp v102, v102, v102 row_ror:8 row_mask:0xf bank_mask:0xf
    v_add_f32_dpp v103, v103, v103 row_ror:8 row_mask:0xf bank_mask:0xf
    v_add_f32_dpp v104, v104, v104 row_ror:8 row_mask:0xf bank_mask:0xf
    v_add_f32_dpp v105, v105, v105 row_ror:8 row_mask:0xf bank_mask:0xf
    v_add_f32_dpp v100, v100, v100 row_ror:4 row_mask:0xf bank_mask:0xf
    v_add_f32_dpp v101, v101, v101 row_ror:4 row_mask:0xf bank_mask:0xf
    v_add_f32_dpp v102, v102, v102 row_ror:4 row_mask:0xf bank_mask:0xf
    v_add_f32_dpp v103, v103, v103 row_ror:4 row_mask:0xf bank_mask:0xf
    v_add_f32_dpp v104, v104, v104 row_ror:4 row_mask:0xf bank_mask:0xf
    v_add_f32_dpp v105, v105, v105 row_ror:4 row_mask:0xf bank_mask:0xf
    v_add_f32_dpp v100, v100, v100 row_ror:2 row_mask:0xf bank_mask:0xf
    v_add_f32_dpp v101, v101, v101 row_ror:2 row_mask:0xf bank_mask:0xf
    v_add_f32_dpp v102, v102, v102 row_ror:2 row_mask:0xf bank_mask:0xf
    v_add_f32_dpp v103, v103, v103 row_ror:2 row_mask:0xf bank_mask:0xf
    v_add_f32_dpp v104, v104, v104 row_ror:2 row_mask:0xf bank_mask:0xf
    v_add_f32_dpp v105, v105, v105 row_ror:2 row_mask:0xf bank_mask:0xf
    v_add_f32_dpp v100, v100, v100 row_ror:1 row_mask:0xf bank_mask:0xf
    v_add_f32_dpp v101, v101, v101 row_ror:1 row_mask:0xf bank_mask:0xf
    v_add_f32_dpp v102, v102, v102 row_ror:1 row_mask:0xf bank_mask:0xf
    v_add_f32_dpp v103, v103, v103 row_ror:1 row_mask:0xf bank_mask:0xf
    v_add_f32_dpp v104, v104, v104 row_ror:1 row_mask:0xf bank_mask:0xf
    v_add_f32_dpp v105, v105, v105 row_ror:1 row_mask:0xf bank_mask:0xf
    v_cmp_eq_u32 vcc, 1, v5
    s_nop 1
    v_cndmask_b32 v100, v100, v101, vcc
    v_cmp_eq_u32 vcc, 2, v5
    s_nop 1
    v_cndmask_b32 v100, v100, v102, vcc
    v_cmp_eq_u32 vcc, 3, v5
    s_nop 1
    v_cndmask_b32 v100, v100, v103, vcc
    v_cmp_eq_u32 vcc, 4, v5
    s_nop 1
    v_cndmask_b32 v100, v100, v104, vcc
    v_cmp_eq_u32 vcc, 5, v5
    s_nop 1
    v_cndmask_b32 v100, v100, v105, vcc
    s_mul_i32 s48, s62, 768
    s_lshl_b32 s49, s49, 2
    s_add_u32 s48, s48, s49
    s_add_u32 s48, s48, 1179648
    s_mov_b32 exec_lo, 0x003f003f
    s_mov_b32 exec_hi, 0x003f003f
    buffer_store_dword v100, v13, s[12:15], s48 offen sc1
    s_mov_b64 exec, -1
    s_mov_b32 s60, 0x100000
L_wd0:
    s_nop 1
    ds_read_b32 v10, v2 offset:20
    s_sub_u32 s60, s60, 1
    s_cbranch_scc1 L_exit1
    s_waitcnt lgkmcnt(0)
    v_readfirstlane_b32 s48, v10
    s_cmp_eq_u32 s48, 0
    s_cbranch_scc1 L_wd0
    ds_read_b128 v[16:19], v2 offset:0
    ds_read_b64 v[20:21], v2 offset:16
    s_waitcnt lgkmcnt(0)
    v_readfirstlane_b32 s84, v16
    v_readfirstlane_b32 s85, v17
    v_readfirstlane_b32 s86, v18
    v_readfirstlane_b32 s87, v19
    v_readfirstlane_b32 s88, v20
    v_readfirstlane_b32 s89, v21
    s_mov_b32 s60, 0x100000
L_wf0:
    s_nop 1
    ds_read_b32 v10, v2 offset:40
    s_sub_u32 s60, s60, 1
    s_cbranch_scc1 L_exit1
    s_waitcnt lgkmcnt(0)
    v_readfirstlane_b32 s48, v10
    s_cmp_lt_u32 s48, 4
    s_cbranch_scc1 L_wf0
    s_cmp_eq_u32 s84, s87
    ds_read_b128 v[16:19], v4 offset:256
    ds_read_b128 v[20:23], v4 offset:1280
    ds_read_b128 v[24:27], v4 offset:2304
    ds_read_b128 v[28:31], v4 offset:3328
    ds_read_b128 v[32:35], v4 offset:4352
    ds_read_b128 v[36:39], v4 offset:5376
    s_add_u32 s54, s33, 0
    s_add_u32 s55, s33, 4096
    s_cmp_eq_u32 s84, s87
    s_waitcnt lgkmcnt(0)
    s_cselect_b32 exec_lo, 0xffff, -1
    s_cselect_b32 exec_hi, 0xffff0000, -1
    buffer_store_dwordx4 v[16:19], v4, s[12:15], s54 offen offset:0 sc1
    s_cselect_b32 exec_lo, 0x0, -1
    s_cselect_b32 exec_hi, 0xffff, -1
    buffer_store_dwordx4 v[20:23], v4, s[12:15], s54 offen offset:1024 sc1
    s_cselect_b32 exec_lo, 0xffff0000, -1
    s_cselect_b32 exec_hi, 0x0, -1
    buffer_store_dwordx4 v[24:27], v4, s[12:15], s54 offen offset:2048 sc1
    s_cselect_b32 exec_lo, 0xffff, -1
    s_cselect_b32 exec_hi, 0xffff0000, -1
    buffer_store_dwordx4 v[28:31], v4, s[12:15], s54 offen offset:3072 sc1
    s_cselect_b32 exec_lo, 0x0, -1
    s_cselect_b32 exec_hi, 0xffff, -1
    buffer_store_dwordx4 v[32:35], v4, s[12:15], s55 offen offset:0 sc1
    s_cselect_b32 exec_lo, 0xffff0000, -1
    s_cselect_b32 exec_hi, 0x0, -1
    buffer_store_dwordx4 v[36:39], v4, s[12:15], s55 offen offset:1024 sc1
    s_mov_b64 exec, -1
L_fl0:
    s_nop 1
    v_mov_b32 v10, 1
    s_waitcnt vmcnt(0)
    s_mov_b64 exec, 1
    buffer_store_dword v10, off, s[12:15], s32 sc1
    ds_write_b32 v2, v10 offset:52
    s_mov_b64 exec, -1
    s_mov_b32 s60, 0x100000
L_wb2:
    s_nop 1
    ds_read_b32 v10, v2 offset:60
    s_sub_u32 s60, s60, 1
    s_cbranch_scc1 L_exit1
    s_waitcnt lgkmcnt(0)
    v_readfirstlane_b32 s48, v10
    s_cmp_lt_u32 s48, 9
    s_cbranch_scc1 L_wb2
    s_mov_b32 s61, 2
    s_lshl_b32 s62, s61, 5
    s_add_u32 s62, s62, s3
    s_lshl_b32 s63, s62, 15
    s_add_u32 s63, s63, 1
    s_mul_hi_u32 s63, s63, 0xaaaaaaab
    s_lshr_b32 s63, s63, 7
    s_mul_i32 s48, s62, 171
    s_lshr_b32 s48, s48, 9
    s_mul_i32 s48, s48, 384
    s_mul_i32 s49, s4, 24
    s_add_u32 s50, s49, s63
    s_mul_i32 s50, s50, 384
    v_add_u32 v10, s50, v7
    v_add_u32 v11, 3072, v10
    v_add_u32 v12, 6144, v10
    buffer_load_dwordx2 v[100:101], v6, s[8:11], s48 offen offset:0
    buffer_load_dwordx2 v[102:103], v6, s[8:11], s48 offen offset:128
    buffer_load_dwordx2 v[104:105], v6, s[8:11], s48 offen offset:256
    buffer_load_dwordx2 v[28:29], v10, s[92:95], 0 offen offset:0
    buffer_load_dwordx2 v[30:31], v10, s[92:95], 0 offen offset:128
    buffer_load_dwordx2 v[32:33], v10, s[92:95], 0 offen offset:256
    buffer_load_dwordx2 v[64:65], v10, s[96:99], 0 offen offset:0
    buffer_load_dwordx2 v[66:67], v10, s[96:99], 0 offen offset:128
    buffer_load_dwordx2 v[68:69], v10, s[96:99], 0 offen offset:256
    buffer_load_dwordx2 v[34:35], v10, s[92:95], 0 offen offset:1536
    buffer_load_dwordx2 v[36:37], v10, s[92:95], 0 offen offset:1664
    buffer_load_dwordx2 v[38:39], v10, s[92:95], 0 offen offset:1792
    buffer_load_dwordx2 v[70:71], v10, s[96:99], 0 offen offset:1536
    buffer_load_dwordx2 v[72:73], v10, s[96:99], 0 offen offset:1664
    buffer_load_dwordx2 v[74:75], v10, s[96:99], 0 offen offset:1792
    buffer_load_dwordx2 v[40:41], v11, s[92:95], 0 offen offset:0
    buffer_load_dwordx2 v[42:43], v11, s[92:95], 0 offen offset:128
    buffer_load_dwordx2 v[44:45], v11, s[92:95], 0 offen offset:256
    buffer_load_dwordx2 v[76:77], v11, s[96:99], 0 offen offset:0
    buffer_load_dwordx2 v[78:79], v11, s[96:99], 0 offen offset:128
    buffer_load_dwordx2 v[80:81], v11, s[96:99], 0 offen offset:256
    buffer_load_dwordx2 v[46:47], v11, s[92:95], 0 offen offset:1536
    buffer_load_dwordx2 v[48:49], v11, s[92:95], 0 offen offset:1664
    buffer_load_dwordx2 v[50:51], v11, s[92:95], 0 offen offset:1792
    buffer_load_dwordx2 v[82:83], v11, s[96:99], 0 offen offset:1536
    buffer_load_dwordx2 v[84:85], v11, s[96:99], 0 offen offset:1664
    buffer_load_dwordx2 v[86:87], v11, s[96:99], 0 offen offset:1792
    buffer_load_dwordx2 v[52:53], v12, s[92:95], 0 offen offset:0
    buffer_load_dwordx2 v[54:55], v12, s[92:95], 0 offen offset:128
    buffer_load_dwordx2 v[56:57], v12, s[92:95], 0 offen offset:256
    buffer_load_dwordx2 v[88:89], v12, s[96:99], 0 offen offset:0
    buffer_load_dwordx2 v[90:91], v12, s[96:99], 0 offen offset:128
    buffer_load_dwordx2 v[92:93], v12, s[96:99], 0 offen offset:256
    buffer_load_dwordx2 v[58:59], v12, s[92:95], 0 offen offset:1536
    buffer_load_dwordx2 v[60:61], v12, s[92:95], 0 offen offset:1664
    buffer_load_dwordx2 v[62:63], v12, s[92:95], 0 offen offset:1792
    buffer_load_dwordx2 v[94:95], v12, s[96:99], 0 offen offset:1536
    buffer_load_dwordx2 v[96:97], v12, s[96:99], 0 offen offset:1664
    buffer_load_dwordx2 v[98:99], v12, s[96:99], 0 offen offset:1792
    s_waitcnt vmcnt(0)
    v_lshlrev_b32 v16, 16, v100
    v_and_b32 v17, 0xffff0000, v100
    v_lshlrev_b32 v18, 16, v101
    v_and_b32 v19, 0xffff0000, v101
    v_lshlrev_b32 v20, 16, v102
    v_and_b32 v21, 0xffff0000, v102
    v_lshlrev_b32 v22, 16, v103
    v_and_b32 v23, 0xffff0000, v103
    v_lshlrev_b32 v24, 16, v104
    v_and_b32 v25, 0xffff0000, v104
    v_lshlrev_b32 v26, 16, v105
    v_and_b32 v27, 0xffff0000, v105
    v_lshlrev_b32 v10, 16, v28
    v_lshlrev_b32 v11, 16, v64
    v_and_b32 v28, 0xffff0000, v28
    v_and_b32 v64, 0xffff0000, v64
    v_mul_f32 v10, v10, v16
    v_mul_f32 v28, v28, v17
    v_mul_f32 v100, v10, v11
    v_fmac_f32 v100, v28, v64
    v_lshlrev_b32 v10, 16, v29
    v_lshlrev_b32 v11, 16, v65
    v_and_b32 v29, 0xffff0000, v29
    v_and_b32 v65, 0xffff0000, v65
    v_mul_f32 v10, v10, v18
    v_mul_f32 v29, v29, v19
    v_fmac_f32 v100, v10, v11
    v_fmac_f32 v100, v29, v65
    v_lshlrev_b32 v10, 16, v30
    v_lshlrev_b32 v11, 16, v66
    v_and_b32 v30, 0xffff0000, v30
    v_and_b32 v66, 0xffff0000, v66
    v_mul_f32 v10, v10, v20
    v_mul_f32 v30, v30, v21
    v_fmac_f32 v100, v10, v11
    v_fmac_f32 v100, v30, v66
    v_lshlrev_b32 v10, 16, v31
    v_lshlrev_b32 v11, 16, v67
    v_and_b32 v31, 0xffff0000, v31
    v_and_b32 v67, 0xffff0000, v67
    v_mul_f32 v10, v10, v22
    v_mul_f32 v31, v31, v23
    v_fmac_f32 v100, v10, v11
    v_fmac_f32 v100, v31, v67
    v_lshlrev_b32 v10, 16, v32
    v_lshlrev_b32 v11, 16, v68
    v_and_b32 v32, 0xffff0000, v32
    v_and_b32 v68, 0xffff0000, v68
    v_mul_f32 v10, v10, v24
    v_mul_f32 v32, v32, v25
    v_fmac_f32 v100, v10, v11
    v_fmac_f32 v100, v32, v68
    v_lshlrev_b32 v10, 16, v33
    v_lshlrev_b32 v11, 16, v69
    v_and_b32 v33, 0xffff0000, v33
    v_and_b32 v69, 0xffff0000, v69
    v_mul_f32 v10, v10, v26
    v_mul_f32 v33, v33, v27
    v_fmac_f32 v100, v10, v11
    v_fmac_f32 v100, v33, v69
    v_lshlrev_b32 v10, 16, v34
    v_lshlrev_b32 v11, 16, v70
    v_and_b32 v34, 0xffff0000, v34
    v_and_b32 v70, 0xffff0000, v70
    v_mul_f32 v10, v10, v16
    v_mul_f32 v34, v34, v17
    v_mul_f32 v101, v10, v11
    v_fmac_f32 v101, v34, v70
    v_lshlrev_b32 v10, 16, v35
    v_lshlrev_b32 v11, 16, v71
    v_and_b32 v35, 0xffff0000, v35
    v_and_b32 v71, 0xffff0000, v71
    v_mul_f32 v10, v10, v18
    v_mul_f32 v35, v35, v19
    v_fmac_f32 v101, v10, v11
    v_fmac_f32 v101, v35, v71
    v_lshlrev_b32 v10, 16, v36
    v_lshlrev_b32 v11, 16, v72
    v_and_b32 v36, 0xffff0000, v36
    v_and_b32 v72, 0xffff0000, v72
    v_mul_f32 v10, v10, v20
    v_mul_f32 v36, v36, v21
    v_fmac_f32 v101, v10, v11
    v_fmac_f32 v101, v36, v72
    v_lshlrev_b32 v10, 16, v37
    v_lshlrev_b32 v11, 16, v73
    v_and_b32 v37, 0xffff0000, v37
    v_and_b32 v73, 0xffff0000, v73
    v_mul_f32 v10, v10, v22
    v_mul_f32 v37, v37, v23
    v_fmac_f32 v101, v10, v11
    v_fmac_f32 v101, v37, v73
    v_lshlrev_b32 v10, 16, v38
    v_lshlrev_b32 v11, 16, v74
    v_and_b32 v38, 0xffff0000, v38
    v_and_b32 v74, 0xffff0000, v74
    v_mul_f32 v10, v10, v24
    v_mul_f32 v38, v38, v25
    v_fmac_f32 v101, v10, v11
    v_fmac_f32 v101, v38, v74
    v_lshlrev_b32 v10, 16, v39
    v_lshlrev_b32 v11, 16, v75
    v_and_b32 v39, 0xffff0000, v39
    v_and_b32 v75, 0xffff0000, v75
    v_mul_f32 v10, v10, v26
    v_mul_f32 v39, v39, v27
    v_fmac_f32 v101, v10, v11
    v_fmac_f32 v101, v39, v75
    v_lshlrev_b32 v10, 16, v40
    v_lshlrev_b32 v11, 16, v76
    v_and_b32 v40, 0xffff0000, v40
    v_and_b32 v76, 0xffff0000, v76
    v_mul_f32 v10, v10, v16
    v_mul_f32 v40, v40, v17
    v_mul_f32 v102, v10, v11
    v_fmac_f32 v102, v40, v76
    v_lshlrev_b32 v10, 16, v41
    v_lshlrev_b32 v11, 16, v77
    v_and_b32 v41, 0xffff0000, v41
    v_and_b32 v77, 0xffff0000, v77
    v_mul_f32 v10, v10, v18
    v_mul_f32 v41, v41, v19
    v_fmac_f32 v102, v10, v11
    v_fmac_f32 v102, v41, v77
    v_lshlrev_b32 v10, 16, v42
    v_lshlrev_b32 v11, 16, v78
    v_and_b32 v42, 0xffff0000, v42
    v_and_b32 v78, 0xffff0000, v78
    v_mul_f32 v10, v10, v20
    v_mul_f32 v42, v42, v21
    v_fmac_f32 v102, v10, v11
    v_fmac_f32 v102, v42, v78
    v_lshlrev_b32 v10, 16, v43
    v_lshlrev_b32 v11, 16, v79
    v_and_b32 v43, 0xffff0000, v43
    v_and_b32 v79, 0xffff0000, v79
    v_mul_f32 v10, v10, v22
    v_mul_f32 v43, v43, v23
    v_fmac_f32 v102, v10, v11
    v_fmac_f32 v102, v43, v79
    v_lshlrev_b32 v10, 16, v44
    v_lshlrev_b32 v11, 16, v80
    v_and_b32 v44, 0xffff0000, v44
    v_and_b32 v80, 0xffff0000, v80
    v_mul_f32 v10, v10, v24
    v_mul_f32 v44, v44, v25
    v_fmac_f32 v102, v10, v11
    v_fmac_f32 v102, v44, v80
    v_lshlrev_b32 v10, 16, v45
    v_lshlrev_b32 v11, 16, v81
    v_and_b32 v45, 0xffff0000, v45
    v_and_b32 v81, 0xffff0000, v81
    v_mul_f32 v10, v10, v26
    v_mul_f32 v45, v45, v27
    v_fmac_f32 v102, v10, v11
    v_fmac_f32 v102, v45, v81
    v_lshlrev_b32 v10, 16, v46
    v_lshlrev_b32 v11, 16, v82
    v_and_b32 v46, 0xffff0000, v46
    v_and_b32 v82, 0xffff0000, v82
    v_mul_f32 v10, v10, v16
    v_mul_f32 v46, v46, v17
    v_mul_f32 v103, v10, v11
    v_fmac_f32 v103, v46, v82
    v_lshlrev_b32 v10, 16, v47
    v_lshlrev_b32 v11, 16, v83
    v_and_b32 v47, 0xffff0000, v47
    v_and_b32 v83, 0xffff0000, v83
    v_mul_f32 v10, v10, v18
    v_mul_f32 v47, v47, v19
    v_fmac_f32 v103, v10, v11
    v_fmac_f32 v103, v47, v83
    v_lshlrev_b32 v10, 16, v48
    v_lshlrev_b32 v11, 16, v84
    v_and_b32 v48, 0xffff0000, v48
    v_and_b32 v84, 0xffff0000, v84
    v_mul_f32 v10, v10, v20
    v_mul_f32 v48, v48, v21
    v_fmac_f32 v103, v10, v11
    v_fmac_f32 v103, v48, v84
    v_lshlrev_b32 v10, 16, v49
    v_lshlrev_b32 v11, 16, v85
    v_and_b32 v49, 0xffff0000, v49
    v_and_b32 v85, 0xffff0000, v85
    v_mul_f32 v10, v10, v22
    v_mul_f32 v49, v49, v23
    v_fmac_f32 v103, v10, v11
    v_fmac_f32 v103, v49, v85
    v_lshlrev_b32 v10, 16, v50
    v_lshlrev_b32 v11, 16, v86
    v_and_b32 v50, 0xffff0000, v50
    v_and_b32 v86, 0xffff0000, v86
    v_mul_f32 v10, v10, v24
    v_mul_f32 v50, v50, v25
    v_fmac_f32 v103, v10, v11
    v_fmac_f32 v103, v50, v86
    v_lshlrev_b32 v10, 16, v51
    v_lshlrev_b32 v11, 16, v87
    v_and_b32 v51, 0xffff0000, v51
    v_and_b32 v87, 0xffff0000, v87
    v_mul_f32 v10, v10, v26
    v_mul_f32 v51, v51, v27
    v_fmac_f32 v103, v10, v11
    v_fmac_f32 v103, v51, v87
    v_lshlrev_b32 v10, 16, v52
    v_lshlrev_b32 v11, 16, v88
    v_and_b32 v52, 0xffff0000, v52
    v_and_b32 v88, 0xffff0000, v88
    v_mul_f32 v10, v10, v16
    v_mul_f32 v52, v52, v17
    v_mul_f32 v104, v10, v11
    v_fmac_f32 v104, v52, v88
    v_lshlrev_b32 v10, 16, v53
    v_lshlrev_b32 v11, 16, v89
    v_and_b32 v53, 0xffff0000, v53
    v_and_b32 v89, 0xffff0000, v89
    v_mul_f32 v10, v10, v18
    v_mul_f32 v53, v53, v19
    v_fmac_f32 v104, v10, v11
    v_fmac_f32 v104, v53, v89
    v_lshlrev_b32 v10, 16, v54
    v_lshlrev_b32 v11, 16, v90
    v_and_b32 v54, 0xffff0000, v54
    v_and_b32 v90, 0xffff0000, v90
    v_mul_f32 v10, v10, v20
    v_mul_f32 v54, v54, v21
    v_fmac_f32 v104, v10, v11
    v_fmac_f32 v104, v54, v90
    v_lshlrev_b32 v10, 16, v55
    v_lshlrev_b32 v11, 16, v91
    v_and_b32 v55, 0xffff0000, v55
    v_and_b32 v91, 0xffff0000, v91
    v_mul_f32 v10, v10, v22
    v_mul_f32 v55, v55, v23
    v_fmac_f32 v104, v10, v11
    v_fmac_f32 v104, v55, v91
    v_lshlrev_b32 v10, 16, v56
    v_lshlrev_b32 v11, 16, v92
    v_and_b32 v56, 0xffff0000, v56
    v_and_b32 v92, 0xffff0000, v92
    v_mul_f32 v10, v10, v24
    v_mul_f32 v56, v56, v25
    v_fmac_f32 v104, v10, v11
    v_fmac_f32 v104, v56, v92
    v_lshlrev_b32 v10, 16, v57
    v_lshlrev_b32 v11, 16, v93
    v_and_b32 v57, 0xffff0000, v57
    v_and_b32 v93, 0xffff0000, v93
    v_mul_f32 v10, v10, v26
    v_mul_f32 v57, v57, v27
    v_fmac_f32 v104, v10, v11
    v_fmac_f32 v104, v57, v93
    v_lshlrev_b32 v10, 16, v58
    v_lshlrev_b32 v11, 16, v94
    v_and_b32 v58, 0xffff0000, v58
    v_and_b32 v94, 0xffff0000, v94
    v_mul_f32 v10, v10, v16
    v_mul_f32 v58, v58, v17
    v_mul_f32 v105, v10, v11
    v_fmac_f32 v105, v58, v94
    v_lshlrev_b32 v10, 16, v59
    v_lshlrev_b32 v11, 16, v95
    v_and_b32 v59, 0xffff0000, v59
    v_and_b32 v95, 0xffff0000, v95
    v_mul_f32 v10, v10, v18
    v_mul_f32 v59, v59, v19
    v_fmac_f32 v105, v10, v11
    v_fmac_f32 v105, v59, v95
    v_lshlrev_b32 v10, 16, v60
    v_lshlrev_b32 v11, 16, v96
    v_and_b32 v60, 0xffff0000, v60
    v_and_b32 v96, 0xffff0000, v96
    v_mul_f32 v10, v10, v20
    v_mul_f32 v60, v60, v21
    v_fmac_f32 v105, v10, v11
    v_fmac_f32 v105, v60, v96
    v_lshlrev_b32 v10, 16, v61
    v_lshlrev_b32 v11, 16, v97
    v_and_b32 v61, 0xffff0000, v61
    v_and_b32 v97, 0xffff0000, v97
    v_mul_f32 v10, v10, v22
    v_mul_f32 v61, v61, v23
    v_fmac_f32 v105, v10, v11
    v_fmac_f32 v105, v61, v97
    v_lshlrev_b32 v10, 16, v62
    v_lshlrev_b32 v11, 16, v98
    v_and_b32 v62, 0xffff0000, v62
    v_and_b32 v98, 0xffff0000, v98
    v_mul_f32 v10, v10, v24
    v_mul_f32 v62, v62, v25
    v_fmac_f32 v105, v10, v11
    v_fmac_f32 v105, v62, v98
    v_lshlrev_b32 v10, 16, v63
    v_lshlrev_b32 v11, 16, v99
    v_and_b32 v63, 0xffff0000, v63
    v_and_b32 v99, 0xffff0000, v99
    v_mul_f32 v10, v10, v26
    v_mul_f32 v63, v63, v27
    v_fmac_f32 v105, v10, v11
    v_fmac_f32 v105, v63, v99
    v_add_f32_dpp v100, v100, v100 row_ror:8 row_mask:0xf bank_mask:0xf
    v_add_f32_dpp v101, v101, v101 row_ror:8 row_mask:0xf bank_mask:0xf
    v_add_f32_dpp v102, v102, v102 row_ror:8 row_mask:0xf bank_mask:0xf
    v_add_f32_dpp v103, v103, v103 row_ror:8 row_mask:0xf bank_mask:0xf
    v_add_f32_dpp v104, v104, v104 row_ror:8 row_mask:0xf bank_mask:0xf
    v_add_f32_dpp v105, v105, v105 row_ror:8 row_mask:0xf bank_mask:0xf
    v_add_f32_dpp v100, v100, v100 row_ror:4 row_mask:0xf bank_mask:0xf
    v_add_f32_dpp v101, v101, v101 row_ror:4 row_mask:0xf bank_mask:0xf
    v_add_f32_dpp v102, v102, v102 row_ror:4 row_mask:0xf bank_mask:0xf
    v_add_f32_dpp v103, v103, v103 row_ror:4 row_mask:0xf bank_mask:0xf
    v_add_f32_dpp v104, v104, v104 row_ror:4 row_mask:0xf bank_mask:0xf
    v_add_f32_dpp v105, v105, v105 row_ror:4 row_mask:0xf bank_mask:0xf
    v_add_f32_dpp v100, v100, v100 row_ror:2 row_mask:0xf bank_mask:0xf
    v_add_f32_dpp v101, v101, v101 row_ror:2 row_mask:0xf bank_mask:0xf
    v_add_f32_dpp v102, v102, v102 row_ror:2 row_mask:0xf bank_mask:0xf
    v_add_f32_dpp v103, v103, v103 row_ror:2 row_mask:0xf bank_mask:0xf
    v_add_f32_dpp v104, v104, v104 row_ror:2 row_mask:0xf bank_mask:0xf
    v_add_f32_dpp v105, v105, v105 row_ror:2 row_mask:0xf bank_mask:0xf
    v_add_f32_dpp v100, v100, v100 row_ror:1 row_mask:0xf bank_mask:0xf
    v_add_f32_dpp v101, v101, v101 row_ror:1 row_mask:0xf bank_mask:0xf
    v_add_f32_dpp v102, v102, v102 row_ror:1 row_mask:0xf bank_mask:0xf
    v_add_f32_dpp v103, v103, v103 row_ror:1 row_mask:0xf bank_mask:0xf
    v_add_f32_dpp v104, v104, v104 row_ror:1 row_mask:0xf bank_mask:0xf
    v_add_f32_dpp v105, v105, v105 row_ror:1 row_mask:0xf bank_mask:0xf
    v_cmp_eq_u32 vcc, 1, v5
    s_nop 1
    v_cndmask_b32 v100, v100, v101, vcc
    v_cmp_eq_u32 vcc, 2, v5
    s_nop 1
    v_cndmask_b32 v100, v100, v102, vcc
    v_cmp_eq_u32 vcc, 3, v5
    s_nop 1
    v_cndmask_b32 v100, v100, v103, vcc
    v_cmp_eq_u32 vcc, 4, v5
    s_nop 1
    v_cndmask_b32 v100, v100, v104, vcc
    v_cmp_eq_u32 vcc, 5, v5
    s_nop 1
    v_cndmask_b32 v100, v100, v105, vcc
    s_mul_i32 s48, s62, 768
    s_lshl_b32 s49, s49, 2
    s_add_u32 s48, s48, s49
    s_add_u32 s48, s48, 1179648
    s_mov_b32 exec_lo, 0x003f003f
    s_mov_b32 exec_hi, 0x003f003f
    buffer_store_dword v100, v13, s[12:15], s48 offen sc1
    s_mov_b64 exec, -1
    s_mov_b32 s60, 0x100000
L_wf1:
    s_nop 1
    ds_read_b32 v10, v2 offset:44
    s_sub_u32 s60, s60, 1
    s_cbranch_scc1 L_exit1
    s_waitcnt lgkmcnt(0)
    v_readfirstlane_b32 s48, v10
    s_cmp_lt_u32 s48, 4
    s_cbranch_scc1 L_wf1
    s_cmp_eq_u32 s85, s88
    s_cbranch_scc1 L_fl1
    ds_read_b128 v[16:19], v4 offset:6400
    ds_read_b128 v[20:23], v4 offset:7424
    ds_read_b128 v[24:27], v4 offset:8448
    ds_read_b128 v[28:31], v4 offset:9472
    ds_read_b128 v[32:35], v4 offset:10496
    ds_read_b128 v[36:39], v4 offset:11520
    s_add_u32 s54, s33, 1572864
    s_add_u32 s55, s33, 1576960
    s_cmp_eq_u32 s85, s88
    s_waitcnt lgkmcnt(0)
    buffer_store_dwordx4 v[16:19], v4, s[12:15], s54 offen offset:0 sc1
    buffer_store_dwordx4 v[20:23], v4, s[12:15], s54 offen offset:1024 sc1
    buffer_store_dwordx4 v[24:27], v4, s[12:15], s54 offen offset:2048 sc1
    buffer_store_dwordx4 v[28:31], v4, s[12:15], s54 offen offset:3072 sc1
    buffer_store_dwordx4 v[32:35], v4, s[12:15], s55 offen offset:0 sc1
    buffer_store_dwordx4 v[36:39], v4, s[12:15], s55 offen offset:1024 sc1
L_fl1:
    s_nop 1
    v_mov_b32 v10, 2
    s_waitcnt vmcnt(0)
    s_mov_b64 exec, 1
    buffer_store_dword v10, off, s[12:15], s32 sc1
    ds_write_b32 v2, v10 offset:52
    s_mov_b64 exec, -1
    s_mov_b32 s60, 0x100000
L_wf2:
    s_nop 1
    ds_read_b32 v10, v2 offset:48
    s_sub_u32 s60, s60, 1
    s_cbranch_scc1 L_exit1
    s_waitcnt lgkmcnt(0)
    v_readfirstlane_b32 s48, v10
    s_cmp_lt_u32 s48, 4
    s_cbranch_scc1 L_wf2
    s_cmp_eq_u32 s86, s89
    s_cbranch_scc1 L_fl2
    ds_read_b128 v[16:19], v4 offset:12544
    ds_read_b128 v[20:23], v4 offset:13568
    ds_read_b128 v[24:27], v4 offset:14592
    ds_read_b128 v[28:31], v4 offset:15616
    ds_read_b128 v[32:35], v4 offset:16640
    ds_read_b128 v[36:39], v4 offset:17664
    s_add_u32 s54, s33, 3145728
    s_add_u32 s55, s33, 3149824
    s_cmp_eq_u32 s86, s89
    s_waitcnt lgkmcnt(0)
    buffer_store_dwordx4 v[16:19], v4, s[12:15], s54 offen offset:0 sc1
    buffer_store_dwordx4 v[20:23], v4, s[12:15], s54 offen offset:1024 sc1
    buffer_store_dwordx4 v[24:27], v4, s[12:15], s54 offen offset:2048 sc1
    buffer_store_dwordx4 v[28:31], v4, s[12:15], s54 offen offset:3072 sc1
    buffer_store_dwordx4 v[32:35], v4, s[12:15], s55 offen offset:0 sc1
    buffer_store_dwordx4 v[36:39], v4, s[12:15], s55 offen offset:1024 sc1
L_fl2:
    s_nop 1
    v_mov_b32 v10, 3
    s_waitcnt vmcnt(0)
    s_mov_b64 exec, 1
    s_cbranch_scc1 L_fn2
    buffer_store_dword v10, off, s[12:15], s32 sc1
L_fn2:
    s_nop 1
    ds_write_b32 v2, v10 offset:52
    s_mov_b64 exec, -1
    s_endpgm
L_h3:
    s_nop 1
    s_waitcnt lgkmcnt(0)
    s_mov_b32 s12, s82
    s_and_b32 s13, s83, 0xffff
    s_mov_b32 s14, 10485760
    s_mov_b32 s15, 0x00020000
    s_barrier
    v_lshlrev_b32 v7, 2, v1
    s_mul_i32 s20, s4, 4352
    s_add_u32 s20, s20, 10223616
    s_lshl_b32 s21, s3, 2
    s_add_u32 s21, s21, s20
    s_mov_b32 s46, 0x155
    v_lshrrev_b32 v13, 2, v1
    v_mul_u32_u24 v13, 4352, v13
    v_and_or_b32 v13, v7, 12, v13
    s_and_b32 s7, s4, 3
    s_mul_i32 s47, s7, 4352
    s_lshl_b32 s7, s7, 2
    v_mov_b32 v8, 208
    s_mov_b32 s45, 2
    v_mov_b32 v3, 144
    v_bfrev_b32 v6, -2
    s_mov_b32 exec_hi, 0
L_h3loop:
    s_nop 1
    s_mov_b32 s60, 0x100000
L_wp1:
    s_nop 1
    ds_read_b32 v10, v2 offset:128
    s_sub_u32 s60, s60, 1
    s_cbranch_scc1 L_exit1
    s_waitcnt lgkmcnt(0)
    v_readfirstlane_b32 s48, v10
    s_cmp_lt_u32 s48, s45
    s_cbranch_scc1 L_wp1
    s_memrealtime s[40:41]
    s_add_u32 s45, s45, 3
    s_mov_b32 exec_lo, 1
    s_waitcnt lgkmcnt(0)
    v_mov_b32 v5, s40
    buffer_store_dword v5, off, s[12:15], s21
    s_mov_b32 exec_lo, -1
    s_mov_b32 s60, 0x100000
L_wp2:
    s_nop 1
    ds_read_b32 v10, v2 offset:128
    s_sub_u32 s60, s60, 1
    s_cbranch_scc1 L_exit1
    s_waitcnt lgkmcnt(0)
    v_readfirstlane_b32 s48, v10
    s_cmp_lt_u32 s48, s45
    s_cbranch_scc1 L_wp2
    buffer_load_dword v5, v7, s[12:15], s20 offen sc0
    s_add_u32 s45, s45, 4
    s_sub_u32 s40, s40, 4096
    s_waitcnt vmcnt(0)
    v_subrev_u32 v5, s40, v5
    v_cmp_gt_u32 vcc, 8192, v5
    s_nop 1
    v_cndmask_b32 v5, v6, v5, vcc
    s_mov_b32 s48, 2048
    s_add_u32 s49, s48, 2048
    v_cmp_gt_u32 vcc, s49, v5
    s_bcnt1_i32_b64 s50, vcc
    s_cmp_lt_u32 s50, 16
    s_cselect_b32 s48, s49, s48
    s_add_u32 s49, s48, 1024
    v_cmp_gt_u32 vcc, s49, v5
    s_bcnt1_i32_b64 s50, vcc
    s_cmp_lt_u32 s50, 16
    s_cselect_b32 s48, s49, s48
    s_add_u32 s49, s48, 512
    v_cmp_gt_u32 vcc, s49, v5
    s_bcnt1_i32_b64 s50, vcc
    s_cmp_lt_u32 s50, 16
    s_cselect_b32 s48, s49, s48
    s_add_u32 s49, s48, 256
    v_cmp_gt_u32 vcc, s49, v5
    s_bcnt1_i32_b64 s50, vcc
    s_cmp_lt_u32 s50, 16
    s_cselect_b32 s48, s49, s48
    s_add_u32 s49, s48, 128
    v_cmp_gt_u32 vcc, s49, v5
    s_bcnt1_i32_b64 s50, vcc
    s_cmp_lt_u32 s50, 16
    s_cselect_b32 s48, s49, s48
    s_add_u32 s49, s48, 64
    v_cmp_gt_u32 vcc, s49, v5
    s_bcnt1_i32_b64 s50, vcc
    s_cmp_lt_u32 s50, 16
    s_cselect_b32 s48, s49, s48
    s_add_u32 s49, s48, 32
    v_cmp_gt_u32 vcc, s49, v5
    s_bcnt1_i32_b64 s50, vcc
    s_cmp_lt_u32 s50, 16
    s_cselect_b32 s48, s49, s48
    s_add_u32 s49, s48, 16
    v_cmp_gt_u32 vcc, s49, v5
    s_bcnt1_i32_b64 s50, vcc
    s_cmp_lt_u32 s50, 16
    s_cselect_b32 s48, s49, s48
    s_add_u32 s49, s48, 8
    v_cmp_gt_u32 vcc, s49, v5
    s_bcnt1_i32_b64 s50, vcc
    s_cmp_lt_u32 s50, 16
    s_cselect_b32 s48, s49, s48
    s_add_u32 s49, s48, s40
    s_or_b32 s49, s49, 1
    v_mov_b32 v5, s49
    ds_write_b32 v3, v5
    v_add_u32 v3, 4, v3
    s_bitcmp1_b32 s46, 0
    s_cbranch_scc0 L_h3ng
    s_cmp_lt_u32 s48, 6136
    s_cselect_b32 exec_lo, 1, 0
    s_cmp_lt_u32 s3, 4
    s_cselect_b32 exec_lo, exec_lo, 0
    buffer_store_dword v5, off, s[12:15], s21 offset:2048 sc1
    s_mov_b32 exec_lo, 0xffff
    s_add_u32 s51, s45, 0
    s_mov_b32 s60, 0x100000
L_wp3:
    s_nop 1
    ds_read_b32 v10, v2 offset:128
    s_sub_u32 s60, s60, 1
    s_cbranch_scc1 L_exit1
    s_waitcnt lgkmcnt(0)
    v_readfirstlane_b32 s48, v10
    s_cmp_lt_u32 s48, s51
    s_cbranch_scc1 L_wp3
    s_sub_u32 s51, s20, s47
    s_mov_b32 s60, 8
    s_mov_b32 s48, 0
L_h3gp:
    s_nop 1
    buffer_load_dword v4, v13, s[12:15], s51 offen offset:2048 sc1
    s_sub_u32 s60, s60, 1
    s_cbranch_scc1 L_h3gw
L_h3gq:
    s_waitcnt vmcnt(0)
    v_subrev_u32 v4, s40, v4
    v_cmp_gt_u32 vcc, 8192, v4
    s_nop 1
    v_cndmask_b32 v4, v6, v4, vcc
    s_nop 1
    v_min_u32_dpp v4, v4, v4 quad_perm:[1,0,3,2] row_mask:0xf bank_mask:0xf
    s_nop 1
    v_min_u32_dpp v4, v4, v4 quad_perm:[2,3,0,1] row_mask:0xf bank_mask:0xf
    v_cmp_eq_u32 vcc, v6, v4
    s_cbranch_vccnz L_h3gp
    v_readlane_b32 s52, v4, 0
    v_readlane_b32 s53, v4, 4
    v_readlane_b32 s54, v4, 8
    v_readlane_b32 s55, v4, 12
    v_readlane_b32 s49, v4, s7
    s_max_u32 s52, s52, s53
    s_max_u32 s54, s54, s55
    s_max_u32 s48, s52, s54
    s_sub_u32 s48, s48, s49
    s_sub_u32 s48, s48, 25
    s_max_i32 s48, s48, 0
    s_min_i32 s48, s48, 1000
L_h3gw:
    s_nop 1
    s_or_b32 s48, s48, 0x10000
    v_mov_b32 v5, s48
    ds_write_b32 v8, v5
    s_mov_b32 exec_lo, -1
    v_add_u32 v8, 4, v8
    s_waitcnt vmcnt(0)
L_h3ng:
    s_nop 1
    s_lshr_b32 s46, s46, 1
    s_add_u32 s45, s45, 5
    s_add_u32 s20, s20, 128
    s_add_u32 s21, s21, 128
    s_cmp_lt_u32 s45, 132
    s_cbranch_scc1 L_h3loop
    s_mov_b64 exec, -1
    v_lshlrev_b32 v12, 2, v1
    v_add_u32 v13, 49408, v12
    v_lshlrev_b32 v8, 4, v1
    s_add_u32 s48, s3, 64
    s_mul_i32 s48, s48, 171
    s_lshr_b32 s48, s48, 9
    s_mul_i32 s58, s48, 4352
    s_add_u32 s58, s58, 9454848
    s_mul_i32 s59, s48, 384
    s_cmp_eq_u32 s48, 21
    s_cselect_b32 s20, 15, 23
    s_mul_i32 s48, s48, 24
    s_add_u32 s62, s2, 512
    s_sub_u32 s56, s62, s48
    s_lshl_b32 s62, s62, 10
    s_mov_b32 s60, 0x40000
L_fs:
    s_nop 1
    buffer_load_dword v4, off, s[12:15], s58 offset:4 sc1
    s_sub_u32 s60, s60, 1
    s_cbranch_scc1 L_exit1
    s_waitcnt vmcnt(0)
    v_cmp_eq_u32 vcc, 0, v4
    s_cbranch_vccnz L_fs
    buffer_load_dword v10, v12, s[12:15], s58 offen offset:128 sc1
    ds_read_b128 v[4:7], v2 offset:112
    v_xor_b32 v11, 1, v1
    v_cmp_eq_u32 vcc, s56, v1
    s_nop 1
    v_cndmask_b32 v11, v1, v11, vcc
    v_add_u32 v11, s48, v11
    v_lshlrev_b32 v11, 10, v11
    s_nop 0
    v_readlane_b32 s64, v11, 0
    v_readlane_b32 s65, v11, 1
    v_readlane_b32 s66, v11, 2
    v_readlane_b32 s67, v11, 3
    v_readlane_b32 s68, v11, 4
    v_readlane_b32 s69, v11, 5
    v_readlane_b32 s70, v11, 6
    v_readlane_b32 s71, v11, 7
    v_readlane_b32 s72, v11, 8
    v_readlane_b32 s73, v11, 9
    v_readlane_b32 s74, v11, 10
    v_readlane_b32 s75, v11, 11
    v_readlane_b32 s84, v11, 12
    v_readlane_b32 s85, v11, 13
    v_readlane_b32 s86, v11, 14
    v_readlane_b32 s87, v11, 15
    v_readlane_b32 s88, v11, 16
    v_readlane_b32 s89, v11, 17
    v_readlane_b32 s90, v11, 18
    v_readlane_b32 s91, v11, 19
    v_readlane_b32 s92, v11, 20
    v_readlane_b32 s93, v11, 21
    v_readlane_b32 s94, v11, 22
    v_readlane_b32 s95, v11, 23
    s_mov_b32 s96, s78
    s_and_b32 s97, s79, 0xffff
    s_mov_b32 s98, 12288
    s_mov_b32 s99, 0x00020000
    v_lshlrev_b32 v12, 1, v1
    s_waitcnt vmcnt(0)
    v_readlane_b32 s57, v10, s56
    v_cndmask_b32 v10, v10, v2, vcc
    s_nop 0
    v_readlane_b32 s24, v10, 0
    v_readlane_b32 s25, v10, 1
    v_readlane_b32 s26, v10, 2
    v_readlane_b32 s27, v10, 3
    v_readlane_b32 s28, v10, 4
    v_readlane_b32 s29, v10, 5
    v_readlane_b32 s30, v10, 6
    v_readlane_b32 s31, v10, 7
    v_readlane_b32 s32, v10, 8
    v_readlane_b32 s33, v10, 9
    v_readlane_b32 s34, v10, 10
    v_readlane_b32 s35, v10, 11
    v_readlane_b32 s36, v10, 12
    v_readlane_b32 s37, v10, 13
    v_readlane_b32 s38, v10, 14
    v_readlane_b32 s39, v10, 15
    v_readlane_b32 s40, v10, 16
    v_readlane_b32 s41, v10, 17
    v_readlane_b32 s42, v10, 18
    v_readlane_b32 s43, v10, 19
    v_readlane_b32 s44, v10, 20
    v_readlane_b32 s45, v10, 21
    v_readlane_b32 s46, v10, 22
    v_readlane_b32 s47, v10, 23
    v_mov_b32 v9, 1
    s_mov_b64 exec, 1
    s_mov_b32 s60, 0x100000
L_wel:
    s_nop 1
    ds_read_b32 v10, v2 offset:136
    s_sub_u32 s60, s60, 1
    s_cbranch_scc1 L_exit1
    s_waitcnt lgkmcnt(0)
    v_readfirstlane_b32 s48, v10
    s_cmp_lt_u32 s48, 4
    s_cbranch_scc1 L_wel
    buffer_atomic_add v9, off, s[12:15], s58 sc0
    s_mov_b64 exec, -1
    s_waitcnt vmcnt(0)
    v_readfirstlane_b32 s48, v9
    s_cmp_lg_u32 s48, s20
    s_cbranch_scc1 L_exit1
    buffer_load_dwordx4 v[32:35], v8, s[12:15], s64 offen sc1
    buffer_load_dwordx4 v[36:39], v8, s[12:15], s65 offen sc1
    buffer_load_dwordx4 v[40:43], v8, s[12:15], s66 offen sc1
    buffer_load_dwordx4 v[44:47], v8, s[12:15], s67 offen sc1
    buffer_load_dwordx4 v[48:51], v8, s[12:15], s68 offen sc1
    buffer_load_dwordx4 v[52:55], v8, s[12:15], s69 offen sc1
    buffer_load_dwordx4 v[56:59], v8, s[12:15], s70 offen sc1
    buffer_load_dwordx4 v[60:63], v8, s[12:15], s71 offen sc1
    buffer_load_dwordx4 v[64:67], v8, s[12:15], s72 offen sc1
    buffer_load_dwordx4 v[68:71], v8, s[12:15], s73 offen sc1
    buffer_load_dwordx4 v[72:75], v8, s[12:15], s74 offen sc1
    buffer_load_dwordx4 v[76:79], v8, s[12:15], s75 offen sc1
    buffer_load_dwordx4 v[80:83], v8, s[12:15], s84 offen sc1
    buffer_load_dwordx4 v[84:87], v8, s[12:15], s85 offen sc1
    buffer_load_dwordx4 v[88:91], v8, s[12:15], s86 offen sc1
    buffer_load_dwordx4 v[92:95], v8, s[12:15], s87 offen sc1
    buffer_load_dwordx4 v[96:99], v8, s[12:15], s88 offen sc1
    buffer_load_dwordx4 v[100:103], v8, s[12:15], s89 offen sc1
    buffer_load_dwordx4 v[104:107], v8, s[12:15], s90 offen sc1
    buffer_load_dwordx4 v[108:111], v8, s[12:15], s91 offen sc1
    buffer_load_dwordx4 v[112:115], v8, s[12:15], s92 offen sc1
    buffer_load_dwordx4 v[116:119], v8, s[12:15], s93 offen sc1
    buffer_load_dwordx4 v[120:123], v8, s[12:15], s94 offen sc1
    buffer_load_dwordx4 v[124:127], v8, s[12:15], s95 offen sc1
    s_mov_b32 s60, 0x100000
L_wn:
    s_nop 1
    ds_read_b32 v10, v2 offset:72
    s_sub_u32 s60, s60, 1
    s_cbranch_scc1 L_exit1
    s_waitcnt lgkmcnt(0)
    v_readfirstlane_b32 s48, v10
    s_cmp_lt_u32 s48, 4
    s_cbranch_scc1 L_wn
    ds_read_b32 v16, v13 offset:0
    ds_read_b32 v17, v13 offset:768
    ds_read_b32 v18, v13 offset:1536
    ds_read_b32 v19, v13 offset:2304
    ds_read_b32 v20, v13 offset:256
    ds_read_b32 v21, v13 offset:1024
    ds_read_b32 v22, v13 offset:1792
    ds_read_b32 v23, v13 offset:2560
    ds_read_b32 v24, v13 offset:512
    ds_read_b32 v25, v13 offset:1280
    ds_read_b32 v26, v13 offset:2048
    ds_read_b32 v27, v13 offset:2816
    s_mov_b32 s60, 0x40000
    s_waitcnt lgkmcnt(8)
    v_add_f32 v16, v16, v17
    v_add_f32 v18, v18, v19
    v_sub_f32 v16, v16, v6
    v_add_f32 v28, v16, v18
    s_waitcnt lgkmcnt(4)
    v_add_f32 v20, v20, v21
    v_add_f32 v22, v22, v23
    v_sub_f32 v20, v20, v6
    v_add_f32 v29, v20, v22
    s_waitcnt lgkmcnt(0)
    v_add_f32 v24, v24, v25
    v_add_f32 v26, v26, v27
    v_sub_f32 v24, v24, v6
    v_add_f32 v30, v24, v26
    s_branch L_fr2
L_fr:
    s_nop 1
    buffer_load_dwordx4 v[32:35], v8, s[12:15], s64 offen sc1
    buffer_load_dwordx4 v[36:39], v8, s[12:15], s65 offen sc1
    buffer_load_dwordx4 v[40:43], v8, s[12:15], s66 offen sc1
    buffer_load_dwordx4 v[44:47], v8, s[12:15], s67 offen sc1
    buffer_load_dwordx4 v[48:51], v8, s[12:15], s68 offen sc1
    buffer_load_dwordx4 v[52:55], v8, s[12:15], s69 offen sc1
    buffer_load_dwordx4 v[56:59], v8, s[12:15], s70 offen sc1
    buffer_load_dwordx4 v[60:63], v8, s[12:15], s71 offen sc1
    buffer_load_dwordx4 v[64:67], v8, s[12:15], s72 offen sc1
    buffer_load_dwordx4 v[68:71], v8, s[12:15], s73 offen sc1
    buffer_load_dwordx4 v[72:75], v8, s[12:15], s74 offen sc1
    buffer_load_dwordx4 v[76:79], v8, s[12:15], s75 offen sc1
    buffer_load_dwordx4 v[80:83], v8, s[12:15], s84 offen sc1
    buffer_load_dwordx4 v[84:87], v8, s[12:15], s85 offen sc1
    buffer_load_dwordx4 v[88:91], v8, s[12:15], s86 offen sc1
    buffer_load_dwordx4 v[92:95], v8, s[12:15], s87 offen sc1
    buffer_load_dwordx4 v[96:99], v8, s[12:15], s88 offen sc1
    buffer_load_dwordx4 v[100:103], v8, s[12:15], s89 offen sc1
    buffer_load_dwordx4 v[104:107], v8, s[12:15], s90 offen sc1
    buffer_load_dwordx4 v[108:111], v8, s[12:15], s91 offen sc1
    buffer_load_dwordx4 v[112:115], v8, s[12:15], s92 offen sc1
    buffer_load_dwordx4 v[116:119], v8, s[12:15], s93 offen sc1
    buffer_load_dwordx4 v[120:123], v8, s[12:15], s94 offen sc1
    buffer_load_dwordx4 v[124:127], v8, s[12:15], s95 offen sc1
L_fr2:
    v_mul_f32 v4, s57, v28
    v_mul_f32 v5, s57, v29
    v_mul_f32 v6, s57, v30
    v_mov_b32 v7, 1
    s_sub_u32 s60, s60, 1
    s_cbranch_scc1 L_exit1
    s_waitcnt vmcnt(22)
    v_fmac_f32 v4, s24, v32
    v_fmac_f32 v5, s24, v33
    v_fmac_f32 v6, s24, v34
    v_fmac_f32 v4, s25, v36
    v_fmac_f32 v5, s25, v37
    v_fmac_f32 v6, s25, v38
    v_min3_u32 v7, v7, v35, v39
    s_waitcnt vmcnt(20)
    v_fmac_f32 v4, s26, v40
    v_fmac_f32 v5, s26, v41
    v_fmac_f32 v6, s26, v42
    v_fmac_f32 v4, s27, v44
    v_fmac_f32 v5, s27, v45
    v_fmac_f32 v6, s27, v46
    v_min3_u32 v7, v7, v43, v47
    s_waitcnt vmcnt(18)
    v_fmac_f32 v4, s28, v48
    v_fmac_f32 v5, s28, v49
    v_fmac_f32 v6, s28, v50
    v_fmac_f32 v4, s29, v52
    v_fmac_f32 v5, s29, v53
    v_fmac_f32 v6, s29, v54
    v_min3_u32 v7, v7, v51, v55
    s_waitcnt vmcnt(16)
    v_fmac_f32 v4, s30, v56
    v_fmac_f32 v5, s30, v57
    v_fmac_f32 v6, s30, v58
    v_fmac_f32 v4, s31, v60
    v_fmac_f32 v5, s31, v61
    v_fmac_f32 v6, s31, v62
    v_min3_u32 v7, v7, v59, v63
    s_waitcnt vmcnt(14)
    v_fmac_f32 v4, s32, v64
    v_fmac_f32 v5, s32, v65
    v_fmac_f32 v6, s32, v66
    v_fmac_f32 v4, s33, v68
    v_fmac_f32 v5, s33, v69
    v_fmac_f32 v6, s33, v70
    v_min3_u32 v7, v7, v67, v71
    s_waitcnt vmcnt(12)
    v_fmac_f32 v4, s34, v72
    v_fmac_f32 v5, s34, v73
    v_fmac_f32 v6, s34, v74
    v_fmac_f32 v4, s35, v76
    v_fmac_f32 v5, s35, v77
    v_fmac_f32 v6, s35, v78
    v_min3_u32 v7, v7, v75, v79
    s_waitcnt vmcnt(10)
    v_fmac_f32 v4, s36, v80
    v_fmac_f32 v5, s36, v81
    v_fmac_f32 v6, s36, v82
    v_fmac_f32 v4, s37, v84
    v_fmac_f32 v5, s37, v85
    v_fmac_f32 v6, s37, v86
    v_min3_u32 v7, v7, v83, v87
    s_waitcnt vmcnt(8)
    v_fmac_f32 v4, s38, v88
    v_fmac_f32 v5, s38, v89
    v_fmac_f32 v6, s38, v90
    v_fmac_f32 v4, s39, v92
    v_fmac_f32 v5, s39, v93
    v_fmac_f32 v6, s39, v94
    v_min3_u32 v7, v7, v91, v95
    s_waitcnt vmcnt(6)
    v_fmac_f32 v4, s40, v96
    v_fmac_f32 v5, s40, v97
    v_fmac_f32 v6, s40, v98
    v_fmac_f32 v4, s41, v100
    v_fmac_f32 v5, s41, v101
    v_fmac_f32 v6, s41, v102
    v_min3_u32 v7, v7, v99, v103
    s_waitcnt vmcnt(4)
    v_fmac_f32 v4, s42, v104
    v_fmac_f32 v5, s42, v105
    v_fmac_f32 v6, s42, v106
    v_fmac_f32 v4, s43, v108
    v_fmac_f32 v5, s43, v109
    v_fmac_f32 v6, s43, v110
    v_min3_u32 v7, v7, v107, v111
    s_waitcnt vmcnt(2)
    v_fmac_f32 v4, s44, v112
    v_fmac_f32 v5, s44, v113
    v_fmac_f32 v6, s44, v114
    v_fmac_f32 v4, s45, v116
    v_fmac_f32 v5, s45, v117
    v_fmac_f32 v6, s45, v118
    v_min3_u32 v7, v7, v115, v119
    s_waitcnt vmcnt(0)
    v_fmac_f32 v4, s46, v120
    v_fmac_f32 v5, s46, v121
    v_fmac_f32 v6, s46, v122
    v_fmac_f32 v4, s47, v124
    v_fmac_f32 v5, s47, v125
    v_fmac_f32 v6, s47, v126
    v_min3_u32 v7, v7, v123, v127
    v_cmp_eq_u32 vcc, 0, v7
    v_cvt_pk_bf16_f32 v4, v4, v4
    v_cvt_pk_bf16_f32 v5, v5, v5
    v_cvt_pk_bf16_f32 v6, v6, v6
    s_cbranch_vccnz L_fr
    buffer_store_short v4, v12, s[96:99], s59 offen offset:0
    buffer_store_short v5, v12, s[96:99], s59 offen offset:128
    buffer_store_short v6, v12, s[96:99], s59 offen offset:256
L_fx:
    s_endpgm
L_h2:
    s_nop 1
    s_mov_b32 s92, s74
    s_and_b32 s93, s75, 0xffff
    s_mov_b32 s94, 2097152
    s_mov_b32 s95, 0x00020000
    s_mov_b32 s96, s76
    s_and_b32 s97, s77, 0xffff
    s_mov_b32 s98, 2097152
    s_mov_b32 s99, 0x00020000
    s_mov_b32 s60, 0x100000
L_wd2:
    s_nop 1
    ds_read_b32 v10, v2 offset:20
    s_sub_u32 s60, s60, 1
    s_cbranch_scc1 L_exit1
    s_waitcnt lgkmcnt(0)
    v_readfirstlane_b32 s48, v10
    s_cmp_eq_u32 s48, 0
    s_cbranch_scc1 L_wd2
    ds_read_b128 v[16:19], v2 offset:0
    ds_read_b64 v[20:21], v2 offset:16
    s_waitcnt lgkmcnt(0)
    v_readfirstlane_b32 s84, v16
    v_readfirstlane_b32 s85, v17
    v_readfirstlane_b32 s86, v18
    v_readfirstlane_b32 s87, v19
    v_readfirstlane_b32 s88, v20
    v_readfirstlane_b32 s89, v21
    v_and_b32 v3, 3, v1
    v_and_b32 v15, 7, v1
    v_lshrrev_b32 v12, 2, v1
    s_mov_b32 s37, 0x3dd53b95
    s_mov_b32 s38, 0xaaaaaaab
    s_mov_b32 s61, 0
    s_mul_i32 s35, s3, 49152
    s_add_u32 s35, s35, 2097152
    s_mov_b32 s40, 6144
    v_lshlrev_b32 v14, 5, v1
    v_lshrrev_b32 v8, 3, v1
    v_mul_u32_u24 v8, 24, v8
    v_mov_b32 v4, 768
    v_mad_u32_u24 v8, v15, v4, v8
    v_lshlrev_b32 v104, 4, v1
    s_mov_b32 s34, 12
L_prep:
    s_nop 1
    s_lshl_b32 s62, s61, 5
    s_add_u32 s62, s62, s3
    s_lshl_b32 s63, s62, 15
    s_add_u32 s63, s63, 1
    s_mul_hi_u32 s63, s63, 0xaaaaaaab
    s_lshr_b32 s63, s63, 7
    s_mov_b32 s32, s84
    s_mov_b32 s39, s87
    s_mov_b32 s84, s85
    s_mov_b32 s85, s86
    s_mov_b32 s87, s88
    s_mov_b32 s88, s89
    s_lshl_b32 s33, s61, 3
    s_add_u32 s33, s33, 1
    s_mov_b32 s60, 0x100000
L_wpf:
    s_nop 1
    ds_read_b32 v10, v2 offset:60
    s_sub_u32 s60, s60, 1
    s_cbranch_scc1 L_exit1
    s_waitcnt lgkmcnt(0)
    v_readfirstlane_b32 s48, v10
    s_cmp_lt_u32 s48, s33
    s_cbranch_scc1 L_wpf
    v_lshlrev_b32 v4, 4, v1
    s_mul_i32 s49, s4, 2736
    s_lshl_b32 s48, s62, 16
    s_mul_hi_u32 s48, s48, 0xaaaaaaab
    s_lshr_b32 s48, s48, 5
    s_lshl_b32 s48, s48, 4
    s_add_u32 s48, s48, s49
    buffer_load_dwordx4 v[80:83], v4, s[92:95], s48 offen offset:0
    buffer_load_dwordx4 v[84:87], v4, s[92:95], s48 offen offset:1024
    buffer_load_dwordx4 v[88:91], v4, s[92:95], s48 offen offset:2048
    buffer_load_dwordx4 v[92:95], v4, s[96:99], s48 offen offset:0
    buffer_load_dwordx4 v[96:99], v4, s[96:99], s48 offen offset:1024
    buffer_load_dwordx4 v[100:103], v4, s[96:99], s48 offen offset:2048
    s_and_b32 s48, s39, 7
    v_mov_b32 v9, s48
    s_bitcmp1_b32 s39, 3
    s_cselect_b64 vcc, -1, 0
    v_cndmask_b32 v9, v9, v15, vcc
    v_xor_b32 v13, s5, v9
    v_lshl_or_b32 v13, v3, 3, v13
    s_lshl_b32 s36, s62, 6
    s_mul_i32 s49, s62, 768
    s_lshl_b32 s50, s63, 2
    s_sub_u32 s49, s49, s50
    s_add_u32 s49, s49, 1179648
    s_add_u32 s33, s33, 4
    s_mov_b32 s60, 0x100000
L_wga:
    s_nop 1
    ds_read_b32 v10, v2 offset:60
    s_sub_u32 s60, s60, 1
    s_cbranch_scc1 L_exit1
    s_waitcnt lgkmcnt(0)
    v_readfirstlane_b32 s48, v10
    s_cmp_lt_u32 s48, s33
    s_cbranch_scc1 L_wga
    v_add_u32 v4, 0, v12
    v_bfe_u32 v5, v4, 3, 2
    v_and_or_b32 v5, v4, 4, v5
    v_xor_b32 v5, v13, v5
    v_add_u32 v4, s36, v4
    v_lshl_add_u32 v6, v4, 5, v5
    v_lshl_add_u32 v6, v6, 4, 1
    v_mul_hi_u32 v6, v6, s38
    v_lshrrev_b32 v6, 1, v6
    v_lshrrev_b32 v11, 1, v6
    v_lshlrev_b32 v11, 2, v11
    buffer_load_dwordx3 v[24:26], v11, s[92:95], 0 offen
    buffer_load_dword v27, v11, s[92:95], 0 offen offset:12
    buffer_load_dwordx3 v[28:30], v11, s[96:99], 0 offen
    buffer_load_dword v31, v11, s[96:99], 0 offen offset:12
    v_lshrrev_b32 v22, 6, v6
    v_lshl_add_u32 v22, v22, 2, s49
    v_and_b32 v7, 15, v6
    v_cmp_eq_u32 s[24:25], 5, v7
    v_and_b32 v23, 1, v6
    v_lshlrev_b32 v23, 4, v23
    s_waitcnt vmcnt(0)
    v_add_u32 v4, 16, v12
    v_bfe_u32 v5, v4, 3, 2
    v_and_or_b32 v5, v4, 4, v5
    v_xor_b32 v5, v13, v5
    v_add_u32 v4, s36, v4
    v_lshl_add_u32 v6, v4, 5, v5
    v_lshl_add_u32 v6, v6, 4, 1
    v_mul_hi_u32 v6, v6, s38
    v_lshrrev_b32 v6, 1, v6
    v_lshrrev_b32 v11, 1, v6
    v_lshlrev_b32 v11, 2, v11
    buffer_load_dwordx3 v[40:42], v11, s[92:95], 0 offen
    buffer_load_dword v43, v11, s[92:95], 0 offen offset:12
    buffer_load_dwordx3 v[44:46], v11, s[96:99], 0 offen
    buffer_load_dword v47, v11, s[96:99], 0 offen offset:12
    v_lshrrev_b32 v38, 6, v6
    v_lshl_add_u32 v38, v38, 2, s49
    v_and_b32 v7, 15, v6
    v_cmp_eq_u32 s[26:27], 5, v7
    v_and_b32 v39, 1, v6
    v_lshlrev_b32 v39, 4, v39
    s_waitcnt vmcnt(0)
    v_add_u32 v4, 32, v12
    v_bfe_u32 v5, v4, 3, 2
    v_and_or_b32 v5, v4, 4, v5
    v_xor_b32 v5, v13, v5
    v_add_u32 v4, s36, v4
    v_lshl_add_u32 v6, v4, 5, v5
    v_lshl_add_u32 v6, v6, 4, 1
    v_mul_hi_u32 v6, v6, s38
    v_lshrrev_b32 v6, 1, v6
    v_lshrrev_b32 v11, 1, v6
    v_lshlrev_b32 v11, 2, v11
    buffer_load_dwordx3 v[56:58], v11, s[92:95], 0 offen
    buffer_load_dword v59, v11, s[92:95], 0 offen offset:12
    buffer_load_dwordx3 v[60:62], v11, s[96:99], 0 offen
    buffer_load_dword v63, v11, s[96:99], 0 offen offset:12
    v_lshrrev_b32 v54, 6, v6
    v_lshl_add_u32 v54, v54, 2, s49
    v_and_b32 v7, 15, v6
    v_cmp_eq_u32 s[28:29], 5, v7
    v_and_b32 v55, 1, v6
    v_lshlrev_b32 v55, 4, v55
    s_waitcnt vmcnt(0)
    v_add_u32 v4, 48, v12
    v_bfe_u32 v5, v4, 3, 2
    v_and_or_b32 v5, v4, 4, v5
    v_xor_b32 v5, v13, v5
    v_add_u32 v4, s36, v4
    v_lshl_add_u32 v6, v4, 5, v5
    v_lshl_add_u32 v6, v6, 4, 1
    v_mul_hi_u32 v6, v6, s38
    v_lshrrev_b32 v6, 1, v6
    v_lshrrev_b32 v11, 1, v6
    v_lshlrev_b32 v11, 2, v11
    buffer_load_dwordx3 v[72:74], v11, s[92:95], 0 offen
    buffer_load_dword v75, v11, s[92:95], 0 offen offset:12
    buffer_load_dwordx3 v[76:78], v11, s[96:99], 0 offen
    buffer_load_dword v79, v11, s[96:99], 0 offen offset:12
    v_lshrrev_b32 v70, 6, v6
    v_lshl_add_u32 v70, v70, 2, s49
    v_and_b32 v7, 15, v6
    v_cmp_eq_u32 s[30:31], 5, v7
    v_and_b32 v71, 1, v6
    v_lshlrev_b32 v71, 4, v71
    s_waitcnt vmcnt(0)
    s_add_u32 s33, s61, 1
    s_mov_b32 s60, 0x100000
L_wfd:
    s_nop 1
    ds_read_b32 v10, v2 offset:52
    s_sub_u32 s60, s60, 1
    s_cbranch_scc1 L_exit1
    s_waitcnt lgkmcnt(0)
    v_readfirstlane_b32 s48, v10
    s_cmp_lt_u32 s48, s33
    s_cbranch_scc1 L_wfd
    v_mul_u32_u24 v4, 4352, v1
    s_xor_b32 s48, s32, s39
    s_xor_b32 s48, s48, s5
    s_and_b32 s48, s48, 7
    v_mov_b32 v6, s33
    s_lshl_b64 vcc, 1, s48
    s_or_b32 s48, s32, s39
    s_bitcmp1_b32 s48, 3
    s_cselect_b64 vcc, 0xff, vcc
    s_cmp_eq_u32 s32, s39
    s_cselect_b64 vcc, 0, vcc
    s_max_u32 s48, s61, 1
    v_mov_b32 v7, s48
    v_cndmask_b32 v6, v7, v6, vcc
    s_cmp_eq_u32 s61, 1
    s_cselect_b64 exec, vcc, 0xff
    s_mov_b32 s60, 0x40000
    s_cbranch_execz L_noflags
L_flags:
    s_nop 1
    buffer_load_dword v5, v4, s[12:15], s59 offen sc1
    s_sub_u32 s60, s60, 1
    s_cbranch_scc1 L_exit1
    s_waitcnt vmcnt(0)
    v_cmpx_gt_u32 vcc, v6, v5
    s_cbranch_execnz L_flags
L_noflags:
    s_nop 1
    s_mov_b64 exec, -1
    buffer_load_dword v22, v22, s[12:15], 0 offen sc1
    buffer_load_dword v38, v38, s[12:15], 0 offen sc1
    buffer_load_dword v54, v54, s[12:15], 0 offen sc1
    buffer_load_dword v70, v70, s[12:15], 0 offen sc1
    s_bitcmp1_b32 s39, 3
    s_cselect_b32 s49, 0, 7
    s_xor_b32 s50, s32, s39
    s_bitcmp1_b32 s50, 3
    s_cselect_b32 s51, 7, 0
    s_and_b32 s50, s50, 7
    s_and_b32 s52, s39, 7
    s_add_u32 s53, s35, 4096
    v_add_u32 v4, 0, v1
    v_mul_u32_u24 v5, 1366, v4
    v_lshrrev_b32 v5, 16, v5
    v_mul_u32_u24 v6, 48, v5
    v_sub_u32 v4, v4, v6
    v_cmp_gt_u32 vcc, s34, v4
    v_and_b32 v6, s51, v5
    v_xor_b32 v6, s50, v6
    v_and_b32 v5, s49, v5
    v_xor_b32 v5, s52, v5
    v_cndmask_b32 v6, v6, v5, vcc
    v_cmp_ne_u32 s[64:65], 0, v6
    v_xor_b32 v6, s5, v6
    v_mad_u32_u24 v6, v6, s40, v104
    s_mov_b64 exec, s[64:65]
    buffer_load_dwordx4 v[80:83], v6, s[12:15], s35 offen offset:0 sc1
    s_mov_b64 exec, -1
    v_add_u32 v4, 64, v1
    v_mul_u32_u24 v5, 1366, v4
    v_lshrrev_b32 v5, 16, v5
    v_mul_u32_u24 v6, 48, v5
    v_sub_u32 v4, v4, v6
    v_cmp_gt_u32 vcc, s34, v4
    v_and_b32 v6, s51, v5
    v_xor_b32 v6, s50, v6
    v_and_b32 v5, s49, v5
    v_xor_b32 v5, s52, v5
    v_cndmask_b32 v6, v6, v5, vcc
    v_cmp_ne_u32 s[66:67], 0, v6
    v_xor_b32 v6, s5, v6
    v_mad_u32_u24 v6, v6, s40, v104
    s_mov_b64 exec, s[66:67]
    buffer_load_dwordx4 v[84:87], v6, s[12:15], s35 offen offset:1024 sc1
    s_mov_b64 exec, -1
    v_add_u32 v4, 128, v1
    v_mul_u32_u24 v5, 1366, v4
    v_lshrrev_b32 v5, 16, v5
    v_mul_u32_u24 v6, 48, v5
    v_sub_u32 v4, v4, v6
    v_cmp_gt_u32 vcc, s34, v4
    v_and_b32 v6, s51, v5
    v_xor_b32 v6, s50, v6
    v_and_b32 v5, s49, v5
    v_xor_b32 v5, s52, v5
    v_cndmask_b32 v6, v6, v5, vcc
    v_cmp_ne_u32 s[68:69], 0, v6
    v_xor_b32 v6, s5, v6
    v_mad_u32_u24 v6, v6, s40, v104
    s_mov_b64 exec, s[68:69]
    buffer_load_dwordx4 v[88:91], v6, s[12:15], s35 offen offset:2048 sc1
    s_mov_b64 exec, -1
    v_add_u32 v4, 192, v1
    v_mul_u32_u24 v5, 1366, v4
    v_lshrrev_b32 v5, 16, v5
    v_mul_u32_u24 v6, 48, v5
    v_sub_u32 v4, v4, v6
    v_cmp_gt_u32 vcc, s34, v4
    v_and_b32 v6, s51, v5
    v_xor_b32 v6, s50, v6
    v_and_b32 v5, s49, v5
    v_xor_b32 v5, s52, v5
    v_cndmask_b32 v6, v6, v5, vcc
    v_cmp_ne_u32 s[70:71], 0, v6
    v_xor_b32 v6, s5, v6
    v_mad_u32_u24 v6, v6, s40, v104
    s_mov_b64 exec, s[70:71]
    buffer_load_dwordx4 v[92:95], v6, s[12:15], s35 offen offset:3072 sc1
    s_mov_b64 exec, -1
    v_add_u32 v4, 256, v1
    v_mul_u32_u24 v5, 1366, v4
    v_lshrrev_b32 v5, 16, v5
    v_mul_u32_u24 v6, 48, v5
    v_sub_u32 v4, v4, v6
    v_cmp_gt_u32 vcc, s34, v4
    v_and_b32 v6, s51, v5
    v_xor_b32 v6, s50, v6
    v_and_b32 v5, s49, v5
    v_xor_b32 v5, s52, v5
    v_cndmask_b32 v6, v6, v5, vcc
    v_cmp_ne_u32 s[72:73], 0, v6
    v_xor_b32 v6, s5, v6
    v_mad_u32_u24 v6, v6, s40, v104
    s_mov_b64 exec, s[72:73]
    buffer_load_dwordx4 v[96:99], v6, s[12:15], s53 offen offset:0 sc1
    s_mov_b64 exec, -1
    v_add_u32 v4, 320, v1
    v_mul_u32_u24 v5, 1366, v4
    v_lshrrev_b32 v5, 16, v5
    v_mul_u32_u24 v6, 48, v5
    v_sub_u32 v4, v4, v6
    v_cmp_gt_u32 vcc, s34, v4
    v_and_b32 v6, s51, v5
    v_xor_b32 v6, s50, v6
    v_and_b32 v5, s49, v5
    v_xor_b32 v5, s52, v5
    v_cndmask_b32 v6, v6, v5, vcc
    v_cmp_ne_u32 s[74:75], 0, v6
    v_xor_b32 v6, s5, v6
    v_mad_u32_u24 v6, v6, s40, v104
    s_mov_b64 exec, s[74:75]
    buffer_load_dwordx4 v[100:103], v6, s[12:15], s53 offen offset:1024 sc1
    s_mov_b64 exec, -1
    s_waitcnt vmcnt(0)
    s_mov_b64 exec, s[64:65]
    ds_write_b128 v104, v[80:83] offset:256
    s_mov_b64 exec, s[66:67]
    ds_write_b128 v104, v[84:87] offset:1280
    s_mov_b64 exec, s[68:69]
    ds_write_b128 v104, v[88:91] offset:2304
    s_mov_b64 exec, s[70:71]
    ds_write_b128 v104, v[92:95] offset:3328
    s_mov_b64 exec, s[72:73]
    ds_write_b128 v104, v[96:99] offset:4352
    s_mov_b64 exec, s[74:75]
    ds_write_b128 v104, v[100:103] offset:5376
    s_mov_b64 exec, -1
    ds_read_b64 v[16:17], v8 offset:256
    ds_read_b64 v[18:19], v8 offset:264
    ds_read_b64 v[20:21], v8 offset:272
    ds_read_b64 v[32:33], v8 offset:448
    ds_read_b64 v[34:35], v8 offset:456
    ds_read_b64 v[36:37], v8 offset:464
    ds_read_b64 v[48:49], v8 offset:640
    ds_read_b64 v[50:51], v8 offset:648
    ds_read_b64 v[52:53], v8 offset:656
    ds_read_b64 v[64:65], v8 offset:832
    ds_read_b64 v[66:67], v8 offset:840
    ds_read_b64 v[68:69], v8 offset:848
    s_mov_b32 s34, 0
    v_mov_b32 v5, 0xf149f2ca
    v_mov_b32 v4, 0xf149f2ca
    s_waitcnt vmcnt(0) lgkmcnt(0)
    v_sub_f32 v16, v16, v22
    v_sub_f32 v17, v17, v22
    v_sub_f32 v18, v18, v22
    v_sub_f32 v19, v19, v22
    v_sub_f32 v20, v20, v22
    v_sub_f32 v21, v21, v22
    v_mul_f32 v16, s37, v16
    v_mul_f32 v17, s37, v17
    v_mul_f32 v18, s37, v18
    v_mul_f32 v19, s37, v19
    v_mul_f32 v20, s37, v20
    v_mul_f32 v21, s37, v21
    v_cndmask_b32 v21, v5, v21, s[24:25]
    v_max3_f32 v4, v4, v16, v17
    v_max3_f32 v4, v4, v18, v19
    v_max3_f32 v4, v4, v20, v21
    v_alignbit_b32 v24, v25, v24, v23
    v_alignbit_b32 v25, v26, v25, v23
    v_alignbit_b32 v26, v27, v26, v23
    v_alignbit_b32 v28, v29, v28, v23
    v_alignbit_b32 v29, v30, v29, v23
    v_alignbit_b32 v30, v31, v30, v23
    v_sub_f32 v32, v32, v38
    v_sub_f32 v33, v33, v38
    v_sub_f32 v34, v34, v38
    v_sub_f32 v35, v35, v38
    v_sub_f32 v36, v36, v38
    v_sub_f32 v37, v37, v38
    v_mul_f32 v32, s37, v32
    v_mul_f32 v33, s37, v33
    v_mul_f32 v34, s37, v34
    v_mul_f32 v35, s37, v35
    v_mul_f32 v36, s37, v36
    v_mul_f32 v37, s37, v37
    v_cndmask_b32 v37, v5, v37, s[26:27]
    v_max3_f32 v4, v4, v32, v33
    v_max3_f32 v4, v4, v34, v35
    v_max3_f32 v4, v4, v36, v37
    v_alignbit_b32 v40, v41, v40, v39
    v_alignbit_b32 v41, v42, v41, v39
    v_alignbit_b32 v42, v43, v42, v39
    v_alignbit_b32 v44, v45, v44, v39
    v_alignbit_b32 v45, v46, v45, v39
    v_alignbit_b32 v46, v47, v46, v39
    v_sub_f32 v48, v48, v54
    v_sub_f32 v49, v49, v54
    v_sub_f32 v50, v50, v54
    v_sub_f32 v51, v51, v54
    v_sub_f32 v52, v52, v54
    v_sub_f32 v53, v53, v54
    v_mul_f32 v48, s37, v48
    v_mul_f32 v49, s37, v49
    v_mul_f32 v50, s37, v50
    v_mul_f32 v51, s37, v51
    v_mul_f32 v52, s37, v52
    v_mul_f32 v53, s37, v53
    v_cndmask_b32 v53, v5, v53, s[28:29]
    v_max3_f32 v4, v4, v48, v49
    v_max3_f32 v4, v4, v50, v51
    v_max3_f32 v4, v4, v52, v53
    v_alignbit_b32 v56, v57, v56, v55
    v_alignbit_b32 v57, v58, v57, v55
    v_alignbit_b32 v58, v59, v58, v55
    v_alignbit_b32 v60, v61, v60, v55
    v_alignbit_b32 v61, v62, v61, v55
    v_alignbit_b32 v62, v63, v62, v55
    v_sub_f32 v64, v64, v70
    v_sub_f32 v65, v65, v70
    v_sub_f32 v66, v66, v70
    v_sub_f32 v67, v67, v70
    v_sub_f32 v68, v68, v70
    v_sub_f32 v69, v69, v70
    v_mul_f32 v64, s37, v64
    v_mul_f32 v65, s37, v65
    v_mul_f32 v66, s37, v66
    v_mul_f32 v67, s37, v67
    v_mul_f32 v68, s37, v68
    v_mul_f32 v69, s37, v69
    v_cndmask_b32 v69, v5, v69, s[30:31]
    v_max3_f32 v4, v4, v64, v65
    v_max3_f32 v4, v4, v66, v67
    v_max3_f32 v4, v4, v68, v69
    v_alignbit_b32 v72, v73, v72, v71
    v_alignbit_b32 v73, v74, v73, v71
    v_alignbit_b32 v74, v75, v74, v71
    v_alignbit_b32 v76, v77, v76, v71
    v_alignbit_b32 v77, v78, v77, v71
    v_alignbit_b32 v78, v79, v78, v71
    v_max_f32_dpp v4, v4, v4 row_ror:8 row_mask:0xf bank_mask:0xf
    s_nop 1
    v_max_f32_dpp v4, v4, v4 row_ror:4 row_mask:0xf bank_mask:0xf
    s_nop 1
    v_max_f32_dpp v4, v4, v4 row_ror:2 row_mask:0xf bank_mask:0xf
    s_nop 1
    v_max_f32_dpp v4, v4, v4 row_ror:1 row_mask:0xf bank_mask:0xf
    v_mov_b32 v5, v4
    s_nop 1
    v_permlane32_swap_b32 v4, v5
    v_max_f32 v4, v4, v5
    v_mov_b32 v5, v4
    s_nop 1
    v_permlane16_swap_b32 v4, v5
    v_max_f32 v4, v4, v5
    v_mov_b32 v5, 0
    v_mov_b32 v6, 0
    v_sub_f32 v16, v16, v4
    v_sub_f32 v17, v17, v4
    v_sub_f32 v18, v18, v4
    v_sub_f32 v19, v19, v4
    v_sub_f32 v20, v20, v4
    v_sub_f32 v21, v21, v4
    v_exp_f32 v16, v16
    v_exp_f32 v17, v17
    v_exp_f32 v18, v18
    v_exp_f32 v19, v19
    v_exp_f32 v20, v20
    v_exp_f32 v21, v21
    v_add_f32 v5, v5, v16
    v_lshlrev_b32 v10, 16, v24
    v_lshlrev_b32 v11, 16, v28
    v_mul_f32 v16, v16, v10
    v_fmac_f32 v6, v16, v11
    v_add_f32 v5, v5, v17
    v_and_b32 v10, 0xffff0000, v24
    v_and_b32 v11, 0xffff0000, v28
    v_mul_f32 v17, v17, v10
    v_fmac_f32 v6, v17, v11
    v_add_f32 v5, v5, v18
    v_lshlrev_b32 v10, 16, v25
    v_lshlrev_b32 v11, 16, v29
    v_mul_f32 v18, v18, v10
    v_fmac_f32 v6, v18, v11
    v_add_f32 v5, v5, v19
    v_and_b32 v10, 0xffff0000, v25
    v_and_b32 v11, 0xffff0000, v29
    v_mul_f32 v19, v19, v10
    v_fmac_f32 v6, v19, v11
    v_add_f32 v5, v5, v20
    v_lshlrev_b32 v10, 16, v26
    v_lshlrev_b32 v11, 16, v30
    v_mul_f32 v20, v20, v10
    v_fmac_f32 v6, v20, v11
    v_add_f32 v5, v5, v21
    v_and_b32 v10, 0xffff0000, v26
    v_and_b32 v11, 0xffff0000, v30
    v_mul_f32 v21, v21, v10
    v_fmac_f32 v6, v21, v11
    ds_write_b128 v14, v[16:19] offset:18688
    ds_write_b64 v14, v[20:21] offset:18704
    v_sub_f32 v32, v32, v4
    v_sub_f32 v33, v33, v4
    v_sub_f32 v34, v34, v4
    v_sub_f32 v35, v35, v4
    v_sub_f32 v36, v36, v4
    v_sub_f32 v37, v37, v4
    v_exp_f32 v32, v32
    v_exp_f32 v33, v33
    v_exp_f32 v34, v34
    v_exp_f32 v35, v35
    v_exp_f32 v36, v36
    v_exp_f32 v37, v37
    v_add_f32 v5, v5, v32
    v_lshlrev_b32 v10, 16, v40
    v_lshlrev_b32 v11, 16, v44
    v_mul_f32 v32, v32, v10
    v_fmac_f32 v6, v32, v11
    v_add_f32 v5, v5, v33
    v_and_b32 v10, 0xffff0000, v40
    v_and_b32 v11, 0xffff0000, v44
    v_mul_f32 v33, v33, v10
    v_fmac_f32 v6, v33, v11
    v_add_f32 v5, v5, v34
    v_lshlrev_b32 v10, 16, v41
    v_lshlrev_b32 v11, 16, v45
    v_mul_f32 v34, v34, v10
    v_fmac_f32 v6, v34, v11
    v_add_f32 v5, v5, v35
    v_and_b32 v10, 0xffff0000, v41
    v_and_b32 v11, 0xffff0000, v45
    v_mul_f32 v35, v35, v10
    v_fmac_f32 v6, v35, v11
    v_add_f32 v5, v5, v36
    v_lshlrev_b32 v10, 16, v42
    v_lshlrev_b32 v11, 16, v46
    v_mul_f32 v36, v36, v10
    v_fmac_f32 v6, v36, v11
    v_add_f32 v5, v5, v37
    v_and_b32 v10, 0xffff0000, v42
    v_and_b32 v11, 0xffff0000, v46
    v_mul_f32 v37, v37, v10
    v_fmac_f32 v6, v37, v11
    ds_write_b128 v14, v[32:35] offset:20736
    ds_write_b64 v14, v[36:37] offset:20752
    v_sub_f32 v48, v48, v4
    v_sub_f32 v49, v49, v4
    v_sub_f32 v50, v50, v4
    v_sub_f32 v51, v51, v4
    v_sub_f32 v52, v52, v4
    v_sub_f32 v53, v53, v4
    v_exp_f32 v48, v48
    v_exp_f32 v49, v49
    v_exp_f32 v50, v50
    v_exp_f32 v51, v51
    v_exp_f32 v52, v52
    v_exp_f32 v53, v53
    v_add_f32 v5, v5, v48
    v_lshlrev_b32 v10, 16, v56
    v_lshlrev_b32 v11, 16, v60
    v_mul_f32 v48, v48, v10
    v_fmac_f32 v6, v48, v11
    v_add_f32 v5, v5, v49
    v_and_b32 v10, 0xffff0000, v56
    v_and_b32 v11, 0xffff0000, v60
    v_mul_f32 v49, v49, v10
    v_fmac_f32 v6, v49, v11
    v_add_f32 v5, v5, v50
    v_lshlrev_b32 v10, 16, v57
    v_lshlrev_b32 v11, 16, v61
    v_mul_f32 v50, v50, v10
    v_fmac_f32 v6, v50, v11
    v_add_f32 v5, v5, v51
    v_and_b32 v10, 0xffff0000, v57
    v_and_b32 v11, 0xffff0000, v61
    v_mul_f32 v51, v51, v10
    v_fmac_f32 v6, v51, v11
    v_add_f32 v5, v5, v52
    v_lshlrev_b32 v10, 16, v58
    v_lshlrev_b32 v11, 16, v62
    v_mul_f32 v52, v52, v10
    v_fmac_f32 v6, v52, v11
    v_add_f32 v5, v5, v53
    v_and_b32 v10, 0xffff0000, v58
    v_and_b32 v11, 0xffff0000, v62
    v_mul_f32 v53, v53, v10
    v_fmac_f32 v6, v53, v11
    ds_write_b128 v14, v[48:51] offset:22784
    ds_write_b64 v14, v[52:53] offset:22800
    v_sub_f32 v64, v64, v4
    v_sub_f32 v65, v65, v4
    v_sub_f32 v66, v66, v4
    v_sub_f32 v67, v67, v4
    v_sub_f32 v68, v68, v4
    v_sub_f32 v69, v69, v4
    v_exp_f32 v64, v64
    v_exp_f32 v65, v65
    v_exp_f32 v66, v66
    v_exp_f32 v67, v67
    v_exp_f32 v68, v68
    v_exp_f32 v69, v69
    v_add_f32 v5, v5, v64
    v_lshlrev_b32 v10, 16, v72
    v_lshlrev_b32 v11, 16, v76
    v_mul_f32 v64, v64, v10
    v_fmac_f32 v6, v64, v11
    v_add_f32 v5, v5, v65
    v_and_b32 v10, 0xffff0000, v72
    v_and_b32 v11, 0xffff0000, v76
    v_mul_f32 v65, v65, v10
    v_fmac_f32 v6, v65, v11
    v_add_f32 v5, v5, v66
    v_lshlrev_b32 v10, 16, v73
    v_lshlrev_b32 v11, 16, v77
    v_mul_f32 v66, v66, v10
    v_fmac_f32 v6, v66, v11
    v_add_f32 v5, v5, v67
    v_and_b32 v10, 0xffff0000, v73
    v_and_b32 v11, 0xffff0000, v77
    v_mul_f32 v67, v67, v10
    v_fmac_f32 v6, v67, v11
    v_add_f32 v5, v5, v68
    v_lshlrev_b32 v10, 16, v74
    v_lshlrev_b32 v11, 16, v78
    v_mul_f32 v68, v68, v10
    v_fmac_f32 v6, v68, v11
    v_add_f32 v5, v5, v69
    v_and_b32 v10, 0xffff0000, v74
    v_and_b32 v11, 0xffff0000, v78
    v_mul_f32 v69, v69, v10
    v_fmac_f32 v6, v69, v11
    ds_write_b128 v14, v[64:67] offset:24832
    ds_write_b64 v14, v[68:69] offset:24848
    v_add_f32_dpp v5, v5, v5 row_ror:8 row_mask:0xf bank_mask:0xf
    v_add_f32_dpp v6, v6, v6 row_ror:8 row_mask:0xf bank_mask:0xf
    s_nop 0
    v_add_f32_dpp v5, v5, v5 row_ror:4 row_mask:0xf bank_mask:0xf
    v_add_f32_dpp v6, v6, v6 row_ror:4 row_mask:0xf bank_mask:0xf
    s_nop 0
    v_add_f32_dpp v5, v5, v5 row_ror:2 row_mask:0xf bank_mask:0xf
    v_add_f32_dpp v6, v6, v6 row_ror:2 row_mask:0xf bank_mask:0xf
    s_nop 0
    v_add_f32_dpp v5, v5, v5 row_ror:1 row_mask:0xf bank_mask:0xf
    v_add_f32_dpp v6, v6, v6 row_ror:1 row_mask:0xf bank_mask:0xf
    v_mov_b32 v10, v5
    v_mov_b32 v11, v6
    s_nop 0
    v_permlane32_swap_b32 v5, v10
    v_permlane32_swap_b32 v6, v11
    v_add_f32 v5, v5, v10
    v_add_f32 v6, v6, v11
    v_mov_b32 v10, v5
    v_mov_b32 v11, v6
    s_nop 0
    v_permlane16_swap_b32 v5, v10
    v_permlane16_swap_b32 v6, v11
    v_add_f32 v5, v5, v10
    v_add_f32 v6, v6, v11
    s_lshl_b32 s48, s61, 2
    v_mov_b32 v10, s48
    v_lshlrev_b32 v11, 2, v10
    v_mov_b32 v7, s39
    s_mov_b64 exec, 1
    ds_write_b128 v11, v[4:7] offset:80
    ds_write_b32 v10, v7 offset:24
    s_lshl_b32 s48, s61, 8
    s_add_u32 s48, s48, s2
    s_lshl_b32 s48, s48, 6
    s_add_u32 s48, s48, 917504
    buffer_store_dwordx4 v[4:7], off, s[12:15], s48 sc1
    s_mov_b64 exec, -1
    v_add_u32 v14, 8192, v14
    v_add_u32 v8, 6144, v8
    v_add_u32 v104, 6144, v104
    s_add_u32 s35, s35, 1566720
    s_add_u32 s61, s61, 1
    s_cmp_lt_u32 s61, 3
    s_cbranch_scc1 L_prep
    s_mov_b32 s61, 0
    v_lshlrev_b32 v12, 2, v1
    v_add_u32 v13, 43264, v12
    v_lshlrev_b32 v8, 4, v1
    v_mov_b32 v31, 1
L_merge:
    s_nop 1
    s_lshl_b32 s48, s61, 2
    v_mov_b32 v3, s48
    v_lshlrev_b32 v11, 2, v3
    ds_read_b128 v[4:7], v11 offset:80
    s_lshl_b32 s62, s61, 8
    s_add_u32 s62, s62, s2
    s_lshl_b32 s62, s62, 10
    s_mov_b32 s60, 0x100000
L_wm:
    s_nop 1
    ds_read_b32 v10, v3 offset:64
    s_sub_u32 s60, s60, 1
    s_cbranch_scc1 L_exit1
    s_waitcnt lgkmcnt(0)
    v_readfirstlane_b32 s48, v10
    s_cmp_lt_u32 s48, 4
    s_cbranch_scc1 L_wm
    ds_read_b32 v16, v13 offset:0
    ds_read_b32 v17, v13 offset:768
    ds_read_b32 v18, v13 offset:1536
    ds_read_b32 v19, v13 offset:2304
    ds_read_b32 v20, v13 offset:256
    ds_read_b32 v21, v13 offset:1024
    ds_read_b32 v22, v13 offset:1792
    ds_read_b32 v23, v13 offset:2560
    ds_read_b32 v24, v13 offset:512
    ds_read_b32 v25, v13 offset:1280
    ds_read_b32 v26, v13 offset:2048
    ds_read_b32 v27, v13 offset:2816
    s_waitcnt lgkmcnt(8)
    v_add_f32 v16, v16, v17
    v_add_f32 v18, v18, v19
    v_sub_f32 v16, v16, v6
    v_add_f32 v28, v16, v18
    s_waitcnt lgkmcnt(4)
    v_add_f32 v20, v20, v21
    v_add_f32 v22, v22, v23
    v_sub_f32 v20, v20, v6
    v_add_f32 v29, v20, v22
    s_waitcnt lgkmcnt(0)
    v_add_f32 v24, v24, v25
    v_add_f32 v26, v26, v27
    v_sub_f32 v24, v24, v6
    v_add_f32 v30, v24, v26
    buffer_store_dwordx4 v[28:31], v8, s[12:15], s62 offen sc1
    v_add_u32 v13, 3072, v13
    s_add_u32 s61, s61, 1
    s_cmp_lt_u32 s61, 3
    s_cbranch_scc1 L_merge
    s_endpgm
.section .rodata,"a"
.p2align 6
.amdhsa_kernel standalone__kv_cache_quant_int4_int2_kv_with_per_channel_or_per_token_scales__decode_kernel
  .amdhsa_next_free_vgpr 136
  .amdhsa_next_free_sgpr 102
  .amdhsa_accum_offset 136
  .amdhsa_group_segment_fixed_size 0
  .amdhsa_kernarg_size 80
  .amdhsa_user_sgpr_count 2
  .amdhsa_user_sgpr_kernarg_segment_ptr 1
  .amdhsa_system_sgpr_workgroup_id_x 1
.end_amdhsa_kernel
```

```asm
; @launch kernel=standalone__kv_cache_quant_int4_int2_kv_with_per_channel_or_per_token_scales__decode_kernel grid=(256,1,1) block=(512,1,1) lds=52480
.amdgcn_target "amdgcn-amd-amdhsa--gfx950"
.text
.globl standalone__kv_cache_quant_int4_int2_kv_with_per_channel_or_per_token_scales__decode_kernel
.p2align 8
.type standalone__kv_cache_quant_int4_int2_kv_with_per_channel_or_per_token_scales__decode_kernel,@function
standalone__kv_cache_quant_int4_int2_kv_with_per_channel_or_per_token_scales__decode_kernel:
    s_cmp_ge_u32 s2, 256
    s_cbranch_scc1 L_exit1
    s_load_dwordx16 s[64:79], s[0:1], 0
    s_load_dwordx4 s[80:83], s[0:1], 64
    v_lshrrev_b32 v10, 6, v0
    v_and_b32 v11, 63, v0
    v_readfirstlane_b32 s28, v10
    s_lshr_b32 s3, s2, 3
    s_and_b32 s4, s2, 7
    s_lshr_b32 s32, s2, 6
    s_xor_b32 s32, s32, s4
    s_lshr_b32 s48, s32, 1
    s_and_b32 s32, s32, 1
    s_lshl_b32 s32, s32, 2
    s_or_b32 s48, s48, s32
    s_cmp_ge_u32 s28, 4
    s_cbranch_scc1 L_helper
    v_lshrrev_b32 v1, 4, v11
    v_and_b32 v52, 15, v11
    v_lshlrev_b32 v2, 4, v52
    v_lshlrev_b32 v3, 3, v52
    v_lshlrev_b32 v62, 7, v1
    v_and_b32 v63, 0x70, v0
    v_or_b32 v63, v63, v62
    v_mov_b32 v50, v63
    s_mov_b32 s45, 768
    s_mov_b32 s46, 384
    s_mov_b32 s47, 0xaaaaaaab
    v_mov_b32 v51, 0xc0000000
    s_lshl_b32 s44, s3, 6
    s_mov_b32 s5, s48
    s_mov_b32 s29, s28
    s_lshr_b32 s33, s29, 6
    s_lshl_b32 s33, s33, 11
    s_and_b32 s32, s29, 63
    s_add_u32 s32, s32, s33
    s_add_u32 s32, s32, s44
    s_bfe_u32 s33, s32, 0x20003
    s_and_b32 s34, s32, 4
    s_or_b32 s33, s33, s34
    s_xor_b32 s33, s33, s5
    s_lshl_b32 s50, s32, 5
    s_or_b32 s50, s50, s33
    s_lshl_b32 s50, s50, 4
    s_or_b32 s50, s50, 1
    v_xor_b32 v10, s50, v50
    v_mul_hi_u32 v10, v10, s47
    v_lshrrev_b32 v10, 1, v10
    v_and_b32 v11, 15, v10
    v_cmp_eq_u32 vcc, 5, v11
    v_mad_u32_u24 v48, v10, s45, v2
    v_add_u32 v11, 3840, v48
    v_cndmask_b32 v49, v51, v11, vcc
    v_lshrrev_b32 v10, 6, v10
    v_mad_u32_u24 v9, v10, s46, v3
    s_waitcnt lgkmcnt(0)
    s_mov_b32 s30, 0
    s_mov_b32 s8, s66
    s_and_b32 s9, s67, 0xffff
    s_mov_b32 s10, 805306368
    s_mov_b32 s11, 0x00020000
    buffer_load_dwordx4 v[64:67], v48, s[8:11], 0 offen offset:0 nt
    buffer_load_dwordx4 v[68:71], v48, s[8:11], 0 offen offset:256 nt
    buffer_load_dwordx4 v[72:75], v48, s[8:11], 0 offen offset:512 nt
    buffer_load_dwordx4 v[76:79], v48, s[8:11], 0 offen offset:768 nt
    buffer_load_dwordx4 v[80:83], v48, s[8:11], 0 offen offset:1024 nt
    buffer_load_dwordx4 v[84:87], v48, s[8:11], 0 offen offset:1280 nt
    s_mov_b32 s20, s64
    s_and_b32 s21, s65, 0xffff
    s_mov_b32 s22, 12288
    s_mov_b32 s23, 0x00020000
    s_lshl_b32 s31, s30, 5
    s_add_u32 s31, s31, s3
    s_mul_i32 s31, s31, 171
    s_lshr_b32 s31, s31, 9
    s_mul_i32 s31, s31, 384
    buffer_load_dwordx2 v[36:37], v3, s[20:23], s31 offen offset:0
    buffer_load_dwordx2 v[38:39], v3, s[20:23], s31 offen offset:128
    buffer_load_dwordx2 v[40:41], v3, s[20:23], s31 offen offset:256
    s_mov_b32 s16, s70
    s_and_b32 s17, s71, 0xffff
    s_mov_b32 s18, 6291456
    s_mov_b32 s19, 0x00020000
    buffer_load_dwordx2 v[42:43], v9, s[16:19], 0 offen offset:0
    buffer_load_dwordx2 v[44:45], v9, s[16:19], 0 offen offset:128
    buffer_load_dwordx2 v[46:47], v9, s[16:19], 0 offen offset:256
    buffer_load_dwordx4 v[88:91], v48, s[8:11], 0 offen offset:1536 nt
    buffer_load_dwordx4 v[92:95], v48, s[8:11], 0 offen offset:1792 nt
    buffer_load_dwordx4 v[96:99], v48, s[8:11], 0 offen offset:2048 nt
    buffer_load_dwordx4 v[100:103], v48, s[8:11], 0 offen offset:2304 nt
    buffer_load_dwordx4 v[104:107], v48, s[8:11], 0 offen offset:2560 nt
    buffer_load_dwordx4 v[108:111], v48, s[8:11], 0 offen offset:2816 nt
    buffer_load_dwordx4 v[112:115], v48, s[8:11], 0 offen offset:3072 nt
    buffer_load_dwordx4 v[116:119], v48, s[8:11], 0 offen offset:3328 nt
    buffer_load_dwordx4 v[120:123], v48, s[8:11], 0 offen offset:3584 nt
    buffer_load_dwordx4 v[124:127], v49, s[8:11], 0 offen offset:0 nt
    buffer_load_dwordx4 v[128:131], v49, s[8:11], 0 offen offset:256 nt
    buffer_load_dwordx4 v[132:135], v49, s[8:11], 0 offen offset:512 nt
    s_mov_b32 s12, s68
    s_and_b32 s13, s69, 0xffff
    s_mov_b32 s14, 805306368
    s_mov_b32 s15, 0x00020000
    v_lshlrev_b32 v11, 5, v1
    v_bfe_u32 v4, v0, 4, 3
    v_mul_u32_u24 v4, s45, v4
    v_lshl_add_u32 v4, v52, 1, v4
    s_lshr_b32 s32, s28, 1
    s_mul_i32 s32, s32, 24
    s_add_u32 s32, s32, 256
    v_add_u32 v4, s32, v4
    v_and_b32 v5, 7, v52
    v_lshl_add_u32 v5, v5, 2, v11
    v_add_u32 v5, 18688, v5
    v_lshlrev_b32 v8, 2, v1
    v_add_u32 v8, v2, v8
    s_mul_i32 s32, s28, 768
    s_add_u32 s32, s32, 43264
    v_add_u32 v8, s32, v8
    v_mov_b32 v53, 0
    v_mov_b32 v60, 0
    v_mov_b32 v61, 0
    s_mov_b32 s42, 0x01110111
    s_mov_b32 s43, 0x01110111
    s_mov_b32 s40, 0xea2bea0c
    s_mov_b32 s41, 0xea2b
    s_mov_b32 s64, 0x2020200
    s_mov_b32 s65, 0x202
    s_mov_b32 s66, 0x8080800
    s_mov_b32 s67, 0x808
    s_mov_b32 s68, 0x20202000
    s_mov_b32 s69, 0x2020
    s_mov_b32 s70, 0xc003c00c
    s_mov_b32 s71, 0xc003
    s_mov_b32 s59, 0
    s_mov_b32 s63, 0
    s_mov_b32 s7, 0
    s_mov_b32 s62, 144
    v_mov_b32 v12, 0
    v_mov_b32 v13, 0
    v_mov_b32 v14, 0
    v_mov_b32 v15, 0
    v_mov_b32 v16, 0
    v_mov_b32 v17, 0
    v_mov_b32 v18, 0
    v_mov_b32 v19, 0
    v_mov_b32 v20, 0
    v_mov_b32 v21, 0
    v_mov_b32 v22, 0
    v_mov_b32 v23, 0
    s_barrier
    s_waitcnt vmcnt(12)
    v_lshlrev_b32 v10, 16, v36
    v_lshlrev_b32 v24, 16, v42
    v_and_b32 v11, 0xffff0000, v36
    v_and_b32 v25, 0xffff0000, v42
    v_mul_f32 v24, v24, v10
    v_mul_f32 v25, v25, v11
    v_lshlrev_b32 v10, 16, v37
    v_lshlrev_b32 v26, 16, v43
    v_and_b32 v11, 0xffff0000, v37
    v_and_b32 v27, 0xffff0000, v43
    v_mul_f32 v26, v26, v10
    v_mul_f32 v27, v27, v11
    v_lshlrev_b32 v10, 16, v38
    v_lshlrev_b32 v28, 16, v44
    v_and_b32 v11, 0xffff0000, v38
    v_and_b32 v29, 0xffff0000, v44
    v_mul_f32 v28, v28, v10
    v_mul_f32 v29, v29, v11
    v_lshlrev_b32 v10, 16, v39
    v_lshlrev_b32 v30, 16, v45
    v_and_b32 v11, 0xffff0000, v39
    v_and_b32 v31, 0xffff0000, v45
    v_mul_f32 v30, v30, v10
    v_mul_f32 v31, v31, v11
    v_lshlrev_b32 v10, 16, v40
    v_lshlrev_b32 v32, 16, v46
    v_and_b32 v11, 0xffff0000, v40
    v_and_b32 v33, 0xffff0000, v46
    v_mul_f32 v32, v32, v10
    v_mul_f32 v33, v33, v11
    v_lshlrev_b32 v10, 16, v41
    v_lshlrev_b32 v34, 16, v47
    v_and_b32 v11, 0xffff0000, v41
    v_and_b32 v35, 0xffff0000, v47
    v_mul_f32 v34, v34, v10
    v_mul_f32 v35, v35, v11
    v_cvt_f32_i32 v64, v64
    v_cvt_f32_i32 v65, v65
    v_cvt_f32_i32 v66, v66
    v_cvt_f32_i32 v67, v67
    v_mul_f32 v54, v64, v24
    v_fmac_f32 v54, v65, v25
    v_fmac_f32 v54, v66, v26
    v_fmac_f32 v54, v67, v27
    v_cvt_f32_i32 v68, v68
    v_cvt_f32_i32 v69, v69
    v_cvt_f32_i32 v70, v70
    v_cvt_f32_i32 v71, v71
    v_fmac_f32 v54, v68, v28
    v_fmac_f32 v54, v69, v29
    v_fmac_f32 v54, v70, v30
    v_fmac_f32 v54, v71, v31
    v_cvt_f32_i32 v72, v72
    v_cvt_f32_i32 v73, v73
    v_cvt_f32_i32 v74, v74
    v_cvt_f32_i32 v75, v75
    v_fmac_f32 v54, v72, v32
    v_fmac_f32 v54, v73, v33
    v_fmac_f32 v54, v74, v34
    v_fmac_f32 v54, v75, v35
    v_cvt_f32_i32 v76, v76
    v_cvt_f32_i32 v77, v77
    v_add_f32_dpp v54, v54, v54 row_ror:8 row_mask:0xf bank_mask:0xf
    v_cvt_f32_i32 v78, v78
    v_cvt_f32_i32 v79, v79
    v_add_f32_dpp v54, v54, v54 row_ror:4 row_mask:0xf bank_mask:0xf
    v_mul_f32 v55, v76, v24
    v_fmac_f32 v55, v77, v25
    v_add_f32_dpp v54, v54, v54 row_ror:2 row_mask:0xf bank_mask:0xf
    v_fmac_f32 v55, v78, v26
    v_fmac_f32 v55, v79, v27
    v_add_f32_dpp v60, v54, v54 row_ror:1 row_mask:0xf bank_mask:0x1
    v_cvt_f32_i32 v80, v80
    v_cvt_f32_i32 v81, v81
    v_cvt_f32_i32 v82, v82
    v_cvt_f32_i32 v83, v83
    v_fmac_f32 v55, v80, v28
    v_fmac_f32 v55, v81, v29
    v_fmac_f32 v55, v82, v30
    v_fmac_f32 v55, v83, v31
    v_cvt_f32_i32 v84, v84
    v_cvt_f32_i32 v85, v85
    v_cvt_f32_i32 v86, v86
    v_cvt_f32_i32 v87, v87
    v_fmac_f32 v55, v84, v32
    v_fmac_f32 v55, v85, v33
    v_fmac_f32 v55, v86, v34
    v_fmac_f32 v55, v87, v35
    s_nop 1
    v_add_f32_dpp v55, v55, v55 row_ror:8 row_mask:0xf bank_mask:0xf
    s_nop 1
    v_add_f32_dpp v55, v55, v55 row_ror:4 row_mask:0xf bank_mask:0xf
    s_nop 1
    v_add_f32_dpp v55, v55, v55 row_ror:2 row_mask:0xf bank_mask:0xf
    s_nop 1
    v_add_f32_dpp v61, v55, v55 row_ror:1 row_mask:0xf bank_mask:0x1
    s_waitcnt vmcnt(6)
    s_add_u32 s29, s29, 4
    s_add_u32 s30, s30, 1
    s_lshr_b32 s33, s29, 6
    s_lshl_b32 s33, s33, 11
    s_and_b32 s32, s29, 63
    s_add_u32 s32, s32, s33
    s_add_u32 s32, s32, s44
    s_bfe_u32 s33, s32, 0x20003
    s_and_b32 s34, s32, 4
    s_or_b32 s33, s33, s34
    s_xor_b32 s33, s33, s5
    s_lshl_b32 s50, s32, 5
    s_or_b32 s50, s50, s33
    s_lshl_b32 s50, s50, 4
    s_or_b32 s50, s50, 1
    v_xor_b32 v10, s50, v50
    v_mul_hi_u32 v10, v10, s47
    v_lshrrev_b32 v10, 1, v10
    v_and_b32 v11, 15, v10
    v_cmp_eq_u32 vcc, 5, v11
    v_mad_u32_u24 v48, v10, s45, v2
    v_add_u32 v11, 3840, v48
    v_cndmask_b32 v49, v51, v11, vcc
    v_lshrrev_b32 v10, 6, v10
    v_mad_u32_u24 v9, v10, s46, v3
    buffer_load_dwordx2 v[42:43], v9, s[16:19], 0 offen offset:0
    buffer_load_dwordx2 v[44:45], v9, s[16:19], 0 offen offset:128
    buffer_load_dwordx2 v[46:47], v9, s[16:19], 0 offen offset:256
    v_cvt_f32_i32 v88, v88
    v_cvt_f32_i32 v89, v89
    v_cvt_f32_i32 v90, v90
    v_cvt_f32_i32 v91, v91
    v_mul_f32 v56, v88, v24
    v_fmac_f32 v56, v89, v25
    v_fmac_f32 v56, v90, v26
    v_fmac_f32 v56, v91, v27
    v_cvt_f32_i32 v92, v92
    v_cvt_f32_i32 v93, v93
    v_cvt_f32_i32 v94, v94
    v_cvt_f32_i32 v95, v95
    v_fmac_f32 v56, v92, v28
    v_fmac_f32 v56, v93, v29
    v_fmac_f32 v56, v94, v30
    v_fmac_f32 v56, v95, v31
    v_cvt_f32_i32 v96, v96
    v_cvt_f32_i32 v97, v97
    v_cvt_f32_i32 v98, v98
    v_cvt_f32_i32 v99, v99
    v_fmac_f32 v56, v96, v32
    v_fmac_f32 v56, v97, v33
    v_fmac_f32 v56, v98, v34
    v_fmac_f32 v56, v99, v35
    v_cvt_f32_i32 v100, v100
    v_cvt_f32_i32 v101, v101
    v_add_f32_dpp v56, v56, v56 row_ror:8 row_mask:0xf bank_mask:0xf
    v_cvt_f32_i32 v102, v102
    v_cvt_f32_i32 v103, v103
    v_add_f32_dpp v56, v56, v56 row_ror:4 row_mask:0xf bank_mask:0xf
    v_mul_f32 v57, v100, v24
    v_fmac_f32 v57, v101, v25
    v_add_f32_dpp v56, v56, v56 row_ror:2 row_mask:0xf bank_mask:0xf
    v_fmac_f32 v57, v102, v26
    v_fmac_f32 v57, v103, v27
    v_add_f32_dpp v60, v56, v56 row_ror:1 row_mask:0xf bank_mask:0x2
    v_cvt_f32_i32 v104, v104
    v_cvt_f32_i32 v105, v105
    v_cvt_f32_i32 v106, v106
    v_cvt_f32_i32 v107, v107
    v_fmac_f32 v57, v104, v28
    v_fmac_f32 v57, v105, v29
    v_fmac_f32 v57, v106, v30
    v_fmac_f32 v57, v107, v31
    v_cvt_f32_i32 v108, v108
    v_cvt_f32_i32 v109, v109
    v_cvt_f32_i32 v110, v110
    v_cvt_f32_i32 v111, v111
    v_fmac_f32 v57, v108, v32
    v_fmac_f32 v57, v109, v33
    v_fmac_f32 v57, v110, v34
    v_fmac_f32 v57, v111, v35
    s_nop 1
    v_add_f32_dpp v57, v57, v57 row_ror:8 row_mask:0xf bank_mask:0xf
    s_nop 1
    v_add_f32_dpp v57, v57, v57 row_ror:4 row_mask:0xf bank_mask:0xf
    s_nop 1
    v_add_f32_dpp v57, v57, v57 row_ror:2 row_mask:0xf bank_mask:0xf
    s_nop 1
    v_add_f32_dpp v61, v57, v57 row_ror:1 row_mask:0xf bank_mask:0x2
    s_waitcnt vmcnt(3)
    buffer_load_dwordx4 v[64:67], v48, s[8:11], 0 offen offset:0 nt
    buffer_load_dwordx4 v[68:71], v48, s[8:11], 0 offen offset:256 nt
    buffer_load_dwordx4 v[72:75], v48, s[8:11], 0 offen offset:512 nt
    buffer_load_dwordx4 v[76:79], v48, s[8:11], 0 offen offset:768 nt
    buffer_load_dwordx4 v[80:83], v48, s[8:11], 0 offen offset:1024 nt
    buffer_load_dwordx4 v[84:87], v48, s[8:11], 0 offen offset:1280 nt
    v_cvt_f32_i32 v112, v112
    v_cvt_f32_i32 v113, v113
    v_cvt_f32_i32 v114, v114
    v_cvt_f32_i32 v115, v115
    v_mul_f32 v58, v112, v24
    v_fmac_f32 v58, v113, v25
    v_fmac_f32 v58, v114, v26
    v_fmac_f32 v58, v115, v27
    v_cvt_f32_i32 v116, v116
    v_cvt_f32_i32 v117, v117
    v_cvt_f32_i32 v118, v118
    v_cvt_f32_i32 v119, v119
    v_fmac_f32 v58, v116, v28
    v_fmac_f32 v58, v117, v29
    v_fmac_f32 v58, v118, v30
    v_fmac_f32 v58, v119, v31
    v_cvt_f32_i32 v120, v120
    v_cvt_f32_i32 v121, v121
    v_cvt_f32_i32 v122, v122
    v_cvt_f32_i32 v123, v123
    v_fmac_f32 v58, v120, v32
    v_fmac_f32 v58, v121, v33
    v_fmac_f32 v58, v122, v34
    v_fmac_f32 v58, v123, v35
    v_cvt_f32_i32 v124, v124
    v_cvt_f32_i32 v125, v125
    v_add_f32_dpp v58, v58, v58 row_ror:8 row_mask:0xf bank_mask:0xf
    v_cvt_f32_i32 v126, v126
    v_cvt_f32_i32 v127, v127
    v_add_f32_dpp v58, v58, v58 row_ror:4 row_mask:0xf bank_mask:0xf
    v_mul_f32 v59, v124, v24
    v_fmac_f32 v59, v125, v25
    v_add_f32_dpp v58, v58, v58 row_ror:2 row_mask:0xf bank_mask:0xf
    v_fmac_f32 v59, v126, v26
    v_fmac_f32 v59, v127, v27
    v_add_f32_dpp v60, v58, v58 row_ror:1 row_mask:0xf bank_mask:0x4
    v_cvt_f32_i32 v128, v128
    v_cvt_f32_i32 v129, v129
    v_cvt_f32_i32 v130, v130
    v_cvt_f32_i32 v131, v131
    v_fmac_f32 v59, v128, v28
    v_fmac_f32 v59, v129, v29
    v_fmac_f32 v59, v130, v30
    v_fmac_f32 v59, v131, v31
    v_cvt_f32_i32 v132, v132
    v_cvt_f32_i32 v133, v133
    v_cvt_f32_i32 v134, v134
    v_cvt_f32_i32 v135, v135
    v_fmac_f32 v59, v132, v32
    v_fmac_f32 v59, v133, v33
    v_fmac_f32 v59, v134, v34
    v_fmac_f32 v59, v135, v35
    s_nop 1
    v_add_f32_dpp v59, v59, v59 row_ror:8 row_mask:0xf bank_mask:0xf
    s_nop 1
    v_add_f32_dpp v59, v59, v59 row_ror:4 row_mask:0xf bank_mask:0xf
    s_nop 1
    v_add_f32_dpp v59, v59, v59 row_ror:2 row_mask:0xf bank_mask:0xf
    s_nop 1
    v_add_f32_dpp v61, v59, v59 row_ror:1 row_mask:0xf bank_mask:0x4
    s_mov_b64 exec, s[42:43]
    ds_write_b64 v4, v[60:61]
    s_mov_b64 exec, -1
    v_add_u32 v4, 48, v4
    s_waitcnt vmcnt(6)
    v_lshlrev_b32 v10, 16, v36
    v_lshlrev_b32 v24, 16, v42
    v_and_b32 v11, 0xffff0000, v36
    v_and_b32 v25, 0xffff0000, v42
    v_mul_f32 v24, v24, v10
    v_mul_f32 v25, v25, v11
    v_lshlrev_b32 v10, 16, v37
    v_lshlrev_b32 v26, 16, v43
    v_and_b32 v11, 0xffff0000, v37
    v_and_b32 v27, 0xffff0000, v43
    v_mul_f32 v26, v26, v10
    v_mul_f32 v27, v27, v11
    v_lshlrev_b32 v10, 16, v38
    v_lshlrev_b32 v28, 16, v44
    v_and_b32 v11, 0xffff0000, v38
    v_and_b32 v29, 0xffff0000, v44
    v_mul_f32 v28, v28, v10
    v_mul_f32 v29, v29, v11
    v_lshlrev_b32 v10, 16, v39
    v_lshlrev_b32 v30, 16, v45
    v_and_b32 v11, 0xffff0000, v39
    v_and_b32 v31, 0xffff0000, v45
    v_mul_f32 v30, v30, v10
    v_mul_f32 v31, v31, v11
    v_lshlrev_b32 v10, 16, v40
    v_lshlrev_b32 v32, 16, v46
    v_and_b32 v11, 0xffff0000, v40
    v_and_b32 v33, 0xffff0000, v46
    v_mul_f32 v32, v32, v10
    v_mul_f32 v33, v33, v11
    v_lshlrev_b32 v10, 16, v41
    v_lshlrev_b32 v34, 16, v47
    v_and_b32 v11, 0xffff0000, v41
    v_and_b32 v35, 0xffff0000, v47
    v_mul_f32 v34, v34, v10
    v_mul_f32 v35, v35, v11
.p2align 6
L_kloop:
    s_nop 1
    s_waitcnt vmcnt(0)
    buffer_load_dwordx4 v[88:91], v48, s[8:11], 0 offen offset:1536 nt
    buffer_load_dwordx4 v[92:95], v48, s[8:11], 0 offen offset:1792 nt
    buffer_load_dwordx4 v[96:99], v48, s[8:11], 0 offen offset:2048 nt
    buffer_load_dwordx4 v[100:103], v48, s[8:11], 0 offen offset:2304 nt
    buffer_load_dwordx4 v[104:107], v48, s[8:11], 0 offen offset:2560 nt
    buffer_load_dwordx4 v[108:111], v48, s[8:11], 0 offen offset:2816 nt
    v_cvt_f32_i32 v64, v64
    v_cvt_f32_i32 v65, v65
    v_cvt_f32_i32 v66, v66
    v_cvt_f32_i32 v67, v67
    v_mul_f32 v54, v64, v24
    v_fmac_f32 v54, v65, v25
    v_fmac_f32 v54, v66, v26
    v_fmac_f32 v54, v67, v27
    v_cvt_f32_i32 v68, v68
    v_cvt_f32_i32 v69, v69
    v_cvt_f32_i32 v70, v70
    v_cvt_f32_i32 v71, v71
    v_fmac_f32 v54, v68, v28
    v_fmac_f32 v54, v69, v29
    v_fmac_f32 v54, v70, v30
    v_fmac_f32 v54, v71, v31
    v_cvt_f32_i32 v72, v72
    v_cvt_f32_i32 v73, v73
    v_cvt_f32_i32 v74, v74
    v_cvt_f32_i32 v75, v75
    v_fmac_f32 v54, v72, v32
    v_fmac_f32 v54, v73, v33
    v_fmac_f32 v54, v74, v34
    v_fmac_f32 v54, v75, v35
    v_cvt_f32_i32 v76, v76
    v_cvt_f32_i32 v77, v77
    v_add_f32_dpp v54, v54, v54 row_ror:8 row_mask:0xf bank_mask:0xf
    v_cvt_f32_i32 v78, v78
    v_cvt_f32_i32 v79, v79
    v_add_f32_dpp v54, v54, v54 row_ror:4 row_mask:0xf bank_mask:0xf
    v_mul_f32 v55, v76, v24
    v_fmac_f32 v55, v77, v25
    v_add_f32_dpp v54, v54, v54 row_ror:2 row_mask:0xf bank_mask:0xf
    v_fmac_f32 v55, v78, v26
    v_fmac_f32 v55, v79, v27
    v_add_f32_dpp v60, v54, v54 row_ror:1 row_mask:0xf bank_mask:0x1
    v_cvt_f32_i32 v80, v80
    v_cvt_f32_i32 v81, v81
    v_cvt_f32_i32 v82, v82
    v_cvt_f32_i32 v83, v83
    v_fmac_f32 v55, v80, v28
    v_fmac_f32 v55, v81, v29
    v_fmac_f32 v55, v82, v30
    v_fmac_f32 v55, v83, v31
    v_cvt_f32_i32 v84, v84
    v_cvt_f32_i32 v85, v85
    v_cvt_f32_i32 v86, v86
    v_cvt_f32_i32 v87, v87
    v_fmac_f32 v55, v84, v32
    v_fmac_f32 v55, v85, v33
    v_fmac_f32 v55, v86, v34
    v_fmac_f32 v55, v87, v35
    s_nop 1
    v_add_f32_dpp v55, v55, v55 row_ror:8 row_mask:0xf bank_mask:0xf
    s_nop 1
    v_add_f32_dpp v55, v55, v55 row_ror:4 row_mask:0xf bank_mask:0xf
    s_nop 1
    v_add_f32_dpp v55, v55, v55 row_ror:2 row_mask:0xf bank_mask:0xf
    s_nop 1
    v_add_f32_dpp v61, v55, v55 row_ror:1 row_mask:0xf bank_mask:0x1
    s_waitcnt vmcnt(0)
    buffer_load_dwordx4 v[112:115], v48, s[8:11], 0 offen offset:3072 nt
    buffer_load_dwordx4 v[116:119], v48, s[8:11], 0 offen offset:3328 nt
    buffer_load_dwordx4 v[120:123], v48, s[8:11], 0 offen offset:3584 nt
    buffer_load_dwordx4 v[124:127], v49, s[8:11], 0 offen offset:0 nt
    buffer_load_dwordx4 v[128:131], v49, s[8:11], 0 offen offset:256 nt
    buffer_load_dwordx4 v[132:135], v49, s[8:11], 0 offen offset:512 nt
    s_add_u32 s29, s29, 4
    s_add_u32 s30, s30, 1
    s_bitcmp1_b64 s[40:41], s30
    s_cbranch_scc1 L_evK
L_evretK:
    s_nop 1
    s_lshr_b32 s33, s29, 6
    s_lshl_b32 s33, s33, 11
    s_and_b32 s32, s29, 63
    s_add_u32 s32, s32, s33
    s_add_u32 s32, s32, s44
    s_bfe_u32 s33, s32, 0x20003
    s_and_b32 s34, s32, 4
    s_or_b32 s33, s33, s34
    s_xor_b32 s33, s33, s5
    s_lshl_b32 s50, s32, 5
    s_or_b32 s50, s50, s33
    s_lshl_b32 s50, s50, 4
    s_or_b32 s50, s50, 1
    v_xor_b32 v10, s50, v50
    v_mul_hi_u32 v10, v10, s47
    v_lshrrev_b32 v10, 1, v10
    v_and_b32 v11, 15, v10
    v_cmp_eq_u32 vcc, 5, v11
    v_mad_u32_u24 v48, v10, s45, v2
    v_add_u32 v11, 3840, v48
    v_cndmask_b32 v49, v51, v11, vcc
    v_lshrrev_b32 v10, 6, v10
    v_mad_u32_u24 v9, v10, s46, v3
    buffer_load_dwordx2 v[42:43], v9, s[16:19], 0 offen offset:0
    buffer_load_dwordx2 v[44:45], v9, s[16:19], 0 offen offset:128
    buffer_load_dwordx2 v[46:47], v9, s[16:19], 0 offen offset:256
    v_cvt_f32_i32 v88, v88
    v_cvt_f32_i32 v89, v89
    v_cvt_f32_i32 v90, v90
    v_cvt_f32_i32 v91, v91
    v_mul_f32 v56, v88, v24
    v_fmac_f32 v56, v89, v25
    v_fmac_f32 v56, v90, v26
    v_fmac_f32 v56, v91, v27
    v_cvt_f32_i32 v92, v92
    v_cvt_f32_i32 v93, v93
    v_cvt_f32_i32 v94, v94
    v_cvt_f32_i32 v95, v95
    v_fmac_f32 v56, v92, v28
    v_fmac_f32 v56, v93, v29
    v_fmac_f32 v56, v94, v30
    v_fmac_f32 v56, v95, v31
    v_cvt_f32_i32 v96, v96
    v_cvt_f32_i32 v97, v97
    v_cvt_f32_i32 v98, v98
    v_cvt_f32_i32 v99, v99
    v_fmac_f32 v56, v96, v32
    v_fmac_f32 v56, v97, v33
    v_fmac_f32 v56, v98, v34
    v_fmac_f32 v56, v99, v35
    v_cvt_f32_i32 v100, v100
    v_cvt_f32_i32 v101, v101
    v_add_f32_dpp v56, v56, v56 row_ror:8 row_mask:0xf bank_mask:0xf
    v_cvt_f32_i32 v102, v102
    v_cvt_f32_i32 v103, v103
    v_add_f32_dpp v56, v56, v56 row_ror:4 row_mask:0xf bank_mask:0xf
    v_mul_f32 v57, v100, v24
    v_fmac_f32 v57, v101, v25
    v_add_f32_dpp v56, v56, v56 row_ror:2 row_mask:0xf bank_mask:0xf
    v_fmac_f32 v57, v102, v26
    v_fmac_f32 v57, v103, v27
    v_add_f32_dpp v60, v56, v56 row_ror:1 row_mask:0xf bank_mask:0x2
    v_cvt_f32_i32 v104, v104
    v_cvt_f32_i32 v105, v105
    v_cvt_f32_i32 v106, v106
    v_cvt_f32_i32 v107, v107
    v_fmac_f32 v57, v104, v28
    v_fmac_f32 v57, v105, v29
    v_fmac_f32 v57, v106, v30
    v_fmac_f32 v57, v107, v31
    v_cvt_f32_i32 v108, v108
    v_cvt_f32_i32 v109, v109
    v_cvt_f32_i32 v110, v110
    v_cvt_f32_i32 v111, v111
    v_fmac_f32 v57, v108, v32
    v_fmac_f32 v57, v109, v33
    v_fmac_f32 v57, v110, v34
    v_fmac_f32 v57, v111, v35
    s_nop 1
    v_add_f32_dpp v57, v57, v57 row_ror:8 row_mask:0xf bank_mask:0xf
    s_nop 1
    v_add_f32_dpp v57, v57, v57 row_ror:4 row_mask:0xf bank_mask:0xf
    s_nop 1
    v_add_f32_dpp v57, v57, v57 row_ror:2 row_mask:0xf bank_mask:0xf
    s_nop 1
    v_add_f32_dpp v61, v57, v57 row_ror:1 row_mask:0xf bank_mask:0x2
    s_waitcnt vmcnt(3)
    buffer_load_dwordx4 v[64:67], v48, s[8:11], 0 offen offset:0 nt
    buffer_load_dwordx4 v[68:71], v48, s[8:11], 0 offen offset:256 nt
    buffer_load_dwordx4 v[72:75], v48, s[8:11], 0 offen offset:512 nt
    buffer_load_dwordx4 v[76:79], v48, s[8:11], 0 offen offset:768 nt
    buffer_load_dwordx4 v[80:83], v48, s[8:11], 0 offen offset:1024 nt
    buffer_load_dwordx4 v[84:87], v48, s[8:11], 0 offen offset:1280 nt
    v_cvt_f32_i32 v112, v112
    v_cvt_f32_i32 v113, v113
    v_cvt_f32_i32 v114, v114
    v_cvt_f32_i32 v115, v115
    v_mul_f32 v58, v112, v24
    v_fmac_f32 v58, v113, v25
    v_fmac_f32 v58, v114, v26
    v_fmac_f32 v58, v115, v27
    v_cvt_f32_i32 v116, v116
    v_cvt_f32_i32 v117, v117
    v_cvt_f32_i32 v118, v118
    v_cvt_f32_i32 v119, v119
    v_fmac_f32 v58, v116, v28
    v_fmac_f32 v58, v117, v29
    v_fmac_f32 v58, v118, v30
    v_fmac_f32 v58, v119, v31
    v_cvt_f32_i32 v120, v120
    v_cvt_f32_i32 v121, v121
    v_cvt_f32_i32 v122, v122
    v_cvt_f32_i32 v123, v123
    v_fmac_f32 v58, v120, v32
    v_fmac_f32 v58, v121, v33
    v_fmac_f32 v58, v122, v34
    v_fmac_f32 v58, v123, v35
    v_cvt_f32_i32 v124, v124
    v_cvt_f32_i32 v125, v125
    v_add_f32_dpp v58, v58, v58 row_ror:8 row_mask:0xf bank_mask:0xf
    v_cvt_f32_i32 v126, v126
    v_cvt_f32_i32 v127, v127
    v_add_f32_dpp v58, v58, v58 row_ror:4 row_mask:0xf bank_mask:0xf
    v_mul_f32 v59, v124, v24
    v_fmac_f32 v59, v125, v25
    v_add_f32_dpp v58, v58, v58 row_ror:2 row_mask:0xf bank_mask:0xf
    v_fmac_f32 v59, v126, v26
    v_fmac_f32 v59, v127, v27
    v_add_f32_dpp v60, v58, v58 row_ror:1 row_mask:0xf bank_mask:0x4
    v_cvt_f32_i32 v128, v128
    v_cvt_f32_i32 v129, v129
    v_cvt_f32_i32 v130, v130
    v_cvt_f32_i32 v131, v131
    v_fmac_f32 v59, v128, v28
    v_fmac_f32 v59, v129, v29
    v_fmac_f32 v59, v130, v30
    v_fmac_f32 v59, v131, v31
    v_cvt_f32_i32 v132, v132
    v_cvt_f32_i32 v133, v133
    v_cvt_f32_i32 v134, v134
    v_cvt_f32_i32 v135, v135
    v_fmac_f32 v59, v132, v32
    v_fmac_f32 v59, v133, v33
    v_fmac_f32 v59, v134, v34
    v_fmac_f32 v59, v135, v35
    s_nop 1
    v_add_f32_dpp v59, v59, v59 row_ror:8 row_mask:0xf bank_mask:0xf
    s_nop 1
    v_add_f32_dpp v59, v59, v59 row_ror:4 row_mask:0xf bank_mask:0xf
    s_nop 1
    v_add_f32_dpp v59, v59, v59 row_ror:2 row_mask:0xf bank_mask:0xf
    s_nop 1
    v_add_f32_dpp v61, v59, v59 row_ror:1 row_mask:0xf bank_mask:0x4
    s_mov_b64 exec, s[42:43]
    ds_write_b64 v4, v[60:61]
    s_mov_b64 exec, -1
    v_add_u32 v4, 48, v4
    s_waitcnt vmcnt(6)
    v_lshlrev_b32 v10, 16, v36
    v_lshlrev_b32 v24, 16, v42
    v_and_b32 v11, 0xffff0000, v36
    v_and_b32 v25, 0xffff0000, v42
    v_mul_f32 v24, v24, v10
    v_mul_f32 v25, v25, v11
    v_lshlrev_b32 v10, 16, v37
    v_lshlrev_b32 v26, 16, v43
    v_and_b32 v11, 0xffff0000, v37
    v_and_b32 v27, 0xffff0000, v43
    v_mul_f32 v26, v26, v10
    v_mul_f32 v27, v27, v11
    v_lshlrev_b32 v10, 16, v38
    v_lshlrev_b32 v28, 16, v44
    v_and_b32 v11, 0xffff0000, v38
    v_and_b32 v29, 0xffff0000, v44
    v_mul_f32 v28, v28, v10
    v_mul_f32 v29, v29, v11
    v_lshlrev_b32 v10, 16, v39
    v_lshlrev_b32 v30, 16, v45
    v_and_b32 v11, 0xffff0000, v39
    v_and_b32 v31, 0xffff0000, v45
    v_mul_f32 v30, v30, v10
    v_mul_f32 v31, v31, v11
    v_lshlrev_b32 v10, 16, v40
    v_lshlrev_b32 v32, 16, v46
    v_and_b32 v11, 0xffff0000, v40
    v_and_b32 v33, 0xffff0000, v46
    v_mul_f32 v32, v32, v10
    v_mul_f32 v33, v33, v11
    v_lshlrev_b32 v10, 16, v41
    v_lshlrev_b32 v34, 16, v47
    v_and_b32 v11, 0xffff0000, v41
    v_and_b32 v35, 0xffff0000, v47
    v_mul_f32 v34, v34, v10
    v_mul_f32 v35, v35, v11
L_kchk:
    s_nop 1
    s_cmp_lg_u32 s59, 0
    s_cbranch_scc1 L_kboost
L_kchk2:
    s_nop 1
    s_cmp_lg_u32 s30, 47
    s_cbranch_scc1 L_kloop
    s_waitcnt vmcnt(0)
    buffer_load_dwordx4 v[88:91], v48, s[8:11], 0 offen offset:1536 nt
    buffer_load_dwordx4 v[92:95], v48, s[8:11], 0 offen offset:1792 nt
    buffer_load_dwordx4 v[96:99], v48, s[8:11], 0 offen offset:2048 nt
    buffer_load_dwordx4 v[100:103], v48, s[8:11], 0 offen offset:2304 nt
    buffer_load_dwordx4 v[104:107], v48, s[8:11], 0 offen offset:2560 nt
    buffer_load_dwordx4 v[108:111], v48, s[8:11], 0 offen offset:2816 nt
    v_cvt_f32_i32 v64, v64
    v_cvt_f32_i32 v65, v65
    v_cvt_f32_i32 v66, v66
    v_cvt_f32_i32 v67, v67
    v_mul_f32 v54, v64, v24
    v_fmac_f32 v54, v65, v25
    v_fmac_f32 v54, v66, v26
    v_fmac_f32 v54, v67, v27
    v_cvt_f32_i32 v68, v68
    v_cvt_f32_i32 v69, v69
    v_cvt_f32_i32 v70, v70
    v_cvt_f32_i32 v71, v71
    v_fmac_f32 v54, v68, v28
    v_fmac_f32 v54, v69, v29
    v_fmac_f32 v54, v70, v30
    v_fmac_f32 v54, v71, v31
    v_cvt_f32_i32 v72, v72
    v_cvt_f32_i32 v73, v73
    v_cvt_f32_i32 v74, v74
    v_cvt_f32_i32 v75, v75
    v_fmac_f32 v54, v72, v32
    v_fmac_f32 v54, v73, v33
    v_fmac_f32 v54, v74, v34
    v_fmac_f32 v54, v75, v35
    v_cvt_f32_i32 v76, v76
    v_cvt_f32_i32 v77, v77
    v_add_f32_dpp v54, v54, v54 row_ror:8 row_mask:0xf bank_mask:0xf
    v_cvt_f32_i32 v78, v78
    v_cvt_f32_i32 v79, v79
    v_add_f32_dpp v54, v54, v54 row_ror:4 row_mask:0xf bank_mask:0xf
    v_mul_f32 v55, v76, v24
    v_fmac_f32 v55, v77, v25
    v_add_f32_dpp v54, v54, v54 row_ror:2 row_mask:0xf bank_mask:0xf
    v_fmac_f32 v55, v78, v26
    v_fmac_f32 v55, v79, v27
    v_add_f32_dpp v60, v54, v54 row_ror:1 row_mask:0xf bank_mask:0x1
    v_cvt_f32_i32 v80, v80
    v_cvt_f32_i32 v81, v81
    v_cvt_f32_i32 v82, v82
    v_cvt_f32_i32 v83, v83
    v_fmac_f32 v55, v80, v28
    v_fmac_f32 v55, v81, v29
    v_fmac_f32 v55, v82, v30
    v_fmac_f32 v55, v83, v31
    v_cvt_f32_i32 v84, v84
    v_cvt_f32_i32 v85, v85
    v_cvt_f32_i32 v86, v86
    v_cvt_f32_i32 v87, v87
    v_fmac_f32 v55, v84, v32
    v_fmac_f32 v55, v85, v33
    v_fmac_f32 v55, v86, v34
    v_fmac_f32 v55, v87, v35
    s_nop 1
    v_add_f32_dpp v55, v55, v55 row_ror:8 row_mask:0xf bank_mask:0xf
    s_nop 1
    v_add_f32_dpp v55, v55, v55 row_ror:4 row_mask:0xf bank_mask:0xf
    s_nop 1
    v_add_f32_dpp v55, v55, v55 row_ror:2 row_mask:0xf bank_mask:0xf
    s_nop 1
    v_add_f32_dpp v61, v55, v55 row_ror:1 row_mask:0xf bank_mask:0x1
    s_waitcnt vmcnt(0)
    buffer_load_dwordx4 v[112:115], v48, s[8:11], 0 offen offset:3072 nt
    buffer_load_dwordx4 v[116:119], v48, s[8:11], 0 offen offset:3328 nt
    buffer_load_dwordx4 v[120:123], v48, s[8:11], 0 offen offset:3584 nt
    buffer_load_dwordx4 v[124:127], v49, s[8:11], 0 offen offset:0 nt
    buffer_load_dwordx4 v[128:131], v49, s[8:11], 0 offen offset:256 nt
    buffer_load_dwordx4 v[132:135], v49, s[8:11], 0 offen offset:512 nt
    s_mov_b32 s29, s28
    s_mov_b32 s30, 0
    s_memrealtime s[36:37]
    s_mov_b32 s6, 0x100000
L_wgtv:
    s_nop 1
    ds_read_b32 v10, v53 offset:216
    s_sub_u32 s6, s6, 1
    s_cbranch_scc1 L_exit1
    s_waitcnt lgkmcnt(0)
    v_readfirstlane_b32 s32, v10
    s_cmp_eq_u32 s32, 0
    s_cbranch_scc1 L_wgtv
    s_and_b32 s32, s32, 0xffff
    s_cbranch_scc0 L_gxtv
    s_add_u32 s32, s32, s36
L_gltv:
    s_nop 1
    s_memrealtime s[36:37]
    s_waitcnt lgkmcnt(0)
    s_sub_u32 s36, s36, s32
    s_cmp_lt_i32 s36, 0
    s_cbranch_scc1 L_gltv
L_gxtv:
    s_nop 1
    s_lshr_b32 s33, s30, 4
    s_lshl_b32 s34, s33, 2
    v_mov_b32 v11, s34
    s_mov_b32 s6, 0x100000
L_wtv:
    s_nop 1
    ds_read_b32 v10, v11 offset:24
    s_sub_u32 s6, s6, 1
    s_cbranch_scc1 L_exit1
    s_waitcnt lgkmcnt(0)
    v_readfirstlane_b32 s32, v10
    s_cmp_eq_u32 s32, 0
    s_cbranch_scc1 L_wtv
    s_and_b32 s5, s32, 7
    s_xor_b32 s5, s5, s48
    s_bitcmp1_b32 s32, 3
    s_cselect_b64 vcc, -1, 0
    v_cndmask_b32 v50, v62, v63, vcc
    s_mov_b32 s49, 45
    s_mov_b32 s40, 0x2a2b2a2a
    s_mov_b32 s41, 0x152b
    s_mov_b32 s64, 0x2020202
    s_mov_b32 s65, 0x102
    s_mov_b32 s66, 0x8080808
    s_mov_b32 s67, 0x408
    s_mov_b32 s68, 0x20202020
    s_mov_b32 s69, 0x1020
    s_mov_b32 s70, 0x10000
    s_mov_b32 s71, 0x1
    s_lshr_b32 s33, s29, 6
    s_lshl_b32 s33, s33, 11
    s_and_b32 s32, s29, 63
    s_add_u32 s32, s32, s33
    s_add_u32 s32, s32, s44
    s_bfe_u32 s33, s32, 0x20003
    s_and_b32 s34, s32, 4
    s_or_b32 s33, s33, s34
    s_xor_b32 s33, s33, s5
    s_lshl_b32 s50, s32, 5
    s_or_b32 s50, s50, s33
    s_lshl_b32 s50, s50, 4
    s_or_b32 s50, s50, 1
    s_lshl_b32 s53, s29, 7
    v_xor_b32 v10, s50, v50
    v_mul_hi_u32 v10, v10, s47
    v_lshrrev_b32 v10, 1, v10
    v_and_b32 v11, 15, v10
    v_cmp_eq_u32 vcc, 5, v11
    v_mad_u32_u24 v48, v10, s45, v2
    v_add_u32 v11, 3840, v48
    v_cndmask_b32 v49, v51, v11, vcc
    v_add_u32 v10, s53, v5
    ds_read_b32 v7, v10
    v_cvt_f32_i32 v88, v88
    v_cvt_f32_i32 v89, v89
    v_cvt_f32_i32 v90, v90
    v_cvt_f32_i32 v91, v91
    v_mul_f32 v56, v88, v24
    v_fmac_f32 v56, v89, v25
    v_fmac_f32 v56, v90, v26
    v_fmac_f32 v56, v91, v27
    v_cvt_f32_i32 v92, v92
    v_cvt_f32_i32 v93, v93
    v_cvt_f32_i32 v94, v94
    v_cvt_f32_i32 v95, v95
    v_fmac_f32 v56, v92, v28
    v_fmac_f32 v56, v93, v29
    v_fmac_f32 v56, v94, v30
    v_fmac_f32 v56, v95, v31
    v_cvt_f32_i32 v96, v96
    v_cvt_f32_i32 v97, v97
    v_cvt_f32_i32 v98, v98
    v_cvt_f32_i32 v99, v99
    v_fmac_f32 v56, v96, v32
    v_fmac_f32 v56, v97, v33
    v_fmac_f32 v56, v98, v34
    v_fmac_f32 v56, v99, v35
    v_cvt_f32_i32 v100, v100
    v_cvt_f32_i32 v101, v101
    v_add_f32_dpp v56, v56, v56 row_ror:8 row_mask:0xf bank_mask:0xf
    v_cvt_f32_i32 v102, v102
    v_cvt_f32_i32 v103, v103
    v_add_f32_dpp v56, v56, v56 row_ror:4 row_mask:0xf bank_mask:0xf
    v_mul_f32 v57, v100, v24
    v_fmac_f32 v57, v101, v25
    v_add_f32_dpp v56, v56, v56 row_ror:2 row_mask:0xf bank_mask:0xf
    v_fmac_f32 v57, v102, v26
    v_fmac_f32 v57, v103, v27
    v_add_f32_dpp v60, v56, v56 row_ror:1 row_mask:0xf bank_mask:0x2
    v_cvt_f32_i32 v104, v104
    v_cvt_f32_i32 v105, v105
    v_cvt_f32_i32 v106, v106
    v_cvt_f32_i32 v107, v107
    v_fmac_f32 v57, v104, v28
    v_fmac_f32 v57, v105, v29
    v_fmac_f32 v57, v106, v30
    v_fmac_f32 v57, v107, v31
    v_cvt_f32_i32 v108, v108
    v_cvt_f32_i32 v109, v109
    v_cvt_f32_i32 v110, v110
    v_cvt_f32_i32 v111, v111
    v_fmac_f32 v57, v108, v32
    v_fmac_f32 v57, v109, v33
    v_fmac_f32 v57, v110, v34
    v_fmac_f32 v57, v111, v35
    s_nop 1
    v_add_f32_dpp v57, v57, v57 row_ror:8 row_mask:0xf bank_mask:0xf
    s_nop 1
    v_add_f32_dpp v57, v57, v57 row_ror:4 row_mask:0xf bank_mask:0xf
    s_nop 1
    v_add_f32_dpp v57, v57, v57 row_ror:2 row_mask:0xf bank_mask:0xf
    s_nop 1
    v_add_f32_dpp v61, v57, v57 row_ror:1 row_mask:0xf bank_mask:0x2
    s_waitcnt vmcnt(0)
    buffer_load_dwordx4 v[64:67], v48, s[12:15], 0 offen offset:0 nt
    buffer_load_dwordx4 v[68:71], v48, s[12:15], 0 offen offset:256 nt
    buffer_load_dwordx4 v[72:75], v48, s[12:15], 0 offen offset:512 nt
    buffer_load_dwordx4 v[76:79], v48, s[12:15], 0 offen offset:768 nt
    buffer_load_dwordx4 v[80:83], v48, s[12:15], 0 offen offset:1024 nt
    buffer_load_dwordx4 v[84:87], v48, s[12:15], 0 offen offset:1280 nt
    v_cvt_f32_i32 v112, v112
    v_cvt_f32_i32 v113, v113
    v_cvt_f32_i32 v114, v114
    v_cvt_f32_i32 v115, v115
    v_mul_f32 v58, v112, v24
    v_fmac_f32 v58, v113, v25
    v_fmac_f32 v58, v114, v26
    v_fmac_f32 v58, v115, v27
    v_cvt_f32_i32 v116, v116
    v_cvt_f32_i32 v117, v117
    v_cvt_f32_i32 v118, v118
    v_cvt_f32_i32 v119, v119
    v_fmac_f32 v58, v116, v28
    v_fmac_f32 v58, v117, v29
    v_fmac_f32 v58, v118, v30
    v_fmac_f32 v58, v119, v31
    v_cvt_f32_i32 v120, v120
    v_cvt_f32_i32 v121, v121
    v_cvt_f32_i32 v122, v122
    v_cvt_f32_i32 v123, v123
    v_fmac_f32 v58, v120, v32
    v_fmac_f32 v58, v121, v33
    v_fmac_f32 v58, v122, v34
    v_fmac_f32 v58, v123, v35
    v_cvt_f32_i32 v124, v124
    v_cvt_f32_i32 v125, v125
    v_add_f32_dpp v58, v58, v58 row_ror:8 row_mask:0xf bank_mask:0xf
    v_cvt_f32_i32 v126, v126
    v_cvt_f32_i32 v127, v127
    v_add_f32_dpp v58, v58, v58 row_ror:4 row_mask:0xf bank_mask:0xf
    v_mul_f32 v59, v124, v24
    v_fmac_f32 v59, v125, v25
    v_add_f32_dpp v58, v58, v58 row_ror:2 row_mask:0xf bank_mask:0xf
    v_fmac_f32 v59, v126, v26
    v_fmac_f32 v59, v127, v27
    v_add_f32_dpp v60, v58, v58 row_ror:1 row_mask:0xf bank_mask:0x4
    v_cvt_f32_i32 v128, v128
    v_cvt_f32_i32 v129, v129
    v_cvt_f32_i32 v130, v130
    v_cvt_f32_i32 v131, v131
    v_fmac_f32 v59, v128, v28
    v_fmac_f32 v59, v129, v29
    v_fmac_f32 v59, v130, v30
    v_fmac_f32 v59, v131, v31
    v_cvt_f32_i32 v132, v132
    v_cvt_f32_i32 v133, v133
    v_cvt_f32_i32 v134, v134
    v_cvt_f32_i32 v135, v135
    v_fmac_f32 v59, v132, v32
    v_fmac_f32 v59, v133, v33
    v_fmac_f32 v59, v134, v34
    v_fmac_f32 v59, v135, v35
    s_nop 1
    v_add_f32_dpp v59, v59, v59 row_ror:8 row_mask:0xf bank_mask:0xf
    s_nop 1
    v_add_f32_dpp v59, v59, v59 row_ror:4 row_mask:0xf bank_mask:0xf
    s_nop 1
    v_add_f32_dpp v59, v59, v59 row_ror:2 row_mask:0xf bank_mask:0xf
    s_nop 1
    v_add_f32_dpp v61, v59, v59 row_ror:1 row_mask:0xf bank_mask:0x4
    s_mov_b64 exec, s[42:43]
    ds_write_b64 v4, v[60:61]
    s_mov_b64 exec, -1
    s_waitcnt lgkmcnt(0)
    v_mov_b32 v6, v7
    v_mov_b32 v11, 1
    s_mov_b64 exec, 1
    ds_add_u32 v53, v11 offset:48
    s_mov_b64 exec, -1
.p2align 6
L_vloop:
    s_nop 1
    s_waitcnt vmcnt(0)
    buffer_load_dwordx4 v[88:91], v48, s[12:15], 0 offen offset:1536 nt
    buffer_load_dwordx4 v[92:95], v48, s[12:15], 0 offen offset:1792 nt
    buffer_load_dwordx4 v[96:99], v48, s[12:15], 0 offen offset:2048 nt
    buffer_load_dwordx4 v[100:103], v48, s[12:15], 0 offen offset:2304 nt
    buffer_load_dwordx4 v[104:107], v48, s[12:15], 0 offen offset:2560 nt
    buffer_load_dwordx4 v[108:111], v48, s[12:15], 0 offen offset:2816 nt
    v_cvt_f32_i32 v64, v64
    v_cvt_f32_i32 v65, v65
    v_cvt_f32_i32 v66, v66
    v_cvt_f32_i32 v67, v67
    v_fmac_f32_dpp v12, v6, v64 row_newbcast:0 row_mask:0xf bank_mask:0xf
    v_fmac_f32_dpp v13, v6, v65 row_newbcast:0 row_mask:0xf bank_mask:0xf
    v_fmac_f32_dpp v14, v6, v66 row_newbcast:0 row_mask:0xf bank_mask:0xf
    v_fmac_f32_dpp v15, v6, v67 row_newbcast:0 row_mask:0xf bank_mask:0xf
    v_cvt_f32_i32 v68, v68
    v_cvt_f32_i32 v69, v69
    v_cvt_f32_i32 v70, v70
    v_cvt_f32_i32 v71, v71
    v_fmac_f32_dpp v16, v6, v68 row_newbcast:0 row_mask:0xf bank_mask:0xf
    v_fmac_f32_dpp v17, v6, v69 row_newbcast:0 row_mask:0xf bank_mask:0xf
    v_fmac_f32_dpp v18, v6, v70 row_newbcast:0 row_mask:0xf bank_mask:0xf
    v_fmac_f32_dpp v19, v6, v71 row_newbcast:0 row_mask:0xf bank_mask:0xf
    v_cvt_f32_i32 v72, v72
    v_cvt_f32_i32 v73, v73
    v_cvt_f32_i32 v74, v74
    v_cvt_f32_i32 v75, v75
    v_fmac_f32_dpp v20, v6, v72 row_newbcast:0 row_mask:0xf bank_mask:0xf
    v_fmac_f32_dpp v21, v6, v73 row_newbcast:0 row_mask:0xf bank_mask:0xf
    v_fmac_f32_dpp v22, v6, v74 row_newbcast:0 row_mask:0xf bank_mask:0xf
    v_fmac_f32_dpp v23, v6, v75 row_newbcast:0 row_mask:0xf bank_mask:0xf
    v_cvt_f32_i32 v76, v76
    v_cvt_f32_i32 v77, v77
    v_cvt_f32_i32 v78, v78
    v_cvt_f32_i32 v79, v79
    v_fmac_f32_dpp v12, v6, v76 row_newbcast:1 row_mask:0xf bank_mask:0xf
    v_fmac_f32_dpp v13, v6, v77 row_newbcast:1 row_mask:0xf bank_mask:0xf
    v_fmac_f32_dpp v14, v6, v78 row_newbcast:1 row_mask:0xf bank_mask:0xf
    v_fmac_f32_dpp v15, v6, v79 row_newbcast:1 row_mask:0xf bank_mask:0xf
    v_cvt_f32_i32 v80, v80
    v_cvt_f32_i32 v81, v81
    v_cvt_f32_i32 v82, v82
    v_cvt_f32_i32 v83, v83
    v_fmac_f32_dpp v16, v6, v80 row_newbcast:1 row_mask:0xf bank_mask:0xf
    v_fmac_f32_dpp v17, v6, v81 row_newbcast:1 row_mask:0xf bank_mask:0xf
    v_fmac_f32_dpp v18, v6, v82 row_newbcast:1 row_mask:0xf bank_mask:0xf
    v_fmac_f32_dpp v19, v6, v83 row_newbcast:1 row_mask:0xf bank_mask:0xf
    v_cvt_f32_i32 v84, v84
    v_cvt_f32_i32 v85, v85
    v_cvt_f32_i32 v86, v86
    v_cvt_f32_i32 v87, v87
    v_fmac_f32_dpp v20, v6, v84 row_newbcast:1 row_mask:0xf bank_mask:0xf
    v_fmac_f32_dpp v21, v6, v85 row_newbcast:1 row_mask:0xf bank_mask:0xf
    v_fmac_f32_dpp v22, v6, v86 row_newbcast:1 row_mask:0xf bank_mask:0xf
    v_fmac_f32_dpp v23, v6, v87 row_newbcast:1 row_mask:0xf bank_mask:0xf
    s_waitcnt vmcnt(0)
    buffer_load_dwordx4 v[112:115], v48, s[12:15], 0 offen offset:3072 nt
    buffer_load_dwordx4 v[116:119], v48, s[12:15], 0 offen offset:3328 nt
    buffer_load_dwordx4 v[120:123], v48, s[12:15], 0 offen offset:3584 nt
    buffer_load_dwordx4 v[124:127], v49, s[12:15], 0 offen offset:0 nt
    buffer_load_dwordx4 v[128:131], v49, s[12:15], 0 offen offset:256 nt
    buffer_load_dwordx4 v[132:135], v49, s[12:15], 0 offen offset:512 nt
    s_add_u32 s29, s29, 4
    s_add_u32 s30, s30, 1
    s_bitcmp1_b64 s[40:41], s30
    s_cbranch_scc1 L_evV
L_evretV:
    s_nop 1
    s_lshr_b32 s33, s29, 6
    s_lshl_b32 s33, s33, 11
    s_and_b32 s32, s29, 63
    s_add_u32 s32, s32, s33
    s_add_u32 s32, s32, s44
    s_bfe_u32 s33, s32, 0x20003
    s_and_b32 s34, s32, 4
    s_or_b32 s33, s33, s34
    s_xor_b32 s33, s33, s5
    s_lshl_b32 s50, s32, 5
    s_or_b32 s50, s50, s33
    s_lshl_b32 s50, s50, 4
    s_or_b32 s50, s50, 1
    s_lshl_b32 s53, s29, 7
    v_xor_b32 v10, s50, v50
    v_mul_hi_u32 v10, v10, s47
    v_lshrrev_b32 v10, 1, v10
    v_and_b32 v11, 15, v10
    v_cmp_eq_u32 vcc, 5, v11
    v_mad_u32_u24 v48, v10, s45, v2
    v_add_u32 v11, 3840, v48
    v_cndmask_b32 v49, v51, v11, vcc
    v_add_u32 v10, s53, v5
    ds_read_b32 v7, v10
    s_cmp_eq_u32 s30, 48
    s_cbranch_scc1 L_el0
L_el0r:
    v_cvt_f32_i32 v88, v88
    v_cvt_f32_i32 v89, v89
    v_cvt_f32_i32 v90, v90
    v_cvt_f32_i32 v91, v91
    v_fmac_f32_dpp v12, v6, v88 row_newbcast:2 row_mask:0xf bank_mask:0xf
    v_fmac_f32_dpp v13, v6, v89 row_newbcast:2 row_mask:0xf bank_mask:0xf
    v_fmac_f32_dpp v14, v6, v90 row_newbcast:2 row_mask:0xf bank_mask:0xf
    v_fmac_f32_dpp v15, v6, v91 row_newbcast:2 row_mask:0xf bank_mask:0xf
    v_cvt_f32_i32 v92, v92
    v_cvt_f32_i32 v93, v93
    v_cvt_f32_i32 v94, v94
    v_cvt_f32_i32 v95, v95
    v_fmac_f32_dpp v16, v6, v92 row_newbcast:2 row_mask:0xf bank_mask:0xf
    v_fmac_f32_dpp v17, v6, v93 row_newbcast:2 row_mask:0xf bank_mask:0xf
    v_fmac_f32_dpp v18, v6, v94 row_newbcast:2 row_mask:0xf bank_mask:0xf
    v_fmac_f32_dpp v19, v6, v95 row_newbcast:2 row_mask:0xf bank_mask:0xf
    v_cvt_f32_i32 v96, v96
    v_cvt_f32_i32 v97, v97
    v_cvt_f32_i32 v98, v98
    v_cvt_f32_i32 v99, v99
    v_fmac_f32_dpp v20, v6, v96 row_newbcast:2 row_mask:0xf bank_mask:0xf
    v_fmac_f32_dpp v21, v6, v97 row_newbcast:2 row_mask:0xf bank_mask:0xf
    v_fmac_f32_dpp v22, v6, v98 row_newbcast:2 row_mask:0xf bank_mask:0xf
    v_fmac_f32_dpp v23, v6, v99 row_newbcast:2 row_mask:0xf bank_mask:0xf
    v_cvt_f32_i32 v100, v100
    v_cvt_f32_i32 v101, v101
    v_cvt_f32_i32 v102, v102
    v_cvt_f32_i32 v103, v103
    v_fmac_f32_dpp v12, v6, v100 row_newbcast:3 row_mask:0xf bank_mask:0xf
    v_fmac_f32_dpp v13, v6, v101 row_newbcast:3 row_mask:0xf bank_mask:0xf
    v_fmac_f32_dpp v14, v6, v102 row_newbcast:3 row_mask:0xf bank_mask:0xf
    v_fmac_f32_dpp v15, v6, v103 row_newbcast:3 row_mask:0xf bank_mask:0xf
    v_cvt_f32_i32 v104, v104
    v_cvt_f32_i32 v105, v105
    v_cvt_f32_i32 v106, v106
    v_cvt_f32_i32 v107, v107
    v_fmac_f32_dpp v16, v6, v104 row_newbcast:3 row_mask:0xf bank_mask:0xf
    v_fmac_f32_dpp v17, v6, v105 row_newbcast:3 row_mask:0xf bank_mask:0xf
    v_fmac_f32_dpp v18, v6, v106 row_newbcast:3 row_mask:0xf bank_mask:0xf
    v_fmac_f32_dpp v19, v6, v107 row_newbcast:3 row_mask:0xf bank_mask:0xf
    v_cvt_f32_i32 v108, v108
    v_cvt_f32_i32 v109, v109
    v_cvt_f32_i32 v110, v110
    v_cvt_f32_i32 v111, v111
    v_fmac_f32_dpp v20, v6, v108 row_newbcast:3 row_mask:0xf bank_mask:0xf
    v_fmac_f32_dpp v21, v6, v109 row_newbcast:3 row_mask:0xf bank_mask:0xf
    v_fmac_f32_dpp v22, v6, v110 row_newbcast:3 row_mask:0xf bank_mask:0xf
    v_fmac_f32_dpp v23, v6, v111 row_newbcast:3 row_mask:0xf bank_mask:0xf
    s_waitcnt vmcnt(0)
    buffer_load_dwordx4 v[64:67], v48, s[12:15], 0 offen offset:0 nt
    buffer_load_dwordx4 v[68:71], v48, s[12:15], 0 offen offset:256 nt
    buffer_load_dwordx4 v[72:75], v48, s[12:15], 0 offen offset:512 nt
    buffer_load_dwordx4 v[76:79], v48, s[12:15], 0 offen offset:768 nt
    buffer_load_dwordx4 v[80:83], v48, s[12:15], 0 offen offset:1024 nt
    buffer_load_dwordx4 v[84:87], v48, s[12:15], 0 offen offset:1280 nt
    v_cvt_f32_i32 v112, v112
    v_cvt_f32_i32 v113, v113
    v_cvt_f32_i32 v114, v114
    v_cvt_f32_i32 v115, v115
    v_fmac_f32_dpp v12, v6, v112 row_newbcast:4 row_mask:0xf bank_mask:0xf
    v_fmac_f32_dpp v13, v6, v113 row_newbcast:4 row_mask:0xf bank_mask:0xf
    v_fmac_f32_dpp v14, v6, v114 row_newbcast:4 row_mask:0xf bank_mask:0xf
    v_fmac_f32_dpp v15, v6, v115 row_newbcast:4 row_mask:0xf bank_mask:0xf
    v_cvt_f32_i32 v116, v116
    v_cvt_f32_i32 v117, v117
    v_cvt_f32_i32 v118, v118
    v_cvt_f32_i32 v119, v119
    v_fmac_f32_dpp v16, v6, v116 row_newbcast:4 row_mask:0xf bank_mask:0xf
    v_fmac_f32_dpp v17, v6, v117 row_newbcast:4 row_mask:0xf bank_mask:0xf
    v_fmac_f32_dpp v18, v6, v118 row_newbcast:4 row_mask:0xf bank_mask:0xf
    v_fmac_f32_dpp v19, v6, v119 row_newbcast:4 row_mask:0xf bank_mask:0xf
    v_cvt_f32_i32 v120, v120
    v_cvt_f32_i32 v121, v121
    v_cvt_f32_i32 v122, v122
    v_cvt_f32_i32 v123, v123
    v_fmac_f32_dpp v20, v6, v120 row_newbcast:4 row_mask:0xf bank_mask:0xf
    v_fmac_f32_dpp v21, v6, v121 row_newbcast:4 row_mask:0xf bank_mask:0xf
    v_fmac_f32_dpp v22, v6, v122 row_newbcast:4 row_mask:0xf bank_mask:0xf
    v_fmac_f32_dpp v23, v6, v123 row_newbcast:4 row_mask:0xf bank_mask:0xf
    v_cvt_f32_i32 v124, v124
    v_cvt_f32_i32 v125, v125
    v_cvt_f32_i32 v126, v126
    v_cvt_f32_i32 v127, v127
    v_fmac_f32_dpp v12, v6, v124 row_newbcast:5 row_mask:0xf bank_mask:0xf
    v_fmac_f32_dpp v13, v6, v125 row_newbcast:5 row_mask:0xf bank_mask:0xf
    v_fmac_f32_dpp v14, v6, v126 row_newbcast:5 row_mask:0xf bank_mask:0xf
    v_fmac_f32_dpp v15, v6, v127 row_newbcast:5 row_mask:0xf bank_mask:0xf
    v_cvt_f32_i32 v128, v128
    v_cvt_f32_i32 v129, v129
    v_cvt_f32_i32 v130, v130
    v_cvt_f32_i32 v131, v131
    v_fmac_f32_dpp v16, v6, v128 row_newbcast:5 row_mask:0xf bank_mask:0xf
    v_fmac_f32_dpp v17, v6, v129 row_newbcast:5 row_mask:0xf bank_mask:0xf
    v_fmac_f32_dpp v18, v6, v130 row_newbcast:5 row_mask:0xf bank_mask:0xf
    v_fmac_f32_dpp v19, v6, v131 row_newbcast:5 row_mask:0xf bank_mask:0xf
    v_cvt_f32_i32 v132, v132
    v_cvt_f32_i32 v133, v133
    v_cvt_f32_i32 v134, v134
    v_cvt_f32_i32 v135, v135
    v_fmac_f32_dpp v20, v6, v132 row_newbcast:5 row_mask:0xf bank_mask:0xf
    v_fmac_f32_dpp v21, v6, v133 row_newbcast:5 row_mask:0xf bank_mask:0xf
    v_fmac_f32_dpp v22, v6, v134 row_newbcast:5 row_mask:0xf bank_mask:0xf
    v_fmac_f32_dpp v23, v6, v135 row_newbcast:5 row_mask:0xf bank_mask:0xf
    s_waitcnt lgkmcnt(0)
    v_mov_b32 v6, v7
L_vchk:
    s_nop 1
    s_cmp_eq_u32 s30, s49
    s_cbranch_scc1 L_deep
    s_cmp_lg_u32 s59, 0
    s_cbranch_scc1 L_vboost
    s_and_b32 s32, s30, 15
    s_cbranch_scc1 L_vloop
L_vend:
    s_nop 1
    v_permlane32_swap_b32 v12, v14
    v_permlane32_swap_b32 v13, v15
    v_permlane32_swap_b32 v16, v18
    v_permlane32_swap_b32 v17, v19
    v_permlane32_swap_b32 v20, v22
    v_permlane32_swap_b32 v21, v23
    v_add_f32 v12, v12, v14
    v_add_f32 v13, v13, v15
    v_add_f32 v16, v16, v18
    v_add_f32 v17, v17, v19
    v_add_f32 v20, v20, v22
    v_add_f32 v21, v21, v23
    v_permlane16_swap_b32 v12, v13
    v_permlane16_swap_b32 v16, v17
    v_permlane16_swap_b32 v20, v21
    s_lshr_b32 s32, s30, 2
    v_mov_b32 v10, s32
    v_add_f32 v12, v12, v13
    ds_write_b32 v8, v12 offset:0
    v_add_f32 v16, v16, v17
    ds_write_b32 v8, v16 offset:256
    v_add_f32 v20, v20, v21
    ds_write_b32 v8, v20 offset:512
    v_mov_b32 v11, 1
    s_mov_b64 exec, 1
    ds_add_u32 v10, v11 offset:60
    s_mov_b64 exec, -1
    v_add_u32 v8, 3072, v8
    v_mov_b32 v12, 0
    v_mov_b32 v13, 0
    v_mov_b32 v14, 0
    v_mov_b32 v15, 0
    v_mov_b32 v16, 0
    v_mov_b32 v17, 0
    v_mov_b32 v18, 0
    v_mov_b32 v19, 0
    v_mov_b32 v20, 0
    v_mov_b32 v21, 0
    v_mov_b32 v22, 0
    v_mov_b32 v23, 0
    s_cmp_lg_u32 s59, 0
    s_cbranch_scc1 L_vboost2
L_vend2:
    s_nop 1
    s_cmp_lg_u32 s30, 48
    s_cbranch_scc1 L_vloop
L_exit1:
    s_endpgm
L_deep:
    s_nop 1
    buffer_load_dwordx4 v[88:91], v48, s[12:15], 0 offen offset:1536 nt
    buffer_load_dwordx4 v[92:95], v48, s[12:15], 0 offen offset:1792 nt
    buffer_load_dwordx4 v[96:99], v48, s[12:15], 0 offen offset:2048 nt
    buffer_load_dwordx4 v[100:103], v48, s[12:15], 0 offen offset:2304 nt
    buffer_load_dwordx4 v[104:107], v48, s[12:15], 0 offen offset:2560 nt
    buffer_load_dwordx4 v[108:111], v48, s[12:15], 0 offen offset:2816 nt
    buffer_load_dwordx4 v[112:115], v48, s[12:15], 0 offen offset:3072 nt
    buffer_load_dwordx4 v[116:119], v48, s[12:15], 0 offen offset:3328 nt
    buffer_load_dwordx4 v[120:123], v48, s[12:15], 0 offen offset:3584 nt
    buffer_load_dwordx4 v[124:127], v49, s[12:15], 0 offen offset:0 nt
    buffer_load_dwordx4 v[128:131], v49, s[12:15], 0 offen offset:256 nt
    buffer_load_dwordx4 v[132:135], v49, s[12:15], 0 offen offset:512 nt
.p2align 6
L_dloop:
    s_nop 1
    s_add_u32 s29, s29, 4
    s_add_u32 s30, s30, 1
    s_lshr_b32 s33, s29, 6
    s_lshl_b32 s33, s33, 11
    s_and_b32 s32, s29, 63
    s_add_u32 s32, s32, s33
    s_add_u32 s32, s32, s44
    s_bfe_u32 s33, s32, 0x20003
    s_and_b32 s34, s32, 4
    s_or_b32 s33, s33, s34
    s_xor_b32 s33, s33, s5
    s_lshl_b32 s50, s32, 5
    s_or_b32 s50, s50, s33
    s_lshl_b32 s50, s50, 4
    s_or_b32 s50, s50, 1
    s_lshl_b32 s53, s29, 7
    v_xor_b32 v10, s50, v50
    v_mul_hi_u32 v10, v10, s47
    v_lshrrev_b32 v10, 1, v10
    v_and_b32 v11, 15, v10
    v_cmp_eq_u32 vcc, 5, v11
    v_mad_u32_u24 v48, v10, s45, v2
    v_add_u32 v11, 3840, v48
    v_cndmask_b32 v49, v51, v11, vcc
    v_add_u32 v10, s53, v5
    ds_read_b32 v7, v10
    s_waitcnt vmcnt(12)
    v_cvt_f32_i32 v64, v64
    v_cvt_f32_i32 v65, v65
    v_cvt_f32_i32 v66, v66
    v_cvt_f32_i32 v67, v67
    v_fmac_f32_dpp v12, v6, v64 row_newbcast:0 row_mask:0xf bank_mask:0xf
    v_fmac_f32_dpp v13, v6, v65 row_newbcast:0 row_mask:0xf bank_mask:0xf
    v_fmac_f32_dpp v14, v6, v66 row_newbcast:0 row_mask:0xf bank_mask:0xf
    v_fmac_f32_dpp v15, v6, v67 row_newbcast:0 row_mask:0xf bank_mask:0xf
    v_cvt_f32_i32 v68, v68
    v_cvt_f32_i32 v69, v69
    v_cvt_f32_i32 v70, v70
    v_cvt_f32_i32 v71, v71
    v_fmac_f32_dpp v16, v6, v68 row_newbcast:0 row_mask:0xf bank_mask:0xf
    v_fmac_f32_dpp v17, v6, v69 row_newbcast:0 row_mask:0xf bank_mask:0xf
    v_fmac_f32_dpp v18, v6, v70 row_newbcast:0 row_mask:0xf bank_mask:0xf
    v_fmac_f32_dpp v19, v6, v71 row_newbcast:0 row_mask:0xf bank_mask:0xf
    v_cvt_f32_i32 v72, v72
    v_cvt_f32_i32 v73, v73
    v_cvt_f32_i32 v74, v74
    v_cvt_f32_i32 v75, v75
    v_fmac_f32_dpp v20, v6, v72 row_newbcast:0 row_mask:0xf bank_mask:0xf
    v_fmac_f32_dpp v21, v6, v73 row_newbcast:0 row_mask:0xf bank_mask:0xf
    v_fmac_f32_dpp v22, v6, v74 row_newbcast:0 row_mask:0xf bank_mask:0xf
    v_fmac_f32_dpp v23, v6, v75 row_newbcast:0 row_mask:0xf bank_mask:0xf
    v_cvt_f32_i32 v76, v76
    v_cvt_f32_i32 v77, v77
    v_cvt_f32_i32 v78, v78
    v_cvt_f32_i32 v79, v79
    v_fmac_f32_dpp v12, v6, v76 row_newbcast:1 row_mask:0xf bank_mask:0xf
    v_fmac_f32_dpp v13, v6, v77 row_newbcast:1 row_mask:0xf bank_mask:0xf
    v_fmac_f32_dpp v14, v6, v78 row_newbcast:1 row_mask:0xf bank_mask:0xf
    v_fmac_f32_dpp v15, v6, v79 row_newbcast:1 row_mask:0xf bank_mask:0xf
    v_cvt_f32_i32 v80, v80
    v_cvt_f32_i32 v81, v81
    v_cvt_f32_i32 v82, v82
    v_cvt_f32_i32 v83, v83
    v_fmac_f32_dpp v16, v6, v80 row_newbcast:1 row_mask:0xf bank_mask:0xf
    v_fmac_f32_dpp v17, v6, v81 row_newbcast:1 row_mask:0xf bank_mask:0xf
    v_fmac_f32_dpp v18, v6, v82 row_newbcast:1 row_mask:0xf bank_mask:0xf
    v_fmac_f32_dpp v19, v6, v83 row_newbcast:1 row_mask:0xf bank_mask:0xf
    v_cvt_f32_i32 v84, v84
    v_cvt_f32_i32 v85, v85
    v_cvt_f32_i32 v86, v86
    v_cvt_f32_i32 v87, v87
    v_fmac_f32_dpp v20, v6, v84 row_newbcast:1 row_mask:0xf bank_mask:0xf
    v_fmac_f32_dpp v21, v6, v85 row_newbcast:1 row_mask:0xf bank_mask:0xf
    v_fmac_f32_dpp v22, v6, v86 row_newbcast:1 row_mask:0xf bank_mask:0xf
    v_fmac_f32_dpp v23, v6, v87 row_newbcast:1 row_mask:0xf bank_mask:0xf
    buffer_load_dwordx4 v[64:67], v48, s[12:15], 0 offen offset:0 nt
    buffer_load_dwordx4 v[68:71], v48, s[12:15], 0 offen offset:256 nt
    buffer_load_dwordx4 v[72:75], v48, s[12:15], 0 offen offset:512 nt
    buffer_load_dwordx4 v[76:79], v48, s[12:15], 0 offen offset:768 nt
    buffer_load_dwordx4 v[80:83], v48, s[12:15], 0 offen offset:1024 nt
    buffer_load_dwordx4 v[84:87], v48, s[12:15], 0 offen offset:1280 nt
    s_waitcnt vmcnt(12)
    s_cmp_eq_u32 s30, 48
    s_cbranch_scc1 L_el1
L_el1r:
    v_cvt_f32_i32 v88, v88
    v_cvt_f32_i32 v89, v89
    v_cvt_f32_i32 v90, v90
    v_cvt_f32_i32 v91, v91
    v_fmac_f32_dpp v12, v6, v88 row_newbcast:2 row_mask:0xf bank_mask:0xf
    v_fmac_f32_dpp v13, v6, v89 row_newbcast:2 row_mask:0xf bank_mask:0xf
    v_fmac_f32_dpp v14, v6, v90 row_newbcast:2 row_mask:0xf bank_mask:0xf
    v_fmac_f32_dpp v15, v6, v91 row_newbcast:2 row_mask:0xf bank_mask:0xf
    v_cvt_f32_i32 v92, v92
    v_cvt_f32_i32 v93, v93
    v_cvt_f32_i32 v94, v94
    v_cvt_f32_i32 v95, v95
    v_fmac_f32_dpp v16, v6, v92 row_newbcast:2 row_mask:0xf bank_mask:0xf
    v_fmac_f32_dpp v17, v6, v93 row_newbcast:2 row_mask:0xf bank_mask:0xf
    v_fmac_f32_dpp v18, v6, v94 row_newbcast:2 row_mask:0xf bank_mask:0xf
    v_fmac_f32_dpp v19, v6, v95 row_newbcast:2 row_mask:0xf bank_mask:0xf
    v_cvt_f32_i32 v96, v96
    v_cvt_f32_i32 v97, v97
    v_cvt_f32_i32 v98, v98
    v_cvt_f32_i32 v99, v99
    v_fmac_f32_dpp v20, v6, v96 row_newbcast:2 row_mask:0xf bank_mask:0xf
    v_fmac_f32_dpp v21, v6, v97 row_newbcast:2 row_mask:0xf bank_mask:0xf
    v_fmac_f32_dpp v22, v6, v98 row_newbcast:2 row_mask:0xf bank_mask:0xf
    v_fmac_f32_dpp v23, v6, v99 row_newbcast:2 row_mask:0xf bank_mask:0xf
    v_cvt_f32_i32 v100, v100
    v_cvt_f32_i32 v101, v101
    v_cvt_f32_i32 v102, v102
    v_cvt_f32_i32 v103, v103
    v_fmac_f32_dpp v12, v6, v100 row_newbcast:3 row_mask:0xf bank_mask:0xf
    v_fmac_f32_dpp v13, v6, v101 row_newbcast:3 row_mask:0xf bank_mask:0xf
    v_fmac_f32_dpp v14, v6, v102 row_newbcast:3 row_mask:0xf bank_mask:0xf
    v_fmac_f32_dpp v15, v6, v103 row_newbcast:3 row_mask:0xf bank_mask:0xf
    v_cvt_f32_i32 v104, v104
    v_cvt_f32_i32 v105, v105
    v_cvt_f32_i32 v106, v106
    v_cvt_f32_i32 v107, v107
    v_fmac_f32_dpp v16, v6, v104 row_newbcast:3 row_mask:0xf bank_mask:0xf
    v_fmac_f32_dpp v17, v6, v105 row_newbcast:3 row_mask:0xf bank_mask:0xf
    v_fmac_f32_dpp v18, v6, v106 row_newbcast:3 row_mask:0xf bank_mask:0xf
    v_fmac_f32_dpp v19, v6, v107 row_newbcast:3 row_mask:0xf bank_mask:0xf
    v_cvt_f32_i32 v108, v108
    v_cvt_f32_i32 v109, v109
    v_cvt_f32_i32 v110, v110
    v_cvt_f32_i32 v111, v111
    v_fmac_f32_dpp v20, v6, v108 row_newbcast:3 row_mask:0xf bank_mask:0xf
    v_fmac_f32_dpp v21, v6, v109 row_newbcast:3 row_mask:0xf bank_mask:0xf
    v_fmac_f32_dpp v22, v6, v110 row_newbcast:3 row_mask:0xf bank_mask:0xf
    v_fmac_f32_dpp v23, v6, v111 row_newbcast:3 row_mask:0xf bank_mask:0xf
    buffer_load_dwordx4 v[88:91], v48, s[12:15], 0 offen offset:1536 nt
    buffer_load_dwordx4 v[92:95], v48, s[12:15], 0 offen offset:1792 nt
    buffer_load_dwordx4 v[96:99], v48, s[12:15], 0 offen offset:2048 nt
    buffer_load_dwordx4 v[100:103], v48, s[12:15], 0 offen offset:2304 nt
    buffer_load_dwordx4 v[104:107], v48, s[12:15], 0 offen offset:2560 nt
    buffer_load_dwordx4 v[108:111], v48, s[12:15], 0 offen offset:2816 nt
    s_waitcnt vmcnt(12)
    v_cvt_f32_i32 v112, v112
    v_cvt_f32_i32 v113, v113
    v_cvt_f32_i32 v114, v114
    v_cvt_f32_i32 v115, v115
    v_fmac_f32_dpp v12, v6, v112 row_newbcast:4 row_mask:0xf bank_mask:0xf
    v_fmac_f32_dpp v13, v6, v113 row_newbcast:4 row_mask:0xf bank_mask:0xf
    v_fmac_f32_dpp v14, v6, v114 row_newbcast:4 row_mask:0xf bank_mask:0xf
    v_fmac_f32_dpp v15, v6, v115 row_newbcast:4 row_mask:0xf bank_mask:0xf
    v_cvt_f32_i32 v116, v116
    v_cvt_f32_i32 v117, v117
    v_cvt_f32_i32 v118, v118
    v_cvt_f32_i32 v119, v119
    v_fmac_f32_dpp v16, v6, v116 row_newbcast:4 row_mask:0xf bank_mask:0xf
    v_fmac_f32_dpp v17, v6, v117 row_newbcast:4 row_mask:0xf bank_mask:0xf
    v_fmac_f32_dpp v18, v6, v118 row_newbcast:4 row_mask:0xf bank_mask:0xf
    v_fmac_f32_dpp v19, v6, v119 row_newbcast:4 row_mask:0xf bank_mask:0xf
    v_cvt_f32_i32 v120, v120
    v_cvt_f32_i32 v121, v121
    v_cvt_f32_i32 v122, v122
    v_cvt_f32_i32 v123, v123
    v_fmac_f32_dpp v20, v6, v120 row_newbcast:4 row_mask:0xf bank_mask:0xf
    v_fmac_f32_dpp v21, v6, v121 row_newbcast:4 row_mask:0xf bank_mask:0xf
    v_fmac_f32_dpp v22, v6, v122 row_newbcast:4 row_mask:0xf bank_mask:0xf
    v_fmac_f32_dpp v23, v6, v123 row_newbcast:4 row_mask:0xf bank_mask:0xf
    v_cvt_f32_i32 v124, v124
    v_cvt_f32_i32 v125, v125
    v_cvt_f32_i32 v126, v126
    v_cvt_f32_i32 v127, v127
    v_fmac_f32_dpp v12, v6, v124 row_newbcast:5 row_mask:0xf bank_mask:0xf
    v_fmac_f32_dpp v13, v6, v125 row_newbcast:5 row_mask:0xf bank_mask:0xf
    v_fmac_f32_dpp v14, v6, v126 row_newbcast:5 row_mask:0xf bank_mask:0xf
    v_fmac_f32_dpp v15, v6, v127 row_newbcast:5 row_mask:0xf bank_mask:0xf
    v_cvt_f32_i32 v128, v128
    v_cvt_f32_i32 v129, v129
    v_cvt_f32_i32 v130, v130
    v_cvt_f32_i32 v131, v131
    v_fmac_f32_dpp v16, v6, v128 row_newbcast:5 row_mask:0xf bank_mask:0xf
    v_fmac_f32_dpp v17, v6, v129 row_newbcast:5 row_mask:0xf bank_mask:0xf
    v_fmac_f32_dpp v18, v6, v130 row_newbcast:5 row_mask:0xf bank_mask:0xf
    v_fmac_f32_dpp v19, v6, v131 row_newbcast:5 row_mask:0xf bank_mask:0xf
    v_cvt_f32_i32 v132, v132
    v_cvt_f32_i32 v133, v133
    v_cvt_f32_i32 v134, v134
    v_cvt_f32_i32 v135, v135
    v_fmac_f32_dpp v20, v6, v132 row_newbcast:5 row_mask:0xf bank_mask:0xf
    v_fmac_f32_dpp v21, v6, v133 row_newbcast:5 row_mask:0xf bank_mask:0xf
    v_fmac_f32_dpp v22, v6, v134 row_newbcast:5 row_mask:0xf bank_mask:0xf
    v_fmac_f32_dpp v23, v6, v135 row_newbcast:5 row_mask:0xf bank_mask:0xf
    buffer_load_dwordx4 v[112:115], v48, s[12:15], 0 offen offset:3072 nt
    buffer_load_dwordx4 v[116:119], v48, s[12:15], 0 offen offset:3328 nt
    buffer_load_dwordx4 v[120:123], v48, s[12:15], 0 offen offset:3584 nt
    buffer_load_dwordx4 v[124:127], v49, s[12:15], 0 offen offset:0 nt
    buffer_load_dwordx4 v[128:131], v49, s[12:15], 0 offen offset:256 nt
    buffer_load_dwordx4 v[132:135], v49, s[12:15], 0 offen offset:512 nt
    s_waitcnt lgkmcnt(0)
    v_mov_b32 v6, v7
    s_cmp_lg_u32 s30, 48
    s_cbranch_scc1 L_dloop
    s_branch L_vend
L_kboost:
    s_nop 1
    s_cmp_eq_u32 s30, 47
    s_cbranch_scc1 L_kchk2
    buffer_load_dwordx4 v[88:91], v48, s[8:11], 0 offen offset:1536 nt
    buffer_load_dwordx4 v[92:95], v48, s[8:11], 0 offen offset:1792 nt
    buffer_load_dwordx4 v[96:99], v48, s[8:11], 0 offen offset:2048 nt
    buffer_load_dwordx4 v[100:103], v48, s[8:11], 0 offen offset:2304 nt
    buffer_load_dwordx4 v[104:107], v48, s[8:11], 0 offen offset:2560 nt
    buffer_load_dwordx4 v[108:111], v48, s[8:11], 0 offen offset:2816 nt
    buffer_load_dwordx4 v[112:115], v48, s[8:11], 0 offen offset:3072 nt
    buffer_load_dwordx4 v[116:119], v48, s[8:11], 0 offen offset:3328 nt
    buffer_load_dwordx4 v[120:123], v48, s[8:11], 0 offen offset:3584 nt
    buffer_load_dwordx4 v[124:127], v49, s[8:11], 0 offen offset:0 nt
    buffer_load_dwordx4 v[128:131], v49, s[8:11], 0 offen offset:256 nt
    buffer_load_dwordx4 v[132:135], v49, s[8:11], 0 offen offset:512 nt
    s_sub_u32 s59, s59, 1
    s_add_u32 s29, s29, 4
    s_add_u32 s30, s30, 1
    s_bitcmp1_b64 s[40:41], s30
    s_cbranch_scc1 L_evKB
L_evretKB:
    s_nop 1
    s_lshr_b32 s33, s29, 6
    s_lshl_b32 s33, s33, 11
    s_and_b32 s32, s29, 63
    s_add_u32 s32, s32, s33
    s_add_u32 s32, s32, s44
    s_bfe_u32 s33, s32, 0x20003
    s_and_b32 s34, s32, 4
    s_or_b32 s33, s33, s34
    s_xor_b32 s33, s33, s5
    s_lshl_b32 s50, s32, 5
    s_or_b32 s50, s50, s33
    s_lshl_b32 s50, s50, 4
    s_or_b32 s50, s50, 1
    v_xor_b32 v10, s50, v50
    v_mul_hi_u32 v10, v10, s47
    v_lshrrev_b32 v10, 1, v10
    v_and_b32 v11, 15, v10
    v_cmp_eq_u32 vcc, 5, v11
    v_mad_u32_u24 v48, v10, s45, v2
    v_add_u32 v11, 3840, v48
    v_cndmask_b32 v49, v51, v11, vcc
    v_lshrrev_b32 v10, 6, v10
    v_mad_u32_u24 v9, v10, s46, v3
    buffer_load_dwordx2 v[42:43], v9, s[16:19], 0 offen offset:0
    buffer_load_dwordx2 v[44:45], v9, s[16:19], 0 offen offset:128
    buffer_load_dwordx2 v[46:47], v9, s[16:19], 0 offen offset:256
    s_waitcnt vmcnt(15)
    v_cvt_f32_i32 v64, v64
    v_cvt_f32_i32 v65, v65
    v_cvt_f32_i32 v66, v66
    v_cvt_f32_i32 v67, v67
    v_mul_f32 v54, v64, v24
    v_fmac_f32 v54, v65, v25
    v_fmac_f32 v54, v66, v26
    v_fmac_f32 v54, v67, v27
    v_cvt_f32_i32 v68, v68
    v_cvt_f32_i32 v69, v69
    v_cvt_f32_i32 v70, v70
    v_cvt_f32_i32 v71, v71
    v_fmac_f32 v54, v68, v28
    v_fmac_f32 v54, v69, v29
    v_fmac_f32 v54, v70, v30
    v_fmac_f32 v54, v71, v31
    v_cvt_f32_i32 v72, v72
    v_cvt_f32_i32 v73, v73
    v_cvt_f32_i32 v74, v74
    v_cvt_f32_i32 v75, v75
    v_fmac_f32 v54, v72, v32
    v_fmac_f32 v54, v73, v33
    v_fmac_f32 v54, v74, v34
    v_fmac_f32 v54, v75, v35
    v_cvt_f32_i32 v76, v76
    v_cvt_f32_i32 v77, v77
    v_add_f32_dpp v54, v54, v54 row_ror:8 row_mask:0xf bank_mask:0xf
    v_cvt_f32_i32 v78, v78
    v_cvt_f32_i32 v79, v79
    v_add_f32_dpp v54, v54, v54 row_ror:4 row_mask:0xf bank_mask:0xf
    v_mul_f32 v55, v76, v24
    v_fmac_f32 v55, v77, v25
    v_add_f32_dpp v54, v54, v54 row_ror:2 row_mask:0xf bank_mask:0xf
    v_fmac_f32 v55, v78, v26
    v_fmac_f32 v55, v79, v27
    v_add_f32_dpp v60, v54, v54 row_ror:1 row_mask:0xf bank_mask:0x1
    v_cvt_f32_i32 v80, v80
    v_cvt_f32_i32 v81, v81
    v_cvt_f32_i32 v82, v82
    v_cvt_f32_i32 v83, v83
    v_fmac_f32 v55, v80, v28
    v_fmac_f32 v55, v81, v29
    v_fmac_f32 v55, v82, v30
    v_fmac_f32 v55, v83, v31
    v_cvt_f32_i32 v84, v84
    v_cvt_f32_i32 v85, v85
    v_cvt_f32_i32 v86, v86
    v_cvt_f32_i32 v87, v87
    v_fmac_f32 v55, v84, v32
    v_fmac_f32 v55, v85, v33
    v_fmac_f32 v55, v86, v34
    v_fmac_f32 v55, v87, v35
    s_nop 1
    v_add_f32_dpp v55, v55, v55 row_ror:8 row_mask:0xf bank_mask:0xf
    s_nop 1
    v_add_f32_dpp v55, v55, v55 row_ror:4 row_mask:0xf bank_mask:0xf
    s_nop 1
    v_add_f32_dpp v55, v55, v55 row_ror:2 row_mask:0xf bank_mask:0xf
    s_nop 1
    v_add_f32_dpp v61, v55, v55 row_ror:1 row_mask:0xf bank_mask:0x1
    buffer_load_dwordx4 v[64:67], v48, s[8:11], 0 offen offset:0 nt
    buffer_load_dwordx4 v[68:71], v48, s[8:11], 0 offen offset:256 nt
    buffer_load_dwordx4 v[72:75], v48, s[8:11], 0 offen offset:512 nt
    buffer_load_dwordx4 v[76:79], v48, s[8:11], 0 offen offset:768 nt
    buffer_load_dwordx4 v[80:83], v48, s[8:11], 0 offen offset:1024 nt
    buffer_load_dwordx4 v[84:87], v48, s[8:11], 0 offen offset:1280 nt
    s_waitcnt vmcnt(15)
    v_cvt_f32_i32 v88, v88
    v_cvt_f32_i32 v89, v89
    v_cvt_f32_i32 v90, v90
    v_cvt_f32_i32 v91, v91
    v_mul_f32 v56, v88, v24
    v_fmac_f32 v56, v89, v25
    v_fmac_f32 v56, v90, v26
    v_fmac_f32 v56, v91, v27
    v_cvt_f32_i32 v92, v92
    v_cvt_f32_i32 v93, v93
    v_cvt_f32_i32 v94, v94
    v_cvt_f32_i32 v95, v95
    v_fmac_f32 v56, v92, v28
    v_fmac_f32 v56, v93, v29
    v_fmac_f32 v56, v94, v30
    v_fmac_f32 v56, v95, v31
    v_cvt_f32_i32 v96, v96
    v_cvt_f32_i32 v97, v97
    v_cvt_f32_i32 v98, v98
    v_cvt_f32_i32 v99, v99
    v_fmac_f32 v56, v96, v32
    v_fmac_f32 v56, v97, v33
    v_fmac_f32 v56, v98, v34
    v_fmac_f32 v56, v99, v35
    v_cvt_f32_i32 v100, v100
    v_cvt_f32_i32 v101, v101
    v_add_f32_dpp v56, v56, v56 row_ror:8 row_mask:0xf bank_mask:0xf
    v_cvt_f32_i32 v102, v102
    v_cvt_f32_i32 v103, v103
    v_add_f32_dpp v56, v56, v56 row_ror:4 row_mask:0xf bank_mask:0xf
    v_mul_f32 v57, v100, v24
    v_fmac_f32 v57, v101, v25
    v_add_f32_dpp v56, v56, v56 row_ror:2 row_mask:0xf bank_mask:0xf
    v_fmac_f32 v57, v102, v26
    v_fmac_f32 v57, v103, v27
    v_add_f32_dpp v60, v56, v56 row_ror:1 row_mask:0xf bank_mask:0x2
    v_cvt_f32_i32 v104, v104
    v_cvt_f32_i32 v105, v105
    v_cvt_f32_i32 v106, v106
    v_cvt_f32_i32 v107, v107
    v_fmac_f32 v57, v104, v28
    v_fmac_f32 v57, v105, v29
    v_fmac_f32 v57, v106, v30
    v_fmac_f32 v57, v107, v31
    v_cvt_f32_i32 v108, v108
    v_cvt_f32_i32 v109, v109
    v_cvt_f32_i32 v110, v110
    v_cvt_f32_i32 v111, v111
    v_fmac_f32 v57, v108, v32
    v_fmac_f32 v57, v109, v33
    v_fmac_f32 v57, v110, v34
    v_fmac_f32 v57, v111, v35
    s_nop 1
    v_add_f32_dpp v57, v57, v57 row_ror:8 row_mask:0xf bank_mask:0xf
    s_nop 1
    v_add_f32_dpp v57, v57, v57 row_ror:4 row_mask:0xf bank_mask:0xf
    s_nop 1
    v_add_f32_dpp v57, v57, v57 row_ror:2 row_mask:0xf bank_mask:0xf
    s_nop 1
    v_add_f32_dpp v61, v57, v57 row_ror:1 row_mask:0xf bank_mask:0x2
    s_waitcnt vmcnt(9)
    v_cvt_f32_i32 v112, v112
    v_cvt_f32_i32 v113, v113
    v_cvt_f32_i32 v114, v114
    v_cvt_f32_i32 v115, v115
    v_mul_f32 v58, v112, v24
    v_fmac_f32 v58, v113, v25
    v_fmac_f32 v58, v114, v26
    v_fmac_f32 v58, v115, v27
    v_cvt_f32_i32 v116, v116
    v_cvt_f32_i32 v117, v117
    v_cvt_f32_i32 v118, v118
    v_cvt_f32_i32 v119, v119
    v_fmac_f32 v58, v116, v28
    v_fmac_f32 v58, v117, v29
    v_fmac_f32 v58, v118, v30
    v_fmac_f32 v58, v119, v31
    v_cvt_f32_i32 v120, v120
    v_cvt_f32_i32 v121, v121
    v_cvt_f32_i32 v122, v122
    v_cvt_f32_i32 v123, v123
    v_fmac_f32 v58, v120, v32
    v_fmac_f32 v58, v121, v33
    v_fmac_f32 v58, v122, v34
    v_fmac_f32 v58, v123, v35
    v_cvt_f32_i32 v124, v124
    v_cvt_f32_i32 v125, v125
    v_add_f32_dpp v58, v58, v58 row_ror:8 row_mask:0xf bank_mask:0xf
    v_cvt_f32_i32 v126, v126
    v_cvt_f32_i32 v127, v127
    v_add_f32_dpp v58, v58, v58 row_ror:4 row_mask:0xf bank_mask:0xf
    v_mul_f32 v59, v124, v24
    v_fmac_f32 v59, v125, v25
    v_add_f32_dpp v58, v58, v58 row_ror:2 row_mask:0xf bank_mask:0xf
    v_fmac_f32 v59, v126, v26
    v_fmac_f32 v59, v127, v27
    v_add_f32_dpp v60, v58, v58 row_ror:1 row_mask:0xf bank_mask:0x4
    v_cvt_f32_i32 v128, v128
    v_cvt_f32_i32 v129, v129
    v_cvt_f32_i32 v130, v130
    v_cvt_f32_i32 v131, v131
    v_fmac_f32 v59, v128, v28
    v_fmac_f32 v59, v129, v29
    v_fmac_f32 v59, v130, v30
    v_fmac_f32 v59, v131, v31
    v_cvt_f32_i32 v132, v132
    v_cvt_f32_i32 v133, v133
    v_cvt_f32_i32 v134, v134
    v_cvt_f32_i32 v135, v135
    v_fmac_f32 v59, v132, v32
    v_fmac_f32 v59, v133, v33
    v_fmac_f32 v59, v134, v34
    v_fmac_f32 v59, v135, v35
    s_nop 1
    v_add_f32_dpp v59, v59, v59 row_ror:8 row_mask:0xf bank_mask:0xf
    s_nop 1
    v_add_f32_dpp v59, v59, v59 row_ror:4 row_mask:0xf bank_mask:0xf
    s_nop 1
    v_add_f32_dpp v59, v59, v59 row_ror:2 row_mask:0xf bank_mask:0xf
    s_nop 1
    v_add_f32_dpp v61, v59, v59 row_ror:1 row_mask:0xf bank_mask:0x4
    s_mov_b64 exec, s[42:43]
    ds_write_b64 v4, v[60:61]
    s_mov_b64 exec, -1
    v_add_u32 v4, 48, v4
    s_waitcnt vmcnt(6)
    v_lshlrev_b32 v10, 16, v36
    v_lshlrev_b32 v24, 16, v42
    v_and_b32 v11, 0xffff0000, v36
    v_and_b32 v25, 0xffff0000, v42
    v_mul_f32 v24, v24, v10
    v_mul_f32 v25, v25, v11
    v_lshlrev_b32 v10, 16, v37
    v_lshlrev_b32 v26, 16, v43
    v_and_b32 v11, 0xffff0000, v37
    v_and_b32 v27, 0xffff0000, v43
    v_mul_f32 v26, v26, v10
    v_mul_f32 v27, v27, v11
    v_lshlrev_b32 v10, 16, v38
    v_lshlrev_b32 v28, 16, v44
    v_and_b32 v11, 0xffff0000, v38
    v_and_b32 v29, 0xffff0000, v44
    v_mul_f32 v28, v28, v10
    v_mul_f32 v29, v29, v11
    v_lshlrev_b32 v10, 16, v39
    v_lshlrev_b32 v30, 16, v45
    v_and_b32 v11, 0xffff0000, v39
    v_and_b32 v31, 0xffff0000, v45
    v_mul_f32 v30, v30, v10
    v_mul_f32 v31, v31, v11
    v_lshlrev_b32 v10, 16, v40
    v_lshlrev_b32 v32, 16, v46
    v_and_b32 v11, 0xffff0000, v40
    v_and_b32 v33, 0xffff0000, v46
    v_mul_f32 v32, v32, v10
    v_mul_f32 v33, v33, v11
    v_lshlrev_b32 v10, 16, v41
    v_lshlrev_b32 v34, 16, v47
    v_and_b32 v11, 0xffff0000, v41
    v_and_b32 v35, 0xffff0000, v47
    v_mul_f32 v34, v34, v10
    v_mul_f32 v35, v35, v11
    s_branch L_kchk
L_vboost:
    s_nop 1
    s_and_b32 s32, s30, 15
    s_cbranch_scc0 L_vend
L_vboost2:
    s_nop 1
    s_cmp_eq_u32 s30, 48
    s_cbranch_scc1 L_vend2
    buffer_load_dwordx4 v[88:91], v48, s[12:15], 0 offen offset:1536 nt
    buffer_load_dwordx4 v[92:95], v48, s[12:15], 0 offen offset:1792 nt
    buffer_load_dwordx4 v[96:99], v48, s[12:15], 0 offen offset:2048 nt
    buffer_load_dwordx4 v[100:103], v48, s[12:15], 0 offen offset:2304 nt
    buffer_load_dwordx4 v[104:107], v48, s[12:15], 0 offen offset:2560 nt
    buffer_load_dwordx4 v[108:111], v48, s[12:15], 0 offen offset:2816 nt
    buffer_load_dwordx4 v[112:115], v48, s[12:15], 0 offen offset:3072 nt
    buffer_load_dwordx4 v[116:119], v48, s[12:15], 0 offen offset:3328 nt
    buffer_load_dwordx4 v[120:123], v48, s[12:15], 0 offen offset:3584 nt
    buffer_load_dwordx4 v[124:127], v49, s[12:15], 0 offen offset:0 nt
    buffer_load_dwordx4 v[128:131], v49, s[12:15], 0 offen offset:256 nt
    buffer_load_dwordx4 v[132:135], v49, s[12:15], 0 offen offset:512 nt
    s_sub_u32 s59, s59, 1
    s_add_u32 s29, s29, 4
    s_add_u32 s30, s30, 1
    s_bitcmp1_b64 s[40:41], s30
    s_cbranch_scc1 L_evVB
L_evretVB:
    s_nop 1
    s_lshr_b32 s33, s29, 6
    s_lshl_b32 s33, s33, 11
    s_and_b32 s32, s29, 63
    s_add_u32 s32, s32, s33
    s_add_u32 s32, s32, s44
    s_bfe_u32 s33, s32, 0x20003
    s_and_b32 s34, s32, 4
    s_or_b32 s33, s33, s34
    s_xor_b32 s33, s33, s5
    s_lshl_b32 s50, s32, 5
    s_or_b32 s50, s50, s33
    s_lshl_b32 s50, s50, 4
    s_or_b32 s50, s50, 1
    s_lshl_b32 s53, s29, 7
    v_xor_b32 v10, s50, v50
    v_mul_hi_u32 v10, v10, s47
    v_lshrrev_b32 v10, 1, v10
    v_and_b32 v11, 15, v10
    v_cmp_eq_u32 vcc, 5, v11
    v_mad_u32_u24 v48, v10, s45, v2
    v_add_u32 v11, 3840, v48
    v_cndmask_b32 v49, v51, v11, vcc
    v_add_u32 v10, s53, v5
    ds_read_b32 v7, v10
    s_waitcnt vmcnt(12)
    v_cvt_f32_i32 v64, v64
    v_cvt_f32_i32 v65, v65
    v_cvt_f32_i32 v66, v66
    v_cvt_f32_i32 v67, v67
    v_fmac_f32_dpp v12, v6, v64 row_newbcast:0 row_mask:0xf bank_mask:0xf
    v_fmac_f32_dpp v13, v6, v65 row_newbcast:0 row_mask:0xf bank_mask:0xf
    v_fmac_f32_dpp v14, v6, v66 row_newbcast:0 row_mask:0xf bank_mask:0xf
    v_fmac_f32_dpp v15, v6, v67 row_newbcast:0 row_mask:0xf bank_mask:0xf
    v_cvt_f32_i32 v68, v68
    v_cvt_f32_i32 v69, v69
    v_cvt_f32_i32 v70, v70
    v_cvt_f32_i32 v71, v71
    v_fmac_f32_dpp v16, v6, v68 row_newbcast:0 row_mask:0xf bank_mask:0xf
    v_fmac_f32_dpp v17, v6, v69 row_newbcast:0 row_mask:0xf bank_mask:0xf
    v_fmac_f32_dpp v18, v6, v70 row_newbcast:0 row_mask:0xf bank_mask:0xf
    v_fmac_f32_dpp v19, v6, v71 row_newbcast:0 row_mask:0xf bank_mask:0xf
    v_cvt_f32_i32 v72, v72
    v_cvt_f32_i32 v73, v73
    v_cvt_f32_i32 v74, v74
    v_cvt_f32_i32 v75, v75
    v_fmac_f32_dpp v20, v6, v72 row_newbcast:0 row_mask:0xf bank_mask:0xf
    v_fmac_f32_dpp v21, v6, v73 row_newbcast:0 row_mask:0xf bank_mask:0xf
    v_fmac_f32_dpp v22, v6, v74 row_newbcast:0 row_mask:0xf bank_mask:0xf
    v_fmac_f32_dpp v23, v6, v75 row_newbcast:0 row_mask:0xf bank_mask:0xf
    v_cvt_f32_i32 v76, v76
    v_cvt_f32_i32 v77, v77
    v_cvt_f32_i32 v78, v78
    v_cvt_f32_i32 v79, v79
    v_fmac_f32_dpp v12, v6, v76 row_newbcast:1 row_mask:0xf bank_mask:0xf
    v_fmac_f32_dpp v13, v6, v77 row_newbcast:1 row_mask:0xf bank_mask:0xf
    v_fmac_f32_dpp v14, v6, v78 row_newbcast:1 row_mask:0xf bank_mask:0xf
    v_fmac_f32_dpp v15, v6, v79 row_newbcast:1 row_mask:0xf bank_mask:0xf
    v_cvt_f32_i32 v80, v80
    v_cvt_f32_i32 v81, v81
    v_cvt_f32_i32 v82, v82
    v_cvt_f32_i32 v83, v83
    v_fmac_f32_dpp v16, v6, v80 row_newbcast:1 row_mask:0xf bank_mask:0xf
    v_fmac_f32_dpp v17, v6, v81 row_newbcast:1 row_mask:0xf bank_mask:0xf
    v_fmac_f32_dpp v18, v6, v82 row_newbcast:1 row_mask:0xf bank_mask:0xf
    v_fmac_f32_dpp v19, v6, v83 row_newbcast:1 row_mask:0xf bank_mask:0xf
    v_cvt_f32_i32 v84, v84
    v_cvt_f32_i32 v85, v85
    v_cvt_f32_i32 v86, v86
    v_cvt_f32_i32 v87, v87
    v_fmac_f32_dpp v20, v6, v84 row_newbcast:1 row_mask:0xf bank_mask:0xf
    v_fmac_f32_dpp v21, v6, v85 row_newbcast:1 row_mask:0xf bank_mask:0xf
    v_fmac_f32_dpp v22, v6, v86 row_newbcast:1 row_mask:0xf bank_mask:0xf
    v_fmac_f32_dpp v23, v6, v87 row_newbcast:1 row_mask:0xf bank_mask:0xf
    buffer_load_dwordx4 v[64:67], v48, s[12:15], 0 offen offset:0 nt
    buffer_load_dwordx4 v[68:71], v48, s[12:15], 0 offen offset:256 nt
    buffer_load_dwordx4 v[72:75], v48, s[12:15], 0 offen offset:512 nt
    buffer_load_dwordx4 v[76:79], v48, s[12:15], 0 offen offset:768 nt
    buffer_load_dwordx4 v[80:83], v48, s[12:15], 0 offen offset:1024 nt
    buffer_load_dwordx4 v[84:87], v48, s[12:15], 0 offen offset:1280 nt
    s_waitcnt vmcnt(12)
    s_cmp_eq_u32 s30, 48
    s_cbranch_scc1 L_el2
L_el2r:
    v_cvt_f32_i32 v88, v88
    v_cvt_f32_i32 v89, v89
    v_cvt_f32_i32 v90, v90
    v_cvt_f32_i32 v91, v91
    v_fmac_f32_dpp v12, v6, v88 row_newbcast:2 row_mask:0xf bank_mask:0xf
    v_fmac_f32_dpp v13, v6, v89 row_newbcast:2 row_mask:0xf bank_mask:0xf
    v_fmac_f32_dpp v14, v6, v90 row_newbcast:2 row_mask:0xf bank_mask:0xf
    v_fmac_f32_dpp v15, v6, v91 row_newbcast:2 row_mask:0xf bank_mask:0xf
    v_cvt_f32_i32 v92, v92
    v_cvt_f32_i32 v93, v93
    v_cvt_f32_i32 v94, v94
    v_cvt_f32_i32 v95, v95
    v_fmac_f32_dpp v16, v6, v92 row_newbcast:2 row_mask:0xf bank_mask:0xf
    v_fmac_f32_dpp v17, v6, v93 row_newbcast:2 row_mask:0xf bank_mask:0xf
    v_fmac_f32_dpp v18, v6, v94 row_newbcast:2 row_mask:0xf bank_mask:0xf
    v_fmac_f32_dpp v19, v6, v95 row_newbcast:2 row_mask:0xf bank_mask:0xf
    v_cvt_f32_i32 v96, v96
    v_cvt_f32_i32 v97, v97
    v_cvt_f32_i32 v98, v98
    v_cvt_f32_i32 v99, v99
    v_fmac_f32_dpp v20, v6, v96 row_newbcast:2 row_mask:0xf bank_mask:0xf
    v_fmac_f32_dpp v21, v6, v97 row_newbcast:2 row_mask:0xf bank_mask:0xf
    v_fmac_f32_dpp v22, v6, v98 row_newbcast:2 row_mask:0xf bank_mask:0xf
    v_fmac_f32_dpp v23, v6, v99 row_newbcast:2 row_mask:0xf bank_mask:0xf
    v_cvt_f32_i32 v100, v100
    v_cvt_f32_i32 v101, v101
    v_cvt_f32_i32 v102, v102
    v_cvt_f32_i32 v103, v103
    v_fmac_f32_dpp v12, v6, v100 row_newbcast:3 row_mask:0xf bank_mask:0xf
    v_fmac_f32_dpp v13, v6, v101 row_newbcast:3 row_mask:0xf bank_mask:0xf
    v_fmac_f32_dpp v14, v6, v102 row_newbcast:3 row_mask:0xf bank_mask:0xf
    v_fmac_f32_dpp v15, v6, v103 row_newbcast:3 row_mask:0xf bank_mask:0xf
    v_cvt_f32_i32 v104, v104
    v_cvt_f32_i32 v105, v105
    v_cvt_f32_i32 v106, v106
    v_cvt_f32_i32 v107, v107
    v_fmac_f32_dpp v16, v6, v104 row_newbcast:3 row_mask:0xf bank_mask:0xf
    v_fmac_f32_dpp v17, v6, v105 row_newbcast:3 row_mask:0xf bank_mask:0xf
    v_fmac_f32_dpp v18, v6, v106 row_newbcast:3 row_mask:0xf bank_mask:0xf
    v_fmac_f32_dpp v19, v6, v107 row_newbcast:3 row_mask:0xf bank_mask:0xf
    v_cvt_f32_i32 v108, v108
    v_cvt_f32_i32 v109, v109
    v_cvt_f32_i32 v110, v110
    v_cvt_f32_i32 v111, v111
    v_fmac_f32_dpp v20, v6, v108 row_newbcast:3 row_mask:0xf bank_mask:0xf
    v_fmac_f32_dpp v21, v6, v109 row_newbcast:3 row_mask:0xf bank_mask:0xf
    v_fmac_f32_dpp v22, v6, v110 row_newbcast:3 row_mask:0xf bank_mask:0xf
    v_fmac_f32_dpp v23, v6, v111 row_newbcast:3 row_mask:0xf bank_mask:0xf
    s_waitcnt vmcnt(6)
    v_cvt_f32_i32 v112, v112
    v_cvt_f32_i32 v113, v113
    v_cvt_f32_i32 v114, v114
    v_cvt_f32_i32 v115, v115
    v_fmac_f32_dpp v12, v6, v112 row_newbcast:4 row_mask:0xf bank_mask:0xf
    v_fmac_f32_dpp v13, v6, v113 row_newbcast:4 row_mask:0xf bank_mask:0xf
    v_fmac_f32_dpp v14, v6, v114 row_newbcast:4 row_mask:0xf bank_mask:0xf
    v_fmac_f32_dpp v15, v6, v115 row_newbcast:4 row_mask:0xf bank_mask:0xf
    v_cvt_f32_i32 v116, v116
    v_cvt_f32_i32 v117, v117
    v_cvt_f32_i32 v118, v118
    v_cvt_f32_i32 v119, v119
    v_fmac_f32_dpp v16, v6, v116 row_newbcast:4 row_mask:0xf bank_mask:0xf
    v_fmac_f32_dpp v17, v6, v117 row_newbcast:4 row_mask:0xf bank_mask:0xf
    v_fmac_f32_dpp v18, v6, v118 row_newbcast:4 row_mask:0xf bank_mask:0xf
    v_fmac_f32_dpp v19, v6, v119 row_newbcast:4 row_mask:0xf bank_mask:0xf
    v_cvt_f32_i32 v120, v120
    v_cvt_f32_i32 v121, v121
    v_cvt_f32_i32 v122, v122
    v_cvt_f32_i32 v123, v123
    v_fmac_f32_dpp v20, v6, v120 row_newbcast:4 row_mask:0xf bank_mask:0xf
    v_fmac_f32_dpp v21, v6, v121 row_newbcast:4 row_mask:0xf bank_mask:0xf
    v_fmac_f32_dpp v22, v6, v122 row_newbcast:4 row_mask:0xf bank_mask:0xf
    v_fmac_f32_dpp v23, v6, v123 row_newbcast:4 row_mask:0xf bank_mask:0xf
    v_cvt_f32_i32 v124, v124
    v_cvt_f32_i32 v125, v125
    v_cvt_f32_i32 v126, v126
    v_cvt_f32_i32 v127, v127
    v_fmac_f32_dpp v12, v6, v124 row_newbcast:5 row_mask:0xf bank_mask:0xf
    v_fmac_f32_dpp v13, v6, v125 row_newbcast:5 row_mask:0xf bank_mask:0xf
    v_fmac_f32_dpp v14, v6, v126 row_newbcast:5 row_mask:0xf bank_mask:0xf
    v_fmac_f32_dpp v15, v6, v127 row_newbcast:5 row_mask:0xf bank_mask:0xf
    v_cvt_f32_i32 v128, v128
    v_cvt_f32_i32 v129, v129
    v_cvt_f32_i32 v130, v130
    v_cvt_f32_i32 v131, v131
    v_fmac_f32_dpp v16, v6, v128 row_newbcast:5 row_mask:0xf bank_mask:0xf
    v_fmac_f32_dpp v17, v6, v129 row_newbcast:5 row_mask:0xf bank_mask:0xf
    v_fmac_f32_dpp v18, v6, v130 row_newbcast:5 row_mask:0xf bank_mask:0xf
    v_fmac_f32_dpp v19, v6, v131 row_newbcast:5 row_mask:0xf bank_mask:0xf
    v_cvt_f32_i32 v132, v132
    v_cvt_f32_i32 v133, v133
    v_cvt_f32_i32 v134, v134
    v_cvt_f32_i32 v135, v135
    v_fmac_f32_dpp v20, v6, v132 row_newbcast:5 row_mask:0xf bank_mask:0xf
    v_fmac_f32_dpp v21, v6, v133 row_newbcast:5 row_mask:0xf bank_mask:0xf
    v_fmac_f32_dpp v22, v6, v134 row_newbcast:5 row_mask:0xf bank_mask:0xf
    v_fmac_f32_dpp v23, v6, v135 row_newbcast:5 row_mask:0xf bank_mask:0xf
    s_waitcnt lgkmcnt(0)
    v_mov_b32 v6, v7
    s_branch L_vchk
L_el0:
    s_nop 1
    v_mov_b32 v11, 1
    s_mov_b64 exec, 1
    ds_add_u32 v53, v11 offset:136
    s_mov_b64 exec, -1
    s_branch L_el0r
L_el1:
    s_nop 1
    v_mov_b32 v11, 1
    s_mov_b64 exec, 1
    ds_add_u32 v53, v11 offset:136
    s_mov_b64 exec, -1
    s_branch L_el1r
L_el2:
    s_nop 1
    v_mov_b32 v11, 1
    s_mov_b64 exec, 1
    ds_add_u32 v53, v11 offset:136
    s_mov_b64 exec, -1
    s_branch L_el2r
L_evK:
    s_nop 1
    s_bitcmp1_b64 s[64:65], s30
    s_cbranch_scc0 L_paK
    s_memrealtime s[60:61]
    s_mov_b32 s72, s59
    v_mov_b32 v11, 1
    s_mov_b64 exec, 1
    ds_add_u32 v53, v11 offset:128
    s_mov_b64 exec, -1
L_paK:
    s_nop 1
    s_bitcmp1_b64 s[66:67], s30
    s_cbranch_scc0 L_pbK
    v_mov_b32 v11, 1
    s_mov_b64 exec, 1
    ds_add_u32 v53, v11 offset:128
    s_mov_b64 exec, -1
L_pbK:
    s_nop 1
    s_bitcmp1_b64 s[68:69], s30
    s_cbranch_scc0 L_pcK
    v_mov_b32 v11, s62
    ds_read_b32 v10, v11
    v_mov_b32 v11, 1
    s_mov_b64 exec, 1
    ds_add_u32 v53, v11 offset:128
    s_mov_b64 exec, -1
    s_add_u32 s62, s62, 4
    s_waitcnt lgkmcnt(0)
    v_readfirstlane_b32 s32, v10
    s_cmp_eq_u32 s32, 0
    s_cbranch_scc1 L_pcK
    s_sub_u32 s32, s60, s32
    s_max_i32 s32, s32, -4096
    s_min_i32 s32, s32, 4096
    s_mul_i32 s32, s32, 8
    s_add_u32 s32, s32, 512
    s_ashr_i32 s32, s32, 10
    s_sub_u32 s32, s32, s72
    s_add_u32 s32, s32, s59
    s_max_i32 s32, s32, 0
    s_min_i32 s59, s32, 6
L_pcK:
    s_nop 1
    s_bitcmp1_b64 s[70:71], s30
    s_cbranch_scc0 L_evretK
    s_and_b32 s32, s30, 15
    s_cbranch_scc0 L_evK2
    s_cmp_eq_u32 s30, 3
    s_cbranch_scc1 L_evK2
    s_lshr_b32 s33, s30, 2
    s_andn2_b32 s33, s33, 3
    s_add_u32 s33, s33, 36
    s_cmp_eq_u32 s32, 1
    s_cselect_b32 s32, s33, 60
    s_cselect_b32 s33, 5376, 0
    v_add_u32 v4, s33, v4
    s_cmp_eq_u32 s30, 2
    s_cselect_b32 s32, 56, s32
    v_mov_b32 v10, s32
    v_mov_b32 v11, 1
    s_mov_b64 exec, 1
    ds_add_u32 v10, v11 offset:0
    s_mov_b64 exec, -1
    s_branch L_evretK
L_evK2:
    s_nop 1
    s_cmp_eq_u32 s30, 16
    s_cbranch_scc0 L_gxtk16
    s_memrealtime s[36:37]
    s_mov_b32 s6, 0x100000
L_wgtk16:
    s_nop 1
    ds_read_b32 v10, v53 offset:208
    s_sub_u32 s6, s6, 1
    s_cbranch_scc1 L_exit1
    s_waitcnt lgkmcnt(0)
    v_readfirstlane_b32 s32, v10
    s_cmp_eq_u32 s32, 0
    s_cbranch_scc1 L_wgtk16
    s_and_b32 s32, s32, 0xffff
    s_cbranch_scc0 L_gxtk16
    s_add_u32 s32, s32, s36
L_gltk16:
    s_nop 1
    s_memrealtime s[36:37]
    s_waitcnt lgkmcnt(0)
    s_sub_u32 s36, s36, s32
    s_cmp_lt_i32 s36, 0
    s_cbranch_scc1 L_gltk16
L_gxtk16:
    s_nop 1
    s_cmp_eq_u32 s30, 32
    s_cbranch_scc0 L_gxtk32
    s_memrealtime s[36:37]
    s_mov_b32 s6, 0x100000
L_wgtk32:
    s_nop 1
    ds_read_b32 v10, v53 offset:212
    s_sub_u32 s6, s6, 1
    s_cbranch_scc1 L_exit1
    s_waitcnt lgkmcnt(0)
    v_readfirstlane_b32 s32, v10
    s_cmp_eq_u32 s32, 0
    s_cbranch_scc1 L_wgtk32
    s_and_b32 s32, s32, 0xffff
    s_cbranch_scc0 L_gxtk32
    s_add_u32 s32, s32, s36
L_gltk32:
    s_nop 1
    s_memrealtime s[36:37]
    s_waitcnt lgkmcnt(0)
    s_sub_u32 s36, s36, s32
    s_cmp_lt_i32 s36, 0
    s_cbranch_scc1 L_gltk32
L_gxtk32:
    s_nop 1
    s_lshr_b32 s33, s30, 4
    s_lshl_b32 s34, s33, 2
    v_mov_b32 v11, s34
    s_lshl_b32 s31, s33, 5
    s_add_u32 s31, s31, s3
    s_mul_i32 s31, s31, 171
    s_lshr_b32 s31, s31, 9
    s_mul_i32 s31, s31, 384
    buffer_load_dwordx2 v[36:37], v3, s[20:23], s31 offen offset:0
    buffer_load_dwordx2 v[38:39], v3, s[20:23], s31 offen offset:128
    buffer_load_dwordx2 v[40:41], v3, s[20:23], s31 offen offset:256
    s_mov_b32 s6, 0x100000
L_wtk:
    s_nop 1
    ds_read_b32 v10, v11 offset:0
    s_sub_u32 s6, s6, 1
    s_cbranch_scc1 L_exit1
    s_waitcnt lgkmcnt(0)
    v_readfirstlane_b32 s32, v10
    s_cmp_eq_u32 s32, 0
    s_cbranch_scc1 L_wtk
    s_and_b32 s5, s32, 7
    s_xor_b32 s5, s5, s48
    s_bitcmp1_b32 s32, 3
    s_cselect_b64 vcc, -1, 0
    v_cndmask_b32 v50, v62, v63, vcc
    s_branch L_evretK
L_evV:
    s_nop 1
    s_bitcmp1_b64 s[64:65], s30
    s_cbranch_scc0 L_paV
    s_memrealtime s[60:61]
    s_mov_b32 s72, s59
    v_mov_b32 v11, 1
    s_mov_b64 exec, 1
    ds_add_u32 v53, v11 offset:128
    s_mov_b64 exec, -1
L_paV:
    s_nop 1
    s_bitcmp1_b64 s[66:67], s30
    s_cbranch_scc0 L_pbV
    v_mov_b32 v11, 1
    s_mov_b64 exec, 1
    ds_add_u32 v53, v11 offset:128
    s_mov_b64 exec, -1
L_pbV:
    s_nop 1
    s_bitcmp1_b64 s[68:69], s30
    s_cbranch_scc0 L_pcV
    v_mov_b32 v11, s62
    ds_read_b32 v10, v11
    v_mov_b32 v11, 1
    s_mov_b64 exec, 1
    ds_add_u32 v53, v11 offset:128
    s_mov_b64 exec, -1
    s_add_u32 s62, s62, 4
    s_waitcnt lgkmcnt(0)
    v_readfirstlane_b32 s32, v10
    s_cmp_eq_u32 s32, 0
    s_cbranch_scc1 L_pcV
    s_sub_u32 s32, s60, s32
    s_max_i32 s32, s32, -4096
    s_min_i32 s32, s32, 4096
    s_cmp_eq_u32 s30, 44
    s_cbranch_scc0 L_pd
    s_mul_i32 s32, s32, 9
    s_add_u32 s32, s32, 2048
    s_ashr_i32 s32, s32, 10
    s_max_i32 s32, s32, 0
    s_min_i32 s32, s32, 4
    s_sub_u32 s49, 48, s32
    s_cmp_eq_u32 s49, 48
    s_cselect_b32 s49, 255, s49
    s_mov_b32 s59, 0
    s_branch L_pcV
L_pd:
    s_nop 1
    s_mul_i32 s32, s32, 8
    s_add_u32 s32, s32, 512
    s_ashr_i32 s32, s32, 10
    s_sub_u32 s32, s32, s72
    s_add_u32 s32, s32, s59
    s_max_i32 s32, s32, 0
    s_min_i32 s59, s32, 6
L_pcV:
    s_nop 1
    s_bitcmp1_b64 s[70:71], s30
    s_cbranch_scc0 L_evretV
    s_cmp_eq_u32 s30, 16
    s_cbranch_scc0 L_gxtv264
    s_memrealtime s[36:37]
    s_mov_b32 s6, 0x100000
L_wgtv264:
    s_nop 1
    ds_read_b32 v10, v53 offset:220
    s_sub_u32 s6, s6, 1
    s_cbranch_scc1 L_exit1
    s_waitcnt lgkmcnt(0)
    v_readfirstlane_b32 s32, v10
    s_cmp_eq_u32 s32, 0
    s_cbranch_scc1 L_wgtv264
    s_and_b32 s32, s32, 0xffff
    s_cbranch_scc0 L_gxtv264
    s_add_u32 s32, s32, s36
L_gltv264:
    s_nop 1
    s_memrealtime s[36:37]
    s_waitcnt lgkmcnt(0)
    s_sub_u32 s36, s36, s32
    s_cmp_lt_i32 s36, 0
    s_cbranch_scc1 L_gltv264
L_gxtv264:
    s_nop 1
    s_cmp_eq_u32 s30, 32
    s_cbranch_scc0 L_gxtv280
    s_memrealtime s[36:37]
    s_mov_b32 s6, 0x100000
L_wgtv280:
    s_nop 1
    ds_read_b32 v10, v53 offset:224
    s_sub_u32 s6, s6, 1
    s_cbranch_scc1 L_exit1
    s_waitcnt lgkmcnt(0)
    v_readfirstlane_b32 s32, v10
    s_cmp_eq_u32 s32, 0
    s_cbranch_scc1 L_wgtv280
    s_and_b32 s32, s32, 0xffff
    s_cbranch_scc0 L_gxtv280
    s_add_u32 s32, s32, s36
L_gltv280:
    s_nop 1
    s_memrealtime s[36:37]
    s_waitcnt lgkmcnt(0)
    s_sub_u32 s36, s36, s32
    s_cmp_lt_i32 s36, 0
    s_cbranch_scc1 L_gltv280
L_gxtv280:
    s_nop 1
    s_lshr_b32 s33, s30, 4
    s_lshl_b32 s34, s33, 2
    v_mov_b32 v11, s34
    s_mov_b32 s6, 0x100000
L_wtv2:
    s_nop 1
    ds_read_b32 v10, v11 offset:24
    s_sub_u32 s6, s6, 1
    s_cbranch_scc1 L_exit1
    s_waitcnt lgkmcnt(0)
    v_readfirstlane_b32 s32, v10
    s_cmp_eq_u32 s32, 0
    s_cbranch_scc1 L_wtv2
    s_and_b32 s5, s32, 7
    s_xor_b32 s5, s5, s48
    s_bitcmp1_b32 s32, 3
    s_cselect_b64 vcc, -1, 0
    v_cndmask_b32 v50, v62, v63, vcc
    s_branch L_evretV
L_evKB:
    s_nop 1
    s_bitcmp1_b64 s[64:65], s30
    s_cbranch_scc0 L_paKB
    s_memrealtime s[60:61]
    s_mov_b32 s72, s59
    v_mov_b32 v11, 1
    s_mov_b64 exec, 1
    ds_add_u32 v53, v11 offset:128
    s_mov_b64 exec, -1
L_paKB:
    s_nop 1
    s_bitcmp1_b64 s[66:67], s30
    s_cbranch_scc0 L_pbKB
    v_mov_b32 v11, 1
    s_mov_b64 exec, 1
    ds_add_u32 v53, v11 offset:128
    s_mov_b64 exec, -1
L_pbKB:
    s_nop 1
    s_bitcmp1_b64 s[68:69], s30
    s_cbranch_scc0 L_pcKB
    v_mov_b32 v11, s62
    ds_read_b32 v10, v11
    v_mov_b32 v11, 1
    s_mov_b64 exec, 1
    ds_add_u32 v53, v11 offset:128
    s_mov_b64 exec, -1
    s_add_u32 s62, s62, 4
    s_waitcnt lgkmcnt(0)
    v_readfirstlane_b32 s32, v10
    s_cmp_eq_u32 s32, 0
    s_cbranch_scc1 L_pcKB
    s_sub_u32 s32, s60, s32
    s_max_i32 s32, s32, -4096
    s_min_i32 s32, s32, 4096
    s_mul_i32 s32, s32, 8
    s_add_u32 s32, s32, 512
    s_ashr_i32 s32, s32, 10
    s_sub_u32 s32, s32, s72
    s_add_u32 s32, s32, s59
    s_max_i32 s32, s32, 0
    s_min_i32 s59, s32, 6
L_pcKB:
    s_nop 1
    s_bitcmp1_b64 s[70:71], s30
    s_cbranch_scc0 L_evretKB
    s_and_b32 s32, s30, 15
    s_cbranch_scc0 L_evK2B
    s_cmp_eq_u32 s30, 3
    s_cbranch_scc1 L_evK2B
    s_lshr_b32 s33, s30, 2
    s_andn2_b32 s33, s33, 3
    s_add_u32 s33, s33, 36
    s_cmp_eq_u32 s32, 1
    s_cselect_b32 s32, s33, 60
    s_cselect_b32 s33, 5376, 0
    v_add_u32 v4, s33, v4
    s_cmp_eq_u32 s30, 2
    s_cselect_b32 s32, 56, s32
    v_mov_b32 v10, s32
    v_mov_b32 v11, 1
    s_mov_b64 exec, 1
    ds_add_u32 v10, v11 offset:0
    s_mov_b64 exec, -1
    s_branch L_evretKB
L_evK2B:
    s_nop 1
    s_cmp_eq_u32 s30, 16
    s_cbranch_scc0 L_gxtkB16
    s_memrealtime s[36:37]
    s_mov_b32 s6, 0x100000
L_wgtkB16:
    s_nop 1
    ds_read_b32 v10, v53 offset:208
    s_sub_u32 s6, s6, 1
    s_cbranch_scc1 L_exit1
    s_waitcnt lgkmcnt(0)
    v_readfirstlane_b32 s32, v10
    s_cmp_eq_u32 s32, 0
    s_cbranch_scc1 L_wgtkB16
    s_and_b32 s32, s32, 0xffff
    s_cbranch_scc0 L_gxtkB16
    s_add_u32 s32, s32, s36
L_gltkB16:
    s_nop 1
    s_memrealtime s[36:37]
    s_waitcnt lgkmcnt(0)
    s_sub_u32 s36, s36, s32
    s_cmp_lt_i32 s36, 0
    s_cbranch_scc1 L_gltkB16
L_gxtkB16:
    s_nop 1
    s_cmp_eq_u32 s30, 32
    s_cbranch_scc0 L_gxtkB32
    s_memrealtime s[36:37]
    s_mov_b32 s6, 0x100000
L_wgtkB32:
    s_nop 1
    ds_read_b32 v10, v53 offset:212
    s_sub_u32 s6, s6, 1
    s_cbranch_scc1 L_exit1
    s_waitcnt lgkmcnt(0)
    v_readfirstlane_b32 s32, v10
    s_cmp_eq_u32 s32, 0
    s_cbranch_scc1 L_wgtkB32
    s_and_b32 s32, s32, 0xffff
    s_cbranch_scc0 L_gxtkB32
    s_add_u32 s32, s32, s36
L_gltkB32:
    s_nop 1
    s_memrealtime s[36:37]
    s_waitcnt lgkmcnt(0)
    s_sub_u32 s36, s36, s32
    s_cmp_lt_i32 s36, 0
    s_cbranch_scc1 L_gltkB32
L_gxtkB32:
    s_nop 1
    s_lshr_b32 s33, s30, 4
    s_lshl_b32 s34, s33, 2
    v_mov_b32 v11, s34
    s_lshl_b32 s31, s33, 5
    s_add_u32 s31, s31, s3
    s_mul_i32 s31, s31, 171
    s_lshr_b32 s31, s31, 9
    s_mul_i32 s31, s31, 384
    buffer_load_dwordx2 v[36:37], v3, s[20:23], s31 offen offset:0
    buffer_load_dwordx2 v[38:39], v3, s[20:23], s31 offen offset:128
    buffer_load_dwordx2 v[40:41], v3, s[20:23], s31 offen offset:256
    s_mov_b32 s6, 0x100000
L_wtkB:
    s_nop 1
    ds_read_b32 v10, v11 offset:0
    s_sub_u32 s6, s6, 1
    s_cbranch_scc1 L_exit1
    s_waitcnt lgkmcnt(0)
    v_readfirstlane_b32 s32, v10
    s_cmp_eq_u32 s32, 0
    s_cbranch_scc1 L_wtkB
    s_and_b32 s5, s32, 7
    s_xor_b32 s5, s5, s48
    s_bitcmp1_b32 s32, 3
    s_cselect_b64 vcc, -1, 0
    v_cndmask_b32 v50, v62, v63, vcc
    s_branch L_evretKB
L_evVB:
    s_nop 1
    s_bitcmp1_b64 s[64:65], s30
    s_cbranch_scc0 L_paVB
    s_memrealtime s[60:61]
    s_mov_b32 s72, s59
    v_mov_b32 v11, 1
    s_mov_b64 exec, 1
    ds_add_u32 v53, v11 offset:128
    s_mov_b64 exec, -1
L_paVB:
    s_nop 1
    s_bitcmp1_b64 s[66:67], s30
    s_cbranch_scc0 L_pbVB
    v_mov_b32 v11, 1
    s_mov_b64 exec, 1
    ds_add_u32 v53, v11 offset:128
    s_mov_b64 exec, -1
L_pbVB:
    s_nop 1
    s_bitcmp1_b64 s[68:69], s30
    s_cbranch_scc0 L_pcVB
    v_mov_b32 v11, s62
    ds_read_b32 v10, v11
    v_mov_b32 v11, 1
    s_mov_b64 exec, 1
    ds_add_u32 v53, v11 offset:128
    s_mov_b64 exec, -1
    s_add_u32 s62, s62, 4
    s_waitcnt lgkmcnt(0)
    v_readfirstlane_b32 s32, v10
    s_cmp_eq_u32 s32, 0
    s_cbranch_scc1 L_pcVB
    s_sub_u32 s32, s60, s32
    s_max_i32 s32, s32, -4096
    s_min_i32 s32, s32, 4096
    s_cmp_eq_u32 s30, 44
    s_cbranch_scc0 L_pdB
    s_mul_i32 s32, s32, 9
    s_add_u32 s32, s32, 2048
    s_ashr_i32 s32, s32, 10
    s_max_i32 s32, s32, 0
    s_min_i32 s32, s32, 4
    s_sub_u32 s49, 48, s32
    s_cmp_eq_u32 s49, 48
    s_cselect_b32 s49, 255, s49
    s_mov_b32 s59, 0
    s_branch L_pcVB
L_pdB:
    s_nop 1
    s_mul_i32 s32, s32, 8
    s_add_u32 s32, s32, 512
    s_ashr_i32 s32, s32, 10
    s_sub_u32 s32, s32, s72
    s_add_u32 s32, s32, s59
    s_max_i32 s32, s32, 0
    s_min_i32 s59, s32, 6
L_pcVB:
    s_nop 1
    s_bitcmp1_b64 s[70:71], s30
    s_cbranch_scc0 L_evretVB
    s_cmp_eq_u32 s30, 16
    s_cbranch_scc0 L_gxtv2B64
    s_memrealtime s[36:37]
    s_mov_b32 s6, 0x100000
L_wgtv2B64:
    s_nop 1
    ds_read_b32 v10, v53 offset:220
    s_sub_u32 s6, s6, 1
    s_cbranch_scc1 L_exit1
    s_waitcnt lgkmcnt(0)
    v_readfirstlane_b32 s32, v10
    s_cmp_eq_u32 s32, 0
    s_cbranch_scc1 L_wgtv2B64
    s_and_b32 s32, s32, 0xffff
    s_cbranch_scc0 L_gxtv2B64
    s_add_u32 s32, s32, s36
L_gltv2B64:
    s_nop 1
    s_memrealtime s[36:37]
    s_waitcnt lgkmcnt(0)
    s_sub_u32 s36, s36, s32
    s_cmp_lt_i32 s36, 0
    s_cbranch_scc1 L_gltv2B64
L_gxtv2B64:
    s_nop 1
    s_cmp_eq_u32 s30, 32
    s_cbranch_scc0 L_gxtv2B80
    s_memrealtime s[36:37]
    s_mov_b32 s6, 0x100000
L_wgtv2B80:
    s_nop 1
    ds_read_b32 v10, v53 offset:224
    s_sub_u32 s6, s6, 1
    s_cbranch_scc1 L_exit1
    s_waitcnt lgkmcnt(0)
    v_readfirstlane_b32 s32, v10
    s_cmp_eq_u32 s32, 0
    s_cbranch_scc1 L_wgtv2B80
    s_and_b32 s32, s32, 0xffff
    s_cbranch_scc0 L_gxtv2B80
    s_add_u32 s32, s32, s36
L_gltv2B80:
    s_nop 1
    s_memrealtime s[36:37]
    s_waitcnt lgkmcnt(0)
    s_sub_u32 s36, s36, s32
    s_cmp_lt_i32 s36, 0
    s_cbranch_scc1 L_gltv2B80
L_gxtv2B80:
    s_nop 1
    s_lshr_b32 s33, s30, 4
    s_lshl_b32 s34, s33, 2
    v_mov_b32 v11, s34
    s_mov_b32 s6, 0x100000
L_wtv2B:
    s_nop 1
    ds_read_b32 v10, v11 offset:24
    s_sub_u32 s6, s6, 1
    s_cbranch_scc1 L_exit1
    s_waitcnt lgkmcnt(0)
    v_readfirstlane_b32 s32, v10
    s_cmp_eq_u32 s32, 0
    s_cbranch_scc1 L_wtv2B
    s_and_b32 s5, s32, 7
    s_xor_b32 s5, s5, s48
    s_bitcmp1_b32 s32, 3
    s_cselect_b64 vcc, -1, 0
    v_cndmask_b32 v50, v62, v63, vcc
    s_branch L_evretVB
L_helper:
    s_nop 1
    s_sub_u32 s6, s28, 4
    s_mov_b32 s5, s48
    v_and_b32 v1, 63, v0
    v_mov_b32 v2, 0
    s_mul_i32 s59, s3, 34816
    s_add_u32 s59, s59, 8388608
    s_cmp_eq_u32 s6, 3
    s_cbranch_scc1 L_h3
    s_mul_i32 s48, s6, 10
    s_sub_u32 s48, s48, 7
    s_cmp_lt_i32 s3, s48
    s_cselect_b32 s90, 1, 0
    s_cbranch_scc0 L_noprobe1
    s_max_u32 s7, s3, 1
    s_sub_u32 s7, s7, 1
    s_lshr_b32 s7, s7, 1
    s_lshl_b32 s49, s3, 1
    s_add_u32 s49, s49, s6
    s_sub_u32 s49, s49, 1
    s_bitcmp1_b32 s3, 0
    s_cselect_b32 s48, 1, 4
    s_cmp_eq_u32 s7, 0
    s_cselect_b32 s49, s49, s48
    s_and_b32 s48, s49, 1
    s_mul_i32 s20, s49, 20
    s_add_u32 s20, s20, s48
    s_add_u32 s20, s20, 2
    s_lshl_b32 s20, s20, 21
    s_xor_b32 s21, s4, s6
    s_and_b32 s21, s21, 1
    s_lshr_b32 s49, s4, 2
    s_xor_b32 s48, s48, s49
    s_xor_b32 s48, s48, s21
    s_lshl_b32 s48, s48, 13
    s_lshl_b32 s49, s6, 14
    s_and_b32 s49, s49, 0x4000
    s_or_b32 s48, s48, s49
    s_xor_b32 s32, s48, 0x0
    s_xor_b32 s33, s48, 0x2000
    s_xor_b32 s34, s48, 0x1000
    s_xor_b32 s35, s48, 0x3000
    s_xor_b32 s36, s48, 0x4000
    s_xor_b32 s37, s48, 0x6000
    s_xor_b32 s38, s48, 0x5000
    s_xor_b32 s39, s48, 0x7000
    v_and_b32 v3, 7, v1
    v_lshlrev_b32 v3, 12, v3
    s_lshl_b32 s48, s4, 8
    v_add_u32 v3, s48, v3
    s_mov_b32 s10, 805306368
    s_mov_b32 s11, 0x00020000
    s_cmp_ge_u32 s7, 3
    s_cselect_b32 s48, 3, 0
    s_sub_u32 s48, s7, s48
    s_lshl_b32 s48, s48, 28
    s_add_u32 s20, s20, s48
    s_cmp_ge_u32 s7, 3
    s_waitcnt lgkmcnt(0)
    s_cselect_b32 s8, s68, s66
    s_cselect_b32 s23, s69, s67
    s_and_b32 s9, s23, 0xffff
    s_add_u32 s22, s8, s20
    s_addc_u32 s23, s23, 0
    s_lshl_b32 s48, s4, 8
    s_add_u32 s56, s22, s48
    s_addc_u32 s57, s23, 0
    s_load_dword s24, s[56:57], 0x0
    s_load_dword s25, s[56:57], 0x1000
    s_load_dword s26, s[56:57], 0x2000
    s_load_dword s27, s[56:57], 0x3000
    s_load_dword s28, s[56:57], 0x4000
    s_load_dword s29, s[56:57], 0x5000
    s_load_dword s30, s[56:57], 0x6000
    s_load_dword s31, s[56:57], 0x7000
    s_mov_b32 s12, s82
    s_and_b32 s13, s83, 0xffff
    s_mov_b32 s14, 10485760
    s_mov_b32 s15, 0x00020000
    s_lshl_b32 s48, s2, 1
    s_add_u32 s48, s48, s6
    s_mul_i32 s48, s48, 26112
    s_add_u32 s48, s48, 8362496
    v_mul_u32_u24 v5, 4352, v1
    v_mov_b32 v3, 0
    s_cmp_eq_u32 s7, 0
    s_cselect_b64 exec, 0x3f, 0
    buffer_store_dwordx2 v[2:3], v5, s[12:15], s48 offen sc1
    s_mov_b64 exec, -1
L_noprobe1:
    s_nop 1
    s_waitcnt lgkmcnt(0)
    s_mov_b32 s12, s82
    s_and_b32 s13, s83, 0xffff
    s_mov_b32 s14, 10485760
    s_mov_b32 s15, 0x00020000
    s_mov_b32 s16, s80
    s_and_b32 s17, s81, 0xffff
    s_mov_b32 s18, 256
    s_mov_b32 s19, 0x00020000
    s_cmp_lg_u32 s6, 0
    s_cbranch_scc1 L_hbar
    v_lshlrev_b32 v5, 2, v1
    ds_write_b32 v5, v2
    s_waitcnt lgkmcnt(0)
L_hbar:
    s_nop 1
    s_barrier
    s_cmp_eq_u32 s90, 0
    s_cbranch_scc1 L_role
    s_mov_b32 s46, 1
    s_mov_b32 s58, 0
    s_cmp_eq_u32 s7, 0
    s_cselect_b32 s47, 1, 3
L_round:
    s_nop 1
    s_add_u32 s48, s4, s46
    s_and_b32 s48, s48, 7
    s_lshl_b32 s48, s48, 8
    s_add_u32 s56, s22, s48
    s_addc_u32 s57, s23, 0
    s_mov_b32 s44, -1
    s_memtime s[40:41]
    s_waitcnt lgkmcnt(0)
    s_load_dword s45, s[56:57], s32
    s_waitcnt lgkmcnt(0)
    s_memtime s[42:43]
    s_waitcnt lgkmcnt(0)
    s_sub_u32 s24, s42, s40
    s_load_dword s45, s[56:57], s33
    s_waitcnt lgkmcnt(0)
    s_memtime s[40:41]
    s_waitcnt lgkmcnt(0)
    s_sub_u32 s25, s40, s42
    s_load_dword s45, s[56:57], s34
    s_waitcnt lgkmcnt(0)
    s_memtime s[42:43]
    s_waitcnt lgkmcnt(0)
    s_sub_u32 s26, s42, s40
    s_load_dword s45, s[56:57], s35
    s_waitcnt lgkmcnt(0)
    s_memtime s[40:41]
    s_waitcnt lgkmcnt(0)
    s_sub_u32 s27, s40, s42
    s_mov_b32 s28, -1
    s_mov_b32 s29, -1
    s_mov_b32 s30, -1
    s_mov_b32 s31, -1
    s_cmp_eq_u32 s7, 0
    s_cbranch_scc1 L_few
    s_load_dword s45, s[56:57], s36
    s_waitcnt lgkmcnt(0)
    s_memtime s[42:43]
    s_waitcnt lgkmcnt(0)
    s_sub_u32 s28, s42, s40
    s_load_dword s45, s[56:57], s37
    s_waitcnt lgkmcnt(0)
    s_memtime s[40:41]
    s_waitcnt lgkmcnt(0)
    s_sub_u32 s29, s40, s42
    s_load_dword s45, s[56:57], s38
    s_waitcnt lgkmcnt(0)
    s_memtime s[42:43]
    s_waitcnt lgkmcnt(0)
    s_sub_u32 s30, s42, s40
    s_load_dword s45, s[56:57], s39
    s_waitcnt lgkmcnt(0)
    s_memtime s[40:41]
    s_waitcnt lgkmcnt(0)
    s_sub_u32 s31, s40, s42
L_few:
    s_nop 1
    s_min_u32 s24, s24, 1400
    s_min_u32 s44, s44, s24
    s_min_u32 s25, s25, 1400
    s_min_u32 s44, s44, s25
    s_min_u32 s26, s26, 1400
    s_min_u32 s44, s44, s26
    s_min_u32 s27, s27, 1400
    s_min_u32 s44, s44, s27
    s_min_u32 s28, s28, 1400
    s_min_u32 s44, s44, s28
    s_min_u32 s29, s29, 1400
    s_min_u32 s44, s44, s29
    s_min_u32 s30, s30, 1400
    s_min_u32 s44, s44, s30
    s_min_u32 s31, s31, 1400
    s_min_u32 s44, s44, s31
    s_cmp_lt_u32 s44, 290
    s_cbranch_scc1 L_skip
    s_sub_u32 s58, s58, s24
    s_add_u32 s58, s58, s25
    s_sub_u32 s58, s58, s26
    s_add_u32 s58, s58, s27
    s_sub_u32 s58, s58, s28
    s_add_u32 s58, s58, s29
    s_sub_u32 s58, s58, s30
    s_add_u32 s58, s58, s31
L_skip:
    s_nop 1
    s_add_u32 s46, s46, 1
    s_cmp_le_u32 s46, s47
    s_cbranch_scc1 L_round
    s_sub_u32 s48, 0, s58
    s_cmp_eq_u32 s21, 0
    s_cselect_b32 s58, s58, s48
    s_add_u32 s58, s58, 0x1010000
    v_mov_b32 v4, s58
    s_mov_b64 exec, 1
    s_lshl_b32 s48, s7, 2
    s_add_u32 s48, s48, 124
    s_cmp_eq_u32 s7, 0
    s_cbranch_scc0 L_post
    s_waitcnt vmcnt(0)
    ds_add_rtn_u32 v5, v2, v4 offset:36
    s_mov_b32 s48, 0
    s_waitcnt lgkmcnt(0)
    v_add_u32 v4, v4, v5
    v_cmp_ne_u32 vcc, 0, v5
    s_and_b64 exec, exec, vcc
    buffer_atomic_add v4, off, s[16:19], s48
    s_branch L_posted
L_post:
    s_nop 1
    s_mov_b32 s60, 0x100000
L_wvw:
    s_nop 1
    ds_read_b32 v10, v2 offset:0
    s_sub_u32 s60, s60, 1
    s_cbranch_scc1 L_exit1
    s_waitcnt lgkmcnt(0)
    v_readfirstlane_b32 s48, v10
    s_cmp_eq_u32 s48, 0
    s_cbranch_scc1 L_wvw
    s_mul_i32 s48, s3, 4352
    s_add_u32 s48, s48, 9489664
    s_nop 0
    buffer_atomic_add v4, off, s[12:15], s48
L_posted:
    s_nop 1
    s_mov_b64 exec, -1
L_role:
    s_nop 1
    s_cmp_eq_u32 s6, 0
    s_cbranch_scc1 L_h0
    s_cmp_eq_u32 s6, 2
    s_cbranch_scc1 L_h2
    v_lshlrev_b32 v5, 2, v1
    s_mov_b32 s60, 0x100000
L_wea:
    s_nop 1
    ds_read_b32 v10, v2 offset:56
    s_sub_u32 s60, s60, 1
    s_cbranch_scc1 L_exit1
    s_waitcnt lgkmcnt(0)
    v_readfirstlane_b32 s48, v10
    s_cmp_lt_u32 s48, 4
    s_cbranch_scc1 L_wea
    s_mov_b64 exec, 0x1
    s_mov_b32 s60, 0x40000
L_polla:
    s_nop 1
    buffer_load_dword v4, v5, s[16:19], 0 offen offset:0 sc1
    s_sub_u32 s60, s60, 1
    s_cbranch_scc1 L_exit1
L_pollwa:
    s_waitcnt vmcnt(0)
    v_lshrrev_b32 v6, 24, v4
    v_cmp_ne_u32 vcc, 48, v6
    s_cbranch_vccnz L_polla
    v_and_b32 v4, 0xffffff, v4
    v_subrev_u32 v4, 3145728, v4
    v_lshrrev_b32 v6, 30, v4
    v_and_b32 v6, 2, v6
    v_add_u32 v4, 4800, v4
    v_cmp_gt_u32 vcc, 9600, v4
    s_nop 1
    v_cndmask_b32 v6, v6, 8, vcc
    v_or_b32 v6, 16, v6
    ds_write_b32 v5, v6 offset:0
    s_mov_b64 exec, -1
    s_mov_b32 s60, 0x100000
L_web:
    s_nop 1
    ds_read_b32 v10, v2 offset:60
    s_sub_u32 s60, s60, 1
    s_cbranch_scc1 L_exit1
    s_waitcnt lgkmcnt(0)
    v_readfirstlane_b32 s48, v10
    s_cmp_eq_u32 s48, 0
    s_cbranch_scc1 L_web
    v_mul_u32_u24 v7, 4352, v1
    s_mov_b32 s48, 9502720
    v_lshrrev_b32 v5, 1, v5
    s_mov_b64 exec, 0x3ff
    s_mov_b32 s60, 0x40000
L_pollb:
    s_nop 1
    buffer_load_dword v4, v7, s[12:15], s48 offen sc1
    s_sub_u32 s60, s60, 1
    s_cbranch_scc1 L_exit1
L_pollwb:
    s_waitcnt vmcnt(0)
    v_lshrrev_b32 v6, 24, v4
    v_cmp_ne_u32 vcc, 8, v6
    s_cbranch_vccnz L_pollb
    v_add_u32_dpp v4, v4, v4 quad_perm:[1,0,3,2] row_mask:0xf bank_mask:0xf
    s_mov_b64 exec, 0x155
    v_and_b32 v4, 0xffffff, v4
    v_subrev_u32 v4, 1048576, v4
    v_lshrrev_b32 v6, 30, v4
    v_and_b32 v6, 2, v6
    v_add_u32 v4, 9600, v4
    v_cmp_gt_u32 vcc, 19200, v4
    s_nop 1
    v_cndmask_b32 v6, v6, 8, vcc
    v_or_b32 v6, 16, v6
    ds_write_b32 v5, v6 offset:4
    s_mov_b64 exec, -1
    s_and_b32 s48, s3, 7
    s_cmp_lg_u32 s48, s4
    s_cbranch_scc1 L_exit1
    s_mul_i32 s48, s3, 3
    s_add_u32 s48, s48, 2
    s_lshr_b32 s48, s48, 5
    s_lshl_b32 s48, s48, 2
    v_mov_b32 v3, s48
    s_mul_i32 s57, s3, 24
    v_add_u32 v13, s57, v1
    v_and_b32 v12, 255, v13
    v_mul_u32_u24 v12, 4352, v12
    v_lshlrev_b32 v13, 6, v13
    s_mov_b32 s49, 8388608
    s_mov_b32 s50, 917504
    v_mov_b32 v4, 0xf149f2ca
    v_mov_b32 v5, 0
    s_mov_b32 s51, 93
    s_cmp_eq_u32 s48, 4
    s_cselect_b32 s51, 117, s51
    s_cmp_eq_u32 s48, 8
    s_cselect_b32 s51, 81, s51
    s_mov_b32 s60, 0x100000
L_wcg:
    s_nop 1
    ds_read_b32 v10, v2 offset:128
    s_sub_u32 s60, s60, 1
    s_cbranch_scc1 L_exit1
    s_waitcnt lgkmcnt(0)
    v_readfirstlane_b32 s48, v10
    s_cmp_lt_u32 s48, s51
    s_cbranch_scc1 L_wcg
    s_mov_b64 exec, 0xffffff
    s_mov_b32 s60, 0x40000
L_cpf:
    s_nop 1
    buffer_load_dword v7, v12, s[12:15], s49 offen sc1
    s_sub_u32 s60, s60, 1
    s_cbranch_scc1 L_exit1
    s_waitcnt vmcnt(0)
    v_cmpx_eq_u32 vcc, 0, v7
    s_cbranch_execnz L_cpf
    s_mov_b64 exec, 0xffffff
    s_mov_b32 s60, 0x40000
L_cpm:
    s_nop 1
    buffer_load_dwordx4 v[4:7], v13, s[12:15], s50 offen sc1
    s_sub_u32 s60, s60, 1
    s_cbranch_scc1 L_exit1
    s_waitcnt vmcnt(0)
    v_cmpx_eq_u32 vcc, 0, v7
    s_cbranch_execnz L_cpm
    s_mov_b64 exec, -1
    v_mov_b32 v6, v4
    s_nop 1
    v_max_f32_dpp v6, v6, v6 row_ror:8 row_mask:0xf bank_mask:0xf
    s_nop 1
    v_max_f32_dpp v6, v6, v6 row_ror:4 row_mask:0xf bank_mask:0xf
    s_nop 1
    v_max_f32_dpp v6, v6, v6 row_ror:2 row_mask:0xf bank_mask:0xf
    s_nop 1
    v_max_f32_dpp v6, v6, v6 row_ror:1 row_mask:0xf bank_mask:0xf
    v_mov_b32 v7, v6
    s_nop 1
    v_permlane32_swap_b32 v6, v7
    v_max_f32 v6, v6, v7
    v_mov_b32 v7, v6
    s_nop 1
    v_permlane16_swap_b32 v6, v7
    v_max_f32 v6, v6, v7
    v_sub_f32 v4, v4, v6
    v_exp_f32 v4, v4
    s_nop 0
    v_mul_f32 v5, v5, v4
    s_nop 1
    v_add_f32_dpp v5, v5, v5 row_ror:8 row_mask:0xf bank_mask:0xf
    s_nop 1
    v_add_f32_dpp v5, v5, v5 row_ror:4 row_mask:0xf bank_mask:0xf
    s_nop 1
    v_add_f32_dpp v5, v5, v5 row_ror:2 row_mask:0xf bank_mask:0xf
    s_nop 1
    v_add_f32_dpp v5, v5, v5 row_ror:1 row_mask:0xf bank_mask:0xf
    v_mov_b32 v7, v5
    s_nop 1
    v_permlane32_swap_b32 v5, v7
    v_add_f32 v5, v5, v7
    v_mov_b32 v7, v5
    s_nop 1
    v_permlane16_swap_b32 v5, v7
    v_add_f32 v5, v5, v7
    v_rcp_f32 v5, v5
    s_nop 0
    v_mul_f32 v4, v4, v5
    s_cmp_lt_u32 s3, 21
    s_cbranch_scc1 L_cown
    s_mul_i32 s48, s3, 4352
    s_add_u32 s48, s48, 9454848
    v_lshlrev_b32 v12, 2, v1
    v_mov_b32 v5, 1
    s_mov_b64 exec, 0xffffff
    buffer_store_dword v4, v12, s[12:15], s48 offen offset:128 sc1
    s_mov_b64 exec, 1
    s_waitcnt vmcnt(0)
    buffer_store_dword v5, off, s[12:15], s48 offset:4 sc1
    s_endpgm
L_cown:
    s_nop 1
    v_readlane_b32 s24, v4, 0
    v_readlane_b32 s25, v4, 1
    v_readlane_b32 s26, v4, 2
    v_readlane_b32 s27, v4, 3
    v_readlane_b32 s28, v4, 4
    v_readlane_b32 s29, v4, 5
    v_readlane_b32 s30, v4, 6
    v_readlane_b32 s31, v4, 7
    v_readlane_b32 s32, v4, 8
    v_readlane_b32 s33, v4, 9
    v_readlane_b32 s34, v4, 10
    v_readlane_b32 s35, v4, 11
    v_readlane_b32 s36, v4, 12
    v_readlane_b32 s37, v4, 13
    v_readlane_b32 s38, v4, 14
    v_readlane_b32 s39, v4, 15
    v_readlane_b32 s40, v4, 16
    v_readlane_b32 s41, v4, 17
    v_readlane_b32 s42, v4, 18
    v_readlane_b32 s43, v4, 19
    v_readlane_b32 s44, v4, 20
    v_readlane_b32 s45, v4, 21
    v_readlane_b32 s46, v4, 22
    v_readlane_b32 s47, v4, 23
    s_mov_b32 s92, s78
    s_and_b32 s93, s79, 0xffff
    s_mov_b32 s94, 12288
    s_mov_b32 s95, 0x00020000
    s_lshl_b32 s57, s57, 10
    v_lshlrev_b32 v13, 4, v1
    v_add_u32 v13, s57, v13
    s_mov_b32 s49, 4096
    s_mov_b32 s50, 8192
    s_mov_b32 s51, 12288
    s_mov_b32 s52, 16384
    s_mov_b32 s53, 20480
    v_mov_b32 v4, 0
    v_mov_b32 v5, 0
    v_mov_b32 v6, 0
    s_mov_b32 s56, 0xffffff
    v_lshlrev_b32 v12, 1, v1
    s_mul_i32 s57, s3, 384
    s_mov_b32 s60, 0x100000
L_wcc:
    s_nop 1
    ds_read_b32 v10, v3 offset:64
    s_sub_u32 s60, s60, 1
    s_cbranch_scc1 L_exit1
    s_waitcnt lgkmcnt(0)
    v_readfirstlane_b32 s48, v10
    s_cmp_lt_u32 s48, 1
    s_cbranch_scc1 L_wcc
    s_mov_b32 s60, 0x40000
L_cr:
    s_nop 1
    s_bitcmp0_b32 s56, 0
    s_cbranch_scc1 L_cl0
    buffer_load_dwordx4 v[16:19], v13, s[12:15], 0 offen offset:0 sc1
L_cl0:
    s_bitcmp0_b32 s56, 1
    s_cbranch_scc1 L_cl1
    buffer_load_dwordx4 v[20:23], v13, s[12:15], 0 offen offset:1024 sc1
L_cl1:
    s_bitcmp0_b32 s56, 2
    s_cbranch_scc1 L_cl2
    buffer_load_dwordx4 v[24:27], v13, s[12:15], 0 offen offset:2048 sc1
L_cl2:
    s_bitcmp0_b32 s56, 3
    s_cbranch_scc1 L_cl3
    buffer_load_dwordx4 v[28:31], v13, s[12:15], 0 offen offset:3072 sc1
L_cl3:
    s_bitcmp0_b32 s56, 4
    s_cbranch_scc1 L_cl4
    buffer_load_dwordx4 v[32:35], v13, s[12:15], s49 offen offset:0 sc1
L_cl4:
    s_bitcmp0_b32 s56, 5
    s_cbranch_scc1 L_cl5
    buffer_load_dwordx4 v[36:39], v13, s[12:15], s49 offen offset:1024 sc1
L_cl5:
    s_bitcmp0_b32 s56, 6
    s_cbranch_scc1 L_cl6
    buffer_load_dwordx4 v[40:43], v13, s[12:15], s49 offen offset:2048 sc1
L_cl6:
    s_bitcmp0_b32 s56, 7
    s_cbranch_scc1 L_cl7
    buffer_load_dwordx4 v[44:47], v13, s[12:15], s49 offen offset:3072 sc1
L_cl7:
    s_bitcmp0_b32 s56, 8
    s_cbranch_scc1 L_cl8
    buffer_load_dwordx4 v[48:51], v13, s[12:15], s50 offen offset:0 sc1
L_cl8:
    s_bitcmp0_b32 s56, 9
    s_cbranch_scc1 L_cl9
    buffer_load_dwordx4 v[52:55], v13, s[12:15], s50 offen offset:1024 sc1
L_cl9:
    s_bitcmp0_b32 s56, 10
    s_cbranch_scc1 L_cl10
    buffer_load_dwordx4 v[56:59], v13, s[12:15], s50 offen offset:2048 sc1
L_cl10:
    s_bitcmp0_b32 s56, 11
    s_cbranch_scc1 L_cl11
    buffer_load_dwordx4 v[60:63], v13, s[12:15], s50 offen offset:3072 sc1
L_cl11:
    s_bitcmp0_b32 s56, 12
    s_cbranch_scc1 L_cl12
    buffer_load_dwordx4 v[64:67], v13, s[12:15], s51 offen offset:0 sc1
L_cl12:
    s_bitcmp0_b32 s56, 13
    s_cbranch_scc1 L_cl13
    buffer_load_dwordx4 v[68:71], v13, s[12:15], s51 offen offset:1024 sc1
L_cl13:
    s_bitcmp0_b32 s56, 14
    s_cbranch_scc1 L_cl14
    buffer_load_dwordx4 v[72:75], v13, s[12:15], s51 offen offset:2048 sc1
L_cl14:
    s_bitcmp0_b32 s56, 15
    s_cbranch_scc1 L_cl15
    buffer_load_dwordx4 v[76:79], v13, s[12:15], s51 offen offset:3072 sc1
L_cl15:
    s_bitcmp0_b32 s56, 16
    s_cbranch_scc1 L_cl16
    buffer_load_dwordx4 v[80:83], v13, s[12:15], s52 offen offset:0 sc1
L_cl16:
    s_bitcmp0_b32 s56, 17
    s_cbranch_scc1 L_cl17
    buffer_load_dwordx4 v[84:87], v13, s[12:15], s52 offen offset:1024 sc1
L_cl17:
    s_bitcmp0_b32 s56, 18
    s_cbranch_scc1 L_cl18
    buffer_load_dwordx4 v[88:91], v13, s[12:15], s52 offen offset:2048 sc1
L_cl18:
    s_bitcmp0_b32 s56, 19
    s_cbranch_scc1 L_cl19
    buffer_load_dwordx4 v[92:95], v13, s[12:15], s52 offen offset:3072 sc1
L_cl19:
    s_bitcmp0_b32 s56, 20
    s_cbranch_scc1 L_cl20
    buffer_load_dwordx4 v[96:99], v13, s[12:15], s53 offen offset:0 sc1
L_cl20:
    s_bitcmp0_b32 s56, 21
    s_cbranch_scc1 L_cl21
    buffer_load_dwordx4 v[100:103], v13, s[12:15], s53 offen offset:1024 sc1
L_cl21:
    s_bitcmp0_b32 s56, 22
    s_cbranch_scc1 L_cl22
    buffer_load_dwordx4 v[104:107], v13, s[12:15], s53 offen offset:2048 sc1
L_cl22:
    s_bitcmp0_b32 s56, 23
    s_cbranch_scc1 L_cl23
    buffer_load_dwordx4 v[108:111], v13, s[12:15], s53 offen offset:3072 sc1
L_cl23:
    s_sub_u32 s60, s60, 1
    s_cbranch_scc1 L_exit1
    s_waitcnt vmcnt(0)
    s_bitcmp0_b32 s56, 0
    s_cbranch_scc1 L_cv0
    v_cmp_eq_u32 vcc, 0, v19
    s_cbranch_vccnz L_cv0
    v_fmac_f32 v4, s24, v16
    v_fmac_f32 v5, s24, v17
    v_fmac_f32 v6, s24, v18
    s_bitset0_b32 s56, 0
L_cv0:
    s_bitcmp0_b32 s56, 1
    s_cbranch_scc1 L_cv1
    v_cmp_eq_u32 vcc, 0, v23
    s_cbranch_vccnz L_cv1
    v_fmac_f32 v4, s25, v20
    v_fmac_f32 v5, s25, v21
    v_fmac_f32 v6, s25, v22
    s_bitset0_b32 s56, 1
L_cv1:
    s_bitcmp0_b32 s56, 2
    s_cbranch_scc1 L_cv2
    v_cmp_eq_u32 vcc, 0, v27
    s_cbranch_vccnz L_cv2
    v_fmac_f32 v4, s26, v24
    v_fmac_f32 v5, s26, v25
    v_fmac_f32 v6, s26, v26
    s_bitset0_b32 s56, 2
L_cv2:
    s_bitcmp0_b32 s56, 3
    s_cbranch_scc1 L_cv3
    v_cmp_eq_u32 vcc, 0, v31
    s_cbranch_vccnz L_cv3
    v_fmac_f32 v4, s27, v28
    v_fmac_f32 v5, s27, v29
    v_fmac_f32 v6, s27, v30
    s_bitset0_b32 s56, 3
L_cv3:
    s_bitcmp0_b32 s56, 4
    s_cbranch_scc1 L_cv4
    v_cmp_eq_u32 vcc, 0, v35
    s_cbranch_vccnz L_cv4
    v_fmac_f32 v4, s28, v32
    v_fmac_f32 v5, s28, v33
    v_fmac_f32 v6, s28, v34
    s_bitset0_b32 s56, 4
L_cv4:
    s_bitcmp0_b32 s56, 5
    s_cbranch_scc1 L_cv5
    v_cmp_eq_u32 vcc, 0, v39
    s_cbranch_vccnz L_cv5
    v_fmac_f32 v4, s29, v36
    v_fmac_f32 v5, s29, v37
    v_fmac_f32 v6, s29, v38
    s_bitset0_b32 s56, 5
L_cv5:
    s_bitcmp0_b32 s56, 6
    s_cbranch_scc1 L_cv6
    v_cmp_eq_u32 vcc, 0, v43
    s_cbranch_vccnz L_cv6
    v_fmac_f32 v4, s30, v40
    v_fmac_f32 v5, s30, v41
    v_fmac_f32 v6, s30, v42
    s_bitset0_b32 s56, 6
L_cv6:
    s_bitcmp0_b32 s56, 7
    s_cbranch_scc1 L_cv7
    v_cmp_eq_u32 vcc, 0, v47
    s_cbranch_vccnz L_cv7
    v_fmac_f32 v4, s31, v44
    v_fmac_f32 v5, s31, v45
    v_fmac_f32 v6, s31, v46
    s_bitset0_b32 s56, 7
L_cv7:
    s_bitcmp0_b32 s56, 8
    s_cbranch_scc1 L_cv8
    v_cmp_eq_u32 vcc, 0, v51
    s_cbranch_vccnz L_cv8
    v_fmac_f32 v4, s32, v48
    v_fmac_f32 v5, s32, v49
    v_fmac_f32 v6, s32, v50
    s_bitset0_b32 s56, 8
L_cv8:
    s_bitcmp0_b32 s56, 9
    s_cbranch_scc1 L_cv9
    v_cmp_eq_u32 vcc, 0, v55
    s_cbranch_vccnz L_cv9
    v_fmac_f32 v4, s33, v52
    v_fmac_f32 v5, s33, v53
    v_fmac_f32 v6, s33, v54
    s_bitset0_b32 s56, 9
L_cv9:
    s_bitcmp0_b32 s56, 10
    s_cbranch_scc1 L_cv10
    v_cmp_eq_u32 vcc, 0, v59
    s_cbranch_vccnz L_cv10
    v_fmac_f32 v4, s34, v56
    v_fmac_f32 v5, s34, v57
    v_fmac_f32 v6, s34, v58
    s_bitset0_b32 s56, 10
L_cv10:
    s_bitcmp0_b32 s56, 11
    s_cbranch_scc1 L_cv11
    v_cmp_eq_u32 vcc, 0, v63
    s_cbranch_vccnz L_cv11
    v_fmac_f32 v4, s35, v60
    v_fmac_f32 v5, s35, v61
    v_fmac_f32 v6, s35, v62
    s_bitset0_b32 s56, 11
L_cv11:
    s_bitcmp0_b32 s56, 12
    s_cbranch_scc1 L_cv12
    v_cmp_eq_u32 vcc, 0, v67
    s_cbranch_vccnz L_cv12
    v_fmac_f32 v4, s36, v64
    v_fmac_f32 v5, s36, v65
    v_fmac_f32 v6, s36, v66
    s_bitset0_b32 s56, 12
L_cv12:
    s_bitcmp0_b32 s56, 13
    s_cbranch_scc1 L_cv13
    v_cmp_eq_u32 vcc, 0, v71
    s_cbranch_vccnz L_cv13
    v_fmac_f32 v4, s37, v68
    v_fmac_f32 v5, s37, v69
    v_fmac_f32 v6, s37, v70
    s_bitset0_b32 s56, 13
L_cv13:
    s_bitcmp0_b32 s56, 14
    s_cbranch_scc1 L_cv14
    v_cmp_eq_u32 vcc, 0, v75
    s_cbranch_vccnz L_cv14
    v_fmac_f32 v4, s38, v72
    v_fmac_f32 v5, s38, v73
    v_fmac_f32 v6, s38, v74
    s_bitset0_b32 s56, 14
L_cv14:
    s_bitcmp0_b32 s56, 15
    s_cbranch_scc1 L_cv15
    v_cmp_eq_u32 vcc, 0, v79
    s_cbranch_vccnz L_cv15
    v_fmac_f32 v4, s39, v76
    v_fmac_f32 v5, s39, v77
    v_fmac_f32 v6, s39, v78
    s_bitset0_b32 s56, 15
L_cv15:
    s_bitcmp0_b32 s56, 16
    s_cbranch_scc1 L_cv16
    v_cmp_eq_u32 vcc, 0, v83
    s_cbranch_vccnz L_cv16
    v_fmac_f32 v4, s40, v80
    v_fmac_f32 v5, s40, v81
    v_fmac_f32 v6, s40, v82
    s_bitset0_b32 s56, 16
L_cv16:
    s_bitcmp0_b32 s56, 17
    s_cbranch_scc1 L_cv17
    v_cmp_eq_u32 vcc, 0, v87
    s_cbranch_vccnz L_cv17
    v_fmac_f32 v4, s41, v84
    v_fmac_f32 v5, s41, v85
    v_fmac_f32 v6, s41, v86
    s_bitset0_b32 s56, 17
L_cv17:
    s_bitcmp0_b32 s56, 18
    s_cbranch_scc1 L_cv18
    v_cmp_eq_u32 vcc, 0, v91
    s_cbranch_vccnz L_cv18
    v_fmac_f32 v4, s42, v88
    v_fmac_f32 v5, s42, v89
    v_fmac_f32 v6, s42, v90
    s_bitset0_b32 s56, 18
L_cv18:
    s_bitcmp0_b32 s56, 19
    s_cbranch_scc1 L_cv19
    v_cmp_eq_u32 vcc, 0, v95
    s_cbranch_vccnz L_cv19
    v_fmac_f32 v4, s43, v92
    v_fmac_f32 v5, s43, v93
    v_fmac_f32 v6, s43, v94
    s_bitset0_b32 s56, 19
L_cv19:
    s_bitcmp0_b32 s56, 20
    s_cbranch_scc1 L_cv20
    v_cmp_eq_u32 vcc, 0, v99
    s_cbranch_vccnz L_cv20
    v_fmac_f32 v4, s44, v96
    v_fmac_f32 v5, s44, v97
    v_fmac_f32 v6, s44, v98
    s_bitset0_b32 s56, 20
L_cv20:
    s_bitcmp0_b32 s56, 21
    s_cbranch_scc1 L_cv21
    v_cmp_eq_u32 vcc, 0, v103
    s_cbranch_vccnz L_cv21
    v_fmac_f32 v4, s45, v100
    v_fmac_f32 v5, s45, v101
    v_fmac_f32 v6, s45, v102
    s_bitset0_b32 s56, 21
L_cv21:
    s_bitcmp0_b32 s56, 22
    s_cbranch_scc1 L_cv22
    v_cmp_eq_u32 vcc, 0, v107
    s_cbranch_vccnz L_cv22
    v_fmac_f32 v4, s46, v104
    v_fmac_f32 v5, s46, v105
    v_fmac_f32 v6, s46, v106
    s_bitset0_b32 s56, 22
L_cv22:
    s_bitcmp0_b32 s56, 23
    s_cbranch_scc1 L_cv23
    v_cmp_eq_u32 vcc, 0, v111
    s_cbranch_vccnz L_cv23
    v_fmac_f32 v4, s47, v108
    v_fmac_f32 v5, s47, v109
    v_fmac_f32 v6, s47, v110
    s_bitset0_b32 s56, 23
L_cv23:
    s_cmp_lg_u32 s56, 0
    s_cbranch_scc1 L_cr
    v_cvt_pk_bf16_f32 v4, v4, v4
    buffer_store_short v4, v12, s[92:95], s57 offen offset:0
    v_cvt_pk_bf16_f32 v5, v5, v5
    buffer_store_short v5, v12, s[92:95], s57 offen offset:128
    v_cvt_pk_bf16_f32 v6, v6, v6
    buffer_store_short v6, v12, s[92:95], s57 offen offset:256
    s_endpgm
L_h0:
    s_nop 1
    s_mov_b32 s8, s64
    s_and_b32 s9, s65, 0xffff
    s_mov_b32 s10, 12288
    s_mov_b32 s11, 0x00020000
    s_mov_b32 s92, s70
    s_and_b32 s93, s71, 0xffff
    s_mov_b32 s94, 6291456
    s_mov_b32 s95, 0x00020000
    s_mov_b32 s96, s72
    s_and_b32 s97, s73, 0xffff
    s_mov_b32 s98, 6291456
    s_mov_b32 s99, 0x00020000
    v_lshrrev_b32 v4, 4, v1
    v_and_b32 v5, 15, v1
    v_lshlrev_b32 v6, 3, v5
    v_mul_u32_u24 v7, 384, v4
    v_add_u32 v7, v7, v6
    v_lshl_add_u32 v13, v5, 2, v4
    v_lshlrev_b32 v13, 2, v13
    v_lshlrev_b32 v4, 4, v1
    s_mul_i32 s32, s5, 4352
    s_add_u32 s32, s32, s59
    s_lshl_b32 s33, s3, 3
    s_add_u32 s33, s33, s5
    s_mul_i32 s33, s33, 6144
    s_add_u32 s33, s33, 2097152
    v_mov_b32 v16, 0
    v_mov_b32 v17, 0
    v_mov_b32 v18, 0
    v_mov_b32 v19, 0
    s_add_u32 s48, s2, 0
    s_lshl_b32 s49, s48, 10
    s_lshl_b32 s48, s48, 6
    s_add_u32 s48, s48, 917504
    buffer_store_dwordx4 v[16:19], v4, s[12:15], s49 offen sc1
    s_mov_b64 exec, 15
    buffer_store_dwordx4 v[16:19], v4, s[12:15], s48 offen sc1
    s_mov_b64 exec, -1
    s_add_u32 s48, s2, 256
    s_lshl_b32 s49, s48, 10
    s_lshl_b32 s48, s48, 6
    s_add_u32 s48, s48, 917504
    buffer_store_dwordx4 v[16:19], v4, s[12:15], s49 offen sc1
    s_mov_b64 exec, 15
    buffer_store_dwordx4 v[16:19], v4, s[12:15], s48 offen sc1
    s_mov_b64 exec, -1
    s_add_u32 s48, s2, 512
    s_lshl_b32 s49, s48, 10
    s_lshl_b32 s48, s48, 6
    s_add_u32 s48, s48, 917504
    buffer_store_dwordx4 v[16:19], v4, s[12:15], s49 offen sc1
    s_mov_b64 exec, 15
    buffer_store_dwordx4 v[16:19], v4, s[12:15], s48 offen sc1
    s_mov_b64 exec, -1
    s_mov_b32 s61, 0
    s_lshl_b32 s62, s61, 5
    s_add_u32 s62, s62, s3
    s_lshl_b32 s63, s62, 15
    s_add_u32 s63, s63, 1
    s_mul_hi_u32 s63, s63, 0xaaaaaaab
    s_lshr_b32 s63, s63, 7
    s_mul_i32 s48, s62, 171
    s_lshr_b32 s48, s48, 9
    s_mul_i32 s48, s48, 384
    s_mul_i32 s49, s4, 24
    s_add_u32 s50, s49, s63
    s_mul_i32 s50, s50, 384
    v_add_u32 v10, s50, v7
    v_add_u32 v11, 3072, v10
    v_add_u32 v12, 6144, v10
    buffer_load_dwordx2 v[100:101], v6, s[8:11], s48 offen offset:0
    buffer_load_dwordx2 v[102:103], v6, s[8:11], s48 offen offset:128
    buffer_load_dwordx2 v[104:105], v6, s[8:11], s48 offen offset:256
    buffer_load_dwordx2 v[28:29], v10, s[92:95], 0 offen offset:0
    buffer_load_dwordx2 v[30:31], v10, s[92:95], 0 offen offset:128
    buffer_load_dwordx2 v[32:33], v10, s[92:95], 0 offen offset:256
    buffer_load_dwordx2 v[64:65], v10, s[96:99], 0 offen offset:0
    buffer_load_dwordx2 v[66:67], v10, s[96:99], 0 offen offset:128
    buffer_load_dwordx2 v[68:69], v10, s[96:99], 0 offen offset:256
    buffer_load_dwordx2 v[34:35], v10, s[92:95], 0 offen offset:1536
    buffer_load_dwordx2 v[36:37], v10, s[92:95], 0 offen offset:1664
    buffer_load_dwordx2 v[38:39], v10, s[92:95], 0 offen offset:1792
    buffer_load_dwordx2 v[70:71], v10, s[96:99], 0 offen offset:1536
    buffer_load_dwordx2 v[72:73], v10, s[96:99], 0 offen offset:1664
    buffer_load_dwordx2 v[74:75], v10, s[96:99], 0 offen offset:1792
    buffer_load_dwordx2 v[40:41], v11, s[92:95], 0 offen offset:0
    buffer_load_dwordx2 v[42:43], v11, s[92:95], 0 offen offset:128
    buffer_load_dwordx2 v[44:45], v11, s[92:95], 0 offen offset:256
    buffer_load_dwordx2 v[76:77], v11, s[96:99], 0 offen offset:0
    buffer_load_dwordx2 v[78:79], v11, s[96:99], 0 offen offset:128
    buffer_load_dwordx2 v[80:81], v11, s[96:99], 0 offen offset:256
    buffer_load_dwordx2 v[46:47], v11, s[92:95], 0 offen offset:1536
    buffer_load_dwordx2 v[48:49], v11, s[92:95], 0 offen offset:1664
    buffer_load_dwordx2 v[50:51], v11, s[92:95], 0 offen offset:1792
    buffer_load_dwordx2 v[82:83], v11, s[96:99], 0 offen offset:1536
    buffer_load_dwordx2 v[84:85], v11, s[96:99], 0 offen offset:1664
    buffer_load_dwordx2 v[86:87], v11, s[96:99], 0 offen offset:1792
    buffer_load_dwordx2 v[52:53], v12, s[92:95], 0 offen offset:0
    buffer_load_dwordx2 v[54:55], v12, s[92:95], 0 offen offset:128
    buffer_load_dwordx2 v[56:57], v12, s[92:95], 0 offen offset:256
    buffer_load_dwordx2 v[88:89], v12, s[96:99], 0 offen offset:0
    buffer_load_dwordx2 v[90:91], v12, s[96:99], 0 offen offset:128
    buffer_load_dwordx2 v[92:93], v12, s[96:99], 0 offen offset:256
    buffer_load_dwordx2 v[58:59], v12, s[92:95], 0 offen offset:1536
    buffer_load_dwordx2 v[60:61], v12, s[92:95], 0 offen offset:1664
    buffer_load_dwordx2 v[62:63], v12, s[92:95], 0 offen offset:1792
    buffer_load_dwordx2 v[94:95], v12, s[96:99], 0 offen offset:1536
    buffer_load_dwordx2 v[96:97], v12, s[96:99], 0 offen offset:1664
    buffer_load_dwordx2 v[98:99], v12, s[96:99], 0 offen offset:1792
    s_waitcnt vmcnt(0)
    v_lshlrev_b32 v16, 16, v100
    v_and_b32 v17, 0xffff0000, v100
    v_lshlrev_b32 v18, 16, v101
    v_and_b32 v19, 0xffff0000, v101
    v_lshlrev_b32 v20, 16, v102
    v_and_b32 v21, 0xffff0000, v102
    v_lshlrev_b32 v22, 16, v103
    v_and_b32 v23, 0xffff0000, v103
    v_lshlrev_b32 v24, 16, v104
    v_and_b32 v25, 0xffff0000, v104
    v_lshlrev_b32 v26, 16, v105
    v_and_b32 v27, 0xffff0000, v105
    v_lshlrev_b32 v10, 16, v28
    v_lshlrev_b32 v11, 16, v64
    v_and_b32 v28, 0xffff0000, v28
    v_and_b32 v64, 0xffff0000, v64
    v_mul_f32 v10, v10, v16
    v_mul_f32 v28, v28, v17
    v_mul_f32 v100, v10, v11
    v_fmac_f32 v100, v28, v64
    v_lshlrev_b32 v10, 16, v29
    v_lshlrev_b32 v11, 16, v65
    v_and_b32 v29, 0xffff0000, v29
    v_and_b32 v65, 0xffff0000, v65
    v_mul_f32 v10, v10, v18
    v_mul_f32 v29, v29, v19
    v_fmac_f32 v100, v10, v11
    v_fmac_f32 v100, v29, v65
    v_lshlrev_b32 v10, 16, v30
    v_lshlrev_b32 v11, 16, v66
    v_and_b32 v30, 0xffff0000, v30
    v_and_b32 v66, 0xffff0000, v66
    v_mul_f32 v10, v10, v20
    v_mul_f32 v30, v30, v21
    v_fmac_f32 v100, v10, v11
    v_fmac_f32 v100, v30, v66
    v_lshlrev_b32 v10, 16, v31
    v_lshlrev_b32 v11, 16, v67
    v_and_b32 v31, 0xffff0000, v31
    v_and_b32 v67, 0xffff0000, v67
    v_mul_f32 v10, v10, v22
    v_mul_f32 v31, v31, v23
    v_fmac_f32 v100, v10, v11
    v_fmac_f32 v100, v31, v67
    v_lshlrev_b32 v10, 16, v32
    v_lshlrev_b32 v11, 16, v68
    v_and_b32 v32, 0xffff0000, v32
    v_and_b32 v68, 0xffff0000, v68
    v_mul_f32 v10, v10, v24
    v_mul_f32 v32, v32, v25
    v_fmac_f32 v100, v10, v11
    v_fmac_f32 v100, v32, v68
    v_lshlrev_b32 v10, 16, v33
    v_lshlrev_b32 v11, 16, v69
    v_and_b32 v33, 0xffff0000, v33
    v_and_b32 v69, 0xffff0000, v69
    v_mul_f32 v10, v10, v26
    v_mul_f32 v33, v33, v27
    v_fmac_f32 v100, v10, v11
    v_fmac_f32 v100, v33, v69
    v_lshlrev_b32 v10, 16, v34
    v_lshlrev_b32 v11, 16, v70
    v_and_b32 v34, 0xffff0000, v34
    v_and_b32 v70, 0xffff0000, v70
    v_mul_f32 v10, v10, v16
    v_mul_f32 v34, v34, v17
    v_mul_f32 v101, v10, v11
    v_fmac_f32 v101, v34, v70
    v_lshlrev_b32 v10, 16, v35
    v_lshlrev_b32 v11, 16, v71
    v_and_b32 v35, 0xffff0000, v35
    v_and_b32 v71, 0xffff0000, v71
    v_mul_f32 v10, v10, v18
    v_mul_f32 v35, v35, v19
    v_fmac_f32 v101, v10, v11
    v_fmac_f32 v101, v35, v71
    v_lshlrev_b32 v10, 16, v36
    v_lshlrev_b32 v11, 16, v72
    v_and_b32 v36, 0xffff0000, v36
    v_and_b32 v72, 0xffff0000, v72
    v_mul_f32 v10, v10, v20
    v_mul_f32 v36, v36, v21
    v_fmac_f32 v101, v10, v11
    v_fmac_f32 v101, v36, v72
    v_lshlrev_b32 v10, 16, v37
    v_lshlrev_b32 v11, 16, v73
    v_and_b32 v37, 0xffff0000, v37
    v_and_b32 v73, 0xffff0000, v73
    v_mul_f32 v10, v10, v22
    v_mul_f32 v37, v37, v23
    v_fmac_f32 v101, v10, v11
    v_fmac_f32 v101, v37, v73
    v_lshlrev_b32 v10, 16, v38
    v_lshlrev_b32 v11, 16, v74
    v_and_b32 v38, 0xffff0000, v38
    v_and_b32 v74, 0xffff0000, v74
    v_mul_f32 v10, v10, v24
    v_mul_f32 v38, v38, v25
    v_fmac_f32 v101, v10, v11
    v_fmac_f32 v101, v38, v74
    v_lshlrev_b32 v10, 16, v39
    v_lshlrev_b32 v11, 16, v75
    v_and_b32 v39, 0xffff0000, v39
    v_and_b32 v75, 0xffff0000, v75
    v_mul_f32 v10, v10, v26
    v_mul_f32 v39, v39, v27
    v_fmac_f32 v101, v10, v11
    v_fmac_f32 v101, v39, v75
    v_lshlrev_b32 v10, 16, v40
    v_lshlrev_b32 v11, 16, v76
    v_and_b32 v40, 0xffff0000, v40
    v_and_b32 v76, 0xffff0000, v76
    v_mul_f32 v10, v10, v16
    v_mul_f32 v40, v40, v17
    v_mul_f32 v102, v10, v11
    v_fmac_f32 v102, v40, v76
    v_lshlrev_b32 v10, 16, v41
    v_lshlrev_b32 v11, 16, v77
    v_and_b32 v41, 0xffff0000, v41
    v_and_b32 v77, 0xffff0000, v77
    v_mul_f32 v10, v10, v18
    v_mul_f32 v41, v41, v19
    v_fmac_f32 v102, v10, v11
    v_fmac_f32 v102, v41, v77
    v_lshlrev_b32 v10, 16, v42
    v_lshlrev_b32 v11, 16, v78
    v_and_b32 v42, 0xffff0000, v42
    v_and_b32 v78, 0xffff0000, v78
    v_mul_f32 v10, v10, v20
    v_mul_f32 v42, v42, v21
    v_fmac_f32 v102, v10, v11
    v_fmac_f32 v102, v42, v78
    v_lshlrev_b32 v10, 16, v43
    v_lshlrev_b32 v11, 16, v79
    v_and_b32 v43, 0xffff0000, v43
    v_and_b32 v79, 0xffff0000, v79
    v_mul_f32 v10, v10, v22
    v_mul_f32 v43, v43, v23
    v_fmac_f32 v102, v10, v11
    v_fmac_f32 v102, v43, v79
    v_lshlrev_b32 v10, 16, v44
    v_lshlrev_b32 v11, 16, v80
    v_and_b32 v44, 0xffff0000, v44
    v_and_b32 v80, 0xffff0000, v80
    v_mul_f32 v10, v10, v24
    v_mul_f32 v44, v44, v25
    v_fmac_f32 v102, v10, v11
    v_fmac_f32 v102, v44, v80
    v_lshlrev_b32 v10, 16, v45
    v_lshlrev_b32 v11, 16, v81
    v_and_b32 v45, 0xffff0000, v45
    v_and_b32 v81, 0xffff0000, v81
    v_mul_f32 v10, v10, v26
    v_mul_f32 v45, v45, v27
    v_fmac_f32 v102, v10, v11
    v_fmac_f32 v102, v45, v81
    v_lshlrev_b32 v10, 16, v46
    v_lshlrev_b32 v11, 16, v82
    v_and_b32 v46, 0xffff0000, v46
    v_and_b32 v82, 0xffff0000, v82
    v_mul_f32 v10, v10, v16
    v_mul_f32 v46, v46, v17
    v_mul_f32 v103, v10, v11
    v_fmac_f32 v103, v46, v82
    v_lshlrev_b32 v10, 16, v47
    v_lshlrev_b32 v11, 16, v83
    v_and_b32 v47, 0xffff0000, v47
    v_and_b32 v83, 0xffff0000, v83
    v_mul_f32 v10, v10, v18
    v_mul_f32 v47, v47, v19
    v_fmac_f32 v103, v10, v11
    v_fmac_f32 v103, v47, v83
    v_lshlrev_b32 v10, 16, v48
    v_lshlrev_b32 v11, 16, v84
    v_and_b32 v48, 0xffff0000, v48
    v_and_b32 v84, 0xffff0000, v84
    v_mul_f32 v10, v10, v20
    v_mul_f32 v48, v48, v21
    v_fmac_f32 v103, v10, v11
    v_fmac_f32 v103, v48, v84
    v_lshlrev_b32 v10, 16, v49
    v_lshlrev_b32 v11, 16, v85
    v_and_b32 v49, 0xffff0000, v49
    v_and_b32 v85, 0xffff0000, v85
    v_mul_f32 v10, v10, v22
    v_mul_f32 v49, v49, v23
    v_fmac_f32 v103, v10, v11
    v_fmac_f32 v103, v49, v85
    v_lshlrev_b32 v10, 16, v50
    v_lshlrev_b32 v11, 16, v86
    v_and_b32 v50, 0xffff0000, v50
    v_and_b32 v86, 0xffff0000, v86
    v_mul_f32 v10, v10, v24
    v_mul_f32 v50, v50, v25
    v_fmac_f32 v103, v10, v11
    v_fmac_f32 v103, v50, v86
    v_lshlrev_b32 v10, 16, v51
    v_lshlrev_b32 v11, 16, v87
    v_and_b32 v51, 0xffff0000, v51
    v_and_b32 v87, 0xffff0000, v87
    v_mul_f32 v10, v10, v26
    v_mul_f32 v51, v51, v27
    v_fmac_f32 v103, v10, v11
    v_fmac_f32 v103, v51, v87
    v_lshlrev_b32 v10, 16, v52
    v_lshlrev_b32 v11, 16, v88
    v_and_b32 v52, 0xffff0000, v52
    v_and_b32 v88, 0xffff0000, v88
    v_mul_f32 v10, v10, v16
    v_mul_f32 v52, v52, v17
    v_mul_f32 v104, v10, v11
    v_fmac_f32 v104, v52, v88
    v_lshlrev_b32 v10, 16, v53
    v_lshlrev_b32 v11, 16, v89
    v_and_b32 v53, 0xffff0000, v53
    v_and_b32 v89, 0xffff0000, v89
    v_mul_f32 v10, v10, v18
    v_mul_f32 v53, v53, v19
    v_fmac_f32 v104, v10, v11
    v_fmac_f32 v104, v53, v89
    v_lshlrev_b32 v10, 16, v54
    v_lshlrev_b32 v11, 16, v90
    v_and_b32 v54, 0xffff0000, v54
    v_and_b32 v90, 0xffff0000, v90
    v_mul_f32 v10, v10, v20
    v_mul_f32 v54, v54, v21
    v_fmac_f32 v104, v10, v11
    v_fmac_f32 v104, v54, v90
    v_lshlrev_b32 v10, 16, v55
    v_lshlrev_b32 v11, 16, v91
    v_and_b32 v55, 0xffff0000, v55
    v_and_b32 v91, 0xffff0000, v91
    v_mul_f32 v10, v10, v22
    v_mul_f32 v55, v55, v23
    v_fmac_f32 v104, v10, v11
    v_fmac_f32 v104, v55, v91
    v_lshlrev_b32 v10, 16, v56
    v_lshlrev_b32 v11, 16, v92
    v_and_b32 v56, 0xffff0000, v56
    v_and_b32 v92, 0xffff0000, v92
    v_mul_f32 v10, v10, v24
    v_mul_f32 v56, v56, v25
    v_fmac_f32 v104, v10, v11
    v_fmac_f32 v104, v56, v92
    v_lshlrev_b32 v10, 16, v57
    v_lshlrev_b32 v11, 16, v93
    v_and_b32 v57, 0xffff0000, v57
    v_and_b32 v93, 0xffff0000, v93
    v_mul_f32 v10, v10, v26
    v_mul_f32 v57, v57, v27
    v_fmac_f32 v104, v10, v11
    v_fmac_f32 v104, v57, v93
    v_lshlrev_b32 v10, 16, v58
    v_lshlrev_b32 v11, 16, v94
    v_and_b32 v58, 0xffff0000, v58
    v_and_b32 v94, 0xffff0000, v94
    v_mul_f32 v10, v10, v16
    v_mul_f32 v58, v58, v17
    v_mul_f32 v105, v10, v11
    v_fmac_f32 v105, v58, v94
    v_lshlrev_b32 v10, 16, v59
    v_lshlrev_b32 v11, 16, v95
    v_and_b32 v59, 0xffff0000, v59
    v_and_b32 v95, 0xffff0000, v95
    v_mul_f32 v10, v10, v18
    v_mul_f32 v59, v59, v19
    v_fmac_f32 v105, v10, v11
    v_fmac_f32 v105, v59, v95
    v_lshlrev_b32 v10, 16, v60
    v_lshlrev_b32 v11, 16, v96
    v_and_b32 v60, 0xffff0000, v60
    v_and_b32 v96, 0xffff0000, v96
    v_mul_f32 v10, v10, v20
    v_mul_f32 v60, v60, v21
    v_fmac_f32 v105, v10, v11
    v_fmac_f32 v105, v60, v96
    v_lshlrev_b32 v10, 16, v61
    v_lshlrev_b32 v11, 16, v97
    v_and_b32 v61, 0xffff0000, v61
    v_and_b32 v97, 0xffff0000, v97
    v_mul_f32 v10, v10, v22
    v_mul_f32 v61, v61, v23
    v_fmac_f32 v105, v10, v11
    v_fmac_f32 v105, v61, v97
    v_lshlrev_b32 v10, 16, v62
    v_lshlrev_b32 v11, 16, v98
    v_and_b32 v62, 0xffff0000, v62
    v_and_b32 v98, 0xffff0000, v98
    v_mul_f32 v10, v10, v24
    v_mul_f32 v62, v62, v25
    v_fmac_f32 v105, v10, v11
    v_fmac_f32 v105, v62, v98
    v_lshlrev_b32 v10, 16, v63
    v_lshlrev_b32 v11, 16, v99
    v_and_b32 v63, 0xffff0000, v63
    v_and_b32 v99, 0xffff0000, v99
    v_mul_f32 v10, v10, v26
    v_mul_f32 v63, v63, v27
    v_fmac_f32 v105, v10, v11
    v_fmac_f32 v105, v63, v99
    v_add_f32_dpp v100, v100, v100 row_ror:8 row_mask:0xf bank_mask:0xf
    v_add_f32_dpp v101, v101, v101 row_ror:8 row_mask:0xf bank_mask:0xf
    v_add_f32_dpp v102, v102, v102 row_ror:8 row_mask:0xf bank_mask:0xf
    v_add_f32_dpp v103, v103, v103 row_ror:8 row_mask:0xf bank_mask:0xf
    v_add_f32_dpp v104, v104, v104 row_ror:8 row_mask:0xf bank_mask:0xf
    v_add_f32_dpp v105, v105, v105 row_ror:8 row_mask:0xf bank_mask:0xf
    v_add_f32_dpp v100, v100, v100 row_ror:4 row_mask:0xf bank_mask:0xf
    v_add_f32_dpp v101, v101, v101 row_ror:4 row_mask:0xf bank_mask:0xf
    v_add_f32_dpp v102, v102, v102 row_ror:4 row_mask:0xf bank_mask:0xf
    v_add_f32_dpp v103, v103, v103 row_ror:4 row_mask:0xf bank_mask:0xf
    v_add_f32_dpp v104, v104, v104 row_ror:4 row_mask:0xf bank_mask:0xf
    v_add_f32_dpp v105, v105, v105 row_ror:4 row_mask:0xf bank_mask:0xf
    v_add_f32_dpp v100, v100, v100 row_ror:2 row_mask:0xf bank_mask:0xf
    v_add_f32_dpp v101, v101, v101 row_ror:2 row_mask:0xf bank_mask:0xf
    v_add_f32_dpp v102, v102, v102 row_ror:2 row_mask:0xf bank_mask:0xf
    v_add_f32_dpp v103, v103, v103 row_ror:2 row_mask:0xf bank_mask:0xf
    v_add_f32_dpp v104, v104, v104 row_ror:2 row_mask:0xf bank_mask:0xf
    v_add_f32_dpp v105, v105, v105 row_ror:2 row_mask:0xf bank_mask:0xf
    v_add_f32_dpp v100, v100, v100 row_ror:1 row_mask:0xf bank_mask:0xf
    v_add_f32_dpp v101, v101, v101 row_ror:1 row_mask:0xf bank_mask:0xf
    v_add_f32_dpp v102, v102, v102 row_ror:1 row_mask:0xf bank_mask:0xf
    v_add_f32_dpp v103, v103, v103 row_ror:1 row_mask:0xf bank_mask:0xf
    v_add_f32_dpp v104, v104, v104 row_ror:1 row_mask:0xf bank_mask:0xf
    v_add_f32_dpp v105, v105, v105 row_ror:1 row_mask:0xf bank_mask:0xf
    v_cmp_eq_u32 vcc, 1, v5
    s_nop 1
    v_cndmask_b32 v100, v100, v101, vcc
    v_cmp_eq_u32 vcc, 2, v5
    s_nop 1
    v_cndmask_b32 v100, v100, v102, vcc
    v_cmp_eq_u32 vcc, 3, v5
    s_nop 1
    v_cndmask_b32 v100, v100, v103, vcc
    v_cmp_eq_u32 vcc, 4, v5
    s_nop 1
    v_cndmask_b32 v100, v100, v104, vcc
    v_cmp_eq_u32 vcc, 5, v5
    s_nop 1
    v_cndmask_b32 v100, v100, v105, vcc
    s_mul_i32 s48, s62, 768
    s_lshl_b32 s49, s49, 2
    s_add_u32 s48, s48, s49
    s_add_u32 s48, s48, 1179648
    s_mov_b32 exec_lo, 0x003f003f
    s_mov_b32 exec_hi, 0x003f003f
    buffer_store_dword v100, v13, s[12:15], s48 offen sc1
    s_mov_b64 exec, -1
    s_mov_b32 s60, 0x100000
L_wb1:
    s_nop 1
    ds_read_b32 v10, v2 offset:60
    s_sub_u32 s60, s60, 1
    s_cbranch_scc1 L_exit1
    s_waitcnt lgkmcnt(0)
    v_readfirstlane_b32 s48, v10
    s_cmp_lt_u32 s48, 1
    s_cbranch_scc1 L_wb1
    s_mov_b32 s61, 1
    s_lshl_b32 s62, s61, 5
    s_add_u32 s62, s62, s3
    s_lshl_b32 s63, s62, 15
    s_add_u32 s63, s63, 1
    s_mul_hi_u32 s63, s63, 0xaaaaaaab
    s_lshr_b32 s63, s63, 7
    s_mul_i32 s48, s62, 171
    s_lshr_b32 s48, s48, 9
    s_mul_i32 s48, s48, 384
    s_mul_i32 s49, s4, 24
    s_add_u32 s50, s49, s63
    s_mul_i32 s50, s50, 384
    v_add_u32 v10, s50, v7
    v_add_u32 v11, 3072, v10
    v_add_u32 v12, 6144, v10
    buffer_load_dwordx2 v[100:101], v6, s[8:11], s48 offen offset:0
    buffer_load_dwordx2 v[102:103], v6, s[8:11], s48 offen offset:128
    buffer_load_dwordx2 v[104:105], v6, s[8:11], s48 offen offset:256
    buffer_load_dwordx2 v[28:29], v10, s[92:95], 0 offen offset:0
    buffer_load_dwordx2 v[30:31], v10, s[92:95], 0 offen offset:128
    buffer_load_dwordx2 v[32:33], v10, s[92:95], 0 offen offset:256
    buffer_load_dwordx2 v[64:65], v10, s[96:99], 0 offen offset:0
    buffer_load_dwordx2 v[66:67], v10, s[96:99], 0 offen offset:128
    buffer_load_dwordx2 v[68:69], v10, s[96:99], 0 offen offset:256
    buffer_load_dwordx2 v[34:35], v10, s[92:95], 0 offen offset:1536
    buffer_load_dwordx2 v[36:37], v10, s[92:95], 0 offen offset:1664
    buffer_load_dwordx2 v[38:39], v10, s[92:95], 0 offen offset:1792
    buffer_load_dwordx2 v[70:71], v10, s[96:99], 0 offen offset:1536
    buffer_load_dwordx2 v[72:73], v10, s[96:99], 0 offen offset:1664
    buffer_load_dwordx2 v[74:75], v10, s[96:99], 0 offen offset:1792
    buffer_load_dwordx2 v[40:41], v11, s[92:95], 0 offen offset:0
    buffer_load_dwordx2 v[42:43], v11, s[92:95], 0 offen offset:128
    buffer_load_dwordx2 v[44:45], v11, s[92:95], 0 offen offset:256
    buffer_load_dwordx2 v[76:77], v11, s[96:99], 0 offen offset:0
    buffer_load_dwordx2 v[78:79], v11, s[96:99], 0 offen offset:128
    buffer_load_dwordx2 v[80:81], v11, s[96:99], 0 offen offset:256
    buffer_load_dwordx2 v[46:47], v11, s[92:95], 0 offen offset:1536
    buffer_load_dwordx2 v[48:49], v11, s[92:95], 0 offen offset:1664
    buffer_load_dwordx2 v[50:51], v11, s[92:95], 0 offen offset:1792
    buffer_load_dwordx2 v[82:83], v11, s[96:99], 0 offen offset:1536
    buffer_load_dwordx2 v[84:85], v11, s[96:99], 0 offen offset:1664
    buffer_load_dwordx2 v[86:87], v11, s[96:99], 0 offen offset:1792
    buffer_load_dwordx2 v[52:53], v12, s[92:95], 0 offen offset:0
    buffer_load_dwordx2 v[54:55], v12, s[92:95], 0 offen offset:128
    buffer_load_dwordx2 v[56:57], v12, s[92:95], 0 offen offset:256
    buffer_load_dwordx2 v[88:89], v12, s[96:99], 0 offen offset:0
    buffer_load_dwordx2 v[90:91], v12, s[96:99], 0 offen offset:128
    buffer_load_dwordx2 v[92:93], v12, s[96:99], 0 offen offset:256
    buffer_load_dwordx2 v[58:59], v12, s[92:95], 0 offen offset:1536
    buffer_load_dwordx2 v[60:61], v12, s[92:95], 0 offen offset:1664
    buffer_load_dwordx2 v[62:63], v12, s[92:95], 0 offen offset:1792
    buffer_load_dwordx2 v[94:95], v12, s[96:99], 0 offen offset:1536
    buffer_load_dwordx2 v[96:97], v12, s[96:99], 0 offen offset:1664
    buffer_load_dwordx2 v[98:99], v12, s[96:99], 0 offen offset:1792
    s_waitcnt vmcnt(0)
    v_lshlrev_b32 v16, 16, v100
    v_and_b32 v17, 0xffff0000, v100
    v_lshlrev_b32 v18, 16, v101
    v_and_b32 v19, 0xffff0000, v101
    v_lshlrev_b32 v20, 16, v102
    v_and_b32 v21, 0xffff0000, v102
    v_lshlrev_b32 v22, 16, v103
    v_and_b32 v23, 0xffff0000, v103
    v_lshlrev_b32 v24, 16, v104
    v_and_b32 v25, 0xffff0000, v104
    v_lshlrev_b32 v26, 16, v105
    v_and_b32 v27, 0xffff0000, v105
    v_lshlrev_b32 v10, 16, v28
    v_lshlrev_b32 v11, 16, v64
    v_and_b32 v28, 0xffff0000, v28
    v_and_b32 v64, 0xffff0000, v64
    v_mul_f32 v10, v10, v16
    v_mul_f32 v28, v28, v17
    v_mul_f32 v100, v10, v11
    v_fmac_f32 v100, v28, v64
    v_lshlrev_b32 v10, 16, v29
    v_lshlrev_b32 v11, 16, v65
    v_and_b32 v29, 0xffff0000, v29
    v_and_b32 v65, 0xffff0000, v65
    v_mul_f32 v10, v10, v18
    v_mul_f32 v29, v29, v19
    v_fmac_f32 v100, v10, v11
    v_fmac_f32 v100, v29, v65
    v_lshlrev_b32 v10, 16, v30
    v_lshlrev_b32 v11, 16, v66
    v_and_b32 v30, 0xffff0000, v30
    v_and_b32 v66, 0xffff0000, v66
    v_mul_f32 v10, v10, v20
    v_mul_f32 v30, v30, v21
    v_fmac_f32 v100, v10, v11
    v_fmac_f32 v100, v30, v66
    v_lshlrev_b32 v10, 16, v31
    v_lshlrev_b32 v11, 16, v67
    v_and_b32 v31, 0xffff0000, v31
    v_and_b32 v67, 0xffff0000, v67
    v_mul_f32 v10, v10, v22
    v_mul_f32 v31, v31, v23
    v_fmac_f32 v100, v10, v11
    v_fmac_f32 v100, v31, v67
    v_lshlrev_b32 v10, 16, v32
    v_lshlrev_b32 v11, 16, v68
    v_and_b32 v32, 0xffff0000, v32
    v_and_b32 v68, 0xffff0000, v68
    v_mul_f32 v10, v10, v24
    v_mul_f32 v32, v32, v25
    v_fmac_f32 v100, v10, v11
    v_fmac_f32 v100, v32, v68
    v_lshlrev_b32 v10, 16, v33
    v_lshlrev_b32 v11, 16, v69
    v_and_b32 v33, 0xffff0000, v33
    v_and_b32 v69, 0xffff0000, v69
    v_mul_f32 v10, v10, v26
    v_mul_f32 v33, v33, v27
    v_fmac_f32 v100, v10, v11
    v_fmac_f32 v100, v33, v69
    v_lshlrev_b32 v10, 16, v34
    v_lshlrev_b32 v11, 16, v70
    v_and_b32 v34, 0xffff0000, v34
    v_and_b32 v70, 0xffff0000, v70
    v_mul_f32 v10, v10, v16
    v_mul_f32 v34, v34, v17
    v_mul_f32 v101, v10, v11
    v_fmac_f32 v101, v34, v70
    v_lshlrev_b32 v10, 16, v35
    v_lshlrev_b32 v11, 16, v71
    v_and_b32 v35, 0xffff0000, v35
    v_and_b32 v71, 0xffff0000, v71
    v_mul_f32 v10, v10, v18
    v_mul_f32 v35, v35, v19
    v_fmac_f32 v101, v10, v11
    v_fmac_f32 v101, v35, v71
    v_lshlrev_b32 v10, 16, v36
    v_lshlrev_b32 v11, 16, v72
    v_and_b32 v36, 0xffff0000, v36
    v_and_b32 v72, 0xffff0000, v72
    v_mul_f32 v10, v10, v20
    v_mul_f32 v36, v36, v21
    v_fmac_f32 v101, v10, v11
    v_fmac_f32 v101, v36, v72
    v_lshlrev_b32 v10, 16, v37
    v_lshlrev_b32 v11, 16, v73
    v_and_b32 v37, 0xffff0000, v37
    v_and_b32 v73, 0xffff0000, v73
    v_mul_f32 v10, v10, v22
    v_mul_f32 v37, v37, v23
    v_fmac_f32 v101, v10, v11
    v_fmac_f32 v101, v37, v73
    v_lshlrev_b32 v10, 16, v38
    v_lshlrev_b32 v11, 16, v74
    v_and_b32 v38, 0xffff0000, v38
    v_and_b32 v74, 0xffff0000, v74
    v_mul_f32 v10, v10, v24
    v_mul_f32 v38, v38, v25
    v_fmac_f32 v101, v10, v11
    v_fmac_f32 v101, v38, v74
    v_lshlrev_b32 v10, 16, v39
    v_lshlrev_b32 v11, 16, v75
    v_and_b32 v39, 0xffff0000, v39
    v_and_b32 v75, 0xffff0000, v75
    v_mul_f32 v10, v10, v26
    v_mul_f32 v39, v39, v27
    v_fmac_f32 v101, v10, v11
    v_fmac_f32 v101, v39, v75
    v_lshlrev_b32 v10, 16, v40
    v_lshlrev_b32 v11, 16, v76
    v_and_b32 v40, 0xffff0000, v40
    v_and_b32 v76, 0xffff0000, v76
    v_mul_f32 v10, v10, v16
    v_mul_f32 v40, v40, v17
    v_mul_f32 v102, v10, v11
    v_fmac_f32 v102, v40, v76
    v_lshlrev_b32 v10, 16, v41
    v_lshlrev_b32 v11, 16, v77
    v_and_b32 v41, 0xffff0000, v41
    v_and_b32 v77, 0xffff0000, v77
    v_mul_f32 v10, v10, v18
    v_mul_f32 v41, v41, v19
    v_fmac_f32 v102, v10, v11
    v_fmac_f32 v102, v41, v77
    v_lshlrev_b32 v10, 16, v42
    v_lshlrev_b32 v11, 16, v78
    v_and_b32 v42, 0xffff0000, v42
    v_and_b32 v78, 0xffff0000, v78
    v_mul_f32 v10, v10, v20
    v_mul_f32 v42, v42, v21
    v_fmac_f32 v102, v10, v11
    v_fmac_f32 v102, v42, v78
    v_lshlrev_b32 v10, 16, v43
    v_lshlrev_b32 v11, 16, v79
    v_and_b32 v43, 0xffff0000, v43
    v_and_b32 v79, 0xffff0000, v79
    v_mul_f32 v10, v10, v22
    v_mul_f32 v43, v43, v23
    v_fmac_f32 v102, v10, v11
    v_fmac_f32 v102, v43, v79
    v_lshlrev_b32 v10, 16, v44
    v_lshlrev_b32 v11, 16, v80
    v_and_b32 v44, 0xffff0000, v44
    v_and_b32 v80, 0xffff0000, v80
    v_mul_f32 v10, v10, v24
    v_mul_f32 v44, v44, v25
    v_fmac_f32 v102, v10, v11
    v_fmac_f32 v102, v44, v80
    v_lshlrev_b32 v10, 16, v45
    v_lshlrev_b32 v11, 16, v81
    v_and_b32 v45, 0xffff0000, v45
    v_and_b32 v81, 0xffff0000, v81
    v_mul_f32 v10, v10, v26
    v_mul_f32 v45, v45, v27
    v_fmac_f32 v102, v10, v11
    v_fmac_f32 v102, v45, v81
    v_lshlrev_b32 v10, 16, v46
    v_lshlrev_b32 v11, 16, v82
    v_and_b32 v46, 0xffff0000, v46
    v_and_b32 v82, 0xffff0000, v82
    v_mul_f32 v10, v10, v16
    v_mul_f32 v46, v46, v17
    v_mul_f32 v103, v10, v11
    v_fmac_f32 v103, v46, v82
    v_lshlrev_b32 v10, 16, v47
    v_lshlrev_b32 v11, 16, v83
    v_and_b32 v47, 0xffff0000, v47
    v_and_b32 v83, 0xffff0000, v83
    v_mul_f32 v10, v10, v18
    v_mul_f32 v47, v47, v19
    v_fmac_f32 v103, v10, v11
    v_fmac_f32 v103, v47, v83
    v_lshlrev_b32 v10, 16, v48
    v_lshlrev_b32 v11, 16, v84
    v_and_b32 v48, 0xffff0000, v48
    v_and_b32 v84, 0xffff0000, v84
    v_mul_f32 v10, v10, v20
    v_mul_f32 v48, v48, v21
    v_fmac_f32 v103, v10, v11
    v_fmac_f32 v103, v48, v84
    v_lshlrev_b32 v10, 16, v49
    v_lshlrev_b32 v11, 16, v85
    v_and_b32 v49, 0xffff0000, v49
    v_and_b32 v85, 0xffff0000, v85
    v_mul_f32 v10, v10, v22
    v_mul_f32 v49, v49, v23
    v_fmac_f32 v103, v10, v11
    v_fmac_f32 v103, v49, v85
    v_lshlrev_b32 v10, 16, v50
    v_lshlrev_b32 v11, 16, v86
    v_and_b32 v50, 0xffff0000, v50
    v_and_b32 v86, 0xffff0000, v86
    v_mul_f32 v10, v10, v24
    v_mul_f32 v50, v50, v25
    v_fmac_f32 v103, v10, v11
    v_fmac_f32 v103, v50, v86
    v_lshlrev_b32 v10, 16, v51
    v_lshlrev_b32 v11, 16, v87
    v_and_b32 v51, 0xffff0000, v51
    v_and_b32 v87, 0xffff0000, v87
    v_mul_f32 v10, v10, v26
    v_mul_f32 v51, v51, v27
    v_fmac_f32 v103, v10, v11
    v_fmac_f32 v103, v51, v87
    v_lshlrev_b32 v10, 16, v52
    v_lshlrev_b32 v11, 16, v88
    v_and_b32 v52, 0xffff0000, v52
    v_and_b32 v88, 0xffff0000, v88
    v_mul_f32 v10, v10, v16
    v_mul_f32 v52, v52, v17
    v_mul_f32 v104, v10, v11
    v_fmac_f32 v104, v52, v88
    v_lshlrev_b32 v10, 16, v53
    v_lshlrev_b32 v11, 16, v89
    v_and_b32 v53, 0xffff0000, v53
    v_and_b32 v89, 0xffff0000, v89
    v_mul_f32 v10, v10, v18
    v_mul_f32 v53, v53, v19
    v_fmac_f32 v104, v10, v11
    v_fmac_f32 v104, v53, v89
    v_lshlrev_b32 v10, 16, v54
    v_lshlrev_b32 v11, 16, v90
    v_and_b32 v54, 0xffff0000, v54
    v_and_b32 v90, 0xffff0000, v90
    v_mul_f32 v10, v10, v20
    v_mul_f32 v54, v54, v21
    v_fmac_f32 v104, v10, v11
    v_fmac_f32 v104, v54, v90
    v_lshlrev_b32 v10, 16, v55
    v_lshlrev_b32 v11, 16, v91
    v_and_b32 v55, 0xffff0000, v55
    v_and_b32 v91, 0xffff0000, v91
    v_mul_f32 v10, v10, v22
    v_mul_f32 v55, v55, v23
    v_fmac_f32 v104, v10, v11
    v_fmac_f32 v104, v55, v91
    v_lshlrev_b32 v10, 16, v56
    v_lshlrev_b32 v11, 16, v92
    v_and_b32 v56, 0xffff0000, v56
    v_and_b32 v92, 0xffff0000, v92
    v_mul_f32 v10, v10, v24
    v_mul_f32 v56, v56, v25
    v_fmac_f32 v104, v10, v11
    v_fmac_f32 v104, v56, v92
    v_lshlrev_b32 v10, 16, v57
    v_lshlrev_b32 v11, 16, v93
    v_and_b32 v57, 0xffff0000, v57
    v_and_b32 v93, 0xffff0000, v93
    v_mul_f32 v10, v10, v26
    v_mul_f32 v57, v57, v27
    v_fmac_f32 v104, v10, v11
    v_fmac_f32 v104, v57, v93
    v_lshlrev_b32 v10, 16, v58
    v_lshlrev_b32 v11, 16, v94
    v_and_b32 v58, 0xffff0000, v58
    v_and_b32 v94, 0xffff0000, v94
    v_mul_f32 v10, v10, v16
    v_mul_f32 v58, v58, v17
    v_mul_f32 v105, v10, v11
    v_fmac_f32 v105, v58, v94
    v_lshlrev_b32 v10, 16, v59
    v_lshlrev_b32 v11, 16, v95
    v_and_b32 v59, 0xffff0000, v59
    v_and_b32 v95, 0xffff0000, v95
    v_mul_f32 v10, v10, v18
    v_mul_f32 v59, v59, v19
    v_fmac_f32 v105, v10, v11
    v_fmac_f32 v105, v59, v95
    v_lshlrev_b32 v10, 16, v60
    v_lshlrev_b32 v11, 16, v96
    v_and_b32 v60, 0xffff0000, v60
    v_and_b32 v96, 0xffff0000, v96
    v_mul_f32 v10, v10, v20
    v_mul_f32 v60, v60, v21
    v_fmac_f32 v105, v10, v11
    v_fmac_f32 v105, v60, v96
    v_lshlrev_b32 v10, 16, v61
    v_lshlrev_b32 v11, 16, v97
    v_and_b32 v61, 0xffff0000, v61
    v_and_b32 v97, 0xffff0000, v97
    v_mul_f32 v10, v10, v22
    v_mul_f32 v61, v61, v23
    v_fmac_f32 v105, v10, v11
    v_fmac_f32 v105, v61, v97
    v_lshlrev_b32 v10, 16, v62
    v_lshlrev_b32 v11, 16, v98
    v_and_b32 v62, 0xffff0000, v62
    v_and_b32 v98, 0xffff0000, v98
    v_mul_f32 v10, v10, v24
    v_mul_f32 v62, v62, v25
    v_fmac_f32 v105, v10, v11
    v_fmac_f32 v105, v62, v98
    v_lshlrev_b32 v10, 16, v63
    v_lshlrev_b32 v11, 16, v99
    v_and_b32 v63, 0xffff0000, v63
    v_and_b32 v99, 0xffff0000, v99
    v_mul_f32 v10, v10, v26
    v_mul_f32 v63, v63, v27
    v_fmac_f32 v105, v10, v11
    v_fmac_f32 v105, v63, v99
    v_add_f32_dpp v100, v100, v100 row_ror:8 row_mask:0xf bank_mask:0xf
    v_add_f32_dpp v101, v101, v101 row_ror:8 row_mask:0xf bank_mask:0xf
    v_add_f32_dpp v102, v102, v102 row_ror:8 row_mask:0xf bank_mask:0xf
    v_add_f32_dpp v103, v103, v103 row_ror:8 row_mask:0xf bank_mask:0xf
    v_add_f32_dpp v104, v104, v104 row_ror:8 row_mask:0xf bank_mask:0xf
    v_add_f32_dpp v105, v105, v105 row_ror:8 row_mask:0xf bank_mask:0xf
    v_add_f32_dpp v100, v100, v100 row_ror:4 row_mask:0xf bank_mask:0xf
    v_add_f32_dpp v101, v101, v101 row_ror:4 row_mask:0xf bank_mask:0xf
    v_add_f32_dpp v102, v102, v102 row_ror:4 row_mask:0xf bank_mask:0xf
    v_add_f32_dpp v103, v103, v103 row_ror:4 row_mask:0xf bank_mask:0xf
    v_add_f32_dpp v104, v104, v104 row_ror:4 row_mask:0xf bank_mask:0xf
    v_add_f32_dpp v105, v105, v105 row_ror:4 row_mask:0xf bank_mask:0xf
    v_add_f32_dpp v100, v100, v100 row_ror:2 row_mask:0xf bank_mask:0xf
    v_add_f32_dpp v101, v101, v101 row_ror:2 row_mask:0xf bank_mask:0xf
    v_add_f32_dpp v102, v102, v102 row_ror:2 row_mask:0xf bank_mask:0xf
    v_add_f32_dpp v103, v103, v103 row_ror:2 row_mask:0xf bank_mask:0xf
    v_add_f32_dpp v104, v104, v104 row_ror:2 row_mask:0xf bank_mask:0xf
    v_add_f32_dpp v105, v105, v105 row_ror:2 row_mask:0xf bank_mask:0xf
    v_add_f32_dpp v100, v100, v100 row_ror:1 row_mask:0xf bank_mask:0xf
    v_add_f32_dpp v101, v101, v101 row_ror:1 row_mask:0xf bank_mask:0xf
    v_add_f32_dpp v102, v102, v102 row_ror:1 row_mask:0xf bank_mask:0xf
    v_add_f32_dpp v103, v103, v103 row_ror:1 row_mask:0xf bank_mask:0xf
    v_add_f32_dpp v104, v104, v104 row_ror:1 row_mask:0xf bank_mask:0xf
    v_add_f32_dpp v105, v105, v105 row_ror:1 row_mask:0xf bank_mask:0xf
    v_cmp_eq_u32 vcc, 1, v5
    s_nop 1
    v_cndmask_b32 v100, v100, v101, vcc
    v_cmp_eq_u32 vcc, 2, v5
    s_nop 1
    v_cndmask_b32 v100, v100, v102, vcc
    v_cmp_eq_u32 vcc, 3, v5
    s_nop 1
    v_cndmask_b32 v100, v100, v103, vcc
    v_cmp_eq_u32 vcc, 4, v5
    s_nop 1
    v_cndmask_b32 v100, v100, v104, vcc
    v_cmp_eq_u32 vcc, 5, v5
    s_nop 1
    v_cndmask_b32 v100, v100, v105, vcc
    s_mul_i32 s48, s62, 768
    s_lshl_b32 s49, s49, 2
    s_add_u32 s48, s48, s49
    s_add_u32 s48, s48, 1179648
    s_mov_b32 exec_lo, 0x003f003f
    s_mov_b32 exec_hi, 0x003f003f
    buffer_store_dword v100, v13, s[12:15], s48 offen sc1
    s_mov_b64 exec, -1
    s_mov_b32 s60, 0x100000
L_wd0:
    s_nop 1
    ds_read_b32 v10, v2 offset:20
    s_sub_u32 s60, s60, 1
    s_cbranch_scc1 L_exit1
    s_waitcnt lgkmcnt(0)
    v_readfirstlane_b32 s48, v10
    s_cmp_eq_u32 s48, 0
    s_cbranch_scc1 L_wd0
    ds_read_b128 v[16:19], v2 offset:0
    ds_read_b64 v[20:21], v2 offset:16
    s_waitcnt lgkmcnt(0)
    v_readfirstlane_b32 s84, v16
    v_readfirstlane_b32 s85, v17
    v_readfirstlane_b32 s86, v18
    v_readfirstlane_b32 s87, v19
    v_readfirstlane_b32 s88, v20
    v_readfirstlane_b32 s89, v21
    s_mov_b32 s60, 0x100000
L_wf0:
    s_nop 1
    ds_read_b32 v10, v2 offset:40
    s_sub_u32 s60, s60, 1
    s_cbranch_scc1 L_exit1
    s_waitcnt lgkmcnt(0)
    v_readfirstlane_b32 s48, v10
    s_cmp_lt_u32 s48, 4
    s_cbranch_scc1 L_wf0
    s_cmp_eq_u32 s84, s87
    ds_read_b128 v[16:19], v4 offset:256
    ds_read_b128 v[20:23], v4 offset:1280
    ds_read_b128 v[24:27], v4 offset:2304
    ds_read_b128 v[28:31], v4 offset:3328
    ds_read_b128 v[32:35], v4 offset:4352
    ds_read_b128 v[36:39], v4 offset:5376
    s_add_u32 s54, s33, 0
    s_add_u32 s55, s33, 4096
    s_cmp_eq_u32 s84, s87
    s_waitcnt lgkmcnt(0)
    s_cselect_b32 exec_lo, 0xffff, -1
    s_cselect_b32 exec_hi, 0xffff0000, -1
    buffer_store_dwordx4 v[16:19], v4, s[12:15], s54 offen offset:0 sc1
    s_cselect_b32 exec_lo, 0x0, -1
    s_cselect_b32 exec_hi, 0xffff, -1
    buffer_store_dwordx4 v[20:23], v4, s[12:15], s54 offen offset:1024 sc1
    s_cselect_b32 exec_lo, 0xffff0000, -1
    s_cselect_b32 exec_hi, 0x0, -1
    buffer_store_dwordx4 v[24:27], v4, s[12:15], s54 offen offset:2048 sc1
    s_cselect_b32 exec_lo, 0xffff, -1
    s_cselect_b32 exec_hi, 0xffff0000, -1
    buffer_store_dwordx4 v[28:31], v4, s[12:15], s54 offen offset:3072 sc1
    s_cselect_b32 exec_lo, 0x0, -1
    s_cselect_b32 exec_hi, 0xffff, -1
    buffer_store_dwordx4 v[32:35], v4, s[12:15], s55 offen offset:0 sc1
    s_cselect_b32 exec_lo, 0xffff0000, -1
    s_cselect_b32 exec_hi, 0x0, -1
    buffer_store_dwordx4 v[36:39], v4, s[12:15], s55 offen offset:1024 sc1
    s_mov_b64 exec, -1
L_fl0:
    s_nop 1
    v_mov_b32 v10, 1
    s_waitcnt vmcnt(0)
    s_mov_b64 exec, 1
    buffer_store_dword v10, off, s[12:15], s32 sc1
    ds_write_b32 v2, v10 offset:52
    s_mov_b64 exec, -1
    s_mov_b32 s60, 0x100000
L_wb2:
    s_nop 1
    ds_read_b32 v10, v2 offset:60
    s_sub_u32 s60, s60, 1
    s_cbranch_scc1 L_exit1
    s_waitcnt lgkmcnt(0)
    v_readfirstlane_b32 s48, v10
    s_cmp_lt_u32 s48, 9
    s_cbranch_scc1 L_wb2
    s_mov_b32 s61, 2
    s_lshl_b32 s62, s61, 5
    s_add_u32 s62, s62, s3
    s_lshl_b32 s63, s62, 15
    s_add_u32 s63, s63, 1
    s_mul_hi_u32 s63, s63, 0xaaaaaaab
    s_lshr_b32 s63, s63, 7
    s_mul_i32 s48, s62, 171
    s_lshr_b32 s48, s48, 9
    s_mul_i32 s48, s48, 384
    s_mul_i32 s49, s4, 24
    s_add_u32 s50, s49, s63
    s_mul_i32 s50, s50, 384
    v_add_u32 v10, s50, v7
    v_add_u32 v11, 3072, v10
    v_add_u32 v12, 6144, v10
    buffer_load_dwordx2 v[100:101], v6, s[8:11], s48 offen offset:0
    buffer_load_dwordx2 v[102:103], v6, s[8:11], s48 offen offset:128
    buffer_load_dwordx2 v[104:105], v6, s[8:11], s48 offen offset:256
    buffer_load_dwordx2 v[28:29], v10, s[92:95], 0 offen offset:0
    buffer_load_dwordx2 v[30:31], v10, s[92:95], 0 offen offset:128
    buffer_load_dwordx2 v[32:33], v10, s[92:95], 0 offen offset:256
    buffer_load_dwordx2 v[64:65], v10, s[96:99], 0 offen offset:0
    buffer_load_dwordx2 v[66:67], v10, s[96:99], 0 offen offset:128
    buffer_load_dwordx2 v[68:69], v10, s[96:99], 0 offen offset:256
    buffer_load_dwordx2 v[34:35], v10, s[92:95], 0 offen offset:1536
    buffer_load_dwordx2 v[36:37], v10, s[92:95], 0 offen offset:1664
    buffer_load_dwordx2 v[38:39], v10, s[92:95], 0 offen offset:1792
    buffer_load_dwordx2 v[70:71], v10, s[96:99], 0 offen offset:1536
    buffer_load_dwordx2 v[72:73], v10, s[96:99], 0 offen offset:1664
    buffer_load_dwordx2 v[74:75], v10, s[96:99], 0 offen offset:1792
    buffer_load_dwordx2 v[40:41], v11, s[92:95], 0 offen offset:0
    buffer_load_dwordx2 v[42:43], v11, s[92:95], 0 offen offset:128
    buffer_load_dwordx2 v[44:45], v11, s[92:95], 0 offen offset:256
    buffer_load_dwordx2 v[76:77], v11, s[96:99], 0 offen offset:0
    buffer_load_dwordx2 v[78:79], v11, s[96:99], 0 offen offset:128
    buffer_load_dwordx2 v[80:81], v11, s[96:99], 0 offen offset:256
    buffer_load_dwordx2 v[46:47], v11, s[92:95], 0 offen offset:1536
    buffer_load_dwordx2 v[48:49], v11, s[92:95], 0 offen offset:1664
    buffer_load_dwordx2 v[50:51], v11, s[92:95], 0 offen offset:1792
    buffer_load_dwordx2 v[82:83], v11, s[96:99], 0 offen offset:1536
    buffer_load_dwordx2 v[84:85], v11, s[96:99], 0 offen offset:1664
    buffer_load_dwordx2 v[86:87], v11, s[96:99], 0 offen offset:1792
    buffer_load_dwordx2 v[52:53], v12, s[92:95], 0 offen offset:0
    buffer_load_dwordx2 v[54:55], v12, s[92:95], 0 offen offset:128
    buffer_load_dwordx2 v[56:57], v12, s[92:95], 0 offen offset:256
    buffer_load_dwordx2 v[88:89], v12, s[96:99], 0 offen offset:0
    buffer_load_dwordx2 v[90:91], v12, s[96:99], 0 offen offset:128
    buffer_load_dwordx2 v[92:93], v12, s[96:99], 0 offen offset:256
    buffer_load_dwordx2 v[58:59], v12, s[92:95], 0 offen offset:1536
    buffer_load_dwordx2 v[60:61], v12, s[92:95], 0 offen offset:1664
    buffer_load_dwordx2 v[62:63], v12, s[92:95], 0 offen offset:1792
    buffer_load_dwordx2 v[94:95], v12, s[96:99], 0 offen offset:1536
    buffer_load_dwordx2 v[96:97], v12, s[96:99], 0 offen offset:1664
    buffer_load_dwordx2 v[98:99], v12, s[96:99], 0 offen offset:1792
    s_waitcnt vmcnt(0)
    v_lshlrev_b32 v16, 16, v100
    v_and_b32 v17, 0xffff0000, v100
    v_lshlrev_b32 v18, 16, v101
    v_and_b32 v19, 0xffff0000, v101
    v_lshlrev_b32 v20, 16, v102
    v_and_b32 v21, 0xffff0000, v102
    v_lshlrev_b32 v22, 16, v103
    v_and_b32 v23, 0xffff0000, v103
    v_lshlrev_b32 v24, 16, v104
    v_and_b32 v25, 0xffff0000, v104
    v_lshlrev_b32 v26, 16, v105
    v_and_b32 v27, 0xffff0000, v105
    v_lshlrev_b32 v10, 16, v28
    v_lshlrev_b32 v11, 16, v64
    v_and_b32 v28, 0xffff0000, v28
    v_and_b32 v64, 0xffff0000, v64
    v_mul_f32 v10, v10, v16
    v_mul_f32 v28, v28, v17
    v_mul_f32 v100, v10, v11
    v_fmac_f32 v100, v28, v64
    v_lshlrev_b32 v10, 16, v29
    v_lshlrev_b32 v11, 16, v65
    v_and_b32 v29, 0xffff0000, v29
    v_and_b32 v65, 0xffff0000, v65
    v_mul_f32 v10, v10, v18
    v_mul_f32 v29, v29, v19
    v_fmac_f32 v100, v10, v11
    v_fmac_f32 v100, v29, v65
    v_lshlrev_b32 v10, 16, v30
    v_lshlrev_b32 v11, 16, v66
    v_and_b32 v30, 0xffff0000, v30
    v_and_b32 v66, 0xffff0000, v66
    v_mul_f32 v10, v10, v20
    v_mul_f32 v30, v30, v21
    v_fmac_f32 v100, v10, v11
    v_fmac_f32 v100, v30, v66
    v_lshlrev_b32 v10, 16, v31
    v_lshlrev_b32 v11, 16, v67
    v_and_b32 v31, 0xffff0000, v31
    v_and_b32 v67, 0xffff0000, v67
    v_mul_f32 v10, v10, v22
    v_mul_f32 v31, v31, v23
    v_fmac_f32 v100, v10, v11
    v_fmac_f32 v100, v31, v67
    v_lshlrev_b32 v10, 16, v32
    v_lshlrev_b32 v11, 16, v68
    v_and_b32 v32, 0xffff0000, v32
    v_and_b32 v68, 0xffff0000, v68
    v_mul_f32 v10, v10, v24
    v_mul_f32 v32, v32, v25
    v_fmac_f32 v100, v10, v11
    v_fmac_f32 v100, v32, v68
    v_lshlrev_b32 v10, 16, v33
    v_lshlrev_b32 v11, 16, v69
    v_and_b32 v33, 0xffff0000, v33
    v_and_b32 v69, 0xffff0000, v69
    v_mul_f32 v10, v10, v26
    v_mul_f32 v33, v33, v27
    v_fmac_f32 v100, v10, v11
    v_fmac_f32 v100, v33, v69
    v_lshlrev_b32 v10, 16, v34
    v_lshlrev_b32 v11, 16, v70
    v_and_b32 v34, 0xffff0000, v34
    v_and_b32 v70, 0xffff0000, v70
    v_mul_f32 v10, v10, v16
    v_mul_f32 v34, v34, v17
    v_mul_f32 v101, v10, v11
    v_fmac_f32 v101, v34, v70
    v_lshlrev_b32 v10, 16, v35
    v_lshlrev_b32 v11, 16, v71
    v_and_b32 v35, 0xffff0000, v35
    v_and_b32 v71, 0xffff0000, v71
    v_mul_f32 v10, v10, v18
    v_mul_f32 v35, v35, v19
    v_fmac_f32 v101, v10, v11
    v_fmac_f32 v101, v35, v71
    v_lshlrev_b32 v10, 16, v36
    v_lshlrev_b32 v11, 16, v72
    v_and_b32 v36, 0xffff0000, v36
    v_and_b32 v72, 0xffff0000, v72
    v_mul_f32 v10, v10, v20
    v_mul_f32 v36, v36, v21
    v_fmac_f32 v101, v10, v11
    v_fmac_f32 v101, v36, v72
    v_lshlrev_b32 v10, 16, v37
    v_lshlrev_b32 v11, 16, v73
    v_and_b32 v37, 0xffff0000, v37
    v_and_b32 v73, 0xffff0000, v73
    v_mul_f32 v10, v10, v22
    v_mul_f32 v37, v37, v23
    v_fmac_f32 v101, v10, v11
    v_fmac_f32 v101, v37, v73
    v_lshlrev_b32 v10, 16, v38
    v_lshlrev_b32 v11, 16, v74
    v_and_b32 v38, 0xffff0000, v38
    v_and_b32 v74, 0xffff0000, v74
    v_mul_f32 v10, v10, v24
    v_mul_f32 v38, v38, v25
    v_fmac_f32 v101, v10, v11
    v_fmac_f32 v101, v38, v74
    v_lshlrev_b32 v10, 16, v39
    v_lshlrev_b32 v11, 16, v75
    v_and_b32 v39, 0xffff0000, v39
    v_and_b32 v75, 0xffff0000, v75
    v_mul_f32 v10, v10, v26
    v_mul_f32 v39, v39, v27
    v_fmac_f32 v101, v10, v11
    v_fmac_f32 v101, v39, v75
    v_lshlrev_b32 v10, 16, v40
    v_lshlrev_b32 v11, 16, v76
    v_and_b32 v40, 0xffff0000, v40
    v_and_b32 v76, 0xffff0000, v76
    v_mul_f32 v10, v10, v16
    v_mul_f32 v40, v40, v17
    v_mul_f32 v102, v10, v11
    v_fmac_f32 v102, v40, v76
    v_lshlrev_b32 v10, 16, v41
    v_lshlrev_b32 v11, 16, v77
    v_and_b32 v41, 0xffff0000, v41
    v_and_b32 v77, 0xffff0000, v77
    v_mul_f32 v10, v10, v18
    v_mul_f32 v41, v41, v19
    v_fmac_f32 v102, v10, v11
    v_fmac_f32 v102, v41, v77
    v_lshlrev_b32 v10, 16, v42
    v_lshlrev_b32 v11, 16, v78
    v_and_b32 v42, 0xffff0000, v42
    v_and_b32 v78, 0xffff0000, v78
    v_mul_f32 v10, v10, v20
    v_mul_f32 v42, v42, v21
    v_fmac_f32 v102, v10, v11
    v_fmac_f32 v102, v42, v78
    v_lshlrev_b32 v10, 16, v43
    v_lshlrev_b32 v11, 16, v79
    v_and_b32 v43, 0xffff0000, v43
    v_and_b32 v79, 0xffff0000, v79
    v_mul_f32 v10, v10, v22
    v_mul_f32 v43, v43, v23
    v_fmac_f32 v102, v10, v11
    v_fmac_f32 v102, v43, v79
    v_lshlrev_b32 v10, 16, v44
    v_lshlrev_b32 v11, 16, v80
    v_and_b32 v44, 0xffff0000, v44
    v_and_b32 v80, 0xffff0000, v80
    v_mul_f32 v10, v10, v24
    v_mul_f32 v44, v44, v25
    v_fmac_f32 v102, v10, v11
    v_fmac_f32 v102, v44, v80
    v_lshlrev_b32 v10, 16, v45
    v_lshlrev_b32 v11, 16, v81
    v_and_b32 v45, 0xffff0000, v45
    v_and_b32 v81, 0xffff0000, v81
    v_mul_f32 v10, v10, v26
    v_mul_f32 v45, v45, v27
    v_fmac_f32 v102, v10, v11
    v_fmac_f32 v102, v45, v81
    v_lshlrev_b32 v10, 16, v46
    v_lshlrev_b32 v11, 16, v82
    v_and_b32 v46, 0xffff0000, v46
    v_and_b32 v82, 0xffff0000, v82
    v_mul_f32 v10, v10, v16
    v_mul_f32 v46, v46, v17
    v_mul_f32 v103, v10, v11
    v_fmac_f32 v103, v46, v82
    v_lshlrev_b32 v10, 16, v47
    v_lshlrev_b32 v11, 16, v83
    v_and_b32 v47, 0xffff0000, v47
    v_and_b32 v83, 0xffff0000, v83
    v_mul_f32 v10, v10, v18
    v_mul_f32 v47, v47, v19
    v_fmac_f32 v103, v10, v11
    v_fmac_f32 v103, v47, v83
    v_lshlrev_b32 v10, 16, v48
    v_lshlrev_b32 v11, 16, v84
    v_and_b32 v48, 0xffff0000, v48
    v_and_b32 v84, 0xffff0000, v84
    v_mul_f32 v10, v10, v20
    v_mul_f32 v48, v48, v21
    v_fmac_f32 v103, v10, v11
    v_fmac_f32 v103, v48, v84
    v_lshlrev_b32 v10, 16, v49
    v_lshlrev_b32 v11, 16, v85
    v_and_b32 v49, 0xffff0000, v49
    v_and_b32 v85, 0xffff0000, v85
    v_mul_f32 v10, v10, v22
    v_mul_f32 v49, v49, v23
    v_fmac_f32 v103, v10, v11
    v_fmac_f32 v103, v49, v85
    v_lshlrev_b32 v10, 16, v50
    v_lshlrev_b32 v11, 16, v86
    v_and_b32 v50, 0xffff0000, v50
    v_and_b32 v86, 0xffff0000, v86
    v_mul_f32 v10, v10, v24
    v_mul_f32 v50, v50, v25
    v_fmac_f32 v103, v10, v11
    v_fmac_f32 v103, v50, v86
    v_lshlrev_b32 v10, 16, v51
    v_lshlrev_b32 v11, 16, v87
    v_and_b32 v51, 0xffff0000, v51
    v_and_b32 v87, 0xffff0000, v87
    v_mul_f32 v10, v10, v26
    v_mul_f32 v51, v51, v27
    v_fmac_f32 v103, v10, v11
    v_fmac_f32 v103, v51, v87
    v_lshlrev_b32 v10, 16, v52
    v_lshlrev_b32 v11, 16, v88
    v_and_b32 v52, 0xffff0000, v52
    v_and_b32 v88, 0xffff0000, v88
    v_mul_f32 v10, v10, v16
    v_mul_f32 v52, v52, v17
    v_mul_f32 v104, v10, v11
    v_fmac_f32 v104, v52, v88
    v_lshlrev_b32 v10, 16, v53
    v_lshlrev_b32 v11, 16, v89
    v_and_b32 v53, 0xffff0000, v53
    v_and_b32 v89, 0xffff0000, v89
    v_mul_f32 v10, v10, v18
    v_mul_f32 v53, v53, v19
    v_fmac_f32 v104, v10, v11
    v_fmac_f32 v104, v53, v89
    v_lshlrev_b32 v10, 16, v54
    v_lshlrev_b32 v11, 16, v90
    v_and_b32 v54, 0xffff0000, v54
    v_and_b32 v90, 0xffff0000, v90
    v_mul_f32 v10, v10, v20
    v_mul_f32 v54, v54, v21
    v_fmac_f32 v104, v10, v11
    v_fmac_f32 v104, v54, v90
    v_lshlrev_b32 v10, 16, v55
    v_lshlrev_b32 v11, 16, v91
    v_and_b32 v55, 0xffff0000, v55
    v_and_b32 v91, 0xffff0000, v91
    v_mul_f32 v10, v10, v22
    v_mul_f32 v55, v55, v23
    v_fmac_f32 v104, v10, v11
    v_fmac_f32 v104, v55, v91
    v_lshlrev_b32 v10, 16, v56
    v_lshlrev_b32 v11, 16, v92
    v_and_b32 v56, 0xffff0000, v56
    v_and_b32 v92, 0xffff0000, v92
    v_mul_f32 v10, v10, v24
    v_mul_f32 v56, v56, v25
    v_fmac_f32 v104, v10, v11
    v_fmac_f32 v104, v56, v92
    v_lshlrev_b32 v10, 16, v57
    v_lshlrev_b32 v11, 16, v93
    v_and_b32 v57, 0xffff0000, v57
    v_and_b32 v93, 0xffff0000, v93
    v_mul_f32 v10, v10, v26
    v_mul_f32 v57, v57, v27
    v_fmac_f32 v104, v10, v11
    v_fmac_f32 v104, v57, v93
    v_lshlrev_b32 v10, 16, v58
    v_lshlrev_b32 v11, 16, v94
    v_and_b32 v58, 0xffff0000, v58
    v_and_b32 v94, 0xffff0000, v94
    v_mul_f32 v10, v10, v16
    v_mul_f32 v58, v58, v17
    v_mul_f32 v105, v10, v11
    v_fmac_f32 v105, v58, v94
    v_lshlrev_b32 v10, 16, v59
    v_lshlrev_b32 v11, 16, v95
    v_and_b32 v59, 0xffff0000, v59
    v_and_b32 v95, 0xffff0000, v95
    v_mul_f32 v10, v10, v18
    v_mul_f32 v59, v59, v19
    v_fmac_f32 v105, v10, v11
    v_fmac_f32 v105, v59, v95
    v_lshlrev_b32 v10, 16, v60
    v_lshlrev_b32 v11, 16, v96
    v_and_b32 v60, 0xffff0000, v60
    v_and_b32 v96, 0xffff0000, v96
    v_mul_f32 v10, v10, v20
    v_mul_f32 v60, v60, v21
    v_fmac_f32 v105, v10, v11
    v_fmac_f32 v105, v60, v96
    v_lshlrev_b32 v10, 16, v61
    v_lshlrev_b32 v11, 16, v97
    v_and_b32 v61, 0xffff0000, v61
    v_and_b32 v97, 0xffff0000, v97
    v_mul_f32 v10, v10, v22
    v_mul_f32 v61, v61, v23
    v_fmac_f32 v105, v10, v11
    v_fmac_f32 v105, v61, v97
    v_lshlrev_b32 v10, 16, v62
    v_lshlrev_b32 v11, 16, v98
    v_and_b32 v62, 0xffff0000, v62
    v_and_b32 v98, 0xffff0000, v98
    v_mul_f32 v10, v10, v24
    v_mul_f32 v62, v62, v25
    v_fmac_f32 v105, v10, v11
    v_fmac_f32 v105, v62, v98
    v_lshlrev_b32 v10, 16, v63
    v_lshlrev_b32 v11, 16, v99
    v_and_b32 v63, 0xffff0000, v63
    v_and_b32 v99, 0xffff0000, v99
    v_mul_f32 v10, v10, v26
    v_mul_f32 v63, v63, v27
    v_fmac_f32 v105, v10, v11
    v_fmac_f32 v105, v63, v99
    v_add_f32_dpp v100, v100, v100 row_ror:8 row_mask:0xf bank_mask:0xf
    v_add_f32_dpp v101, v101, v101 row_ror:8 row_mask:0xf bank_mask:0xf
    v_add_f32_dpp v102, v102, v102 row_ror:8 row_mask:0xf bank_mask:0xf
    v_add_f32_dpp v103, v103, v103 row_ror:8 row_mask:0xf bank_mask:0xf
    v_add_f32_dpp v104, v104, v104 row_ror:8 row_mask:0xf bank_mask:0xf
    v_add_f32_dpp v105, v105, v105 row_ror:8 row_mask:0xf bank_mask:0xf
    v_add_f32_dpp v100, v100, v100 row_ror:4 row_mask:0xf bank_mask:0xf
    v_add_f32_dpp v101, v101, v101 row_ror:4 row_mask:0xf bank_mask:0xf
    v_add_f32_dpp v102, v102, v102 row_ror:4 row_mask:0xf bank_mask:0xf
    v_add_f32_dpp v103, v103, v103 row_ror:4 row_mask:0xf bank_mask:0xf
    v_add_f32_dpp v104, v104, v104 row_ror:4 row_mask:0xf bank_mask:0xf
    v_add_f32_dpp v105, v105, v105 row_ror:4 row_mask:0xf bank_mask:0xf
    v_add_f32_dpp v100, v100, v100 row_ror:2 row_mask:0xf bank_mask:0xf
    v_add_f32_dpp v101, v101, v101 row_ror:2 row_mask:0xf bank_mask:0xf
    v_add_f32_dpp v102, v102, v102 row_ror:2 row_mask:0xf bank_mask:0xf
    v_add_f32_dpp v103, v103, v103 row_ror:2 row_mask:0xf bank_mask:0xf
    v_add_f32_dpp v104, v104, v104 row_ror:2 row_mask:0xf bank_mask:0xf
    v_add_f32_dpp v105, v105, v105 row_ror:2 row_mask:0xf bank_mask:0xf
    v_add_f32_dpp v100, v100, v100 row_ror:1 row_mask:0xf bank_mask:0xf
    v_add_f32_dpp v101, v101, v101 row_ror:1 row_mask:0xf bank_mask:0xf
    v_add_f32_dpp v102, v102, v102 row_ror:1 row_mask:0xf bank_mask:0xf
    v_add_f32_dpp v103, v103, v103 row_ror:1 row_mask:0xf bank_mask:0xf
    v_add_f32_dpp v104, v104, v104 row_ror:1 row_mask:0xf bank_mask:0xf
    v_add_f32_dpp v105, v105, v105 row_ror:1 row_mask:0xf bank_mask:0xf
    v_cmp_eq_u32 vcc, 1, v5
    s_nop 1
    v_cndmask_b32 v100, v100, v101, vcc
    v_cmp_eq_u32 vcc, 2, v5
    s_nop 1
    v_cndmask_b32 v100, v100, v102, vcc
    v_cmp_eq_u32 vcc, 3, v5
    s_nop 1
    v_cndmask_b32 v100, v100, v103, vcc
    v_cmp_eq_u32 vcc, 4, v5
    s_nop 1
    v_cndmask_b32 v100, v100, v104, vcc
    v_cmp_eq_u32 vcc, 5, v5
    s_nop 1
    v_cndmask_b32 v100, v100, v105, vcc
    s_mul_i32 s48, s62, 768
    s_lshl_b32 s49, s49, 2
    s_add_u32 s48, s48, s49
    s_add_u32 s48, s48, 1179648
    s_mov_b32 exec_lo, 0x003f003f
    s_mov_b32 exec_hi, 0x003f003f
    buffer_store_dword v100, v13, s[12:15], s48 offen sc1
    s_mov_b64 exec, -1
    s_mov_b32 s60, 0x100000
L_wf1:
    s_nop 1
    ds_read_b32 v10, v2 offset:44
    s_sub_u32 s60, s60, 1
    s_cbranch_scc1 L_exit1
    s_waitcnt lgkmcnt(0)
    v_readfirstlane_b32 s48, v10
    s_cmp_lt_u32 s48, 4
    s_cbranch_scc1 L_wf1
    s_cmp_eq_u32 s85, s88
    s_cbranch_scc1 L_fl1
    ds_read_b128 v[16:19], v4 offset:6400
    ds_read_b128 v[20:23], v4 offset:7424
    ds_read_b128 v[24:27], v4 offset:8448
    ds_read_b128 v[28:31], v4 offset:9472
    ds_read_b128 v[32:35], v4 offset:10496
    ds_read_b128 v[36:39], v4 offset:11520
    s_add_u32 s54, s33, 1572864
    s_add_u32 s55, s33, 1576960
    s_cmp_eq_u32 s85, s88
    s_waitcnt lgkmcnt(0)
    buffer_store_dwordx4 v[16:19], v4, s[12:15], s54 offen offset:0 sc1
    buffer_store_dwordx4 v[20:23], v4, s[12:15], s54 offen offset:1024 sc1
    buffer_store_dwordx4 v[24:27], v4, s[12:15], s54 offen offset:2048 sc1
    buffer_store_dwordx4 v[28:31], v4, s[12:15], s54 offen offset:3072 sc1
    buffer_store_dwordx4 v[32:35], v4, s[12:15], s55 offen offset:0 sc1
    buffer_store_dwordx4 v[36:39], v4, s[12:15], s55 offen offset:1024 sc1
L_fl1:
    s_nop 1
    v_mov_b32 v10, 2
    s_waitcnt vmcnt(0)
    s_mov_b64 exec, 1
    buffer_store_dword v10, off, s[12:15], s32 sc1
    ds_write_b32 v2, v10 offset:52
    s_mov_b64 exec, -1
    s_mov_b32 s60, 0x100000
L_wf2:
    s_nop 1
    ds_read_b32 v10, v2 offset:48
    s_sub_u32 s60, s60, 1
    s_cbranch_scc1 L_exit1
    s_waitcnt lgkmcnt(0)
    v_readfirstlane_b32 s48, v10
    s_cmp_lt_u32 s48, 4
    s_cbranch_scc1 L_wf2
    s_cmp_eq_u32 s86, s89
    s_cbranch_scc1 L_fl2
    ds_read_b128 v[16:19], v4 offset:12544
    ds_read_b128 v[20:23], v4 offset:13568
    ds_read_b128 v[24:27], v4 offset:14592
    ds_read_b128 v[28:31], v4 offset:15616
    ds_read_b128 v[32:35], v4 offset:16640
    ds_read_b128 v[36:39], v4 offset:17664
    s_add_u32 s54, s33, 3145728
    s_add_u32 s55, s33, 3149824
    s_cmp_eq_u32 s86, s89
    s_waitcnt lgkmcnt(0)
    buffer_store_dwordx4 v[16:19], v4, s[12:15], s54 offen offset:0 sc1
    buffer_store_dwordx4 v[20:23], v4, s[12:15], s54 offen offset:1024 sc1
    buffer_store_dwordx4 v[24:27], v4, s[12:15], s54 offen offset:2048 sc1
    buffer_store_dwordx4 v[28:31], v4, s[12:15], s54 offen offset:3072 sc1
    buffer_store_dwordx4 v[32:35], v4, s[12:15], s55 offen offset:0 sc1
    buffer_store_dwordx4 v[36:39], v4, s[12:15], s55 offen offset:1024 sc1
L_fl2:
    s_nop 1
    v_mov_b32 v10, 3
    s_waitcnt vmcnt(0)
    s_mov_b64 exec, 1
    s_cbranch_scc1 L_fn2
    buffer_store_dword v10, off, s[12:15], s32 sc1
L_fn2:
    s_nop 1
    ds_write_b32 v2, v10 offset:52
    s_mov_b64 exec, -1
    s_endpgm
L_h3:
    s_nop 1
    s_waitcnt lgkmcnt(0)
    s_mov_b32 s12, s82
    s_and_b32 s13, s83, 0xffff
    s_mov_b32 s14, 10485760
    s_mov_b32 s15, 0x00020000
    s_barrier
    v_lshlrev_b32 v7, 2, v1
    s_mul_i32 s20, s4, 4352
    s_add_u32 s20, s20, 10223616
    s_lshl_b32 s21, s3, 2
    s_add_u32 s21, s21, s20
    s_mov_b32 s46, 0x155
    v_lshrrev_b32 v13, 2, v1
    v_mul_u32_u24 v13, 4352, v13
    v_and_or_b32 v13, v7, 12, v13
    s_and_b32 s7, s4, 3
    s_mul_i32 s47, s7, 4352
    s_lshl_b32 s7, s7, 2
    v_mov_b32 v8, 208
    s_mov_b32 s45, 2
    v_mov_b32 v3, 144
    v_bfrev_b32 v6, -2
    s_mov_b32 exec_hi, 0
L_h3loop:
    s_nop 1
    s_mov_b32 s60, 0x100000
L_wp1:
    s_nop 1
    ds_read_b32 v10, v2 offset:128
    s_sub_u32 s60, s60, 1
    s_cbranch_scc1 L_exit1
    s_waitcnt lgkmcnt(0)
    v_readfirstlane_b32 s48, v10
    s_cmp_lt_u32 s48, s45
    s_cbranch_scc1 L_wp1
    s_memrealtime s[40:41]
    s_add_u32 s45, s45, 3
    s_mov_b32 exec_lo, 1
    s_waitcnt lgkmcnt(0)
    v_mov_b32 v5, s40
    buffer_store_dword v5, off, s[12:15], s21
    s_mov_b32 exec_lo, -1
    s_mov_b32 s60, 0x100000
L_wp2:
    s_nop 1
    ds_read_b32 v10, v2 offset:128
    s_sub_u32 s60, s60, 1
    s_cbranch_scc1 L_exit1
    s_waitcnt lgkmcnt(0)
    v_readfirstlane_b32 s48, v10
    s_cmp_lt_u32 s48, s45
    s_cbranch_scc1 L_wp2
    buffer_load_dword v5, v7, s[12:15], s20 offen sc0
    s_add_u32 s45, s45, 4
    s_sub_u32 s40, s40, 4096
    s_waitcnt vmcnt(0)
    v_subrev_u32 v5, s40, v5
    v_cmp_gt_u32 vcc, 8192, v5
    s_nop 1
    v_cndmask_b32 v5, v6, v5, vcc
    s_mov_b32 s48, 2048
    s_add_u32 s49, s48, 2048
    v_cmp_gt_u32 vcc, s49, v5
    s_bcnt1_i32_b64 s50, vcc
    s_cmp_lt_u32 s50, 16
    s_cselect_b32 s48, s49, s48
    s_add_u32 s49, s48, 1024
    v_cmp_gt_u32 vcc, s49, v5
    s_bcnt1_i32_b64 s50, vcc
    s_cmp_lt_u32 s50, 16
    s_cselect_b32 s48, s49, s48
    s_add_u32 s49, s48, 512
    v_cmp_gt_u32 vcc, s49, v5
    s_bcnt1_i32_b64 s50, vcc
    s_cmp_lt_u32 s50, 16
    s_cselect_b32 s48, s49, s48
    s_add_u32 s49, s48, 256
    v_cmp_gt_u32 vcc, s49, v5
    s_bcnt1_i32_b64 s50, vcc
    s_cmp_lt_u32 s50, 16
    s_cselect_b32 s48, s49, s48
    s_add_u32 s49, s48, 128
    v_cmp_gt_u32 vcc, s49, v5
    s_bcnt1_i32_b64 s50, vcc
    s_cmp_lt_u32 s50, 16
    s_cselect_b32 s48, s49, s48
    s_add_u32 s49, s48, 64
    v_cmp_gt_u32 vcc, s49, v5
    s_bcnt1_i32_b64 s50, vcc
    s_cmp_lt_u32 s50, 16
    s_cselect_b32 s48, s49, s48
    s_add_u32 s49, s48, 32
    v_cmp_gt_u32 vcc, s49, v5
    s_bcnt1_i32_b64 s50, vcc
    s_cmp_lt_u32 s50, 16
    s_cselect_b32 s48, s49, s48
    s_add_u32 s49, s48, 16
    v_cmp_gt_u32 vcc, s49, v5
    s_bcnt1_i32_b64 s50, vcc
    s_cmp_lt_u32 s50, 16
    s_cselect_b32 s48, s49, s48
    s_add_u32 s49, s48, 8
    v_cmp_gt_u32 vcc, s49, v5
    s_bcnt1_i32_b64 s50, vcc
    s_cmp_lt_u32 s50, 16
    s_cselect_b32 s48, s49, s48
    s_add_u32 s49, s48, s40
    s_or_b32 s49, s49, 1
    v_mov_b32 v5, s49
    ds_write_b32 v3, v5
    v_add_u32 v3, 4, v3
    s_bitcmp1_b32 s46, 0
    s_cbranch_scc0 L_h3ng
    s_cmp_lt_u32 s48, 6136
    s_cselect_b32 exec_lo, 1, 0
    s_cmp_lt_u32 s3, 4
    s_cselect_b32 exec_lo, exec_lo, 0
    buffer_store_dword v5, off, s[12:15], s21 offset:2048 sc1
    s_mov_b32 exec_lo, 0xffff
    s_add_u32 s51, s45, 0
    s_mov_b32 s60, 0x100000
L_wp3:
    s_nop 1
    ds_read_b32 v10, v2 offset:128
    s_sub_u32 s60, s60, 1
    s_cbranch_scc1 L_exit1
    s_waitcnt lgkmcnt(0)
    v_readfirstlane_b32 s48, v10
    s_cmp_lt_u32 s48, s51
    s_cbranch_scc1 L_wp3
    s_sub_u32 s51, s20, s47
    s_mov_b32 s60, 8
    s_mov_b32 s48, 0
L_h3gp:
    s_nop 1
    buffer_load_dword v4, v13, s[12:15], s51 offen offset:2048 sc1
    s_sub_u32 s60, s60, 1
    s_cbranch_scc1 L_h3gw
L_h3gq:
    s_waitcnt vmcnt(0)
    v_subrev_u32 v4, s40, v4
    v_cmp_gt_u32 vcc, 8192, v4
    s_nop 1
    v_cndmask_b32 v4, v6, v4, vcc
    s_nop 1
    v_min_u32_dpp v4, v4, v4 quad_perm:[1,0,3,2] row_mask:0xf bank_mask:0xf
    s_nop 1
    v_min_u32_dpp v4, v4, v4 quad_perm:[2,3,0,1] row_mask:0xf bank_mask:0xf
    v_cmp_eq_u32 vcc, v6, v4
    s_cbranch_vccnz L_h3gp
    v_readlane_b32 s52, v4, 0
    v_readlane_b32 s53, v4, 4
    v_readlane_b32 s54, v4, 8
    v_readlane_b32 s55, v4, 12
    v_readlane_b32 s49, v4, s7
    s_max_u32 s52, s52, s53
    s_max_u32 s54, s54, s55
    s_max_u32 s48, s52, s54
    s_sub_u32 s48, s48, s49
    s_sub_u32 s48, s48, 25
    s_max_i32 s48, s48, 0
    s_min_i32 s48, s48, 1000
L_h3gw:
    s_nop 1
    s_or_b32 s48, s48, 0x10000
    v_mov_b32 v5, s48
    ds_write_b32 v8, v5
    s_mov_b32 exec_lo, -1
    v_add_u32 v8, 4, v8
    s_waitcnt vmcnt(0)
L_h3ng:
    s_nop 1
    s_lshr_b32 s46, s46, 1
    s_add_u32 s45, s45, 5
    s_add_u32 s20, s20, 128
    s_add_u32 s21, s21, 128
    s_cmp_lt_u32 s45, 132
    s_cbranch_scc1 L_h3loop
    s_mov_b64 exec, -1
    v_lshlrev_b32 v12, 2, v1
    v_add_u32 v13, 49408, v12
    v_lshlrev_b32 v8, 4, v1
    s_add_u32 s48, s3, 64
    s_mul_i32 s48, s48, 171
    s_lshr_b32 s48, s48, 9
    s_mul_i32 s58, s48, 4352
    s_add_u32 s58, s58, 9454848
    s_mul_i32 s59, s48, 384
    s_cmp_eq_u32 s48, 21
    s_cselect_b32 s20, 15, 23
    s_mul_i32 s48, s48, 24
    s_add_u32 s62, s2, 512
    s_sub_u32 s56, s62, s48
    s_lshl_b32 s62, s62, 10
    s_mov_b32 s60, 0x40000
L_fs:
    s_nop 1
    buffer_load_dword v4, off, s[12:15], s58 offset:4 sc1
    s_sub_u32 s60, s60, 1
    s_cbranch_scc1 L_exit1
    s_waitcnt vmcnt(0)
    v_cmp_eq_u32 vcc, 0, v4
    s_cbranch_vccnz L_fs
    buffer_load_dword v10, v12, s[12:15], s58 offen offset:128 sc1
    ds_read_b128 v[4:7], v2 offset:112
    v_xor_b32 v11, 1, v1
    v_cmp_eq_u32 vcc, s56, v1
    s_nop 1
    v_cndmask_b32 v11, v1, v11, vcc
    v_add_u32 v11, s48, v11
    v_lshlrev_b32 v11, 10, v11
    s_nop 0
    v_readlane_b32 s64, v11, 0
    v_readlane_b32 s65, v11, 1
    v_readlane_b32 s66, v11, 2
    v_readlane_b32 s67, v11, 3
    v_readlane_b32 s68, v11, 4
    v_readlane_b32 s69, v11, 5
    v_readlane_b32 s70, v11, 6
    v_readlane_b32 s71, v11, 7
    v_readlane_b32 s72, v11, 8
    v_readlane_b32 s73, v11, 9
    v_readlane_b32 s74, v11, 10
    v_readlane_b32 s75, v11, 11
    v_readlane_b32 s84, v11, 12
    v_readlane_b32 s85, v11, 13
    v_readlane_b32 s86, v11, 14
    v_readlane_b32 s87, v11, 15
    v_readlane_b32 s88, v11, 16
    v_readlane_b32 s89, v11, 17
    v_readlane_b32 s90, v11, 18
    v_readlane_b32 s91, v11, 19
    v_readlane_b32 s92, v11, 20
    v_readlane_b32 s93, v11, 21
    v_readlane_b32 s94, v11, 22
    v_readlane_b32 s95, v11, 23
    s_mov_b32 s96, s78
    s_and_b32 s97, s79, 0xffff
    s_mov_b32 s98, 12288
    s_mov_b32 s99, 0x00020000
    v_lshlrev_b32 v12, 1, v1
    s_waitcnt vmcnt(0)
    v_readlane_b32 s57, v10, s56
    v_cndmask_b32 v10, v10, v2, vcc
    s_nop 0
    v_readlane_b32 s24, v10, 0
    v_readlane_b32 s25, v10, 1
    v_readlane_b32 s26, v10, 2
    v_readlane_b32 s27, v10, 3
    v_readlane_b32 s28, v10, 4
    v_readlane_b32 s29, v10, 5
    v_readlane_b32 s30, v10, 6
    v_readlane_b32 s31, v10, 7
    v_readlane_b32 s32, v10, 8
    v_readlane_b32 s33, v10, 9
    v_readlane_b32 s34, v10, 10
    v_readlane_b32 s35, v10, 11
    v_readlane_b32 s36, v10, 12
    v_readlane_b32 s37, v10, 13
    v_readlane_b32 s38, v10, 14
    v_readlane_b32 s39, v10, 15
    v_readlane_b32 s40, v10, 16
    v_readlane_b32 s41, v10, 17
    v_readlane_b32 s42, v10, 18
    v_readlane_b32 s43, v10, 19
    v_readlane_b32 s44, v10, 20
    v_readlane_b32 s45, v10, 21
    v_readlane_b32 s46, v10, 22
    v_readlane_b32 s47, v10, 23
    v_mov_b32 v9, 1
    s_mov_b64 exec, 1
    s_mov_b32 s60, 0x100000
L_wel:
    s_nop 1
    ds_read_b32 v10, v2 offset:136
    s_sub_u32 s60, s60, 1
    s_cbranch_scc1 L_exit1
    s_waitcnt lgkmcnt(0)
    v_readfirstlane_b32 s48, v10
    s_cmp_lt_u32 s48, 4
    s_cbranch_scc1 L_wel
    buffer_atomic_add v9, off, s[12:15], s58 sc0
    s_mov_b64 exec, -1
    s_waitcnt vmcnt(0)
    v_readfirstlane_b32 s48, v9
    s_cmp_lg_u32 s48, s20
    s_cbranch_scc1 L_exit1
    buffer_load_dwordx4 v[32:35], v8, s[12:15], s64 offen sc1
    buffer_load_dwordx4 v[36:39], v8, s[12:15], s65 offen sc1
    buffer_load_dwordx4 v[40:43], v8, s[12:15], s66 offen sc1
    buffer_load_dwordx4 v[44:47], v8, s[12:15], s67 offen sc1
    buffer_load_dwordx4 v[48:51], v8, s[12:15], s68 offen sc1
    buffer_load_dwordx4 v[52:55], v8, s[12:15], s69 offen sc1
    buffer_load_dwordx4 v[56:59], v8, s[12:15], s70 offen sc1
    buffer_load_dwordx4 v[60:63], v8, s[12:15], s71 offen sc1
    buffer_load_dwordx4 v[64:67], v8, s[12:15], s72 offen sc1
    buffer_load_dwordx4 v[68:71], v8, s[12:15], s73 offen sc1
    buffer_load_dwordx4 v[72:75], v8, s[12:15], s74 offen sc1
    buffer_load_dwordx4 v[76:79], v8, s[12:15], s75 offen sc1
    buffer_load_dwordx4 v[80:83], v8, s[12:15], s84 offen sc1
    buffer_load_dwordx4 v[84:87], v8, s[12:15], s85 offen sc1
    buffer_load_dwordx4 v[88:91], v8, s[12:15], s86 offen sc1
    buffer_load_dwordx4 v[92:95], v8, s[12:15], s87 offen sc1
    buffer_load_dwordx4 v[96:99], v8, s[12:15], s88 offen sc1
    buffer_load_dwordx4 v[100:103], v8, s[12:15], s89 offen sc1
    buffer_load_dwordx4 v[104:107], v8, s[12:15], s90 offen sc1
    buffer_load_dwordx4 v[108:111], v8, s[12:15], s91 offen sc1
    buffer_load_dwordx4 v[112:115], v8, s[12:15], s92 offen sc1
    buffer_load_dwordx4 v[116:119], v8, s[12:15], s93 offen sc1
    buffer_load_dwordx4 v[120:123], v8, s[12:15], s94 offen sc1
    buffer_load_dwordx4 v[124:127], v8, s[12:15], s95 offen sc1
    s_mov_b32 s60, 0x100000
L_wn:
    s_nop 1
    ds_read_b32 v10, v2 offset:72
    s_sub_u32 s60, s60, 1
    s_cbranch_scc1 L_exit1
    s_waitcnt lgkmcnt(0)
    v_readfirstlane_b32 s48, v10
    s_cmp_lt_u32 s48, 4
    s_cbranch_scc1 L_wn
    ds_read_b32 v16, v13 offset:0
    ds_read_b32 v17, v13 offset:768
    ds_read_b32 v18, v13 offset:1536
    ds_read_b32 v19, v13 offset:2304
    ds_read_b32 v20, v13 offset:256
    ds_read_b32 v21, v13 offset:1024
    ds_read_b32 v22, v13 offset:1792
    ds_read_b32 v23, v13 offset:2560
    ds_read_b32 v24, v13 offset:512
    ds_read_b32 v25, v13 offset:1280
    ds_read_b32 v26, v13 offset:2048
    ds_read_b32 v27, v13 offset:2816
    s_mov_b32 s60, 0x40000
    s_waitcnt lgkmcnt(8)
    v_add_f32 v16, v16, v17
    v_add_f32 v18, v18, v19
    v_sub_f32 v16, v16, v6
    v_add_f32 v28, v16, v18
    s_waitcnt lgkmcnt(4)
    v_add_f32 v20, v20, v21
    v_add_f32 v22, v22, v23
    v_sub_f32 v20, v20, v6
    v_add_f32 v29, v20, v22
    s_waitcnt lgkmcnt(0)
    v_add_f32 v24, v24, v25
    v_add_f32 v26, v26, v27
    v_sub_f32 v24, v24, v6
    v_add_f32 v30, v24, v26
    s_branch L_fr2
L_fr:
    s_nop 1
    buffer_load_dwordx4 v[32:35], v8, s[12:15], s64 offen sc1
    buffer_load_dwordx4 v[36:39], v8, s[12:15], s65 offen sc1
    buffer_load_dwordx4 v[40:43], v8, s[12:15], s66 offen sc1
    buffer_load_dwordx4 v[44:47], v8, s[12:15], s67 offen sc1
    buffer_load_dwordx4 v[48:51], v8, s[12:15], s68 offen sc1
    buffer_load_dwordx4 v[52:55], v8, s[12:15], s69 offen sc1
    buffer_load_dwordx4 v[56:59], v8, s[12:15], s70 offen sc1
    buffer_load_dwordx4 v[60:63], v8, s[12:15], s71 offen sc1
    buffer_load_dwordx4 v[64:67], v8, s[12:15], s72 offen sc1
    buffer_load_dwordx4 v[68:71], v8, s[12:15], s73 offen sc1
    buffer_load_dwordx4 v[72:75], v8, s[12:15], s74 offen sc1
    buffer_load_dwordx4 v[76:79], v8, s[12:15], s75 offen sc1
    buffer_load_dwordx4 v[80:83], v8, s[12:15], s84 offen sc1
    buffer_load_dwordx4 v[84:87], v8, s[12:15], s85 offen sc1
    buffer_load_dwordx4 v[88:91], v8, s[12:15], s86 offen sc1
    buffer_load_dwordx4 v[92:95], v8, s[12:15], s87 offen sc1
    buffer_load_dwordx4 v[96:99], v8, s[12:15], s88 offen sc1
    buffer_load_dwordx4 v[100:103], v8, s[12:15], s89 offen sc1
    buffer_load_dwordx4 v[104:107], v8, s[12:15], s90 offen sc1
    buffer_load_dwordx4 v[108:111], v8, s[12:15], s91 offen sc1
    buffer_load_dwordx4 v[112:115], v8, s[12:15], s92 offen sc1
    buffer_load_dwordx4 v[116:119], v8, s[12:15], s93 offen sc1
    buffer_load_dwordx4 v[120:123], v8, s[12:15], s94 offen sc1
    buffer_load_dwordx4 v[124:127], v8, s[12:15], s95 offen sc1
L_fr2:
    v_mul_f32 v4, s57, v28
    v_mul_f32 v5, s57, v29
    v_mul_f32 v6, s57, v30
    v_mov_b32 v7, 1
    s_sub_u32 s60, s60, 1
    s_cbranch_scc1 L_exit1
    s_waitcnt vmcnt(22)
    v_fmac_f32 v4, s24, v32
    v_fmac_f32 v5, s24, v33
    v_fmac_f32 v6, s24, v34
    v_fmac_f32 v4, s25, v36
    v_fmac_f32 v5, s25, v37
    v_fmac_f32 v6, s25, v38
    v_min3_u32 v7, v7, v35, v39
    s_waitcnt vmcnt(20)
    v_fmac_f32 v4, s26, v40
    v_fmac_f32 v5, s26, v41
    v_fmac_f32 v6, s26, v42
    v_fmac_f32 v4, s27, v44
    v_fmac_f32 v5, s27, v45
    v_fmac_f32 v6, s27, v46
    v_min3_u32 v7, v7, v43, v47
    s_waitcnt vmcnt(18)
    v_fmac_f32 v4, s28, v48
    v_fmac_f32 v5, s28, v49
    v_fmac_f32 v6, s28, v50
    v_fmac_f32 v4, s29, v52
    v_fmac_f32 v5, s29, v53
    v_fmac_f32 v6, s29, v54
    v_min3_u32 v7, v7, v51, v55
    s_waitcnt vmcnt(16)
    v_fmac_f32 v4, s30, v56
    v_fmac_f32 v5, s30, v57
    v_fmac_f32 v6, s30, v58
    v_fmac_f32 v4, s31, v60
    v_fmac_f32 v5, s31, v61
    v_fmac_f32 v6, s31, v62
    v_min3_u32 v7, v7, v59, v63
    s_waitcnt vmcnt(14)
    v_fmac_f32 v4, s32, v64
    v_fmac_f32 v5, s32, v65
    v_fmac_f32 v6, s32, v66
    v_fmac_f32 v4, s33, v68
    v_fmac_f32 v5, s33, v69
    v_fmac_f32 v6, s33, v70
    v_min3_u32 v7, v7, v67, v71
    s_waitcnt vmcnt(12)
    v_fmac_f32 v4, s34, v72
    v_fmac_f32 v5, s34, v73
    v_fmac_f32 v6, s34, v74
    v_fmac_f32 v4, s35, v76
    v_fmac_f32 v5, s35, v77
    v_fmac_f32 v6, s35, v78
    v_min3_u32 v7, v7, v75, v79
    s_waitcnt vmcnt(10)
    v_fmac_f32 v4, s36, v80
    v_fmac_f32 v5, s36, v81
    v_fmac_f32 v6, s36, v82
    v_fmac_f32 v4, s37, v84
    v_fmac_f32 v5, s37, v85
    v_fmac_f32 v6, s37, v86
    v_min3_u32 v7, v7, v83, v87
    s_waitcnt vmcnt(8)
    v_fmac_f32 v4, s38, v88
    v_fmac_f32 v5, s38, v89
    v_fmac_f32 v6, s38, v90
    v_fmac_f32 v4, s39, v92
    v_fmac_f32 v5, s39, v93
    v_fmac_f32 v6, s39, v94
    v_min3_u32 v7, v7, v91, v95
    s_waitcnt vmcnt(6)
    v_fmac_f32 v4, s40, v96
    v_fmac_f32 v5, s40, v97
    v_fmac_f32 v6, s40, v98
    v_fmac_f32 v4, s41, v100
    v_fmac_f32 v5, s41, v101
    v_fmac_f32 v6, s41, v102
    v_min3_u32 v7, v7, v99, v103
    s_waitcnt vmcnt(4)
    v_fmac_f32 v4, s42, v104
    v_fmac_f32 v5, s42, v105
    v_fmac_f32 v6, s42, v106
    v_fmac_f32 v4, s43, v108
    v_fmac_f32 v5, s43, v109
    v_fmac_f32 v6, s43, v110
    v_min3_u32 v7, v7, v107, v111
    s_waitcnt vmcnt(2)
    v_fmac_f32 v4, s44, v112
    v_fmac_f32 v5, s44, v113
    v_fmac_f32 v6, s44, v114
    v_fmac_f32 v4, s45, v116
    v_fmac_f32 v5, s45, v117
    v_fmac_f32 v6, s45, v118
    v_min3_u32 v7, v7, v115, v119
    s_waitcnt vmcnt(0)
    v_fmac_f32 v4, s46, v120
    v_fmac_f32 v5, s46, v121
    v_fmac_f32 v6, s46, v122
    v_fmac_f32 v4, s47, v124
    v_fmac_f32 v5, s47, v125
    v_fmac_f32 v6, s47, v126
    v_min3_u32 v7, v7, v123, v127
    v_cmp_eq_u32 vcc, 0, v7
    v_cvt_pk_bf16_f32 v4, v4, v4
    v_cvt_pk_bf16_f32 v5, v5, v5
    v_cvt_pk_bf16_f32 v6, v6, v6
    s_cbranch_vccnz L_fr
    buffer_store_short v4, v12, s[96:99], s59 offen offset:0
    buffer_store_short v5, v12, s[96:99], s59 offen offset:128
    buffer_store_short v6, v12, s[96:99], s59 offen offset:256
L_fx:
    s_endpgm
L_h2:
    s_nop 1
    s_mov_b32 s92, s74
    s_and_b32 s93, s75, 0xffff
    s_mov_b32 s94, 2097152
    s_mov_b32 s95, 0x00020000
    s_mov_b32 s96, s76
    s_and_b32 s97, s77, 0xffff
    s_mov_b32 s98, 2097152
    s_mov_b32 s99, 0x00020000
    s_mov_b32 s60, 0x100000
L_wd2:
    s_nop 1
    ds_read_b32 v10, v2 offset:20
    s_sub_u32 s60, s60, 1
    s_cbranch_scc1 L_exit1
    s_waitcnt lgkmcnt(0)
    v_readfirstlane_b32 s48, v10
    s_cmp_eq_u32 s48, 0
    s_cbranch_scc1 L_wd2
    ds_read_b128 v[16:19], v2 offset:0
    ds_read_b64 v[20:21], v2 offset:16
    s_waitcnt lgkmcnt(0)
    v_readfirstlane_b32 s84, v16
    v_readfirstlane_b32 s85, v17
    v_readfirstlane_b32 s86, v18
    v_readfirstlane_b32 s87, v19
    v_readfirstlane_b32 s88, v20
    v_readfirstlane_b32 s89, v21
    v_and_b32 v3, 3, v1
    v_and_b32 v15, 7, v1
    v_lshrrev_b32 v12, 2, v1
    s_mov_b32 s37, 0x3dd53b95
    s_mov_b32 s38, 0xaaaaaaab
    s_mov_b32 s61, 0
    s_mul_i32 s35, s3, 49152
    s_add_u32 s35, s35, 2097152
    s_mov_b32 s40, 6144
    v_lshlrev_b32 v14, 5, v1
    v_lshrrev_b32 v8, 3, v1
    v_mul_u32_u24 v8, 24, v8
    v_mov_b32 v4, 768
    v_mad_u32_u24 v8, v15, v4, v8
    v_lshlrev_b32 v104, 4, v1
    s_mov_b32 s34, 9
L_prep:
    s_nop 1
    s_lshl_b32 s62, s61, 5
    s_add_u32 s62, s62, s3
    s_lshl_b32 s63, s62, 15
    s_add_u32 s63, s63, 1
    s_mul_hi_u32 s63, s63, 0xaaaaaaab
    s_lshr_b32 s63, s63, 7
    s_mov_b32 s32, s84
    s_mov_b32 s39, s87
    s_mov_b32 s84, s85
    s_mov_b32 s85, s86
    s_mov_b32 s87, s88
    s_mov_b32 s88, s89
    s_lshl_b32 s33, s61, 3
    s_add_u32 s33, s33, 1
    s_mov_b32 s60, 0x100000
L_wpf:
    s_nop 1
    ds_read_b32 v10, v2 offset:60
    s_sub_u32 s60, s60, 1
    s_cbranch_scc1 L_exit1
    s_waitcnt lgkmcnt(0)
    v_readfirstlane_b32 s48, v10
    s_cmp_lt_u32 s48, s33
    s_cbranch_scc1 L_wpf
    v_lshlrev_b32 v4, 4, v1
    s_mul_i32 s49, s4, 2736
    s_lshl_b32 s48, s62, 16
    s_mul_hi_u32 s48, s48, 0xaaaaaaab
    s_lshr_b32 s48, s48, 5
    s_lshl_b32 s48, s48, 4
    s_add_u32 s48, s48, s49
    buffer_load_dwordx4 v[80:83], v4, s[92:95], s48 offen offset:0
    buffer_load_dwordx4 v[84:87], v4, s[92:95], s48 offen offset:1024
    buffer_load_dwordx4 v[88:91], v4, s[92:95], s48 offen offset:2048
    buffer_load_dwordx4 v[92:95], v4, s[96:99], s48 offen offset:0
    buffer_load_dwordx4 v[96:99], v4, s[96:99], s48 offen offset:1024
    buffer_load_dwordx4 v[100:103], v4, s[96:99], s48 offen offset:2048
    s_and_b32 s48, s39, 7
    v_mov_b32 v9, s48
    s_bitcmp1_b32 s39, 3
    s_cselect_b64 vcc, -1, 0
    v_cndmask_b32 v9, v9, v15, vcc
    v_xor_b32 v13, s5, v9
    v_lshl_or_b32 v13, v3, 3, v13
    s_lshl_b32 s36, s62, 6
    s_mul_i32 s49, s62, 768
    s_lshl_b32 s50, s63, 2
    s_sub_u32 s49, s49, s50
    s_add_u32 s49, s49, 1179648
    s_add_u32 s33, s33, 4
    s_mov_b32 s60, 0x100000
L_wga:
    s_nop 1
    ds_read_b32 v10, v2 offset:60
    s_sub_u32 s60, s60, 1
    s_cbranch_scc1 L_exit1
    s_waitcnt lgkmcnt(0)
    v_readfirstlane_b32 s48, v10
    s_cmp_lt_u32 s48, s33
    s_cbranch_scc1 L_wga
    v_add_u32 v4, 0, v12
    v_bfe_u32 v5, v4, 3, 2
    v_and_or_b32 v5, v4, 4, v5
    v_xor_b32 v5, v13, v5
    v_add_u32 v4, s36, v4
    v_lshl_add_u32 v6, v4, 5, v5
    v_lshl_add_u32 v6, v6, 4, 1
    v_mul_hi_u32 v6, v6, s38
    v_lshrrev_b32 v6, 1, v6
    v_lshrrev_b32 v11, 1, v6
    v_lshlrev_b32 v11, 2, v11
    buffer_load_dwordx3 v[24:26], v11, s[92:95], 0 offen
    buffer_load_dword v27, v11, s[92:95], 0 offen offset:12
    buffer_load_dwordx3 v[28:30], v11, s[96:99], 0 offen
    buffer_load_dword v31, v11, s[96:99], 0 offen offset:12
    v_lshrrev_b32 v22, 6, v6
    v_lshl_add_u32 v22, v22, 2, s49
    v_and_b32 v7, 15, v6
    v_cmp_eq_u32 s[24:25], 5, v7
    v_and_b32 v23, 1, v6
    v_lshlrev_b32 v23, 4, v23
    s_waitcnt vmcnt(0)
    v_add_u32 v4, 16, v12
    v_bfe_u32 v5, v4, 3, 2
    v_and_or_b32 v5, v4, 4, v5
    v_xor_b32 v5, v13, v5
    v_add_u32 v4, s36, v4
    v_lshl_add_u32 v6, v4, 5, v5
    v_lshl_add_u32 v6, v6, 4, 1
    v_mul_hi_u32 v6, v6, s38
    v_lshrrev_b32 v6, 1, v6
    v_lshrrev_b32 v11, 1, v6
    v_lshlrev_b32 v11, 2, v11
    buffer_load_dwordx3 v[40:42], v11, s[92:95], 0 offen
    buffer_load_dword v43, v11, s[92:95], 0 offen offset:12
    buffer_load_dwordx3 v[44:46], v11, s[96:99], 0 offen
    buffer_load_dword v47, v11, s[96:99], 0 offen offset:12
    v_lshrrev_b32 v38, 6, v6
    v_lshl_add_u32 v38, v38, 2, s49
    v_and_b32 v7, 15, v6
    v_cmp_eq_u32 s[26:27], 5, v7
    v_and_b32 v39, 1, v6
    v_lshlrev_b32 v39, 4, v39
    s_waitcnt vmcnt(0)
    v_add_u32 v4, 32, v12
    v_bfe_u32 v5, v4, 3, 2
    v_and_or_b32 v5, v4, 4, v5
    v_xor_b32 v5, v13, v5
    v_add_u32 v4, s36, v4
    v_lshl_add_u32 v6, v4, 5, v5
    v_lshl_add_u32 v6, v6, 4, 1
    v_mul_hi_u32 v6, v6, s38
    v_lshrrev_b32 v6, 1, v6
    v_lshrrev_b32 v11, 1, v6
    v_lshlrev_b32 v11, 2, v11
    buffer_load_dwordx3 v[56:58], v11, s[92:95], 0 offen
    buffer_load_dword v59, v11, s[92:95], 0 offen offset:12
    buffer_load_dwordx3 v[60:62], v11, s[96:99], 0 offen
    buffer_load_dword v63, v11, s[96:99], 0 offen offset:12
    v_lshrrev_b32 v54, 6, v6
    v_lshl_add_u32 v54, v54, 2, s49
    v_and_b32 v7, 15, v6
    v_cmp_eq_u32 s[28:29], 5, v7
    v_and_b32 v55, 1, v6
    v_lshlrev_b32 v55, 4, v55
    s_waitcnt vmcnt(0)
    v_add_u32 v4, 48, v12
    v_bfe_u32 v5, v4, 3, 2
    v_and_or_b32 v5, v4, 4, v5
    v_xor_b32 v5, v13, v5
    v_add_u32 v4, s36, v4
    v_lshl_add_u32 v6, v4, 5, v5
    v_lshl_add_u32 v6, v6, 4, 1
    v_mul_hi_u32 v6, v6, s38
    v_lshrrev_b32 v6, 1, v6
    v_lshrrev_b32 v11, 1, v6
    v_lshlrev_b32 v11, 2, v11
    buffer_load_dwordx3 v[72:74], v11, s[92:95], 0 offen
    buffer_load_dword v75, v11, s[92:95], 0 offen offset:12
    buffer_load_dwordx3 v[76:78], v11, s[96:99], 0 offen
    buffer_load_dword v79, v11, s[96:99], 0 offen offset:12
    v_lshrrev_b32 v70, 6, v6
    v_lshl_add_u32 v70, v70, 2, s49
    v_and_b32 v7, 15, v6
    v_cmp_eq_u32 s[30:31], 5, v7
    v_and_b32 v71, 1, v6
    v_lshlrev_b32 v71, 4, v71
    s_waitcnt vmcnt(0)
    s_add_u32 s33, s61, 1
    s_mov_b32 s60, 0x100000
L_wfd:
    s_nop 1
    ds_read_b32 v10, v2 offset:52
    s_sub_u32 s60, s60, 1
    s_cbranch_scc1 L_exit1
    s_waitcnt lgkmcnt(0)
    v_readfirstlane_b32 s48, v10
    s_cmp_lt_u32 s48, s33
    s_cbranch_scc1 L_wfd
    v_mul_u32_u24 v4, 4352, v1
    s_xor_b32 s48, s32, s39
    s_xor_b32 s48, s48, s5
    s_and_b32 s48, s48, 7
    v_mov_b32 v6, s33
    s_lshl_b64 vcc, 1, s48
    s_or_b32 s48, s32, s39
    s_bitcmp1_b32 s48, 3
    s_cselect_b64 vcc, 0xff, vcc
    s_cmp_eq_u32 s32, s39
    s_cselect_b64 vcc, 0, vcc
    s_max_u32 s48, s61, 1
    v_mov_b32 v7, s48
    v_cndmask_b32 v6, v7, v6, vcc
    s_cmp_eq_u32 s61, 1
    s_cselect_b64 exec, vcc, 0xff
    s_mov_b32 s60, 0x40000
    s_cbranch_execz L_noflags
L_flags:
    s_nop 1
    buffer_load_dword v5, v4, s[12:15], s59 offen sc1
    s_sub_u32 s60, s60, 1
    s_cbranch_scc1 L_exit1
    s_waitcnt vmcnt(0)
    v_cmpx_gt_u32 vcc, v6, v5
    s_cbranch_execnz L_flags
L_noflags:
    s_nop 1
    s_mov_b64 exec, -1
    buffer_load_dword v22, v22, s[12:15], 0 offen sc1
    buffer_load_dword v38, v38, s[12:15], 0 offen sc1
    buffer_load_dword v54, v54, s[12:15], 0 offen sc1
    buffer_load_dword v70, v70, s[12:15], 0 offen sc1
    s_bitcmp1_b32 s39, 3
    s_cselect_b32 s49, 0, 7
    s_xor_b32 s50, s32, s39
    s_bitcmp1_b32 s50, 3
    s_cselect_b32 s51, 7, 0
    s_and_b32 s50, s50, 7
    s_and_b32 s52, s39, 7
    s_add_u32 s53, s35, 4096
    v_add_u32 v4, 0, v1
    v_mul_u32_u24 v5, 1366, v4
    v_lshrrev_b32 v5, 16, v5
    v_mul_u32_u24 v6, 48, v5
    v_sub_u32 v4, v4, v6
    v_cmp_gt_u32 vcc, s34, v4
    v_and_b32 v6, s51, v5
    v_xor_b32 v6, s50, v6
    v_and_b32 v5, s49, v5
    v_xor_b32 v5, s52, v5
    v_cndmask_b32 v6, v6, v5, vcc
    v_cmp_ne_u32 s[64:65], 0, v6
    v_xor_b32 v6, s5, v6
    v_mad_u32_u24 v6, v6, s40, v104
    s_mov_b64 exec, s[64:65]
    buffer_load_dwordx4 v[80:83], v6, s[12:15], s35 offen offset:0 sc1
    s_mov_b64 exec, -1
    v_add_u32 v4, 64, v1
    v_mul_u32_u24 v5, 1366, v4
    v_lshrrev_b32 v5, 16, v5
    v_mul_u32_u24 v6, 48, v5
    v_sub_u32 v4, v4, v6
    v_cmp_gt_u32 vcc, s34, v4
    v_and_b32 v6, s51, v5
    v_xor_b32 v6, s50, v6
    v_and_b32 v5, s49, v5
    v_xor_b32 v5, s52, v5
    v_cndmask_b32 v6, v6, v5, vcc
    v_cmp_ne_u32 s[66:67], 0, v6
    v_xor_b32 v6, s5, v6
    v_mad_u32_u24 v6, v6, s40, v104
    s_mov_b64 exec, s[66:67]
    buffer_load_dwordx4 v[84:87], v6, s[12:15], s35 offen offset:1024 sc1
    s_mov_b64 exec, -1
    v_add_u32 v4, 128, v1
    v_mul_u32_u24 v5, 1366, v4
    v_lshrrev_b32 v5, 16, v5
    v_mul_u32_u24 v6, 48, v5
    v_sub_u32 v4, v4, v6
    v_cmp_gt_u32 vcc, s34, v4
    v_and_b32 v6, s51, v5
    v_xor_b32 v6, s50, v6
    v_and_b32 v5, s49, v5
    v_xor_b32 v5, s52, v5
    v_cndmask_b32 v6, v6, v5, vcc
    v_cmp_ne_u32 s[68:69], 0, v6
    v_xor_b32 v6, s5, v6
    v_mad_u32_u24 v6, v6, s40, v104
    s_mov_b64 exec, s[68:69]
    buffer_load_dwordx4 v[88:91], v6, s[12:15], s35 offen offset:2048 sc1
    s_mov_b64 exec, -1
    v_add_u32 v4, 192, v1
    v_mul_u32_u24 v5, 1366, v4
    v_lshrrev_b32 v5, 16, v5
    v_mul_u32_u24 v6, 48, v5
    v_sub_u32 v4, v4, v6
    v_cmp_gt_u32 vcc, s34, v4
    v_and_b32 v6, s51, v5
    v_xor_b32 v6, s50, v6
    v_and_b32 v5, s49, v5
    v_xor_b32 v5, s52, v5
    v_cndmask_b32 v6, v6, v5, vcc
    v_cmp_ne_u32 s[70:71], 0, v6
    v_xor_b32 v6, s5, v6
    v_mad_u32_u24 v6, v6, s40, v104
    s_mov_b64 exec, s[70:71]
    buffer_load_dwordx4 v[92:95], v6, s[12:15], s35 offen offset:3072 sc1
    s_mov_b64 exec, -1
    v_add_u32 v4, 256, v1
    v_mul_u32_u24 v5, 1366, v4
    v_lshrrev_b32 v5, 16, v5
    v_mul_u32_u24 v6, 48, v5
    v_sub_u32 v4, v4, v6
    v_cmp_gt_u32 vcc, s34, v4
    v_and_b32 v6, s51, v5
    v_xor_b32 v6, s50, v6
    v_and_b32 v5, s49, v5
    v_xor_b32 v5, s52, v5
    v_cndmask_b32 v6, v6, v5, vcc
    v_cmp_ne_u32 s[72:73], 0, v6
    v_xor_b32 v6, s5, v6
    v_mad_u32_u24 v6, v6, s40, v104
    s_mov_b64 exec, s[72:73]
    buffer_load_dwordx4 v[96:99], v6, s[12:15], s53 offen offset:0 sc1
    s_mov_b64 exec, -1
    v_add_u32 v4, 320, v1
    v_mul_u32_u24 v5, 1366, v4
    v_lshrrev_b32 v5, 16, v5
    v_mul_u32_u24 v6, 48, v5
    v_sub_u32 v4, v4, v6
    v_cmp_gt_u32 vcc, s34, v4
    v_and_b32 v6, s51, v5
    v_xor_b32 v6, s50, v6
    v_and_b32 v5, s49, v5
    v_xor_b32 v5, s52, v5
    v_cndmask_b32 v6, v6, v5, vcc
    v_cmp_ne_u32 s[74:75], 0, v6
    v_xor_b32 v6, s5, v6
    v_mad_u32_u24 v6, v6, s40, v104
    s_mov_b64 exec, s[74:75]
    buffer_load_dwordx4 v[100:103], v6, s[12:15], s53 offen offset:1024 sc1
    s_mov_b64 exec, -1
    s_waitcnt vmcnt(0)
    s_mov_b64 exec, s[64:65]
    ds_write_b128 v104, v[80:83] offset:256
    s_mov_b64 exec, s[66:67]
    ds_write_b128 v104, v[84:87] offset:1280
    s_mov_b64 exec, s[68:69]
    ds_write_b128 v104, v[88:91] offset:2304
    s_mov_b64 exec, s[70:71]
    ds_write_b128 v104, v[92:95] offset:3328
    s_mov_b64 exec, s[72:73]
    ds_write_b128 v104, v[96:99] offset:4352
    s_mov_b64 exec, s[74:75]
    ds_write_b128 v104, v[100:103] offset:5376
    s_mov_b64 exec, -1
    ds_read_b64 v[16:17], v8 offset:256
    ds_read_b64 v[18:19], v8 offset:264
    ds_read_b64 v[20:21], v8 offset:272
    ds_read_b64 v[32:33], v8 offset:448
    ds_read_b64 v[34:35], v8 offset:456
    ds_read_b64 v[36:37], v8 offset:464
    ds_read_b64 v[48:49], v8 offset:640
    ds_read_b64 v[50:51], v8 offset:648
    ds_read_b64 v[52:53], v8 offset:656
    ds_read_b64 v[64:65], v8 offset:832
    ds_read_b64 v[66:67], v8 offset:840
    ds_read_b64 v[68:69], v8 offset:848
    s_mov_b32 s34, 0
    v_mov_b32 v5, 0xf149f2ca
    v_mov_b32 v4, 0xf149f2ca
    s_waitcnt vmcnt(0) lgkmcnt(0)
    v_sub_f32 v16, v16, v22
    v_sub_f32 v17, v17, v22
    v_sub_f32 v18, v18, v22
    v_sub_f32 v19, v19, v22
    v_sub_f32 v20, v20, v22
    v_sub_f32 v21, v21, v22
    v_mul_f32 v16, s37, v16
    v_mul_f32 v17, s37, v17
    v_mul_f32 v18, s37, v18
    v_mul_f32 v19, s37, v19
    v_mul_f32 v20, s37, v20
    v_mul_f32 v21, s37, v21
    v_cndmask_b32 v21, v5, v21, s[24:25]
    v_max3_f32 v4, v4, v16, v17
    v_max3_f32 v4, v4, v18, v19
    v_max3_f32 v4, v4, v20, v21
    v_alignbit_b32 v24, v25, v24, v23
    v_alignbit_b32 v25, v26, v25, v23
    v_alignbit_b32 v26, v27, v26, v23
    v_alignbit_b32 v28, v29, v28, v23
    v_alignbit_b32 v29, v30, v29, v23
    v_alignbit_b32 v30, v31, v30, v23
    v_sub_f32 v32, v32, v38
    v_sub_f32 v33, v33, v38
    v_sub_f32 v34, v34, v38
    v_sub_f32 v35, v35, v38
    v_sub_f32 v36, v36, v38
    v_sub_f32 v37, v37, v38
    v_mul_f32 v32, s37, v32
    v_mul_f32 v33, s37, v33
    v_mul_f32 v34, s37, v34
    v_mul_f32 v35, s37, v35
    v_mul_f32 v36, s37, v36
    v_mul_f32 v37, s37, v37
    v_cndmask_b32 v37, v5, v37, s[26:27]
    v_max3_f32 v4, v4, v32, v33
    v_max3_f32 v4, v4, v34, v35
    v_max3_f32 v4, v4, v36, v37
    v_alignbit_b32 v40, v41, v40, v39
    v_alignbit_b32 v41, v42, v41, v39
    v_alignbit_b32 v42, v43, v42, v39
    v_alignbit_b32 v44, v45, v44, v39
    v_alignbit_b32 v45, v46, v45, v39
    v_alignbit_b32 v46, v47, v46, v39
    v_sub_f32 v48, v48, v54
    v_sub_f32 v49, v49, v54
    v_sub_f32 v50, v50, v54
    v_sub_f32 v51, v51, v54
    v_sub_f32 v52, v52, v54
    v_sub_f32 v53, v53, v54
    v_mul_f32 v48, s37, v48
    v_mul_f32 v49, s37, v49
    v_mul_f32 v50, s37, v50
    v_mul_f32 v51, s37, v51
    v_mul_f32 v52, s37, v52
    v_mul_f32 v53, s37, v53
    v_cndmask_b32 v53, v5, v53, s[28:29]
    v_max3_f32 v4, v4, v48, v49
    v_max3_f32 v4, v4, v50, v51
    v_max3_f32 v4, v4, v52, v53
    v_alignbit_b32 v56, v57, v56, v55
    v_alignbit_b32 v57, v58, v57, v55
    v_alignbit_b32 v58, v59, v58, v55
    v_alignbit_b32 v60, v61, v60, v55
    v_alignbit_b32 v61, v62, v61, v55
    v_alignbit_b32 v62, v63, v62, v55
    v_sub_f32 v64, v64, v70
    v_sub_f32 v65, v65, v70
    v_sub_f32 v66, v66, v70
    v_sub_f32 v67, v67, v70
    v_sub_f32 v68, v68, v70
    v_sub_f32 v69, v69, v70
    v_mul_f32 v64, s37, v64
    v_mul_f32 v65, s37, v65
    v_mul_f32 v66, s37, v66
    v_mul_f32 v67, s37, v67
    v_mul_f32 v68, s37, v68
    v_mul_f32 v69, s37, v69
    v_cndmask_b32 v69, v5, v69, s[30:31]
    v_max3_f32 v4, v4, v64, v65
    v_max3_f32 v4, v4, v66, v67
    v_max3_f32 v4, v4, v68, v69
    v_alignbit_b32 v72, v73, v72, v71
    v_alignbit_b32 v73, v74, v73, v71
    v_alignbit_b32 v74, v75, v74, v71
    v_alignbit_b32 v76, v77, v76, v71
    v_alignbit_b32 v77, v78, v77, v71
    v_alignbit_b32 v78, v79, v78, v71
    v_max_f32_dpp v4, v4, v4 row_ror:8 row_mask:0xf bank_mask:0xf
    s_nop 1
    v_max_f32_dpp v4, v4, v4 row_ror:4 row_mask:0xf bank_mask:0xf
    s_nop 1
    v_max_f32_dpp v4, v4, v4 row_ror:2 row_mask:0xf bank_mask:0xf
    s_nop 1
    v_max_f32_dpp v4, v4, v4 row_ror:1 row_mask:0xf bank_mask:0xf
    v_mov_b32 v5, v4
    s_nop 1
    v_permlane32_swap_b32 v4, v5
    v_max_f32 v4, v4, v5
    v_mov_b32 v5, v4
    s_nop 1
    v_permlane16_swap_b32 v4, v5
    v_max_f32 v4, v4, v5
    v_mov_b32 v5, 0
    v_mov_b32 v6, 0
    v_sub_f32 v16, v16, v4
    v_sub_f32 v17, v17, v4
    v_sub_f32 v18, v18, v4
    v_sub_f32 v19, v19, v4
    v_sub_f32 v20, v20, v4
    v_sub_f32 v21, v21, v4
    v_exp_f32 v16, v16
    v_exp_f32 v17, v17
    v_exp_f32 v18, v18
    v_exp_f32 v19, v19
    v_exp_f32 v20, v20
    v_exp_f32 v21, v21
    v_add_f32 v5, v5, v16
    v_lshlrev_b32 v10, 16, v24
    v_lshlrev_b32 v11, 16, v28
    v_mul_f32 v16, v16, v10
    v_fmac_f32 v6, v16, v11
    v_add_f32 v5, v5, v17
    v_and_b32 v10, 0xffff0000, v24
    v_and_b32 v11, 0xffff0000, v28
    v_mul_f32 v17, v17, v10
    v_fmac_f32 v6, v17, v11
    v_add_f32 v5, v5, v18
    v_lshlrev_b32 v10, 16, v25
    v_lshlrev_b32 v11, 16, v29
    v_mul_f32 v18, v18, v10
    v_fmac_f32 v6, v18, v11
    v_add_f32 v5, v5, v19
    v_and_b32 v10, 0xffff0000, v25
    v_and_b32 v11, 0xffff0000, v29
    v_mul_f32 v19, v19, v10
    v_fmac_f32 v6, v19, v11
    v_add_f32 v5, v5, v20
    v_lshlrev_b32 v10, 16, v26
    v_lshlrev_b32 v11, 16, v30
    v_mul_f32 v20, v20, v10
    v_fmac_f32 v6, v20, v11
    v_add_f32 v5, v5, v21
    v_and_b32 v10, 0xffff0000, v26
    v_and_b32 v11, 0xffff0000, v30
    v_mul_f32 v21, v21, v10
    v_fmac_f32 v6, v21, v11
    ds_write_b128 v14, v[16:19] offset:18688
    ds_write_b64 v14, v[20:21] offset:18704
    v_sub_f32 v32, v32, v4
    v_sub_f32 v33, v33, v4
    v_sub_f32 v34, v34, v4
    v_sub_f32 v35, v35, v4
    v_sub_f32 v36, v36, v4
    v_sub_f32 v37, v37, v4
    v_exp_f32 v32, v32
    v_exp_f32 v33, v33
    v_exp_f32 v34, v34
    v_exp_f32 v35, v35
    v_exp_f32 v36, v36
    v_exp_f32 v37, v37
    v_add_f32 v5, v5, v32
    v_lshlrev_b32 v10, 16, v40
    v_lshlrev_b32 v11, 16, v44
    v_mul_f32 v32, v32, v10
    v_fmac_f32 v6, v32, v11
    v_add_f32 v5, v5, v33
    v_and_b32 v10, 0xffff0000, v40
    v_and_b32 v11, 0xffff0000, v44
    v_mul_f32 v33, v33, v10
    v_fmac_f32 v6, v33, v11
    v_add_f32 v5, v5, v34
    v_lshlrev_b32 v10, 16, v41
    v_lshlrev_b32 v11, 16, v45
    v_mul_f32 v34, v34, v10
    v_fmac_f32 v6, v34, v11
    v_add_f32 v5, v5, v35
    v_and_b32 v10, 0xffff0000, v41
    v_and_b32 v11, 0xffff0000, v45
    v_mul_f32 v35, v35, v10
    v_fmac_f32 v6, v35, v11
    v_add_f32 v5, v5, v36
    v_lshlrev_b32 v10, 16, v42
    v_lshlrev_b32 v11, 16, v46
    v_mul_f32 v36, v36, v10
    v_fmac_f32 v6, v36, v11
    v_add_f32 v5, v5, v37
    v_and_b32 v10, 0xffff0000, v42
    v_and_b32 v11, 0xffff0000, v46
    v_mul_f32 v37, v37, v10
    v_fmac_f32 v6, v37, v11
    ds_write_b128 v14, v[32:35] offset:20736
    ds_write_b64 v14, v[36:37] offset:20752
    v_sub_f32 v48, v48, v4
    v_sub_f32 v49, v49, v4
    v_sub_f32 v50, v50, v4
    v_sub_f32 v51, v51, v4
    v_sub_f32 v52, v52, v4
    v_sub_f32 v53, v53, v4
    v_exp_f32 v48, v48
    v_exp_f32 v49, v49
    v_exp_f32 v50, v50
    v_exp_f32 v51, v51
    v_exp_f32 v52, v52
    v_exp_f32 v53, v53
    v_add_f32 v5, v5, v48
    v_lshlrev_b32 v10, 16, v56
    v_lshlrev_b32 v11, 16, v60
    v_mul_f32 v48, v48, v10
    v_fmac_f32 v6, v48, v11
    v_add_f32 v5, v5, v49
    v_and_b32 v10, 0xffff0000, v56
    v_and_b32 v11, 0xffff0000, v60
    v_mul_f32 v49, v49, v10
    v_fmac_f32 v6, v49, v11
    v_add_f32 v5, v5, v50
    v_lshlrev_b32 v10, 16, v57
    v_lshlrev_b32 v11, 16, v61
    v_mul_f32 v50, v50, v10
    v_fmac_f32 v6, v50, v11
    v_add_f32 v5, v5, v51
    v_and_b32 v10, 0xffff0000, v57
    v_and_b32 v11, 0xffff0000, v61
    v_mul_f32 v51, v51, v10
    v_fmac_f32 v6, v51, v11
    v_add_f32 v5, v5, v52
    v_lshlrev_b32 v10, 16, v58
    v_lshlrev_b32 v11, 16, v62
    v_mul_f32 v52, v52, v10
    v_fmac_f32 v6, v52, v11
    v_add_f32 v5, v5, v53
    v_and_b32 v10, 0xffff0000, v58
    v_and_b32 v11, 0xffff0000, v62
    v_mul_f32 v53, v53, v10
    v_fmac_f32 v6, v53, v11
    ds_write_b128 v14, v[48:51] offset:22784
    ds_write_b64 v14, v[52:53] offset:22800
    v_sub_f32 v64, v64, v4
    v_sub_f32 v65, v65, v4
    v_sub_f32 v66, v66, v4
    v_sub_f32 v67, v67, v4
    v_sub_f32 v68, v68, v4
    v_sub_f32 v69, v69, v4
    v_exp_f32 v64, v64
    v_exp_f32 v65, v65
    v_exp_f32 v66, v66
    v_exp_f32 v67, v67
    v_exp_f32 v68, v68
    v_exp_f32 v69, v69
    v_add_f32 v5, v5, v64
    v_lshlrev_b32 v10, 16, v72
    v_lshlrev_b32 v11, 16, v76
    v_mul_f32 v64, v64, v10
    v_fmac_f32 v6, v64, v11
    v_add_f32 v5, v5, v65
    v_and_b32 v10, 0xffff0000, v72
    v_and_b32 v11, 0xffff0000, v76
    v_mul_f32 v65, v65, v10
    v_fmac_f32 v6, v65, v11
    v_add_f32 v5, v5, v66
    v_lshlrev_b32 v10, 16, v73
    v_lshlrev_b32 v11, 16, v77
    v_mul_f32 v66, v66, v10
    v_fmac_f32 v6, v66, v11
    v_add_f32 v5, v5, v67
    v_and_b32 v10, 0xffff0000, v73
    v_and_b32 v11, 0xffff0000, v77
    v_mul_f32 v67, v67, v10
    v_fmac_f32 v6, v67, v11
    v_add_f32 v5, v5, v68
    v_lshlrev_b32 v10, 16, v74
    v_lshlrev_b32 v11, 16, v78
    v_mul_f32 v68, v68, v10
    v_fmac_f32 v6, v68, v11
    v_add_f32 v5, v5, v69
    v_and_b32 v10, 0xffff0000, v74
    v_and_b32 v11, 0xffff0000, v78
    v_mul_f32 v69, v69, v10
    v_fmac_f32 v6, v69, v11
    ds_write_b128 v14, v[64:67] offset:24832
    ds_write_b64 v14, v[68:69] offset:24848
    v_add_f32_dpp v5, v5, v5 row_ror:8 row_mask:0xf bank_mask:0xf
    v_add_f32_dpp v6, v6, v6 row_ror:8 row_mask:0xf bank_mask:0xf
    s_nop 0
    v_add_f32_dpp v5, v5, v5 row_ror:4 row_mask:0xf bank_mask:0xf
    v_add_f32_dpp v6, v6, v6 row_ror:4 row_mask:0xf bank_mask:0xf
    s_nop 0
    v_add_f32_dpp v5, v5, v5 row_ror:2 row_mask:0xf bank_mask:0xf
    v_add_f32_dpp v6, v6, v6 row_ror:2 row_mask:0xf bank_mask:0xf
    s_nop 0
    v_add_f32_dpp v5, v5, v5 row_ror:1 row_mask:0xf bank_mask:0xf
    v_add_f32_dpp v6, v6, v6 row_ror:1 row_mask:0xf bank_mask:0xf
    v_mov_b32 v10, v5
    v_mov_b32 v11, v6
    s_nop 0
    v_permlane32_swap_b32 v5, v10
    v_permlane32_swap_b32 v6, v11
    v_add_f32 v5, v5, v10
    v_add_f32 v6, v6, v11
    v_mov_b32 v10, v5
    v_mov_b32 v11, v6
    s_nop 0
    v_permlane16_swap_b32 v5, v10
    v_permlane16_swap_b32 v6, v11
    v_add_f32 v5, v5, v10
    v_add_f32 v6, v6, v11
    s_lshl_b32 s48, s61, 2
    v_mov_b32 v10, s48
    v_lshlrev_b32 v11, 2, v10
    v_mov_b32 v7, s39
    s_mov_b64 exec, 1
    ds_write_b128 v11, v[4:7] offset:80
    ds_write_b32 v10, v7 offset:24
    s_lshl_b32 s48, s61, 8
    s_add_u32 s48, s48, s2
    s_lshl_b32 s48, s48, 6
    s_add_u32 s48, s48, 917504
    buffer_store_dwordx4 v[4:7], off, s[12:15], s48 sc1
    s_mov_b64 exec, -1
    v_add_u32 v14, 8192, v14
    v_add_u32 v8, 6144, v8
    v_add_u32 v104, 6144, v104
    s_add_u32 s35, s35, 1566720
    s_add_u32 s61, s61, 1
    s_cmp_lt_u32 s61, 3
    s_cbranch_scc1 L_prep
    s_mov_b32 s61, 0
    v_lshlrev_b32 v12, 2, v1
    v_add_u32 v13, 43264, v12
    v_lshlrev_b32 v8, 4, v1
    v_mov_b32 v31, 1
L_merge:
    s_nop 1
    s_lshl_b32 s48, s61, 2
    v_mov_b32 v3, s48
    v_lshlrev_b32 v11, 2, v3
    ds_read_b128 v[4:7], v11 offset:80
    s_lshl_b32 s62, s61, 8
    s_add_u32 s62, s62, s2
    s_lshl_b32 s62, s62, 10
    s_mov_b32 s60, 0x100000
L_wm:
    s_nop 1
    ds_read_b32 v10, v3 offset:64
    s_sub_u32 s60, s60, 1
    s_cbranch_scc1 L_exit1
    s_waitcnt lgkmcnt(0)
    v_readfirstlane_b32 s48, v10
    s_cmp_lt_u32 s48, 4
    s_cbranch_scc1 L_wm
    ds_read_b32 v16, v13 offset:0
    ds_read_b32 v17, v13 offset:768
    ds_read_b32 v18, v13 offset:1536
    ds_read_b32 v19, v13 offset:2304
    ds_read_b32 v20, v13 offset:256
    ds_read_b32 v21, v13 offset:1024
    ds_read_b32 v22, v13 offset:1792
    ds_read_b32 v23, v13 offset:2560
    ds_read_b32 v24, v13 offset:512
    ds_read_b32 v25, v13 offset:1280
    ds_read_b32 v26, v13 offset:2048
    ds_read_b32 v27, v13 offset:2816
    s_waitcnt lgkmcnt(8)
    v_add_f32 v16, v16, v17
    v_add_f32 v18, v18, v19
    v_sub_f32 v16, v16, v6
    v_add_f32 v28, v16, v18
    s_waitcnt lgkmcnt(4)
    v_add_f32 v20, v20, v21
    v_add_f32 v22, v22, v23
    v_sub_f32 v20, v20, v6
    v_add_f32 v29, v20, v22
    s_waitcnt lgkmcnt(0)
    v_add_f32 v24, v24, v25
    v_add_f32 v26, v26, v27
    v_sub_f32 v24, v24, v6
    v_add_f32 v30, v24, v26
    buffer_store_dwordx4 v[28:31], v8, s[12:15], s62 offen sc1
    v_add_u32 v13, 3072, v13
    s_add_u32 s61, s61, 1
    s_cmp_lt_u32 s61, 3
    s_cbranch_scc1 L_merge
    s_endpgm
.section .rodata,"a"
.p2align 6
.amdhsa_kernel standalone__kv_cache_quant_int4_int2_kv_with_per_channel_or_per_token_scales__decode_kernel
  .amdhsa_next_free_vgpr 136
  .amdhsa_next_free_sgpr 102
  .amdhsa_accum_offset 136
  .amdhsa_group_segment_fixed_size 0
  .amdhsa_kernarg_size 80
  .amdhsa_user_sgpr_count 2
  .amdhsa_user_sgpr_kernarg_segment_ptr 1
  .amdhsa_system_sgpr_workgroup_id_x 1
.end_amdhsa_kernel
```

```asm
; @launch kernel=standalone__kv_cache_quant_int4_int2_kv_with_per_channel_or_per_token_scales__decode_kernel grid=(256,1,1) block=(512,1,1) lds=52480
.amdgcn_target "amdgcn-amd-amdhsa--gfx950"
.text
.globl standalone__kv_cache_quant_int4_int2_kv_with_per_channel_or_per_token_scales__decode_kernel
.p2align 8
.type standalone__kv_cache_quant_int4_int2_kv_with_per_channel_or_per_token_scales__decode_kernel,@function
standalone__kv_cache_quant_int4_int2_kv_with_per_channel_or_per_token_scales__decode_kernel:
    s_cmp_ge_u32 s2, 256
    s_cbranch_scc1 L_exit1
    s_load_dwordx16 s[64:79], s[0:1], 0
    s_load_dwordx4 s[80:83], s[0:1], 64
    v_lshrrev_b32 v10, 6, v0
    v_and_b32 v11, 63, v0
    v_readfirstlane_b32 s28, v10
    s_lshr_b32 s3, s2, 3
    s_and_b32 s4, s2, 7
    s_lshr_b32 s32, s2, 6
    s_xor_b32 s32, s32, s4
    s_lshr_b32 s48, s32, 1
    s_and_b32 s32, s32, 1
    s_lshl_b32 s32, s32, 2
    s_or_b32 s48, s48, s32
    s_cmp_ge_u32 s28, 4
    s_cbranch_scc1 L_helper
    v_lshrrev_b32 v1, 4, v11
    v_and_b32 v52, 15, v11
    v_lshlrev_b32 v2, 4, v52
    v_lshlrev_b32 v3, 3, v52
    v_lshlrev_b32 v62, 7, v1
    v_and_b32 v63, 0x70, v0
    v_or_b32 v63, v63, v62
    v_mov_b32 v50, v63
    s_mov_b32 s45, 768
    s_mov_b32 s46, 384
    s_mov_b32 s47, 0xaaaaaaab
    v_mov_b32 v51, 0xc0000000
    s_lshl_b32 s44, s3, 6
    s_mov_b32 s5, s48
    s_mov_b32 s29, s28
    s_lshr_b32 s33, s29, 6
    s_lshl_b32 s33, s33, 11
    s_and_b32 s32, s29, 63
    s_add_u32 s32, s32, s33
    s_add_u32 s32, s32, s44
    s_bfe_u32 s33, s32, 0x20003
    s_and_b32 s34, s32, 4
    s_or_b32 s33, s33, s34
    s_xor_b32 s33, s33, s5
    s_lshl_b32 s50, s32, 5
    s_or_b32 s50, s50, s33
    s_lshl_b32 s50, s50, 4
    s_or_b32 s50, s50, 1
    v_xor_b32 v10, s50, v50
    v_mul_hi_u32 v10, v10, s47
    v_lshrrev_b32 v10, 1, v10
    v_and_b32 v11, 15, v10
    v_cmp_eq_u32 vcc, 5, v11
    v_mad_u32_u24 v48, v10, s45, v2
    v_add_u32 v11, 3840, v48
    v_cndmask_b32 v49, v51, v11, vcc
    v_lshrrev_b32 v10, 6, v10
    v_mad_u32_u24 v9, v10, s46, v3
    s_waitcnt lgkmcnt(0)
    s_mov_b32 s30, 0
    s_mov_b32 s8, s66
    s_and_b32 s9, s67, 0xffff
    s_mov_b32 s10, 805306368
    s_mov_b32 s11, 0x00020000
    buffer_load_dwordx4 v[64:67], v48, s[8:11], 0 offen offset:0 nt
    buffer_load_dwordx4 v[68:71], v48, s[8:11], 0 offen offset:256 nt
    buffer_load_dwordx4 v[72:75], v48, s[8:11], 0 offen offset:512 nt
    buffer_load_dwordx4 v[76:79], v48, s[8:11], 0 offen offset:768 nt
    buffer_load_dwordx4 v[80:83], v48, s[8:11], 0 offen offset:1024 nt
    buffer_load_dwordx4 v[84:87], v48, s[8:11], 0 offen offset:1280 nt
    s_mov_b32 s20, s64
    s_and_b32 s21, s65, 0xffff
    s_mov_b32 s22, 12288
    s_mov_b32 s23, 0x00020000
    s_lshl_b32 s31, s30, 5
    s_add_u32 s31, s31, s3
    s_mul_i32 s31, s31, 171
    s_lshr_b32 s31, s31, 9
    s_mul_i32 s31, s31, 384
    buffer_load_dwordx2 v[36:37], v3, s[20:23], s31 offen offset:0
    buffer_load_dwordx2 v[38:39], v3, s[20:23], s31 offen offset:128
    buffer_load_dwordx2 v[40:41], v3, s[20:23], s31 offen offset:256
    s_mov_b32 s16, s70
    s_and_b32 s17, s71, 0xffff
    s_mov_b32 s18, 6291456
    s_mov_b32 s19, 0x00020000
    buffer_load_dwordx2 v[42:43], v9, s[16:19], 0 offen offset:0
    buffer_load_dwordx2 v[44:45], v9, s[16:19], 0 offen offset:128
    buffer_load_dwordx2 v[46:47], v9, s[16:19], 0 offen offset:256
    buffer_load_dwordx4 v[88:91], v48, s[8:11], 0 offen offset:1536 nt
    buffer_load_dwordx4 v[92:95], v48, s[8:11], 0 offen offset:1792 nt
    buffer_load_dwordx4 v[96:99], v48, s[8:11], 0 offen offset:2048 nt
    buffer_load_dwordx4 v[100:103], v48, s[8:11], 0 offen offset:2304 nt
    buffer_load_dwordx4 v[104:107], v48, s[8:11], 0 offen offset:2560 nt
    buffer_load_dwordx4 v[108:111], v48, s[8:11], 0 offen offset:2816 nt
    buffer_load_dwordx4 v[112:115], v48, s[8:11], 0 offen offset:3072 nt
    buffer_load_dwordx4 v[116:119], v48, s[8:11], 0 offen offset:3328 nt
    buffer_load_dwordx4 v[120:123], v48, s[8:11], 0 offen offset:3584 nt
    buffer_load_dwordx4 v[124:127], v49, s[8:11], 0 offen offset:0 nt
    buffer_load_dwordx4 v[128:131], v49, s[8:11], 0 offen offset:256 nt
    buffer_load_dwordx4 v[132:135], v49, s[8:11], 0 offen offset:512 nt
    s_mov_b32 s12, s68
    s_and_b32 s13, s69, 0xffff
    s_mov_b32 s14, 805306368
    s_mov_b32 s15, 0x00020000
    v_lshlrev_b32 v11, 5, v1
    v_bfe_u32 v4, v0, 4, 3
    v_mul_u32_u24 v4, s45, v4
    v_lshl_add_u32 v4, v52, 1, v4
    s_lshr_b32 s32, s28, 1
    s_mul_i32 s32, s32, 24
    s_add_u32 s32, s32, 256
    v_add_u32 v4, s32, v4
    v_and_b32 v5, 7, v52
    v_lshl_add_u32 v5, v5, 2, v11
    v_add_u32 v5, 18688, v5
    v_lshlrev_b32 v8, 2, v1
    v_add_u32 v8, v2, v8
    s_mul_i32 s32, s28, 768
    s_add_u32 s32, s32, 43264
    v_add_u32 v8, s32, v8
    v_mov_b32 v53, 0
    v_mov_b32 v60, 0
    v_mov_b32 v61, 0
    s_mov_b32 s42, 0x01110111
    s_mov_b32 s43, 0x01110111
    s_mov_b32 s40, 0xea2bea0c
    s_mov_b32 s41, 0xea2b
    s_mov_b32 s64, 0x2020200
    s_mov_b32 s65, 0x202
    s_mov_b32 s66, 0x8080800
    s_mov_b32 s67, 0x808
    s_mov_b32 s68, 0x20202000
    s_mov_b32 s69, 0x2020
    s_mov_b32 s70, 0xc003c00c
    s_mov_b32 s71, 0xc003
    s_mov_b32 s59, 0
    s_mov_b32 s63, 0
    s_mov_b32 s7, 0
    s_mov_b32 s62, 144
    v_mov_b32 v12, 0
    v_mov_b32 v13, 0
    v_mov_b32 v14, 0
    v_mov_b32 v15, 0
    v_mov_b32 v16, 0
    v_mov_b32 v17, 0
    v_mov_b32 v18, 0
    v_mov_b32 v19, 0
    v_mov_b32 v20, 0
    v_mov_b32 v21, 0
    v_mov_b32 v22, 0
    v_mov_b32 v23, 0
    s_barrier
    s_waitcnt vmcnt(12)
    v_lshlrev_b32 v10, 16, v36
    v_lshlrev_b32 v24, 16, v42
    v_and_b32 v11, 0xffff0000, v36
    v_and_b32 v25, 0xffff0000, v42
    v_mul_f32 v24, v24, v10
    v_mul_f32 v25, v25, v11
    v_lshlrev_b32 v10, 16, v37
    v_lshlrev_b32 v26, 16, v43
    v_and_b32 v11, 0xffff0000, v37
    v_and_b32 v27, 0xffff0000, v43
    v_mul_f32 v26, v26, v10
    v_mul_f32 v27, v27, v11
    v_lshlrev_b32 v10, 16, v38
    v_lshlrev_b32 v28, 16, v44
    v_and_b32 v11, 0xffff0000, v38
    v_and_b32 v29, 0xffff0000, v44
    v_mul_f32 v28, v28, v10
    v_mul_f32 v29, v29, v11
    v_lshlrev_b32 v10, 16, v39
    v_lshlrev_b32 v30, 16, v45
    v_and_b32 v11, 0xffff0000, v39
    v_and_b32 v31, 0xffff0000, v45
    v_mul_f32 v30, v30, v10
    v_mul_f32 v31, v31, v11
    v_lshlrev_b32 v10, 16, v40
    v_lshlrev_b32 v32, 16, v46
    v_and_b32 v11, 0xffff0000, v40
    v_and_b32 v33, 0xffff0000, v46
    v_mul_f32 v32, v32, v10
    v_mul_f32 v33, v33, v11
    v_lshlrev_b32 v10, 16, v41
    v_lshlrev_b32 v34, 16, v47
    v_and_b32 v11, 0xffff0000, v41
    v_and_b32 v35, 0xffff0000, v47
    v_mul_f32 v34, v34, v10
    v_mul_f32 v35, v35, v11
    v_cvt_f32_i32 v64, v64
    v_cvt_f32_i32 v65, v65
    v_cvt_f32_i32 v66, v66
    v_cvt_f32_i32 v67, v67
    v_mul_f32 v54, v64, v24
    v_fmac_f32 v54, v65, v25
    v_fmac_f32 v54, v66, v26
    v_fmac_f32 v54, v67, v27
    v_cvt_f32_i32 v68, v68
    v_cvt_f32_i32 v69, v69
    v_cvt_f32_i32 v70, v70
    v_cvt_f32_i32 v71, v71
    v_fmac_f32 v54, v68, v28
    v_fmac_f32 v54, v69, v29
    v_fmac_f32 v54, v70, v30
    v_fmac_f32 v54, v71, v31
    v_cvt_f32_i32 v72, v72
    v_cvt_f32_i32 v73, v73
    v_cvt_f32_i32 v74, v74
    v_cvt_f32_i32 v75, v75
    v_fmac_f32 v54, v72, v32
    v_fmac_f32 v54, v73, v33
    v_fmac_f32 v54, v74, v34
    v_fmac_f32 v54, v75, v35
    v_cvt_f32_i32 v76, v76
    v_cvt_f32_i32 v77, v77
    v_add_f32_dpp v54, v54, v54 row_ror:8 row_mask:0xf bank_mask:0xf
    v_cvt_f32_i32 v78, v78
    v_cvt_f32_i32 v79, v79
    v_add_f32_dpp v54, v54, v54 row_ror:4 row_mask:0xf bank_mask:0xf
    v_mul_f32 v55, v76, v24
    v_fmac_f32 v55, v77, v25
    v_add_f32_dpp v54, v54, v54 row_ror:2 row_mask:0xf bank_mask:0xf
    v_fmac_f32 v55, v78, v26
    v_fmac_f32 v55, v79, v27
    v_add_f32_dpp v60, v54, v54 row_ror:1 row_mask:0xf bank_mask:0x1
    v_cvt_f32_i32 v80, v80
    v_cvt_f32_i32 v81, v81
    v_cvt_f32_i32 v82, v82
    v_cvt_f32_i32 v83, v83
    v_fmac_f32 v55, v80, v28
    v_fmac_f32 v55, v81, v29
    v_fmac_f32 v55, v82, v30
    v_fmac_f32 v55, v83, v31
    v_cvt_f32_i32 v84, v84
    v_cvt_f32_i32 v85, v85
    v_cvt_f32_i32 v86, v86
    v_cvt_f32_i32 v87, v87
    v_fmac_f32 v55, v84, v32
    v_fmac_f32 v55, v85, v33
    v_fmac_f32 v55, v86, v34
    v_fmac_f32 v55, v87, v35
    s_nop 1
    v_add_f32_dpp v55, v55, v55 row_ror:8 row_mask:0xf bank_mask:0xf
    s_nop 1
    v_add_f32_dpp v55, v55, v55 row_ror:4 row_mask:0xf bank_mask:0xf
    s_nop 1
    v_add_f32_dpp v55, v55, v55 row_ror:2 row_mask:0xf bank_mask:0xf
    s_nop 1
    v_add_f32_dpp v61, v55, v55 row_ror:1 row_mask:0xf bank_mask:0x1
    s_waitcnt vmcnt(6)
    s_add_u32 s29, s29, 4
    s_add_u32 s30, s30, 1
    s_lshr_b32 s33, s29, 6
    s_lshl_b32 s33, s33, 11
    s_and_b32 s32, s29, 63
    s_add_u32 s32, s32, s33
    s_add_u32 s32, s32, s44
    s_bfe_u32 s33, s32, 0x20003
    s_and_b32 s34, s32, 4
    s_or_b32 s33, s33, s34
    s_xor_b32 s33, s33, s5
    s_lshl_b32 s50, s32, 5
    s_or_b32 s50, s50, s33
    s_lshl_b32 s50, s50, 4
    s_or_b32 s50, s50, 1
    v_xor_b32 v10, s50, v50
    v_mul_hi_u32 v10, v10, s47
    v_lshrrev_b32 v10, 1, v10
    v_and_b32 v11, 15, v10
    v_cmp_eq_u32 vcc, 5, v11
    v_mad_u32_u24 v48, v10, s45, v2
    v_add_u32 v11, 3840, v48
    v_cndmask_b32 v49, v51, v11, vcc
    v_lshrrev_b32 v10, 6, v10
    v_mad_u32_u24 v9, v10, s46, v3
    buffer_load_dwordx2 v[42:43], v9, s[16:19], 0 offen offset:0
    buffer_load_dwordx2 v[44:45], v9, s[16:19], 0 offen offset:128
    buffer_load_dwordx2 v[46:47], v9, s[16:19], 0 offen offset:256
    v_cvt_f32_i32 v88, v88
    v_cvt_f32_i32 v89, v89
    v_cvt_f32_i32 v90, v90
    v_cvt_f32_i32 v91, v91
    v_mul_f32 v56, v88, v24
    v_fmac_f32 v56, v89, v25
    v_fmac_f32 v56, v90, v26
    v_fmac_f32 v56, v91, v27
    v_cvt_f32_i32 v92, v92
    v_cvt_f32_i32 v93, v93
    v_cvt_f32_i32 v94, v94
    v_cvt_f32_i32 v95, v95
    v_fmac_f32 v56, v92, v28
    v_fmac_f32 v56, v93, v29
    v_fmac_f32 v56, v94, v30
    v_fmac_f32 v56, v95, v31
    v_cvt_f32_i32 v96, v96
    v_cvt_f32_i32 v97, v97
    v_cvt_f32_i32 v98, v98
    v_cvt_f32_i32 v99, v99
    v_fmac_f32 v56, v96, v32
    v_fmac_f32 v56, v97, v33
    v_fmac_f32 v56, v98, v34
    v_fmac_f32 v56, v99, v35
    v_cvt_f32_i32 v100, v100
    v_cvt_f32_i32 v101, v101
    v_add_f32_dpp v56, v56, v56 row_ror:8 row_mask:0xf bank_mask:0xf
    v_cvt_f32_i32 v102, v102
    v_cvt_f32_i32 v103, v103
    v_add_f32_dpp v56, v56, v56 row_ror:4 row_mask:0xf bank_mask:0xf
    v_mul_f32 v57, v100, v24
    v_fmac_f32 v57, v101, v25
    v_add_f32_dpp v56, v56, v56 row_ror:2 row_mask:0xf bank_mask:0xf
    v_fmac_f32 v57, v102, v26
    v_fmac_f32 v57, v103, v27
    v_add_f32_dpp v60, v56, v56 row_ror:1 row_mask:0xf bank_mask:0x2
    v_cvt_f32_i32 v104, v104
    v_cvt_f32_i32 v105, v105
    v_cvt_f32_i32 v106, v106
    v_cvt_f32_i32 v107, v107
    v_fmac_f32 v57, v104, v28
    v_fmac_f32 v57, v105, v29
    v_fmac_f32 v57, v106, v30
    v_fmac_f32 v57, v107, v31
    v_cvt_f32_i32 v108, v108
    v_cvt_f32_i32 v109, v109
    v_cvt_f32_i32 v110, v110
    v_cvt_f32_i32 v111, v111
    v_fmac_f32 v57, v108, v32
    v_fmac_f32 v57, v109, v33
    v_fmac_f32 v57, v110, v34
    v_fmac_f32 v57, v111, v35
    s_nop 1
    v_add_f32_dpp v57, v57, v57 row_ror:8 row_mask:0xf bank_mask:0xf
    s_nop 1
    v_add_f32_dpp v57, v57, v57 row_ror:4 row_mask:0xf bank_mask:0xf
    s_nop 1
    v_add_f32_dpp v57, v57, v57 row_ror:2 row_mask:0xf bank_mask:0xf
    s_nop 1
    v_add_f32_dpp v61, v57, v57 row_ror:1 row_mask:0xf bank_mask:0x2
    s_waitcnt vmcnt(3)
    buffer_load_dwordx4 v[64:67], v48, s[8:11], 0 offen offset:0 nt
    buffer_load_dwordx4 v[68:71], v48, s[8:11], 0 offen offset:256 nt
    buffer_load_dwordx4 v[72:75], v48, s[8:11], 0 offen offset:512 nt
    buffer_load_dwordx4 v[76:79], v48, s[8:11], 0 offen offset:768 nt
    buffer_load_dwordx4 v[80:83], v48, s[8:11], 0 offen offset:1024 nt
    buffer_load_dwordx4 v[84:87], v48, s[8:11], 0 offen offset:1280 nt
    v_cvt_f32_i32 v112, v112
    v_cvt_f32_i32 v113, v113
    v_cvt_f32_i32 v114, v114
    v_cvt_f32_i32 v115, v115
    v_mul_f32 v58, v112, v24
    v_fmac_f32 v58, v113, v25
    v_fmac_f32 v58, v114, v26
    v_fmac_f32 v58, v115, v27
    v_cvt_f32_i32 v116, v116
    v_cvt_f32_i32 v117, v117
    v_cvt_f32_i32 v118, v118
    v_cvt_f32_i32 v119, v119
    v_fmac_f32 v58, v116, v28
    v_fmac_f32 v58, v117, v29
    v_fmac_f32 v58, v118, v30
    v_fmac_f32 v58, v119, v31
    v_cvt_f32_i32 v120, v120
    v_cvt_f32_i32 v121, v121
    v_cvt_f32_i32 v122, v122
    v_cvt_f32_i32 v123, v123
    v_fmac_f32 v58, v120, v32
    v_fmac_f32 v58, v121, v33
    v_fmac_f32 v58, v122, v34
    v_fmac_f32 v58, v123, v35
    v_cvt_f32_i32 v124, v124
    v_cvt_f32_i32 v125, v125
    v_add_f32_dpp v58, v58, v58 row_ror:8 row_mask:0xf bank_mask:0xf
    v_cvt_f32_i32 v126, v126
    v_cvt_f32_i32 v127, v127
    v_add_f32_dpp v58, v58, v58 row_ror:4 row_mask:0xf bank_mask:0xf
    v_mul_f32 v59, v124, v24
    v_fmac_f32 v59, v125, v25
    v_add_f32_dpp v58, v58, v58 row_ror:2 row_mask:0xf bank_mask:0xf
    v_fmac_f32 v59, v126, v26
    v_fmac_f32 v59, v127, v27
    v_add_f32_dpp v60, v58, v58 row_ror:1 row_mask:0xf bank_mask:0x4
    v_cvt_f32_i32 v128, v128
    v_cvt_f32_i32 v129, v129
    v_cvt_f32_i32 v130, v130
    v_cvt_f32_i32 v131, v131
    v_fmac_f32 v59, v128, v28
    v_fmac_f32 v59, v129, v29
    v_fmac_f32 v59, v130, v30
    v_fmac_f32 v59, v131, v31
    v_cvt_f32_i32 v132, v132
    v_cvt_f32_i32 v133, v133
    v_cvt_f32_i32 v134, v134
    v_cvt_f32_i32 v135, v135
    v_fmac_f32 v59, v132, v32
    v_fmac_f32 v59, v133, v33
    v_fmac_f32 v59, v134, v34
    v_fmac_f32 v59, v135, v35
    s_nop 1
    v_add_f32_dpp v59, v59, v59 row_ror:8 row_mask:0xf bank_mask:0xf
    s_nop 1
    v_add_f32_dpp v59, v59, v59 row_ror:4 row_mask:0xf bank_mask:0xf
    s_nop 1
    v_add_f32_dpp v59, v59, v59 row_ror:2 row_mask:0xf bank_mask:0xf
    s_nop 1
    v_add_f32_dpp v61, v59, v59 row_ror:1 row_mask:0xf bank_mask:0x4
    s_mov_b64 exec, s[42:43]
    ds_write_b64 v4, v[60:61]
    s_mov_b64 exec, -1
    v_add_u32 v4, 48, v4
    s_waitcnt vmcnt(6)
    v_lshlrev_b32 v10, 16, v36
    v_lshlrev_b32 v24, 16, v42
    v_and_b32 v11, 0xffff0000, v36
    v_and_b32 v25, 0xffff0000, v42
    v_mul_f32 v24, v24, v10
    v_mul_f32 v25, v25, v11
    v_lshlrev_b32 v10, 16, v37
    v_lshlrev_b32 v26, 16, v43
    v_and_b32 v11, 0xffff0000, v37
    v_and_b32 v27, 0xffff0000, v43
    v_mul_f32 v26, v26, v10
    v_mul_f32 v27, v27, v11
    v_lshlrev_b32 v10, 16, v38
    v_lshlrev_b32 v28, 16, v44
    v_and_b32 v11, 0xffff0000, v38
    v_and_b32 v29, 0xffff0000, v44
    v_mul_f32 v28, v28, v10
    v_mul_f32 v29, v29, v11
    v_lshlrev_b32 v10, 16, v39
    v_lshlrev_b32 v30, 16, v45
    v_and_b32 v11, 0xffff0000, v39
    v_and_b32 v31, 0xffff0000, v45
    v_mul_f32 v30, v30, v10
    v_mul_f32 v31, v31, v11
    v_lshlrev_b32 v10, 16, v40
    v_lshlrev_b32 v32, 16, v46
    v_and_b32 v11, 0xffff0000, v40
    v_and_b32 v33, 0xffff0000, v46
    v_mul_f32 v32, v32, v10
    v_mul_f32 v33, v33, v11
    v_lshlrev_b32 v10, 16, v41
    v_lshlrev_b32 v34, 16, v47
    v_and_b32 v11, 0xffff0000, v41
    v_and_b32 v35, 0xffff0000, v47
    v_mul_f32 v34, v34, v10
    v_mul_f32 v35, v35, v11
.p2align 6
L_kloop:
    s_nop 1
    s_waitcnt vmcnt(0)
    buffer_load_dwordx4 v[88:91], v48, s[8:11], 0 offen offset:1536 nt
    buffer_load_dwordx4 v[92:95], v48, s[8:11], 0 offen offset:1792 nt
    buffer_load_dwordx4 v[96:99], v48, s[8:11], 0 offen offset:2048 nt
    buffer_load_dwordx4 v[100:103], v48, s[8:11], 0 offen offset:2304 nt
    buffer_load_dwordx4 v[104:107], v48, s[8:11], 0 offen offset:2560 nt
    buffer_load_dwordx4 v[108:111], v48, s[8:11], 0 offen offset:2816 nt
    v_cvt_f32_i32 v64, v64
    v_cvt_f32_i32 v65, v65
    v_cvt_f32_i32 v66, v66
    v_cvt_f32_i32 v67, v67
    v_mul_f32 v54, v64, v24
    v_fmac_f32 v54, v65, v25
    v_fmac_f32 v54, v66, v26
    v_fmac_f32 v54, v67, v27
    v_cvt_f32_i32 v68, v68
    v_cvt_f32_i32 v69, v69
    v_cvt_f32_i32 v70, v70
    v_cvt_f32_i32 v71, v71
    v_fmac_f32 v54, v68, v28
    v_fmac_f32 v54, v69, v29
    v_fmac_f32 v54, v70, v30
    v_fmac_f32 v54, v71, v31
    v_cvt_f32_i32 v72, v72
    v_cvt_f32_i32 v73, v73
    v_cvt_f32_i32 v74, v74
    v_cvt_f32_i32 v75, v75
    v_fmac_f32 v54, v72, v32
    v_fmac_f32 v54, v73, v33
    v_fmac_f32 v54, v74, v34
    v_fmac_f32 v54, v75, v35
    v_cvt_f32_i32 v76, v76
    v_cvt_f32_i32 v77, v77
    v_add_f32_dpp v54, v54, v54 row_ror:8 row_mask:0xf bank_mask:0xf
    v_cvt_f32_i32 v78, v78
    v_cvt_f32_i32 v79, v79
    v_add_f32_dpp v54, v54, v54 row_ror:4 row_mask:0xf bank_mask:0xf
    v_mul_f32 v55, v76, v24
    v_fmac_f32 v55, v77, v25
    v_add_f32_dpp v54, v54, v54 row_ror:2 row_mask:0xf bank_mask:0xf
    v_fmac_f32 v55, v78, v26
    v_fmac_f32 v55, v79, v27
    v_add_f32_dpp v60, v54, v54 row_ror:1 row_mask:0xf bank_mask:0x1
    v_cvt_f32_i32 v80, v80
    v_cvt_f32_i32 v81, v81
    v_cvt_f32_i32 v82, v82
    v_cvt_f32_i32 v83, v83
    v_fmac_f32 v55, v80, v28
    v_fmac_f32 v55, v81, v29
    v_fmac_f32 v55, v82, v30
    v_fmac_f32 v55, v83, v31
    v_cvt_f32_i32 v84, v84
    v_cvt_f32_i32 v85, v85
    v_cvt_f32_i32 v86, v86
    v_cvt_f32_i32 v87, v87
    v_fmac_f32 v55, v84, v32
    v_fmac_f32 v55, v85, v33
    v_fmac_f32 v55, v86, v34
    v_fmac_f32 v55, v87, v35
    s_nop 1
    v_add_f32_dpp v55, v55, v55 row_ror:8 row_mask:0xf bank_mask:0xf
    s_nop 1
    v_add_f32_dpp v55, v55, v55 row_ror:4 row_mask:0xf bank_mask:0xf
    s_nop 1
    v_add_f32_dpp v55, v55, v55 row_ror:2 row_mask:0xf bank_mask:0xf
    s_nop 1
    v_add_f32_dpp v61, v55, v55 row_ror:1 row_mask:0xf bank_mask:0x1
    s_waitcnt vmcnt(0)
    buffer_load_dwordx4 v[112:115], v48, s[8:11], 0 offen offset:3072 nt
    buffer_load_dwordx4 v[116:119], v48, s[8:11], 0 offen offset:3328 nt
    buffer_load_dwordx4 v[120:123], v48, s[8:11], 0 offen offset:3584 nt
    buffer_load_dwordx4 v[124:127], v49, s[8:11], 0 offen offset:0 nt
    buffer_load_dwordx4 v[128:131], v49, s[8:11], 0 offen offset:256 nt
    buffer_load_dwordx4 v[132:135], v49, s[8:11], 0 offen offset:512 nt
    s_add_u32 s29, s29, 4
    s_add_u32 s30, s30, 1
    s_bitcmp1_b64 s[40:41], s30
    s_cbranch_scc1 L_evK
L_evretK:
    s_nop 1
    s_lshr_b32 s33, s29, 6
    s_lshl_b32 s33, s33, 11
    s_and_b32 s32, s29, 63
    s_add_u32 s32, s32, s33
    s_add_u32 s32, s32, s44
    s_bfe_u32 s33, s32, 0x20003
    s_and_b32 s34, s32, 4
    s_or_b32 s33, s33, s34
    s_xor_b32 s33, s33, s5
    s_lshl_b32 s50, s32, 5
    s_or_b32 s50, s50, s33
    s_lshl_b32 s50, s50, 4
    s_or_b32 s50, s50, 1
    v_xor_b32 v10, s50, v50
    v_mul_hi_u32 v10, v10, s47
    v_lshrrev_b32 v10, 1, v10
    v_and_b32 v11, 15, v10
    v_cmp_eq_u32 vcc, 5, v11
    v_mad_u32_u24 v48, v10, s45, v2
    v_add_u32 v11, 3840, v48
    v_cndmask_b32 v49, v51, v11, vcc
    v_lshrrev_b32 v10, 6, v10
    v_mad_u32_u24 v9, v10, s46, v3
    buffer_load_dwordx2 v[42:43], v9, s[16:19], 0 offen offset:0
    buffer_load_dwordx2 v[44:45], v9, s[16:19], 0 offen offset:128
    buffer_load_dwordx2 v[46:47], v9, s[16:19], 0 offen offset:256
    v_cvt_f32_i32 v88, v88
    v_cvt_f32_i32 v89, v89
    v_cvt_f32_i32 v90, v90
    v_cvt_f32_i32 v91, v91
    v_mul_f32 v56, v88, v24
    v_fmac_f32 v56, v89, v25
    v_fmac_f32 v56, v90, v26
    v_fmac_f32 v56, v91, v27
    v_cvt_f32_i32 v92, v92
    v_cvt_f32_i32 v93, v93
    v_cvt_f32_i32 v94, v94
    v_cvt_f32_i32 v95, v95
    v_fmac_f32 v56, v92, v28
    v_fmac_f32 v56, v93, v29
    v_fmac_f32 v56, v94, v30
    v_fmac_f32 v56, v95, v31
    v_cvt_f32_i32 v96, v96
    v_cvt_f32_i32 v97, v97
    v_cvt_f32_i32 v98, v98
    v_cvt_f32_i32 v99, v99
    v_fmac_f32 v56, v96, v32
    v_fmac_f32 v56, v97, v33
    v_fmac_f32 v56, v98, v34
    v_fmac_f32 v56, v99, v35
    v_cvt_f32_i32 v100, v100
    v_cvt_f32_i32 v101, v101
    v_add_f32_dpp v56, v56, v56 row_ror:8 row_mask:0xf bank_mask:0xf
    v_cvt_f32_i32 v102, v102
    v_cvt_f32_i32 v103, v103
    v_add_f32_dpp v56, v56, v56 row_ror:4 row_mask:0xf bank_mask:0xf
    v_mul_f32 v57, v100, v24
    v_fmac_f32 v57, v101, v25
    v_add_f32_dpp v56, v56, v56 row_ror:2 row_mask:0xf bank_mask:0xf
    v_fmac_f32 v57, v102, v26
    v_fmac_f32 v57, v103, v27
    v_add_f32_dpp v60, v56, v56 row_ror:1 row_mask:0xf bank_mask:0x2
    v_cvt_f32_i32 v104, v104
    v_cvt_f32_i32 v105, v105
    v_cvt_f32_i32 v106, v106
    v_cvt_f32_i32 v107, v107
    v_fmac_f32 v57, v104, v28
    v_fmac_f32 v57, v105, v29
    v_fmac_f32 v57, v106, v30
    v_fmac_f32 v57, v107, v31
    v_cvt_f32_i32 v108, v108
    v_cvt_f32_i32 v109, v109
    v_cvt_f32_i32 v110, v110
    v_cvt_f32_i32 v111, v111
    v_fmac_f32 v57, v108, v32
    v_fmac_f32 v57, v109, v33
    v_fmac_f32 v57, v110, v34
    v_fmac_f32 v57, v111, v35
    s_nop 1
    v_add_f32_dpp v57, v57, v57 row_ror:8 row_mask:0xf bank_mask:0xf
    s_nop 1
    v_add_f32_dpp v57, v57, v57 row_ror:4 row_mask:0xf bank_mask:0xf
    s_nop 1
    v_add_f32_dpp v57, v57, v57 row_ror:2 row_mask:0xf bank_mask:0xf
    s_nop 1
    v_add_f32_dpp v61, v57, v57 row_ror:1 row_mask:0xf bank_mask:0x2
    s_waitcnt vmcnt(3)
    buffer_load_dwordx4 v[64:67], v48, s[8:11], 0 offen offset:0 nt
    buffer_load_dwordx4 v[68:71], v48, s[8:11], 0 offen offset:256 nt
    buffer_load_dwordx4 v[72:75], v48, s[8:11], 0 offen offset:512 nt
    buffer_load_dwordx4 v[76:79], v48, s[8:11], 0 offen offset:768 nt
    buffer_load_dwordx4 v[80:83], v48, s[8:11], 0 offen offset:1024 nt
    buffer_load_dwordx4 v[84:87], v48, s[8:11], 0 offen offset:1280 nt
    v_cvt_f32_i32 v112, v112
    v_cvt_f32_i32 v113, v113
    v_cvt_f32_i32 v114, v114
    v_cvt_f32_i32 v115, v115
    v_mul_f32 v58, v112, v24
    v_fmac_f32 v58, v113, v25
    v_fmac_f32 v58, v114, v26
    v_fmac_f32 v58, v115, v27
    v_cvt_f32_i32 v116, v116
    v_cvt_f32_i32 v117, v117
    v_cvt_f32_i32 v118, v118
    v_cvt_f32_i32 v119, v119
    v_fmac_f32 v58, v116, v28
    v_fmac_f32 v58, v117, v29
    v_fmac_f32 v58, v118, v30
    v_fmac_f32 v58, v119, v31
    v_cvt_f32_i32 v120, v120
    v_cvt_f32_i32 v121, v121
    v_cvt_f32_i32 v122, v122
    v_cvt_f32_i32 v123, v123
    v_fmac_f32 v58, v120, v32
    v_fmac_f32 v58, v121, v33
    v_fmac_f32 v58, v122, v34
    v_fmac_f32 v58, v123, v35
    v_cvt_f32_i32 v124, v124
    v_cvt_f32_i32 v125, v125
    v_add_f32_dpp v58, v58, v58 row_ror:8 row_mask:0xf bank_mask:0xf
    v_cvt_f32_i32 v126, v126
    v_cvt_f32_i32 v127, v127
    v_add_f32_dpp v58, v58, v58 row_ror:4 row_mask:0xf bank_mask:0xf
    v_mul_f32 v59, v124, v24
    v_fmac_f32 v59, v125, v25
    v_add_f32_dpp v58, v58, v58 row_ror:2 row_mask:0xf bank_mask:0xf
    v_fmac_f32 v59, v126, v26
    v_fmac_f32 v59, v127, v27
    v_add_f32_dpp v60, v58, v58 row_ror:1 row_mask:0xf bank_mask:0x4
    v_cvt_f32_i32 v128, v128
    v_cvt_f32_i32 v129, v129
    v_cvt_f32_i32 v130, v130
    v_cvt_f32_i32 v131, v131
    v_fmac_f32 v59, v128, v28
    v_fmac_f32 v59, v129, v29
    v_fmac_f32 v59, v130, v30
    v_fmac_f32 v59, v131, v31
    v_cvt_f32_i32 v132, v132
    v_cvt_f32_i32 v133, v133
    v_cvt_f32_i32 v134, v134
    v_cvt_f32_i32 v135, v135
    v_fmac_f32 v59, v132, v32
    v_fmac_f32 v59, v133, v33
    v_fmac_f32 v59, v134, v34
    v_fmac_f32 v59, v135, v35
    s_nop 1
    v_add_f32_dpp v59, v59, v59 row_ror:8 row_mask:0xf bank_mask:0xf
    s_nop 1
    v_add_f32_dpp v59, v59, v59 row_ror:4 row_mask:0xf bank_mask:0xf
    s_nop 1
    v_add_f32_dpp v59, v59, v59 row_ror:2 row_mask:0xf bank_mask:0xf
    s_nop 1
    v_add_f32_dpp v61, v59, v59 row_ror:1 row_mask:0xf bank_mask:0x4
    s_mov_b64 exec, s[42:43]
    ds_write_b64 v4, v[60:61]
    s_mov_b64 exec, -1
    v_add_u32 v4, 48, v4
    s_waitcnt vmcnt(6)
    v_lshlrev_b32 v10, 16, v36
    v_lshlrev_b32 v24, 16, v42
    v_and_b32 v11, 0xffff0000, v36
    v_and_b32 v25, 0xffff0000, v42
    v_mul_f32 v24, v24, v10
    v_mul_f32 v25, v25, v11
    v_lshlrev_b32 v10, 16, v37
    v_lshlrev_b32 v26, 16, v43
    v_and_b32 v11, 0xffff0000, v37
    v_and_b32 v27, 0xffff0000, v43
    v_mul_f32 v26, v26, v10
    v_mul_f32 v27, v27, v11
    v_lshlrev_b32 v10, 16, v38
    v_lshlrev_b32 v28, 16, v44
    v_and_b32 v11, 0xffff0000, v38
    v_and_b32 v29, 0xffff0000, v44
    v_mul_f32 v28, v28, v10
    v_mul_f32 v29, v29, v11
    v_lshlrev_b32 v10, 16, v39
    v_lshlrev_b32 v30, 16, v45
    v_and_b32 v11, 0xffff0000, v39
    v_and_b32 v31, 0xffff0000, v45
    v_mul_f32 v30, v30, v10
    v_mul_f32 v31, v31, v11
    v_lshlrev_b32 v10, 16, v40
    v_lshlrev_b32 v32, 16, v46
    v_and_b32 v11, 0xffff0000, v40
    v_and_b32 v33, 0xffff0000, v46
    v_mul_f32 v32, v32, v10
    v_mul_f32 v33, v33, v11
    v_lshlrev_b32 v10, 16, v41
    v_lshlrev_b32 v34, 16, v47
    v_and_b32 v11, 0xffff0000, v41
    v_and_b32 v35, 0xffff0000, v47
    v_mul_f32 v34, v34, v10
    v_mul_f32 v35, v35, v11
L_kchk:
    s_nop 1
    s_cmp_lg_u32 s59, 0
    s_cbranch_scc1 L_kboost
L_kchk2:
    s_nop 1
    s_cmp_lg_u32 s30, 47
    s_cbranch_scc1 L_kloop
    s_waitcnt vmcnt(0)
    buffer_load_dwordx4 v[88:91], v48, s[8:11], 0 offen offset:1536 nt
    buffer_load_dwordx4 v[92:95], v48, s[8:11], 0 offen offset:1792 nt
    buffer_load_dwordx4 v[96:99], v48, s[8:11], 0 offen offset:2048 nt
    buffer_load_dwordx4 v[100:103], v48, s[8:11], 0 offen offset:2304 nt
    buffer_load_dwordx4 v[104:107], v48, s[8:11], 0 offen offset:2560 nt
    buffer_load_dwordx4 v[108:111], v48, s[8:11], 0 offen offset:2816 nt
    v_cvt_f32_i32 v64, v64
    v_cvt_f32_i32 v65, v65
    v_cvt_f32_i32 v66, v66
    v_cvt_f32_i32 v67, v67
    v_mul_f32 v54, v64, v24
    v_fmac_f32 v54, v65, v25
    v_fmac_f32 v54, v66, v26
    v_fmac_f32 v54, v67, v27
    v_cvt_f32_i32 v68, v68
    v_cvt_f32_i32 v69, v69
    v_cvt_f32_i32 v70, v70
    v_cvt_f32_i32 v71, v71
    v_fmac_f32 v54, v68, v28
    v_fmac_f32 v54, v69, v29
    v_fmac_f32 v54, v70, v30
    v_fmac_f32 v54, v71, v31
    v_cvt_f32_i32 v72, v72
    v_cvt_f32_i32 v73, v73
    v_cvt_f32_i32 v74, v74
    v_cvt_f32_i32 v75, v75
    v_fmac_f32 v54, v72, v32
    v_fmac_f32 v54, v73, v33
    v_fmac_f32 v54, v74, v34
    v_fmac_f32 v54, v75, v35
    v_cvt_f32_i32 v76, v76
    v_cvt_f32_i32 v77, v77
    v_add_f32_dpp v54, v54, v54 row_ror:8 row_mask:0xf bank_mask:0xf
    v_cvt_f32_i32 v78, v78
    v_cvt_f32_i32 v79, v79
    v_add_f32_dpp v54, v54, v54 row_ror:4 row_mask:0xf bank_mask:0xf
    v_mul_f32 v55, v76, v24
    v_fmac_f32 v55, v77, v25
    v_add_f32_dpp v54, v54, v54 row_ror:2 row_mask:0xf bank_mask:0xf
    v_fmac_f32 v55, v78, v26
    v_fmac_f32 v55, v79, v27
    v_add_f32_dpp v60, v54, v54 row_ror:1 row_mask:0xf bank_mask:0x1
    v_cvt_f32_i32 v80, v80
    v_cvt_f32_i32 v81, v81
    v_cvt_f32_i32 v82, v82
    v_cvt_f32_i32 v83, v83
    v_fmac_f32 v55, v80, v28
    v_fmac_f32 v55, v81, v29
    v_fmac_f32 v55, v82, v30
    v_fmac_f32 v55, v83, v31
    v_cvt_f32_i32 v84, v84
    v_cvt_f32_i32 v85, v85
    v_cvt_f32_i32 v86, v86
    v_cvt_f32_i32 v87, v87
    v_fmac_f32 v55, v84, v32
    v_fmac_f32 v55, v85, v33
    v_fmac_f32 v55, v86, v34
    v_fmac_f32 v55, v87, v35
    s_nop 1
    v_add_f32_dpp v55, v55, v55 row_ror:8 row_mask:0xf bank_mask:0xf
    s_nop 1
    v_add_f32_dpp v55, v55, v55 row_ror:4 row_mask:0xf bank_mask:0xf
    s_nop 1
    v_add_f32_dpp v55, v55, v55 row_ror:2 row_mask:0xf bank_mask:0xf
    s_nop 1
    v_add_f32_dpp v61, v55, v55 row_ror:1 row_mask:0xf bank_mask:0x1
    s_waitcnt vmcnt(0)
    buffer_load_dwordx4 v[112:115], v48, s[8:11], 0 offen offset:3072 nt
    buffer_load_dwordx4 v[116:119], v48, s[8:11], 0 offen offset:3328 nt
    buffer_load_dwordx4 v[120:123], v48, s[8:11], 0 offen offset:3584 nt
    buffer_load_dwordx4 v[124:127], v49, s[8:11], 0 offen offset:0 nt
    buffer_load_dwordx4 v[128:131], v49, s[8:11], 0 offen offset:256 nt
    buffer_load_dwordx4 v[132:135], v49, s[8:11], 0 offen offset:512 nt
    s_mov_b32 s29, s28
    s_mov_b32 s30, 0
    s_memrealtime s[36:37]
    s_mov_b32 s6, 0x100000
L_wgtv:
    s_nop 1
    ds_read_b32 v10, v53 offset:216
    s_sub_u32 s6, s6, 1
    s_cbranch_scc1 L_exit1
    s_waitcnt lgkmcnt(0)
    v_readfirstlane_b32 s32, v10
    s_cmp_eq_u32 s32, 0
    s_cbranch_scc1 L_wgtv
    s_and_b32 s32, s32, 0xffff
    s_cbranch_scc0 L_gxtv
    s_add_u32 s32, s32, s36
L_gltv:
    s_nop 1
    s_memrealtime s[36:37]
    s_waitcnt lgkmcnt(0)
    s_sub_u32 s36, s36, s32
    s_cmp_lt_i32 s36, 0
    s_cbranch_scc1 L_gltv
L_gxtv:
    s_nop 1
    s_lshr_b32 s33, s30, 4
    s_lshl_b32 s34, s33, 2
    v_mov_b32 v11, s34
    s_mov_b32 s6, 0x100000
L_wtv:
    s_nop 1
    ds_read_b32 v10, v11 offset:24
    s_sub_u32 s6, s6, 1
    s_cbranch_scc1 L_exit1
    s_waitcnt lgkmcnt(0)
    v_readfirstlane_b32 s32, v10
    s_cmp_eq_u32 s32, 0
    s_cbranch_scc1 L_wtv
    s_and_b32 s5, s32, 7
    s_xor_b32 s5, s5, s48
    s_bitcmp1_b32 s32, 3
    s_cselect_b64 vcc, -1, 0
    v_cndmask_b32 v50, v62, v63, vcc
    s_mov_b32 s49, 45
    s_mov_b32 s40, 0x2a2b2a2a
    s_mov_b32 s41, 0x152b
    s_mov_b32 s64, 0x2020202
    s_mov_b32 s65, 0x102
    s_mov_b32 s66, 0x8080808
    s_mov_b32 s67, 0x408
    s_mov_b32 s68, 0x20202020
    s_mov_b32 s69, 0x1020
    s_mov_b32 s70, 0x10000
    s_mov_b32 s71, 0x1
    s_lshr_b32 s33, s29, 6
    s_lshl_b32 s33, s33, 11
    s_and_b32 s32, s29, 63
    s_add_u32 s32, s32, s33
    s_add_u32 s32, s32, s44
    s_bfe_u32 s33, s32, 0x20003
    s_and_b32 s34, s32, 4
    s_or_b32 s33, s33, s34
    s_xor_b32 s33, s33, s5
    s_lshl_b32 s50, s32, 5
    s_or_b32 s50, s50, s33
    s_lshl_b32 s50, s50, 4
    s_or_b32 s50, s50, 1
    s_lshl_b32 s53, s29, 7
    v_xor_b32 v10, s50, v50
    v_mul_hi_u32 v10, v10, s47
    v_lshrrev_b32 v10, 1, v10
    v_and_b32 v11, 15, v10
    v_cmp_eq_u32 vcc, 5, v11
    v_mad_u32_u24 v48, v10, s45, v2
    v_add_u32 v11, 3840, v48
    v_cndmask_b32 v49, v51, v11, vcc
    v_add_u32 v10, s53, v5
    ds_read_b32 v7, v10
    v_cvt_f32_i32 v88, v88
    v_cvt_f32_i32 v89, v89
    v_cvt_f32_i32 v90, v90
    v_cvt_f32_i32 v91, v91
    v_mul_f32 v56, v88, v24
    v_fmac_f32 v56, v89, v25
    v_fmac_f32 v56, v90, v26
    v_fmac_f32 v56, v91, v27
    v_cvt_f32_i32 v92, v92
    v_cvt_f32_i32 v93, v93
    v_cvt_f32_i32 v94, v94
    v_cvt_f32_i32 v95, v95
    v_fmac_f32 v56, v92, v28
    v_fmac_f32 v56, v93, v29
    v_fmac_f32 v56, v94, v30
    v_fmac_f32 v56, v95, v31
    v_cvt_f32_i32 v96, v96
    v_cvt_f32_i32 v97, v97
    v_cvt_f32_i32 v98, v98
    v_cvt_f32_i32 v99, v99
    v_fmac_f32 v56, v96, v32
    v_fmac_f32 v56, v97, v33
    v_fmac_f32 v56, v98, v34
    v_fmac_f32 v56, v99, v35
    v_cvt_f32_i32 v100, v100
    v_cvt_f32_i32 v101, v101
    v_add_f32_dpp v56, v56, v56 row_ror:8 row_mask:0xf bank_mask:0xf
    v_cvt_f32_i32 v102, v102
    v_cvt_f32_i32 v103, v103
    v_add_f32_dpp v56, v56, v56 row_ror:4 row_mask:0xf bank_mask:0xf
    v_mul_f32 v57, v100, v24
    v_fmac_f32 v57, v101, v25
    v_add_f32_dpp v56, v56, v56 row_ror:2 row_mask:0xf bank_mask:0xf
    v_fmac_f32 v57, v102, v26
    v_fmac_f32 v57, v103, v27
    v_add_f32_dpp v60, v56, v56 row_ror:1 row_mask:0xf bank_mask:0x2
    v_cvt_f32_i32 v104, v104
    v_cvt_f32_i32 v105, v105
    v_cvt_f32_i32 v106, v106
    v_cvt_f32_i32 v107, v107
    v_fmac_f32 v57, v104, v28
    v_fmac_f32 v57, v105, v29
    v_fmac_f32 v57, v106, v30
    v_fmac_f32 v57, v107, v31
    v_cvt_f32_i32 v108, v108
    v_cvt_f32_i32 v109, v109
    v_cvt_f32_i32 v110, v110
    v_cvt_f32_i32 v111, v111
    v_fmac_f32 v57, v108, v32
    v_fmac_f32 v57, v109, v33
    v_fmac_f32 v57, v110, v34
    v_fmac_f32 v57, v111, v35
    s_nop 1
    v_add_f32_dpp v57, v57, v57 row_ror:8 row_mask:0xf bank_mask:0xf
    s_nop 1
    v_add_f32_dpp v57, v57, v57 row_ror:4 row_mask:0xf bank_mask:0xf
    s_nop 1
    v_add_f32_dpp v57, v57, v57 row_ror:2 row_mask:0xf bank_mask:0xf
    s_nop 1
    v_add_f32_dpp v61, v57, v57 row_ror:1 row_mask:0xf bank_mask:0x2
    s_waitcnt vmcnt(0)
    buffer_load_dwordx4 v[64:67], v48, s[12:15], 0 offen offset:0 nt
    buffer_load_dwordx4 v[68:71], v48, s[12:15], 0 offen offset:256 nt
    buffer_load_dwordx4 v[72:75], v48, s[12:15], 0 offen offset:512 nt
    buffer_load_dwordx4 v[76:79], v48, s[12:15], 0 offen offset:768 nt
    buffer_load_dwordx4 v[80:83], v48, s[12:15], 0 offen offset:1024 nt
    buffer_load_dwordx4 v[84:87], v48, s[12:15], 0 offen offset:1280 nt
    v_cvt_f32_i32 v112, v112
    v_cvt_f32_i32 v113, v113
    v_cvt_f32_i32 v114, v114
    v_cvt_f32_i32 v115, v115
    v_mul_f32 v58, v112, v24
    v_fmac_f32 v58, v113, v25
    v_fmac_f32 v58, v114, v26
    v_fmac_f32 v58, v115, v27
    v_cvt_f32_i32 v116, v116
    v_cvt_f32_i32 v117, v117
    v_cvt_f32_i32 v118, v118
    v_cvt_f32_i32 v119, v119
    v_fmac_f32 v58, v116, v28
    v_fmac_f32 v58, v117, v29
    v_fmac_f32 v58, v118, v30
    v_fmac_f32 v58, v119, v31
    v_cvt_f32_i32 v120, v120
    v_cvt_f32_i32 v121, v121
    v_cvt_f32_i32 v122, v122
    v_cvt_f32_i32 v123, v123
    v_fmac_f32 v58, v120, v32
    v_fmac_f32 v58, v121, v33
    v_fmac_f32 v58, v122, v34
    v_fmac_f32 v58, v123, v35
    v_cvt_f32_i32 v124, v124
    v_cvt_f32_i32 v125, v125
    v_add_f32_dpp v58, v58, v58 row_ror:8 row_mask:0xf bank_mask:0xf
    v_cvt_f32_i32 v126, v126
    v_cvt_f32_i32 v127, v127
    v_add_f32_dpp v58, v58, v58 row_ror:4 row_mask:0xf bank_mask:0xf
    v_mul_f32 v59, v124, v24
    v_fmac_f32 v59, v125, v25
    v_add_f32_dpp v58, v58, v58 row_ror:2 row_mask:0xf bank_mask:0xf
    v_fmac_f32 v59, v126, v26
    v_fmac_f32 v59, v127, v27
    v_add_f32_dpp v60, v58, v58 row_ror:1 row_mask:0xf bank_mask:0x4
    v_cvt_f32_i32 v128, v128
    v_cvt_f32_i32 v129, v129
    v_cvt_f32_i32 v130, v130
    v_cvt_f32_i32 v131, v131
    v_fmac_f32 v59, v128, v28
    v_fmac_f32 v59, v129, v29
    v_fmac_f32 v59, v130, v30
    v_fmac_f32 v59, v131, v31
    v_cvt_f32_i32 v132, v132
    v_cvt_f32_i32 v133, v133
    v_cvt_f32_i32 v134, v134
    v_cvt_f32_i32 v135, v135
    v_fmac_f32 v59, v132, v32
    v_fmac_f32 v59, v133, v33
    v_fmac_f32 v59, v134, v34
    v_fmac_f32 v59, v135, v35
    s_nop 1
    v_add_f32_dpp v59, v59, v59 row_ror:8 row_mask:0xf bank_mask:0xf
    s_nop 1
    v_add_f32_dpp v59, v59, v59 row_ror:4 row_mask:0xf bank_mask:0xf
    s_nop 1
    v_add_f32_dpp v59, v59, v59 row_ror:2 row_mask:0xf bank_mask:0xf
    s_nop 1
    v_add_f32_dpp v61, v59, v59 row_ror:1 row_mask:0xf bank_mask:0x4
    s_mov_b64 exec, s[42:43]
    ds_write_b64 v4, v[60:61]
    s_mov_b64 exec, -1
    s_waitcnt lgkmcnt(0)
    v_mov_b32 v6, v7
    v_mov_b32 v11, 1
    s_mov_b64 exec, 1
    ds_add_u32 v53, v11 offset:48
    s_mov_b64 exec, -1
.p2align 6
L_vloop:
    s_nop 1
    s_waitcnt vmcnt(0)
    buffer_load_dwordx4 v[88:91], v48, s[12:15], 0 offen offset:1536 nt
    buffer_load_dwordx4 v[92:95], v48, s[12:15], 0 offen offset:1792 nt
    buffer_load_dwordx4 v[96:99], v48, s[12:15], 0 offen offset:2048 nt
    buffer_load_dwordx4 v[100:103], v48, s[12:15], 0 offen offset:2304 nt
    buffer_load_dwordx4 v[104:107], v48, s[12:15], 0 offen offset:2560 nt
    buffer_load_dwordx4 v[108:111], v48, s[12:15], 0 offen offset:2816 nt
    v_cvt_f32_i32 v64, v64
    v_cvt_f32_i32 v65, v65
    v_cvt_f32_i32 v66, v66
    v_cvt_f32_i32 v67, v67
    v_fmac_f32_dpp v12, v6, v64 row_newbcast:0 row_mask:0xf bank_mask:0xf
    v_fmac_f32_dpp v13, v6, v65 row_newbcast:0 row_mask:0xf bank_mask:0xf
    v_fmac_f32_dpp v14, v6, v66 row_newbcast:0 row_mask:0xf bank_mask:0xf
    v_fmac_f32_dpp v15, v6, v67 row_newbcast:0 row_mask:0xf bank_mask:0xf
    v_cvt_f32_i32 v68, v68
    v_cvt_f32_i32 v69, v69
    v_cvt_f32_i32 v70, v70
    v_cvt_f32_i32 v71, v71
    v_fmac_f32_dpp v16, v6, v68 row_newbcast:0 row_mask:0xf bank_mask:0xf
    v_fmac_f32_dpp v17, v6, v69 row_newbcast:0 row_mask:0xf bank_mask:0xf
    v_fmac_f32_dpp v18, v6, v70 row_newbcast:0 row_mask:0xf bank_mask:0xf
    v_fmac_f32_dpp v19, v6, v71 row_newbcast:0 row_mask:0xf bank_mask:0xf
    v_cvt_f32_i32 v72, v72
    v_cvt_f32_i32 v73, v73
    v_cvt_f32_i32 v74, v74
    v_cvt_f32_i32 v75, v75
    v_fmac_f32_dpp v20, v6, v72 row_newbcast:0 row_mask:0xf bank_mask:0xf
    v_fmac_f32_dpp v21, v6, v73 row_newbcast:0 row_mask:0xf bank_mask:0xf
    v_fmac_f32_dpp v22, v6, v74 row_newbcast:0 row_mask:0xf bank_mask:0xf
    v_fmac_f32_dpp v23, v6, v75 row_newbcast:0 row_mask:0xf bank_mask:0xf
    v_cvt_f32_i32 v76, v76
    v_cvt_f32_i32 v77, v77
    v_cvt_f32_i32 v78, v78
    v_cvt_f32_i32 v79, v79
    v_fmac_f32_dpp v12, v6, v76 row_newbcast:1 row_mask:0xf bank_mask:0xf
    v_fmac_f32_dpp v13, v6, v77 row_newbcast:1 row_mask:0xf bank_mask:0xf
    v_fmac_f32_dpp v14, v6, v78 row_newbcast:1 row_mask:0xf bank_mask:0xf
    v_fmac_f32_dpp v15, v6, v79 row_newbcast:1 row_mask:0xf bank_mask:0xf
    v_cvt_f32_i32 v80, v80
    v_cvt_f32_i32 v81, v81
    v_cvt_f32_i32 v82, v82
    v_cvt_f32_i32 v83, v83
    v_fmac_f32_dpp v16, v6, v80 row_newbcast:1 row_mask:0xf bank_mask:0xf
    v_fmac_f32_dpp v17, v6, v81 row_newbcast:1 row_mask:0xf bank_mask:0xf
    v_fmac_f32_dpp v18, v6, v82 row_newbcast:1 row_mask:0xf bank_mask:0xf
    v_fmac_f32_dpp v19, v6, v83 row_newbcast:1 row_mask:0xf bank_mask:0xf
    v_cvt_f32_i32 v84, v84
    v_cvt_f32_i32 v85, v85
    v_cvt_f32_i32 v86, v86
    v_cvt_f32_i32 v87, v87
    v_fmac_f32_dpp v20, v6, v84 row_newbcast:1 row_mask:0xf bank_mask:0xf
    v_fmac_f32_dpp v21, v6, v85 row_newbcast:1 row_mask:0xf bank_mask:0xf
    v_fmac_f32_dpp v22, v6, v86 row_newbcast:1 row_mask:0xf bank_mask:0xf
    v_fmac_f32_dpp v23, v6, v87 row_newbcast:1 row_mask:0xf bank_mask:0xf
    s_waitcnt vmcnt(0)
    buffer_load_dwordx4 v[112:115], v48, s[12:15], 0 offen offset:3072 nt
    buffer_load_dwordx4 v[116:119], v48, s[12:15], 0 offen offset:3328 nt
    buffer_load_dwordx4 v[120:123], v48, s[12:15], 0 offen offset:3584 nt
    buffer_load_dwordx4 v[124:127], v49, s[12:15], 0 offen offset:0 nt
    buffer_load_dwordx4 v[128:131], v49, s[12:15], 0 offen offset:256 nt
    buffer_load_dwordx4 v[132:135], v49, s[12:15], 0 offen offset:512 nt
    s_add_u32 s29, s29, 4
    s_add_u32 s30, s30, 1
    s_bitcmp1_b64 s[40:41], s30
    s_cbranch_scc1 L_evV
L_evretV:
    s_nop 1
    s_lshr_b32 s33, s29, 6
    s_lshl_b32 s33, s33, 11
    s_and_b32 s32, s29, 63
    s_add_u32 s32, s32, s33
    s_add_u32 s32, s32, s44
    s_bfe_u32 s33, s32, 0x20003
    s_and_b32 s34, s32, 4
    s_or_b32 s33, s33, s34
    s_xor_b32 s33, s33, s5
    s_lshl_b32 s50, s32, 5
    s_or_b32 s50, s50, s33
    s_lshl_b32 s50, s50, 4
    s_or_b32 s50, s50, 1
    s_lshl_b32 s53, s29, 7
    v_xor_b32 v10, s50, v50
    v_mul_hi_u32 v10, v10, s47
    v_lshrrev_b32 v10, 1, v10
    v_and_b32 v11, 15, v10
    v_cmp_eq_u32 vcc, 5, v11
    v_mad_u32_u24 v48, v10, s45, v2
    v_add_u32 v11, 3840, v48
    v_cndmask_b32 v49, v51, v11, vcc
    v_add_u32 v10, s53, v5
    ds_read_b32 v7, v10
    s_cmp_eq_u32 s30, 48
    s_cbranch_scc1 L_el0
L_el0r:
    v_cvt_f32_i32 v88, v88
    v_cvt_f32_i32 v89, v89
    v_cvt_f32_i32 v90, v90
    v_cvt_f32_i32 v91, v91
    v_fmac_f32_dpp v12, v6, v88 row_newbcast:2 row_mask:0xf bank_mask:0xf
    v_fmac_f32_dpp v13, v6, v89 row_newbcast:2 row_mask:0xf bank_mask:0xf
    v_fmac_f32_dpp v14, v6, v90 row_newbcast:2 row_mask:0xf bank_mask:0xf
    v_fmac_f32_dpp v15, v6, v91 row_newbcast:2 row_mask:0xf bank_mask:0xf
    v_cvt_f32_i32 v92, v92
    v_cvt_f32_i32 v93, v93
    v_cvt_f32_i32 v94, v94
    v_cvt_f32_i32 v95, v95
    v_fmac_f32_dpp v16, v6, v92 row_newbcast:2 row_mask:0xf bank_mask:0xf
    v_fmac_f32_dpp v17, v6, v93 row_newbcast:2 row_mask:0xf bank_mask:0xf
    v_fmac_f32_dpp v18, v6, v94 row_newbcast:2 row_mask:0xf bank_mask:0xf
    v_fmac_f32_dpp v19, v6, v95 row_newbcast:2 row_mask:0xf bank_mask:0xf
    v_cvt_f32_i32 v96, v96
    v_cvt_f32_i32 v97, v97
    v_cvt_f32_i32 v98, v98
    v_cvt_f32_i32 v99, v99
    v_fmac_f32_dpp v20, v6, v96 row_newbcast:2 row_mask:0xf bank_mask:0xf
    v_fmac_f32_dpp v21, v6, v97 row_newbcast:2 row_mask:0xf bank_mask:0xf
    v_fmac_f32_dpp v22, v6, v98 row_newbcast:2 row_mask:0xf bank_mask:0xf
    v_fmac_f32_dpp v23, v6, v99 row_newbcast:2 row_mask:0xf bank_mask:0xf
    v_cvt_f32_i32 v100, v100
    v_cvt_f32_i32 v101, v101
    v_cvt_f32_i32 v102, v102
    v_cvt_f32_i32 v103, v103
    v_fmac_f32_dpp v12, v6, v100 row_newbcast:3 row_mask:0xf bank_mask:0xf
    v_fmac_f32_dpp v13, v6, v101 row_newbcast:3 row_mask:0xf bank_mask:0xf
    v_fmac_f32_dpp v14, v6, v102 row_newbcast:3 row_mask:0xf bank_mask:0xf
    v_fmac_f32_dpp v15, v6, v103 row_newbcast:3 row_mask:0xf bank_mask:0xf
    v_cvt_f32_i32 v104, v104
    v_cvt_f32_i32 v105, v105
    v_cvt_f32_i32 v106, v106
    v_cvt_f32_i32 v107, v107
    v_fmac_f32_dpp v16, v6, v104 row_newbcast:3 row_mask:0xf bank_mask:0xf
    v_fmac_f32_dpp v17, v6, v105 row_newbcast:3 row_mask:0xf bank_mask:0xf
    v_fmac_f32_dpp v18, v6, v106 row_newbcast:3 row_mask:0xf bank_mask:0xf
    v_fmac_f32_dpp v19, v6, v107 row_newbcast:3 row_mask:0xf bank_mask:0xf
    v_cvt_f32_i32 v108, v108
    v_cvt_f32_i32 v109, v109
    v_cvt_f32_i32 v110, v110
    v_cvt_f32_i32 v111, v111
    v_fmac_f32_dpp v20, v6, v108 row_newbcast:3 row_mask:0xf bank_mask:0xf
    v_fmac_f32_dpp v21, v6, v109 row_newbcast:3 row_mask:0xf bank_mask:0xf
    v_fmac_f32_dpp v22, v6, v110 row_newbcast:3 row_mask:0xf bank_mask:0xf
    v_fmac_f32_dpp v23, v6, v111 row_newbcast:3 row_mask:0xf bank_mask:0xf
    s_waitcnt vmcnt(0)
    buffer_load_dwordx4 v[64:67], v48, s[12:15], 0 offen offset:0 nt
    buffer_load_dwordx4 v[68:71], v48, s[12:15], 0 offen offset:256 nt
    buffer_load_dwordx4 v[72:75], v48, s[12:15], 0 offen offset:512 nt
    buffer_load_dwordx4 v[76:79], v48, s[12:15], 0 offen offset:768 nt
    buffer_load_dwordx4 v[80:83], v48, s[12:15], 0 offen offset:1024 nt
    buffer_load_dwordx4 v[84:87], v48, s[12:15], 0 offen offset:1280 nt
    v_cvt_f32_i32 v112, v112
    v_cvt_f32_i32 v113, v113
    v_cvt_f32_i32 v114, v114
    v_cvt_f32_i32 v115, v115
    v_fmac_f32_dpp v12, v6, v112 row_newbcast:4 row_mask:0xf bank_mask:0xf
    v_fmac_f32_dpp v13, v6, v113 row_newbcast:4 row_mask:0xf bank_mask:0xf
    v_fmac_f32_dpp v14, v6, v114 row_newbcast:4 row_mask:0xf bank_mask:0xf
    v_fmac_f32_dpp v15, v6, v115 row_newbcast:4 row_mask:0xf bank_mask:0xf
    v_cvt_f32_i32 v116, v116
    v_cvt_f32_i32 v117, v117
    v_cvt_f32_i32 v118, v118
    v_cvt_f32_i32 v119, v119
    v_fmac_f32_dpp v16, v6, v116 row_newbcast:4 row_mask:0xf bank_mask:0xf
    v_fmac_f32_dpp v17, v6, v117 row_newbcast:4 row_mask:0xf bank_mask:0xf
    v_fmac_f32_dpp v18, v6, v118 row_newbcast:4 row_mask:0xf bank_mask:0xf
    v_fmac_f32_dpp v19, v6, v119 row_newbcast:4 row_mask:0xf bank_mask:0xf
    v_cvt_f32_i32 v120, v120
    v_cvt_f32_i32 v121, v121
    v_cvt_f32_i32 v122, v122
    v_cvt_f32_i32 v123, v123
    v_fmac_f32_dpp v20, v6, v120 row_newbcast:4 row_mask:0xf bank_mask:0xf
    v_fmac_f32_dpp v21, v6, v121 row_newbcast:4 row_mask:0xf bank_mask:0xf
    v_fmac_f32_dpp v22, v6, v122 row_newbcast:4 row_mask:0xf bank_mask:0xf
    v_fmac_f32_dpp v23, v6, v123 row_newbcast:4 row_mask:0xf bank_mask:0xf
    v_cvt_f32_i32 v124, v124
    v_cvt_f32_i32 v125, v125
    v_cvt_f32_i32 v126, v126
    v_cvt_f32_i32 v127, v127
    v_fmac_f32_dpp v12, v6, v124 row_newbcast:5 row_mask:0xf bank_mask:0xf
    v_fmac_f32_dpp v13, v6, v125 row_newbcast:5 row_mask:0xf bank_mask:0xf
    v_fmac_f32_dpp v14, v6, v126 row_newbcast:5 row_mask:0xf bank_mask:0xf
    v_fmac_f32_dpp v15, v6, v127 row_newbcast:5 row_mask:0xf bank_mask:0xf
    v_cvt_f32_i32 v128, v128
    v_cvt_f32_i32 v129, v129
    v_cvt_f32_i32 v130, v130
    v_cvt_f32_i32 v131, v131
    v_fmac_f32_dpp v16, v6, v128 row_newbcast:5 row_mask:0xf bank_mask:0xf
    v_fmac_f32_dpp v17, v6, v129 row_newbcast:5 row_mask:0xf bank_mask:0xf
    v_fmac_f32_dpp v18, v6, v130 row_newbcast:5 row_mask:0xf bank_mask:0xf
    v_fmac_f32_dpp v19, v6, v131 row_newbcast:5 row_mask:0xf bank_mask:0xf
    v_cvt_f32_i32 v132, v132
    v_cvt_f32_i32 v133, v133
    v_cvt_f32_i32 v134, v134
    v_cvt_f32_i32 v135, v135
    v_fmac_f32_dpp v20, v6, v132 row_newbcast:5 row_mask:0xf bank_mask:0xf
    v_fmac_f32_dpp v21, v6, v133 row_newbcast:5 row_mask:0xf bank_mask:0xf
    v_fmac_f32_dpp v22, v6, v134 row_newbcast:5 row_mask:0xf bank_mask:0xf
    v_fmac_f32_dpp v23, v6, v135 row_newbcast:5 row_mask:0xf bank_mask:0xf
    s_waitcnt lgkmcnt(0)
    v_mov_b32 v6, v7
L_vchk:
    s_nop 1
    s_cmp_eq_u32 s30, s49
    s_cbranch_scc1 L_deep
    s_cmp_lg_u32 s59, 0
    s_cbranch_scc1 L_vboost
    s_and_b32 s32, s30, 15
    s_cbranch_scc1 L_vloop
L_vend:
    s_nop 1
    v_permlane32_swap_b32 v12, v14
    v_permlane32_swap_b32 v13, v15
    v_permlane32_swap_b32 v16, v18
    v_permlane32_swap_b32 v17, v19
    v_permlane32_swap_b32 v20, v22
    v_permlane32_swap_b32 v21, v23
    v_add_f32 v12, v12, v14
    v_add_f32 v13, v13, v15
    v_add_f32 v16, v16, v18
    v_add_f32 v17, v17, v19
    v_add_f32 v20, v20, v22
    v_add_f32 v21, v21, v23
    v_permlane16_swap_b32 v12, v13
    v_permlane16_swap_b32 v16, v17
    v_permlane16_swap_b32 v20, v21
    s_lshr_b32 s32, s30, 2
    v_mov_b32 v10, s32
    v_add_f32 v12, v12, v13
    ds_write_b32 v8, v12 offset:0
    v_add_f32 v16, v16, v17
    ds_write_b32 v8, v16 offset:256
    v_add_f32 v20, v20, v21
    ds_write_b32 v8, v20 offset:512
    v_mov_b32 v11, 1
    s_mov_b64 exec, 1
    ds_add_u32 v10, v11 offset:60
    s_mov_b64 exec, -1
    v_add_u32 v8, 3072, v8
    v_mov_b32 v12, 0
    v_mov_b32 v13, 0
    v_mov_b32 v14, 0
    v_mov_b32 v15, 0
    v_mov_b32 v16, 0
    v_mov_b32 v17, 0
    v_mov_b32 v18, 0
    v_mov_b32 v19, 0
    v_mov_b32 v20, 0
    v_mov_b32 v21, 0
    v_mov_b32 v22, 0
    v_mov_b32 v23, 0
    s_cmp_lg_u32 s59, 0
    s_cbranch_scc1 L_vboost2
L_vend2:
    s_nop 1
    s_cmp_lg_u32 s30, 48
    s_cbranch_scc1 L_vloop
L_exit1:
    s_endpgm
L_deep:
    s_nop 1
    buffer_load_dwordx4 v[88:91], v48, s[12:15], 0 offen offset:1536 nt
    buffer_load_dwordx4 v[92:95], v48, s[12:15], 0 offen offset:1792 nt
    buffer_load_dwordx4 v[96:99], v48, s[12:15], 0 offen offset:2048 nt
    buffer_load_dwordx4 v[100:103], v48, s[12:15], 0 offen offset:2304 nt
    buffer_load_dwordx4 v[104:107], v48, s[12:15], 0 offen offset:2560 nt
    buffer_load_dwordx4 v[108:111], v48, s[12:15], 0 offen offset:2816 nt
    buffer_load_dwordx4 v[112:115], v48, s[12:15], 0 offen offset:3072 nt
    buffer_load_dwordx4 v[116:119], v48, s[12:15], 0 offen offset:3328 nt
    buffer_load_dwordx4 v[120:123], v48, s[12:15], 0 offen offset:3584 nt
    buffer_load_dwordx4 v[124:127], v49, s[12:15], 0 offen offset:0 nt
    buffer_load_dwordx4 v[128:131], v49, s[12:15], 0 offen offset:256 nt
    buffer_load_dwordx4 v[132:135], v49, s[12:15], 0 offen offset:512 nt
.p2align 6
L_dloop:
    s_nop 1
    s_add_u32 s29, s29, 4
    s_add_u32 s30, s30, 1
    s_lshr_b32 s33, s29, 6
    s_lshl_b32 s33, s33, 11
    s_and_b32 s32, s29, 63
    s_add_u32 s32, s32, s33
    s_add_u32 s32, s32, s44
    s_bfe_u32 s33, s32, 0x20003
    s_and_b32 s34, s32, 4
    s_or_b32 s33, s33, s34
    s_xor_b32 s33, s33, s5
    s_lshl_b32 s50, s32, 5
    s_or_b32 s50, s50, s33
    s_lshl_b32 s50, s50, 4
    s_or_b32 s50, s50, 1
    s_lshl_b32 s53, s29, 7
    v_xor_b32 v10, s50, v50
    v_mul_hi_u32 v10, v10, s47
    v_lshrrev_b32 v10, 1, v10
    v_and_b32 v11, 15, v10
    v_cmp_eq_u32 vcc, 5, v11
    v_mad_u32_u24 v48, v10, s45, v2
    v_add_u32 v11, 3840, v48
    v_cndmask_b32 v49, v51, v11, vcc
    v_add_u32 v10, s53, v5
    ds_read_b32 v7, v10
    s_waitcnt vmcnt(12)
    v_cvt_f32_i32 v64, v64
    v_cvt_f32_i32 v65, v65
    v_cvt_f32_i32 v66, v66
    v_cvt_f32_i32 v67, v67
    v_fmac_f32_dpp v12, v6, v64 row_newbcast:0 row_mask:0xf bank_mask:0xf
    v_fmac_f32_dpp v13, v6, v65 row_newbcast:0 row_mask:0xf bank_mask:0xf
    v_fmac_f32_dpp v14, v6, v66 row_newbcast:0 row_mask:0xf bank_mask:0xf
    v_fmac_f32_dpp v15, v6, v67 row_newbcast:0 row_mask:0xf bank_mask:0xf
    v_cvt_f32_i32 v68, v68
    v_cvt_f32_i32 v69, v69
    v_cvt_f32_i32 v70, v70
    v_cvt_f32_i32 v71, v71
    v_fmac_f32_dpp v16, v6, v68 row_newbcast:0 row_mask:0xf bank_mask:0xf
    v_fmac_f32_dpp v17, v6, v69 row_newbcast:0 row_mask:0xf bank_mask:0xf
    v_fmac_f32_dpp v18, v6, v70 row_newbcast:0 row_mask:0xf bank_mask:0xf
    v_fmac_f32_dpp v19, v6, v71 row_newbcast:0 row_mask:0xf bank_mask:0xf
    v_cvt_f32_i32 v72, v72
    v_cvt_f32_i32 v73, v73
    v_cvt_f32_i32 v74, v74
    v_cvt_f32_i32 v75, v75
    v_fmac_f32_dpp v20, v6, v72 row_newbcast:0 row_mask:0xf bank_mask:0xf
    v_fmac_f32_dpp v21, v6, v73 row_newbcast:0 row_mask:0xf bank_mask:0xf
    v_fmac_f32_dpp v22, v6, v74 row_newbcast:0 row_mask:0xf bank_mask:0xf
    v_fmac_f32_dpp v23, v6, v75 row_newbcast:0 row_mask:0xf bank_mask:0xf
    v_cvt_f32_i32 v76, v76
    v_cvt_f32_i32 v77, v77
    v_cvt_f32_i32 v78, v78
    v_cvt_f32_i32 v79, v79
    v_fmac_f32_dpp v12, v6, v76 row_newbcast:1 row_mask:0xf bank_mask:0xf
    v_fmac_f32_dpp v13, v6, v77 row_newbcast:1 row_mask:0xf bank_mask:0xf
    v_fmac_f32_dpp v14, v6, v78 row_newbcast:1 row_mask:0xf bank_mask:0xf
    v_fmac_f32_dpp v15, v6, v79 row_newbcast:1 row_mask:0xf bank_mask:0xf
    v_cvt_f32_i32 v80, v80
    v_cvt_f32_i32 v81, v81
    v_cvt_f32_i32 v82, v82
    v_cvt_f32_i32 v83, v83
    v_fmac_f32_dpp v16, v6, v80 row_newbcast:1 row_mask:0xf bank_mask:0xf
    v_fmac_f32_dpp v17, v6, v81 row_newbcast:1 row_mask:0xf bank_mask:0xf
    v_fmac_f32_dpp v18, v6, v82 row_newbcast:1 row_mask:0xf bank_mask:0xf
    v_fmac_f32_dpp v19, v6, v83 row_newbcast:1 row_mask:0xf bank_mask:0xf
    v_cvt_f32_i32 v84, v84
    v_cvt_f32_i32 v85, v85
    v_cvt_f32_i32 v86, v86
    v_cvt_f32_i32 v87, v87
    v_fmac_f32_dpp v20, v6, v84 row_newbcast:1 row_mask:0xf bank_mask:0xf
    v_fmac_f32_dpp v21, v6, v85 row_newbcast:1 row_mask:0xf bank_mask:0xf
    v_fmac_f32_dpp v22, v6, v86 row_newbcast:1 row_mask:0xf bank_mask:0xf
    v_fmac_f32_dpp v23, v6, v87 row_newbcast:1 row_mask:0xf bank_mask:0xf
    buffer_load_dwordx4 v[64:67], v48, s[12:15], 0 offen offset:0 nt
    buffer_load_dwordx4 v[68:71], v48, s[12:15], 0 offen offset:256 nt
    buffer_load_dwordx4 v[72:75], v48, s[12:15], 0 offen offset:512 nt
    buffer_load_dwordx4 v[76:79], v48, s[12:15], 0 offen offset:768 nt
    buffer_load_dwordx4 v[80:83], v48, s[12:15], 0 offen offset:1024 nt
    buffer_load_dwordx4 v[84:87], v48, s[12:15], 0 offen offset:1280 nt
    s_waitcnt vmcnt(12)
    s_cmp_eq_u32 s30, 48
    s_cbranch_scc1 L_el1
L_el1r:
    v_cvt_f32_i32 v88, v88
    v_cvt_f32_i32 v89, v89
    v_cvt_f32_i32 v90, v90
    v_cvt_f32_i32 v91, v91
    v_fmac_f32_dpp v12, v6, v88 row_newbcast:2 row_mask:0xf bank_mask:0xf
    v_fmac_f32_dpp v13, v6, v89 row_newbcast:2 row_mask:0xf bank_mask:0xf
    v_fmac_f32_dpp v14, v6, v90 row_newbcast:2 row_mask:0xf bank_mask:0xf
    v_fmac_f32_dpp v15, v6, v91 row_newbcast:2 row_mask:0xf bank_mask:0xf
    v_cvt_f32_i32 v92, v92
    v_cvt_f32_i32 v93, v93
    v_cvt_f32_i32 v94, v94
    v_cvt_f32_i32 v95, v95
    v_fmac_f32_dpp v16, v6, v92 row_newbcast:2 row_mask:0xf bank_mask:0xf
    v_fmac_f32_dpp v17, v6, v93 row_newbcast:2 row_mask:0xf bank_mask:0xf
    v_fmac_f32_dpp v18, v6, v94 row_newbcast:2 row_mask:0xf bank_mask:0xf
    v_fmac_f32_dpp v19, v6, v95 row_newbcast:2 row_mask:0xf bank_mask:0xf
    v_cvt_f32_i32 v96, v96
    v_cvt_f32_i32 v97, v97
    v_cvt_f32_i32 v98, v98
    v_cvt_f32_i32 v99, v99
    v_fmac_f32_dpp v20, v6, v96 row_newbcast:2 row_mask:0xf bank_mask:0xf
    v_fmac_f32_dpp v21, v6, v97 row_newbcast:2 row_mask:0xf bank_mask:0xf
    v_fmac_f32_dpp v22, v6, v98 row_newbcast:2 row_mask:0xf bank_mask:0xf
    v_fmac_f32_dpp v23, v6, v99 row_newbcast:2 row_mask:0xf bank_mask:0xf
    v_cvt_f32_i32 v100, v100
    v_cvt_f32_i32 v101, v101
    v_cvt_f32_i32 v102, v102
    v_cvt_f32_i32 v103, v103
    v_fmac_f32_dpp v12, v6, v100 row_newbcast:3 row_mask:0xf bank_mask:0xf
    v_fmac_f32_dpp v13, v6, v101 row_newbcast:3 row_mask:0xf bank_mask:0xf
    v_fmac_f32_dpp v14, v6, v102 row_newbcast:3 row_mask:0xf bank_mask:0xf
    v_fmac_f32_dpp v15, v6, v103 row_newbcast:3 row_mask:0xf bank_mask:0xf
    v_cvt_f32_i32 v104, v104
    v_cvt_f32_i32 v105, v105
    v_cvt_f32_i32 v106, v106
    v_cvt_f32_i32 v107, v107
    v_fmac_f32_dpp v16, v6, v104 row_newbcast:3 row_mask:0xf bank_mask:0xf
    v_fmac_f32_dpp v17, v6, v105 row_newbcast:3 row_mask:0xf bank_mask:0xf
    v_fmac_f32_dpp v18, v6, v106 row_newbcast:3 row_mask:0xf bank_mask:0xf
    v_fmac_f32_dpp v19, v6, v107 row_newbcast:3 row_mask:0xf bank_mask:0xf
    v_cvt_f32_i32 v108, v108
    v_cvt_f32_i32 v109, v109
    v_cvt_f32_i32 v110, v110
    v_cvt_f32_i32 v111, v111
    v_fmac_f32_dpp v20, v6, v108 row_newbcast:3 row_mask:0xf bank_mask:0xf
    v_fmac_f32_dpp v21, v6, v109 row_newbcast:3 row_mask:0xf bank_mask:0xf
    v_fmac_f32_dpp v22, v6, v110 row_newbcast:3 row_mask:0xf bank_mask:0xf
    v_fmac_f32_dpp v23, v6, v111 row_newbcast:3 row_mask:0xf bank_mask:0xf
    buffer_load_dwordx4 v[88:91], v48, s[12:15], 0 offen offset:1536 nt
    buffer_load_dwordx4 v[92:95], v48, s[12:15], 0 offen offset:1792 nt
    buffer_load_dwordx4 v[96:99], v48, s[12:15], 0 offen offset:2048 nt
    buffer_load_dwordx4 v[100:103], v48, s[12:15], 0 offen offset:2304 nt
    buffer_load_dwordx4 v[104:107], v48, s[12:15], 0 offen offset:2560 nt
    buffer_load_dwordx4 v[108:111], v48, s[12:15], 0 offen offset:2816 nt
    s_waitcnt vmcnt(12)
    v_cvt_f32_i32 v112, v112
    v_cvt_f32_i32 v113, v113
    v_cvt_f32_i32 v114, v114
    v_cvt_f32_i32 v115, v115
    v_fmac_f32_dpp v12, v6, v112 row_newbcast:4 row_mask:0xf bank_mask:0xf
    v_fmac_f32_dpp v13, v6, v113 row_newbcast:4 row_mask:0xf bank_mask:0xf
    v_fmac_f32_dpp v14, v6, v114 row_newbcast:4 row_mask:0xf bank_mask:0xf
    v_fmac_f32_dpp v15, v6, v115 row_newbcast:4 row_mask:0xf bank_mask:0xf
    v_cvt_f32_i32 v116, v116
    v_cvt_f32_i32 v117, v117
    v_cvt_f32_i32 v118, v118
    v_cvt_f32_i32 v119, v119
    v_fmac_f32_dpp v16, v6, v116 row_newbcast:4 row_mask:0xf bank_mask:0xf
    v_fmac_f32_dpp v17, v6, v117 row_newbcast:4 row_mask:0xf bank_mask:0xf
    v_fmac_f32_dpp v18, v6, v118 row_newbcast:4 row_mask:0xf bank_mask:0xf
    v_fmac_f32_dpp v19, v6, v119 row_newbcast:4 row_mask:0xf bank_mask:0xf
    v_cvt_f32_i32 v120, v120
    v_cvt_f32_i32 v121, v121
    v_cvt_f32_i32 v122, v122
    v_cvt_f32_i32 v123, v123
    v_fmac_f32_dpp v20, v6, v120 row_newbcast:4 row_mask:0xf bank_mask:0xf
    v_fmac_f32_dpp v21, v6, v121 row_newbcast:4 row_mask:0xf bank_mask:0xf
    v_fmac_f32_dpp v22, v6, v122 row_newbcast:4 row_mask:0xf bank_mask:0xf
    v_fmac_f32_dpp v23, v6, v123 row_newbcast:4 row_mask:0xf bank_mask:0xf
    v_cvt_f32_i32 v124, v124
    v_cvt_f32_i32 v125, v125
    v_cvt_f32_i32 v126, v126
    v_cvt_f32_i32 v127, v127
    v_fmac_f32_dpp v12, v6, v124 row_newbcast:5 row_mask:0xf bank_mask:0xf
    v_fmac_f32_dpp v13, v6, v125 row_newbcast:5 row_mask:0xf bank_mask:0xf
    v_fmac_f32_dpp v14, v6, v126 row_newbcast:5 row_mask:0xf bank_mask:0xf
    v_fmac_f32_dpp v15, v6, v127 row_newbcast:5 row_mask:0xf bank_mask:0xf
    v_cvt_f32_i32 v128, v128
    v_cvt_f32_i32 v129, v129
    v_cvt_f32_i32 v130, v130
    v_cvt_f32_i32 v131, v131
    v_fmac_f32_dpp v16, v6, v128 row_newbcast:5 row_mask:0xf bank_mask:0xf
    v_fmac_f32_dpp v17, v6, v129 row_newbcast:5 row_mask:0xf bank_mask:0xf
    v_fmac_f32_dpp v18, v6, v130 row_newbcast:5 row_mask:0xf bank_mask:0xf
    v_fmac_f32_dpp v19, v6, v131 row_newbcast:5 row_mask:0xf bank_mask:0xf
    v_cvt_f32_i32 v132, v132
    v_cvt_f32_i32 v133, v133
    v_cvt_f32_i32 v134, v134
    v_cvt_f32_i32 v135, v135
    v_fmac_f32_dpp v20, v6, v132 row_newbcast:5 row_mask:0xf bank_mask:0xf
    v_fmac_f32_dpp v21, v6, v133 row_newbcast:5 row_mask:0xf bank_mask:0xf
    v_fmac_f32_dpp v22, v6, v134 row_newbcast:5 row_mask:0xf bank_mask:0xf
    v_fmac_f32_dpp v23, v6, v135 row_newbcast:5 row_mask:0xf bank_mask:0xf
    buffer_load_dwordx4 v[112:115], v48, s[12:15], 0 offen offset:3072 nt
    buffer_load_dwordx4 v[116:119], v48, s[12:15], 0 offen offset:3328 nt
    buffer_load_dwordx4 v[120:123], v48, s[12:15], 0 offen offset:3584 nt
    buffer_load_dwordx4 v[124:127], v49, s[12:15], 0 offen offset:0 nt
    buffer_load_dwordx4 v[128:131], v49, s[12:15], 0 offen offset:256 nt
    buffer_load_dwordx4 v[132:135], v49, s[12:15], 0 offen offset:512 nt
    s_waitcnt lgkmcnt(0)
    v_mov_b32 v6, v7
    s_cmp_lg_u32 s30, 48
    s_cbranch_scc1 L_dloop
    s_branch L_vend
L_kboost:
    s_nop 1
    s_cmp_eq_u32 s30, 47
    s_cbranch_scc1 L_kchk2
    buffer_load_dwordx4 v[88:91], v48, s[8:11], 0 offen offset:1536 nt
    buffer_load_dwordx4 v[92:95], v48, s[8:11], 0 offen offset:1792 nt
    buffer_load_dwordx4 v[96:99], v48, s[8:11], 0 offen offset:2048 nt
    buffer_load_dwordx4 v[100:103], v48, s[8:11], 0 offen offset:2304 nt
    buffer_load_dwordx4 v[104:107], v48, s[8:11], 0 offen offset:2560 nt
    buffer_load_dwordx4 v[108:111], v48, s[8:11], 0 offen offset:2816 nt
    buffer_load_dwordx4 v[112:115], v48, s[8:11], 0 offen offset:3072 nt
    buffer_load_dwordx4 v[116:119], v48, s[8:11], 0 offen offset:3328 nt
    buffer_load_dwordx4 v[120:123], v48, s[8:11], 0 offen offset:3584 nt
    buffer_load_dwordx4 v[124:127], v49, s[8:11], 0 offen offset:0 nt
    buffer_load_dwordx4 v[128:131], v49, s[8:11], 0 offen offset:256 nt
    buffer_load_dwordx4 v[132:135], v49, s[8:11], 0 offen offset:512 nt
    s_sub_u32 s59, s59, 1
    s_add_u32 s29, s29, 4
    s_add_u32 s30, s30, 1
    s_bitcmp1_b64 s[40:41], s30
    s_cbranch_scc1 L_evKB
L_evretKB:
    s_nop 1
    s_lshr_b32 s33, s29, 6
    s_lshl_b32 s33, s33, 11
    s_and_b32 s32, s29, 63
    s_add_u32 s32, s32, s33
    s_add_u32 s32, s32, s44
    s_bfe_u32 s33, s32, 0x20003
    s_and_b32 s34, s32, 4
    s_or_b32 s33, s33, s34
    s_xor_b32 s33, s33, s5
    s_lshl_b32 s50, s32, 5
    s_or_b32 s50, s50, s33
    s_lshl_b32 s50, s50, 4
    s_or_b32 s50, s50, 1
    v_xor_b32 v10, s50, v50
    v_mul_hi_u32 v10, v10, s47
    v_lshrrev_b32 v10, 1, v10
    v_and_b32 v11, 15, v10
    v_cmp_eq_u32 vcc, 5, v11
    v_mad_u32_u24 v48, v10, s45, v2
    v_add_u32 v11, 3840, v48
    v_cndmask_b32 v49, v51, v11, vcc
    v_lshrrev_b32 v10, 6, v10
    v_mad_u32_u24 v9, v10, s46, v3
    buffer_load_dwordx2 v[42:43], v9, s[16:19], 0 offen offset:0
    buffer_load_dwordx2 v[44:45], v9, s[16:19], 0 offen offset:128
    buffer_load_dwordx2 v[46:47], v9, s[16:19], 0 offen offset:256
    s_waitcnt vmcnt(15)
    v_cvt_f32_i32 v64, v64
    v_cvt_f32_i32 v65, v65
    v_cvt_f32_i32 v66, v66
    v_cvt_f32_i32 v67, v67
    v_mul_f32 v54, v64, v24
    v_fmac_f32 v54, v65, v25
    v_fmac_f32 v54, v66, v26
    v_fmac_f32 v54, v67, v27
    v_cvt_f32_i32 v68, v68
    v_cvt_f32_i32 v69, v69
    v_cvt_f32_i32 v70, v70
    v_cvt_f32_i32 v71, v71
    v_fmac_f32 v54, v68, v28
    v_fmac_f32 v54, v69, v29
    v_fmac_f32 v54, v70, v30
    v_fmac_f32 v54, v71, v31
    v_cvt_f32_i32 v72, v72
    v_cvt_f32_i32 v73, v73
    v_cvt_f32_i32 v74, v74
    v_cvt_f32_i32 v75, v75
    v_fmac_f32 v54, v72, v32
    v_fmac_f32 v54, v73, v33
    v_fmac_f32 v54, v74, v34
    v_fmac_f32 v54, v75, v35
    v_cvt_f32_i32 v76, v76
    v_cvt_f32_i32 v77, v77
    v_add_f32_dpp v54, v54, v54 row_ror:8 row_mask:0xf bank_mask:0xf
    v_cvt_f32_i32 v78, v78
    v_cvt_f32_i32 v79, v79
    v_add_f32_dpp v54, v54, v54 row_ror:4 row_mask:0xf bank_mask:0xf
    v_mul_f32 v55, v76, v24
    v_fmac_f32 v55, v77, v25
    v_add_f32_dpp v54, v54, v54 row_ror:2 row_mask:0xf bank_mask:0xf
    v_fmac_f32 v55, v78, v26
    v_fmac_f32 v55, v79, v27
    v_add_f32_dpp v60, v54, v54 row_ror:1 row_mask:0xf bank_mask:0x1
    v_cvt_f32_i32 v80, v80
    v_cvt_f32_i32 v81, v81
    v_cvt_f32_i32 v82, v82
    v_cvt_f32_i32 v83, v83
    v_fmac_f32 v55, v80, v28
    v_fmac_f32 v55, v81, v29
    v_fmac_f32 v55, v82, v30
    v_fmac_f32 v55, v83, v31
    v_cvt_f32_i32 v84, v84
    v_cvt_f32_i32 v85, v85
    v_cvt_f32_i32 v86, v86
    v_cvt_f32_i32 v87, v87
    v_fmac_f32 v55, v84, v32
    v_fmac_f32 v55, v85, v33
    v_fmac_f32 v55, v86, v34
    v_fmac_f32 v55, v87, v35
    s_nop 1
    v_add_f32_dpp v55, v55, v55 row_ror:8 row_mask:0xf bank_mask:0xf
    s_nop 1
    v_add_f32_dpp v55, v55, v55 row_ror:4 row_mask:0xf bank_mask:0xf
    s_nop 1
    v_add_f32_dpp v55, v55, v55 row_ror:2 row_mask:0xf bank_mask:0xf
    s_nop 1
    v_add_f32_dpp v61, v55, v55 row_ror:1 row_mask:0xf bank_mask:0x1
    buffer_load_dwordx4 v[64:67], v48, s[8:11], 0 offen offset:0 nt
    buffer_load_dwordx4 v[68:71], v48, s[8:11], 0 offen offset:256 nt
    buffer_load_dwordx4 v[72:75], v48, s[8:11], 0 offen offset:512 nt
    buffer_load_dwordx4 v[76:79], v48, s[8:11], 0 offen offset:768 nt
    buffer_load_dwordx4 v[80:83], v48, s[8:11], 0 offen offset:1024 nt
    buffer_load_dwordx4 v[84:87], v48, s[8:11], 0 offen offset:1280 nt
    s_waitcnt vmcnt(15)
    v_cvt_f32_i32 v88, v88
    v_cvt_f32_i32 v89, v89
    v_cvt_f32_i32 v90, v90
    v_cvt_f32_i32 v91, v91
    v_mul_f32 v56, v88, v24
    v_fmac_f32 v56, v89, v25
    v_fmac_f32 v56, v90, v26
    v_fmac_f32 v56, v91, v27
    v_cvt_f32_i32 v92, v92
    v_cvt_f32_i32 v93, v93
    v_cvt_f32_i32 v94, v94
    v_cvt_f32_i32 v95, v95
    v_fmac_f32 v56, v92, v28
    v_fmac_f32 v56, v93, v29
    v_fmac_f32 v56, v94, v30
    v_fmac_f32 v56, v95, v31
    v_cvt_f32_i32 v96, v96
    v_cvt_f32_i32 v97, v97
    v_cvt_f32_i32 v98, v98
    v_cvt_f32_i32 v99, v99
    v_fmac_f32 v56, v96, v32
    v_fmac_f32 v56, v97, v33
    v_fmac_f32 v56, v98, v34
    v_fmac_f32 v56, v99, v35
    v_cvt_f32_i32 v100, v100
    v_cvt_f32_i32 v101, v101
    v_add_f32_dpp v56, v56, v56 row_ror:8 row_mask:0xf bank_mask:0xf
    v_cvt_f32_i32 v102, v102
    v_cvt_f32_i32 v103, v103
    v_add_f32_dpp v56, v56, v56 row_ror:4 row_mask:0xf bank_mask:0xf
    v_mul_f32 v57, v100, v24
    v_fmac_f32 v57, v101, v25
    v_add_f32_dpp v56, v56, v56 row_ror:2 row_mask:0xf bank_mask:0xf
    v_fmac_f32 v57, v102, v26
    v_fmac_f32 v57, v103, v27
    v_add_f32_dpp v60, v56, v56 row_ror:1 row_mask:0xf bank_mask:0x2
    v_cvt_f32_i32 v104, v104
    v_cvt_f32_i32 v105, v105
    v_cvt_f32_i32 v106, v106
    v_cvt_f32_i32 v107, v107
    v_fmac_f32 v57, v104, v28
    v_fmac_f32 v57, v105, v29
    v_fmac_f32 v57, v106, v30
    v_fmac_f32 v57, v107, v31
    v_cvt_f32_i32 v108, v108
    v_cvt_f32_i32 v109, v109
    v_cvt_f32_i32 v110, v110
    v_cvt_f32_i32 v111, v111
    v_fmac_f32 v57, v108, v32
    v_fmac_f32 v57, v109, v33
    v_fmac_f32 v57, v110, v34
    v_fmac_f32 v57, v111, v35
    s_nop 1
    v_add_f32_dpp v57, v57, v57 row_ror:8 row_mask:0xf bank_mask:0xf
    s_nop 1
    v_add_f32_dpp v57, v57, v57 row_ror:4 row_mask:0xf bank_mask:0xf
    s_nop 1
    v_add_f32_dpp v57, v57, v57 row_ror:2 row_mask:0xf bank_mask:0xf
    s_nop 1
    v_add_f32_dpp v61, v57, v57 row_ror:1 row_mask:0xf bank_mask:0x2
    s_waitcnt vmcnt(9)
    v_cvt_f32_i32 v112, v112
    v_cvt_f32_i32 v113, v113
    v_cvt_f32_i32 v114, v114
    v_cvt_f32_i32 v115, v115
    v_mul_f32 v58, v112, v24
    v_fmac_f32 v58, v113, v25
    v_fmac_f32 v58, v114, v26
    v_fmac_f32 v58, v115, v27
    v_cvt_f32_i32 v116, v116
    v_cvt_f32_i32 v117, v117
    v_cvt_f32_i32 v118, v118
    v_cvt_f32_i32 v119, v119
    v_fmac_f32 v58, v116, v28
    v_fmac_f32 v58, v117, v29
    v_fmac_f32 v58, v118, v30
    v_fmac_f32 v58, v119, v31
    v_cvt_f32_i32 v120, v120
    v_cvt_f32_i32 v121, v121
    v_cvt_f32_i32 v122, v122
    v_cvt_f32_i32 v123, v123
    v_fmac_f32 v58, v120, v32
    v_fmac_f32 v58, v121, v33
    v_fmac_f32 v58, v122, v34
    v_fmac_f32 v58, v123, v35
    v_cvt_f32_i32 v124, v124
    v_cvt_f32_i32 v125, v125
    v_add_f32_dpp v58, v58, v58 row_ror:8 row_mask:0xf bank_mask:0xf
    v_cvt_f32_i32 v126, v126
    v_cvt_f32_i32 v127, v127
    v_add_f32_dpp v58, v58, v58 row_ror:4 row_mask:0xf bank_mask:0xf
    v_mul_f32 v59, v124, v24
    v_fmac_f32 v59, v125, v25
    v_add_f32_dpp v58, v58, v58 row_ror:2 row_mask:0xf bank_mask:0xf
    v_fmac_f32 v59, v126, v26
    v_fmac_f32 v59, v127, v27
    v_add_f32_dpp v60, v58, v58 row_ror:1 row_mask:0xf bank_mask:0x4
    v_cvt_f32_i32 v128, v128
    v_cvt_f32_i32 v129, v129
    v_cvt_f32_i32 v130, v130
    v_cvt_f32_i32 v131, v131
    v_fmac_f32 v59, v128, v28
    v_fmac_f32 v59, v129, v29
    v_fmac_f32 v59, v130, v30
    v_fmac_f32 v59, v131, v31
    v_cvt_f32_i32 v132, v132
    v_cvt_f32_i32 v133, v133
    v_cvt_f32_i32 v134, v134
    v_cvt_f32_i32 v135, v135
    v_fmac_f32 v59, v132, v32
    v_fmac_f32 v59, v133, v33
    v_fmac_f32 v59, v134, v34
    v_fmac_f32 v59, v135, v35
    s_nop 1
    v_add_f32_dpp v59, v59, v59 row_ror:8 row_mask:0xf bank_mask:0xf
    s_nop 1
    v_add_f32_dpp v59, v59, v59 row_ror:4 row_mask:0xf bank_mask:0xf
    s_nop 1
    v_add_f32_dpp v59, v59, v59 row_ror:2 row_mask:0xf bank_mask:0xf
    s_nop 1
    v_add_f32_dpp v61, v59, v59 row_ror:1 row_mask:0xf bank_mask:0x4
    s_mov_b64 exec, s[42:43]
    ds_write_b64 v4, v[60:61]
    s_mov_b64 exec, -1
    v_add_u32 v4, 48, v4
    s_waitcnt vmcnt(6)
    v_lshlrev_b32 v10, 16, v36
    v_lshlrev_b32 v24, 16, v42
    v_and_b32 v11, 0xffff0000, v36
    v_and_b32 v25, 0xffff0000, v42
    v_mul_f32 v24, v24, v10
    v_mul_f32 v25, v25, v11
    v_lshlrev_b32 v10, 16, v37
    v_lshlrev_b32 v26, 16, v43
    v_and_b32 v11, 0xffff0000, v37
    v_and_b32 v27, 0xffff0000, v43
    v_mul_f32 v26, v26, v10
    v_mul_f32 v27, v27, v11
    v_lshlrev_b32 v10, 16, v38
    v_lshlrev_b32 v28, 16, v44
    v_and_b32 v11, 0xffff0000, v38
    v_and_b32 v29, 0xffff0000, v44
    v_mul_f32 v28, v28, v10
    v_mul_f32 v29, v29, v11
    v_lshlrev_b32 v10, 16, v39
    v_lshlrev_b32 v30, 16, v45
    v_and_b32 v11, 0xffff0000, v39
    v_and_b32 v31, 0xffff0000, v45
    v_mul_f32 v30, v30, v10
    v_mul_f32 v31, v31, v11
    v_lshlrev_b32 v10, 16, v40
    v_lshlrev_b32 v32, 16, v46
    v_and_b32 v11, 0xffff0000, v40
    v_and_b32 v33, 0xffff0000, v46
    v_mul_f32 v32, v32, v10
    v_mul_f32 v33, v33, v11
    v_lshlrev_b32 v10, 16, v41
    v_lshlrev_b32 v34, 16, v47
    v_and_b32 v11, 0xffff0000, v41
    v_and_b32 v35, 0xffff0000, v47
    v_mul_f32 v34, v34, v10
    v_mul_f32 v35, v35, v11
    s_branch L_kchk
L_vboost:
    s_nop 1
    s_and_b32 s32, s30, 15
    s_cbranch_scc0 L_vend
L_vboost2:
    s_nop 1
    s_cmp_eq_u32 s30, 48
    s_cbranch_scc1 L_vend2
    buffer_load_dwordx4 v[88:91], v48, s[12:15], 0 offen offset:1536 nt
    buffer_load_dwordx4 v[92:95], v48, s[12:15], 0 offen offset:1792 nt
    buffer_load_dwordx4 v[96:99], v48, s[12:15], 0 offen offset:2048 nt
    buffer_load_dwordx4 v[100:103], v48, s[12:15], 0 offen offset:2304 nt
    buffer_load_dwordx4 v[104:107], v48, s[12:15], 0 offen offset:2560 nt
    buffer_load_dwordx4 v[108:111], v48, s[12:15], 0 offen offset:2816 nt
    buffer_load_dwordx4 v[112:115], v48, s[12:15], 0 offen offset:3072 nt
    buffer_load_dwordx4 v[116:119], v48, s[12:15], 0 offen offset:3328 nt
    buffer_load_dwordx4 v[120:123], v48, s[12:15], 0 offen offset:3584 nt
    buffer_load_dwordx4 v[124:127], v49, s[12:15], 0 offen offset:0 nt
    buffer_load_dwordx4 v[128:131], v49, s[12:15], 0 offen offset:256 nt
    buffer_load_dwordx4 v[132:135], v49, s[12:15], 0 offen offset:512 nt
    s_sub_u32 s59, s59, 1
    s_add_u32 s29, s29, 4
    s_add_u32 s30, s30, 1
    s_bitcmp1_b64 s[40:41], s30
    s_cbranch_scc1 L_evVB
L_evretVB:
    s_nop 1
    s_lshr_b32 s33, s29, 6
    s_lshl_b32 s33, s33, 11
    s_and_b32 s32, s29, 63
    s_add_u32 s32, s32, s33
    s_add_u32 s32, s32, s44
    s_bfe_u32 s33, s32, 0x20003
    s_and_b32 s34, s32, 4
    s_or_b32 s33, s33, s34
    s_xor_b32 s33, s33, s5
    s_lshl_b32 s50, s32, 5
    s_or_b32 s50, s50, s33
    s_lshl_b32 s50, s50, 4
    s_or_b32 s50, s50, 1
    s_lshl_b32 s53, s29, 7
    v_xor_b32 v10, s50, v50
    v_mul_hi_u32 v10, v10, s47
    v_lshrrev_b32 v10, 1, v10
    v_and_b32 v11, 15, v10
    v_cmp_eq_u32 vcc, 5, v11
    v_mad_u32_u24 v48, v10, s45, v2
    v_add_u32 v11, 3840, v48
    v_cndmask_b32 v49, v51, v11, vcc
    v_add_u32 v10, s53, v5
    ds_read_b32 v7, v10
    s_waitcnt vmcnt(12)
    v_cvt_f32_i32 v64, v64
    v_cvt_f32_i32 v65, v65
    v_cvt_f32_i32 v66, v66
    v_cvt_f32_i32 v67, v67
    v_fmac_f32_dpp v12, v6, v64 row_newbcast:0 row_mask:0xf bank_mask:0xf
    v_fmac_f32_dpp v13, v6, v65 row_newbcast:0 row_mask:0xf bank_mask:0xf
    v_fmac_f32_dpp v14, v6, v66 row_newbcast:0 row_mask:0xf bank_mask:0xf
    v_fmac_f32_dpp v15, v6, v67 row_newbcast:0 row_mask:0xf bank_mask:0xf
    v_cvt_f32_i32 v68, v68
    v_cvt_f32_i32 v69, v69
    v_cvt_f32_i32 v70, v70
    v_cvt_f32_i32 v71, v71
    v_fmac_f32_dpp v16, v6, v68 row_newbcast:0 row_mask:0xf bank_mask:0xf
    v_fmac_f32_dpp v17, v6, v69 row_newbcast:0 row_mask:0xf bank_mask:0xf
    v_fmac_f32_dpp v18, v6, v70 row_newbcast:0 row_mask:0xf bank_mask:0xf
    v_fmac_f32_dpp v19, v6, v71 row_newbcast:0 row_mask:0xf bank_mask:0xf
    v_cvt_f32_i32 v72, v72
    v_cvt_f32_i32 v73, v73
    v_cvt_f32_i32 v74, v74
    v_cvt_f32_i32 v75, v75
    v_fmac_f32_dpp v20, v6, v72 row_newbcast:0 row_mask:0xf bank_mask:0xf
    v_fmac_f32_dpp v21, v6, v73 row_newbcast:0 row_mask:0xf bank_mask:0xf
    v_fmac_f32_dpp v22, v6, v74 row_newbcast:0 row_mask:0xf bank_mask:0xf
    v_fmac_f32_dpp v23, v6, v75 row_newbcast:0 row_mask:0xf bank_mask:0xf
    v_cvt_f32_i32 v76, v76
    v_cvt_f32_i32 v77, v77
    v_cvt_f32_i32 v78, v78
    v_cvt_f32_i32 v79, v79
    v_fmac_f32_dpp v12, v6, v76 row_newbcast:1 row_mask:0xf bank_mask:0xf
    v_fmac_f32_dpp v13, v6, v77 row_newbcast:1 row_mask:0xf bank_mask:0xf
    v_fmac_f32_dpp v14, v6, v78 row_newbcast:1 row_mask:0xf bank_mask:0xf
    v_fmac_f32_dpp v15, v6, v79 row_newbcast:1 row_mask:0xf bank_mask:0xf
    v_cvt_f32_i32 v80, v80
    v_cvt_f32_i32 v81, v81
    v_cvt_f32_i32 v82, v82
    v_cvt_f32_i32 v83, v83
    v_fmac_f32_dpp v16, v6, v80 row_newbcast:1 row_mask:0xf bank_mask:0xf
    v_fmac_f32_dpp v17, v6, v81 row_newbcast:1 row_mask:0xf bank_mask:0xf
    v_fmac_f32_dpp v18, v6, v82 row_newbcast:1 row_mask:0xf bank_mask:0xf
    v_fmac_f32_dpp v19, v6, v83 row_newbcast:1 row_mask:0xf bank_mask:0xf
    v_cvt_f32_i32 v84, v84
    v_cvt_f32_i32 v85, v85
    v_cvt_f32_i32 v86, v86
    v_cvt_f32_i32 v87, v87
    v_fmac_f32_dpp v20, v6, v84 row_newbcast:1 row_mask:0xf bank_mask:0xf
    v_fmac_f32_dpp v21, v6, v85 row_newbcast:1 row_mask:0xf bank_mask:0xf
    v_fmac_f32_dpp v22, v6, v86 row_newbcast:1 row_mask:0xf bank_mask:0xf
    v_fmac_f32_dpp v23, v6, v87 row_newbcast:1 row_mask:0xf bank_mask:0xf
    buffer_load_dwordx4 v[64:67], v48, s[12:15], 0 offen offset:0 nt
    buffer_load_dwordx4 v[68:71], v48, s[12:15], 0 offen offset:256 nt
    buffer_load_dwordx4 v[72:75], v48, s[12:15], 0 offen offset:512 nt
    buffer_load_dwordx4 v[76:79], v48, s[12:15], 0 offen offset:768 nt
    buffer_load_dwordx4 v[80:83], v48, s[12:15], 0 offen offset:1024 nt
    buffer_load_dwordx4 v[84:87], v48, s[12:15], 0 offen offset:1280 nt
    s_waitcnt vmcnt(12)
    s_cmp_eq_u32 s30, 48
    s_cbranch_scc1 L_el2
L_el2r:
    v_cvt_f32_i32 v88, v88
    v_cvt_f32_i32 v89, v89
    v_cvt_f32_i32 v90, v90
    v_cvt_f32_i32 v91, v91
    v_fmac_f32_dpp v12, v6, v88 row_newbcast:2 row_mask:0xf bank_mask:0xf
    v_fmac_f32_dpp v13, v6, v89 row_newbcast:2 row_mask:0xf bank_mask:0xf
    v_fmac_f32_dpp v14, v6, v90 row_newbcast:2 row_mask:0xf bank_mask:0xf
    v_fmac_f32_dpp v15, v6, v91 row_newbcast:2 row_mask:0xf bank_mask:0xf
    v_cvt_f32_i32 v92, v92
    v_cvt_f32_i32 v93, v93
    v_cvt_f32_i32 v94, v94
    v_cvt_f32_i32 v95, v95
    v_fmac_f32_dpp v16, v6, v92 row_newbcast:2 row_mask:0xf bank_mask:0xf
    v_fmac_f32_dpp v17, v6, v93 row_newbcast:2 row_mask:0xf bank_mask:0xf
    v_fmac_f32_dpp v18, v6, v94 row_newbcast:2 row_mask:0xf bank_mask:0xf
    v_fmac_f32_dpp v19, v6, v95 row_newbcast:2 row_mask:0xf bank_mask:0xf
    v_cvt_f32_i32 v96, v96
    v_cvt_f32_i32 v97, v97
    v_cvt_f32_i32 v98, v98
    v_cvt_f32_i32 v99, v99
    v_fmac_f32_dpp v20, v6, v96 row_newbcast:2 row_mask:0xf bank_mask:0xf
    v_fmac_f32_dpp v21, v6, v97 row_newbcast:2 row_mask:0xf bank_mask:0xf
    v_fmac_f32_dpp v22, v6, v98 row_newbcast:2 row_mask:0xf bank_mask:0xf
    v_fmac_f32_dpp v23, v6, v99 row_newbcast:2 row_mask:0xf bank_mask:0xf
    v_cvt_f32_i32 v100, v100
    v_cvt_f32_i32 v101, v101
    v_cvt_f32_i32 v102, v102
    v_cvt_f32_i32 v103, v103
    v_fmac_f32_dpp v12, v6, v100 row_newbcast:3 row_mask:0xf bank_mask:0xf
    v_fmac_f32_dpp v13, v6, v101 row_newbcast:3 row_mask:0xf bank_mask:0xf
    v_fmac_f32_dpp v14, v6, v102 row_newbcast:3 row_mask:0xf bank_mask:0xf
    v_fmac_f32_dpp v15, v6, v103 row_newbcast:3 row_mask:0xf bank_mask:0xf
    v_cvt_f32_i32 v104, v104
    v_cvt_f32_i32 v105, v105
    v_cvt_f32_i32 v106, v106
    v_cvt_f32_i32 v107, v107
    v_fmac_f32_dpp v16, v6, v104 row_newbcast:3 row_mask:0xf bank_mask:0xf
    v_fmac_f32_dpp v17, v6, v105 row_newbcast:3 row_mask:0xf bank_mask:0xf
    v_fmac_f32_dpp v18, v6, v106 row_newbcast:3 row_mask:0xf bank_mask:0xf
    v_fmac_f32_dpp v19, v6, v107 row_newbcast:3 row_mask:0xf bank_mask:0xf
    v_cvt_f32_i32 v108, v108
    v_cvt_f32_i32 v109, v109
    v_cvt_f32_i32 v110, v110
    v_cvt_f32_i32 v111, v111
    v_fmac_f32_dpp v20, v6, v108 row_newbcast:3 row_mask:0xf bank_mask:0xf
    v_fmac_f32_dpp v21, v6, v109 row_newbcast:3 row_mask:0xf bank_mask:0xf
    v_fmac_f32_dpp v22, v6, v110 row_newbcast:3 row_mask:0xf bank_mask:0xf
    v_fmac_f32_dpp v23, v6, v111 row_newbcast:3 row_mask:0xf bank_mask:0xf
    s_waitcnt vmcnt(6)
    v_cvt_f32_i32 v112, v112
    v_cvt_f32_i32 v113, v113
    v_cvt_f32_i32 v114, v114
    v_cvt_f32_i32 v115, v115
    v_fmac_f32_dpp v12, v6, v112 row_newbcast:4 row_mask:0xf bank_mask:0xf
    v_fmac_f32_dpp v13, v6, v113 row_newbcast:4 row_mask:0xf bank_mask:0xf
    v_fmac_f32_dpp v14, v6, v114 row_newbcast:4 row_mask:0xf bank_mask:0xf
    v_fmac_f32_dpp v15, v6, v115 row_newbcast:4 row_mask:0xf bank_mask:0xf
    v_cvt_f32_i32 v116, v116
    v_cvt_f32_i32 v117, v117
    v_cvt_f32_i32 v118, v118
    v_cvt_f32_i32 v119, v119
    v_fmac_f32_dpp v16, v6, v116 row_newbcast:4 row_mask:0xf bank_mask:0xf
    v_fmac_f32_dpp v17, v6, v117 row_newbcast:4 row_mask:0xf bank_mask:0xf
    v_fmac_f32_dpp v18, v6, v118 row_newbcast:4 row_mask:0xf bank_mask:0xf
    v_fmac_f32_dpp v19, v6, v119 row_newbcast:4 row_mask:0xf bank_mask:0xf
    v_cvt_f32_i32 v120, v120
    v_cvt_f32_i32 v121, v121
    v_cvt_f32_i32 v122, v122
    v_cvt_f32_i32 v123, v123
    v_fmac_f32_dpp v20, v6, v120 row_newbcast:4 row_mask:0xf bank_mask:0xf
    v_fmac_f32_dpp v21, v6, v121 row_newbcast:4 row_mask:0xf bank_mask:0xf
    v_fmac_f32_dpp v22, v6, v122 row_newbcast:4 row_mask:0xf bank_mask:0xf
    v_fmac_f32_dpp v23, v6, v123 row_newbcast:4 row_mask:0xf bank_mask:0xf
    v_cvt_f32_i32 v124, v124
    v_cvt_f32_i32 v125, v125
    v_cvt_f32_i32 v126, v126
    v_cvt_f32_i32 v127, v127
    v_fmac_f32_dpp v12, v6, v124 row_newbcast:5 row_mask:0xf bank_mask:0xf
    v_fmac_f32_dpp v13, v6, v125 row_newbcast:5 row_mask:0xf bank_mask:0xf
    v_fmac_f32_dpp v14, v6, v126 row_newbcast:5 row_mask:0xf bank_mask:0xf
    v_fmac_f32_dpp v15, v6, v127 row_newbcast:5 row_mask:0xf bank_mask:0xf
    v_cvt_f32_i32 v128, v128
    v_cvt_f32_i32 v129, v129
    v_cvt_f32_i32 v130, v130
    v_cvt_f32_i32 v131, v131
    v_fmac_f32_dpp v16, v6, v128 row_newbcast:5 row_mask:0xf bank_mask:0xf
    v_fmac_f32_dpp v17, v6, v129 row_newbcast:5 row_mask:0xf bank_mask:0xf
    v_fmac_f32_dpp v18, v6, v130 row_newbcast:5 row_mask:0xf bank_mask:0xf
    v_fmac_f32_dpp v19, v6, v131 row_newbcast:5 row_mask:0xf bank_mask:0xf
    v_cvt_f32_i32 v132, v132
    v_cvt_f32_i32 v133, v133
    v_cvt_f32_i32 v134, v134
    v_cvt_f32_i32 v135, v135
    v_fmac_f32_dpp v20, v6, v132 row_newbcast:5 row_mask:0xf bank_mask:0xf
    v_fmac_f32_dpp v21, v6, v133 row_newbcast:5 row_mask:0xf bank_mask:0xf
    v_fmac_f32_dpp v22, v6, v134 row_newbcast:5 row_mask:0xf bank_mask:0xf
    v_fmac_f32_dpp v23, v6, v135 row_newbcast:5 row_mask:0xf bank_mask:0xf
    s_waitcnt lgkmcnt(0)
    v_mov_b32 v6, v7
    s_branch L_vchk
L_el0:
    s_nop 1
    v_mov_b32 v11, 1
    s_mov_b64 exec, 1
    ds_add_u32 v53, v11 offset:136
    s_mov_b64 exec, -1
    s_branch L_el0r
L_el1:
    s_nop 1
    v_mov_b32 v11, 1
    s_mov_b64 exec, 1
    ds_add_u32 v53, v11 offset:136
    s_mov_b64 exec, -1
    s_branch L_el1r
L_el2:
    s_nop 1
    v_mov_b32 v11, 1
    s_mov_b64 exec, 1
    ds_add_u32 v53, v11 offset:136
    s_mov_b64 exec, -1
    s_branch L_el2r
L_evK:
    s_nop 1
    s_bitcmp1_b64 s[64:65], s30
    s_cbranch_scc0 L_paK
    s_memrealtime s[60:61]
    s_mov_b32 s72, s59
    v_mov_b32 v11, 1
    s_mov_b64 exec, 1
    ds_add_u32 v53, v11 offset:128
    s_mov_b64 exec, -1
L_paK:
    s_nop 1
    s_bitcmp1_b64 s[66:67], s30
    s_cbranch_scc0 L_pbK
    v_mov_b32 v11, 1
    s_mov_b64 exec, 1
    ds_add_u32 v53, v11 offset:128
    s_mov_b64 exec, -1
L_pbK:
    s_nop 1
    s_bitcmp1_b64 s[68:69], s30
    s_cbranch_scc0 L_pcK
    v_mov_b32 v11, s62
    ds_read_b32 v10, v11
    v_mov_b32 v11, 1
    s_mov_b64 exec, 1
    ds_add_u32 v53, v11 offset:128
    s_mov_b64 exec, -1
    s_add_u32 s62, s62, 4
    s_waitcnt lgkmcnt(0)
    v_readfirstlane_b32 s32, v10
    s_cmp_eq_u32 s32, 0
    s_cbranch_scc1 L_pcK
    s_sub_u32 s32, s60, s32
    s_max_i32 s32, s32, -4096
    s_min_i32 s32, s32, 4096
    s_mul_i32 s32, s32, 8
    s_add_u32 s32, s32, 512
    s_ashr_i32 s32, s32, 10
    s_sub_u32 s32, s32, s72
    s_add_u32 s32, s32, s59
    s_max_i32 s32, s32, 0
    s_min_i32 s59, s32, 6
L_pcK:
    s_nop 1
    s_bitcmp1_b64 s[70:71], s30
    s_cbranch_scc0 L_evretK
    s_and_b32 s32, s30, 15
    s_cbranch_scc0 L_evK2
    s_cmp_eq_u32 s30, 3
    s_cbranch_scc1 L_evK2
    s_lshr_b32 s33, s30, 2
    s_andn2_b32 s33, s33, 3
    s_add_u32 s33, s33, 36
    s_cmp_eq_u32 s32, 1
    s_cselect_b32 s32, s33, 60
    s_cselect_b32 s33, 5376, 0
    v_add_u32 v4, s33, v4
    s_cmp_eq_u32 s30, 2
    s_cselect_b32 s32, 56, s32
    v_mov_b32 v10, s32
    v_mov_b32 v11, 1
    s_mov_b64 exec, 1
    ds_add_u32 v10, v11 offset:0
    s_mov_b64 exec, -1
    s_branch L_evretK
L_evK2:
    s_nop 1
    s_cmp_eq_u32 s30, 16
    s_cbranch_scc0 L_gxtk16
    s_memrealtime s[36:37]
    s_mov_b32 s6, 0x100000
L_wgtk16:
    s_nop 1
    ds_read_b32 v10, v53 offset:208
    s_sub_u32 s6, s6, 1
    s_cbranch_scc1 L_exit1
    s_waitcnt lgkmcnt(0)
    v_readfirstlane_b32 s32, v10
    s_cmp_eq_u32 s32, 0
    s_cbranch_scc1 L_wgtk16
    s_and_b32 s32, s32, 0xffff
    s_cbranch_scc0 L_gxtk16
    s_add_u32 s32, s32, s36
L_gltk16:
    s_nop 1
    s_memrealtime s[36:37]
    s_waitcnt lgkmcnt(0)
    s_sub_u32 s36, s36, s32
    s_cmp_lt_i32 s36, 0
    s_cbranch_scc1 L_gltk16
L_gxtk16:
    s_nop 1
    s_cmp_eq_u32 s30, 32
    s_cbranch_scc0 L_gxtk32
    s_memrealtime s[36:37]
    s_mov_b32 s6, 0x100000
L_wgtk32:
    s_nop 1
    ds_read_b32 v10, v53 offset:212
    s_sub_u32 s6, s6, 1
    s_cbranch_scc1 L_exit1
    s_waitcnt lgkmcnt(0)
    v_readfirstlane_b32 s32, v10
    s_cmp_eq_u32 s32, 0
    s_cbranch_scc1 L_wgtk32
    s_and_b32 s32, s32, 0xffff
    s_cbranch_scc0 L_gxtk32
    s_add_u32 s32, s32, s36
L_gltk32:
    s_nop 1
    s_memrealtime s[36:37]
    s_waitcnt lgkmcnt(0)
    s_sub_u32 s36, s36, s32
    s_cmp_lt_i32 s36, 0
    s_cbranch_scc1 L_gltk32
L_gxtk32:
    s_nop 1
    s_lshr_b32 s33, s30, 4
    s_lshl_b32 s34, s33, 2
    v_mov_b32 v11, s34
    s_lshl_b32 s31, s33, 5
    s_add_u32 s31, s31, s3
    s_mul_i32 s31, s31, 171
    s_lshr_b32 s31, s31, 9
    s_mul_i32 s31, s31, 384
    buffer_load_dwordx2 v[36:37], v3, s[20:23], s31 offen offset:0
    buffer_load_dwordx2 v[38:39], v3, s[20:23], s31 offen offset:128
    buffer_load_dwordx2 v[40:41], v3, s[20:23], s31 offen offset:256
    s_mov_b32 s6, 0x100000
L_wtk:
    s_nop 1
    ds_read_b32 v10, v11 offset:0
    s_sub_u32 s6, s6, 1
    s_cbranch_scc1 L_exit1
    s_waitcnt lgkmcnt(0)
    v_readfirstlane_b32 s32, v10
    s_cmp_eq_u32 s32, 0
    s_cbranch_scc1 L_wtk
    s_and_b32 s5, s32, 7
    s_xor_b32 s5, s5, s48
    s_bitcmp1_b32 s32, 3
    s_cselect_b64 vcc, -1, 0
    v_cndmask_b32 v50, v62, v63, vcc
    s_branch L_evretK
L_evV:
    s_nop 1
    s_bitcmp1_b64 s[64:65], s30
    s_cbranch_scc0 L_paV
    s_memrealtime s[60:61]
    s_mov_b32 s72, s59
    v_mov_b32 v11, 1
    s_mov_b64 exec, 1
    ds_add_u32 v53, v11 offset:128
    s_mov_b64 exec, -1
L_paV:
    s_nop 1
    s_bitcmp1_b64 s[66:67], s30
    s_cbranch_scc0 L_pbV
    v_mov_b32 v11, 1
    s_mov_b64 exec, 1
    ds_add_u32 v53, v11 offset:128
    s_mov_b64 exec, -1
L_pbV:
    s_nop 1
    s_bitcmp1_b64 s[68:69], s30
    s_cbranch_scc0 L_pcV
    v_mov_b32 v11, s62
    ds_read_b32 v10, v11
    v_mov_b32 v11, 1
    s_mov_b64 exec, 1
    ds_add_u32 v53, v11 offset:128
    s_mov_b64 exec, -1
    s_add_u32 s62, s62, 4
    s_waitcnt lgkmcnt(0)
    v_readfirstlane_b32 s32, v10
    s_cmp_eq_u32 s32, 0
    s_cbranch_scc1 L_pcV
    s_sub_u32 s32, s60, s32
    s_max_i32 s32, s32, -4096
    s_min_i32 s32, s32, 4096
    s_cmp_eq_u32 s30, 44
    s_cbranch_scc0 L_pd
    s_mul_i32 s32, s32, 9
    s_add_u32 s32, s32, 2048
    s_ashr_i32 s32, s32, 10
    s_max_i32 s32, s32, 0
    s_min_i32 s32, s32, 4
    s_sub_u32 s49, 48, s32
    s_cmp_eq_u32 s49, 48
    s_cselect_b32 s49, 255, s49
    s_mov_b32 s59, 0
    s_branch L_pcV
L_pd:
    s_nop 1
    s_mul_i32 s32, s32, 8
    s_add_u32 s32, s32, 512
    s_ashr_i32 s32, s32, 10
    s_sub_u32 s32, s32, s72
    s_add_u32 s32, s32, s59
    s_max_i32 s32, s32, 0
    s_min_i32 s59, s32, 6
L_pcV:
    s_nop 1
    s_bitcmp1_b64 s[70:71], s30
    s_cbranch_scc0 L_evretV
    s_cmp_eq_u32 s30, 16
    s_cbranch_scc0 L_gxtv264
    s_memrealtime s[36:37]
    s_mov_b32 s6, 0x100000
L_wgtv264:
    s_nop 1
    ds_read_b32 v10, v53 offset:220
    s_sub_u32 s6, s6, 1
    s_cbranch_scc1 L_exit1
    s_waitcnt lgkmcnt(0)
    v_readfirstlane_b32 s32, v10
    s_cmp_eq_u32 s32, 0
    s_cbranch_scc1 L_wgtv264
    s_and_b32 s32, s32, 0xffff
    s_cbranch_scc0 L_gxtv264
    s_add_u32 s32, s32, s36
L_gltv264:
    s_nop 1
    s_memrealtime s[36:37]
    s_waitcnt lgkmcnt(0)
    s_sub_u32 s36, s36, s32
    s_cmp_lt_i32 s36, 0
    s_cbranch_scc1 L_gltv264
L_gxtv264:
    s_nop 1
    s_cmp_eq_u32 s30, 32
    s_cbranch_scc0 L_gxtv280
    s_memrealtime s[36:37]
    s_mov_b32 s6, 0x100000
L_wgtv280:
    s_nop 1
    ds_read_b32 v10, v53 offset:224
    s_sub_u32 s6, s6, 1
    s_cbranch_scc1 L_exit1
    s_waitcnt lgkmcnt(0)
    v_readfirstlane_b32 s32, v10
    s_cmp_eq_u32 s32, 0
    s_cbranch_scc1 L_wgtv280
    s_and_b32 s32, s32, 0xffff
    s_cbranch_scc0 L_gxtv280
    s_add_u32 s32, s32, s36
L_gltv280:
    s_nop 1
    s_memrealtime s[36:37]
    s_waitcnt lgkmcnt(0)
    s_sub_u32 s36, s36, s32
    s_cmp_lt_i32 s36, 0
    s_cbranch_scc1 L_gltv280
L_gxtv280:
    s_nop 1
    s_lshr_b32 s33, s30, 4
    s_lshl_b32 s34, s33, 2
    v_mov_b32 v11, s34
    s_mov_b32 s6, 0x100000
L_wtv2:
    s_nop 1
    ds_read_b32 v10, v11 offset:24
    s_sub_u32 s6, s6, 1
    s_cbranch_scc1 L_exit1
    s_waitcnt lgkmcnt(0)
    v_readfirstlane_b32 s32, v10
    s_cmp_eq_u32 s32, 0
    s_cbranch_scc1 L_wtv2
    s_and_b32 s5, s32, 7
    s_xor_b32 s5, s5, s48
    s_bitcmp1_b32 s32, 3
    s_cselect_b64 vcc, -1, 0
    v_cndmask_b32 v50, v62, v63, vcc
    s_branch L_evretV
L_evKB:
    s_nop 1
    s_bitcmp1_b64 s[64:65], s30
    s_cbranch_scc0 L_paKB
    s_memrealtime s[60:61]
    s_mov_b32 s72, s59
    v_mov_b32 v11, 1
    s_mov_b64 exec, 1
    ds_add_u32 v53, v11 offset:128
    s_mov_b64 exec, -1
L_paKB:
    s_nop 1
    s_bitcmp1_b64 s[66:67], s30
    s_cbranch_scc0 L_pbKB
    v_mov_b32 v11, 1
    s_mov_b64 exec, 1
    ds_add_u32 v53, v11 offset:128
    s_mov_b64 exec, -1
L_pbKB:
    s_nop 1
    s_bitcmp1_b64 s[68:69], s30
    s_cbranch_scc0 L_pcKB
    v_mov_b32 v11, s62
    ds_read_b32 v10, v11
    v_mov_b32 v11, 1
    s_mov_b64 exec, 1
    ds_add_u32 v53, v11 offset:128
    s_mov_b64 exec, -1
    s_add_u32 s62, s62, 4
    s_waitcnt lgkmcnt(0)
    v_readfirstlane_b32 s32, v10
    s_cmp_eq_u32 s32, 0
    s_cbranch_scc1 L_pcKB
    s_sub_u32 s32, s60, s32
    s_max_i32 s32, s32, -4096
    s_min_i32 s32, s32, 4096
    s_mul_i32 s32, s32, 8
    s_add_u32 s32, s32, 512
    s_ashr_i32 s32, s32, 10
    s_sub_u32 s32, s32, s72
    s_add_u32 s32, s32, s59
    s_max_i32 s32, s32, 0
    s_min_i32 s59, s32, 6
L_pcKB:
    s_nop 1
    s_bitcmp1_b64 s[70:71], s30
    s_cbranch_scc0 L_evretKB
    s_and_b32 s32, s30, 15
    s_cbranch_scc0 L_evK2B
    s_cmp_eq_u32 s30, 3
    s_cbranch_scc1 L_evK2B
    s_lshr_b32 s33, s30, 2
    s_andn2_b32 s33, s33, 3
    s_add_u32 s33, s33, 36
    s_cmp_eq_u32 s32, 1
    s_cselect_b32 s32, s33, 60
    s_cselect_b32 s33, 5376, 0
    v_add_u32 v4, s33, v4
    s_cmp_eq_u32 s30, 2
    s_cselect_b32 s32, 56, s32
    v_mov_b32 v10, s32
    v_mov_b32 v11, 1
    s_mov_b64 exec, 1
    ds_add_u32 v10, v11 offset:0
    s_mov_b64 exec, -1
    s_branch L_evretKB
L_evK2B:
    s_nop 1
    s_cmp_eq_u32 s30, 16
    s_cbranch_scc0 L_gxtkB16
    s_memrealtime s[36:37]
    s_mov_b32 s6, 0x100000
L_wgtkB16:
    s_nop 1
    ds_read_b32 v10, v53 offset:208
    s_sub_u32 s6, s6, 1
    s_cbranch_scc1 L_exit1
    s_waitcnt lgkmcnt(0)
    v_readfirstlane_b32 s32, v10
    s_cmp_eq_u32 s32, 0
    s_cbranch_scc1 L_wgtkB16
    s_and_b32 s32, s32, 0xffff
    s_cbranch_scc0 L_gxtkB16
    s_add_u32 s32, s32, s36
L_gltkB16:
    s_nop 1
    s_memrealtime s[36:37]
    s_waitcnt lgkmcnt(0)
    s_sub_u32 s36, s36, s32
    s_cmp_lt_i32 s36, 0
    s_cbranch_scc1 L_gltkB16
L_gxtkB16:
    s_nop 1
    s_cmp_eq_u32 s30, 32
    s_cbranch_scc0 L_gxtkB32
    s_memrealtime s[36:37]
    s_mov_b32 s6, 0x100000
L_wgtkB32:
    s_nop 1
    ds_read_b32 v10, v53 offset:212
    s_sub_u32 s6, s6, 1
    s_cbranch_scc1 L_exit1
    s_waitcnt lgkmcnt(0)
    v_readfirstlane_b32 s32, v10
    s_cmp_eq_u32 s32, 0
    s_cbranch_scc1 L_wgtkB32
    s_and_b32 s32, s32, 0xffff
    s_cbranch_scc0 L_gxtkB32
    s_add_u32 s32, s32, s36
L_gltkB32:
    s_nop 1
    s_memrealtime s[36:37]
    s_waitcnt lgkmcnt(0)
    s_sub_u32 s36, s36, s32
    s_cmp_lt_i32 s36, 0
    s_cbranch_scc1 L_gltkB32
L_gxtkB32:
    s_nop 1
    s_lshr_b32 s33, s30, 4
    s_lshl_b32 s34, s33, 2
    v_mov_b32 v11, s34
    s_lshl_b32 s31, s33, 5
    s_add_u32 s31, s31, s3
    s_mul_i32 s31, s31, 171
    s_lshr_b32 s31, s31, 9
    s_mul_i32 s31, s31, 384
    buffer_load_dwordx2 v[36:37], v3, s[20:23], s31 offen offset:0
    buffer_load_dwordx2 v[38:39], v3, s[20:23], s31 offen offset:128
    buffer_load_dwordx2 v[40:41], v3, s[20:23], s31 offen offset:256
    s_mov_b32 s6, 0x100000
L_wtkB:
    s_nop 1
    ds_read_b32 v10, v11 offset:0
    s_sub_u32 s6, s6, 1
    s_cbranch_scc1 L_exit1
    s_waitcnt lgkmcnt(0)
    v_readfirstlane_b32 s32, v10
    s_cmp_eq_u32 s32, 0
    s_cbranch_scc1 L_wtkB
    s_and_b32 s5, s32, 7
    s_xor_b32 s5, s5, s48
    s_bitcmp1_b32 s32, 3
    s_cselect_b64 vcc, -1, 0
    v_cndmask_b32 v50, v62, v63, vcc
    s_branch L_evretKB
L_evVB:
    s_nop 1
    s_bitcmp1_b64 s[64:65], s30
    s_cbranch_scc0 L_paVB
    s_memrealtime s[60:61]
    s_mov_b32 s72, s59
    v_mov_b32 v11, 1
    s_mov_b64 exec, 1
    ds_add_u32 v53, v11 offset:128
    s_mov_b64 exec, -1
L_paVB:
    s_nop 1
    s_bitcmp1_b64 s[66:67], s30
    s_cbranch_scc0 L_pbVB
    v_mov_b32 v11, 1
    s_mov_b64 exec, 1
    ds_add_u32 v53, v11 offset:128
    s_mov_b64 exec, -1
L_pbVB:
    s_nop 1
    s_bitcmp1_b64 s[68:69], s30
    s_cbranch_scc0 L_pcVB
    v_mov_b32 v11, s62
    ds_read_b32 v10, v11
    v_mov_b32 v11, 1
    s_mov_b64 exec, 1
    ds_add_u32 v53, v11 offset:128
    s_mov_b64 exec, -1
    s_add_u32 s62, s62, 4
    s_waitcnt lgkmcnt(0)
    v_readfirstlane_b32 s32, v10
    s_cmp_eq_u32 s32, 0
    s_cbranch_scc1 L_pcVB
    s_sub_u32 s32, s60, s32
    s_max_i32 s32, s32, -4096
    s_min_i32 s32, s32, 4096
    s_cmp_eq_u32 s30, 44
    s_cbranch_scc0 L_pdB
    s_mul_i32 s32, s32, 9
    s_add_u32 s32, s32, 2048
    s_ashr_i32 s32, s32, 10
    s_max_i32 s32, s32, 0
    s_min_i32 s32, s32, 4
    s_sub_u32 s49, 48, s32
    s_cmp_eq_u32 s49, 48
    s_cselect_b32 s49, 255, s49
    s_mov_b32 s59, 0
    s_branch L_pcVB
L_pdB:
    s_nop 1
    s_mul_i32 s32, s32, 8
    s_add_u32 s32, s32, 512
    s_ashr_i32 s32, s32, 10
    s_sub_u32 s32, s32, s72
    s_add_u32 s32, s32, s59
    s_max_i32 s32, s32, 0
    s_min_i32 s59, s32, 6
L_pcVB:
    s_nop 1
    s_bitcmp1_b64 s[70:71], s30
    s_cbranch_scc0 L_evretVB
    s_cmp_eq_u32 s30, 16
    s_cbranch_scc0 L_gxtv2B64
    s_memrealtime s[36:37]
    s_mov_b32 s6, 0x100000
L_wgtv2B64:
    s_nop 1
    ds_read_b32 v10, v53 offset:220
    s_sub_u32 s6, s6, 1
    s_cbranch_scc1 L_exit1
    s_waitcnt lgkmcnt(0)
    v_readfirstlane_b32 s32, v10
    s_cmp_eq_u32 s32, 0
    s_cbranch_scc1 L_wgtv2B64
    s_and_b32 s32, s32, 0xffff
    s_cbranch_scc0 L_gxtv2B64
    s_add_u32 s32, s32, s36
L_gltv2B64:
    s_nop 1
    s_memrealtime s[36:37]
    s_waitcnt lgkmcnt(0)
    s_sub_u32 s36, s36, s32
    s_cmp_lt_i32 s36, 0
    s_cbranch_scc1 L_gltv2B64
L_gxtv2B64:
    s_nop 1
    s_cmp_eq_u32 s30, 32
    s_cbranch_scc0 L_gxtv2B80
    s_memrealtime s[36:37]
    s_mov_b32 s6, 0x100000
L_wgtv2B80:
    s_nop 1
    ds_read_b32 v10, v53 offset:224
    s_sub_u32 s6, s6, 1
    s_cbranch_scc1 L_exit1
    s_waitcnt lgkmcnt(0)
    v_readfirstlane_b32 s32, v10
    s_cmp_eq_u32 s32, 0
    s_cbranch_scc1 L_wgtv2B80
    s_and_b32 s32, s32, 0xffff
    s_cbranch_scc0 L_gxtv2B80
    s_add_u32 s32, s32, s36
L_gltv2B80:
    s_nop 1
    s_memrealtime s[36:37]
    s_waitcnt lgkmcnt(0)
    s_sub_u32 s36, s36, s32
    s_cmp_lt_i32 s36, 0
    s_cbranch_scc1 L_gltv2B80
L_gxtv2B80:
    s_nop 1
    s_lshr_b32 s33, s30, 4
    s_lshl_b32 s34, s33, 2
    v_mov_b32 v11, s34
    s_mov_b32 s6, 0x100000
L_wtv2B:
    s_nop 1
    ds_read_b32 v10, v11 offset:24
    s_sub_u32 s6, s6, 1
    s_cbranch_scc1 L_exit1
    s_waitcnt lgkmcnt(0)
    v_readfirstlane_b32 s32, v10
    s_cmp_eq_u32 s32, 0
    s_cbranch_scc1 L_wtv2B
    s_and_b32 s5, s32, 7
    s_xor_b32 s5, s5, s48
    s_bitcmp1_b32 s32, 3
    s_cselect_b64 vcc, -1, 0
    v_cndmask_b32 v50, v62, v63, vcc
    s_branch L_evretVB
L_helper:
    s_nop 1
    s_sub_u32 s6, s28, 4
    s_mov_b32 s5, s48
    v_and_b32 v1, 63, v0
    v_mov_b32 v2, 0
    s_mul_i32 s59, s3, 34816
    s_add_u32 s59, s59, 8388608
    s_cmp_eq_u32 s6, 3
    s_cbranch_scc1 L_h3
    s_mul_i32 s48, s6, 25
    s_sub_u32 s48, s48, 22
    s_cmp_lt_i32 s3, s48
    s_cselect_b32 s90, 1, 0
    s_cbranch_scc0 L_noprobe1
    s_add_u32 s49, s3, 2
    s_mul_i32 s48, s49, 205
    s_lshr_b32 s48, s48, 10
    s_mul_i32 s7, s48, 5
    s_sub_u32 s7, s49, s7
    s_add_u32 s7, s7, 1
    s_lshl_b32 s49, s3, 1
    s_add_u32 s49, s49, s6
    s_sub_u32 s49, s49, 1
    s_cmp_lt_u32 s3, 3
    s_cselect_b32 s7, 0, s7
    s_cselect_b32 s49, s49, s48
    s_and_b32 s48, s49, 1
    s_mul_i32 s20, s49, 20
    s_add_u32 s20, s20, s48
    s_add_u32 s20, s20, 2
    s_lshr_b32 s91, s20, 5
    s_xor_b32 s91, s91, s4
    s_lshl_b32 s20, s20, 21
    s_xor_b32 s21, s4, s6
    s_and_b32 s21, s21, 1
    s_lshr_b32 s49, s4, 2
    s_xor_b32 s48, s48, s49
    s_xor_b32 s48, s48, s21
    s_lshl_b32 s48, s48, 13
    s_lshl_b32 s49, s6, 14
    s_and_b32 s49, s49, 0x4000
    s_or_b32 s48, s48, s49
    s_xor_b32 s32, s48, 0x0
    s_xor_b32 s33, s48, 0x2000
    s_xor_b32 s34, s48, 0x1000
    s_xor_b32 s35, s48, 0x3000
    s_xor_b32 s36, s48, 0x4000
    s_xor_b32 s37, s48, 0x6000
    s_xor_b32 s38, s48, 0x5000
    s_xor_b32 s39, s48, 0x7000
    v_and_b32 v3, 7, v1
    v_lshlrev_b32 v3, 12, v3
    s_lshl_b32 s48, s4, 8
    v_add_u32 v3, s48, v3
    s_mov_b32 s10, 805306368
    s_mov_b32 s11, 0x00020000
    s_cmp_ge_u32 s7, 3
    s_cselect_b32 s48, 3, 0
    s_sub_u32 s48, s7, s48
    s_lshl_b32 s48, s48, 28
    s_add_u32 s20, s20, s48
    s_cmp_ge_u32 s7, 3
    s_waitcnt lgkmcnt(0)
    s_cselect_b32 s8, s68, s66
    s_cselect_b32 s23, s69, s67
    s_and_b32 s9, s23, 0xffff
    s_add_u32 s22, s8, s20
    s_addc_u32 s23, s23, 0
    s_lshl_b32 s48, s4, 8
    s_add_u32 s56, s22, s48
    s_addc_u32 s57, s23, 0
    s_load_dword s24, s[56:57], 0x0
    s_load_dword s25, s[56:57], 0x1000
    s_load_dword s26, s[56:57], 0x2000
    s_load_dword s27, s[56:57], 0x3000
    s_load_dword s28, s[56:57], 0x4000
    s_load_dword s29, s[56:57], 0x5000
    s_load_dword s30, s[56:57], 0x6000
    s_load_dword s31, s[56:57], 0x7000
    s_mov_b32 s12, s82
    s_and_b32 s13, s83, 0xffff
    s_mov_b32 s14, 10485760
    s_mov_b32 s15, 0x00020000
    s_lshl_b32 s48, s2, 1
    s_add_u32 s48, s48, s6
    s_mul_i32 s48, s48, 26112
    s_add_u32 s48, s48, 8362496
    v_mul_u32_u24 v5, 4352, v1
    v_mov_b32 v3, 0
    v_mov_b32 v4, 0
    s_cmp_eq_u32 s7, 0
    s_cselect_b64 exec, 0x3f, 0
    buffer_store_dwordx3 v[2:4], v5, s[12:15], s48 offen sc1
    s_mov_b64 exec, -1
    s_cmp_lg_u32 s7, 0
    s_cbranch_scc1 L_noprobe2
L_noprobe1:
    s_nop 1
    s_waitcnt lgkmcnt(0)
L_noprobe2:
    s_nop 1
    s_mov_b32 s12, s82
    s_and_b32 s13, s83, 0xffff
    s_mov_b32 s14, 10485760
    s_mov_b32 s15, 0x00020000
    s_mov_b32 s16, s80
    s_and_b32 s17, s81, 0xffff
    s_mov_b32 s18, 256
    s_mov_b32 s19, 0x00020000
    s_cmp_lg_u32 s6, 0
    s_cbranch_scc1 L_hbar
    v_lshlrev_b32 v5, 2, v1
    ds_write_b32 v5, v2
    s_waitcnt lgkmcnt(0)
L_hbar:
    s_nop 1
    s_barrier
    s_cmp_eq_u32 s90, 0
    s_cbranch_scc1 L_role
    s_mov_b32 s46, 1
    s_mov_b32 s58, 0
    s_mov_b32 s61, 0
    s_mov_b32 s62, 0
    s_mov_b32 s63, 0
    s_cmp_eq_u32 s7, 0
    s_cselect_b32 s47, 1, 7
    s_waitcnt lgkmcnt(0)
L_round:
    s_nop 1
    s_add_u32 s48, s4, s46
    s_and_b32 s48, s48, 7
    s_lshl_b32 s48, s48, 8
    s_add_u32 s56, s22, s48
    s_addc_u32 s57, s23, 0
    s_mov_b32 s44, -1
    s_memtime s[40:41]
    s_waitcnt lgkmcnt(0)
    s_load_dword s45, s[56:57], s32
    s_waitcnt lgkmcnt(0)
    s_memtime s[42:43]
    s_waitcnt lgkmcnt(0)
    s_sub_u32 s24, s42, s40
    s_load_dword s45, s[56:57], s33
    s_waitcnt lgkmcnt(0)
    s_memtime s[40:41]
    s_waitcnt lgkmcnt(0)
    s_sub_u32 s25, s40, s42
    s_load_dword s45, s[56:57], s34
    s_waitcnt lgkmcnt(0)
    s_memtime s[42:43]
    s_waitcnt lgkmcnt(0)
    s_sub_u32 s26, s42, s40
    s_load_dword s45, s[56:57], s35
    s_waitcnt lgkmcnt(0)
    s_memtime s[40:41]
    s_waitcnt lgkmcnt(0)
    s_sub_u32 s27, s40, s42
    s_mov_b32 s28, -1
    s_mov_b32 s29, -1
    s_mov_b32 s30, -1
    s_mov_b32 s31, -1
    s_cmp_eq_u32 s7, 0
    s_cbranch_scc1 L_few
    s_load_dword s45, s[56:57], s36
    s_waitcnt lgkmcnt(0)
    s_memtime s[42:43]
    s_waitcnt lgkmcnt(0)
    s_sub_u32 s28, s42, s40
    s_load_dword s45, s[56:57], s37
    s_waitcnt lgkmcnt(0)
    s_memtime s[40:41]
    s_waitcnt lgkmcnt(0)
    s_sub_u32 s29, s40, s42
    s_load_dword s45, s[56:57], s38
    s_waitcnt lgkmcnt(0)
    s_memtime s[42:43]
    s_waitcnt lgkmcnt(0)
    s_sub_u32 s30, s42, s40
    s_load_dword s45, s[56:57], s39
    s_waitcnt lgkmcnt(0)
    s_memtime s[40:41]
    s_waitcnt lgkmcnt(0)
    s_sub_u32 s31, s40, s42
L_few:
    s_nop 1
    s_min_u32 s24, s24, 1400
    s_min_u32 s44, s44, s24
    s_min_u32 s25, s25, 1400
    s_min_u32 s44, s44, s25
    s_min_u32 s26, s26, 1400
    s_min_u32 s44, s44, s26
    s_min_u32 s27, s27, 1400
    s_min_u32 s44, s44, s27
    s_min_u32 s28, s28, 1400
    s_min_u32 s44, s44, s28
    s_min_u32 s29, s29, 1400
    s_min_u32 s44, s44, s29
    s_min_u32 s30, s30, 1400
    s_min_u32 s44, s44, s30
    s_min_u32 s31, s31, 1400
    s_min_u32 s44, s44, s31
    s_cmp_lt_u32 s44, 290
    s_cbranch_scc1 L_skip
    s_sub_u32 s58, s58, s24
    s_add_u32 s58, s58, s25
    s_sub_u32 s58, s58, s26
    s_add_u32 s58, s58, s27
    s_sub_u32 s58, s58, s28
    s_add_u32 s58, s58, s29
    s_sub_u32 s58, s58, s30
    s_add_u32 s58, s58, s31
    s_cmp_eq_u32 s7, 0
    s_cbranch_scc1 L_skip
    s_min_u32 s48, s24, s26
    s_min_u32 s50, s28, s30
    s_min_u32 s48, s48, s50
    s_add_u32 s48, s48, 100
    s_min_u32 s49, s25, s27
    s_min_u32 s50, s29, s31
    s_min_u32 s49, s49, s50
    s_add_u32 s49, s49, 100
    s_min_u32 s24, s24, s48
    s_min_u32 s25, s25, s49
    s_min_u32 s26, s26, s48
    s_min_u32 s27, s27, s49
    s_min_u32 s28, s28, s48
    s_min_u32 s29, s29, s49
    s_min_u32 s30, s30, s48
    s_min_u32 s31, s31, s49
    s_sub_u32 s61, s61, s24
    s_sub_u32 s62, s62, s24
    s_sub_u32 s63, s63, s24
    s_add_u32 s61, s61, s25
    s_sub_u32 s62, s62, s25
    s_add_u32 s63, s63, s25
    s_add_u32 s61, s61, s26
    s_sub_u32 s62, s62, s26
    s_sub_u32 s63, s63, s26
    s_sub_u32 s61, s61, s27
    s_sub_u32 s62, s62, s27
    s_add_u32 s63, s63, s27
    s_sub_u32 s61, s61, s28
    s_add_u32 s62, s62, s28
    s_add_u32 s63, s63, s28
    s_add_u32 s61, s61, s29
    s_add_u32 s62, s62, s29
    s_sub_u32 s63, s63, s29
    s_add_u32 s61, s61, s30
    s_add_u32 s62, s62, s30
    s_add_u32 s63, s63, s30
    s_sub_u32 s61, s61, s31
    s_add_u32 s62, s62, s31
    s_sub_u32 s63, s63, s31
L_skip:
    s_nop 1
    s_add_u32 s46, s46, 1
    s_cmp_le_u32 s46, s47
    s_cbranch_scc1 L_round
    s_sub_u32 s48, 0, s58
    s_cmp_eq_u32 s21, 0
    s_cselect_b32 s58, s58, s48
    s_add_u32 s58, s58, 0x1010000
    v_mov_b32 v4, s58
    s_mov_b64 exec, 1
    s_lshl_b32 s48, s7, 2
    s_add_u32 s48, s48, 124
    s_cmp_eq_u32 s7, 0
    s_cbranch_scc0 L_post
    s_waitcnt vmcnt(0)
    ds_add_rtn_u32 v5, v2, v4 offset:36
    s_mov_b32 s48, 0
    s_waitcnt lgkmcnt(0)
    v_add_u32 v4, v4, v5
    v_cmp_ne_u32 vcc, 0, v5
    s_and_b64 exec, exec, vcc
    buffer_atomic_add v4, off, s[16:19], s48
    s_branch L_posted
L_post:
    s_nop 1
    s_mov_b32 s60, 0x100000
L_wvw:
    s_nop 1
    ds_read_b32 v10, v2 offset:0
    s_sub_u32 s60, s60, 1
    s_cbranch_scc1 L_exit1
    s_waitcnt lgkmcnt(0)
    v_readfirstlane_b32 s48, v10
    s_cmp_eq_u32 s48, 0
    s_cbranch_scc1 L_wvw
    s_lshr_b32 s48, s91, 1
    s_xor_b32 s48, s48, s21
    s_sub_u32 s49, 0, s61
    s_bitcmp1_b32 s48, 0
    s_cselect_b32 s61, s49, s61
    s_xor_b32 s48, s91, s21
    s_bitcmp1_b32 s4, 0
    s_cselect_b32 s48, s91, s48
    s_cselect_b32 s62, s62, s63
    s_sub_u32 s49, 0, s62
    s_bitcmp1_b32 s48, 0
    s_cselect_b32 s62, s49, s62
    s_add_u32 s61, s61, 0x1010000
    v_writelane_b32 v4, s61, 1
    s_add_u32 s62, s62, 0x1010000
    v_writelane_b32 v4, s62, 2
    s_lshl_b32 s48, s7, 2
    s_and_b32 s49, s4, 1
    s_or_b32 s48, s48, s49
    s_lshr_b32 s49, s4, 1
    s_and_b32 s49, s49, 2
    s_or_b32 s48, s48, s49
    s_mul_i32 s48, s48, 4352
    s_add_u32 s48, s48, 9485312
    s_mov_b64 exec, 7
    v_lshlrev_b32 v5, 2, v1
    buffer_atomic_add v4, v5, s[12:15], s48 offen
L_posted:
    s_nop 1
    s_mov_b64 exec, -1
L_role:
    s_nop 1
    s_cmp_eq_u32 s6, 0
    s_cbranch_scc1 L_h0
    s_cmp_eq_u32 s6, 2
    s_cbranch_scc1 L_h2
    v_lshlrev_b32 v5, 2, v1
    s_mov_b32 s60, 0x100000
L_wea:
    s_nop 1
    ds_read_b32 v10, v2 offset:56
    s_sub_u32 s60, s60, 1
    s_cbranch_scc1 L_exit1
    s_waitcnt lgkmcnt(0)
    v_readfirstlane_b32 s48, v10
    s_cmp_lt_u32 s48, 4
    s_cbranch_scc1 L_wea
    s_mov_b64 exec, 0x1
    s_mov_b32 s60, 0x40000
L_polla:
    s_nop 1
    buffer_load_dword v4, v5, s[16:19], 0 offen offset:0 sc1
    s_sub_u32 s60, s60, 1
    s_cbranch_scc1 L_exit1
L_pollwa:
    s_waitcnt vmcnt(0)
    v_lshrrev_b32 v6, 24, v4
    v_cmp_ne_u32 vcc, 48, v6
    s_cbranch_vccnz L_polla
    v_and_b32 v4, 0xffffff, v4
    v_subrev_u32 v4, 3145728, v4
    v_lshrrev_b32 v6, 30, v4
    v_and_b32 v6, 2, v6
    v_add_u32 v4, 4800, v4
    v_cmp_gt_u32 vcc, 9600, v4
    s_nop 1
    v_cndmask_b32 v6, v6, 8, vcc
    v_or_b32 v6, 16, v6
    ds_write_b32 v5, v6 offset:0
    s_mov_b64 exec, -1
    s_mov_b32 s60, 0x100000
L_web:
    s_nop 1
    ds_read_b32 v10, v2 offset:60
    s_sub_u32 s60, s60, 1
    s_cbranch_scc1 L_exit1
    s_waitcnt lgkmcnt(0)
    v_readfirstlane_b32 s48, v10
    s_cmp_eq_u32 s48, 0
    s_cbranch_scc1 L_web
    v_mul_u32_u24 v7, 4352, v1
    s_mov_b32 s48, 9502720
    s_mov_b64 exec, 0xfffff
    s_mov_b32 s60, 0x40000
L_pollb:
    s_nop 1
    buffer_load_dwordx3 v[16:18], v7, s[12:15], s48 offen sc1
    s_sub_u32 s60, s60, 1
    s_cbranch_scc1 L_exit1
    s_waitcnt vmcnt(0)
    v_min3_u32 v6, v16, v17, v18
    v_lshrrev_b32 v6, 24, v6
    v_cmp_ne_u32 vcc, 10, v6
    s_cbranch_vccnz L_pollb
    v_subrev_u32 v16, 0xa0a0000, v16
    v_subrev_u32 v17, 0xa0a0000, v17
    v_subrev_u32 v18, 0xa0a0000, v18
    v_add_u32_dpp v16, v16, v16 quad_perm:[1,0,3,2] row_mask:0xf bank_mask:0xf
    v_add_u32_dpp v17, v17, v17 quad_perm:[1,0,3,2] row_mask:0xf bank_mask:0xf
    s_nop 0
    v_add_u32_dpp v16, v16, v16 quad_perm:[2,3,0,1] row_mask:0xf bank_mask:0xf
    v_add_u32_dpp v17, v17, v17 quad_perm:[2,3,0,1] row_mask:0xf bank_mask:0xf
    v_ashrrev_i32 v6, 31, v16
    v_xor_b32 v17, v17, v6
    v_xor_b32 v4, v18, v6
    s_mov_b64 vcc, 0x55555
    v_cndmask_b32 v18, v18, v4, vcc
    s_nop 1
    v_add_u32_dpp v18, v18, v18 quad_perm:[1,0,3,2] row_mask:0xf bank_mask:0xf
    s_nop 1
    v_add_u32_dpp v18, v18, v18 quad_perm:[2,3,0,1] row_mask:0xf bank_mask:0xf
    v_and_b32 v20, 2, v6
    v_or_b32 v4, 1, v20
    v_cmp_gt_i32 vcc, -2800, v17
    s_nop 1
    v_cndmask_b32 v20, v20, v4, vcc
    v_or_b32 v4, 4, v20
    v_cmp_gt_i32 vcc, -2800, v18
    s_nop 1
    v_cndmask_b32 v20, v20, v4, vcc
    v_add_u32 v4, 56000, v16
    v_cmp_gt_u32 vcc, 112000, v4
    s_nop 1
    v_cndmask_b32 v20, v20, 8, vcc
    v_and_b32 v20, 15, v20
    s_nop 0
    v_readlane_b32 s24, v20, 0
    v_readlane_b32 s25, v20, 4
    v_readlane_b32 s26, v20, 8
    v_readlane_b32 s27, v20, 12
    v_readlane_b32 s28, v20, 16
    s_xor_b32 s48, s24, s27
    s_and_b32 s48, s48, 10
    s_cselect_b32 s24, s24, s27
    s_xor_b32 s48, s25, s28
    s_and_b32 s48, s48, 10
    s_cselect_b32 s25, s25, s28
    s_or_b32 s24, s24, 16
    v_writelane_b32 v6, s24, 0
    s_or_b32 s25, s25, 16
    v_writelane_b32 v6, s25, 1
    s_or_b32 s26, s26, 16
    v_writelane_b32 v6, s26, 2
    s_or_b32 s27, s27, 16
    v_writelane_b32 v6, s27, 3
    s_or_b32 s28, s28, 16
    v_writelane_b32 v6, s28, 4
    s_mov_b64 exec, 0x1f
    ds_write_b32 v5, v6 offset:4
    s_mov_b64 exec, -1
    s_and_b32 s48, s3, 7
    s_cmp_lg_u32 s48, s4
    s_cbranch_scc1 L_exit1
    s_mul_i32 s48, s3, 3
    s_add_u32 s48, s48, 2
    s_lshr_b32 s48, s48, 5
    s_lshl_b32 s48, s48, 2
    v_mov_b32 v3, s48
    s_mul_i32 s57, s3, 24
    v_add_u32 v13, s57, v1
    v_and_b32 v12, 255, v13
    v_mul_u32_u24 v12, 4352, v12
    v_lshlrev_b32 v13, 6, v13
    s_mov_b32 s49, 8388608
    s_mov_b32 s50, 917504
    v_mov_b32 v4, 0xf149f2ca
    v_mov_b32 v5, 0
    s_mov_b32 s51, 93
    s_cmp_eq_u32 s48, 4
    s_cselect_b32 s51, 117, s51
    s_cmp_eq_u32 s48, 8
    s_cselect_b32 s51, 81, s51
    s_mov_b32 s60, 0x100000
L_wcg:
    s_nop 1
    ds_read_b32 v10, v2 offset:128
    s_sub_u32 s60, s60, 1
    s_cbranch_scc1 L_exit1
    s_waitcnt lgkmcnt(0)
    v_readfirstlane_b32 s48, v10
    s_cmp_lt_u32 s48, s51
    s_cbranch_scc1 L_wcg
    s_mov_b64 exec, 0xffffff
    s_mov_b32 s60, 0x40000
L_cpf:
    s_nop 1
    buffer_load_dword v7, v12, s[12:15], s49 offen sc1
    s_sub_u32 s60, s60, 1
    s_cbranch_scc1 L_exit1
    s_waitcnt vmcnt(0)
    v_cmpx_eq_u32 vcc, 0, v7
    s_cbranch_execnz L_cpf
    s_mov_b64 exec, 0xffffff
    s_mov_b32 s60, 0x40000
L_cpm:
    s_nop 1
    buffer_load_dwordx4 v[4:7], v13, s[12:15], s50 offen sc1
    s_sub_u32 s60, s60, 1
    s_cbranch_scc1 L_exit1
    s_waitcnt vmcnt(0)
    v_cmpx_eq_u32 vcc, 0, v7
    s_cbranch_execnz L_cpm
    s_mov_b64 exec, -1
    v_mov_b32 v6, v4
    s_nop 1
    v_max_f32_dpp v6, v6, v6 row_ror:8 row_mask:0xf bank_mask:0xf
    s_nop 1
    v_max_f32_dpp v6, v6, v6 row_ror:4 row_mask:0xf bank_mask:0xf
    s_nop 1
    v_max_f32_dpp v6, v6, v6 row_ror:2 row_mask:0xf bank_mask:0xf
    s_nop 1
    v_max_f32_dpp v6, v6, v6 row_ror:1 row_mask:0xf bank_mask:0xf
    v_mov_b32 v7, v6
    s_nop 1
    v_permlane32_swap_b32 v6, v7
    v_max_f32 v6, v6, v7
    v_mov_b32 v7, v6
    s_nop 1
    v_permlane16_swap_b32 v6, v7
    v_max_f32 v6, v6, v7
    v_sub_f32 v4, v4, v6
    v_exp_f32 v4, v4
    s_nop 0
    v_mul_f32 v5, v5, v4
    s_nop 1
    v_add_f32_dpp v5, v5, v5 row_ror:8 row_mask:0xf bank_mask:0xf
    s_nop 1
    v_add_f32_dpp v5, v5, v5 row_ror:4 row_mask:0xf bank_mask:0xf
    s_nop 1
    v_add_f32_dpp v5, v5, v5 row_ror:2 row_mask:0xf bank_mask:0xf
    s_nop 1
    v_add_f32_dpp v5, v5, v5 row_ror:1 row_mask:0xf bank_mask:0xf
    v_mov_b32 v7, v5
    s_nop 1
    v_permlane32_swap_b32 v5, v7
    v_add_f32 v5, v5, v7
    v_mov_b32 v7, v5
    s_nop 1
    v_permlane16_swap_b32 v5, v7
    v_add_f32 v5, v5, v7
    v_rcp_f32 v5, v5
    s_nop 0
    v_mul_f32 v4, v4, v5
    s_cmp_lt_u32 s3, 21
    s_cbranch_scc1 L_cown
    s_mul_i32 s48, s3, 4352
    s_add_u32 s48, s48, 9498368
    v_lshlrev_b32 v12, 2, v1
    v_mov_b32 v5, 1
    s_mov_b64 exec, 0xffffff
    buffer_store_dword v4, v12, s[12:15], s48 offen offset:128 sc1
    s_mov_b64 exec, 1
    s_waitcnt vmcnt(0)
    buffer_store_dword v5, off, s[12:15], s48 offset:4 sc1
    s_endpgm
L_cown:
    s_nop 1
    v_readlane_b32 s24, v4, 0
    v_readlane_b32 s25, v4, 1
    v_readlane_b32 s26, v4, 2
    v_readlane_b32 s27, v4, 3
    v_readlane_b32 s28, v4, 4
    v_readlane_b32 s29, v4, 5
    v_readlane_b32 s30, v4, 6
    v_readlane_b32 s31, v4, 7
    v_readlane_b32 s32, v4, 8
    v_readlane_b32 s33, v4, 9
    v_readlane_b32 s34, v4, 10
    v_readlane_b32 s35, v4, 11
    v_readlane_b32 s36, v4, 12
    v_readlane_b32 s37, v4, 13
    v_readlane_b32 s38, v4, 14
    v_readlane_b32 s39, v4, 15
    v_readlane_b32 s40, v4, 16
    v_readlane_b32 s41, v4, 17
    v_readlane_b32 s42, v4, 18
    v_readlane_b32 s43, v4, 19
    v_readlane_b32 s44, v4, 20
    v_readlane_b32 s45, v4, 21
    v_readlane_b32 s46, v4, 22
    v_readlane_b32 s47, v4, 23
    s_mov_b32 s92, s78
    s_and_b32 s93, s79, 0xffff
    s_mov_b32 s94, 12288
    s_mov_b32 s95, 0x00020000
    s_lshl_b32 s57, s57, 10
    v_lshlrev_b32 v13, 4, v1
    v_add_u32 v13, s57, v13
    s_mov_b32 s49, 4096
    s_mov_b32 s50, 8192
    s_mov_b32 s51, 12288
    s_mov_b32 s52, 16384
    s_mov_b32 s53, 20480
    v_mov_b32 v4, 0
    v_mov_b32 v5, 0
    v_mov_b32 v6, 0
    s_mov_b32 s56, 0xffffff
    v_lshlrev_b32 v12, 1, v1
    s_mul_i32 s57, s3, 384
    s_mov_b32 s60, 0x100000
L_wcc:
    s_nop 1
    ds_read_b32 v10, v3 offset:64
    s_sub_u32 s60, s60, 1
    s_cbranch_scc1 L_exit1
    s_waitcnt lgkmcnt(0)
    v_readfirstlane_b32 s48, v10
    s_cmp_lt_u32 s48, 1
    s_cbranch_scc1 L_wcc
    s_mov_b32 s60, 0x40000
L_cr:
    s_nop 1
    s_bitcmp0_b32 s56, 0
    s_cbranch_scc1 L_cl0
    buffer_load_dwordx4 v[16:19], v13, s[12:15], 0 offen offset:0 sc1
L_cl0:
    s_bitcmp0_b32 s56, 1
    s_cbranch_scc1 L_cl1
    buffer_load_dwordx4 v[20:23], v13, s[12:15], 0 offen offset:1024 sc1
L_cl1:
    s_bitcmp0_b32 s56, 2
    s_cbranch_scc1 L_cl2
    buffer_load_dwordx4 v[24:27], v13, s[12:15], 0 offen offset:2048 sc1
L_cl2:
    s_bitcmp0_b32 s56, 3
    s_cbranch_scc1 L_cl3
    buffer_load_dwordx4 v[28:31], v13, s[12:15], 0 offen offset:3072 sc1
L_cl3:
    s_bitcmp0_b32 s56, 4
    s_cbranch_scc1 L_cl4
    buffer_load_dwordx4 v[32:35], v13, s[12:15], s49 offen offset:0 sc1
L_cl4:
    s_bitcmp0_b32 s56, 5
    s_cbranch_scc1 L_cl5
    buffer_load_dwordx4 v[36:39], v13, s[12:15], s49 offen offset:1024 sc1
L_cl5:
    s_bitcmp0_b32 s56, 6
    s_cbranch_scc1 L_cl6
    buffer_load_dwordx4 v[40:43], v13, s[12:15], s49 offen offset:2048 sc1
L_cl6:
    s_bitcmp0_b32 s56, 7
    s_cbranch_scc1 L_cl7
    buffer_load_dwordx4 v[44:47], v13, s[12:15], s49 offen offset:3072 sc1
L_cl7:
    s_bitcmp0_b32 s56, 8
    s_cbranch_scc1 L_cl8
    buffer_load_dwordx4 v[48:51], v13, s[12:15], s50 offen offset:0 sc1
L_cl8:
    s_bitcmp0_b32 s56, 9
    s_cbranch_scc1 L_cl9
    buffer_load_dwordx4 v[52:55], v13, s[12:15], s50 offen offset:1024 sc1
L_cl9:
    s_bitcmp0_b32 s56, 10
    s_cbranch_scc1 L_cl10
    buffer_load_dwordx4 v[56:59], v13, s[12:15], s50 offen offset:2048 sc1
L_cl10:
    s_bitcmp0_b32 s56, 11
    s_cbranch_scc1 L_cl11
    buffer_load_dwordx4 v[60:63], v13, s[12:15], s50 offen offset:3072 sc1
L_cl11:
    s_bitcmp0_b32 s56, 12
    s_cbranch_scc1 L_cl12
    buffer_load_dwordx4 v[64:67], v13, s[12:15], s51 offen offset:0 sc1
L_cl12:
    s_bitcmp0_b32 s56, 13
    s_cbranch_scc1 L_cl13
    buffer_load_dwordx4 v[68:71], v13, s[12:15], s51 offen offset:1024 sc1
L_cl13:
    s_bitcmp0_b32 s56, 14
    s_cbranch_scc1 L_cl14
    buffer_load_dwordx4 v[72:75], v13, s[12:15], s51 offen offset:2048 sc1
L_cl14:
    s_bitcmp0_b32 s56, 15
    s_cbranch_scc1 L_cl15
    buffer_load_dwordx4 v[76:79], v13, s[12:15], s51 offen offset:3072 sc1
L_cl15:
    s_bitcmp0_b32 s56, 16
    s_cbranch_scc1 L_cl16
    buffer_load_dwordx4 v[80:83], v13, s[12:15], s52 offen offset:0 sc1
L_cl16:
    s_bitcmp0_b32 s56, 17
    s_cbranch_scc1 L_cl17
    buffer_load_dwordx4 v[84:87], v13, s[12:15], s52 offen offset:1024 sc1
L_cl17:
    s_bitcmp0_b32 s56, 18
    s_cbranch_scc1 L_cl18
    buffer_load_dwordx4 v[88:91], v13, s[12:15], s52 offen offset:2048 sc1
L_cl18:
    s_bitcmp0_b32 s56, 19
    s_cbranch_scc1 L_cl19
    buffer_load_dwordx4 v[92:95], v13, s[12:15], s52 offen offset:3072 sc1
L_cl19:
    s_bitcmp0_b32 s56, 20
    s_cbranch_scc1 L_cl20
    buffer_load_dwordx4 v[96:99], v13, s[12:15], s53 offen offset:0 sc1
L_cl20:
    s_bitcmp0_b32 s56, 21
    s_cbranch_scc1 L_cl21
    buffer_load_dwordx4 v[100:103], v13, s[12:15], s53 offen offset:1024 sc1
L_cl21:
    s_bitcmp0_b32 s56, 22
    s_cbranch_scc1 L_cl22
    buffer_load_dwordx4 v[104:107], v13, s[12:15], s53 offen offset:2048 sc1
L_cl22:
    s_bitcmp0_b32 s56, 23
    s_cbranch_scc1 L_cl23
    buffer_load_dwordx4 v[108:111], v13, s[12:15], s53 offen offset:3072 sc1
L_cl23:
    s_sub_u32 s60, s60, 1
    s_cbranch_scc1 L_exit1
    s_waitcnt vmcnt(0)
    s_bitcmp0_b32 s56, 0
    s_cbranch_scc1 L_cv0
    v_cmp_eq_u32 vcc, 0, v19
    s_cbranch_vccnz L_cv0
    v_fmac_f32 v4, s24, v16
    v_fmac_f32 v5, s24, v17
    v_fmac_f32 v6, s24, v18
    s_bitset0_b32 s56, 0
L_cv0:
    s_bitcmp0_b32 s56, 1
    s_cbranch_scc1 L_cv1
    v_cmp_eq_u32 vcc, 0, v23
    s_cbranch_vccnz L_cv1
    v_fmac_f32 v4, s25, v20
    v_fmac_f32 v5, s25, v21
    v_fmac_f32 v6, s25, v22
    s_bitset0_b32 s56, 1
L_cv1:
    s_bitcmp0_b32 s56, 2
    s_cbranch_scc1 L_cv2
    v_cmp_eq_u32 vcc, 0, v27
    s_cbranch_vccnz L_cv2
    v_fmac_f32 v4, s26, v24
    v_fmac_f32 v5, s26, v25
    v_fmac_f32 v6, s26, v26
    s_bitset0_b32 s56, 2
L_cv2:
    s_bitcmp0_b32 s56, 3
    s_cbranch_scc1 L_cv3
    v_cmp_eq_u32 vcc, 0, v31
    s_cbranch_vccnz L_cv3
    v_fmac_f32 v4, s27, v28
    v_fmac_f32 v5, s27, v29
    v_fmac_f32 v6, s27, v30
    s_bitset0_b32 s56, 3
L_cv3:
    s_bitcmp0_b32 s56, 4
    s_cbranch_scc1 L_cv4
    v_cmp_eq_u32 vcc, 0, v35
    s_cbranch_vccnz L_cv4
    v_fmac_f32 v4, s28, v32
    v_fmac_f32 v5, s28, v33
    v_fmac_f32 v6, s28, v34
    s_bitset0_b32 s56, 4
L_cv4:
    s_bitcmp0_b32 s56, 5
    s_cbranch_scc1 L_cv5
    v_cmp_eq_u32 vcc, 0, v39
    s_cbranch_vccnz L_cv5
    v_fmac_f32 v4, s29, v36
    v_fmac_f32 v5, s29, v37
    v_fmac_f32 v6, s29, v38
    s_bitset0_b32 s56, 5
L_cv5:
    s_bitcmp0_b32 s56, 6
    s_cbranch_scc1 L_cv6
    v_cmp_eq_u32 vcc, 0, v43
    s_cbranch_vccnz L_cv6
    v_fmac_f32 v4, s30, v40
    v_fmac_f32 v5, s30, v41
    v_fmac_f32 v6, s30, v42
    s_bitset0_b32 s56, 6
L_cv6:
    s_bitcmp0_b32 s56, 7
    s_cbranch_scc1 L_cv7
    v_cmp_eq_u32 vcc, 0, v47
    s_cbranch_vccnz L_cv7
    v_fmac_f32 v4, s31, v44
    v_fmac_f32 v5, s31, v45
    v_fmac_f32 v6, s31, v46
    s_bitset0_b32 s56, 7
L_cv7:
    s_bitcmp0_b32 s56, 8
    s_cbranch_scc1 L_cv8
    v_cmp_eq_u32 vcc, 0, v51
    s_cbranch_vccnz L_cv8
    v_fmac_f32 v4, s32, v48
    v_fmac_f32 v5, s32, v49
    v_fmac_f32 v6, s32, v50
    s_bitset0_b32 s56, 8
L_cv8:
    s_bitcmp0_b32 s56, 9
    s_cbranch_scc1 L_cv9
    v_cmp_eq_u32 vcc, 0, v55
    s_cbranch_vccnz L_cv9
    v_fmac_f32 v4, s33, v52
    v_fmac_f32 v5, s33, v53
    v_fmac_f32 v6, s33, v54
    s_bitset0_b32 s56, 9
L_cv9:
    s_bitcmp0_b32 s56, 10
    s_cbranch_scc1 L_cv10
    v_cmp_eq_u32 vcc, 0, v59
    s_cbranch_vccnz L_cv10
    v_fmac_f32 v4, s34, v56
    v_fmac_f32 v5, s34, v57
    v_fmac_f32 v6, s34, v58
    s_bitset0_b32 s56, 10
L_cv10:
    s_bitcmp0_b32 s56, 11
    s_cbranch_scc1 L_cv11
    v_cmp_eq_u32 vcc, 0, v63
    s_cbranch_vccnz L_cv11
    v_fmac_f32 v4, s35, v60
    v_fmac_f32 v5, s35, v61
    v_fmac_f32 v6, s35, v62
    s_bitset0_b32 s56, 11
L_cv11:
    s_bitcmp0_b32 s56, 12
    s_cbranch_scc1 L_cv12
    v_cmp_eq_u32 vcc, 0, v67
    s_cbranch_vccnz L_cv12
    v_fmac_f32 v4, s36, v64
    v_fmac_f32 v5, s36, v65
    v_fmac_f32 v6, s36, v66
    s_bitset0_b32 s56, 12
L_cv12:
    s_bitcmp0_b32 s56, 13
    s_cbranch_scc1 L_cv13
    v_cmp_eq_u32 vcc, 0, v71
    s_cbranch_vccnz L_cv13
    v_fmac_f32 v4, s37, v68
    v_fmac_f32 v5, s37, v69
    v_fmac_f32 v6, s37, v70
    s_bitset0_b32 s56, 13
L_cv13:
    s_bitcmp0_b32 s56, 14
    s_cbranch_scc1 L_cv14
    v_cmp_eq_u32 vcc, 0, v75
    s_cbranch_vccnz L_cv14
    v_fmac_f32 v4, s38, v72
    v_fmac_f32 v5, s38, v73
    v_fmac_f32 v6, s38, v74
    s_bitset0_b32 s56, 14
L_cv14:
    s_bitcmp0_b32 s56, 15
    s_cbranch_scc1 L_cv15
    v_cmp_eq_u32 vcc, 0, v79
    s_cbranch_vccnz L_cv15
    v_fmac_f32 v4, s39, v76
    v_fmac_f32 v5, s39, v77
    v_fmac_f32 v6, s39, v78
    s_bitset0_b32 s56, 15
L_cv15:
    s_bitcmp0_b32 s56, 16
    s_cbranch_scc1 L_cv16
    v_cmp_eq_u32 vcc, 0, v83
    s_cbranch_vccnz L_cv16
    v_fmac_f32 v4, s40, v80
    v_fmac_f32 v5, s40, v81
    v_fmac_f32 v6, s40, v82
    s_bitset0_b32 s56, 16
L_cv16:
    s_bitcmp0_b32 s56, 17
    s_cbranch_scc1 L_cv17
    v_cmp_eq_u32 vcc, 0, v87
    s_cbranch_vccnz L_cv17
    v_fmac_f32 v4, s41, v84
    v_fmac_f32 v5, s41, v85
    v_fmac_f32 v6, s41, v86
    s_bitset0_b32 s56, 17
L_cv17:
    s_bitcmp0_b32 s56, 18
    s_cbranch_scc1 L_cv18
    v_cmp_eq_u32 vcc, 0, v91
    s_cbranch_vccnz L_cv18
    v_fmac_f32 v4, s42, v88
    v_fmac_f32 v5, s42, v89
    v_fmac_f32 v6, s42, v90
    s_bitset0_b32 s56, 18
L_cv18:
    s_bitcmp0_b32 s56, 19
    s_cbranch_scc1 L_cv19
    v_cmp_eq_u32 vcc, 0, v95
    s_cbranch_vccnz L_cv19
    v_fmac_f32 v4, s43, v92
    v_fmac_f32 v5, s43, v93
    v_fmac_f32 v6, s43, v94
    s_bitset0_b32 s56, 19
L_cv19:
    s_bitcmp0_b32 s56, 20
    s_cbranch_scc1 L_cv20
    v_cmp_eq_u32 vcc, 0, v99
    s_cbranch_vccnz L_cv20
    v_fmac_f32 v4, s44, v96
    v_fmac_f32 v5, s44, v97
    v_fmac_f32 v6, s44, v98
    s_bitset0_b32 s56, 20
L_cv20:
    s_bitcmp0_b32 s56, 21
    s_cbranch_scc1 L_cv21
    v_cmp_eq_u32 vcc, 0, v103
    s_cbranch_vccnz L_cv21
    v_fmac_f32 v4, s45, v100
    v_fmac_f32 v5, s45, v101
    v_fmac_f32 v6, s45, v102
    s_bitset0_b32 s56, 21
L_cv21:
    s_bitcmp0_b32 s56, 22
    s_cbranch_scc1 L_cv22
    v_cmp_eq_u32 vcc, 0, v107
    s_cbranch_vccnz L_cv22
    v_fmac_f32 v4, s46, v104
    v_fmac_f32 v5, s46, v105
    v_fmac_f32 v6, s46, v106
    s_bitset0_b32 s56, 22
L_cv22:
    s_bitcmp0_b32 s56, 23
    s_cbranch_scc1 L_cv23
    v_cmp_eq_u32 vcc, 0, v111
    s_cbranch_vccnz L_cv23
    v_fmac_f32 v4, s47, v108
    v_fmac_f32 v5, s47, v109
    v_fmac_f32 v6, s47, v110
    s_bitset0_b32 s56, 23
L_cv23:
    s_cmp_lg_u32 s56, 0
    s_cbranch_scc1 L_cr
    v_cvt_pk_bf16_f32 v4, v4, v4
    buffer_store_short v4, v12, s[92:95], s57 offen offset:0
    v_cvt_pk_bf16_f32 v5, v5, v5
    buffer_store_short v5, v12, s[92:95], s57 offen offset:128
    v_cvt_pk_bf16_f32 v6, v6, v6
    buffer_store_short v6, v12, s[92:95], s57 offen offset:256
    s_endpgm
L_h0:
    s_nop 1
    s_mov_b32 s8, s64
    s_and_b32 s9, s65, 0xffff
    s_mov_b32 s10, 12288
    s_mov_b32 s11, 0x00020000
    s_mov_b32 s92, s70
    s_and_b32 s93, s71, 0xffff
    s_mov_b32 s94, 6291456
    s_mov_b32 s95, 0x00020000
    s_mov_b32 s96, s72
    s_and_b32 s97, s73, 0xffff
    s_mov_b32 s98, 6291456
    s_mov_b32 s99, 0x00020000
    v_lshrrev_b32 v4, 4, v1
    v_and_b32 v5, 15, v1
    v_lshlrev_b32 v6, 3, v5
    v_mul_u32_u24 v7, 384, v4
    v_add_u32 v7, v7, v6
    v_lshl_add_u32 v13, v5, 2, v4
    v_lshlrev_b32 v13, 2, v13
    v_lshlrev_b32 v4, 4, v1
    s_mul_i32 s32, s5, 4352
    s_add_u32 s32, s32, s59
    s_lshl_b32 s33, s3, 3
    s_add_u32 s33, s33, s5
    s_mul_i32 s33, s33, 6144
    s_add_u32 s33, s33, 2097152
    v_mov_b32 v16, 0
    v_mov_b32 v17, 0
    v_mov_b32 v18, 0
    v_mov_b32 v19, 0
    s_add_u32 s48, s2, 0
    s_lshl_b32 s49, s48, 10
    s_lshl_b32 s48, s48, 6
    s_add_u32 s48, s48, 917504
    buffer_store_dwordx4 v[16:19], v4, s[12:15], s49 offen sc1
    s_mov_b64 exec, 15
    buffer_store_dwordx4 v[16:19], v4, s[12:15], s48 offen sc1
    s_mov_b64 exec, -1
    s_add_u32 s48, s2, 256
    s_lshl_b32 s49, s48, 10
    s_lshl_b32 s48, s48, 6
    s_add_u32 s48, s48, 917504
    buffer_store_dwordx4 v[16:19], v4, s[12:15], s49 offen sc1
    s_mov_b64 exec, 15
    buffer_store_dwordx4 v[16:19], v4, s[12:15], s48 offen sc1
    s_mov_b64 exec, -1
    s_add_u32 s48, s2, 512
    s_lshl_b32 s49, s48, 10
    s_lshl_b32 s48, s48, 6
    s_add_u32 s48, s48, 917504
    buffer_store_dwordx4 v[16:19], v4, s[12:15], s49 offen sc1
    s_mov_b64 exec, 15
    buffer_store_dwordx4 v[16:19], v4, s[12:15], s48 offen sc1
    s_mov_b64 exec, -1
    s_mov_b32 s61, 0
    s_lshl_b32 s62, s61, 5
    s_add_u32 s62, s62, s3
    s_lshl_b32 s63, s62, 15
    s_add_u32 s63, s63, 1
    s_mul_hi_u32 s63, s63, 0xaaaaaaab
    s_lshr_b32 s63, s63, 7
    s_mul_i32 s48, s62, 171
    s_lshr_b32 s48, s48, 9
    s_mul_i32 s48, s48, 384
    s_mul_i32 s49, s4, 24
    s_add_u32 s50, s49, s63
    s_mul_i32 s50, s50, 384
    v_add_u32 v10, s50, v7
    v_add_u32 v11, 3072, v10
    v_add_u32 v12, 6144, v10
    buffer_load_dwordx2 v[100:101], v6, s[8:11], s48 offen offset:0
    buffer_load_dwordx2 v[102:103], v6, s[8:11], s48 offen offset:128
    buffer_load_dwordx2 v[104:105], v6, s[8:11], s48 offen offset:256
    buffer_load_dwordx2 v[28:29], v10, s[92:95], 0 offen offset:0
    buffer_load_dwordx2 v[30:31], v10, s[92:95], 0 offen offset:128
    buffer_load_dwordx2 v[32:33], v10, s[92:95], 0 offen offset:256
    buffer_load_dwordx2 v[64:65], v10, s[96:99], 0 offen offset:0
    buffer_load_dwordx2 v[66:67], v10, s[96:99], 0 offen offset:128
    buffer_load_dwordx2 v[68:69], v10, s[96:99], 0 offen offset:256
    buffer_load_dwordx2 v[34:35], v10, s[92:95], 0 offen offset:1536
    buffer_load_dwordx2 v[36:37], v10, s[92:95], 0 offen offset:1664
    buffer_load_dwordx2 v[38:39], v10, s[92:95], 0 offen offset:1792
    buffer_load_dwordx2 v[70:71], v10, s[96:99], 0 offen offset:1536
    buffer_load_dwordx2 v[72:73], v10, s[96:99], 0 offen offset:1664
    buffer_load_dwordx2 v[74:75], v10, s[96:99], 0 offen offset:1792
    buffer_load_dwordx2 v[40:41], v11, s[92:95], 0 offen offset:0
    buffer_load_dwordx2 v[42:43], v11, s[92:95], 0 offen offset:128
    buffer_load_dwordx2 v[44:45], v11, s[92:95], 0 offen offset:256
    buffer_load_dwordx2 v[76:77], v11, s[96:99], 0 offen offset:0
    buffer_load_dwordx2 v[78:79], v11, s[96:99], 0 offen offset:128
    buffer_load_dwordx2 v[80:81], v11, s[96:99], 0 offen offset:256
    buffer_load_dwordx2 v[46:47], v11, s[92:95], 0 offen offset:1536
    buffer_load_dwordx2 v[48:49], v11, s[92:95], 0 offen offset:1664
    buffer_load_dwordx2 v[50:51], v11, s[92:95], 0 offen offset:1792
    buffer_load_dwordx2 v[82:83], v11, s[96:99], 0 offen offset:1536
    buffer_load_dwordx2 v[84:85], v11, s[96:99], 0 offen offset:1664
    buffer_load_dwordx2 v[86:87], v11, s[96:99], 0 offen offset:1792
    buffer_load_dwordx2 v[52:53], v12, s[92:95], 0 offen offset:0
    buffer_load_dwordx2 v[54:55], v12, s[92:95], 0 offen offset:128
    buffer_load_dwordx2 v[56:57], v12, s[92:95], 0 offen offset:256
    buffer_load_dwordx2 v[88:89], v12, s[96:99], 0 offen offset:0
    buffer_load_dwordx2 v[90:91], v12, s[96:99], 0 offen offset:128
    buffer_load_dwordx2 v[92:93], v12, s[96:99], 0 offen offset:256
    buffer_load_dwordx2 v[58:59], v12, s[92:95], 0 offen offset:1536
    buffer_load_dwordx2 v[60:61], v12, s[92:95], 0 offen offset:1664
    buffer_load_dwordx2 v[62:63], v12, s[92:95], 0 offen offset:1792
    buffer_load_dwordx2 v[94:95], v12, s[96:99], 0 offen offset:1536
    buffer_load_dwordx2 v[96:97], v12, s[96:99], 0 offen offset:1664
    buffer_load_dwordx2 v[98:99], v12, s[96:99], 0 offen offset:1792
    s_waitcnt vmcnt(0)
    v_lshlrev_b32 v16, 16, v100
    v_and_b32 v17, 0xffff0000, v100
    v_lshlrev_b32 v18, 16, v101
    v_and_b32 v19, 0xffff0000, v101
    v_lshlrev_b32 v20, 16, v102
    v_and_b32 v21, 0xffff0000, v102
    v_lshlrev_b32 v22, 16, v103
    v_and_b32 v23, 0xffff0000, v103
    v_lshlrev_b32 v24, 16, v104
    v_and_b32 v25, 0xffff0000, v104
    v_lshlrev_b32 v26, 16, v105
    v_and_b32 v27, 0xffff0000, v105
    v_lshlrev_b32 v10, 16, v28
    v_lshlrev_b32 v11, 16, v64
    v_and_b32 v28, 0xffff0000, v28
    v_and_b32 v64, 0xffff0000, v64
    v_mul_f32 v10, v10, v16
    v_mul_f32 v28, v28, v17
    v_mul_f32 v100, v10, v11
    v_fmac_f32 v100, v28, v64
    v_lshlrev_b32 v10, 16, v29
    v_lshlrev_b32 v11, 16, v65
    v_and_b32 v29, 0xffff0000, v29
    v_and_b32 v65, 0xffff0000, v65
    v_mul_f32 v10, v10, v18
    v_mul_f32 v29, v29, v19
    v_fmac_f32 v100, v10, v11
    v_fmac_f32 v100, v29, v65
    v_lshlrev_b32 v10, 16, v30
    v_lshlrev_b32 v11, 16, v66
    v_and_b32 v30, 0xffff0000, v30
    v_and_b32 v66, 0xffff0000, v66
    v_mul_f32 v10, v10, v20
    v_mul_f32 v30, v30, v21
    v_fmac_f32 v100, v10, v11
    v_fmac_f32 v100, v30, v66
    v_lshlrev_b32 v10, 16, v31
    v_lshlrev_b32 v11, 16, v67
    v_and_b32 v31, 0xffff0000, v31
    v_and_b32 v67, 0xffff0000, v67
    v_mul_f32 v10, v10, v22
    v_mul_f32 v31, v31, v23
    v_fmac_f32 v100, v10, v11
    v_fmac_f32 v100, v31, v67
    v_lshlrev_b32 v10, 16, v32
    v_lshlrev_b32 v11, 16, v68
    v_and_b32 v32, 0xffff0000, v32
    v_and_b32 v68, 0xffff0000, v68
    v_mul_f32 v10, v10, v24
    v_mul_f32 v32, v32, v25
    v_fmac_f32 v100, v10, v11
    v_fmac_f32 v100, v32, v68
    v_lshlrev_b32 v10, 16, v33
    v_lshlrev_b32 v11, 16, v69
    v_and_b32 v33, 0xffff0000, v33
    v_and_b32 v69, 0xffff0000, v69
    v_mul_f32 v10, v10, v26
    v_mul_f32 v33, v33, v27
    v_fmac_f32 v100, v10, v11
    v_fmac_f32 v100, v33, v69
    v_lshlrev_b32 v10, 16, v34
    v_lshlrev_b32 v11, 16, v70
    v_and_b32 v34, 0xffff0000, v34
    v_and_b32 v70, 0xffff0000, v70
    v_mul_f32 v10, v10, v16
    v_mul_f32 v34, v34, v17
    v_mul_f32 v101, v10, v11
    v_fmac_f32 v101, v34, v70
    v_lshlrev_b32 v10, 16, v35
    v_lshlrev_b32 v11, 16, v71
    v_and_b32 v35, 0xffff0000, v35
    v_and_b32 v71, 0xffff0000, v71
    v_mul_f32 v10, v10, v18
    v_mul_f32 v35, v35, v19
    v_fmac_f32 v101, v10, v11
    v_fmac_f32 v101, v35, v71
    v_lshlrev_b32 v10, 16, v36
    v_lshlrev_b32 v11, 16, v72
    v_and_b32 v36, 0xffff0000, v36
    v_and_b32 v72, 0xffff0000, v72
    v_mul_f32 v10, v10, v20
    v_mul_f32 v36, v36, v21
    v_fmac_f32 v101, v10, v11
    v_fmac_f32 v101, v36, v72
    v_lshlrev_b32 v10, 16, v37
    v_lshlrev_b32 v11, 16, v73
    v_and_b32 v37, 0xffff0000, v37
    v_and_b32 v73, 0xffff0000, v73
    v_mul_f32 v10, v10, v22
    v_mul_f32 v37, v37, v23
    v_fmac_f32 v101, v10, v11
    v_fmac_f32 v101, v37, v73
    v_lshlrev_b32 v10, 16, v38
    v_lshlrev_b32 v11, 16, v74
    v_and_b32 v38, 0xffff0000, v38
    v_and_b32 v74, 0xffff0000, v74
    v_mul_f32 v10, v10, v24
    v_mul_f32 v38, v38, v25
    v_fmac_f32 v101, v10, v11
    v_fmac_f32 v101, v38, v74
    v_lshlrev_b32 v10, 16, v39
    v_lshlrev_b32 v11, 16, v75
    v_and_b32 v39, 0xffff0000, v39
    v_and_b32 v75, 0xffff0000, v75
    v_mul_f32 v10, v10, v26
    v_mul_f32 v39, v39, v27
    v_fmac_f32 v101, v10, v11
    v_fmac_f32 v101, v39, v75
    v_lshlrev_b32 v10, 16, v40
    v_lshlrev_b32 v11, 16, v76
    v_and_b32 v40, 0xffff0000, v40
    v_and_b32 v76, 0xffff0000, v76
    v_mul_f32 v10, v10, v16
    v_mul_f32 v40, v40, v17
    v_mul_f32 v102, v10, v11
    v_fmac_f32 v102, v40, v76
    v_lshlrev_b32 v10, 16, v41
    v_lshlrev_b32 v11, 16, v77
    v_and_b32 v41, 0xffff0000, v41
    v_and_b32 v77, 0xffff0000, v77
    v_mul_f32 v10, v10, v18
    v_mul_f32 v41, v41, v19
    v_fmac_f32 v102, v10, v11
    v_fmac_f32 v102, v41, v77
    v_lshlrev_b32 v10, 16, v42
    v_lshlrev_b32 v11, 16, v78
    v_and_b32 v42, 0xffff0000, v42
    v_and_b32 v78, 0xffff0000, v78
    v_mul_f32 v10, v10, v20
    v_mul_f32 v42, v42, v21
    v_fmac_f32 v102, v10, v11
    v_fmac_f32 v102, v42, v78
    v_lshlrev_b32 v10, 16, v43
    v_lshlrev_b32 v11, 16, v79
    v_and_b32 v43, 0xffff0000, v43
    v_and_b32 v79, 0xffff0000, v79
    v_mul_f32 v10, v10, v22
    v_mul_f32 v43, v43, v23
    v_fmac_f32 v102, v10, v11
    v_fmac_f32 v102, v43, v79
    v_lshlrev_b32 v10, 16, v44
    v_lshlrev_b32 v11, 16, v80
    v_and_b32 v44, 0xffff0000, v44
    v_and_b32 v80, 0xffff0000, v80
    v_mul_f32 v10, v10, v24
    v_mul_f32 v44, v44, v25
    v_fmac_f32 v102, v10, v11
    v_fmac_f32 v102, v44, v80
    v_lshlrev_b32 v10, 16, v45
    v_lshlrev_b32 v11, 16, v81
    v_and_b32 v45, 0xffff0000, v45
    v_and_b32 v81, 0xffff0000, v81
    v_mul_f32 v10, v10, v26
    v_mul_f32 v45, v45, v27
    v_fmac_f32 v102, v10, v11
    v_fmac_f32 v102, v45, v81
    v_lshlrev_b32 v10, 16, v46
    v_lshlrev_b32 v11, 16, v82
    v_and_b32 v46, 0xffff0000, v46
    v_and_b32 v82, 0xffff0000, v82
    v_mul_f32 v10, v10, v16
    v_mul_f32 v46, v46, v17
    v_mul_f32 v103, v10, v11
    v_fmac_f32 v103, v46, v82
    v_lshlrev_b32 v10, 16, v47
    v_lshlrev_b32 v11, 16, v83
    v_and_b32 v47, 0xffff0000, v47
    v_and_b32 v83, 0xffff0000, v83
    v_mul_f32 v10, v10, v18
    v_mul_f32 v47, v47, v19
    v_fmac_f32 v103, v10, v11
    v_fmac_f32 v103, v47, v83
    v_lshlrev_b32 v10, 16, v48
    v_lshlrev_b32 v11, 16, v84
    v_and_b32 v48, 0xffff0000, v48
    v_and_b32 v84, 0xffff0000, v84
    v_mul_f32 v10, v10, v20
    v_mul_f32 v48, v48, v21
    v_fmac_f32 v103, v10, v11
    v_fmac_f32 v103, v48, v84
    v_lshlrev_b32 v10, 16, v49
    v_lshlrev_b32 v11, 16, v85
    v_and_b32 v49, 0xffff0000, v49
    v_and_b32 v85, 0xffff0000, v85
    v_mul_f32 v10, v10, v22
    v_mul_f32 v49, v49, v23
    v_fmac_f32 v103, v10, v11
    v_fmac_f32 v103, v49, v85
    v_lshlrev_b32 v10, 16, v50
    v_lshlrev_b32 v11, 16, v86
    v_and_b32 v50, 0xffff0000, v50
    v_and_b32 v86, 0xffff0000, v86
    v_mul_f32 v10, v10, v24
    v_mul_f32 v50, v50, v25
    v_fmac_f32 v103, v10, v11
    v_fmac_f32 v103, v50, v86
    v_lshlrev_b32 v10, 16, v51
    v_lshlrev_b32 v11, 16, v87
    v_and_b32 v51, 0xffff0000, v51
    v_and_b32 v87, 0xffff0000, v87
    v_mul_f32 v10, v10, v26
    v_mul_f32 v51, v51, v27
    v_fmac_f32 v103, v10, v11
    v_fmac_f32 v103, v51, v87
    v_lshlrev_b32 v10, 16, v52
    v_lshlrev_b32 v11, 16, v88
    v_and_b32 v52, 0xffff0000, v52
    v_and_b32 v88, 0xffff0000, v88
    v_mul_f32 v10, v10, v16
    v_mul_f32 v52, v52, v17
    v_mul_f32 v104, v10, v11
    v_fmac_f32 v104, v52, v88
    v_lshlrev_b32 v10, 16, v53
    v_lshlrev_b32 v11, 16, v89
    v_and_b32 v53, 0xffff0000, v53
    v_and_b32 v89, 0xffff0000, v89
    v_mul_f32 v10, v10, v18
    v_mul_f32 v53, v53, v19
    v_fmac_f32 v104, v10, v11
    v_fmac_f32 v104, v53, v89
    v_lshlrev_b32 v10, 16, v54
    v_lshlrev_b32 v11, 16, v90
    v_and_b32 v54, 0xffff0000, v54
    v_and_b32 v90, 0xffff0000, v90
    v_mul_f32 v10, v10, v20
    v_mul_f32 v54, v54, v21
    v_fmac_f32 v104, v10, v11
    v_fmac_f32 v104, v54, v90
    v_lshlrev_b32 v10, 16, v55
    v_lshlrev_b32 v11, 16, v91
    v_and_b32 v55, 0xffff0000, v55
    v_and_b32 v91, 0xffff0000, v91
    v_mul_f32 v10, v10, v22
    v_mul_f32 v55, v55, v23
    v_fmac_f32 v104, v10, v11
    v_fmac_f32 v104, v55, v91
    v_lshlrev_b32 v10, 16, v56
    v_lshlrev_b32 v11, 16, v92
    v_and_b32 v56, 0xffff0000, v56
    v_and_b32 v92, 0xffff0000, v92
    v_mul_f32 v10, v10, v24
    v_mul_f32 v56, v56, v25
    v_fmac_f32 v104, v10, v11
    v_fmac_f32 v104, v56, v92
    v_lshlrev_b32 v10, 16, v57
    v_lshlrev_b32 v11, 16, v93
    v_and_b32 v57, 0xffff0000, v57
    v_and_b32 v93, 0xffff0000, v93
    v_mul_f32 v10, v10, v26
    v_mul_f32 v57, v57, v27
    v_fmac_f32 v104, v10, v11
    v_fmac_f32 v104, v57, v93
    v_lshlrev_b32 v10, 16, v58
    v_lshlrev_b32 v11, 16, v94
    v_and_b32 v58, 0xffff0000, v58
    v_and_b32 v94, 0xffff0000, v94
    v_mul_f32 v10, v10, v16
    v_mul_f32 v58, v58, v17
    v_mul_f32 v105, v10, v11
    v_fmac_f32 v105, v58, v94
    v_lshlrev_b32 v10, 16, v59
    v_lshlrev_b32 v11, 16, v95
    v_and_b32 v59, 0xffff0000, v59
    v_and_b32 v95, 0xffff0000, v95
    v_mul_f32 v10, v10, v18
    v_mul_f32 v59, v59, v19
    v_fmac_f32 v105, v10, v11
    v_fmac_f32 v105, v59, v95
    v_lshlrev_b32 v10, 16, v60
    v_lshlrev_b32 v11, 16, v96
    v_and_b32 v60, 0xffff0000, v60
    v_and_b32 v96, 0xffff0000, v96
    v_mul_f32 v10, v10, v20
    v_mul_f32 v60, v60, v21
    v_fmac_f32 v105, v10, v11
    v_fmac_f32 v105, v60, v96
    v_lshlrev_b32 v10, 16, v61
    v_lshlrev_b32 v11, 16, v97
    v_and_b32 v61, 0xffff0000, v61
    v_and_b32 v97, 0xffff0000, v97
    v_mul_f32 v10, v10, v22
    v_mul_f32 v61, v61, v23
    v_fmac_f32 v105, v10, v11
    v_fmac_f32 v105, v61, v97
    v_lshlrev_b32 v10, 16, v62
    v_lshlrev_b32 v11, 16, v98
    v_and_b32 v62, 0xffff0000, v62
    v_and_b32 v98, 0xffff0000, v98
    v_mul_f32 v10, v10, v24
    v_mul_f32 v62, v62, v25
    v_fmac_f32 v105, v10, v11
    v_fmac_f32 v105, v62, v98
    v_lshlrev_b32 v10, 16, v63
    v_lshlrev_b32 v11, 16, v99
    v_and_b32 v63, 0xffff0000, v63
    v_and_b32 v99, 0xffff0000, v99
    v_mul_f32 v10, v10, v26
    v_mul_f32 v63, v63, v27
    v_fmac_f32 v105, v10, v11
    v_fmac_f32 v105, v63, v99
    v_add_f32_dpp v100, v100, v100 row_ror:8 row_mask:0xf bank_mask:0xf
    v_add_f32_dpp v101, v101, v101 row_ror:8 row_mask:0xf bank_mask:0xf
    v_add_f32_dpp v102, v102, v102 row_ror:8 row_mask:0xf bank_mask:0xf
    v_add_f32_dpp v103, v103, v103 row_ror:8 row_mask:0xf bank_mask:0xf
    v_add_f32_dpp v104, v104, v104 row_ror:8 row_mask:0xf bank_mask:0xf
    v_add_f32_dpp v105, v105, v105 row_ror:8 row_mask:0xf bank_mask:0xf
    v_add_f32_dpp v100, v100, v100 row_ror:4 row_mask:0xf bank_mask:0xf
    v_add_f32_dpp v101, v101, v101 row_ror:4 row_mask:0xf bank_mask:0xf
    v_add_f32_dpp v102, v102, v102 row_ror:4 row_mask:0xf bank_mask:0xf
    v_add_f32_dpp v103, v103, v103 row_ror:4 row_mask:0xf bank_mask:0xf
    v_add_f32_dpp v104, v104, v104 row_ror:4 row_mask:0xf bank_mask:0xf
    v_add_f32_dpp v105, v105, v105 row_ror:4 row_mask:0xf bank_mask:0xf
    v_add_f32_dpp v100, v100, v100 row_ror:2 row_mask:0xf bank_mask:0xf
    v_add_f32_dpp v101, v101, v101 row_ror:2 row_mask:0xf bank_mask:0xf
    v_add_f32_dpp v102, v102, v102 row_ror:2 row_mask:0xf bank_mask:0xf
    v_add_f32_dpp v103, v103, v103 row_ror:2 row_mask:0xf bank_mask:0xf
    v_add_f32_dpp v104, v104, v104 row_ror:2 row_mask:0xf bank_mask:0xf
    v_add_f32_dpp v105, v105, v105 row_ror:2 row_mask:0xf bank_mask:0xf
    v_add_f32_dpp v100, v100, v100 row_ror:1 row_mask:0xf bank_mask:0xf
    v_add_f32_dpp v101, v101, v101 row_ror:1 row_mask:0xf bank_mask:0xf
    v_add_f32_dpp v102, v102, v102 row_ror:1 row_mask:0xf bank_mask:0xf
    v_add_f32_dpp v103, v103, v103 row_ror:1 row_mask:0xf bank_mask:0xf
    v_add_f32_dpp v104, v104, v104 row_ror:1 row_mask:0xf bank_mask:0xf
    v_add_f32_dpp v105, v105, v105 row_ror:1 row_mask:0xf bank_mask:0xf
    v_cmp_eq_u32 vcc, 1, v5
    s_nop 1
    v_cndmask_b32 v100, v100, v101, vcc
    v_cmp_eq_u32 vcc, 2, v5
    s_nop 1
    v_cndmask_b32 v100, v100, v102, vcc
    v_cmp_eq_u32 vcc, 3, v5
    s_nop 1
    v_cndmask_b32 v100, v100, v103, vcc
    v_cmp_eq_u32 vcc, 4, v5
    s_nop 1
    v_cndmask_b32 v100, v100, v104, vcc
    v_cmp_eq_u32 vcc, 5, v5
    s_nop 1
    v_cndmask_b32 v100, v100, v105, vcc
    s_mul_i32 s48, s62, 768
    s_lshl_b32 s49, s49, 2
    s_add_u32 s48, s48, s49
    s_add_u32 s48, s48, 1179648
    s_mov_b32 exec_lo, 0x003f003f
    s_mov_b32 exec_hi, 0x003f003f
    buffer_store_dword v100, v13, s[12:15], s48 offen sc1
    s_mov_b64 exec, -1
    s_mov_b32 s60, 0x100000
L_wb1:
    s_nop 1
    ds_read_b32 v10, v2 offset:60
    s_sub_u32 s60, s60, 1
    s_cbranch_scc1 L_exit1
    s_waitcnt lgkmcnt(0)
    v_readfirstlane_b32 s48, v10
    s_cmp_lt_u32 s48, 1
    s_cbranch_scc1 L_wb1
    s_mov_b32 s61, 1
    s_lshl_b32 s62, s61, 5
    s_add_u32 s62, s62, s3
    s_lshl_b32 s63, s62, 15
    s_add_u32 s63, s63, 1
    s_mul_hi_u32 s63, s63, 0xaaaaaaab
    s_lshr_b32 s63, s63, 7
    s_mul_i32 s48, s62, 171
    s_lshr_b32 s48, s48, 9
    s_mul_i32 s48, s48, 384
    s_mul_i32 s49, s4, 24
    s_add_u32 s50, s49, s63
    s_mul_i32 s50, s50, 384
    v_add_u32 v10, s50, v7
    v_add_u32 v11, 3072, v10
    v_add_u32 v12, 6144, v10
    buffer_load_dwordx2 v[100:101], v6, s[8:11], s48 offen offset:0
    buffer_load_dwordx2 v[102:103], v6, s[8:11], s48 offen offset:128
    buffer_load_dwordx2 v[104:105], v6, s[8:11], s48 offen offset:256
    buffer_load_dwordx2 v[28:29], v10, s[92:95], 0 offen offset:0
    buffer_load_dwordx2 v[30:31], v10, s[92:95], 0 offen offset:128
    buffer_load_dwordx2 v[32:33], v10, s[92:95], 0 offen offset:256
    buffer_load_dwordx2 v[64:65], v10, s[96:99], 0 offen offset:0
    buffer_load_dwordx2 v[66:67], v10, s[96:99], 0 offen offset:128
    buffer_load_dwordx2 v[68:69], v10, s[96:99], 0 offen offset:256
    buffer_load_dwordx2 v[34:35], v10, s[92:95], 0 offen offset:1536
    buffer_load_dwordx2 v[36:37], v10, s[92:95], 0 offen offset:1664
    buffer_load_dwordx2 v[38:39], v10, s[92:95], 0 offen offset:1792
    buffer_load_dwordx2 v[70:71], v10, s[96:99], 0 offen offset:1536
    buffer_load_dwordx2 v[72:73], v10, s[96:99], 0 offen offset:1664
    buffer_load_dwordx2 v[74:75], v10, s[96:99], 0 offen offset:1792
    buffer_load_dwordx2 v[40:41], v11, s[92:95], 0 offen offset:0
    buffer_load_dwordx2 v[42:43], v11, s[92:95], 0 offen offset:128
    buffer_load_dwordx2 v[44:45], v11, s[92:95], 0 offen offset:256
    buffer_load_dwordx2 v[76:77], v11, s[96:99], 0 offen offset:0
    buffer_load_dwordx2 v[78:79], v11, s[96:99], 0 offen offset:128
    buffer_load_dwordx2 v[80:81], v11, s[96:99], 0 offen offset:256
    buffer_load_dwordx2 v[46:47], v11, s[92:95], 0 offen offset:1536
    buffer_load_dwordx2 v[48:49], v11, s[92:95], 0 offen offset:1664
    buffer_load_dwordx2 v[50:51], v11, s[92:95], 0 offen offset:1792
    buffer_load_dwordx2 v[82:83], v11, s[96:99], 0 offen offset:1536
    buffer_load_dwordx2 v[84:85], v11, s[96:99], 0 offen offset:1664
    buffer_load_dwordx2 v[86:87], v11, s[96:99], 0 offen offset:1792
    buffer_load_dwordx2 v[52:53], v12, s[92:95], 0 offen offset:0
    buffer_load_dwordx2 v[54:55], v12, s[92:95], 0 offen offset:128
    buffer_load_dwordx2 v[56:57], v12, s[92:95], 0 offen offset:256
    buffer_load_dwordx2 v[88:89], v12, s[96:99], 0 offen offset:0
    buffer_load_dwordx2 v[90:91], v12, s[96:99], 0 offen offset:128
    buffer_load_dwordx2 v[92:93], v12, s[96:99], 0 offen offset:256
    buffer_load_dwordx2 v[58:59], v12, s[92:95], 0 offen offset:1536
    buffer_load_dwordx2 v[60:61], v12, s[92:95], 0 offen offset:1664
    buffer_load_dwordx2 v[62:63], v12, s[92:95], 0 offen offset:1792
    buffer_load_dwordx2 v[94:95], v12, s[96:99], 0 offen offset:1536
    buffer_load_dwordx2 v[96:97], v12, s[96:99], 0 offen offset:1664
    buffer_load_dwordx2 v[98:99], v12, s[96:99], 0 offen offset:1792
    s_waitcnt vmcnt(0)
    v_lshlrev_b32 v16, 16, v100
    v_and_b32 v17, 0xffff0000, v100
    v_lshlrev_b32 v18, 16, v101
    v_and_b32 v19, 0xffff0000, v101
    v_lshlrev_b32 v20, 16, v102
    v_and_b32 v21, 0xffff0000, v102
    v_lshlrev_b32 v22, 16, v103
    v_and_b32 v23, 0xffff0000, v103
    v_lshlrev_b32 v24, 16, v104
    v_and_b32 v25, 0xffff0000, v104
    v_lshlrev_b32 v26, 16, v105
    v_and_b32 v27, 0xffff0000, v105
    v_lshlrev_b32 v10, 16, v28
    v_lshlrev_b32 v11, 16, v64
    v_and_b32 v28, 0xffff0000, v28
    v_and_b32 v64, 0xffff0000, v64
    v_mul_f32 v10, v10, v16
    v_mul_f32 v28, v28, v17
    v_mul_f32 v100, v10, v11
    v_fmac_f32 v100, v28, v64
    v_lshlrev_b32 v10, 16, v29
    v_lshlrev_b32 v11, 16, v65
    v_and_b32 v29, 0xffff0000, v29
    v_and_b32 v65, 0xffff0000, v65
    v_mul_f32 v10, v10, v18
    v_mul_f32 v29, v29, v19
    v_fmac_f32 v100, v10, v11
    v_fmac_f32 v100, v29, v65
    v_lshlrev_b32 v10, 16, v30
    v_lshlrev_b32 v11, 16, v66
    v_and_b32 v30, 0xffff0000, v30
    v_and_b32 v66, 0xffff0000, v66
    v_mul_f32 v10, v10, v20
    v_mul_f32 v30, v30, v21
    v_fmac_f32 v100, v10, v11
    v_fmac_f32 v100, v30, v66
    v_lshlrev_b32 v10, 16, v31
    v_lshlrev_b32 v11, 16, v67
    v_and_b32 v31, 0xffff0000, v31
    v_and_b32 v67, 0xffff0000, v67
    v_mul_f32 v10, v10, v22
    v_mul_f32 v31, v31, v23
    v_fmac_f32 v100, v10, v11
    v_fmac_f32 v100, v31, v67
    v_lshlrev_b32 v10, 16, v32
    v_lshlrev_b32 v11, 16, v68
    v_and_b32 v32, 0xffff0000, v32
    v_and_b32 v68, 0xffff0000, v68
    v_mul_f32 v10, v10, v24
    v_mul_f32 v32, v32, v25
    v_fmac_f32 v100, v10, v11
    v_fmac_f32 v100, v32, v68
    v_lshlrev_b32 v10, 16, v33
    v_lshlrev_b32 v11, 16, v69
    v_and_b32 v33, 0xffff0000, v33
    v_and_b32 v69, 0xffff0000, v69
    v_mul_f32 v10, v10, v26
    v_mul_f32 v33, v33, v27
    v_fmac_f32 v100, v10, v11
    v_fmac_f32 v100, v33, v69
    v_lshlrev_b32 v10, 16, v34
    v_lshlrev_b32 v11, 16, v70
    v_and_b32 v34, 0xffff0000, v34
    v_and_b32 v70, 0xffff0000, v70
    v_mul_f32 v10, v10, v16
    v_mul_f32 v34, v34, v17
    v_mul_f32 v101, v10, v11
    v_fmac_f32 v101, v34, v70
    v_lshlrev_b32 v10, 16, v35
    v_lshlrev_b32 v11, 16, v71
    v_and_b32 v35, 0xffff0000, v35
    v_and_b32 v71, 0xffff0000, v71
    v_mul_f32 v10, v10, v18
    v_mul_f32 v35, v35, v19
    v_fmac_f32 v101, v10, v11
    v_fmac_f32 v101, v35, v71
    v_lshlrev_b32 v10, 16, v36
    v_lshlrev_b32 v11, 16, v72
    v_and_b32 v36, 0xffff0000, v36
    v_and_b32 v72, 0xffff0000, v72
    v_mul_f32 v10, v10, v20
    v_mul_f32 v36, v36, v21
    v_fmac_f32 v101, v10, v11
    v_fmac_f32 v101, v36, v72
    v_lshlrev_b32 v10, 16, v37
    v_lshlrev_b32 v11, 16, v73
    v_and_b32 v37, 0xffff0000, v37
    v_and_b32 v73, 0xffff0000, v73
    v_mul_f32 v10, v10, v22
    v_mul_f32 v37, v37, v23
    v_fmac_f32 v101, v10, v11
    v_fmac_f32 v101, v37, v73
    v_lshlrev_b32 v10, 16, v38
    v_lshlrev_b32 v11, 16, v74
    v_and_b32 v38, 0xffff0000, v38
    v_and_b32 v74, 0xffff0000, v74
    v_mul_f32 v10, v10, v24
    v_mul_f32 v38, v38, v25
    v_fmac_f32 v101, v10, v11
    v_fmac_f32 v101, v38, v74
    v_lshlrev_b32 v10, 16, v39
    v_lshlrev_b32 v11, 16, v75
    v_and_b32 v39, 0xffff0000, v39
    v_and_b32 v75, 0xffff0000, v75
    v_mul_f32 v10, v10, v26
    v_mul_f32 v39, v39, v27
    v_fmac_f32 v101, v10, v11
    v_fmac_f32 v101, v39, v75
    v_lshlrev_b32 v10, 16, v40
    v_lshlrev_b32 v11, 16, v76
    v_and_b32 v40, 0xffff0000, v40
    v_and_b32 v76, 0xffff0000, v76
    v_mul_f32 v10, v10, v16
    v_mul_f32 v40, v40, v17
    v_mul_f32 v102, v10, v11
    v_fmac_f32 v102, v40, v76
    v_lshlrev_b32 v10, 16, v41
    v_lshlrev_b32 v11, 16, v77
    v_and_b32 v41, 0xffff0000, v41
    v_and_b32 v77, 0xffff0000, v77
    v_mul_f32 v10, v10, v18
    v_mul_f32 v41, v41, v19
    v_fmac_f32 v102, v10, v11
    v_fmac_f32 v102, v41, v77
    v_lshlrev_b32 v10, 16, v42
    v_lshlrev_b32 v11, 16, v78
    v_and_b32 v42, 0xffff0000, v42
    v_and_b32 v78, 0xffff0000, v78
    v_mul_f32 v10, v10, v20
    v_mul_f32 v42, v42, v21
    v_fmac_f32 v102, v10, v11
    v_fmac_f32 v102, v42, v78
    v_lshlrev_b32 v10, 16, v43
    v_lshlrev_b32 v11, 16, v79
    v_and_b32 v43, 0xffff0000, v43
    v_and_b32 v79, 0xffff0000, v79
    v_mul_f32 v10, v10, v22
    v_mul_f32 v43, v43, v23
    v_fmac_f32 v102, v10, v11
    v_fmac_f32 v102, v43, v79
    v_lshlrev_b32 v10, 16, v44
    v_lshlrev_b32 v11, 16, v80
    v_and_b32 v44, 0xffff0000, v44
    v_and_b32 v80, 0xffff0000, v80
    v_mul_f32 v10, v10, v24
    v_mul_f32 v44, v44, v25
    v_fmac_f32 v102, v10, v11
    v_fmac_f32 v102, v44, v80
    v_lshlrev_b32 v10, 16, v45
    v_lshlrev_b32 v11, 16, v81
    v_and_b32 v45, 0xffff0000, v45
    v_and_b32 v81, 0xffff0000, v81
    v_mul_f32 v10, v10, v26
    v_mul_f32 v45, v45, v27
    v_fmac_f32 v102, v10, v11
    v_fmac_f32 v102, v45, v81
    v_lshlrev_b32 v10, 16, v46
    v_lshlrev_b32 v11, 16, v82
    v_and_b32 v46, 0xffff0000, v46
    v_and_b32 v82, 0xffff0000, v82
    v_mul_f32 v10, v10, v16
    v_mul_f32 v46, v46, v17
    v_mul_f32 v103, v10, v11
    v_fmac_f32 v103, v46, v82
    v_lshlrev_b32 v10, 16, v47
    v_lshlrev_b32 v11, 16, v83
    v_and_b32 v47, 0xffff0000, v47
    v_and_b32 v83, 0xffff0000, v83
    v_mul_f32 v10, v10, v18
    v_mul_f32 v47, v47, v19
    v_fmac_f32 v103, v10, v11
    v_fmac_f32 v103, v47, v83
    v_lshlrev_b32 v10, 16, v48
    v_lshlrev_b32 v11, 16, v84
    v_and_b32 v48, 0xffff0000, v48
    v_and_b32 v84, 0xffff0000, v84
    v_mul_f32 v10, v10, v20
    v_mul_f32 v48, v48, v21
    v_fmac_f32 v103, v10, v11
    v_fmac_f32 v103, v48, v84
    v_lshlrev_b32 v10, 16, v49
    v_lshlrev_b32 v11, 16, v85
    v_and_b32 v49, 0xffff0000, v49
    v_and_b32 v85, 0xffff0000, v85
    v_mul_f32 v10, v10, v22
    v_mul_f32 v49, v49, v23
    v_fmac_f32 v103, v10, v11
    v_fmac_f32 v103, v49, v85
    v_lshlrev_b32 v10, 16, v50
    v_lshlrev_b32 v11, 16, v86
    v_and_b32 v50, 0xffff0000, v50
    v_and_b32 v86, 0xffff0000, v86
    v_mul_f32 v10, v10, v24
    v_mul_f32 v50, v50, v25
    v_fmac_f32 v103, v10, v11
    v_fmac_f32 v103, v50, v86
    v_lshlrev_b32 v10, 16, v51
    v_lshlrev_b32 v11, 16, v87
    v_and_b32 v51, 0xffff0000, v51
    v_and_b32 v87, 0xffff0000, v87
    v_mul_f32 v10, v10, v26
    v_mul_f32 v51, v51, v27
    v_fmac_f32 v103, v10, v11
    v_fmac_f32 v103, v51, v87
    v_lshlrev_b32 v10, 16, v52
    v_lshlrev_b32 v11, 16, v88
    v_and_b32 v52, 0xffff0000, v52
    v_and_b32 v88, 0xffff0000, v88
    v_mul_f32 v10, v10, v16
    v_mul_f32 v52, v52, v17
    v_mul_f32 v104, v10, v11
    v_fmac_f32 v104, v52, v88
    v_lshlrev_b32 v10, 16, v53
    v_lshlrev_b32 v11, 16, v89
    v_and_b32 v53, 0xffff0000, v53
    v_and_b32 v89, 0xffff0000, v89
    v_mul_f32 v10, v10, v18
    v_mul_f32 v53, v53, v19
    v_fmac_f32 v104, v10, v11
    v_fmac_f32 v104, v53, v89
    v_lshlrev_b32 v10, 16, v54
    v_lshlrev_b32 v11, 16, v90
    v_and_b32 v54, 0xffff0000, v54
    v_and_b32 v90, 0xffff0000, v90
    v_mul_f32 v10, v10, v20
    v_mul_f32 v54, v54, v21
    v_fmac_f32 v104, v10, v11
    v_fmac_f32 v104, v54, v90
    v_lshlrev_b32 v10, 16, v55
    v_lshlrev_b32 v11, 16, v91
    v_and_b32 v55, 0xffff0000, v55
    v_and_b32 v91, 0xffff0000, v91
    v_mul_f32 v10, v10, v22
    v_mul_f32 v55, v55, v23
    v_fmac_f32 v104, v10, v11
    v_fmac_f32 v104, v55, v91
    v_lshlrev_b32 v10, 16, v56
    v_lshlrev_b32 v11, 16, v92
    v_and_b32 v56, 0xffff0000, v56
    v_and_b32 v92, 0xffff0000, v92
    v_mul_f32 v10, v10, v24
    v_mul_f32 v56, v56, v25
    v_fmac_f32 v104, v10, v11
    v_fmac_f32 v104, v56, v92
    v_lshlrev_b32 v10, 16, v57
    v_lshlrev_b32 v11, 16, v93
    v_and_b32 v57, 0xffff0000, v57
    v_and_b32 v93, 0xffff0000, v93
    v_mul_f32 v10, v10, v26
    v_mul_f32 v57, v57, v27
    v_fmac_f32 v104, v10, v11
    v_fmac_f32 v104, v57, v93
    v_lshlrev_b32 v10, 16, v58
    v_lshlrev_b32 v11, 16, v94
    v_and_b32 v58, 0xffff0000, v58
    v_and_b32 v94, 0xffff0000, v94
    v_mul_f32 v10, v10, v16
    v_mul_f32 v58, v58, v17
    v_mul_f32 v105, v10, v11
    v_fmac_f32 v105, v58, v94
    v_lshlrev_b32 v10, 16, v59
    v_lshlrev_b32 v11, 16, v95
    v_and_b32 v59, 0xffff0000, v59
    v_and_b32 v95, 0xffff0000, v95
    v_mul_f32 v10, v10, v18
    v_mul_f32 v59, v59, v19
    v_fmac_f32 v105, v10, v11
    v_fmac_f32 v105, v59, v95
    v_lshlrev_b32 v10, 16, v60
    v_lshlrev_b32 v11, 16, v96
    v_and_b32 v60, 0xffff0000, v60
    v_and_b32 v96, 0xffff0000, v96
    v_mul_f32 v10, v10, v20
    v_mul_f32 v60, v60, v21
    v_fmac_f32 v105, v10, v11
    v_fmac_f32 v105, v60, v96
    v_lshlrev_b32 v10, 16, v61
    v_lshlrev_b32 v11, 16, v97
    v_and_b32 v61, 0xffff0000, v61
    v_and_b32 v97, 0xffff0000, v97
    v_mul_f32 v10, v10, v22
    v_mul_f32 v61, v61, v23
    v_fmac_f32 v105, v10, v11
    v_fmac_f32 v105, v61, v97
    v_lshlrev_b32 v10, 16, v62
    v_lshlrev_b32 v11, 16, v98
    v_and_b32 v62, 0xffff0000, v62
    v_and_b32 v98, 0xffff0000, v98
    v_mul_f32 v10, v10, v24
    v_mul_f32 v62, v62, v25
    v_fmac_f32 v105, v10, v11
    v_fmac_f32 v105, v62, v98
    v_lshlrev_b32 v10, 16, v63
    v_lshlrev_b32 v11, 16, v99
    v_and_b32 v63, 0xffff0000, v63
    v_and_b32 v99, 0xffff0000, v99
    v_mul_f32 v10, v10, v26
    v_mul_f32 v63, v63, v27
    v_fmac_f32 v105, v10, v11
    v_fmac_f32 v105, v63, v99
    v_add_f32_dpp v100, v100, v100 row_ror:8 row_mask:0xf bank_mask:0xf
    v_add_f32_dpp v101, v101, v101 row_ror:8 row_mask:0xf bank_mask:0xf
    v_add_f32_dpp v102, v102, v102 row_ror:8 row_mask:0xf bank_mask:0xf
    v_add_f32_dpp v103, v103, v103 row_ror:8 row_mask:0xf bank_mask:0xf
    v_add_f32_dpp v104, v104, v104 row_ror:8 row_mask:0xf bank_mask:0xf
    v_add_f32_dpp v105, v105, v105 row_ror:8 row_mask:0xf bank_mask:0xf
    v_add_f32_dpp v100, v100, v100 row_ror:4 row_mask:0xf bank_mask:0xf
    v_add_f32_dpp v101, v101, v101 row_ror:4 row_mask:0xf bank_mask:0xf
    v_add_f32_dpp v102, v102, v102 row_ror:4 row_mask:0xf bank_mask:0xf
    v_add_f32_dpp v103, v103, v103 row_ror:4 row_mask:0xf bank_mask:0xf
    v_add_f32_dpp v104, v104, v104 row_ror:4 row_mask:0xf bank_mask:0xf
    v_add_f32_dpp v105, v105, v105 row_ror:4 row_mask:0xf bank_mask:0xf
    v_add_f32_dpp v100, v100, v100 row_ror:2 row_mask:0xf bank_mask:0xf
    v_add_f32_dpp v101, v101, v101 row_ror:2 row_mask:0xf bank_mask:0xf
    v_add_f32_dpp v102, v102, v102 row_ror:2 row_mask:0xf bank_mask:0xf
    v_add_f32_dpp v103, v103, v103 row_ror:2 row_mask:0xf bank_mask:0xf
    v_add_f32_dpp v104, v104, v104 row_ror:2 row_mask:0xf bank_mask:0xf
    v_add_f32_dpp v105, v105, v105 row_ror:2 row_mask:0xf bank_mask:0xf
    v_add_f32_dpp v100, v100, v100 row_ror:1 row_mask:0xf bank_mask:0xf
    v_add_f32_dpp v101, v101, v101 row_ror:1 row_mask:0xf bank_mask:0xf
    v_add_f32_dpp v102, v102, v102 row_ror:1 row_mask:0xf bank_mask:0xf
    v_add_f32_dpp v103, v103, v103 row_ror:1 row_mask:0xf bank_mask:0xf
    v_add_f32_dpp v104, v104, v104 row_ror:1 row_mask:0xf bank_mask:0xf
    v_add_f32_dpp v105, v105, v105 row_ror:1 row_mask:0xf bank_mask:0xf
    v_cmp_eq_u32 vcc, 1, v5
    s_nop 1
    v_cndmask_b32 v100, v100, v101, vcc
    v_cmp_eq_u32 vcc, 2, v5
    s_nop 1
    v_cndmask_b32 v100, v100, v102, vcc
    v_cmp_eq_u32 vcc, 3, v5
    s_nop 1
    v_cndmask_b32 v100, v100, v103, vcc
    v_cmp_eq_u32 vcc, 4, v5
    s_nop 1
    v_cndmask_b32 v100, v100, v104, vcc
    v_cmp_eq_u32 vcc, 5, v5
    s_nop 1
    v_cndmask_b32 v100, v100, v105, vcc
    s_mul_i32 s48, s62, 768
    s_lshl_b32 s49, s49, 2
    s_add_u32 s48, s48, s49
    s_add_u32 s48, s48, 1179648
    s_mov_b32 exec_lo, 0x003f003f
    s_mov_b32 exec_hi, 0x003f003f
    buffer_store_dword v100, v13, s[12:15], s48 offen sc1
    s_mov_b64 exec, -1
    s_mov_b32 s60, 0x100000
L_wd0:
    s_nop 1
    ds_read_b32 v10, v2 offset:20
    s_sub_u32 s60, s60, 1
    s_cbranch_scc1 L_exit1
    s_waitcnt lgkmcnt(0)
    v_readfirstlane_b32 s48, v10
    s_cmp_eq_u32 s48, 0
    s_cbranch_scc1 L_wd0
    ds_read_b128 v[16:19], v2 offset:0
    ds_read_b64 v[20:21], v2 offset:16
    s_waitcnt lgkmcnt(0)
    v_readfirstlane_b32 s84, v16
    v_readfirstlane_b32 s85, v17
    v_readfirstlane_b32 s86, v18
    v_readfirstlane_b32 s87, v19
    v_readfirstlane_b32 s88, v20
    v_readfirstlane_b32 s89, v21
    s_mov_b32 s60, 0x100000
L_wf0:
    s_nop 1
    ds_read_b32 v10, v2 offset:40
    s_sub_u32 s60, s60, 1
    s_cbranch_scc1 L_exit1
    s_waitcnt lgkmcnt(0)
    v_readfirstlane_b32 s48, v10
    s_cmp_lt_u32 s48, 4
    s_cbranch_scc1 L_wf0
    s_cmp_eq_u32 s84, s87
    ds_read_b128 v[16:19], v4 offset:256
    ds_read_b128 v[20:23], v4 offset:1280
    ds_read_b128 v[24:27], v4 offset:2304
    ds_read_b128 v[28:31], v4 offset:3328
    ds_read_b128 v[32:35], v4 offset:4352
    ds_read_b128 v[36:39], v4 offset:5376
    s_add_u32 s54, s33, 0
    s_add_u32 s55, s33, 4096
    s_cmp_eq_u32 s84, s87
    s_waitcnt lgkmcnt(0)
    s_cselect_b32 exec_lo, 0xffff, -1
    s_cselect_b32 exec_hi, 0xffff0000, -1
    buffer_store_dwordx4 v[16:19], v4, s[12:15], s54 offen offset:0 sc1
    s_cselect_b32 exec_lo, 0x0, -1
    s_cselect_b32 exec_hi, 0xffff, -1
    buffer_store_dwordx4 v[20:23], v4, s[12:15], s54 offen offset:1024 sc1
    s_cselect_b32 exec_lo, 0xffff0000, -1
    s_cselect_b32 exec_hi, 0x0, -1
    buffer_store_dwordx4 v[24:27], v4, s[12:15], s54 offen offset:2048 sc1
    s_cselect_b32 exec_lo, 0xffff, -1
    s_cselect_b32 exec_hi, 0xffff0000, -1
    buffer_store_dwordx4 v[28:31], v4, s[12:15], s54 offen offset:3072 sc1
    s_cselect_b32 exec_lo, 0x0, -1
    s_cselect_b32 exec_hi, 0xffff, -1
    buffer_store_dwordx4 v[32:35], v4, s[12:15], s55 offen offset:0 sc1
    s_cselect_b32 exec_lo, 0xffff0000, -1
    s_cselect_b32 exec_hi, 0x0, -1
    buffer_store_dwordx4 v[36:39], v4, s[12:15], s55 offen offset:1024 sc1
    s_mov_b64 exec, -1
L_fl0:
    s_nop 1
    v_mov_b32 v10, 1
    s_waitcnt vmcnt(0)
    s_mov_b64 exec, 1
    buffer_store_dword v10, off, s[12:15], s32 sc1
    ds_write_b32 v2, v10 offset:52
    s_mov_b64 exec, -1
    s_mov_b32 s60, 0x100000
L_wb2:
    s_nop 1
    ds_read_b32 v10, v2 offset:60
    s_sub_u32 s60, s60, 1
    s_cbranch_scc1 L_exit1
    s_waitcnt lgkmcnt(0)
    v_readfirstlane_b32 s48, v10
    s_cmp_lt_u32 s48, 9
    s_cbranch_scc1 L_wb2
    s_mov_b32 s61, 2
    s_lshl_b32 s62, s61, 5
    s_add_u32 s62, s62, s3
    s_lshl_b32 s63, s62, 15
    s_add_u32 s63, s63, 1
    s_mul_hi_u32 s63, s63, 0xaaaaaaab
    s_lshr_b32 s63, s63, 7
    s_mul_i32 s48, s62, 171
    s_lshr_b32 s48, s48, 9
    s_mul_i32 s48, s48, 384
    s_mul_i32 s49, s4, 24
    s_add_u32 s50, s49, s63
    s_mul_i32 s50, s50, 384
    v_add_u32 v10, s50, v7
    v_add_u32 v11, 3072, v10
    v_add_u32 v12, 6144, v10
    buffer_load_dwordx2 v[100:101], v6, s[8:11], s48 offen offset:0
    buffer_load_dwordx2 v[102:103], v6, s[8:11], s48 offen offset:128
    buffer_load_dwordx2 v[104:105], v6, s[8:11], s48 offen offset:256
    buffer_load_dwordx2 v[28:29], v10, s[92:95], 0 offen offset:0
    buffer_load_dwordx2 v[30:31], v10, s[92:95], 0 offen offset:128
    buffer_load_dwordx2 v[32:33], v10, s[92:95], 0 offen offset:256
    buffer_load_dwordx2 v[64:65], v10, s[96:99], 0 offen offset:0
    buffer_load_dwordx2 v[66:67], v10, s[96:99], 0 offen offset:128
    buffer_load_dwordx2 v[68:69], v10, s[96:99], 0 offen offset:256
    buffer_load_dwordx2 v[34:35], v10, s[92:95], 0 offen offset:1536
    buffer_load_dwordx2 v[36:37], v10, s[92:95], 0 offen offset:1664
    buffer_load_dwordx2 v[38:39], v10, s[92:95], 0 offen offset:1792
    buffer_load_dwordx2 v[70:71], v10, s[96:99], 0 offen offset:1536
    buffer_load_dwordx2 v[72:73], v10, s[96:99], 0 offen offset:1664
    buffer_load_dwordx2 v[74:75], v10, s[96:99], 0 offen offset:1792
    buffer_load_dwordx2 v[40:41], v11, s[92:95], 0 offen offset:0
    buffer_load_dwordx2 v[42:43], v11, s[92:95], 0 offen offset:128
    buffer_load_dwordx2 v[44:45], v11, s[92:95], 0 offen offset:256
    buffer_load_dwordx2 v[76:77], v11, s[96:99], 0 offen offset:0
    buffer_load_dwordx2 v[78:79], v11, s[96:99], 0 offen offset:128
    buffer_load_dwordx2 v[80:81], v11, s[96:99], 0 offen offset:256
    buffer_load_dwordx2 v[46:47], v11, s[92:95], 0 offen offset:1536
    buffer_load_dwordx2 v[48:49], v11, s[92:95], 0 offen offset:1664
    buffer_load_dwordx2 v[50:51], v11, s[92:95], 0 offen offset:1792
    buffer_load_dwordx2 v[82:83], v11, s[96:99], 0 offen offset:1536
    buffer_load_dwordx2 v[84:85], v11, s[96:99], 0 offen offset:1664
    buffer_load_dwordx2 v[86:87], v11, s[96:99], 0 offen offset:1792
    buffer_load_dwordx2 v[52:53], v12, s[92:95], 0 offen offset:0
    buffer_load_dwordx2 v[54:55], v12, s[92:95], 0 offen offset:128
    buffer_load_dwordx2 v[56:57], v12, s[92:95], 0 offen offset:256
    buffer_load_dwordx2 v[88:89], v12, s[96:99], 0 offen offset:0
    buffer_load_dwordx2 v[90:91], v12, s[96:99], 0 offen offset:128
    buffer_load_dwordx2 v[92:93], v12, s[96:99], 0 offen offset:256
    buffer_load_dwordx2 v[58:59], v12, s[92:95], 0 offen offset:1536
    buffer_load_dwordx2 v[60:61], v12, s[92:95], 0 offen offset:1664
    buffer_load_dwordx2 v[62:63], v12, s[92:95], 0 offen offset:1792
    buffer_load_dwordx2 v[94:95], v12, s[96:99], 0 offen offset:1536
    buffer_load_dwordx2 v[96:97], v12, s[96:99], 0 offen offset:1664
    buffer_load_dwordx2 v[98:99], v12, s[96:99], 0 offen offset:1792
    s_waitcnt vmcnt(0)
    v_lshlrev_b32 v16, 16, v100
    v_and_b32 v17, 0xffff0000, v100
    v_lshlrev_b32 v18, 16, v101
    v_and_b32 v19, 0xffff0000, v101
    v_lshlrev_b32 v20, 16, v102
    v_and_b32 v21, 0xffff0000, v102
    v_lshlrev_b32 v22, 16, v103
    v_and_b32 v23, 0xffff0000, v103
    v_lshlrev_b32 v24, 16, v104
    v_and_b32 v25, 0xffff0000, v104
    v_lshlrev_b32 v26, 16, v105
    v_and_b32 v27, 0xffff0000, v105
    v_lshlrev_b32 v10, 16, v28
    v_lshlrev_b32 v11, 16, v64
    v_and_b32 v28, 0xffff0000, v28
    v_and_b32 v64, 0xffff0000, v64
    v_mul_f32 v10, v10, v16
    v_mul_f32 v28, v28, v17
    v_mul_f32 v100, v10, v11
    v_fmac_f32 v100, v28, v64
    v_lshlrev_b32 v10, 16, v29
    v_lshlrev_b32 v11, 16, v65
    v_and_b32 v29, 0xffff0000, v29
    v_and_b32 v65, 0xffff0000, v65
    v_mul_f32 v10, v10, v18
    v_mul_f32 v29, v29, v19
    v_fmac_f32 v100, v10, v11
    v_fmac_f32 v100, v29, v65
    v_lshlrev_b32 v10, 16, v30
    v_lshlrev_b32 v11, 16, v66
    v_and_b32 v30, 0xffff0000, v30
    v_and_b32 v66, 0xffff0000, v66
    v_mul_f32 v10, v10, v20
    v_mul_f32 v30, v30, v21
    v_fmac_f32 v100, v10, v11
    v_fmac_f32 v100, v30, v66
    v_lshlrev_b32 v10, 16, v31
    v_lshlrev_b32 v11, 16, v67
    v_and_b32 v31, 0xffff0000, v31
    v_and_b32 v67, 0xffff0000, v67
    v_mul_f32 v10, v10, v22
    v_mul_f32 v31, v31, v23
    v_fmac_f32 v100, v10, v11
    v_fmac_f32 v100, v31, v67
    v_lshlrev_b32 v10, 16, v32
    v_lshlrev_b32 v11, 16, v68
    v_and_b32 v32, 0xffff0000, v32
    v_and_b32 v68, 0xffff0000, v68
    v_mul_f32 v10, v10, v24
    v_mul_f32 v32, v32, v25
    v_fmac_f32 v100, v10, v11
    v_fmac_f32 v100, v32, v68
    v_lshlrev_b32 v10, 16, v33
    v_lshlrev_b32 v11, 16, v69
    v_and_b32 v33, 0xffff0000, v33
    v_and_b32 v69, 0xffff0000, v69
    v_mul_f32 v10, v10, v26
    v_mul_f32 v33, v33, v27
    v_fmac_f32 v100, v10, v11
    v_fmac_f32 v100, v33, v69
    v_lshlrev_b32 v10, 16, v34
    v_lshlrev_b32 v11, 16, v70
    v_and_b32 v34, 0xffff0000, v34
    v_and_b32 v70, 0xffff0000, v70
    v_mul_f32 v10, v10, v16
    v_mul_f32 v34, v34, v17
    v_mul_f32 v101, v10, v11
    v_fmac_f32 v101, v34, v70
    v_lshlrev_b32 v10, 16, v35
    v_lshlrev_b32 v11, 16, v71
    v_and_b32 v35, 0xffff0000, v35
    v_and_b32 v71, 0xffff0000, v71
    v_mul_f32 v10, v10, v18
    v_mul_f32 v35, v35, v19
    v_fmac_f32 v101, v10, v11
    v_fmac_f32 v101, v35, v71
    v_lshlrev_b32 v10, 16, v36
    v_lshlrev_b32 v11, 16, v72
    v_and_b32 v36, 0xffff0000, v36
    v_and_b32 v72, 0xffff0000, v72
    v_mul_f32 v10, v10, v20
    v_mul_f32 v36, v36, v21
    v_fmac_f32 v101, v10, v11
    v_fmac_f32 v101, v36, v72
    v_lshlrev_b32 v10, 16, v37
    v_lshlrev_b32 v11, 16, v73
    v_and_b32 v37, 0xffff0000, v37
    v_and_b32 v73, 0xffff0000, v73
    v_mul_f32 v10, v10, v22
    v_mul_f32 v37, v37, v23
    v_fmac_f32 v101, v10, v11
    v_fmac_f32 v101, v37, v73
    v_lshlrev_b32 v10, 16, v38
    v_lshlrev_b32 v11, 16, v74
    v_and_b32 v38, 0xffff0000, v38
    v_and_b32 v74, 0xffff0000, v74
    v_mul_f32 v10, v10, v24
    v_mul_f32 v38, v38, v25
    v_fmac_f32 v101, v10, v11
    v_fmac_f32 v101, v38, v74
    v_lshlrev_b32 v10, 16, v39
    v_lshlrev_b32 v11, 16, v75
    v_and_b32 v39, 0xffff0000, v39
    v_and_b32 v75, 0xffff0000, v75
    v_mul_f32 v10, v10, v26
    v_mul_f32 v39, v39, v27
    v_fmac_f32 v101, v10, v11
    v_fmac_f32 v101, v39, v75
    v_lshlrev_b32 v10, 16, v40
    v_lshlrev_b32 v11, 16, v76
    v_and_b32 v40, 0xffff0000, v40
    v_and_b32 v76, 0xffff0000, v76
    v_mul_f32 v10, v10, v16
    v_mul_f32 v40, v40, v17
    v_mul_f32 v102, v10, v11
    v_fmac_f32 v102, v40, v76
    v_lshlrev_b32 v10, 16, v41
    v_lshlrev_b32 v11, 16, v77
    v_and_b32 v41, 0xffff0000, v41
    v_and_b32 v77, 0xffff0000, v77
    v_mul_f32 v10, v10, v18
    v_mul_f32 v41, v41, v19
    v_fmac_f32 v102, v10, v11
    v_fmac_f32 v102, v41, v77
    v_lshlrev_b32 v10, 16, v42
    v_lshlrev_b32 v11, 16, v78
    v_and_b32 v42, 0xffff0000, v42
    v_and_b32 v78, 0xffff0000, v78
    v_mul_f32 v10, v10, v20
    v_mul_f32 v42, v42, v21
    v_fmac_f32 v102, v10, v11
    v_fmac_f32 v102, v42, v78
    v_lshlrev_b32 v10, 16, v43
    v_lshlrev_b32 v11, 16, v79
    v_and_b32 v43, 0xffff0000, v43
    v_and_b32 v79, 0xffff0000, v79
    v_mul_f32 v10, v10, v22
    v_mul_f32 v43, v43, v23
    v_fmac_f32 v102, v10, v11
    v_fmac_f32 v102, v43, v79
    v_lshlrev_b32 v10, 16, v44
    v_lshlrev_b32 v11, 16, v80
    v_and_b32 v44, 0xffff0000, v44
    v_and_b32 v80, 0xffff0000, v80
    v_mul_f32 v10, v10, v24
    v_mul_f32 v44, v44, v25
    v_fmac_f32 v102, v10, v11
    v_fmac_f32 v102, v44, v80
    v_lshlrev_b32 v10, 16, v45
    v_lshlrev_b32 v11, 16, v81
    v_and_b32 v45, 0xffff0000, v45
    v_and_b32 v81, 0xffff0000, v81
    v_mul_f32 v10, v10, v26
    v_mul_f32 v45, v45, v27
    v_fmac_f32 v102, v10, v11
    v_fmac_f32 v102, v45, v81
    v_lshlrev_b32 v10, 16, v46
    v_lshlrev_b32 v11, 16, v82
    v_and_b32 v46, 0xffff0000, v46
    v_and_b32 v82, 0xffff0000, v82
    v_mul_f32 v10, v10, v16
    v_mul_f32 v46, v46, v17
    v_mul_f32 v103, v10, v11
    v_fmac_f32 v103, v46, v82
    v_lshlrev_b32 v10, 16, v47
    v_lshlrev_b32 v11, 16, v83
    v_and_b32 v47, 0xffff0000, v47
    v_and_b32 v83, 0xffff0000, v83
    v_mul_f32 v10, v10, v18
    v_mul_f32 v47, v47, v19
    v_fmac_f32 v103, v10, v11
    v_fmac_f32 v103, v47, v83
    v_lshlrev_b32 v10, 16, v48
    v_lshlrev_b32 v11, 16, v84
    v_and_b32 v48, 0xffff0000, v48
    v_and_b32 v84, 0xffff0000, v84
    v_mul_f32 v10, v10, v20
    v_mul_f32 v48, v48, v21
    v_fmac_f32 v103, v10, v11
    v_fmac_f32 v103, v48, v84
    v_lshlrev_b32 v10, 16, v49
    v_lshlrev_b32 v11, 16, v85
    v_and_b32 v49, 0xffff0000, v49
    v_and_b32 v85, 0xffff0000, v85
    v_mul_f32 v10, v10, v22
    v_mul_f32 v49, v49, v23
    v_fmac_f32 v103, v10, v11
    v_fmac_f32 v103, v49, v85
    v_lshlrev_b32 v10, 16, v50
    v_lshlrev_b32 v11, 16, v86
    v_and_b32 v50, 0xffff0000, v50
    v_and_b32 v86, 0xffff0000, v86
    v_mul_f32 v10, v10, v24
    v_mul_f32 v50, v50, v25
    v_fmac_f32 v103, v10, v11
    v_fmac_f32 v103, v50, v86
    v_lshlrev_b32 v10, 16, v51
    v_lshlrev_b32 v11, 16, v87
    v_and_b32 v51, 0xffff0000, v51
    v_and_b32 v87, 0xffff0000, v87
    v_mul_f32 v10, v10, v26
    v_mul_f32 v51, v51, v27
    v_fmac_f32 v103, v10, v11
    v_fmac_f32 v103, v51, v87
    v_lshlrev_b32 v10, 16, v52
    v_lshlrev_b32 v11, 16, v88
    v_and_b32 v52, 0xffff0000, v52
    v_and_b32 v88, 0xffff0000, v88
    v_mul_f32 v10, v10, v16
    v_mul_f32 v52, v52, v17
    v_mul_f32 v104, v10, v11
    v_fmac_f32 v104, v52, v88
    v_lshlrev_b32 v10, 16, v53
    v_lshlrev_b32 v11, 16, v89
    v_and_b32 v53, 0xffff0000, v53
    v_and_b32 v89, 0xffff0000, v89
    v_mul_f32 v10, v10, v18
    v_mul_f32 v53, v53, v19
    v_fmac_f32 v104, v10, v11
    v_fmac_f32 v104, v53, v89
    v_lshlrev_b32 v10, 16, v54
    v_lshlrev_b32 v11, 16, v90
    v_and_b32 v54, 0xffff0000, v54
    v_and_b32 v90, 0xffff0000, v90
    v_mul_f32 v10, v10, v20
    v_mul_f32 v54, v54, v21
    v_fmac_f32 v104, v10, v11
    v_fmac_f32 v104, v54, v90
    v_lshlrev_b32 v10, 16, v55
    v_lshlrev_b32 v11, 16, v91
    v_and_b32 v55, 0xffff0000, v55
    v_and_b32 v91, 0xffff0000, v91
    v_mul_f32 v10, v10, v22
    v_mul_f32 v55, v55, v23
    v_fmac_f32 v104, v10, v11
    v_fmac_f32 v104, v55, v91
    v_lshlrev_b32 v10, 16, v56
    v_lshlrev_b32 v11, 16, v92
    v_and_b32 v56, 0xffff0000, v56
    v_and_b32 v92, 0xffff0000, v92
    v_mul_f32 v10, v10, v24
    v_mul_f32 v56, v56, v25
    v_fmac_f32 v104, v10, v11
    v_fmac_f32 v104, v56, v92
    v_lshlrev_b32 v10, 16, v57
    v_lshlrev_b32 v11, 16, v93
    v_and_b32 v57, 0xffff0000, v57
    v_and_b32 v93, 0xffff0000, v93
    v_mul_f32 v10, v10, v26
    v_mul_f32 v57, v57, v27
    v_fmac_f32 v104, v10, v11
    v_fmac_f32 v104, v57, v93
    v_lshlrev_b32 v10, 16, v58
    v_lshlrev_b32 v11, 16, v94
    v_and_b32 v58, 0xffff0000, v58
    v_and_b32 v94, 0xffff0000, v94
    v_mul_f32 v10, v10, v16
    v_mul_f32 v58, v58, v17
    v_mul_f32 v105, v10, v11
    v_fmac_f32 v105, v58, v94
    v_lshlrev_b32 v10, 16, v59
    v_lshlrev_b32 v11, 16, v95
    v_and_b32 v59, 0xffff0000, v59
    v_and_b32 v95, 0xffff0000, v95
    v_mul_f32 v10, v10, v18
    v_mul_f32 v59, v59, v19
    v_fmac_f32 v105, v10, v11
    v_fmac_f32 v105, v59, v95
    v_lshlrev_b32 v10, 16, v60
    v_lshlrev_b32 v11, 16, v96
    v_and_b32 v60, 0xffff0000, v60
    v_and_b32 v96, 0xffff0000, v96
    v_mul_f32 v10, v10, v20
    v_mul_f32 v60, v60, v21
    v_fmac_f32 v105, v10, v11
    v_fmac_f32 v105, v60, v96
    v_lshlrev_b32 v10, 16, v61
    v_lshlrev_b32 v11, 16, v97
    v_and_b32 v61, 0xffff0000, v61
    v_and_b32 v97, 0xffff0000, v97
    v_mul_f32 v10, v10, v22
    v_mul_f32 v61, v61, v23
    v_fmac_f32 v105, v10, v11
    v_fmac_f32 v105, v61, v97
    v_lshlrev_b32 v10, 16, v62
    v_lshlrev_b32 v11, 16, v98
    v_and_b32 v62, 0xffff0000, v62
    v_and_b32 v98, 0xffff0000, v98
    v_mul_f32 v10, v10, v24
    v_mul_f32 v62, v62, v25
    v_fmac_f32 v105, v10, v11
    v_fmac_f32 v105, v62, v98
    v_lshlrev_b32 v10, 16, v63
    v_lshlrev_b32 v11, 16, v99
    v_and_b32 v63, 0xffff0000, v63
    v_and_b32 v99, 0xffff0000, v99
    v_mul_f32 v10, v10, v26
    v_mul_f32 v63, v63, v27
    v_fmac_f32 v105, v10, v11
    v_fmac_f32 v105, v63, v99
    v_add_f32_dpp v100, v100, v100 row_ror:8 row_mask:0xf bank_mask:0xf
    v_add_f32_dpp v101, v101, v101 row_ror:8 row_mask:0xf bank_mask:0xf
    v_add_f32_dpp v102, v102, v102 row_ror:8 row_mask:0xf bank_mask:0xf
    v_add_f32_dpp v103, v103, v103 row_ror:8 row_mask:0xf bank_mask:0xf
    v_add_f32_dpp v104, v104, v104 row_ror:8 row_mask:0xf bank_mask:0xf
    v_add_f32_dpp v105, v105, v105 row_ror:8 row_mask:0xf bank_mask:0xf
    v_add_f32_dpp v100, v100, v100 row_ror:4 row_mask:0xf bank_mask:0xf
    v_add_f32_dpp v101, v101, v101 row_ror:4 row_mask:0xf bank_mask:0xf
    v_add_f32_dpp v102, v102, v102 row_ror:4 row_mask:0xf bank_mask:0xf
    v_add_f32_dpp v103, v103, v103 row_ror:4 row_mask:0xf bank_mask:0xf
    v_add_f32_dpp v104, v104, v104 row_ror:4 row_mask:0xf bank_mask:0xf
    v_add_f32_dpp v105, v105, v105 row_ror:4 row_mask:0xf bank_mask:0xf
    v_add_f32_dpp v100, v100, v100 row_ror:2 row_mask:0xf bank_mask:0xf
    v_add_f32_dpp v101, v101, v101 row_ror:2 row_mask:0xf bank_mask:0xf
    v_add_f32_dpp v102, v102, v102 row_ror:2 row_mask:0xf bank_mask:0xf
    v_add_f32_dpp v103, v103, v103 row_ror:2 row_mask:0xf bank_mask:0xf
    v_add_f32_dpp v104, v104, v104 row_ror:2 row_mask:0xf bank_mask:0xf
    v_add_f32_dpp v105, v105, v105 row_ror:2 row_mask:0xf bank_mask:0xf
    v_add_f32_dpp v100, v100, v100 row_ror:1 row_mask:0xf bank_mask:0xf
    v_add_f32_dpp v101, v101, v101 row_ror:1 row_mask:0xf bank_mask:0xf
    v_add_f32_dpp v102, v102, v102 row_ror:1 row_mask:0xf bank_mask:0xf
    v_add_f32_dpp v103, v103, v103 row_ror:1 row_mask:0xf bank_mask:0xf
    v_add_f32_dpp v104, v104, v104 row_ror:1 row_mask:0xf bank_mask:0xf
    v_add_f32_dpp v105, v105, v105 row_ror:1 row_mask:0xf bank_mask:0xf
    v_cmp_eq_u32 vcc, 1, v5
    s_nop 1
    v_cndmask_b32 v100, v100, v101, vcc
    v_cmp_eq_u32 vcc, 2, v5
    s_nop 1
    v_cndmask_b32 v100, v100, v102, vcc
    v_cmp_eq_u32 vcc, 3, v5
    s_nop 1
    v_cndmask_b32 v100, v100, v103, vcc
    v_cmp_eq_u32 vcc, 4, v5
    s_nop 1
    v_cndmask_b32 v100, v100, v104, vcc
    v_cmp_eq_u32 vcc, 5, v5
    s_nop 1
    v_cndmask_b32 v100, v100, v105, vcc
    s_mul_i32 s48, s62, 768
    s_lshl_b32 s49, s49, 2
    s_add_u32 s48, s48, s49
    s_add_u32 s48, s48, 1179648
    s_mov_b32 exec_lo, 0x003f003f
    s_mov_b32 exec_hi, 0x003f003f
    buffer_store_dword v100, v13, s[12:15], s48 offen sc1
    s_mov_b64 exec, -1
    s_mov_b32 s60, 0x100000
L_wf1:
    s_nop 1
    ds_read_b32 v10, v2 offset:44
    s_sub_u32 s60, s60, 1
    s_cbranch_scc1 L_exit1
    s_waitcnt lgkmcnt(0)
    v_readfirstlane_b32 s48, v10
    s_cmp_lt_u32 s48, 4
    s_cbranch_scc1 L_wf1
    s_cmp_eq_u32 s85, s88
    s_cbranch_scc1 L_fl1
    ds_read_b128 v[16:19], v4 offset:6400
    ds_read_b128 v[20:23], v4 offset:7424
    ds_read_b128 v[24:27], v4 offset:8448
    ds_read_b128 v[28:31], v4 offset:9472
    ds_read_b128 v[32:35], v4 offset:10496
    ds_read_b128 v[36:39], v4 offset:11520
    s_add_u32 s54, s33, 1572864
    s_add_u32 s55, s33, 1576960
    s_cmp_eq_u32 s85, s88
    s_waitcnt lgkmcnt(0)
    buffer_store_dwordx4 v[16:19], v4, s[12:15], s54 offen offset:0 sc1
    buffer_store_dwordx4 v[20:23], v4, s[12:15], s54 offen offset:1024 sc1
    buffer_store_dwordx4 v[24:27], v4, s[12:15], s54 offen offset:2048 sc1
    buffer_store_dwordx4 v[28:31], v4, s[12:15], s54 offen offset:3072 sc1
    buffer_store_dwordx4 v[32:35], v4, s[12:15], s55 offen offset:0 sc1
    buffer_store_dwordx4 v[36:39], v4, s[12:15], s55 offen offset:1024 sc1
L_fl1:
    s_nop 1
    v_mov_b32 v10, 2
    s_waitcnt vmcnt(0)
    s_mov_b64 exec, 1
    buffer_store_dword v10, off, s[12:15], s32 sc1
    ds_write_b32 v2, v10 offset:52
    s_mov_b64 exec, -1
    s_mov_b32 s60, 0x100000
L_wf2:
    s_nop 1
    ds_read_b32 v10, v2 offset:48
    s_sub_u32 s60, s60, 1
    s_cbranch_scc1 L_exit1
    s_waitcnt lgkmcnt(0)
    v_readfirstlane_b32 s48, v10
    s_cmp_lt_u32 s48, 4
    s_cbranch_scc1 L_wf2
    s_cmp_eq_u32 s86, s89
    s_cbranch_scc1 L_fl2
    ds_read_b128 v[16:19], v4 offset:12544
    ds_read_b128 v[20:23], v4 offset:13568
    ds_read_b128 v[24:27], v4 offset:14592
    ds_read_b128 v[28:31], v4 offset:15616
    ds_read_b128 v[32:35], v4 offset:16640
    ds_read_b128 v[36:39], v4 offset:17664
    s_add_u32 s54, s33, 3145728
    s_add_u32 s55, s33, 3149824
    s_cmp_eq_u32 s86, s89
    s_waitcnt lgkmcnt(0)
    buffer_store_dwordx4 v[16:19], v4, s[12:15], s54 offen offset:0 sc1
    buffer_store_dwordx4 v[20:23], v4, s[12:15], s54 offen offset:1024 sc1
    buffer_store_dwordx4 v[24:27], v4, s[12:15], s54 offen offset:2048 sc1
    buffer_store_dwordx4 v[28:31], v4, s[12:15], s54 offen offset:3072 sc1
    buffer_store_dwordx4 v[32:35], v4, s[12:15], s55 offen offset:0 sc1
    buffer_store_dwordx4 v[36:39], v4, s[12:15], s55 offen offset:1024 sc1
L_fl2:
    s_nop 1
    v_mov_b32 v10, 3
    s_waitcnt vmcnt(0)
    s_mov_b64 exec, 1
    s_cbranch_scc1 L_fn2
    buffer_store_dword v10, off, s[12:15], s32 sc1
L_fn2:
    s_nop 1
    ds_write_b32 v2, v10 offset:52
    s_mov_b64 exec, -1
    s_endpgm
L_h3:
    s_nop 1
    s_waitcnt lgkmcnt(0)
    s_mov_b32 s12, s82
    s_and_b32 s13, s83, 0xffff
    s_mov_b32 s14, 10485760
    s_mov_b32 s15, 0x00020000
    s_barrier
    v_lshlrev_b32 v7, 2, v1
    s_mul_i32 s20, s4, 4352
    s_add_u32 s20, s20, 10223616
    s_lshl_b32 s21, s3, 2
    s_add_u32 s21, s21, s20
    s_mov_b32 s46, 0x155
    v_lshrrev_b32 v13, 2, v1
    v_mul_u32_u24 v13, 4352, v13
    v_and_or_b32 v13, v7, 12, v13
    s_and_b32 s7, s4, 3
    s_mul_i32 s47, s7, 4352
    s_lshl_b32 s7, s7, 2
    v_mov_b32 v8, 208
    s_mov_b32 s45, 2
    v_mov_b32 v3, 144
    v_bfrev_b32 v6, -2
    s_mov_b32 exec_hi, 0
L_h3loop:
    s_nop 1
    s_mov_b32 s60, 0x100000
L_wp1:
    s_nop 1
    ds_read_b32 v10, v2 offset:128
    s_sub_u32 s60, s60, 1
    s_cbranch_scc1 L_exit1
    s_waitcnt lgkmcnt(0)
    v_readfirstlane_b32 s48, v10
    s_cmp_lt_u32 s48, s45
    s_cbranch_scc1 L_wp1
    s_memrealtime s[40:41]
    s_add_u32 s45, s45, 3
    s_mov_b32 exec_lo, 1
    s_waitcnt lgkmcnt(0)
    v_mov_b32 v5, s40
    buffer_store_dword v5, off, s[12:15], s21
    s_mov_b32 exec_lo, -1
    s_mov_b32 s60, 0x100000
L_wp2:
    s_nop 1
    ds_read_b32 v10, v2 offset:128
    s_sub_u32 s60, s60, 1
    s_cbranch_scc1 L_exit1
    s_waitcnt lgkmcnt(0)
    v_readfirstlane_b32 s48, v10
    s_cmp_lt_u32 s48, s45
    s_cbranch_scc1 L_wp2
    buffer_load_dword v5, v7, s[12:15], s20 offen sc0
    s_add_u32 s45, s45, 4
    s_sub_u32 s40, s40, 4096
    s_waitcnt vmcnt(0)
    v_subrev_u32 v5, s40, v5
    v_cmp_gt_u32 vcc, 8192, v5
    s_nop 1
    v_cndmask_b32 v5, v6, v5, vcc
    s_mov_b32 s48, 2048
    s_add_u32 s49, s48, 2048
    v_cmp_gt_u32 vcc, s49, v5
    s_bcnt1_i32_b64 s50, vcc
    s_cmp_lt_u32 s50, 16
    s_cselect_b32 s48, s49, s48
    s_add_u32 s49, s48, 1024
    v_cmp_gt_u32 vcc, s49, v5
    s_bcnt1_i32_b64 s50, vcc
    s_cmp_lt_u32 s50, 16
    s_cselect_b32 s48, s49, s48
    s_add_u32 s49, s48, 512
    v_cmp_gt_u32 vcc, s49, v5
    s_bcnt1_i32_b64 s50, vcc
    s_cmp_lt_u32 s50, 16
    s_cselect_b32 s48, s49, s48
    s_add_u32 s49, s48, 256
    v_cmp_gt_u32 vcc, s49, v5
    s_bcnt1_i32_b64 s50, vcc
    s_cmp_lt_u32 s50, 16
    s_cselect_b32 s48, s49, s48
    s_add_u32 s49, s48, 128
    v_cmp_gt_u32 vcc, s49, v5
    s_bcnt1_i32_b64 s50, vcc
    s_cmp_lt_u32 s50, 16
    s_cselect_b32 s48, s49, s48
    s_add_u32 s49, s48, 64
    v_cmp_gt_u32 vcc, s49, v5
    s_bcnt1_i32_b64 s50, vcc
    s_cmp_lt_u32 s50, 16
    s_cselect_b32 s48, s49, s48
    s_add_u32 s49, s48, 32
    v_cmp_gt_u32 vcc, s49, v5
    s_bcnt1_i32_b64 s50, vcc
    s_cmp_lt_u32 s50, 16
    s_cselect_b32 s48, s49, s48
    s_add_u32 s49, s48, 16
    v_cmp_gt_u32 vcc, s49, v5
    s_bcnt1_i32_b64 s50, vcc
    s_cmp_lt_u32 s50, 16
    s_cselect_b32 s48, s49, s48
    s_add_u32 s49, s48, 8
    v_cmp_gt_u32 vcc, s49, v5
    s_bcnt1_i32_b64 s50, vcc
    s_cmp_lt_u32 s50, 16
    s_cselect_b32 s48, s49, s48
    s_add_u32 s49, s48, s40
    s_or_b32 s49, s49, 1
    v_mov_b32 v5, s49
    ds_write_b32 v3, v5
    v_add_u32 v3, 4, v3
    s_bitcmp1_b32 s46, 0
    s_cbranch_scc0 L_h3ng
    s_cmp_lt_u32 s48, 6136
    s_cselect_b32 exec_lo, 1, 0
    s_cmp_lt_u32 s3, 4
    s_cselect_b32 exec_lo, exec_lo, 0
    buffer_store_dword v5, off, s[12:15], s21 offset:2048 sc1
    s_mov_b32 exec_lo, 0xffff
    s_add_u32 s51, s45, 0
    s_mov_b32 s60, 0x100000
L_wp3:
    s_nop 1
    ds_read_b32 v10, v2 offset:128
    s_sub_u32 s60, s60, 1
    s_cbranch_scc1 L_exit1
    s_waitcnt lgkmcnt(0)
    v_readfirstlane_b32 s48, v10
    s_cmp_lt_u32 s48, s51
    s_cbranch_scc1 L_wp3
    s_sub_u32 s51, s20, s47
    s_mov_b32 s60, 8
    s_mov_b32 s48, 0
L_h3gp:
    s_nop 1
    buffer_load_dword v4, v13, s[12:15], s51 offen offset:2048 sc1
    s_sub_u32 s60, s60, 1
    s_cbranch_scc1 L_h3gw
L_h3gq:
    s_waitcnt vmcnt(0)
    v_subrev_u32 v4, s40, v4
    v_cmp_gt_u32 vcc, 8192, v4
    s_nop 1
    v_cndmask_b32 v4, v6, v4, vcc
    s_nop 1
    v_min_u32_dpp v4, v4, v4 quad_perm:[1,0,3,2] row_mask:0xf bank_mask:0xf
    s_nop 1
    v_min_u32_dpp v4, v4, v4 quad_perm:[2,3,0,1] row_mask:0xf bank_mask:0xf
    v_cmp_eq_u32 vcc, v6, v4
    s_cbranch_vccnz L_h3gp
    v_readlane_b32 s52, v4, 0
    v_readlane_b32 s53, v4, 4
    v_readlane_b32 s54, v4, 8
    v_readlane_b32 s55, v4, 12
    v_readlane_b32 s49, v4, s7
    s_max_u32 s52, s52, s53
    s_max_u32 s54, s54, s55
    s_max_u32 s48, s52, s54
    s_sub_u32 s48, s48, s49
    s_sub_u32 s48, s48, 10
    s_max_i32 s48, s48, 0
    s_min_i32 s48, s48, 1000
L_h3gw:
    s_nop 1
    s_or_b32 s48, s48, 0x10000
    v_mov_b32 v5, s48
    ds_write_b32 v8, v5
    s_mov_b32 exec_lo, -1
    v_add_u32 v8, 4, v8
    s_waitcnt vmcnt(0)
L_h3ng:
    s_nop 1
    s_lshr_b32 s46, s46, 1
    s_add_u32 s45, s45, 5
    s_add_u32 s20, s20, 128
    s_add_u32 s21, s21, 128
    s_cmp_lt_u32 s45, 132
    s_cbranch_scc1 L_h3loop
    s_mov_b64 exec, -1
    v_lshlrev_b32 v12, 2, v1
    v_add_u32 v13, 49408, v12
    v_lshlrev_b32 v8, 4, v1
    s_add_u32 s48, s3, 64
    s_mul_i32 s48, s48, 171
    s_lshr_b32 s48, s48, 9
    s_mul_i32 s58, s48, 4352
    s_add_u32 s58, s58, 9498368
    s_mul_i32 s59, s48, 384
    s_cmp_eq_u32 s48, 21
    s_cselect_b32 s20, 15, 23
    s_mul_i32 s48, s48, 24
    s_add_u32 s62, s2, 512
    s_sub_u32 s56, s62, s48
    s_lshl_b32 s62, s62, 10
    s_mov_b32 s60, 0x40000
L_fs:
    s_nop 1
    buffer_load_dword v4, off, s[12:15], s58 offset:4 sc1
    s_sub_u32 s60, s60, 1
    s_cbranch_scc1 L_exit1
    s_waitcnt vmcnt(0)
    v_cmp_eq_u32 vcc, 0, v4
    s_cbranch_vccnz L_fs
    buffer_load_dword v10, v12, s[12:15], s58 offen offset:128 sc1
    ds_read_b128 v[4:7], v2 offset:112
    v_xor_b32 v11, 1, v1
    v_cmp_eq_u32 vcc, s56, v1
    s_nop 1
    v_cndmask_b32 v11, v1, v11, vcc
    v_add_u32 v11, s48, v11
    v_lshlrev_b32 v11, 10, v11
    s_nop 0
    v_readlane_b32 s64, v11, 0
    v_readlane_b32 s65, v11, 1
    v_readlane_b32 s66, v11, 2
    v_readlane_b32 s67, v11, 3
    v_readlane_b32 s68, v11, 4
    v_readlane_b32 s69, v11, 5
    v_readlane_b32 s70, v11, 6
    v_readlane_b32 s71, v11, 7
    v_readlane_b32 s72, v11, 8
    v_readlane_b32 s73, v11, 9
    v_readlane_b32 s74, v11, 10
    v_readlane_b32 s75, v11, 11
    v_readlane_b32 s84, v11, 12
    v_readlane_b32 s85, v11, 13
    v_readlane_b32 s86, v11, 14
    v_readlane_b32 s87, v11, 15
    v_readlane_b32 s88, v11, 16
    v_readlane_b32 s89, v11, 17
    v_readlane_b32 s90, v11, 18
    v_readlane_b32 s91, v11, 19
    v_readlane_b32 s92, v11, 20
    v_readlane_b32 s93, v11, 21
    v_readlane_b32 s94, v11, 22
    v_readlane_b32 s95, v11, 23
    s_mov_b32 s96, s78
    s_and_b32 s97, s79, 0xffff
    s_mov_b32 s98, 12288
    s_mov_b32 s99, 0x00020000
    v_lshlrev_b32 v12, 1, v1
    s_waitcnt vmcnt(0)
    v_readlane_b32 s57, v10, s56
    v_cndmask_b32 v10, v10, v2, vcc
    s_nop 0
    v_readlane_b32 s24, v10, 0
    v_readlane_b32 s25, v10, 1
    v_readlane_b32 s26, v10, 2
    v_readlane_b32 s27, v10, 3
    v_readlane_b32 s28, v10, 4
    v_readlane_b32 s29, v10, 5
    v_readlane_b32 s30, v10, 6
    v_readlane_b32 s31, v10, 7
    v_readlane_b32 s32, v10, 8
    v_readlane_b32 s33, v10, 9
    v_readlane_b32 s34, v10, 10
    v_readlane_b32 s35, v10, 11
    v_readlane_b32 s36, v10, 12
    v_readlane_b32 s37, v10, 13
    v_readlane_b32 s38, v10, 14
    v_readlane_b32 s39, v10, 15
    v_readlane_b32 s40, v10, 16
    v_readlane_b32 s41, v10, 17
    v_readlane_b32 s42, v10, 18
    v_readlane_b32 s43, v10, 19
    v_readlane_b32 s44, v10, 20
    v_readlane_b32 s45, v10, 21
    v_readlane_b32 s46, v10, 22
    v_readlane_b32 s47, v10, 23
    v_mov_b32 v9, 1
    s_mov_b64 exec, 1
    s_mov_b32 s60, 0x100000
L_wel:
    s_nop 1
    ds_read_b32 v10, v2 offset:136
    s_sub_u32 s60, s60, 1
    s_cbranch_scc1 L_exit1
    s_waitcnt lgkmcnt(0)
    v_readfirstlane_b32 s48, v10
    s_cmp_lt_u32 s48, 4
    s_cbranch_scc1 L_wel
    buffer_atomic_add v9, off, s[12:15], s58 sc0
    s_mov_b64 exec, -1
    s_waitcnt vmcnt(0)
    v_readfirstlane_b32 s48, v9
    s_cmp_lg_u32 s48, s20
    s_cbranch_scc1 L_exit1
    buffer_load_dwordx4 v[32:35], v8, s[12:15], s64 offen sc1
    buffer_load_dwordx4 v[36:39], v8, s[12:15], s65 offen sc1
    buffer_load_dwordx4 v[40:43], v8, s[12:15], s66 offen sc1
    buffer_load_dwordx4 v[44:47], v8, s[12:15], s67 offen sc1
    buffer_load_dwordx4 v[48:51], v8, s[12:15], s68 offen sc1
    buffer_load_dwordx4 v[52:55], v8, s[12:15], s69 offen sc1
    buffer_load_dwordx4 v[56:59], v8, s[12:15], s70 offen sc1
    buffer_load_dwordx4 v[60:63], v8, s[12:15], s71 offen sc1
    buffer_load_dwordx4 v[64:67], v8, s[12:15], s72 offen sc1
    buffer_load_dwordx4 v[68:71], v8, s[12:15], s73 offen sc1
    buffer_load_dwordx4 v[72:75], v8, s[12:15], s74 offen sc1
    buffer_load_dwordx4 v[76:79], v8, s[12:15], s75 offen sc1
    buffer_load_dwordx4 v[80:83], v8, s[12:15], s84 offen sc1
    buffer_load_dwordx4 v[84:87], v8, s[12:15], s85 offen sc1
    buffer_load_dwordx4 v[88:91], v8, s[12:15], s86 offen sc1
    buffer_load_dwordx4 v[92:95], v8, s[12:15], s87 offen sc1
    buffer_load_dwordx4 v[96:99], v8, s[12:15], s88 offen sc1
    buffer_load_dwordx4 v[100:103], v8, s[12:15], s89 offen sc1
    buffer_load_dwordx4 v[104:107], v8, s[12:15], s90 offen sc1
    buffer_load_dwordx4 v[108:111], v8, s[12:15], s91 offen sc1
    buffer_load_dwordx4 v[112:115], v8, s[12:15], s92 offen sc1
    buffer_load_dwordx4 v[116:119], v8, s[12:15], s93 offen sc1
    buffer_load_dwordx4 v[120:123], v8, s[12:15], s94 offen sc1
    buffer_load_dwordx4 v[124:127], v8, s[12:15], s95 offen sc1
    s_mov_b32 s60, 0x100000
L_wn:
    s_nop 1
    ds_read_b32 v10, v2 offset:72
    s_sub_u32 s60, s60, 1
    s_cbranch_scc1 L_exit1
    s_waitcnt lgkmcnt(0)
    v_readfirstlane_b32 s48, v10
    s_cmp_lt_u32 s48, 4
    s_cbranch_scc1 L_wn
    ds_read_b32 v16, v13 offset:0
    ds_read_b32 v17, v13 offset:768
    ds_read_b32 v18, v13 offset:1536
    ds_read_b32 v19, v13 offset:2304
    ds_read_b32 v20, v13 offset:256
    ds_read_b32 v21, v13 offset:1024
    ds_read_b32 v22, v13 offset:1792
    ds_read_b32 v23, v13 offset:2560
    ds_read_b32 v24, v13 offset:512
    ds_read_b32 v25, v13 offset:1280
    ds_read_b32 v26, v13 offset:2048
    ds_read_b32 v27, v13 offset:2816
    s_mov_b32 s60, 0x40000
    s_waitcnt lgkmcnt(8)
    v_add_f32 v16, v16, v17
    v_add_f32 v18, v18, v19
    v_sub_f32 v16, v16, v6
    v_add_f32 v28, v16, v18
    s_waitcnt lgkmcnt(4)
    v_add_f32 v20, v20, v21
    v_add_f32 v22, v22, v23
    v_sub_f32 v20, v20, v6
    v_add_f32 v29, v20, v22
    s_waitcnt lgkmcnt(0)
    v_add_f32 v24, v24, v25
    v_add_f32 v26, v26, v27
    v_sub_f32 v24, v24, v6
    v_add_f32 v30, v24, v26
    s_branch L_fr2
L_fr:
    s_nop 1
    buffer_load_dwordx4 v[32:35], v8, s[12:15], s64 offen sc1
    buffer_load_dwordx4 v[36:39], v8, s[12:15], s65 offen sc1
    buffer_load_dwordx4 v[40:43], v8, s[12:15], s66 offen sc1
    buffer_load_dwordx4 v[44:47], v8, s[12:15], s67 offen sc1
    buffer_load_dwordx4 v[48:51], v8, s[12:15], s68 offen sc1
    buffer_load_dwordx4 v[52:55], v8, s[12:15], s69 offen sc1
    buffer_load_dwordx4 v[56:59], v8, s[12:15], s70 offen sc1
    buffer_load_dwordx4 v[60:63], v8, s[12:15], s71 offen sc1
    buffer_load_dwordx4 v[64:67], v8, s[12:15], s72 offen sc1
    buffer_load_dwordx4 v[68:71], v8, s[12:15], s73 offen sc1
    buffer_load_dwordx4 v[72:75], v8, s[12:15], s74 offen sc1
    buffer_load_dwordx4 v[76:79], v8, s[12:15], s75 offen sc1
    buffer_load_dwordx4 v[80:83], v8, s[12:15], s84 offen sc1
    buffer_load_dwordx4 v[84:87], v8, s[12:15], s85 offen sc1
    buffer_load_dwordx4 v[88:91], v8, s[12:15], s86 offen sc1
    buffer_load_dwordx4 v[92:95], v8, s[12:15], s87 offen sc1
    buffer_load_dwordx4 v[96:99], v8, s[12:15], s88 offen sc1
    buffer_load_dwordx4 v[100:103], v8, s[12:15], s89 offen sc1
    buffer_load_dwordx4 v[104:107], v8, s[12:15], s90 offen sc1
    buffer_load_dwordx4 v[108:111], v8, s[12:15], s91 offen sc1
    buffer_load_dwordx4 v[112:115], v8, s[12:15], s92 offen sc1
    buffer_load_dwordx4 v[116:119], v8, s[12:15], s93 offen sc1
    buffer_load_dwordx4 v[120:123], v8, s[12:15], s94 offen sc1
    buffer_load_dwordx4 v[124:127], v8, s[12:15], s95 offen sc1
L_fr2:
    v_mul_f32 v4, s57, v28
    v_mul_f32 v5, s57, v29
    v_mul_f32 v6, s57, v30
    v_mov_b32 v7, 1
    s_sub_u32 s60, s60, 1
    s_cbranch_scc1 L_exit1
    s_waitcnt vmcnt(22)
    v_fmac_f32 v4, s24, v32
    v_fmac_f32 v5, s24, v33
    v_fmac_f32 v6, s24, v34
    v_fmac_f32 v4, s25, v36
    v_fmac_f32 v5, s25, v37
    v_fmac_f32 v6, s25, v38
    v_min3_u32 v7, v7, v35, v39
    s_waitcnt vmcnt(20)
    v_fmac_f32 v4, s26, v40
    v_fmac_f32 v5, s26, v41
    v_fmac_f32 v6, s26, v42
    v_fmac_f32 v4, s27, v44
    v_fmac_f32 v5, s27, v45
    v_fmac_f32 v6, s27, v46
    v_min3_u32 v7, v7, v43, v47
    s_waitcnt vmcnt(18)
    v_fmac_f32 v4, s28, v48
    v_fmac_f32 v5, s28, v49
    v_fmac_f32 v6, s28, v50
    v_fmac_f32 v4, s29, v52
    v_fmac_f32 v5, s29, v53
    v_fmac_f32 v6, s29, v54
    v_min3_u32 v7, v7, v51, v55
    s_waitcnt vmcnt(16)
    v_fmac_f32 v4, s30, v56
    v_fmac_f32 v5, s30, v57
    v_fmac_f32 v6, s30, v58
    v_fmac_f32 v4, s31, v60
    v_fmac_f32 v5, s31, v61
    v_fmac_f32 v6, s31, v62
    v_min3_u32 v7, v7, v59, v63
    s_waitcnt vmcnt(14)
    v_fmac_f32 v4, s32, v64
    v_fmac_f32 v5, s32, v65
    v_fmac_f32 v6, s32, v66
    v_fmac_f32 v4, s33, v68
    v_fmac_f32 v5, s33, v69
    v_fmac_f32 v6, s33, v70
    v_min3_u32 v7, v7, v67, v71
    s_waitcnt vmcnt(12)
    v_fmac_f32 v4, s34, v72
    v_fmac_f32 v5, s34, v73
    v_fmac_f32 v6, s34, v74
    v_fmac_f32 v4, s35, v76
    v_fmac_f32 v5, s35, v77
    v_fmac_f32 v6, s35, v78
    v_min3_u32 v7, v7, v75, v79
    s_waitcnt vmcnt(10)
    v_fmac_f32 v4, s36, v80
    v_fmac_f32 v5, s36, v81
    v_fmac_f32 v6, s36, v82
    v_fmac_f32 v4, s37, v84
    v_fmac_f32 v5, s37, v85
    v_fmac_f32 v6, s37, v86
    v_min3_u32 v7, v7, v83, v87
    s_waitcnt vmcnt(8)
    v_fmac_f32 v4, s38, v88
    v_fmac_f32 v5, s38, v89
    v_fmac_f32 v6, s38, v90
    v_fmac_f32 v4, s39, v92
    v_fmac_f32 v5, s39, v93
    v_fmac_f32 v6, s39, v94
    v_min3_u32 v7, v7, v91, v95
    s_waitcnt vmcnt(6)
    v_fmac_f32 v4, s40, v96
    v_fmac_f32 v5, s40, v97
    v_fmac_f32 v6, s40, v98
    v_fmac_f32 v4, s41, v100
    v_fmac_f32 v5, s41, v101
    v_fmac_f32 v6, s41, v102
    v_min3_u32 v7, v7, v99, v103
    s_waitcnt vmcnt(4)
    v_fmac_f32 v4, s42, v104
    v_fmac_f32 v5, s42, v105
    v_fmac_f32 v6, s42, v106
    v_fmac_f32 v4, s43, v108
    v_fmac_f32 v5, s43, v109
    v_fmac_f32 v6, s43, v110
    v_min3_u32 v7, v7, v107, v111
    s_waitcnt vmcnt(2)
    v_fmac_f32 v4, s44, v112
    v_fmac_f32 v5, s44, v113
    v_fmac_f32 v6, s44, v114
    v_fmac_f32 v4, s45, v116
    v_fmac_f32 v5, s45, v117
    v_fmac_f32 v6, s45, v118
    v_min3_u32 v7, v7, v115, v119
    s_waitcnt vmcnt(0)
    v_fmac_f32 v4, s46, v120
    v_fmac_f32 v5, s46, v121
    v_fmac_f32 v6, s46, v122
    v_fmac_f32 v4, s47, v124
    v_fmac_f32 v5, s47, v125
    v_fmac_f32 v6, s47, v126
    v_min3_u32 v7, v7, v123, v127
    v_cmp_eq_u32 vcc, 0, v7
    v_cvt_pk_bf16_f32 v4, v4, v4
    v_cvt_pk_bf16_f32 v5, v5, v5
    v_cvt_pk_bf16_f32 v6, v6, v6
    s_cbranch_vccnz L_fr
    buffer_store_short v4, v12, s[96:99], s59 offen offset:0
    buffer_store_short v5, v12, s[96:99], s59 offen offset:128
    buffer_store_short v6, v12, s[96:99], s59 offen offset:256
L_fx:
    s_endpgm
L_h2:
    s_nop 1
    s_mov_b32 s92, s74
    s_and_b32 s93, s75, 0xffff
    s_mov_b32 s94, 2097152
    s_mov_b32 s95, 0x00020000
    s_mov_b32 s96, s76
    s_and_b32 s97, s77, 0xffff
    s_mov_b32 s98, 2097152
    s_mov_b32 s99, 0x00020000
    s_mov_b32 s60, 0x100000
L_wd2:
    s_nop 1
    ds_read_b32 v10, v2 offset:20
    s_sub_u32 s60, s60, 1
    s_cbranch_scc1 L_exit1
    s_waitcnt lgkmcnt(0)
    v_readfirstlane_b32 s48, v10
    s_cmp_eq_u32 s48, 0
    s_cbranch_scc1 L_wd2
    ds_read_b128 v[16:19], v2 offset:0
    ds_read_b64 v[20:21], v2 offset:16
    s_waitcnt lgkmcnt(0)
    v_readfirstlane_b32 s84, v16
    v_readfirstlane_b32 s85, v17
    v_readfirstlane_b32 s86, v18
    v_readfirstlane_b32 s87, v19
    v_readfirstlane_b32 s88, v20
    v_readfirstlane_b32 s89, v21
    v_and_b32 v3, 3, v1
    v_and_b32 v15, 7, v1
    v_lshrrev_b32 v12, 2, v1
    s_mov_b32 s37, 0x3dd53b95
    s_mov_b32 s38, 0xaaaaaaab
    s_mov_b32 s61, 0
    s_mul_i32 s35, s3, 49152
    s_add_u32 s35, s35, 2097152
    s_mov_b32 s40, 6144
    v_lshlrev_b32 v14, 5, v1
    v_lshrrev_b32 v8, 3, v1
    v_mul_u32_u24 v8, 24, v8
    v_mov_b32 v4, 768
    v_mad_u32_u24 v8, v15, v4, v8
    v_lshlrev_b32 v104, 4, v1
    s_mov_b32 s34, 9
L_prep:
    s_nop 1
    s_lshl_b32 s62, s61, 5
    s_add_u32 s62, s62, s3
    s_lshl_b32 s63, s62, 15
    s_add_u32 s63, s63, 1
    s_mul_hi_u32 s63, s63, 0xaaaaaaab
    s_lshr_b32 s63, s63, 7
    s_mov_b32 s32, s84
    s_mov_b32 s39, s87
    s_mov_b32 s84, s85
    s_mov_b32 s85, s86
    s_mov_b32 s87, s88
    s_mov_b32 s88, s89
    s_lshl_b32 s33, s61, 3
    s_add_u32 s33, s33, 1
    s_mov_b32 s60, 0x100000
L_wpf:
    s_nop 1
    ds_read_b32 v10, v2 offset:60
    s_sub_u32 s60, s60, 1
    s_cbranch_scc1 L_exit1
    s_waitcnt lgkmcnt(0)
    v_readfirstlane_b32 s48, v10
    s_cmp_lt_u32 s48, s33
    s_cbranch_scc1 L_wpf
    v_lshlrev_b32 v4, 4, v1
    s_mul_i32 s49, s4, 2736
    s_lshl_b32 s48, s62, 16
    s_mul_hi_u32 s48, s48, 0xaaaaaaab
    s_lshr_b32 s48, s48, 5
    s_lshl_b32 s48, s48, 4
    s_add_u32 s48, s48, s49
    buffer_load_dwordx4 v[80:83], v4, s[92:95], s48 offen offset:0
    buffer_load_dwordx4 v[84:87], v4, s[92:95], s48 offen offset:1024
    buffer_load_dwordx4 v[88:91], v4, s[92:95], s48 offen offset:2048
    buffer_load_dwordx4 v[92:95], v4, s[96:99], s48 offen offset:0
    buffer_load_dwordx4 v[96:99], v4, s[96:99], s48 offen offset:1024
    buffer_load_dwordx4 v[100:103], v4, s[96:99], s48 offen offset:2048
    s_and_b32 s48, s39, 7
    v_mov_b32 v9, s48
    s_bitcmp1_b32 s39, 3
    s_cselect_b64 vcc, -1, 0
    v_cndmask_b32 v9, v9, v15, vcc
    v_xor_b32 v13, s5, v9
    v_lshl_or_b32 v13, v3, 3, v13
    s_lshl_b32 s36, s62, 6
    s_mul_i32 s49, s62, 768
    s_lshl_b32 s50, s63, 2
    s_sub_u32 s49, s49, s50
    s_add_u32 s49, s49, 1179648
    s_add_u32 s33, s33, 4
    s_mov_b32 s60, 0x100000
L_wga:
    s_nop 1
    ds_read_b32 v10, v2 offset:60
    s_sub_u32 s60, s60, 1
    s_cbranch_scc1 L_exit1
    s_waitcnt lgkmcnt(0)
    v_readfirstlane_b32 s48, v10
    s_cmp_lt_u32 s48, s33
    s_cbranch_scc1 L_wga
    v_add_u32 v4, 0, v12
    v_bfe_u32 v5, v4, 3, 2
    v_and_or_b32 v5, v4, 4, v5
    v_xor_b32 v5, v13, v5
    v_add_u32 v4, s36, v4
    v_lshl_add_u32 v6, v4, 5, v5
    v_lshl_add_u32 v6, v6, 4, 1
    v_mul_hi_u32 v6, v6, s38
    v_lshrrev_b32 v6, 1, v6
    v_lshrrev_b32 v11, 1, v6
    v_lshlrev_b32 v11, 2, v11
    buffer_load_dwordx3 v[24:26], v11, s[92:95], 0 offen
    buffer_load_dword v27, v11, s[92:95], 0 offen offset:12
    buffer_load_dwordx3 v[28:30], v11, s[96:99], 0 offen
    buffer_load_dword v31, v11, s[96:99], 0 offen offset:12
    v_lshrrev_b32 v22, 6, v6
    v_lshl_add_u32 v22, v22, 2, s49
    v_and_b32 v7, 15, v6
    v_cmp_eq_u32 s[24:25], 5, v7
    v_and_b32 v23, 1, v6
    v_lshlrev_b32 v23, 4, v23
    s_waitcnt vmcnt(0)
    v_add_u32 v4, 16, v12
    v_bfe_u32 v5, v4, 3, 2
    v_and_or_b32 v5, v4, 4, v5
    v_xor_b32 v5, v13, v5
    v_add_u32 v4, s36, v4
    v_lshl_add_u32 v6, v4, 5, v5
    v_lshl_add_u32 v6, v6, 4, 1
    v_mul_hi_u32 v6, v6, s38
    v_lshrrev_b32 v6, 1, v6
    v_lshrrev_b32 v11, 1, v6
    v_lshlrev_b32 v11, 2, v11
    buffer_load_dwordx3 v[40:42], v11, s[92:95], 0 offen
    buffer_load_dword v43, v11, s[92:95], 0 offen offset:12
    buffer_load_dwordx3 v[44:46], v11, s[96:99], 0 offen
    buffer_load_dword v47, v11, s[96:99], 0 offen offset:12
    v_lshrrev_b32 v38, 6, v6
    v_lshl_add_u32 v38, v38, 2, s49
    v_and_b32 v7, 15, v6
    v_cmp_eq_u32 s[26:27], 5, v7
    v_and_b32 v39, 1, v6
    v_lshlrev_b32 v39, 4, v39
    s_waitcnt vmcnt(0)
    v_add_u32 v4, 32, v12
    v_bfe_u32 v5, v4, 3, 2
    v_and_or_b32 v5, v4, 4, v5
    v_xor_b32 v5, v13, v5
    v_add_u32 v4, s36, v4
    v_lshl_add_u32 v6, v4, 5, v5
    v_lshl_add_u32 v6, v6, 4, 1
    v_mul_hi_u32 v6, v6, s38
    v_lshrrev_b32 v6, 1, v6
    v_lshrrev_b32 v11, 1, v6
    v_lshlrev_b32 v11, 2, v11
    buffer_load_dwordx3 v[56:58], v11, s[92:95], 0 offen
    buffer_load_dword v59, v11, s[92:95], 0 offen offset:12
    buffer_load_dwordx3 v[60:62], v11, s[96:99], 0 offen
    buffer_load_dword v63, v11, s[96:99], 0 offen offset:12
    v_lshrrev_b32 v54, 6, v6
    v_lshl_add_u32 v54, v54, 2, s49
    v_and_b32 v7, 15, v6
    v_cmp_eq_u32 s[28:29], 5, v7
    v_and_b32 v55, 1, v6
    v_lshlrev_b32 v55, 4, v55
    s_waitcnt vmcnt(0)
    v_add_u32 v4, 48, v12
    v_bfe_u32 v5, v4, 3, 2
    v_and_or_b32 v5, v4, 4, v5
    v_xor_b32 v5, v13, v5
    v_add_u32 v4, s36, v4
    v_lshl_add_u32 v6, v4, 5, v5
    v_lshl_add_u32 v6, v6, 4, 1
    v_mul_hi_u32 v6, v6, s38
    v_lshrrev_b32 v6, 1, v6
    v_lshrrev_b32 v11, 1, v6
    v_lshlrev_b32 v11, 2, v11
    buffer_load_dwordx3 v[72:74], v11, s[92:95], 0 offen
    buffer_load_dword v75, v11, s[92:95], 0 offen offset:12
    buffer_load_dwordx3 v[76:78], v11, s[96:99], 0 offen
    buffer_load_dword v79, v11, s[96:99], 0 offen offset:12
    v_lshrrev_b32 v70, 6, v6
    v_lshl_add_u32 v70, v70, 2, s49
    v_and_b32 v7, 15, v6
    v_cmp_eq_u32 s[30:31], 5, v7
    v_and_b32 v71, 1, v6
    v_lshlrev_b32 v71, 4, v71
    s_waitcnt vmcnt(0)
    s_add_u32 s33, s61, 1
    s_mov_b32 s60, 0x100000
L_wfd:
    s_nop 1
    ds_read_b32 v10, v2 offset:52
    s_sub_u32 s60, s60, 1
    s_cbranch_scc1 L_exit1
    s_waitcnt lgkmcnt(0)
    v_readfirstlane_b32 s48, v10
    s_cmp_lt_u32 s48, s33
    s_cbranch_scc1 L_wfd
    v_mul_u32_u24 v4, 4352, v1
    s_xor_b32 s48, s32, s39
    s_xor_b32 s48, s48, s5
    s_and_b32 s48, s48, 7
    v_mov_b32 v6, s33
    s_lshl_b64 vcc, 1, s48
    s_or_b32 s48, s32, s39
    s_bitcmp1_b32 s48, 3
    s_cselect_b64 vcc, 0xff, vcc
    s_cmp_eq_u32 s32, s39
    s_cselect_b64 vcc, 0, vcc
    s_max_u32 s48, s61, 1
    v_mov_b32 v7, s48
    v_cndmask_b32 v6, v7, v6, vcc
    s_cmp_eq_u32 s61, 1
    s_cselect_b64 exec, vcc, 0xff
    s_mov_b32 s60, 0x40000
    s_cbranch_execz L_noflags
L_flags:
    s_nop 1
    buffer_load_dword v5, v4, s[12:15], s59 offen sc1
    s_sub_u32 s60, s60, 1
    s_cbranch_scc1 L_exit1
    s_waitcnt vmcnt(0)
    v_cmpx_gt_u32 vcc, v6, v5
    s_cbranch_execnz L_flags
L_noflags:
    s_nop 1
    s_mov_b64 exec, -1
    buffer_load_dword v22, v22, s[12:15], 0 offen sc1
    buffer_load_dword v38, v38, s[12:15], 0 offen sc1
    buffer_load_dword v54, v54, s[12:15], 0 offen sc1
    buffer_load_dword v70, v70, s[12:15], 0 offen sc1
    s_bitcmp1_b32 s39, 3
    s_cselect_b32 s49, 0, 7
    s_xor_b32 s50, s32, s39
    s_bitcmp1_b32 s50, 3
    s_cselect_b32 s51, 7, 0
    s_and_b32 s50, s50, 7
    s_and_b32 s52, s39, 7
    s_add_u32 s53, s35, 4096
    v_add_u32 v4, 0, v1
    v_mul_u32_u24 v5, 1366, v4
    v_lshrrev_b32 v5, 16, v5
    v_mul_u32_u24 v6, 48, v5
    v_sub_u32 v4, v4, v6
    v_cmp_gt_u32 vcc, s34, v4
    v_and_b32 v6, s51, v5
    v_xor_b32 v6, s50, v6
    v_and_b32 v5, s49, v5
    v_xor_b32 v5, s52, v5
    v_cndmask_b32 v6, v6, v5, vcc
    v_cmp_ne_u32 s[64:65], 0, v6
    v_xor_b32 v6, s5, v6
    v_mad_u32_u24 v6, v6, s40, v104
    s_mov_b64 exec, s[64:65]
    buffer_load_dwordx4 v[80:83], v6, s[12:15], s35 offen offset:0 sc1
    s_mov_b64 exec, -1
    v_add_u32 v4, 64, v1
    v_mul_u32_u24 v5, 1366, v4
    v_lshrrev_b32 v5, 16, v5
    v_mul_u32_u24 v6, 48, v5
    v_sub_u32 v4, v4, v6
    v_cmp_gt_u32 vcc, s34, v4
    v_and_b32 v6, s51, v5
    v_xor_b32 v6, s50, v6
    v_and_b32 v5, s49, v5
    v_xor_b32 v5, s52, v5
    v_cndmask_b32 v6, v6, v5, vcc
    v_cmp_ne_u32 s[66:67], 0, v6
    v_xor_b32 v6, s5, v6
    v_mad_u32_u24 v6, v6, s40, v104
    s_mov_b64 exec, s[66:67]
    buffer_load_dwordx4 v[84:87], v6, s[12:15], s35 offen offset:1024 sc1
    s_mov_b64 exec, -1
    v_add_u32 v4, 128, v1
    v_mul_u32_u24 v5, 1366, v4
    v_lshrrev_b32 v5, 16, v5
    v_mul_u32_u24 v6, 48, v5
    v_sub_u32 v4, v4, v6
    v_cmp_gt_u32 vcc, s34, v4
    v_and_b32 v6, s51, v5
    v_xor_b32 v6, s50, v6
    v_and_b32 v5, s49, v5
    v_xor_b32 v5, s52, v5
    v_cndmask_b32 v6, v6, v5, vcc
    v_cmp_ne_u32 s[68:69], 0, v6
    v_xor_b32 v6, s5, v6
    v_mad_u32_u24 v6, v6, s40, v104
    s_mov_b64 exec, s[68:69]
    buffer_load_dwordx4 v[88:91], v6, s[12:15], s35 offen offset:2048 sc1
    s_mov_b64 exec, -1
    v_add_u32 v4, 192, v1
    v_mul_u32_u24 v5, 1366, v4
    v_lshrrev_b32 v5, 16, v5
    v_mul_u32_u24 v6, 48, v5
    v_sub_u32 v4, v4, v6
    v_cmp_gt_u32 vcc, s34, v4
    v_and_b32 v6, s51, v5
    v_xor_b32 v6, s50, v6
    v_and_b32 v5, s49, v5
    v_xor_b32 v5, s52, v5
    v_cndmask_b32 v6, v6, v5, vcc
    v_cmp_ne_u32 s[70:71], 0, v6
    v_xor_b32 v6, s5, v6
    v_mad_u32_u24 v6, v6, s40, v104
    s_mov_b64 exec, s[70:71]
    buffer_load_dwordx4 v[92:95], v6, s[12:15], s35 offen offset:3072 sc1
    s_mov_b64 exec, -1
    v_add_u32 v4, 256, v1
    v_mul_u32_u24 v5, 1366, v4
    v_lshrrev_b32 v5, 16, v5
    v_mul_u32_u24 v6, 48, v5
    v_sub_u32 v4, v4, v6
    v_cmp_gt_u32 vcc, s34, v4
    v_and_b32 v6, s51, v5
    v_xor_b32 v6, s50, v6
    v_and_b32 v5, s49, v5
    v_xor_b32 v5, s52, v5
    v_cndmask_b32 v6, v6, v5, vcc
    v_cmp_ne_u32 s[72:73], 0, v6
    v_xor_b32 v6, s5, v6
    v_mad_u32_u24 v6, v6, s40, v104
    s_mov_b64 exec, s[72:73]
    buffer_load_dwordx4 v[96:99], v6, s[12:15], s53 offen offset:0 sc1
    s_mov_b64 exec, -1
    v_add_u32 v4, 320, v1
    v_mul_u32_u24 v5, 1366, v4
    v_lshrrev_b32 v5, 16, v5
    v_mul_u32_u24 v6, 48, v5
    v_sub_u32 v4, v4, v6
    v_cmp_gt_u32 vcc, s34, v4
    v_and_b32 v6, s51, v5
    v_xor_b32 v6, s50, v6
    v_and_b32 v5, s49, v5
    v_xor_b32 v5, s52, v5
    v_cndmask_b32 v6, v6, v5, vcc
    v_cmp_ne_u32 s[74:75], 0, v6
    v_xor_b32 v6, s5, v6
    v_mad_u32_u24 v6, v6, s40, v104
    s_mov_b64 exec, s[74:75]
    buffer_load_dwordx4 v[100:103], v6, s[12:15], s53 offen offset:1024 sc1
    s_mov_b64 exec, -1
    s_waitcnt vmcnt(0)
    s_mov_b64 exec, s[64:65]
    ds_write_b128 v104, v[80:83] offset:256
    s_mov_b64 exec, s[66:67]
    ds_write_b128 v104, v[84:87] offset:1280
    s_mov_b64 exec, s[68:69]
    ds_write_b128 v104, v[88:91] offset:2304
    s_mov_b64 exec, s[70:71]
    ds_write_b128 v104, v[92:95] offset:3328
    s_mov_b64 exec, s[72:73]
    ds_write_b128 v104, v[96:99] offset:4352
    s_mov_b64 exec, s[74:75]
    ds_write_b128 v104, v[100:103] offset:5376
    s_mov_b64 exec, -1
    ds_read_b64 v[16:17], v8 offset:256
    ds_read_b64 v[18:19], v8 offset:264
    ds_read_b64 v[20:21], v8 offset:272
    ds_read_b64 v[32:33], v8 offset:448
    ds_read_b64 v[34:35], v8 offset:456
    ds_read_b64 v[36:37], v8 offset:464
    ds_read_b64 v[48:49], v8 offset:640
    ds_read_b64 v[50:51], v8 offset:648
    ds_read_b64 v[52:53], v8 offset:656
    ds_read_b64 v[64:65], v8 offset:832
    ds_read_b64 v[66:67], v8 offset:840
    ds_read_b64 v[68:69], v8 offset:848
    s_mov_b32 s34, 0
    v_mov_b32 v5, 0xf149f2ca
    v_mov_b32 v4, 0xf149f2ca
    s_waitcnt vmcnt(0) lgkmcnt(0)
    v_sub_f32 v16, v16, v22
    v_sub_f32 v17, v17, v22
    v_sub_f32 v18, v18, v22
    v_sub_f32 v19, v19, v22
    v_sub_f32 v20, v20, v22
    v_sub_f32 v21, v21, v22
    v_mul_f32 v16, s37, v16
    v_mul_f32 v17, s37, v17
    v_mul_f32 v18, s37, v18
    v_mul_f32 v19, s37, v19
    v_mul_f32 v20, s37, v20
    v_mul_f32 v21, s37, v21
    v_cndmask_b32 v21, v5, v21, s[24:25]
    v_max3_f32 v4, v4, v16, v17
    v_max3_f32 v4, v4, v18, v19
    v_max3_f32 v4, v4, v20, v21
    v_alignbit_b32 v24, v25, v24, v23
    v_alignbit_b32 v25, v26, v25, v23
    v_alignbit_b32 v26, v27, v26, v23
    v_alignbit_b32 v28, v29, v28, v23
    v_alignbit_b32 v29, v30, v29, v23
    v_alignbit_b32 v30, v31, v30, v23
    v_sub_f32 v32, v32, v38
    v_sub_f32 v33, v33, v38
    v_sub_f32 v34, v34, v38
    v_sub_f32 v35, v35, v38
    v_sub_f32 v36, v36, v38
    v_sub_f32 v37, v37, v38
    v_mul_f32 v32, s37, v32
    v_mul_f32 v33, s37, v33
    v_mul_f32 v34, s37, v34
    v_mul_f32 v35, s37, v35
    v_mul_f32 v36, s37, v36
    v_mul_f32 v37, s37, v37
    v_cndmask_b32 v37, v5, v37, s[26:27]
    v_max3_f32 v4, v4, v32, v33
    v_max3_f32 v4, v4, v34, v35
    v_max3_f32 v4, v4, v36, v37
    v_alignbit_b32 v40, v41, v40, v39
    v_alignbit_b32 v41, v42, v41, v39
    v_alignbit_b32 v42, v43, v42, v39
    v_alignbit_b32 v44, v45, v44, v39
    v_alignbit_b32 v45, v46, v45, v39
    v_alignbit_b32 v46, v47, v46, v39
    v_sub_f32 v48, v48, v54
    v_sub_f32 v49, v49, v54
    v_sub_f32 v50, v50, v54
    v_sub_f32 v51, v51, v54
    v_sub_f32 v52, v52, v54
    v_sub_f32 v53, v53, v54
    v_mul_f32 v48, s37, v48
    v_mul_f32 v49, s37, v49
    v_mul_f32 v50, s37, v50
    v_mul_f32 v51, s37, v51
    v_mul_f32 v52, s37, v52
    v_mul_f32 v53, s37, v53
    v_cndmask_b32 v53, v5, v53, s[28:29]
    v_max3_f32 v4, v4, v48, v49
    v_max3_f32 v4, v4, v50, v51
    v_max3_f32 v4, v4, v52, v53
    v_alignbit_b32 v56, v57, v56, v55
    v_alignbit_b32 v57, v58, v57, v55
    v_alignbit_b32 v58, v59, v58, v55
    v_alignbit_b32 v60, v61, v60, v55
    v_alignbit_b32 v61, v62, v61, v55
    v_alignbit_b32 v62, v63, v62, v55
    v_sub_f32 v64, v64, v70
    v_sub_f32 v65, v65, v70
    v_sub_f32 v66, v66, v70
    v_sub_f32 v67, v67, v70
    v_sub_f32 v68, v68, v70
    v_sub_f32 v69, v69, v70
    v_mul_f32 v64, s37, v64
    v_mul_f32 v65, s37, v65
    v_mul_f32 v66, s37, v66
    v_mul_f32 v67, s37, v67
    v_mul_f32 v68, s37, v68
    v_mul_f32 v69, s37, v69
    v_cndmask_b32 v69, v5, v69, s[30:31]
    v_max3_f32 v4, v4, v64, v65
    v_max3_f32 v4, v4, v66, v67
    v_max3_f32 v4, v4, v68, v69
    v_alignbit_b32 v72, v73, v72, v71
    v_alignbit_b32 v73, v74, v73, v71
    v_alignbit_b32 v74, v75, v74, v71
    v_alignbit_b32 v76, v77, v76, v71
    v_alignbit_b32 v77, v78, v77, v71
    v_alignbit_b32 v78, v79, v78, v71
    v_max_f32_dpp v4, v4, v4 row_ror:8 row_mask:0xf bank_mask:0xf
    s_nop 1
    v_max_f32_dpp v4, v4, v4 row_ror:4 row_mask:0xf bank_mask:0xf
    s_nop 1
    v_max_f32_dpp v4, v4, v4 row_ror:2 row_mask:0xf bank_mask:0xf
    s_nop 1
    v_max_f32_dpp v4, v4, v4 row_ror:1 row_mask:0xf bank_mask:0xf
    v_mov_b32 v5, v4
    s_nop 1
    v_permlane32_swap_b32 v4, v5
    v_max_f32 v4, v4, v5
    v_mov_b32 v5, v4
    s_nop 1
    v_permlane16_swap_b32 v4, v5
    v_max_f32 v4, v4, v5
    v_mov_b32 v5, 0
    v_mov_b32 v6, 0
    v_sub_f32 v16, v16, v4
    v_sub_f32 v17, v17, v4
    v_sub_f32 v18, v18, v4
    v_sub_f32 v19, v19, v4
    v_sub_f32 v20, v20, v4
    v_sub_f32 v21, v21, v4
    v_exp_f32 v16, v16
    v_exp_f32 v17, v17
    v_exp_f32 v18, v18
    v_exp_f32 v19, v19
    v_exp_f32 v20, v20
    v_exp_f32 v21, v21
    v_add_f32 v5, v5, v16
    v_lshlrev_b32 v10, 16, v24
    v_lshlrev_b32 v11, 16, v28
    v_mul_f32 v16, v16, v10
    v_fmac_f32 v6, v16, v11
    v_add_f32 v5, v5, v17
    v_and_b32 v10, 0xffff0000, v24
    v_and_b32 v11, 0xffff0000, v28
    v_mul_f32 v17, v17, v10
    v_fmac_f32 v6, v17, v11
    v_add_f32 v5, v5, v18
    v_lshlrev_b32 v10, 16, v25
    v_lshlrev_b32 v11, 16, v29
    v_mul_f32 v18, v18, v10
    v_fmac_f32 v6, v18, v11
    v_add_f32 v5, v5, v19
    v_and_b32 v10, 0xffff0000, v25
    v_and_b32 v11, 0xffff0000, v29
    v_mul_f32 v19, v19, v10
    v_fmac_f32 v6, v19, v11
    v_add_f32 v5, v5, v20
    v_lshlrev_b32 v10, 16, v26
    v_lshlrev_b32 v11, 16, v30
    v_mul_f32 v20, v20, v10
    v_fmac_f32 v6, v20, v11
    v_add_f32 v5, v5, v21
    v_and_b32 v10, 0xffff0000, v26
    v_and_b32 v11, 0xffff0000, v30
    v_mul_f32 v21, v21, v10
    v_fmac_f32 v6, v21, v11
    ds_write_b128 v14, v[16:19] offset:18688
    ds_write_b64 v14, v[20:21] offset:18704
    v_sub_f32 v32, v32, v4
    v_sub_f32 v33, v33, v4
    v_sub_f32 v34, v34, v4
    v_sub_f32 v35, v35, v4
    v_sub_f32 v36, v36, v4
    v_sub_f32 v37, v37, v4
    v_exp_f32 v32, v32
    v_exp_f32 v33, v33
    v_exp_f32 v34, v34
    v_exp_f32 v35, v35
    v_exp_f32 v36, v36
    v_exp_f32 v37, v37
    v_add_f32 v5, v5, v32
    v_lshlrev_b32 v10, 16, v40
    v_lshlrev_b32 v11, 16, v44
    v_mul_f32 v32, v32, v10
    v_fmac_f32 v6, v32, v11
    v_add_f32 v5, v5, v33
    v_and_b32 v10, 0xffff0000, v40
    v_and_b32 v11, 0xffff0000, v44
    v_mul_f32 v33, v33, v10
    v_fmac_f32 v6, v33, v11
    v_add_f32 v5, v5, v34
    v_lshlrev_b32 v10, 16, v41
    v_lshlrev_b32 v11, 16, v45
    v_mul_f32 v34, v34, v10
    v_fmac_f32 v6, v34, v11
    v_add_f32 v5, v5, v35
    v_and_b32 v10, 0xffff0000, v41
    v_and_b32 v11, 0xffff0000, v45
    v_mul_f32 v35, v35, v10
    v_fmac_f32 v6, v35, v11
    v_add_f32 v5, v5, v36
    v_lshlrev_b32 v10, 16, v42
    v_lshlrev_b32 v11, 16, v46
    v_mul_f32 v36, v36, v10
    v_fmac_f32 v6, v36, v11
    v_add_f32 v5, v5, v37
    v_and_b32 v10, 0xffff0000, v42
    v_and_b32 v11, 0xffff0000, v46
    v_mul_f32 v37, v37, v10
    v_fmac_f32 v6, v37, v11
    ds_write_b128 v14, v[32:35] offset:20736
    ds_write_b64 v14, v[36:37] offset:20752
    v_sub_f32 v48, v48, v4
    v_sub_f32 v49, v49, v4
    v_sub_f32 v50, v50, v4
    v_sub_f32 v51, v51, v4
    v_sub_f32 v52, v52, v4
    v_sub_f32 v53, v53, v4
    v_exp_f32 v48, v48
    v_exp_f32 v49, v49
    v_exp_f32 v50, v50
    v_exp_f32 v51, v51
    v_exp_f32 v52, v52
    v_exp_f32 v53, v53
    v_add_f32 v5, v5, v48
    v_lshlrev_b32 v10, 16, v56
    v_lshlrev_b32 v11, 16, v60
    v_mul_f32 v48, v48, v10
    v_fmac_f32 v6, v48, v11
    v_add_f32 v5, v5, v49
    v_and_b32 v10, 0xffff0000, v56
    v_and_b32 v11, 0xffff0000, v60
    v_mul_f32 v49, v49, v10
    v_fmac_f32 v6, v49, v11
    v_add_f32 v5, v5, v50
    v_lshlrev_b32 v10, 16, v57
    v_lshlrev_b32 v11, 16, v61
    v_mul_f32 v50, v50, v10
    v_fmac_f32 v6, v50, v11
    v_add_f32 v5, v5, v51
    v_and_b32 v10, 0xffff0000, v57
    v_and_b32 v11, 0xffff0000, v61
    v_mul_f32 v51, v51, v10
    v_fmac_f32 v6, v51, v11
    v_add_f32 v5, v5, v52
    v_lshlrev_b32 v10, 16, v58
    v_lshlrev_b32 v11, 16, v62
    v_mul_f32 v52, v52, v10
    v_fmac_f32 v6, v52, v11
    v_add_f32 v5, v5, v53
    v_and_b32 v10, 0xffff0000, v58
    v_and_b32 v11, 0xffff0000, v62
    v_mul_f32 v53, v53, v10
    v_fmac_f32 v6, v53, v11
    ds_write_b128 v14, v[48:51] offset:22784
    ds_write_b64 v14, v[52:53] offset:22800
    v_sub_f32 v64, v64, v4
    v_sub_f32 v65, v65, v4
    v_sub_f32 v66, v66, v4
    v_sub_f32 v67, v67, v4
    v_sub_f32 v68, v68, v4
    v_sub_f32 v69, v69, v4
    v_exp_f32 v64, v64
    v_exp_f32 v65, v65
    v_exp_f32 v66, v66
    v_exp_f32 v67, v67
    v_exp_f32 v68, v68
    v_exp_f32 v69, v69
    v_add_f32 v5, v5, v64
    v_lshlrev_b32 v10, 16, v72
    v_lshlrev_b32 v11, 16, v76
    v_mul_f32 v64, v64, v10
    v_fmac_f32 v6, v64, v11
    v_add_f32 v5, v5, v65
    v_and_b32 v10, 0xffff0000, v72
    v_and_b32 v11, 0xffff0000, v76
    v_mul_f32 v65, v65, v10
    v_fmac_f32 v6, v65, v11
    v_add_f32 v5, v5, v66
    v_lshlrev_b32 v10, 16, v73
    v_lshlrev_b32 v11, 16, v77
    v_mul_f32 v66, v66, v10
    v_fmac_f32 v6, v66, v11
    v_add_f32 v5, v5, v67
    v_and_b32 v10, 0xffff0000, v73
    v_and_b32 v11, 0xffff0000, v77
    v_mul_f32 v67, v67, v10
    v_fmac_f32 v6, v67, v11
    v_add_f32 v5, v5, v68
    v_lshlrev_b32 v10, 16, v74
    v_lshlrev_b32 v11, 16, v78
    v_mul_f32 v68, v68, v10
    v_fmac_f32 v6, v68, v11
    v_add_f32 v5, v5, v69
    v_and_b32 v10, 0xffff0000, v74
    v_and_b32 v11, 0xffff0000, v78
    v_mul_f32 v69, v69, v10
    v_fmac_f32 v6, v69, v11
    ds_write_b128 v14, v[64:67] offset:24832
    ds_write_b64 v14, v[68:69] offset:24848
    v_add_f32_dpp v5, v5, v5 row_ror:8 row_mask:0xf bank_mask:0xf
    v_add_f32_dpp v6, v6, v6 row_ror:8 row_mask:0xf bank_mask:0xf
    s_nop 0
    v_add_f32_dpp v5, v5, v5 row_ror:4 row_mask:0xf bank_mask:0xf
    v_add_f32_dpp v6, v6, v6 row_ror:4 row_mask:0xf bank_mask:0xf
    s_nop 0
    v_add_f32_dpp v5, v5, v5 row_ror:2 row_mask:0xf bank_mask:0xf
    v_add_f32_dpp v6, v6, v6 row_ror:2 row_mask:0xf bank_mask:0xf
    s_nop 0
    v_add_f32_dpp v5, v5, v5 row_ror:1 row_mask:0xf bank_mask:0xf
    v_add_f32_dpp v6, v6, v6 row_ror:1 row_mask:0xf bank_mask:0xf
    v_mov_b32 v10, v5
    v_mov_b32 v11, v6
    s_nop 0
    v_permlane32_swap_b32 v5, v10
    v_permlane32_swap_b32 v6, v11
    v_add_f32 v5, v5, v10
    v_add_f32 v6, v6, v11
    v_mov_b32 v10, v5
    v_mov_b32 v11, v6
    s_nop 0
    v_permlane16_swap_b32 v5, v10
    v_permlane16_swap_b32 v6, v11
    v_add_f32 v5, v5, v10
    v_add_f32 v6, v6, v11
    s_lshl_b32 s48, s61, 2
    v_mov_b32 v10, s48
    v_lshlrev_b32 v11, 2, v10
    v_mov_b32 v7, s39
    s_mov_b64 exec, 1
    ds_write_b128 v11, v[4:7] offset:80
    ds_write_b32 v10, v7 offset:24
    s_lshl_b32 s48, s61, 8
    s_add_u32 s48, s48, s2
    s_lshl_b32 s48, s48, 6
    s_add_u32 s48, s48, 917504
    buffer_store_dwordx4 v[4:7], off, s[12:15], s48 sc1
    s_mov_b64 exec, -1
    v_add_u32 v14, 8192, v14
    v_add_u32 v8, 6144, v8
    v_add_u32 v104, 6144, v104
    s_add_u32 s35, s35, 1566720
    s_add_u32 s61, s61, 1
    s_cmp_lt_u32 s61, 3
    s_cbranch_scc1 L_prep
    s_mov_b32 s61, 0
    v_lshlrev_b32 v12, 2, v1
    v_add_u32 v13, 43264, v12
    v_lshlrev_b32 v8, 4, v1
    v_mov_b32 v31, 1
L_merge:
    s_nop 1
    s_lshl_b32 s48, s61, 2
    v_mov_b32 v3, s48
    v_lshlrev_b32 v11, 2, v3
    ds_read_b128 v[4:7], v11 offset:80
    s_lshl_b32 s62, s61, 8
    s_add_u32 s62, s62, s2
    s_lshl_b32 s62, s62, 10
    s_mov_b32 s60, 0x100000
L_wm:
    s_nop 1
    ds_read_b32 v10, v3 offset:64
    s_sub_u32 s60, s60, 1
    s_cbranch_scc1 L_exit1
    s_waitcnt lgkmcnt(0)
    v_readfirstlane_b32 s48, v10
    s_cmp_lt_u32 s48, 4
    s_cbranch_scc1 L_wm
    ds_read_b32 v16, v13 offset:0
    ds_read_b32 v17, v13 offset:768
    ds_read_b32 v18, v13 offset:1536
    ds_read_b32 v19, v13 offset:2304
    ds_read_b32 v20, v13 offset:256
    ds_read_b32 v21, v13 offset:1024
    ds_read_b32 v22, v13 offset:1792
    ds_read_b32 v23, v13 offset:2560
    ds_read_b32 v24, v13 offset:512
    ds_read_b32 v25, v13 offset:1280
    ds_read_b32 v26, v13 offset:2048
    ds_read_b32 v27, v13 offset:2816
    s_waitcnt lgkmcnt(8)
    v_add_f32 v16, v16, v17
    v_add_f32 v18, v18, v19
    v_sub_f32 v16, v16, v6
    v_add_f32 v28, v16, v18
    s_waitcnt lgkmcnt(4)
    v_add_f32 v20, v20, v21
    v_add_f32 v22, v22, v23
    v_sub_f32 v20, v20, v6
    v_add_f32 v29, v20, v22
    s_waitcnt lgkmcnt(0)
    v_add_f32 v24, v24, v25
    v_add_f32 v26, v26, v27
    v_sub_f32 v24, v24, v6
    v_add_f32 v30, v24, v26
    buffer_store_dwordx4 v[28:31], v8, s[12:15], s62 offen sc1
    v_add_u32 v13, 3072, v13
    s_add_u32 s61, s61, 1
    s_cmp_lt_u32 s61, 3
    s_cbranch_scc1 L_merge
    s_endpgm
.section .rodata,"a"
.p2align 6
.amdhsa_kernel standalone__kv_cache_quant_int4_int2_kv_with_per_channel_or_per_token_scales__decode_kernel
  .amdhsa_next_free_vgpr 136
  .amdhsa_next_free_sgpr 102
  .amdhsa_accum_offset 136
  .amdhsa_group_segment_fixed_size 0
  .amdhsa_kernarg_size 80
  .amdhsa_user_sgpr_count 2
  .amdhsa_user_sgpr_kernarg_segment_ptr 1
  .amdhsa_system_sgpr_workgroup_id_x 1
.end_amdhsa_kernel
```

```asm
; @launch kernel=standalone__kv_cache_quant_int4_int2_kv_with_per_channel_or_per_token_scales__decode_kernel grid=(256,1,1) block=(512,1,1) lds=52480
.amdgcn_target "amdgcn-amd-amdhsa--gfx950"
.text
.globl standalone__kv_cache_quant_int4_int2_kv_with_per_channel_or_per_token_scales__decode_kernel
.p2align 8
.type standalone__kv_cache_quant_int4_int2_kv_with_per_channel_or_per_token_scales__decode_kernel,@function
standalone__kv_cache_quant_int4_int2_kv_with_per_channel_or_per_token_scales__decode_kernel:
    s_cmp_ge_u32 s2, 256
    s_cbranch_scc1 L_exit1
    s_load_dwordx16 s[64:79], s[0:1], 0
    s_load_dwordx4 s[80:83], s[0:1], 64
    v_lshrrev_b32 v10, 6, v0
    v_and_b32 v11, 63, v0
    v_readfirstlane_b32 s28, v10
    s_lshr_b32 s3, s2, 3
    s_and_b32 s4, s2, 7
    s_lshr_b32 s32, s2, 6
    s_xor_b32 s32, s32, s4
    s_lshr_b32 s48, s32, 1
    s_and_b32 s32, s32, 1
    s_lshl_b32 s32, s32, 2
    s_or_b32 s48, s48, s32
    s_cmp_ge_u32 s28, 4
    s_cbranch_scc1 L_helper
    v_lshrrev_b32 v1, 4, v11
    v_and_b32 v52, 15, v11
    v_lshlrev_b32 v2, 4, v52
    v_lshlrev_b32 v3, 3, v52
    v_lshlrev_b32 v62, 7, v1
    v_and_b32 v63, 0x70, v0
    v_or_b32 v63, v63, v62
    v_mov_b32 v50, v63
    s_mov_b32 s45, 768
    s_mov_b32 s46, 384
    s_mov_b32 s47, 0xaaaaaaab
    v_mov_b32 v51, 0xc0000000
    s_lshl_b32 s44, s3, 6
    s_mov_b32 s5, s48
    s_mov_b32 s29, s28
    s_lshr_b32 s33, s29, 6
    s_lshl_b32 s33, s33, 11
    s_and_b32 s32, s29, 63
    s_add_u32 s32, s32, s33
    s_add_u32 s32, s32, s44
    s_bfe_u32 s33, s32, 0x20003
    s_and_b32 s34, s32, 4
    s_or_b32 s33, s33, s34
    s_xor_b32 s33, s33, s5
    s_lshl_b32 s50, s32, 5
    s_or_b32 s50, s50, s33
    s_lshl_b32 s50, s50, 4
    s_or_b32 s50, s50, 1
    v_xor_b32 v10, s50, v50
    v_mul_hi_u32 v10, v10, s47
    v_lshrrev_b32 v10, 1, v10
    v_and_b32 v11, 15, v10
    v_cmp_eq_u32 vcc, 5, v11
    v_mad_u32_u24 v48, v10, s45, v2
    v_add_u32 v11, 3840, v48
    v_cndmask_b32 v49, v51, v11, vcc
    v_lshrrev_b32 v10, 6, v10
    v_mad_u32_u24 v9, v10, s46, v3
    s_waitcnt lgkmcnt(0)
    s_mov_b32 s30, 0
    s_mov_b32 s8, s66
    s_and_b32 s9, s67, 0xffff
    s_mov_b32 s10, 805306368
    s_mov_b32 s11, 0x00020000
    buffer_load_dwordx4 v[64:67], v48, s[8:11], 0 offen offset:0 nt
    buffer_load_dwordx4 v[68:71], v48, s[8:11], 0 offen offset:256 nt
    buffer_load_dwordx4 v[72:75], v48, s[8:11], 0 offen offset:512 nt
    buffer_load_dwordx4 v[76:79], v48, s[8:11], 0 offen offset:768 nt
    buffer_load_dwordx4 v[80:83], v48, s[8:11], 0 offen offset:1024 nt
    buffer_load_dwordx4 v[84:87], v48, s[8:11], 0 offen offset:1280 nt
    s_mov_b32 s20, s64
    s_and_b32 s21, s65, 0xffff
    s_mov_b32 s22, 12288
    s_mov_b32 s23, 0x00020000
    s_lshl_b32 s31, s30, 5
    s_add_u32 s31, s31, s3
    s_mul_i32 s31, s31, 171
    s_lshr_b32 s31, s31, 9
    s_mul_i32 s31, s31, 384
    buffer_load_dwordx2 v[36:37], v3, s[20:23], s31 offen offset:0
    buffer_load_dwordx2 v[38:39], v3, s[20:23], s31 offen offset:128
    buffer_load_dwordx2 v[40:41], v3, s[20:23], s31 offen offset:256
    s_mov_b32 s16, s70
    s_and_b32 s17, s71, 0xffff
    s_mov_b32 s18, 6291456
    s_mov_b32 s19, 0x00020000
    buffer_load_dwordx2 v[42:43], v9, s[16:19], 0 offen offset:0
    buffer_load_dwordx2 v[44:45], v9, s[16:19], 0 offen offset:128
    buffer_load_dwordx2 v[46:47], v9, s[16:19], 0 offen offset:256
    buffer_load_dwordx4 v[88:91], v48, s[8:11], 0 offen offset:1536 nt
    buffer_load_dwordx4 v[92:95], v48, s[8:11], 0 offen offset:1792 nt
    buffer_load_dwordx4 v[96:99], v48, s[8:11], 0 offen offset:2048 nt
    buffer_load_dwordx4 v[100:103], v48, s[8:11], 0 offen offset:2304 nt
    buffer_load_dwordx4 v[104:107], v48, s[8:11], 0 offen offset:2560 nt
    buffer_load_dwordx4 v[108:111], v48, s[8:11], 0 offen offset:2816 nt
    buffer_load_dwordx4 v[112:115], v48, s[8:11], 0 offen offset:3072 nt
    buffer_load_dwordx4 v[116:119], v48, s[8:11], 0 offen offset:3328 nt
    buffer_load_dwordx4 v[120:123], v48, s[8:11], 0 offen offset:3584 nt
    buffer_load_dwordx4 v[124:127], v49, s[8:11], 0 offen offset:0 nt
    buffer_load_dwordx4 v[128:131], v49, s[8:11], 0 offen offset:256 nt
    buffer_load_dwordx4 v[132:135], v49, s[8:11], 0 offen offset:512 nt
    s_mov_b32 s12, s68
    s_and_b32 s13, s69, 0xffff
    s_mov_b32 s14, 805306368
    s_mov_b32 s15, 0x00020000
    v_lshlrev_b32 v11, 5, v1
    v_bfe_u32 v4, v0, 4, 3
    v_mul_u32_u24 v4, s45, v4
    v_lshl_add_u32 v4, v52, 1, v4
    s_lshr_b32 s32, s28, 1
    s_mul_i32 s32, s32, 24
    s_add_u32 s32, s32, 256
    v_add_u32 v4, s32, v4
    v_and_b32 v5, 7, v52
    v_lshl_add_u32 v5, v5, 2, v11
    v_add_u32 v5, 18688, v5
    v_lshlrev_b32 v8, 2, v1
    v_add_u32 v8, v2, v8
    s_mul_i32 s32, s28, 768
    s_add_u32 s32, s32, 43264
    v_add_u32 v8, s32, v8
    v_mov_b32 v53, 0
    v_mov_b32 v60, 0
    v_mov_b32 v61, 0
    s_mov_b32 s42, 0x01110111
    s_mov_b32 s43, 0x01110111
    s_mov_b32 s40, 0xea2bea0c
    s_mov_b32 s41, 0xea2b
    s_mov_b32 s64, 0x2020200
    s_mov_b32 s65, 0x202
    s_mov_b32 s66, 0x8080800
    s_mov_b32 s67, 0x808
    s_mov_b32 s68, 0x20202000
    s_mov_b32 s69, 0x2020
    s_mov_b32 s70, 0xc003c00c
    s_mov_b32 s71, 0xc003
    s_mov_b32 s59, 0
    s_mov_b32 s63, 0
    s_mov_b32 s7, 0
    s_mov_b32 s62, 144
    v_mov_b32 v12, 0
    v_mov_b32 v13, 0
    v_mov_b32 v14, 0
    v_mov_b32 v15, 0
    v_mov_b32 v16, 0
    v_mov_b32 v17, 0
    v_mov_b32 v18, 0
    v_mov_b32 v19, 0
    v_mov_b32 v20, 0
    v_mov_b32 v21, 0
    v_mov_b32 v22, 0
    v_mov_b32 v23, 0
    s_barrier
    s_waitcnt vmcnt(12)
    v_lshlrev_b32 v10, 16, v36
    v_lshlrev_b32 v24, 16, v42
    v_and_b32 v11, 0xffff0000, v36
    v_and_b32 v25, 0xffff0000, v42
    v_mul_f32 v24, v24, v10
    v_mul_f32 v25, v25, v11
    v_lshlrev_b32 v10, 16, v37
    v_lshlrev_b32 v26, 16, v43
    v_and_b32 v11, 0xffff0000, v37
    v_and_b32 v27, 0xffff0000, v43
    v_mul_f32 v26, v26, v10
    v_mul_f32 v27, v27, v11
    v_lshlrev_b32 v10, 16, v38
    v_lshlrev_b32 v28, 16, v44
    v_and_b32 v11, 0xffff0000, v38
    v_and_b32 v29, 0xffff0000, v44
    v_mul_f32 v28, v28, v10
    v_mul_f32 v29, v29, v11
    v_lshlrev_b32 v10, 16, v39
    v_lshlrev_b32 v30, 16, v45
    v_and_b32 v11, 0xffff0000, v39
    v_and_b32 v31, 0xffff0000, v45
    v_mul_f32 v30, v30, v10
    v_mul_f32 v31, v31, v11
    v_lshlrev_b32 v10, 16, v40
    v_lshlrev_b32 v32, 16, v46
    v_and_b32 v11, 0xffff0000, v40
    v_and_b32 v33, 0xffff0000, v46
    v_mul_f32 v32, v32, v10
    v_mul_f32 v33, v33, v11
    v_lshlrev_b32 v10, 16, v41
    v_lshlrev_b32 v34, 16, v47
    v_and_b32 v11, 0xffff0000, v41
    v_and_b32 v35, 0xffff0000, v47
    v_mul_f32 v34, v34, v10
    v_mul_f32 v35, v35, v11
    v_cvt_f32_i32 v64, v64
    v_cvt_f32_i32 v65, v65
    v_cvt_f32_i32 v66, v66
    v_cvt_f32_i32 v67, v67
    v_mul_f32 v54, v64, v24
    v_fmac_f32 v54, v65, v25
    v_fmac_f32 v54, v66, v26
    v_fmac_f32 v54, v67, v27
    v_cvt_f32_i32 v68, v68
    v_cvt_f32_i32 v69, v69
    v_cvt_f32_i32 v70, v70
    v_cvt_f32_i32 v71, v71
    v_fmac_f32 v54, v68, v28
    v_fmac_f32 v54, v69, v29
    v_fmac_f32 v54, v70, v30
    v_fmac_f32 v54, v71, v31
    v_cvt_f32_i32 v72, v72
    v_cvt_f32_i32 v73, v73
    v_cvt_f32_i32 v74, v74
    v_cvt_f32_i32 v75, v75
    v_fmac_f32 v54, v72, v32
    v_fmac_f32 v54, v73, v33
    v_fmac_f32 v54, v74, v34
    v_fmac_f32 v54, v75, v35
    v_cvt_f32_i32 v76, v76
    v_cvt_f32_i32 v77, v77
    v_add_f32_dpp v54, v54, v54 row_ror:8 row_mask:0xf bank_mask:0xf
    v_cvt_f32_i32 v78, v78
    v_cvt_f32_i32 v79, v79
    v_add_f32_dpp v54, v54, v54 row_ror:4 row_mask:0xf bank_mask:0xf
    v_mul_f32 v55, v76, v24
    v_fmac_f32 v55, v77, v25
    v_add_f32_dpp v54, v54, v54 row_ror:2 row_mask:0xf bank_mask:0xf
    v_fmac_f32 v55, v78, v26
    v_fmac_f32 v55, v79, v27
    v_add_f32_dpp v60, v54, v54 row_ror:1 row_mask:0xf bank_mask:0x1
    v_cvt_f32_i32 v80, v80
    v_cvt_f32_i32 v81, v81
    v_cvt_f32_i32 v82, v82
    v_cvt_f32_i32 v83, v83
    v_fmac_f32 v55, v80, v28
    v_fmac_f32 v55, v81, v29
    v_fmac_f32 v55, v82, v30
    v_fmac_f32 v55, v83, v31
    v_cvt_f32_i32 v84, v84
    v_cvt_f32_i32 v85, v85
    v_cvt_f32_i32 v86, v86
    v_cvt_f32_i32 v87, v87
    v_fmac_f32 v55, v84, v32
    v_fmac_f32 v55, v85, v33
    v_fmac_f32 v55, v86, v34
    v_fmac_f32 v55, v87, v35
    s_nop 1
    v_add_f32_dpp v55, v55, v55 row_ror:8 row_mask:0xf bank_mask:0xf
    s_nop 1
    v_add_f32_dpp v55, v55, v55 row_ror:4 row_mask:0xf bank_mask:0xf
    s_nop 1
    v_add_f32_dpp v55, v55, v55 row_ror:2 row_mask:0xf bank_mask:0xf
    s_nop 1
    v_add_f32_dpp v61, v55, v55 row_ror:1 row_mask:0xf bank_mask:0x1
    s_waitcnt vmcnt(6)
    s_add_u32 s29, s29, 4
    s_add_u32 s30, s30, 1
    s_lshr_b32 s33, s29, 6
    s_lshl_b32 s33, s33, 11
    s_and_b32 s32, s29, 63
    s_add_u32 s32, s32, s33
    s_add_u32 s32, s32, s44
    s_bfe_u32 s33, s32, 0x20003
    s_and_b32 s34, s32, 4
    s_or_b32 s33, s33, s34
    s_xor_b32 s33, s33, s5
    s_lshl_b32 s50, s32, 5
    s_or_b32 s50, s50, s33
    s_lshl_b32 s50, s50, 4
    s_or_b32 s50, s50, 1
    v_xor_b32 v10, s50, v50
    v_mul_hi_u32 v10, v10, s47
    v_lshrrev_b32 v10, 1, v10
    v_and_b32 v11, 15, v10
    v_cmp_eq_u32 vcc, 5, v11
    v_mad_u32_u24 v48, v10, s45, v2
    v_add_u32 v11, 3840, v48
    v_cndmask_b32 v49, v51, v11, vcc
    v_lshrrev_b32 v10, 6, v10
    v_mad_u32_u24 v9, v10, s46, v3
    buffer_load_dwordx2 v[42:43], v9, s[16:19], 0 offen offset:0
    buffer_load_dwordx2 v[44:45], v9, s[16:19], 0 offen offset:128
    buffer_load_dwordx2 v[46:47], v9, s[16:19], 0 offen offset:256
    v_cvt_f32_i32 v88, v88
    v_cvt_f32_i32 v89, v89
    v_cvt_f32_i32 v90, v90
    v_cvt_f32_i32 v91, v91
    v_mul_f32 v56, v88, v24
    v_fmac_f32 v56, v89, v25
    v_fmac_f32 v56, v90, v26
    v_fmac_f32 v56, v91, v27
    v_cvt_f32_i32 v92, v92
    v_cvt_f32_i32 v93, v93
    v_cvt_f32_i32 v94, v94
    v_cvt_f32_i32 v95, v95
    v_fmac_f32 v56, v92, v28
    v_fmac_f32 v56, v93, v29
    v_fmac_f32 v56, v94, v30
    v_fmac_f32 v56, v95, v31
    v_cvt_f32_i32 v96, v96
    v_cvt_f32_i32 v97, v97
    v_cvt_f32_i32 v98, v98
    v_cvt_f32_i32 v99, v99
    v_fmac_f32 v56, v96, v32
    v_fmac_f32 v56, v97, v33
    v_fmac_f32 v56, v98, v34
    v_fmac_f32 v56, v99, v35
    v_cvt_f32_i32 v100, v100
    v_cvt_f32_i32 v101, v101
    v_add_f32_dpp v56, v56, v56 row_ror:8 row_mask:0xf bank_mask:0xf
    v_cvt_f32_i32 v102, v102
    v_cvt_f32_i32 v103, v103
    v_add_f32_dpp v56, v56, v56 row_ror:4 row_mask:0xf bank_mask:0xf
    v_mul_f32 v57, v100, v24
    v_fmac_f32 v57, v101, v25
    v_add_f32_dpp v56, v56, v56 row_ror:2 row_mask:0xf bank_mask:0xf
    v_fmac_f32 v57, v102, v26
    v_fmac_f32 v57, v103, v27
    v_add_f32_dpp v60, v56, v56 row_ror:1 row_mask:0xf bank_mask:0x2
    v_cvt_f32_i32 v104, v104
    v_cvt_f32_i32 v105, v105
    v_cvt_f32_i32 v106, v106
    v_cvt_f32_i32 v107, v107
    v_fmac_f32 v57, v104, v28
    v_fmac_f32 v57, v105, v29
    v_fmac_f32 v57, v106, v30
    v_fmac_f32 v57, v107, v31
    v_cvt_f32_i32 v108, v108
    v_cvt_f32_i32 v109, v109
    v_cvt_f32_i32 v110, v110
    v_cvt_f32_i32 v111, v111
    v_fmac_f32 v57, v108, v32
    v_fmac_f32 v57, v109, v33
    v_fmac_f32 v57, v110, v34
    v_fmac_f32 v57, v111, v35
    s_nop 1
    v_add_f32_dpp v57, v57, v57 row_ror:8 row_mask:0xf bank_mask:0xf
    s_nop 1
    v_add_f32_dpp v57, v57, v57 row_ror:4 row_mask:0xf bank_mask:0xf
    s_nop 1
    v_add_f32_dpp v57, v57, v57 row_ror:2 row_mask:0xf bank_mask:0xf
    s_nop 1
    v_add_f32_dpp v61, v57, v57 row_ror:1 row_mask:0xf bank_mask:0x2
    s_waitcnt vmcnt(3)
    buffer_load_dwordx4 v[64:67], v48, s[8:11], 0 offen offset:0 nt
    buffer_load_dwordx4 v[68:71], v48, s[8:11], 0 offen offset:256 nt
    buffer_load_dwordx4 v[72:75], v48, s[8:11], 0 offen offset:512 nt
    buffer_load_dwordx4 v[76:79], v48, s[8:11], 0 offen offset:768 nt
    buffer_load_dwordx4 v[80:83], v48, s[8:11], 0 offen offset:1024 nt
    buffer_load_dwordx4 v[84:87], v48, s[8:11], 0 offen offset:1280 nt
    v_cvt_f32_i32 v112, v112
    v_cvt_f32_i32 v113, v113
    v_cvt_f32_i32 v114, v114
    v_cvt_f32_i32 v115, v115
    v_mul_f32 v58, v112, v24
    v_fmac_f32 v58, v113, v25
    v_fmac_f32 v58, v114, v26
    v_fmac_f32 v58, v115, v27
    v_cvt_f32_i32 v116, v116
    v_cvt_f32_i32 v117, v117
    v_cvt_f32_i32 v118, v118
    v_cvt_f32_i32 v119, v119
    v_fmac_f32 v58, v116, v28
    v_fmac_f32 v58, v117, v29
    v_fmac_f32 v58, v118, v30
    v_fmac_f32 v58, v119, v31
    v_cvt_f32_i32 v120, v120
    v_cvt_f32_i32 v121, v121
    v_cvt_f32_i32 v122, v122
    v_cvt_f32_i32 v123, v123
    v_fmac_f32 v58, v120, v32
    v_fmac_f32 v58, v121, v33
    v_fmac_f32 v58, v122, v34
    v_fmac_f32 v58, v123, v35
    v_cvt_f32_i32 v124, v124
    v_cvt_f32_i32 v125, v125
    v_add_f32_dpp v58, v58, v58 row_ror:8 row_mask:0xf bank_mask:0xf
    v_cvt_f32_i32 v126, v126
    v_cvt_f32_i32 v127, v127
    v_add_f32_dpp v58, v58, v58 row_ror:4 row_mask:0xf bank_mask:0xf
    v_mul_f32 v59, v124, v24
    v_fmac_f32 v59, v125, v25
    v_add_f32_dpp v58, v58, v58 row_ror:2 row_mask:0xf bank_mask:0xf
    v_fmac_f32 v59, v126, v26
    v_fmac_f32 v59, v127, v27
    v_add_f32_dpp v60, v58, v58 row_ror:1 row_mask:0xf bank_mask:0x4
    v_cvt_f32_i32 v128, v128
    v_cvt_f32_i32 v129, v129
    v_cvt_f32_i32 v130, v130
    v_cvt_f32_i32 v131, v131
    v_fmac_f32 v59, v128, v28
    v_fmac_f32 v59, v129, v29
    v_fmac_f32 v59, v130, v30
    v_fmac_f32 v59, v131, v31
    v_cvt_f32_i32 v132, v132
    v_cvt_f32_i32 v133, v133
    v_cvt_f32_i32 v134, v134
    v_cvt_f32_i32 v135, v135
    v_fmac_f32 v59, v132, v32
    v_fmac_f32 v59, v133, v33
    v_fmac_f32 v59, v134, v34
    v_fmac_f32 v59, v135, v35
    s_nop 1
    v_add_f32_dpp v59, v59, v59 row_ror:8 row_mask:0xf bank_mask:0xf
    s_nop 1
    v_add_f32_dpp v59, v59, v59 row_ror:4 row_mask:0xf bank_mask:0xf
    s_nop 1
    v_add_f32_dpp v59, v59, v59 row_ror:2 row_mask:0xf bank_mask:0xf
    s_nop 1
    v_add_f32_dpp v61, v59, v59 row_ror:1 row_mask:0xf bank_mask:0x4
    s_mov_b64 exec, s[42:43]
    ds_write_b64 v4, v[60:61]
    s_mov_b64 exec, -1
    v_add_u32 v4, 48, v4
    s_waitcnt vmcnt(6)
    v_lshlrev_b32 v10, 16, v36
    v_lshlrev_b32 v24, 16, v42
    v_and_b32 v11, 0xffff0000, v36
    v_and_b32 v25, 0xffff0000, v42
    v_mul_f32 v24, v24, v10
    v_mul_f32 v25, v25, v11
    v_lshlrev_b32 v10, 16, v37
    v_lshlrev_b32 v26, 16, v43
    v_and_b32 v11, 0xffff0000, v37
    v_and_b32 v27, 0xffff0000, v43
    v_mul_f32 v26, v26, v10
    v_mul_f32 v27, v27, v11
    v_lshlrev_b32 v10, 16, v38
    v_lshlrev_b32 v28, 16, v44
    v_and_b32 v11, 0xffff0000, v38
    v_and_b32 v29, 0xffff0000, v44
    v_mul_f32 v28, v28, v10
    v_mul_f32 v29, v29, v11
    v_lshlrev_b32 v10, 16, v39
    v_lshlrev_b32 v30, 16, v45
    v_and_b32 v11, 0xffff0000, v39
    v_and_b32 v31, 0xffff0000, v45
    v_mul_f32 v30, v30, v10
    v_mul_f32 v31, v31, v11
    v_lshlrev_b32 v10, 16, v40
    v_lshlrev_b32 v32, 16, v46
    v_and_b32 v11, 0xffff0000, v40
    v_and_b32 v33, 0xffff0000, v46
    v_mul_f32 v32, v32, v10
    v_mul_f32 v33, v33, v11
    v_lshlrev_b32 v10, 16, v41
    v_lshlrev_b32 v34, 16, v47
    v_and_b32 v11, 0xffff0000, v41
    v_and_b32 v35, 0xffff0000, v47
    v_mul_f32 v34, v34, v10
    v_mul_f32 v35, v35, v11
.p2align 6
L_kloop:
    s_nop 1
    s_waitcnt vmcnt(0)
    buffer_load_dwordx4 v[88:91], v48, s[8:11], 0 offen offset:1536 nt
    buffer_load_dwordx4 v[92:95], v48, s[8:11], 0 offen offset:1792 nt
    buffer_load_dwordx4 v[96:99], v48, s[8:11], 0 offen offset:2048 nt
    buffer_load_dwordx4 v[100:103], v48, s[8:11], 0 offen offset:2304 nt
    buffer_load_dwordx4 v[104:107], v48, s[8:11], 0 offen offset:2560 nt
    buffer_load_dwordx4 v[108:111], v48, s[8:11], 0 offen offset:2816 nt
    v_cvt_f32_i32 v64, v64
    v_cvt_f32_i32 v65, v65
    v_cvt_f32_i32 v66, v66
    v_cvt_f32_i32 v67, v67
    v_mul_f32 v54, v64, v24
    v_fmac_f32 v54, v65, v25
    v_fmac_f32 v54, v66, v26
    v_fmac_f32 v54, v67, v27
    v_cvt_f32_i32 v68, v68
    v_cvt_f32_i32 v69, v69
    v_cvt_f32_i32 v70, v70
    v_cvt_f32_i32 v71, v71
    v_fmac_f32 v54, v68, v28
    v_fmac_f32 v54, v69, v29
    v_fmac_f32 v54, v70, v30
    v_fmac_f32 v54, v71, v31
    v_cvt_f32_i32 v72, v72
    v_cvt_f32_i32 v73, v73
    v_cvt_f32_i32 v74, v74
    v_cvt_f32_i32 v75, v75
    v_fmac_f32 v54, v72, v32
    v_fmac_f32 v54, v73, v33
    v_fmac_f32 v54, v74, v34
    v_fmac_f32 v54, v75, v35
    v_cvt_f32_i32 v76, v76
    v_cvt_f32_i32 v77, v77
    v_add_f32_dpp v54, v54, v54 row_ror:8 row_mask:0xf bank_mask:0xf
    v_cvt_f32_i32 v78, v78
    v_cvt_f32_i32 v79, v79
    v_add_f32_dpp v54, v54, v54 row_ror:4 row_mask:0xf bank_mask:0xf
    v_mul_f32 v55, v76, v24
    v_fmac_f32 v55, v77, v25
    v_add_f32_dpp v54, v54, v54 row_ror:2 row_mask:0xf bank_mask:0xf
    v_fmac_f32 v55, v78, v26
    v_fmac_f32 v55, v79, v27
    v_add_f32_dpp v60, v54, v54 row_ror:1 row_mask:0xf bank_mask:0x1
    v_cvt_f32_i32 v80, v80
    v_cvt_f32_i32 v81, v81
    v_cvt_f32_i32 v82, v82
    v_cvt_f32_i32 v83, v83
    v_fmac_f32 v55, v80, v28
    v_fmac_f32 v55, v81, v29
    v_fmac_f32 v55, v82, v30
    v_fmac_f32 v55, v83, v31
    v_cvt_f32_i32 v84, v84
    v_cvt_f32_i32 v85, v85
    v_cvt_f32_i32 v86, v86
    v_cvt_f32_i32 v87, v87
    v_fmac_f32 v55, v84, v32
    v_fmac_f32 v55, v85, v33
    v_fmac_f32 v55, v86, v34
    v_fmac_f32 v55, v87, v35
    s_nop 1
    v_add_f32_dpp v55, v55, v55 row_ror:8 row_mask:0xf bank_mask:0xf
    s_nop 1
    v_add_f32_dpp v55, v55, v55 row_ror:4 row_mask:0xf bank_mask:0xf
    s_nop 1
    v_add_f32_dpp v55, v55, v55 row_ror:2 row_mask:0xf bank_mask:0xf
    s_nop 1
    v_add_f32_dpp v61, v55, v55 row_ror:1 row_mask:0xf bank_mask:0x1
    s_waitcnt vmcnt(0)
    buffer_load_dwordx4 v[112:115], v48, s[8:11], 0 offen offset:3072 nt
    buffer_load_dwordx4 v[116:119], v48, s[8:11], 0 offen offset:3328 nt
    buffer_load_dwordx4 v[120:123], v48, s[8:11], 0 offen offset:3584 nt
    buffer_load_dwordx4 v[124:127], v49, s[8:11], 0 offen offset:0 nt
    buffer_load_dwordx4 v[128:131], v49, s[8:11], 0 offen offset:256 nt
    buffer_load_dwordx4 v[132:135], v49, s[8:11], 0 offen offset:512 nt
    s_add_u32 s29, s29, 4
    s_add_u32 s30, s30, 1
    s_bitcmp1_b64 s[40:41], s30
    s_cbranch_scc1 L_evK
L_evretK:
    s_nop 1
    s_lshr_b32 s33, s29, 6
    s_lshl_b32 s33, s33, 11
    s_and_b32 s32, s29, 63
    s_add_u32 s32, s32, s33
    s_add_u32 s32, s32, s44
    s_bfe_u32 s33, s32, 0x20003
    s_and_b32 s34, s32, 4
    s_or_b32 s33, s33, s34
    s_xor_b32 s33, s33, s5
    s_lshl_b32 s50, s32, 5
    s_or_b32 s50, s50, s33
    s_lshl_b32 s50, s50, 4
    s_or_b32 s50, s50, 1
    v_xor_b32 v10, s50, v50
    v_mul_hi_u32 v10, v10, s47
    v_lshrrev_b32 v10, 1, v10
    v_and_b32 v11, 15, v10
    v_cmp_eq_u32 vcc, 5, v11
    v_mad_u32_u24 v48, v10, s45, v2
    v_add_u32 v11, 3840, v48
    v_cndmask_b32 v49, v51, v11, vcc
    v_lshrrev_b32 v10, 6, v10
    v_mad_u32_u24 v9, v10, s46, v3
    buffer_load_dwordx2 v[42:43], v9, s[16:19], 0 offen offset:0
    buffer_load_dwordx2 v[44:45], v9, s[16:19], 0 offen offset:128
    buffer_load_dwordx2 v[46:47], v9, s[16:19], 0 offen offset:256
    v_cvt_f32_i32 v88, v88
    v_cvt_f32_i32 v89, v89
    v_cvt_f32_i32 v90, v90
    v_cvt_f32_i32 v91, v91
    v_mul_f32 v56, v88, v24
    v_fmac_f32 v56, v89, v25
    v_fmac_f32 v56, v90, v26
    v_fmac_f32 v56, v91, v27
    v_cvt_f32_i32 v92, v92
    v_cvt_f32_i32 v93, v93
    v_cvt_f32_i32 v94, v94
    v_cvt_f32_i32 v95, v95
    v_fmac_f32 v56, v92, v28
    v_fmac_f32 v56, v93, v29
    v_fmac_f32 v56, v94, v30
    v_fmac_f32 v56, v95, v31
    v_cvt_f32_i32 v96, v96
    v_cvt_f32_i32 v97, v97
    v_cvt_f32_i32 v98, v98
    v_cvt_f32_i32 v99, v99
    v_fmac_f32 v56, v96, v32
    v_fmac_f32 v56, v97, v33
    v_fmac_f32 v56, v98, v34
    v_fmac_f32 v56, v99, v35
    v_cvt_f32_i32 v100, v100
    v_cvt_f32_i32 v101, v101
    v_add_f32_dpp v56, v56, v56 row_ror:8 row_mask:0xf bank_mask:0xf
    v_cvt_f32_i32 v102, v102
    v_cvt_f32_i32 v103, v103
    v_add_f32_dpp v56, v56, v56 row_ror:4 row_mask:0xf bank_mask:0xf
    v_mul_f32 v57, v100, v24
    v_fmac_f32 v57, v101, v25
    v_add_f32_dpp v56, v56, v56 row_ror:2 row_mask:0xf bank_mask:0xf
    v_fmac_f32 v57, v102, v26
    v_fmac_f32 v57, v103, v27
    v_add_f32_dpp v60, v56, v56 row_ror:1 row_mask:0xf bank_mask:0x2
    v_cvt_f32_i32 v104, v104
    v_cvt_f32_i32 v105, v105
    v_cvt_f32_i32 v106, v106
    v_cvt_f32_i32 v107, v107
    v_fmac_f32 v57, v104, v28
    v_fmac_f32 v57, v105, v29
    v_fmac_f32 v57, v106, v30
    v_fmac_f32 v57, v107, v31
    v_cvt_f32_i32 v108, v108
    v_cvt_f32_i32 v109, v109
    v_cvt_f32_i32 v110, v110
    v_cvt_f32_i32 v111, v111
    v_fmac_f32 v57, v108, v32
    v_fmac_f32 v57, v109, v33
    v_fmac_f32 v57, v110, v34
    v_fmac_f32 v57, v111, v35
    s_nop 1
    v_add_f32_dpp v57, v57, v57 row_ror:8 row_mask:0xf bank_mask:0xf
    s_nop 1
    v_add_f32_dpp v57, v57, v57 row_ror:4 row_mask:0xf bank_mask:0xf
    s_nop 1
    v_add_f32_dpp v57, v57, v57 row_ror:2 row_mask:0xf bank_mask:0xf
    s_nop 1
    v_add_f32_dpp v61, v57, v57 row_ror:1 row_mask:0xf bank_mask:0x2
    s_waitcnt vmcnt(3)
    buffer_load_dwordx4 v[64:67], v48, s[8:11], 0 offen offset:0 nt
    buffer_load_dwordx4 v[68:71], v48, s[8:11], 0 offen offset:256 nt
    buffer_load_dwordx4 v[72:75], v48, s[8:11], 0 offen offset:512 nt
    buffer_load_dwordx4 v[76:79], v48, s[8:11], 0 offen offset:768 nt
    buffer_load_dwordx4 v[80:83], v48, s[8:11], 0 offen offset:1024 nt
    buffer_load_dwordx4 v[84:87], v48, s[8:11], 0 offen offset:1280 nt
    v_cvt_f32_i32 v112, v112
    v_cvt_f32_i32 v113, v113
    v_cvt_f32_i32 v114, v114
    v_cvt_f32_i32 v115, v115
    v_mul_f32 v58, v112, v24
    v_fmac_f32 v58, v113, v25
    v_fmac_f32 v58, v114, v26
    v_fmac_f32 v58, v115, v27
    v_cvt_f32_i32 v116, v116
    v_cvt_f32_i32 v117, v117
    v_cvt_f32_i32 v118, v118
    v_cvt_f32_i32 v119, v119
    v_fmac_f32 v58, v116, v28
    v_fmac_f32 v58, v117, v29
    v_fmac_f32 v58, v118, v30
    v_fmac_f32 v58, v119, v31
    v_cvt_f32_i32 v120, v120
    v_cvt_f32_i32 v121, v121
    v_cvt_f32_i32 v122, v122
    v_cvt_f32_i32 v123, v123
    v_fmac_f32 v58, v120, v32
    v_fmac_f32 v58, v121, v33
    v_fmac_f32 v58, v122, v34
    v_fmac_f32 v58, v123, v35
    v_cvt_f32_i32 v124, v124
    v_cvt_f32_i32 v125, v125
    v_add_f32_dpp v58, v58, v58 row_ror:8 row_mask:0xf bank_mask:0xf
    v_cvt_f32_i32 v126, v126
    v_cvt_f32_i32 v127, v127
    v_add_f32_dpp v58, v58, v58 row_ror:4 row_mask:0xf bank_mask:0xf
    v_mul_f32 v59, v124, v24
    v_fmac_f32 v59, v125, v25
    v_add_f32_dpp v58, v58, v58 row_ror:2 row_mask:0xf bank_mask:0xf
    v_fmac_f32 v59, v126, v26
    v_fmac_f32 v59, v127, v27
    v_add_f32_dpp v60, v58, v58 row_ror:1 row_mask:0xf bank_mask:0x4
    v_cvt_f32_i32 v128, v128
    v_cvt_f32_i32 v129, v129
    v_cvt_f32_i32 v130, v130
    v_cvt_f32_i32 v131, v131
    v_fmac_f32 v59, v128, v28
    v_fmac_f32 v59, v129, v29
    v_fmac_f32 v59, v130, v30
    v_fmac_f32 v59, v131, v31
    v_cvt_f32_i32 v132, v132
    v_cvt_f32_i32 v133, v133
    v_cvt_f32_i32 v134, v134
    v_cvt_f32_i32 v135, v135
    v_fmac_f32 v59, v132, v32
    v_fmac_f32 v59, v133, v33
    v_fmac_f32 v59, v134, v34
    v_fmac_f32 v59, v135, v35
    s_nop 1
    v_add_f32_dpp v59, v59, v59 row_ror:8 row_mask:0xf bank_mask:0xf
    s_nop 1
    v_add_f32_dpp v59, v59, v59 row_ror:4 row_mask:0xf bank_mask:0xf
    s_nop 1
    v_add_f32_dpp v59, v59, v59 row_ror:2 row_mask:0xf bank_mask:0xf
    s_nop 1
    v_add_f32_dpp v61, v59, v59 row_ror:1 row_mask:0xf bank_mask:0x4
    s_mov_b64 exec, s[42:43]
    ds_write_b64 v4, v[60:61]
    s_mov_b64 exec, -1
    v_add_u32 v4, 48, v4
    s_waitcnt vmcnt(6)
    v_lshlrev_b32 v10, 16, v36
    v_lshlrev_b32 v24, 16, v42
    v_and_b32 v11, 0xffff0000, v36
    v_and_b32 v25, 0xffff0000, v42
    v_mul_f32 v24, v24, v10
    v_mul_f32 v25, v25, v11
    v_lshlrev_b32 v10, 16, v37
    v_lshlrev_b32 v26, 16, v43
    v_and_b32 v11, 0xffff0000, v37
    v_and_b32 v27, 0xffff0000, v43
    v_mul_f32 v26, v26, v10
    v_mul_f32 v27, v27, v11
    v_lshlrev_b32 v10, 16, v38
    v_lshlrev_b32 v28, 16, v44
    v_and_b32 v11, 0xffff0000, v38
    v_and_b32 v29, 0xffff0000, v44
    v_mul_f32 v28, v28, v10
    v_mul_f32 v29, v29, v11
    v_lshlrev_b32 v10, 16, v39
    v_lshlrev_b32 v30, 16, v45
    v_and_b32 v11, 0xffff0000, v39
    v_and_b32 v31, 0xffff0000, v45
    v_mul_f32 v30, v30, v10
    v_mul_f32 v31, v31, v11
    v_lshlrev_b32 v10, 16, v40
    v_lshlrev_b32 v32, 16, v46
    v_and_b32 v11, 0xffff0000, v40
    v_and_b32 v33, 0xffff0000, v46
    v_mul_f32 v32, v32, v10
    v_mul_f32 v33, v33, v11
    v_lshlrev_b32 v10, 16, v41
    v_lshlrev_b32 v34, 16, v47
    v_and_b32 v11, 0xffff0000, v41
    v_and_b32 v35, 0xffff0000, v47
    v_mul_f32 v34, v34, v10
    v_mul_f32 v35, v35, v11
L_kchk:
    s_nop 1
    s_cmp_lg_u32 s59, 0
    s_cbranch_scc1 L_kboost
L_kchk2:
    s_nop 1
    s_cmp_lg_u32 s30, 47
    s_cbranch_scc1 L_kloop
    s_waitcnt vmcnt(0)
    buffer_load_dwordx4 v[88:91], v48, s[8:11], 0 offen offset:1536 nt
    buffer_load_dwordx4 v[92:95], v48, s[8:11], 0 offen offset:1792 nt
    buffer_load_dwordx4 v[96:99], v48, s[8:11], 0 offen offset:2048 nt
    buffer_load_dwordx4 v[100:103], v48, s[8:11], 0 offen offset:2304 nt
    buffer_load_dwordx4 v[104:107], v48, s[8:11], 0 offen offset:2560 nt
    buffer_load_dwordx4 v[108:111], v48, s[8:11], 0 offen offset:2816 nt
    v_cvt_f32_i32 v64, v64
    v_cvt_f32_i32 v65, v65
    v_cvt_f32_i32 v66, v66
    v_cvt_f32_i32 v67, v67
    v_mul_f32 v54, v64, v24
    v_fmac_f32 v54, v65, v25
    v_fmac_f32 v54, v66, v26
    v_fmac_f32 v54, v67, v27
    v_cvt_f32_i32 v68, v68
    v_cvt_f32_i32 v69, v69
    v_cvt_f32_i32 v70, v70
    v_cvt_f32_i32 v71, v71
    v_fmac_f32 v54, v68, v28
    v_fmac_f32 v54, v69, v29
    v_fmac_f32 v54, v70, v30
    v_fmac_f32 v54, v71, v31
    v_cvt_f32_i32 v72, v72
    v_cvt_f32_i32 v73, v73
    v_cvt_f32_i32 v74, v74
    v_cvt_f32_i32 v75, v75
    v_fmac_f32 v54, v72, v32
    v_fmac_f32 v54, v73, v33
    v_fmac_f32 v54, v74, v34
    v_fmac_f32 v54, v75, v35
    v_cvt_f32_i32 v76, v76
    v_cvt_f32_i32 v77, v77
    v_add_f32_dpp v54, v54, v54 row_ror:8 row_mask:0xf bank_mask:0xf
    v_cvt_f32_i32 v78, v78
    v_cvt_f32_i32 v79, v79
    v_add_f32_dpp v54, v54, v54 row_ror:4 row_mask:0xf bank_mask:0xf
    v_mul_f32 v55, v76, v24
    v_fmac_f32 v55, v77, v25
    v_add_f32_dpp v54, v54, v54 row_ror:2 row_mask:0xf bank_mask:0xf
    v_fmac_f32 v55, v78, v26
    v_fmac_f32 v55, v79, v27
    v_add_f32_dpp v60, v54, v54 row_ror:1 row_mask:0xf bank_mask:0x1
    v_cvt_f32_i32 v80, v80
    v_cvt_f32_i32 v81, v81
    v_cvt_f32_i32 v82, v82
    v_cvt_f32_i32 v83, v83
    v_fmac_f32 v55, v80, v28
    v_fmac_f32 v55, v81, v29
    v_fmac_f32 v55, v82, v30
    v_fmac_f32 v55, v83, v31
    v_cvt_f32_i32 v84, v84
    v_cvt_f32_i32 v85, v85
    v_cvt_f32_i32 v86, v86
    v_cvt_f32_i32 v87, v87
    v_fmac_f32 v55, v84, v32
    v_fmac_f32 v55, v85, v33
    v_fmac_f32 v55, v86, v34
    v_fmac_f32 v55, v87, v35
    s_nop 1
    v_add_f32_dpp v55, v55, v55 row_ror:8 row_mask:0xf bank_mask:0xf
    s_nop 1
    v_add_f32_dpp v55, v55, v55 row_ror:4 row_mask:0xf bank_mask:0xf
    s_nop 1
    v_add_f32_dpp v55, v55, v55 row_ror:2 row_mask:0xf bank_mask:0xf
    s_nop 1
    v_add_f32_dpp v61, v55, v55 row_ror:1 row_mask:0xf bank_mask:0x1
    s_waitcnt vmcnt(0)
    buffer_load_dwordx4 v[112:115], v48, s[8:11], 0 offen offset:3072 nt
    buffer_load_dwordx4 v[116:119], v48, s[8:11], 0 offen offset:3328 nt
    buffer_load_dwordx4 v[120:123], v48, s[8:11], 0 offen offset:3584 nt
    buffer_load_dwordx4 v[124:127], v49, s[8:11], 0 offen offset:0 nt
    buffer_load_dwordx4 v[128:131], v49, s[8:11], 0 offen offset:256 nt
    buffer_load_dwordx4 v[132:135], v49, s[8:11], 0 offen offset:512 nt
    s_mov_b32 s29, s28
    s_mov_b32 s30, 0
    s_memrealtime s[36:37]
    s_mov_b32 s6, 0x100000
L_wgtv:
    s_nop 1
    ds_read_b32 v10, v53 offset:216
    s_sub_u32 s6, s6, 1
    s_cbranch_scc1 L_exit1
    s_waitcnt lgkmcnt(0)
    v_readfirstlane_b32 s32, v10
    s_cmp_eq_u32 s32, 0
    s_cbranch_scc1 L_wgtv
    s_and_b32 s32, s32, 0xffff
    s_cbranch_scc0 L_gxtv
    s_add_u32 s32, s32, s36
L_gltv:
    s_nop 1
    s_memrealtime s[36:37]
    s_waitcnt lgkmcnt(0)
    s_sub_u32 s36, s36, s32
    s_cmp_lt_i32 s36, 0
    s_cbranch_scc1 L_gltv
L_gxtv:
    s_nop 1
    s_lshr_b32 s33, s30, 4
    s_lshl_b32 s34, s33, 2
    v_mov_b32 v11, s34
    s_mov_b32 s6, 0x100000
L_wtv:
    s_nop 1
    ds_read_b32 v10, v11 offset:24
    s_sub_u32 s6, s6, 1
    s_cbranch_scc1 L_exit1
    s_waitcnt lgkmcnt(0)
    v_readfirstlane_b32 s32, v10
    s_cmp_eq_u32 s32, 0
    s_cbranch_scc1 L_wtv
    s_and_b32 s5, s32, 7
    s_xor_b32 s5, s5, s48
    s_bitcmp1_b32 s32, 3
    s_cselect_b64 vcc, -1, 0
    v_cndmask_b32 v50, v62, v63, vcc
    s_mov_b32 s49, 45
    s_mov_b32 s40, 0x2a2b2a2a
    s_mov_b32 s41, 0x152b
    s_mov_b32 s64, 0x2020202
    s_mov_b32 s65, 0x102
    s_mov_b32 s66, 0x8080808
    s_mov_b32 s67, 0x408
    s_mov_b32 s68, 0x20202020
    s_mov_b32 s69, 0x1020
    s_mov_b32 s70, 0x10000
    s_mov_b32 s71, 0x1
    s_lshr_b32 s33, s29, 6
    s_lshl_b32 s33, s33, 11
    s_and_b32 s32, s29, 63
    s_add_u32 s32, s32, s33
    s_add_u32 s32, s32, s44
    s_bfe_u32 s33, s32, 0x20003
    s_and_b32 s34, s32, 4
    s_or_b32 s33, s33, s34
    s_xor_b32 s33, s33, s5
    s_lshl_b32 s50, s32, 5
    s_or_b32 s50, s50, s33
    s_lshl_b32 s50, s50, 4
    s_or_b32 s50, s50, 1
    s_lshl_b32 s53, s29, 7
    v_xor_b32 v10, s50, v50
    v_mul_hi_u32 v10, v10, s47
    v_lshrrev_b32 v10, 1, v10
    v_and_b32 v11, 15, v10
    v_cmp_eq_u32 vcc, 5, v11
    v_mad_u32_u24 v48, v10, s45, v2
    v_add_u32 v11, 3840, v48
    v_cndmask_b32 v49, v51, v11, vcc
    v_add_u32 v10, s53, v5
    ds_read_b32 v7, v10
    v_cvt_f32_i32 v88, v88
    v_cvt_f32_i32 v89, v89
    v_cvt_f32_i32 v90, v90
    v_cvt_f32_i32 v91, v91
    v_mul_f32 v56, v88, v24
    v_fmac_f32 v56, v89, v25
    v_fmac_f32 v56, v90, v26
    v_fmac_f32 v56, v91, v27
    v_cvt_f32_i32 v92, v92
    v_cvt_f32_i32 v93, v93
    v_cvt_f32_i32 v94, v94
    v_cvt_f32_i32 v95, v95
    v_fmac_f32 v56, v92, v28
    v_fmac_f32 v56, v93, v29
    v_fmac_f32 v56, v94, v30
    v_fmac_f32 v56, v95, v31
    v_cvt_f32_i32 v96, v96
    v_cvt_f32_i32 v97, v97
    v_cvt_f32_i32 v98, v98
    v_cvt_f32_i32 v99, v99
    v_fmac_f32 v56, v96, v32
    v_fmac_f32 v56, v97, v33
    v_fmac_f32 v56, v98, v34
    v_fmac_f32 v56, v99, v35
    v_cvt_f32_i32 v100, v100
    v_cvt_f32_i32 v101, v101
    v_add_f32_dpp v56, v56, v56 row_ror:8 row_mask:0xf bank_mask:0xf
    v_cvt_f32_i32 v102, v102
    v_cvt_f32_i32 v103, v103
    v_add_f32_dpp v56, v56, v56 row_ror:4 row_mask:0xf bank_mask:0xf
    v_mul_f32 v57, v100, v24
    v_fmac_f32 v57, v101, v25
    v_add_f32_dpp v56, v56, v56 row_ror:2 row_mask:0xf bank_mask:0xf
    v_fmac_f32 v57, v102, v26
    v_fmac_f32 v57, v103, v27
    v_add_f32_dpp v60, v56, v56 row_ror:1 row_mask:0xf bank_mask:0x2
    v_cvt_f32_i32 v104, v104
    v_cvt_f32_i32 v105, v105
    v_cvt_f32_i32 v106, v106
    v_cvt_f32_i32 v107, v107
    v_fmac_f32 v57, v104, v28
    v_fmac_f32 v57, v105, v29
    v_fmac_f32 v57, v106, v30
    v_fmac_f32 v57, v107, v31
    v_cvt_f32_i32 v108, v108
    v_cvt_f32_i32 v109, v109
    v_cvt_f32_i32 v110, v110
    v_cvt_f32_i32 v111, v111
    v_fmac_f32 v57, v108, v32
    v_fmac_f32 v57, v109, v33
    v_fmac_f32 v57, v110, v34
    v_fmac_f32 v57, v111, v35
    s_nop 1
    v_add_f32_dpp v57, v57, v57 row_ror:8 row_mask:0xf bank_mask:0xf
    s_nop 1
    v_add_f32_dpp v57, v57, v57 row_ror:4 row_mask:0xf bank_mask:0xf
    s_nop 1
    v_add_f32_dpp v57, v57, v57 row_ror:2 row_mask:0xf bank_mask:0xf
    s_nop 1
    v_add_f32_dpp v61, v57, v57 row_ror:1 row_mask:0xf bank_mask:0x2
    s_waitcnt vmcnt(0)
    buffer_load_dwordx4 v[64:67], v48, s[12:15], 0 offen offset:0 nt
    buffer_load_dwordx4 v[68:71], v48, s[12:15], 0 offen offset:256 nt
    buffer_load_dwordx4 v[72:75], v48, s[12:15], 0 offen offset:512 nt
    buffer_load_dwordx4 v[76:79], v48, s[12:15], 0 offen offset:768 nt
    buffer_load_dwordx4 v[80:83], v48, s[12:15], 0 offen offset:1024 nt
    buffer_load_dwordx4 v[84:87], v48, s[12:15], 0 offen offset:1280 nt
    v_cvt_f32_i32 v112, v112
    v_cvt_f32_i32 v113, v113
    v_cvt_f32_i32 v114, v114
    v_cvt_f32_i32 v115, v115
    v_mul_f32 v58, v112, v24
    v_fmac_f32 v58, v113, v25
    v_fmac_f32 v58, v114, v26
    v_fmac_f32 v58, v115, v27
    v_cvt_f32_i32 v116, v116
    v_cvt_f32_i32 v117, v117
    v_cvt_f32_i32 v118, v118
    v_cvt_f32_i32 v119, v119
    v_fmac_f32 v58, v116, v28
    v_fmac_f32 v58, v117, v29
    v_fmac_f32 v58, v118, v30
    v_fmac_f32 v58, v119, v31
    v_cvt_f32_i32 v120, v120
    v_cvt_f32_i32 v121, v121
    v_cvt_f32_i32 v122, v122
    v_cvt_f32_i32 v123, v123
    v_fmac_f32 v58, v120, v32
    v_fmac_f32 v58, v121, v33
    v_fmac_f32 v58, v122, v34
    v_fmac_f32 v58, v123, v35
    v_cvt_f32_i32 v124, v124
    v_cvt_f32_i32 v125, v125
    v_add_f32_dpp v58, v58, v58 row_ror:8 row_mask:0xf bank_mask:0xf
    v_cvt_f32_i32 v126, v126
    v_cvt_f32_i32 v127, v127
    v_add_f32_dpp v58, v58, v58 row_ror:4 row_mask:0xf bank_mask:0xf
    v_mul_f32 v59, v124, v24
    v_fmac_f32 v59, v125, v25
    v_add_f32_dpp v58, v58, v58 row_ror:2 row_mask:0xf bank_mask:0xf
    v_fmac_f32 v59, v126, v26
    v_fmac_f32 v59, v127, v27
    v_add_f32_dpp v60, v58, v58 row_ror:1 row_mask:0xf bank_mask:0x4
    v_cvt_f32_i32 v128, v128
    v_cvt_f32_i32 v129, v129
    v_cvt_f32_i32 v130, v130
    v_cvt_f32_i32 v131, v131
    v_fmac_f32 v59, v128, v28
    v_fmac_f32 v59, v129, v29
    v_fmac_f32 v59, v130, v30
    v_fmac_f32 v59, v131, v31
    v_cvt_f32_i32 v132, v132
    v_cvt_f32_i32 v133, v133
    v_cvt_f32_i32 v134, v134
    v_cvt_f32_i32 v135, v135
    v_fmac_f32 v59, v132, v32
    v_fmac_f32 v59, v133, v33
    v_fmac_f32 v59, v134, v34
    v_fmac_f32 v59, v135, v35
    s_nop 1
    v_add_f32_dpp v59, v59, v59 row_ror:8 row_mask:0xf bank_mask:0xf
    s_nop 1
    v_add_f32_dpp v59, v59, v59 row_ror:4 row_mask:0xf bank_mask:0xf
    s_nop 1
    v_add_f32_dpp v59, v59, v59 row_ror:2 row_mask:0xf bank_mask:0xf
    s_nop 1
    v_add_f32_dpp v61, v59, v59 row_ror:1 row_mask:0xf bank_mask:0x4
    s_mov_b64 exec, s[42:43]
    ds_write_b64 v4, v[60:61]
    s_mov_b64 exec, -1
    s_waitcnt lgkmcnt(0)
    v_mov_b32 v6, v7
    v_mov_b32 v11, 1
    s_mov_b64 exec, 1
    ds_add_u32 v53, v11 offset:48
    s_mov_b64 exec, -1
.p2align 6
L_vloop:
    s_nop 1
    s_waitcnt vmcnt(0)
    buffer_load_dwordx4 v[88:91], v48, s[12:15], 0 offen offset:1536 nt
    buffer_load_dwordx4 v[92:95], v48, s[12:15], 0 offen offset:1792 nt
    buffer_load_dwordx4 v[96:99], v48, s[12:15], 0 offen offset:2048 nt
    buffer_load_dwordx4 v[100:103], v48, s[12:15], 0 offen offset:2304 nt
    buffer_load_dwordx4 v[104:107], v48, s[12:15], 0 offen offset:2560 nt
    buffer_load_dwordx4 v[108:111], v48, s[12:15], 0 offen offset:2816 nt
    v_cvt_f32_i32 v64, v64
    v_cvt_f32_i32 v65, v65
    v_cvt_f32_i32 v66, v66
    v_cvt_f32_i32 v67, v67
    v_fmac_f32_dpp v12, v6, v64 row_newbcast:0 row_mask:0xf bank_mask:0xf
    v_fmac_f32_dpp v13, v6, v65 row_newbcast:0 row_mask:0xf bank_mask:0xf
    v_fmac_f32_dpp v14, v6, v66 row_newbcast:0 row_mask:0xf bank_mask:0xf
    v_fmac_f32_dpp v15, v6, v67 row_newbcast:0 row_mask:0xf bank_mask:0xf
    v_cvt_f32_i32 v68, v68
    v_cvt_f32_i32 v69, v69
    v_cvt_f32_i32 v70, v70
    v_cvt_f32_i32 v71, v71
    v_fmac_f32_dpp v16, v6, v68 row_newbcast:0 row_mask:0xf bank_mask:0xf
    v_fmac_f32_dpp v17, v6, v69 row_newbcast:0 row_mask:0xf bank_mask:0xf
    v_fmac_f32_dpp v18, v6, v70 row_newbcast:0 row_mask:0xf bank_mask:0xf
    v_fmac_f32_dpp v19, v6, v71 row_newbcast:0 row_mask:0xf bank_mask:0xf
    v_cvt_f32_i32 v72, v72
    v_cvt_f32_i32 v73, v73
    v_cvt_f32_i32 v74, v74
    v_cvt_f32_i32 v75, v75
    v_fmac_f32_dpp v20, v6, v72 row_newbcast:0 row_mask:0xf bank_mask:0xf
    v_fmac_f32_dpp v21, v6, v73 row_newbcast:0 row_mask:0xf bank_mask:0xf
    v_fmac_f32_dpp v22, v6, v74 row_newbcast:0 row_mask:0xf bank_mask:0xf
    v_fmac_f32_dpp v23, v6, v75 row_newbcast:0 row_mask:0xf bank_mask:0xf
    v_cvt_f32_i32 v76, v76
    v_cvt_f32_i32 v77, v77
    v_cvt_f32_i32 v78, v78
    v_cvt_f32_i32 v79, v79
    v_fmac_f32_dpp v12, v6, v76 row_newbcast:1 row_mask:0xf bank_mask:0xf
    v_fmac_f32_dpp v13, v6, v77 row_newbcast:1 row_mask:0xf bank_mask:0xf
    v_fmac_f32_dpp v14, v6, v78 row_newbcast:1 row_mask:0xf bank_mask:0xf
    v_fmac_f32_dpp v15, v6, v79 row_newbcast:1 row_mask:0xf bank_mask:0xf
    v_cvt_f32_i32 v80, v80
    v_cvt_f32_i32 v81, v81
    v_cvt_f32_i32 v82, v82
    v_cvt_f32_i32 v83, v83
    v_fmac_f32_dpp v16, v6, v80 row_newbcast:1 row_mask:0xf bank_mask:0xf
    v_fmac_f32_dpp v17, v6, v81 row_newbcast:1 row_mask:0xf bank_mask:0xf
    v_fmac_f32_dpp v18, v6, v82 row_newbcast:1 row_mask:0xf bank_mask:0xf
    v_fmac_f32_dpp v19, v6, v83 row_newbcast:1 row_mask:0xf bank_mask:0xf
    v_cvt_f32_i32 v84, v84
    v_cvt_f32_i32 v85, v85
    v_cvt_f32_i32 v86, v86
    v_cvt_f32_i32 v87, v87
    v_fmac_f32_dpp v20, v6, v84 row_newbcast:1 row_mask:0xf bank_mask:0xf
    v_fmac_f32_dpp v21, v6, v85 row_newbcast:1 row_mask:0xf bank_mask:0xf
    v_fmac_f32_dpp v22, v6, v86 row_newbcast:1 row_mask:0xf bank_mask:0xf
    v_fmac_f32_dpp v23, v6, v87 row_newbcast:1 row_mask:0xf bank_mask:0xf
    s_waitcnt vmcnt(0)
    buffer_load_dwordx4 v[112:115], v48, s[12:15], 0 offen offset:3072 nt
    buffer_load_dwordx4 v[116:119], v48, s[12:15], 0 offen offset:3328 nt
    buffer_load_dwordx4 v[120:123], v48, s[12:15], 0 offen offset:3584 nt
    buffer_load_dwordx4 v[124:127], v49, s[12:15], 0 offen offset:0 nt
    buffer_load_dwordx4 v[128:131], v49, s[12:15], 0 offen offset:256 nt
    buffer_load_dwordx4 v[132:135], v49, s[12:15], 0 offen offset:512 nt
    s_add_u32 s29, s29, 4
    s_add_u32 s30, s30, 1
    s_bitcmp1_b64 s[40:41], s30
    s_cbranch_scc1 L_evV
L_evretV:
    s_nop 1
    s_lshr_b32 s33, s29, 6
    s_lshl_b32 s33, s33, 11
    s_and_b32 s32, s29, 63
    s_add_u32 s32, s32, s33
    s_add_u32 s32, s32, s44
    s_bfe_u32 s33, s32, 0x20003
    s_and_b32 s34, s32, 4
    s_or_b32 s33, s33, s34
    s_xor_b32 s33, s33, s5
    s_lshl_b32 s50, s32, 5
    s_or_b32 s50, s50, s33
    s_lshl_b32 s50, s50, 4
    s_or_b32 s50, s50, 1
    s_lshl_b32 s53, s29, 7
    v_xor_b32 v10, s50, v50
    v_mul_hi_u32 v10, v10, s47
    v_lshrrev_b32 v10, 1, v10
    v_and_b32 v11, 15, v10
    v_cmp_eq_u32 vcc, 5, v11
    v_mad_u32_u24 v48, v10, s45, v2
    v_add_u32 v11, 3840, v48
    v_cndmask_b32 v49, v51, v11, vcc
    v_add_u32 v10, s53, v5
    ds_read_b32 v7, v10
    s_cmp_eq_u32 s30, 48
    s_cbranch_scc1 L_el0
L_el0r:
    v_cvt_f32_i32 v88, v88
    v_cvt_f32_i32 v89, v89
    v_cvt_f32_i32 v90, v90
    v_cvt_f32_i32 v91, v91
    v_fmac_f32_dpp v12, v6, v88 row_newbcast:2 row_mask:0xf bank_mask:0xf
    v_fmac_f32_dpp v13, v6, v89 row_newbcast:2 row_mask:0xf bank_mask:0xf
    v_fmac_f32_dpp v14, v6, v90 row_newbcast:2 row_mask:0xf bank_mask:0xf
    v_fmac_f32_dpp v15, v6, v91 row_newbcast:2 row_mask:0xf bank_mask:0xf
    v_cvt_f32_i32 v92, v92
    v_cvt_f32_i32 v93, v93
    v_cvt_f32_i32 v94, v94
    v_cvt_f32_i32 v95, v95
    v_fmac_f32_dpp v16, v6, v92 row_newbcast:2 row_mask:0xf bank_mask:0xf
    v_fmac_f32_dpp v17, v6, v93 row_newbcast:2 row_mask:0xf bank_mask:0xf
    v_fmac_f32_dpp v18, v6, v94 row_newbcast:2 row_mask:0xf bank_mask:0xf
    v_fmac_f32_dpp v19, v6, v95 row_newbcast:2 row_mask:0xf bank_mask:0xf
    v_cvt_f32_i32 v96, v96
    v_cvt_f32_i32 v97, v97
    v_cvt_f32_i32 v98, v98
    v_cvt_f32_i32 v99, v99
    v_fmac_f32_dpp v20, v6, v96 row_newbcast:2 row_mask:0xf bank_mask:0xf
    v_fmac_f32_dpp v21, v6, v97 row_newbcast:2 row_mask:0xf bank_mask:0xf
    v_fmac_f32_dpp v22, v6, v98 row_newbcast:2 row_mask:0xf bank_mask:0xf
    v_fmac_f32_dpp v23, v6, v99 row_newbcast:2 row_mask:0xf bank_mask:0xf
    v_cvt_f32_i32 v100, v100
    v_cvt_f32_i32 v101, v101
    v_cvt_f32_i32 v102, v102
    v_cvt_f32_i32 v103, v103
    v_fmac_f32_dpp v12, v6, v100 row_newbcast:3 row_mask:0xf bank_mask:0xf
    v_fmac_f32_dpp v13, v6, v101 row_newbcast:3 row_mask:0xf bank_mask:0xf
    v_fmac_f32_dpp v14, v6, v102 row_newbcast:3 row_mask:0xf bank_mask:0xf
    v_fmac_f32_dpp v15, v6, v103 row_newbcast:3 row_mask:0xf bank_mask:0xf
    v_cvt_f32_i32 v104, v104
    v_cvt_f32_i32 v105, v105
    v_cvt_f32_i32 v106, v106
    v_cvt_f32_i32 v107, v107
    v_fmac_f32_dpp v16, v6, v104 row_newbcast:3 row_mask:0xf bank_mask:0xf
    v_fmac_f32_dpp v17, v6, v105 row_newbcast:3 row_mask:0xf bank_mask:0xf
    v_fmac_f32_dpp v18, v6, v106 row_newbcast:3 row_mask:0xf bank_mask:0xf
    v_fmac_f32_dpp v19, v6, v107 row_newbcast:3 row_mask:0xf bank_mask:0xf
    v_cvt_f32_i32 v108, v108
    v_cvt_f32_i32 v109, v109
    v_cvt_f32_i32 v110, v110
    v_cvt_f32_i32 v111, v111
    v_fmac_f32_dpp v20, v6, v108 row_newbcast:3 row_mask:0xf bank_mask:0xf
    v_fmac_f32_dpp v21, v6, v109 row_newbcast:3 row_mask:0xf bank_mask:0xf
    v_fmac_f32_dpp v22, v6, v110 row_newbcast:3 row_mask:0xf bank_mask:0xf
    v_fmac_f32_dpp v23, v6, v111 row_newbcast:3 row_mask:0xf bank_mask:0xf
    s_waitcnt vmcnt(0)
    buffer_load_dwordx4 v[64:67], v48, s[12:15], 0 offen offset:0 nt
    buffer_load_dwordx4 v[68:71], v48, s[12:15], 0 offen offset:256 nt
    buffer_load_dwordx4 v[72:75], v48, s[12:15], 0 offen offset:512 nt
    buffer_load_dwordx4 v[76:79], v48, s[12:15], 0 offen offset:768 nt
    buffer_load_dwordx4 v[80:83], v48, s[12:15], 0 offen offset:1024 nt
    buffer_load_dwordx4 v[84:87], v48, s[12:15], 0 offen offset:1280 nt
    v_cvt_f32_i32 v112, v112
    v_cvt_f32_i32 v113, v113
    v_cvt_f32_i32 v114, v114
    v_cvt_f32_i32 v115, v115
    v_fmac_f32_dpp v12, v6, v112 row_newbcast:4 row_mask:0xf bank_mask:0xf
    v_fmac_f32_dpp v13, v6, v113 row_newbcast:4 row_mask:0xf bank_mask:0xf
    v_fmac_f32_dpp v14, v6, v114 row_newbcast:4 row_mask:0xf bank_mask:0xf
    v_fmac_f32_dpp v15, v6, v115 row_newbcast:4 row_mask:0xf bank_mask:0xf
    v_cvt_f32_i32 v116, v116
    v_cvt_f32_i32 v117, v117
    v_cvt_f32_i32 v118, v118
    v_cvt_f32_i32 v119, v119
    v_fmac_f32_dpp v16, v6, v116 row_newbcast:4 row_mask:0xf bank_mask:0xf
    v_fmac_f32_dpp v17, v6, v117 row_newbcast:4 row_mask:0xf bank_mask:0xf
    v_fmac_f32_dpp v18, v6, v118 row_newbcast:4 row_mask:0xf bank_mask:0xf
    v_fmac_f32_dpp v19, v6, v119 row_newbcast:4 row_mask:0xf bank_mask:0xf
    v_cvt_f32_i32 v120, v120
    v_cvt_f32_i32 v121, v121
    v_cvt_f32_i32 v122, v122
    v_cvt_f32_i32 v123, v123
    v_fmac_f32_dpp v20, v6, v120 row_newbcast:4 row_mask:0xf bank_mask:0xf
    v_fmac_f32_dpp v21, v6, v121 row_newbcast:4 row_mask:0xf bank_mask:0xf
    v_fmac_f32_dpp v22, v6, v122 row_newbcast:4 row_mask:0xf bank_mask:0xf
    v_fmac_f32_dpp v23, v6, v123 row_newbcast:4 row_mask:0xf bank_mask:0xf
    v_cvt_f32_i32 v124, v124
    v_cvt_f32_i32 v125, v125
    v_cvt_f32_i32 v126, v126
    v_cvt_f32_i32 v127, v127
    v_fmac_f32_dpp v12, v6, v124 row_newbcast:5 row_mask:0xf bank_mask:0xf
    v_fmac_f32_dpp v13, v6, v125 row_newbcast:5 row_mask:0xf bank_mask:0xf
    v_fmac_f32_dpp v14, v6, v126 row_newbcast:5 row_mask:0xf bank_mask:0xf
    v_fmac_f32_dpp v15, v6, v127 row_newbcast:5 row_mask:0xf bank_mask:0xf
    v_cvt_f32_i32 v128, v128
    v_cvt_f32_i32 v129, v129
    v_cvt_f32_i32 v130, v130
    v_cvt_f32_i32 v131, v131
    v_fmac_f32_dpp v16, v6, v128 row_newbcast:5 row_mask:0xf bank_mask:0xf
    v_fmac_f32_dpp v17, v6, v129 row_newbcast:5 row_mask:0xf bank_mask:0xf
    v_fmac_f32_dpp v18, v6, v130 row_newbcast:5 row_mask:0xf bank_mask:0xf
    v_fmac_f32_dpp v19, v6, v131 row_newbcast:5 row_mask:0xf bank_mask:0xf
    v_cvt_f32_i32 v132, v132
    v_cvt_f32_i32 v133, v133
    v_cvt_f32_i32 v134, v134
    v_cvt_f32_i32 v135, v135
    v_fmac_f32_dpp v20, v6, v132 row_newbcast:5 row_mask:0xf bank_mask:0xf
    v_fmac_f32_dpp v21, v6, v133 row_newbcast:5 row_mask:0xf bank_mask:0xf
    v_fmac_f32_dpp v22, v6, v134 row_newbcast:5 row_mask:0xf bank_mask:0xf
    v_fmac_f32_dpp v23, v6, v135 row_newbcast:5 row_mask:0xf bank_mask:0xf
    s_waitcnt lgkmcnt(0)
    v_mov_b32 v6, v7
L_vchk:
    s_nop 1
    s_cmp_eq_u32 s30, s49
    s_cbranch_scc1 L_deep
    s_cmp_lg_u32 s59, 0
    s_cbranch_scc1 L_vboost
    s_and_b32 s32, s30, 15
    s_cbranch_scc1 L_vloop
L_vend:
    s_nop 1
    v_permlane32_swap_b32 v12, v14
    v_permlane32_swap_b32 v13, v15
    v_permlane32_swap_b32 v16, v18
    v_permlane32_swap_b32 v17, v19
    v_permlane32_swap_b32 v20, v22
    v_permlane32_swap_b32 v21, v23
    v_add_f32 v12, v12, v14
    v_add_f32 v13, v13, v15
    v_add_f32 v16, v16, v18
    v_add_f32 v17, v17, v19
    v_add_f32 v20, v20, v22
    v_add_f32 v21, v21, v23
    v_permlane16_swap_b32 v12, v13
    v_permlane16_swap_b32 v16, v17
    v_permlane16_swap_b32 v20, v21
    s_lshr_b32 s32, s30, 2
    v_mov_b32 v10, s32
    v_add_f32 v12, v12, v13
    ds_write_b32 v8, v12 offset:0
    v_add_f32 v16, v16, v17
    ds_write_b32 v8, v16 offset:256
    v_add_f32 v20, v20, v21
    ds_write_b32 v8, v20 offset:512
    v_mov_b32 v11, 1
    s_mov_b64 exec, 1
    ds_add_u32 v10, v11 offset:60
    s_mov_b64 exec, -1
    v_add_u32 v8, 3072, v8
    v_mov_b32 v12, 0
    v_mov_b32 v13, 0
    v_mov_b32 v14, 0
    v_mov_b32 v15, 0
    v_mov_b32 v16, 0
    v_mov_b32 v17, 0
    v_mov_b32 v18, 0
    v_mov_b32 v19, 0
    v_mov_b32 v20, 0
    v_mov_b32 v21, 0
    v_mov_b32 v22, 0
    v_mov_b32 v23, 0
    s_cmp_lg_u32 s59, 0
    s_cbranch_scc1 L_vboost2
L_vend2:
    s_nop 1
    s_cmp_lg_u32 s30, 48
    s_cbranch_scc1 L_vloop
L_exit1:
    s_endpgm
L_deep:
    s_nop 1
    buffer_load_dwordx4 v[88:91], v48, s[12:15], 0 offen offset:1536 nt
    buffer_load_dwordx4 v[92:95], v48, s[12:15], 0 offen offset:1792 nt
    buffer_load_dwordx4 v[96:99], v48, s[12:15], 0 offen offset:2048 nt
    buffer_load_dwordx4 v[100:103], v48, s[12:15], 0 offen offset:2304 nt
    buffer_load_dwordx4 v[104:107], v48, s[12:15], 0 offen offset:2560 nt
    buffer_load_dwordx4 v[108:111], v48, s[12:15], 0 offen offset:2816 nt
    buffer_load_dwordx4 v[112:115], v48, s[12:15], 0 offen offset:3072 nt
    buffer_load_dwordx4 v[116:119], v48, s[12:15], 0 offen offset:3328 nt
    buffer_load_dwordx4 v[120:123], v48, s[12:15], 0 offen offset:3584 nt
    buffer_load_dwordx4 v[124:127], v49, s[12:15], 0 offen offset:0 nt
    buffer_load_dwordx4 v[128:131], v49, s[12:15], 0 offen offset:256 nt
    buffer_load_dwordx4 v[132:135], v49, s[12:15], 0 offen offset:512 nt
.p2align 6
L_dloop:
    s_nop 1
    s_add_u32 s29, s29, 4
    s_add_u32 s30, s30, 1
    s_lshr_b32 s33, s29, 6
    s_lshl_b32 s33, s33, 11
    s_and_b32 s32, s29, 63
    s_add_u32 s32, s32, s33
    s_add_u32 s32, s32, s44
    s_bfe_u32 s33, s32, 0x20003
    s_and_b32 s34, s32, 4
    s_or_b32 s33, s33, s34
    s_xor_b32 s33, s33, s5
    s_lshl_b32 s50, s32, 5
    s_or_b32 s50, s50, s33
    s_lshl_b32 s50, s50, 4
    s_or_b32 s50, s50, 1
    s_lshl_b32 s53, s29, 7
    v_xor_b32 v10, s50, v50
    v_mul_hi_u32 v10, v10, s47
    v_lshrrev_b32 v10, 1, v10
    v_and_b32 v11, 15, v10
    v_cmp_eq_u32 vcc, 5, v11
    v_mad_u32_u24 v48, v10, s45, v2
    v_add_u32 v11, 3840, v48
    v_cndmask_b32 v49, v51, v11, vcc
    v_add_u32 v10, s53, v5
    ds_read_b32 v7, v10
    s_waitcnt vmcnt(12)
    v_cvt_f32_i32 v64, v64
    v_cvt_f32_i32 v65, v65
    v_cvt_f32_i32 v66, v66
    v_cvt_f32_i32 v67, v67
    v_fmac_f32_dpp v12, v6, v64 row_newbcast:0 row_mask:0xf bank_mask:0xf
    v_fmac_f32_dpp v13, v6, v65 row_newbcast:0 row_mask:0xf bank_mask:0xf
    v_fmac_f32_dpp v14, v6, v66 row_newbcast:0 row_mask:0xf bank_mask:0xf
    v_fmac_f32_dpp v15, v6, v67 row_newbcast:0 row_mask:0xf bank_mask:0xf
    v_cvt_f32_i32 v68, v68
    v_cvt_f32_i32 v69, v69
    v_cvt_f32_i32 v70, v70
    v_cvt_f32_i32 v71, v71
    v_fmac_f32_dpp v16, v6, v68 row_newbcast:0 row_mask:0xf bank_mask:0xf
    v_fmac_f32_dpp v17, v6, v69 row_newbcast:0 row_mask:0xf bank_mask:0xf
    v_fmac_f32_dpp v18, v6, v70 row_newbcast:0 row_mask:0xf bank_mask:0xf
    v_fmac_f32_dpp v19, v6, v71 row_newbcast:0 row_mask:0xf bank_mask:0xf
    v_cvt_f32_i32 v72, v72
    v_cvt_f32_i32 v73, v73
    v_cvt_f32_i32 v74, v74
    v_cvt_f32_i32 v75, v75
    v_fmac_f32_dpp v20, v6, v72 row_newbcast:0 row_mask:0xf bank_mask:0xf
    v_fmac_f32_dpp v21, v6, v73 row_newbcast:0 row_mask:0xf bank_mask:0xf
    v_fmac_f32_dpp v22, v6, v74 row_newbcast:0 row_mask:0xf bank_mask:0xf
    v_fmac_f32_dpp v23, v6, v75 row_newbcast:0 row_mask:0xf bank_mask:0xf
    v_cvt_f32_i32 v76, v76
    v_cvt_f32_i32 v77, v77
    v_cvt_f32_i32 v78, v78
    v_cvt_f32_i32 v79, v79
    v_fmac_f32_dpp v12, v6, v76 row_newbcast:1 row_mask:0xf bank_mask:0xf
    v_fmac_f32_dpp v13, v6, v77 row_newbcast:1 row_mask:0xf bank_mask:0xf
    v_fmac_f32_dpp v14, v6, v78 row_newbcast:1 row_mask:0xf bank_mask:0xf
    v_fmac_f32_dpp v15, v6, v79 row_newbcast:1 row_mask:0xf bank_mask:0xf
    v_cvt_f32_i32 v80, v80
    v_cvt_f32_i32 v81, v81
    v_cvt_f32_i32 v82, v82
    v_cvt_f32_i32 v83, v83
    v_fmac_f32_dpp v16, v6, v80 row_newbcast:1 row_mask:0xf bank_mask:0xf
    v_fmac_f32_dpp v17, v6, v81 row_newbcast:1 row_mask:0xf bank_mask:0xf
    v_fmac_f32_dpp v18, v6, v82 row_newbcast:1 row_mask:0xf bank_mask:0xf
    v_fmac_f32_dpp v19, v6, v83 row_newbcast:1 row_mask:0xf bank_mask:0xf
    v_cvt_f32_i32 v84, v84
    v_cvt_f32_i32 v85, v85
    v_cvt_f32_i32 v86, v86
    v_cvt_f32_i32 v87, v87
    v_fmac_f32_dpp v20, v6, v84 row_newbcast:1 row_mask:0xf bank_mask:0xf
    v_fmac_f32_dpp v21, v6, v85 row_newbcast:1 row_mask:0xf bank_mask:0xf
    v_fmac_f32_dpp v22, v6, v86 row_newbcast:1 row_mask:0xf bank_mask:0xf
    v_fmac_f32_dpp v23, v6, v87 row_newbcast:1 row_mask:0xf bank_mask:0xf
    buffer_load_dwordx4 v[64:67], v48, s[12:15], 0 offen offset:0 nt
    buffer_load_dwordx4 v[68:71], v48, s[12:15], 0 offen offset:256 nt
    buffer_load_dwordx4 v[72:75], v48, s[12:15], 0 offen offset:512 nt
    buffer_load_dwordx4 v[76:79], v48, s[12:15], 0 offen offset:768 nt
    buffer_load_dwordx4 v[80:83], v48, s[12:15], 0 offen offset:1024 nt
    buffer_load_dwordx4 v[84:87], v48, s[12:15], 0 offen offset:1280 nt
    s_waitcnt vmcnt(12)
    s_cmp_eq_u32 s30, 48
    s_cbranch_scc1 L_el1
L_el1r:
    v_cvt_f32_i32 v88, v88
    v_cvt_f32_i32 v89, v89
    v_cvt_f32_i32 v90, v90
    v_cvt_f32_i32 v91, v91
    v_fmac_f32_dpp v12, v6, v88 row_newbcast:2 row_mask:0xf bank_mask:0xf
    v_fmac_f32_dpp v13, v6, v89 row_newbcast:2 row_mask:0xf bank_mask:0xf
    v_fmac_f32_dpp v14, v6, v90 row_newbcast:2 row_mask:0xf bank_mask:0xf
    v_fmac_f32_dpp v15, v6, v91 row_newbcast:2 row_mask:0xf bank_mask:0xf
    v_cvt_f32_i32 v92, v92
    v_cvt_f32_i32 v93, v93
    v_cvt_f32_i32 v94, v94
    v_cvt_f32_i32 v95, v95
    v_fmac_f32_dpp v16, v6, v92 row_newbcast:2 row_mask:0xf bank_mask:0xf
    v_fmac_f32_dpp v17, v6, v93 row_newbcast:2 row_mask:0xf bank_mask:0xf
    v_fmac_f32_dpp v18, v6, v94 row_newbcast:2 row_mask:0xf bank_mask:0xf
    v_fmac_f32_dpp v19, v6, v95 row_newbcast:2 row_mask:0xf bank_mask:0xf
    v_cvt_f32_i32 v96, v96
    v_cvt_f32_i32 v97, v97
    v_cvt_f32_i32 v98, v98
    v_cvt_f32_i32 v99, v99
    v_fmac_f32_dpp v20, v6, v96 row_newbcast:2 row_mask:0xf bank_mask:0xf
    v_fmac_f32_dpp v21, v6, v97 row_newbcast:2 row_mask:0xf bank_mask:0xf
    v_fmac_f32_dpp v22, v6, v98 row_newbcast:2 row_mask:0xf bank_mask:0xf
    v_fmac_f32_dpp v23, v6, v99 row_newbcast:2 row_mask:0xf bank_mask:0xf
    v_cvt_f32_i32 v100, v100
    v_cvt_f32_i32 v101, v101
    v_cvt_f32_i32 v102, v102
    v_cvt_f32_i32 v103, v103
    v_fmac_f32_dpp v12, v6, v100 row_newbcast:3 row_mask:0xf bank_mask:0xf
    v_fmac_f32_dpp v13, v6, v101 row_newbcast:3 row_mask:0xf bank_mask:0xf
    v_fmac_f32_dpp v14, v6, v102 row_newbcast:3 row_mask:0xf bank_mask:0xf
    v_fmac_f32_dpp v15, v6, v103 row_newbcast:3 row_mask:0xf bank_mask:0xf
    v_cvt_f32_i32 v104, v104
    v_cvt_f32_i32 v105, v105
    v_cvt_f32_i32 v106, v106
    v_cvt_f32_i32 v107, v107
    v_fmac_f32_dpp v16, v6, v104 row_newbcast:3 row_mask:0xf bank_mask:0xf
    v_fmac_f32_dpp v17, v6, v105 row_newbcast:3 row_mask:0xf bank_mask:0xf
    v_fmac_f32_dpp v18, v6, v106 row_newbcast:3 row_mask:0xf bank_mask:0xf
    v_fmac_f32_dpp v19, v6, v107 row_newbcast:3 row_mask:0xf bank_mask:0xf
    v_cvt_f32_i32 v108, v108
    v_cvt_f32_i32 v109, v109
    v_cvt_f32_i32 v110, v110
    v_cvt_f32_i32 v111, v111
    v_fmac_f32_dpp v20, v6, v108 row_newbcast:3 row_mask:0xf bank_mask:0xf
    v_fmac_f32_dpp v21, v6, v109 row_newbcast:3 row_mask:0xf bank_mask:0xf
    v_fmac_f32_dpp v22, v6, v110 row_newbcast:3 row_mask:0xf bank_mask:0xf
    v_fmac_f32_dpp v23, v6, v111 row_newbcast:3 row_mask:0xf bank_mask:0xf
    buffer_load_dwordx4 v[88:91], v48, s[12:15], 0 offen offset:1536 nt
    buffer_load_dwordx4 v[92:95], v48, s[12:15], 0 offen offset:1792 nt
    buffer_load_dwordx4 v[96:99], v48, s[12:15], 0 offen offset:2048 nt
    buffer_load_dwordx4 v[100:103], v48, s[12:15], 0 offen offset:2304 nt
    buffer_load_dwordx4 v[104:107], v48, s[12:15], 0 offen offset:2560 nt
    buffer_load_dwordx4 v[108:111], v48, s[12:15], 0 offen offset:2816 nt
    s_waitcnt vmcnt(12)
    v_cvt_f32_i32 v112, v112
    v_cvt_f32_i32 v113, v113
    v_cvt_f32_i32 v114, v114
    v_cvt_f32_i32 v115, v115
    v_fmac_f32_dpp v12, v6, v112 row_newbcast:4 row_mask:0xf bank_mask:0xf
    v_fmac_f32_dpp v13, v6, v113 row_newbcast:4 row_mask:0xf bank_mask:0xf
    v_fmac_f32_dpp v14, v6, v114 row_newbcast:4 row_mask:0xf bank_mask:0xf
    v_fmac_f32_dpp v15, v6, v115 row_newbcast:4 row_mask:0xf bank_mask:0xf
    v_cvt_f32_i32 v116, v116
    v_cvt_f32_i32 v117, v117
    v_cvt_f32_i32 v118, v118
    v_cvt_f32_i32 v119, v119
    v_fmac_f32_dpp v16, v6, v116 row_newbcast:4 row_mask:0xf bank_mask:0xf
    v_fmac_f32_dpp v17, v6, v117 row_newbcast:4 row_mask:0xf bank_mask:0xf
    v_fmac_f32_dpp v18, v6, v118 row_newbcast:4 row_mask:0xf bank_mask:0xf
    v_fmac_f32_dpp v19, v6, v119 row_newbcast:4 row_mask:0xf bank_mask:0xf
    v_cvt_f32_i32 v120, v120
    v_cvt_f32_i32 v121, v121
    v_cvt_f32_i32 v122, v122
    v_cvt_f32_i32 v123, v123
    v_fmac_f32_dpp v20, v6, v120 row_newbcast:4 row_mask:0xf bank_mask:0xf
    v_fmac_f32_dpp v21, v6, v121 row_newbcast:4 row_mask:0xf bank_mask:0xf
    v_fmac_f32_dpp v22, v6, v122 row_newbcast:4 row_mask:0xf bank_mask:0xf
    v_fmac_f32_dpp v23, v6, v123 row_newbcast:4 row_mask:0xf bank_mask:0xf
    v_cvt_f32_i32 v124, v124
    v_cvt_f32_i32 v125, v125
    v_cvt_f32_i32 v126, v126
    v_cvt_f32_i32 v127, v127
    v_fmac_f32_dpp v12, v6, v124 row_newbcast:5 row_mask:0xf bank_mask:0xf
    v_fmac_f32_dpp v13, v6, v125 row_newbcast:5 row_mask:0xf bank_mask:0xf
    v_fmac_f32_dpp v14, v6, v126 row_newbcast:5 row_mask:0xf bank_mask:0xf
    v_fmac_f32_dpp v15, v6, v127 row_newbcast:5 row_mask:0xf bank_mask:0xf
    v_cvt_f32_i32 v128, v128
    v_cvt_f32_i32 v129, v129
    v_cvt_f32_i32 v130, v130
    v_cvt_f32_i32 v131, v131
    v_fmac_f32_dpp v16, v6, v128 row_newbcast:5 row_mask:0xf bank_mask:0xf
    v_fmac_f32_dpp v17, v6, v129 row_newbcast:5 row_mask:0xf bank_mask:0xf
    v_fmac_f32_dpp v18, v6, v130 row_newbcast:5 row_mask:0xf bank_mask:0xf
    v_fmac_f32_dpp v19, v6, v131 row_newbcast:5 row_mask:0xf bank_mask:0xf
    v_cvt_f32_i32 v132, v132
    v_cvt_f32_i32 v133, v133
    v_cvt_f32_i32 v134, v134
    v_cvt_f32_i32 v135, v135
    v_fmac_f32_dpp v20, v6, v132 row_newbcast:5 row_mask:0xf bank_mask:0xf
    v_fmac_f32_dpp v21, v6, v133 row_newbcast:5 row_mask:0xf bank_mask:0xf
    v_fmac_f32_dpp v22, v6, v134 row_newbcast:5 row_mask:0xf bank_mask:0xf
    v_fmac_f32_dpp v23, v6, v135 row_newbcast:5 row_mask:0xf bank_mask:0xf
    buffer_load_dwordx4 v[112:115], v48, s[12:15], 0 offen offset:3072 nt
    buffer_load_dwordx4 v[116:119], v48, s[12:15], 0 offen offset:3328 nt
    buffer_load_dwordx4 v[120:123], v48, s[12:15], 0 offen offset:3584 nt
    buffer_load_dwordx4 v[124:127], v49, s[12:15], 0 offen offset:0 nt
    buffer_load_dwordx4 v[128:131], v49, s[12:15], 0 offen offset:256 nt
    buffer_load_dwordx4 v[132:135], v49, s[12:15], 0 offen offset:512 nt
    s_waitcnt lgkmcnt(0)
    v_mov_b32 v6, v7
    s_cmp_lg_u32 s30, 48
    s_cbranch_scc1 L_dloop
    s_branch L_vend
L_kboost:
    s_nop 1
    s_cmp_eq_u32 s30, 47
    s_cbranch_scc1 L_kchk2
    buffer_load_dwordx4 v[88:91], v48, s[8:11], 0 offen offset:1536 nt
    buffer_load_dwordx4 v[92:95], v48, s[8:11], 0 offen offset:1792 nt
    buffer_load_dwordx4 v[96:99], v48, s[8:11], 0 offen offset:2048 nt
    buffer_load_dwordx4 v[100:103], v48, s[8:11], 0 offen offset:2304 nt
    buffer_load_dwordx4 v[104:107], v48, s[8:11], 0 offen offset:2560 nt
    buffer_load_dwordx4 v[108:111], v48, s[8:11], 0 offen offset:2816 nt
    buffer_load_dwordx4 v[112:115], v48, s[8:11], 0 offen offset:3072 nt
    buffer_load_dwordx4 v[116:119], v48, s[8:11], 0 offen offset:3328 nt
    buffer_load_dwordx4 v[120:123], v48, s[8:11], 0 offen offset:3584 nt
    buffer_load_dwordx4 v[124:127], v49, s[8:11], 0 offen offset:0 nt
    buffer_load_dwordx4 v[128:131], v49, s[8:11], 0 offen offset:256 nt
    buffer_load_dwordx4 v[132:135], v49, s[8:11], 0 offen offset:512 nt
    s_sub_u32 s59, s59, 1
    s_add_u32 s29, s29, 4
    s_add_u32 s30, s30, 1
    s_bitcmp1_b64 s[40:41], s30
    s_cbranch_scc1 L_evKB
L_evretKB:
    s_nop 1
    s_lshr_b32 s33, s29, 6
    s_lshl_b32 s33, s33, 11
    s_and_b32 s32, s29, 63
    s_add_u32 s32, s32, s33
    s_add_u32 s32, s32, s44
    s_bfe_u32 s33, s32, 0x20003
    s_and_b32 s34, s32, 4
    s_or_b32 s33, s33, s34
    s_xor_b32 s33, s33, s5
    s_lshl_b32 s50, s32, 5
    s_or_b32 s50, s50, s33
    s_lshl_b32 s50, s50, 4
    s_or_b32 s50, s50, 1
    v_xor_b32 v10, s50, v50
    v_mul_hi_u32 v10, v10, s47
    v_lshrrev_b32 v10, 1, v10
    v_and_b32 v11, 15, v10
    v_cmp_eq_u32 vcc, 5, v11
    v_mad_u32_u24 v48, v10, s45, v2
    v_add_u32 v11, 3840, v48
    v_cndmask_b32 v49, v51, v11, vcc
    v_lshrrev_b32 v10, 6, v10
    v_mad_u32_u24 v9, v10, s46, v3
    buffer_load_dwordx2 v[42:43], v9, s[16:19], 0 offen offset:0
    buffer_load_dwordx2 v[44:45], v9, s[16:19], 0 offen offset:128
    buffer_load_dwordx2 v[46:47], v9, s[16:19], 0 offen offset:256
    s_waitcnt vmcnt(15)
    v_cvt_f32_i32 v64, v64
    v_cvt_f32_i32 v65, v65
    v_cvt_f32_i32 v66, v66
    v_cvt_f32_i32 v67, v67
    v_mul_f32 v54, v64, v24
    v_fmac_f32 v54, v65, v25
    v_fmac_f32 v54, v66, v26
    v_fmac_f32 v54, v67, v27
    v_cvt_f32_i32 v68, v68
    v_cvt_f32_i32 v69, v69
    v_cvt_f32_i32 v70, v70
    v_cvt_f32_i32 v71, v71
    v_fmac_f32 v54, v68, v28
    v_fmac_f32 v54, v69, v29
    v_fmac_f32 v54, v70, v30
    v_fmac_f32 v54, v71, v31
    v_cvt_f32_i32 v72, v72
    v_cvt_f32_i32 v73, v73
    v_cvt_f32_i32 v74, v74
    v_cvt_f32_i32 v75, v75
    v_fmac_f32 v54, v72, v32
    v_fmac_f32 v54, v73, v33
    v_fmac_f32 v54, v74, v34
    v_fmac_f32 v54, v75, v35
    v_cvt_f32_i32 v76, v76
    v_cvt_f32_i32 v77, v77
    v_add_f32_dpp v54, v54, v54 row_ror:8 row_mask:0xf bank_mask:0xf
    v_cvt_f32_i32 v78, v78
    v_cvt_f32_i32 v79, v79
    v_add_f32_dpp v54, v54, v54 row_ror:4 row_mask:0xf bank_mask:0xf
    v_mul_f32 v55, v76, v24
    v_fmac_f32 v55, v77, v25
    v_add_f32_dpp v54, v54, v54 row_ror:2 row_mask:0xf bank_mask:0xf
    v_fmac_f32 v55, v78, v26
    v_fmac_f32 v55, v79, v27
    v_add_f32_dpp v60, v54, v54 row_ror:1 row_mask:0xf bank_mask:0x1
    v_cvt_f32_i32 v80, v80
    v_cvt_f32_i32 v81, v81
    v_cvt_f32_i32 v82, v82
    v_cvt_f32_i32 v83, v83
    v_fmac_f32 v55, v80, v28
    v_fmac_f32 v55, v81, v29
    v_fmac_f32 v55, v82, v30
    v_fmac_f32 v55, v83, v31
    v_cvt_f32_i32 v84, v84
    v_cvt_f32_i32 v85, v85
    v_cvt_f32_i32 v86, v86
    v_cvt_f32_i32 v87, v87
    v_fmac_f32 v55, v84, v32
    v_fmac_f32 v55, v85, v33
    v_fmac_f32 v55, v86, v34
    v_fmac_f32 v55, v87, v35
    s_nop 1
    v_add_f32_dpp v55, v55, v55 row_ror:8 row_mask:0xf bank_mask:0xf
    s_nop 1
    v_add_f32_dpp v55, v55, v55 row_ror:4 row_mask:0xf bank_mask:0xf
    s_nop 1
    v_add_f32_dpp v55, v55, v55 row_ror:2 row_mask:0xf bank_mask:0xf
    s_nop 1
    v_add_f32_dpp v61, v55, v55 row_ror:1 row_mask:0xf bank_mask:0x1
    buffer_load_dwordx4 v[64:67], v48, s[8:11], 0 offen offset:0 nt
    buffer_load_dwordx4 v[68:71], v48, s[8:11], 0 offen offset:256 nt
    buffer_load_dwordx4 v[72:75], v48, s[8:11], 0 offen offset:512 nt
    buffer_load_dwordx4 v[76:79], v48, s[8:11], 0 offen offset:768 nt
    buffer_load_dwordx4 v[80:83], v48, s[8:11], 0 offen offset:1024 nt
    buffer_load_dwordx4 v[84:87], v48, s[8:11], 0 offen offset:1280 nt
    s_waitcnt vmcnt(15)
    v_cvt_f32_i32 v88, v88
    v_cvt_f32_i32 v89, v89
    v_cvt_f32_i32 v90, v90
    v_cvt_f32_i32 v91, v91
    v_mul_f32 v56, v88, v24
    v_fmac_f32 v56, v89, v25
    v_fmac_f32 v56, v90, v26
    v_fmac_f32 v56, v91, v27
    v_cvt_f32_i32 v92, v92
    v_cvt_f32_i32 v93, v93
    v_cvt_f32_i32 v94, v94
    v_cvt_f32_i32 v95, v95
    v_fmac_f32 v56, v92, v28
    v_fmac_f32 v56, v93, v29
    v_fmac_f32 v56, v94, v30
    v_fmac_f32 v56, v95, v31
    v_cvt_f32_i32 v96, v96
    v_cvt_f32_i32 v97, v97
    v_cvt_f32_i32 v98, v98
    v_cvt_f32_i32 v99, v99
    v_fmac_f32 v56, v96, v32
    v_fmac_f32 v56, v97, v33
    v_fmac_f32 v56, v98, v34
    v_fmac_f32 v56, v99, v35
    v_cvt_f32_i32 v100, v100
    v_cvt_f32_i32 v101, v101
    v_add_f32_dpp v56, v56, v56 row_ror:8 row_mask:0xf bank_mask:0xf
    v_cvt_f32_i32 v102, v102
    v_cvt_f32_i32 v103, v103
    v_add_f32_dpp v56, v56, v56 row_ror:4 row_mask:0xf bank_mask:0xf
    v_mul_f32 v57, v100, v24
    v_fmac_f32 v57, v101, v25
    v_add_f32_dpp v56, v56, v56 row_ror:2 row_mask:0xf bank_mask:0xf
    v_fmac_f32 v57, v102, v26
    v_fmac_f32 v57, v103, v27
    v_add_f32_dpp v60, v56, v56 row_ror:1 row_mask:0xf bank_mask:0x2
    v_cvt_f32_i32 v104, v104
    v_cvt_f32_i32 v105, v105
    v_cvt_f32_i32 v106, v106
    v_cvt_f32_i32 v107, v107
    v_fmac_f32 v57, v104, v28
    v_fmac_f32 v57, v105, v29
    v_fmac_f32 v57, v106, v30
    v_fmac_f32 v57, v107, v31
    v_cvt_f32_i32 v108, v108
    v_cvt_f32_i32 v109, v109
    v_cvt_f32_i32 v110, v110
    v_cvt_f32_i32 v111, v111
    v_fmac_f32 v57, v108, v32
    v_fmac_f32 v57, v109, v33
    v_fmac_f32 v57, v110, v34
    v_fmac_f32 v57, v111, v35
    s_nop 1
    v_add_f32_dpp v57, v57, v57 row_ror:8 row_mask:0xf bank_mask:0xf
    s_nop 1
    v_add_f32_dpp v57, v57, v57 row_ror:4 row_mask:0xf bank_mask:0xf
    s_nop 1
    v_add_f32_dpp v57, v57, v57 row_ror:2 row_mask:0xf bank_mask:0xf
    s_nop 1
    v_add_f32_dpp v61, v57, v57 row_ror:1 row_mask:0xf bank_mask:0x2
    s_waitcnt vmcnt(9)
    v_cvt_f32_i32 v112, v112
    v_cvt_f32_i32 v113, v113
    v_cvt_f32_i32 v114, v114
    v_cvt_f32_i32 v115, v115
    v_mul_f32 v58, v112, v24
    v_fmac_f32 v58, v113, v25
    v_fmac_f32 v58, v114, v26
    v_fmac_f32 v58, v115, v27
    v_cvt_f32_i32 v116, v116
    v_cvt_f32_i32 v117, v117
    v_cvt_f32_i32 v118, v118
    v_cvt_f32_i32 v119, v119
    v_fmac_f32 v58, v116, v28
    v_fmac_f32 v58, v117, v29
    v_fmac_f32 v58, v118, v30
    v_fmac_f32 v58, v119, v31
    v_cvt_f32_i32 v120, v120
    v_cvt_f32_i32 v121, v121
    v_cvt_f32_i32 v122, v122
    v_cvt_f32_i32 v123, v123
    v_fmac_f32 v58, v120, v32
    v_fmac_f32 v58, v121, v33
    v_fmac_f32 v58, v122, v34
    v_fmac_f32 v58, v123, v35
    v_cvt_f32_i32 v124, v124
    v_cvt_f32_i32 v125, v125
    v_add_f32_dpp v58, v58, v58 row_ror:8 row_mask:0xf bank_mask:0xf
    v_cvt_f32_i32 v126, v126
    v_cvt_f32_i32 v127, v127
    v_add_f32_dpp v58, v58, v58 row_ror:4 row_mask:0xf bank_mask:0xf
    v_mul_f32 v59, v124, v24
    v_fmac_f32 v59, v125, v25
    v_add_f32_dpp v58, v58, v58 row_ror:2 row_mask:0xf bank_mask:0xf
    v_fmac_f32 v59, v126, v26
    v_fmac_f32 v59, v127, v27
    v_add_f32_dpp v60, v58, v58 row_ror:1 row_mask:0xf bank_mask:0x4
    v_cvt_f32_i32 v128, v128
    v_cvt_f32_i32 v129, v129
    v_cvt_f32_i32 v130, v130
    v_cvt_f32_i32 v131, v131
    v_fmac_f32 v59, v128, v28
    v_fmac_f32 v59, v129, v29
    v_fmac_f32 v59, v130, v30
    v_fmac_f32 v59, v131, v31
    v_cvt_f32_i32 v132, v132
    v_cvt_f32_i32 v133, v133
    v_cvt_f32_i32 v134, v134
    v_cvt_f32_i32 v135, v135
    v_fmac_f32 v59, v132, v32
    v_fmac_f32 v59, v133, v33
    v_fmac_f32 v59, v134, v34
    v_fmac_f32 v59, v135, v35
    s_nop 1
    v_add_f32_dpp v59, v59, v59 row_ror:8 row_mask:0xf bank_mask:0xf
    s_nop 1
    v_add_f32_dpp v59, v59, v59 row_ror:4 row_mask:0xf bank_mask:0xf
    s_nop 1
    v_add_f32_dpp v59, v59, v59 row_ror:2 row_mask:0xf bank_mask:0xf
    s_nop 1
    v_add_f32_dpp v61, v59, v59 row_ror:1 row_mask:0xf bank_mask:0x4
    s_mov_b64 exec, s[42:43]
    ds_write_b64 v4, v[60:61]
    s_mov_b64 exec, -1
    v_add_u32 v4, 48, v4
    s_waitcnt vmcnt(6)
    v_lshlrev_b32 v10, 16, v36
    v_lshlrev_b32 v24, 16, v42
    v_and_b32 v11, 0xffff0000, v36
    v_and_b32 v25, 0xffff0000, v42
    v_mul_f32 v24, v24, v10
    v_mul_f32 v25, v25, v11
    v_lshlrev_b32 v10, 16, v37
    v_lshlrev_b32 v26, 16, v43
    v_and_b32 v11, 0xffff0000, v37
    v_and_b32 v27, 0xffff0000, v43
    v_mul_f32 v26, v26, v10
    v_mul_f32 v27, v27, v11
    v_lshlrev_b32 v10, 16, v38
    v_lshlrev_b32 v28, 16, v44
    v_and_b32 v11, 0xffff0000, v38
    v_and_b32 v29, 0xffff0000, v44
    v_mul_f32 v28, v28, v10
    v_mul_f32 v29, v29, v11
    v_lshlrev_b32 v10, 16, v39
    v_lshlrev_b32 v30, 16, v45
    v_and_b32 v11, 0xffff0000, v39
    v_and_b32 v31, 0xffff0000, v45
    v_mul_f32 v30, v30, v10
    v_mul_f32 v31, v31, v11
    v_lshlrev_b32 v10, 16, v40
    v_lshlrev_b32 v32, 16, v46
    v_and_b32 v11, 0xffff0000, v40
    v_and_b32 v33, 0xffff0000, v46
    v_mul_f32 v32, v32, v10
    v_mul_f32 v33, v33, v11
    v_lshlrev_b32 v10, 16, v41
    v_lshlrev_b32 v34, 16, v47
    v_and_b32 v11, 0xffff0000, v41
    v_and_b32 v35, 0xffff0000, v47
    v_mul_f32 v34, v34, v10
    v_mul_f32 v35, v35, v11
    s_branch L_kchk
L_vboost:
    s_nop 1
    s_and_b32 s32, s30, 15
    s_cbranch_scc0 L_vend
L_vboost2:
    s_nop 1
    s_cmp_eq_u32 s30, 48
    s_cbranch_scc1 L_vend2
    buffer_load_dwordx4 v[88:91], v48, s[12:15], 0 offen offset:1536 nt
    buffer_load_dwordx4 v[92:95], v48, s[12:15], 0 offen offset:1792 nt
    buffer_load_dwordx4 v[96:99], v48, s[12:15], 0 offen offset:2048 nt
    buffer_load_dwordx4 v[100:103], v48, s[12:15], 0 offen offset:2304 nt
    buffer_load_dwordx4 v[104:107], v48, s[12:15], 0 offen offset:2560 nt
    buffer_load_dwordx4 v[108:111], v48, s[12:15], 0 offen offset:2816 nt
    buffer_load_dwordx4 v[112:115], v48, s[12:15], 0 offen offset:3072 nt
    buffer_load_dwordx4 v[116:119], v48, s[12:15], 0 offen offset:3328 nt
    buffer_load_dwordx4 v[120:123], v48, s[12:15], 0 offen offset:3584 nt
    buffer_load_dwordx4 v[124:127], v49, s[12:15], 0 offen offset:0 nt
    buffer_load_dwordx4 v[128:131], v49, s[12:15], 0 offen offset:256 nt
    buffer_load_dwordx4 v[132:135], v49, s[12:15], 0 offen offset:512 nt
    s_sub_u32 s59, s59, 1
    s_add_u32 s29, s29, 4
    s_add_u32 s30, s30, 1
    s_bitcmp1_b64 s[40:41], s30
    s_cbranch_scc1 L_evVB
L_evretVB:
    s_nop 1
    s_lshr_b32 s33, s29, 6
    s_lshl_b32 s33, s33, 11
    s_and_b32 s32, s29, 63
    s_add_u32 s32, s32, s33
    s_add_u32 s32, s32, s44
    s_bfe_u32 s33, s32, 0x20003
    s_and_b32 s34, s32, 4
    s_or_b32 s33, s33, s34
    s_xor_b32 s33, s33, s5
    s_lshl_b32 s50, s32, 5
    s_or_b32 s50, s50, s33
    s_lshl_b32 s50, s50, 4
    s_or_b32 s50, s50, 1
    s_lshl_b32 s53, s29, 7
    v_xor_b32 v10, s50, v50
    v_mul_hi_u32 v10, v10, s47
    v_lshrrev_b32 v10, 1, v10
    v_and_b32 v11, 15, v10
    v_cmp_eq_u32 vcc, 5, v11
    v_mad_u32_u24 v48, v10, s45, v2
    v_add_u32 v11, 3840, v48
    v_cndmask_b32 v49, v51, v11, vcc
    v_add_u32 v10, s53, v5
    ds_read_b32 v7, v10
    s_waitcnt vmcnt(12)
    v_cvt_f32_i32 v64, v64
    v_cvt_f32_i32 v65, v65
    v_cvt_f32_i32 v66, v66
    v_cvt_f32_i32 v67, v67
    v_fmac_f32_dpp v12, v6, v64 row_newbcast:0 row_mask:0xf bank_mask:0xf
    v_fmac_f32_dpp v13, v6, v65 row_newbcast:0 row_mask:0xf bank_mask:0xf
    v_fmac_f32_dpp v14, v6, v66 row_newbcast:0 row_mask:0xf bank_mask:0xf
    v_fmac_f32_dpp v15, v6, v67 row_newbcast:0 row_mask:0xf bank_mask:0xf
    v_cvt_f32_i32 v68, v68
    v_cvt_f32_i32 v69, v69
    v_cvt_f32_i32 v70, v70
    v_cvt_f32_i32 v71, v71
    v_fmac_f32_dpp v16, v6, v68 row_newbcast:0 row_mask:0xf bank_mask:0xf
    v_fmac_f32_dpp v17, v6, v69 row_newbcast:0 row_mask:0xf bank_mask:0xf
    v_fmac_f32_dpp v18, v6, v70 row_newbcast:0 row_mask:0xf bank_mask:0xf
    v_fmac_f32_dpp v19, v6, v71 row_newbcast:0 row_mask:0xf bank_mask:0xf
    v_cvt_f32_i32 v72, v72
    v_cvt_f32_i32 v73, v73
    v_cvt_f32_i32 v74, v74
    v_cvt_f32_i32 v75, v75
    v_fmac_f32_dpp v20, v6, v72 row_newbcast:0 row_mask:0xf bank_mask:0xf
    v_fmac_f32_dpp v21, v6, v73 row_newbcast:0 row_mask:0xf bank_mask:0xf
    v_fmac_f32_dpp v22, v6, v74 row_newbcast:0 row_mask:0xf bank_mask:0xf
    v_fmac_f32_dpp v23, v6, v75 row_newbcast:0 row_mask:0xf bank_mask:0xf
    v_cvt_f32_i32 v76, v76
    v_cvt_f32_i32 v77, v77
    v_cvt_f32_i32 v78, v78
    v_cvt_f32_i32 v79, v79
    v_fmac_f32_dpp v12, v6, v76 row_newbcast:1 row_mask:0xf bank_mask:0xf
    v_fmac_f32_dpp v13, v6, v77 row_newbcast:1 row_mask:0xf bank_mask:0xf
    v_fmac_f32_dpp v14, v6, v78 row_newbcast:1 row_mask:0xf bank_mask:0xf
    v_fmac_f32_dpp v15, v6, v79 row_newbcast:1 row_mask:0xf bank_mask:0xf
    v_cvt_f32_i32 v80, v80
    v_cvt_f32_i32 v81, v81
    v_cvt_f32_i32 v82, v82
    v_cvt_f32_i32 v83, v83
    v_fmac_f32_dpp v16, v6, v80 row_newbcast:1 row_mask:0xf bank_mask:0xf
    v_fmac_f32_dpp v17, v6, v81 row_newbcast:1 row_mask:0xf bank_mask:0xf
    v_fmac_f32_dpp v18, v6, v82 row_newbcast:1 row_mask:0xf bank_mask:0xf
    v_fmac_f32_dpp v19, v6, v83 row_newbcast:1 row_mask:0xf bank_mask:0xf
    v_cvt_f32_i32 v84, v84
    v_cvt_f32_i32 v85, v85
    v_cvt_f32_i32 v86, v86
    v_cvt_f32_i32 v87, v87
    v_fmac_f32_dpp v20, v6, v84 row_newbcast:1 row_mask:0xf bank_mask:0xf
    v_fmac_f32_dpp v21, v6, v85 row_newbcast:1 row_mask:0xf bank_mask:0xf
    v_fmac_f32_dpp v22, v6, v86 row_newbcast:1 row_mask:0xf bank_mask:0xf
    v_fmac_f32_dpp v23, v6, v87 row_newbcast:1 row_mask:0xf bank_mask:0xf
    buffer_load_dwordx4 v[64:67], v48, s[12:15], 0 offen offset:0 nt
    buffer_load_dwordx4 v[68:71], v48, s[12:15], 0 offen offset:256 nt
    buffer_load_dwordx4 v[72:75], v48, s[12:15], 0 offen offset:512 nt
    buffer_load_dwordx4 v[76:79], v48, s[12:15], 0 offen offset:768 nt
    buffer_load_dwordx4 v[80:83], v48, s[12:15], 0 offen offset:1024 nt
    buffer_load_dwordx4 v[84:87], v48, s[12:15], 0 offen offset:1280 nt
    s_waitcnt vmcnt(12)
    s_cmp_eq_u32 s30, 48
    s_cbranch_scc1 L_el2
L_el2r:
    v_cvt_f32_i32 v88, v88
    v_cvt_f32_i32 v89, v89
    v_cvt_f32_i32 v90, v90
    v_cvt_f32_i32 v91, v91
    v_fmac_f32_dpp v12, v6, v88 row_newbcast:2 row_mask:0xf bank_mask:0xf
    v_fmac_f32_dpp v13, v6, v89 row_newbcast:2 row_mask:0xf bank_mask:0xf
    v_fmac_f32_dpp v14, v6, v90 row_newbcast:2 row_mask:0xf bank_mask:0xf
    v_fmac_f32_dpp v15, v6, v91 row_newbcast:2 row_mask:0xf bank_mask:0xf
    v_cvt_f32_i32 v92, v92
    v_cvt_f32_i32 v93, v93
    v_cvt_f32_i32 v94, v94
    v_cvt_f32_i32 v95, v95
    v_fmac_f32_dpp v16, v6, v92 row_newbcast:2 row_mask:0xf bank_mask:0xf
    v_fmac_f32_dpp v17, v6, v93 row_newbcast:2 row_mask:0xf bank_mask:0xf
    v_fmac_f32_dpp v18, v6, v94 row_newbcast:2 row_mask:0xf bank_mask:0xf
    v_fmac_f32_dpp v19, v6, v95 row_newbcast:2 row_mask:0xf bank_mask:0xf
    v_cvt_f32_i32 v96, v96
    v_cvt_f32_i32 v97, v97
    v_cvt_f32_i32 v98, v98
    v_cvt_f32_i32 v99, v99
    v_fmac_f32_dpp v20, v6, v96 row_newbcast:2 row_mask:0xf bank_mask:0xf
    v_fmac_f32_dpp v21, v6, v97 row_newbcast:2 row_mask:0xf bank_mask:0xf
    v_fmac_f32_dpp v22, v6, v98 row_newbcast:2 row_mask:0xf bank_mask:0xf
    v_fmac_f32_dpp v23, v6, v99 row_newbcast:2 row_mask:0xf bank_mask:0xf
    v_cvt_f32_i32 v100, v100
    v_cvt_f32_i32 v101, v101
    v_cvt_f32_i32 v102, v102
    v_cvt_f32_i32 v103, v103
    v_fmac_f32_dpp v12, v6, v100 row_newbcast:3 row_mask:0xf bank_mask:0xf
    v_fmac_f32_dpp v13, v6, v101 row_newbcast:3 row_mask:0xf bank_mask:0xf
    v_fmac_f32_dpp v14, v6, v102 row_newbcast:3 row_mask:0xf bank_mask:0xf
    v_fmac_f32_dpp v15, v6, v103 row_newbcast:3 row_mask:0xf bank_mask:0xf
    v_cvt_f32_i32 v104, v104
    v_cvt_f32_i32 v105, v105
    v_cvt_f32_i32 v106, v106
    v_cvt_f32_i32 v107, v107
    v_fmac_f32_dpp v16, v6, v104 row_newbcast:3 row_mask:0xf bank_mask:0xf
    v_fmac_f32_dpp v17, v6, v105 row_newbcast:3 row_mask:0xf bank_mask:0xf
    v_fmac_f32_dpp v18, v6, v106 row_newbcast:3 row_mask:0xf bank_mask:0xf
    v_fmac_f32_dpp v19, v6, v107 row_newbcast:3 row_mask:0xf bank_mask:0xf
    v_cvt_f32_i32 v108, v108
    v_cvt_f32_i32 v109, v109
    v_cvt_f32_i32 v110, v110
    v_cvt_f32_i32 v111, v111
    v_fmac_f32_dpp v20, v6, v108 row_newbcast:3 row_mask:0xf bank_mask:0xf
    v_fmac_f32_dpp v21, v6, v109 row_newbcast:3 row_mask:0xf bank_mask:0xf
    v_fmac_f32_dpp v22, v6, v110 row_newbcast:3 row_mask:0xf bank_mask:0xf
    v_fmac_f32_dpp v23, v6, v111 row_newbcast:3 row_mask:0xf bank_mask:0xf
    s_waitcnt vmcnt(6)
    v_cvt_f32_i32 v112, v112
    v_cvt_f32_i32 v113, v113
    v_cvt_f32_i32 v114, v114
    v_cvt_f32_i32 v115, v115
    v_fmac_f32_dpp v12, v6, v112 row_newbcast:4 row_mask:0xf bank_mask:0xf
    v_fmac_f32_dpp v13, v6, v113 row_newbcast:4 row_mask:0xf bank_mask:0xf
    v_fmac_f32_dpp v14, v6, v114 row_newbcast:4 row_mask:0xf bank_mask:0xf
    v_fmac_f32_dpp v15, v6, v115 row_newbcast:4 row_mask:0xf bank_mask:0xf
    v_cvt_f32_i32 v116, v116
    v_cvt_f32_i32 v117, v117
    v_cvt_f32_i32 v118, v118
    v_cvt_f32_i32 v119, v119
    v_fmac_f32_dpp v16, v6, v116 row_newbcast:4 row_mask:0xf bank_mask:0xf
    v_fmac_f32_dpp v17, v6, v117 row_newbcast:4 row_mask:0xf bank_mask:0xf
    v_fmac_f32_dpp v18, v6, v118 row_newbcast:4 row_mask:0xf bank_mask:0xf
    v_fmac_f32_dpp v19, v6, v119 row_newbcast:4 row_mask:0xf bank_mask:0xf
    v_cvt_f32_i32 v120, v120
    v_cvt_f32_i32 v121, v121
    v_cvt_f32_i32 v122, v122
    v_cvt_f32_i32 v123, v123
    v_fmac_f32_dpp v20, v6, v120 row_newbcast:4 row_mask:0xf bank_mask:0xf
    v_fmac_f32_dpp v21, v6, v121 row_newbcast:4 row_mask:0xf bank_mask:0xf
    v_fmac_f32_dpp v22, v6, v122 row_newbcast:4 row_mask:0xf bank_mask:0xf
    v_fmac_f32_dpp v23, v6, v123 row_newbcast:4 row_mask:0xf bank_mask:0xf
    v_cvt_f32_i32 v124, v124
    v_cvt_f32_i32 v125, v125
    v_cvt_f32_i32 v126, v126
    v_cvt_f32_i32 v127, v127
    v_fmac_f32_dpp v12, v6, v124 row_newbcast:5 row_mask:0xf bank_mask:0xf
    v_fmac_f32_dpp v13, v6, v125 row_newbcast:5 row_mask:0xf bank_mask:0xf
    v_fmac_f32_dpp v14, v6, v126 row_newbcast:5 row_mask:0xf bank_mask:0xf
    v_fmac_f32_dpp v15, v6, v127 row_newbcast:5 row_mask:0xf bank_mask:0xf
    v_cvt_f32_i32 v128, v128
    v_cvt_f32_i32 v129, v129
    v_cvt_f32_i32 v130, v130
    v_cvt_f32_i32 v131, v131
    v_fmac_f32_dpp v16, v6, v128 row_newbcast:5 row_mask:0xf bank_mask:0xf
    v_fmac_f32_dpp v17, v6, v129 row_newbcast:5 row_mask:0xf bank_mask:0xf
    v_fmac_f32_dpp v18, v6, v130 row_newbcast:5 row_mask:0xf bank_mask:0xf
    v_fmac_f32_dpp v19, v6, v131 row_newbcast:5 row_mask:0xf bank_mask:0xf
    v_cvt_f32_i32 v132, v132
    v_cvt_f32_i32 v133, v133
    v_cvt_f32_i32 v134, v134
    v_cvt_f32_i32 v135, v135
    v_fmac_f32_dpp v20, v6, v132 row_newbcast:5 row_mask:0xf bank_mask:0xf
    v_fmac_f32_dpp v21, v6, v133 row_newbcast:5 row_mask:0xf bank_mask:0xf
    v_fmac_f32_dpp v22, v6, v134 row_newbcast:5 row_mask:0xf bank_mask:0xf
    v_fmac_f32_dpp v23, v6, v135 row_newbcast:5 row_mask:0xf bank_mask:0xf
    s_waitcnt lgkmcnt(0)
    v_mov_b32 v6, v7
    s_branch L_vchk
L_el0:
    s_nop 1
    v_mov_b32 v11, 1
    s_mov_b64 exec, 1
    ds_add_u32 v53, v11 offset:136
    s_mov_b64 exec, -1
    s_branch L_el0r
L_el1:
    s_nop 1
    v_mov_b32 v11, 1
    s_mov_b64 exec, 1
    ds_add_u32 v53, v11 offset:136
    s_mov_b64 exec, -1
    s_branch L_el1r
L_el2:
    s_nop 1
    v_mov_b32 v11, 1
    s_mov_b64 exec, 1
    ds_add_u32 v53, v11 offset:136
    s_mov_b64 exec, -1
    s_branch L_el2r
L_evK:
    s_nop 1
    s_bitcmp1_b64 s[64:65], s30
    s_cbranch_scc0 L_paK
    s_memrealtime s[60:61]
    s_mov_b32 s72, s59
    v_mov_b32 v11, 1
    s_mov_b64 exec, 1
    ds_add_u32 v53, v11 offset:128
    s_mov_b64 exec, -1
L_paK:
    s_nop 1
    s_bitcmp1_b64 s[66:67], s30
    s_cbranch_scc0 L_pbK
    v_mov_b32 v11, 1
    s_mov_b64 exec, 1
    ds_add_u32 v53, v11 offset:128
    s_mov_b64 exec, -1
L_pbK:
    s_nop 1
    s_bitcmp1_b64 s[68:69], s30
    s_cbranch_scc0 L_pcK
    v_mov_b32 v11, s62
    ds_read_b32 v10, v11
    v_mov_b32 v11, 1
    s_mov_b64 exec, 1
    ds_add_u32 v53, v11 offset:128
    s_mov_b64 exec, -1
    s_add_u32 s62, s62, 4
    s_waitcnt lgkmcnt(0)
    v_readfirstlane_b32 s32, v10
    s_cmp_eq_u32 s32, 0
    s_cbranch_scc1 L_pcK
    s_sub_u32 s32, s60, s32
    s_max_i32 s32, s32, -4096
    s_min_i32 s32, s32, 4096
    s_mul_i32 s32, s32, 8
    s_add_u32 s32, s32, 512
    s_ashr_i32 s32, s32, 10
    s_sub_u32 s32, s32, s72
    s_add_u32 s32, s32, s59
    s_max_i32 s32, s32, 0
    s_min_i32 s59, s32, 6
L_pcK:
    s_nop 1
    s_bitcmp1_b64 s[70:71], s30
    s_cbranch_scc0 L_evretK
    s_and_b32 s32, s30, 15
    s_cbranch_scc0 L_evK2
    s_cmp_eq_u32 s30, 3
    s_cbranch_scc1 L_evK2
    s_lshr_b32 s33, s30, 2
    s_andn2_b32 s33, s33, 3
    s_add_u32 s33, s33, 36
    s_cmp_eq_u32 s32, 1
    s_cselect_b32 s32, s33, 60
    s_cselect_b32 s33, 5376, 0
    v_add_u32 v4, s33, v4
    s_cmp_eq_u32 s30, 2
    s_cselect_b32 s32, 56, s32
    v_mov_b32 v10, s32
    v_mov_b32 v11, 1
    s_mov_b64 exec, 1
    ds_add_u32 v10, v11 offset:0
    s_mov_b64 exec, -1
    s_branch L_evretK
L_evK2:
    s_nop 1
    s_cmp_eq_u32 s30, 16
    s_cbranch_scc0 L_gxtk16
    s_memrealtime s[36:37]
    s_mov_b32 s6, 0x100000
L_wgtk16:
    s_nop 1
    ds_read_b32 v10, v53 offset:208
    s_sub_u32 s6, s6, 1
    s_cbranch_scc1 L_exit1
    s_waitcnt lgkmcnt(0)
    v_readfirstlane_b32 s32, v10
    s_cmp_eq_u32 s32, 0
    s_cbranch_scc1 L_wgtk16
    s_and_b32 s32, s32, 0xffff
    s_cbranch_scc0 L_gxtk16
    s_add_u32 s32, s32, s36
L_gltk16:
    s_nop 1
    s_memrealtime s[36:37]
    s_waitcnt lgkmcnt(0)
    s_sub_u32 s36, s36, s32
    s_cmp_lt_i32 s36, 0
    s_cbranch_scc1 L_gltk16
L_gxtk16:
    s_nop 1
    s_cmp_eq_u32 s30, 32
    s_cbranch_scc0 L_gxtk32
    s_memrealtime s[36:37]
    s_mov_b32 s6, 0x100000
L_wgtk32:
    s_nop 1
    ds_read_b32 v10, v53 offset:212
    s_sub_u32 s6, s6, 1
    s_cbranch_scc1 L_exit1
    s_waitcnt lgkmcnt(0)
    v_readfirstlane_b32 s32, v10
    s_cmp_eq_u32 s32, 0
    s_cbranch_scc1 L_wgtk32
    s_and_b32 s32, s32, 0xffff
    s_cbranch_scc0 L_gxtk32
    s_add_u32 s32, s32, s36
L_gltk32:
    s_nop 1
    s_memrealtime s[36:37]
    s_waitcnt lgkmcnt(0)
    s_sub_u32 s36, s36, s32
    s_cmp_lt_i32 s36, 0
    s_cbranch_scc1 L_gltk32
L_gxtk32:
    s_nop 1
    s_lshr_b32 s33, s30, 4
    s_lshl_b32 s34, s33, 2
    v_mov_b32 v11, s34
    s_lshl_b32 s31, s33, 5
    s_add_u32 s31, s31, s3
    s_mul_i32 s31, s31, 171
    s_lshr_b32 s31, s31, 9
    s_mul_i32 s31, s31, 384
    buffer_load_dwordx2 v[36:37], v3, s[20:23], s31 offen offset:0
    buffer_load_dwordx2 v[38:39], v3, s[20:23], s31 offen offset:128
    buffer_load_dwordx2 v[40:41], v3, s[20:23], s31 offen offset:256
    s_mov_b32 s6, 0x100000
L_wtk:
    s_nop 1
    ds_read_b32 v10, v11 offset:0
    s_sub_u32 s6, s6, 1
    s_cbranch_scc1 L_exit1
    s_waitcnt lgkmcnt(0)
    v_readfirstlane_b32 s32, v10
    s_cmp_eq_u32 s32, 0
    s_cbranch_scc1 L_wtk
    s_and_b32 s5, s32, 7
    s_xor_b32 s5, s5, s48
    s_bitcmp1_b32 s32, 3
    s_cselect_b64 vcc, -1, 0
    v_cndmask_b32 v50, v62, v63, vcc
    s_branch L_evretK
L_evV:
    s_nop 1
    s_bitcmp1_b64 s[64:65], s30
    s_cbranch_scc0 L_paV
    s_memrealtime s[60:61]
    s_mov_b32 s72, s59
    v_mov_b32 v11, 1
    s_mov_b64 exec, 1
    ds_add_u32 v53, v11 offset:128
    s_mov_b64 exec, -1
L_paV:
    s_nop 1
    s_bitcmp1_b64 s[66:67], s30
    s_cbranch_scc0 L_pbV
    v_mov_b32 v11, 1
    s_mov_b64 exec, 1
    ds_add_u32 v53, v11 offset:128
    s_mov_b64 exec, -1
L_pbV:
    s_nop 1
    s_bitcmp1_b64 s[68:69], s30
    s_cbranch_scc0 L_pcV
    v_mov_b32 v11, s62
    ds_read_b32 v10, v11
    v_mov_b32 v11, 1
    s_mov_b64 exec, 1
    ds_add_u32 v53, v11 offset:128
    s_mov_b64 exec, -1
    s_add_u32 s62, s62, 4
    s_waitcnt lgkmcnt(0)
    v_readfirstlane_b32 s32, v10
    s_cmp_eq_u32 s32, 0
    s_cbranch_scc1 L_pcV
    s_sub_u32 s32, s60, s32
    s_max_i32 s32, s32, -4096
    s_min_i32 s32, s32, 4096
    s_cmp_eq_u32 s30, 44
    s_cbranch_scc0 L_pd
    s_mul_i32 s32, s32, 9
    s_add_u32 s32, s32, 2048
    s_ashr_i32 s32, s32, 10
    s_max_i32 s32, s32, 0
    s_min_i32 s32, s32, 4
    s_sub_u32 s49, 48, s32
    s_cmp_eq_u32 s49, 48
    s_cselect_b32 s49, 255, s49
    s_mov_b32 s59, 0
    s_branch L_pcV
L_pd:
    s_nop 1
    s_mul_i32 s32, s32, 8
    s_add_u32 s32, s32, 512
    s_ashr_i32 s32, s32, 10
    s_sub_u32 s32, s32, s72
    s_add_u32 s32, s32, s59
    s_max_i32 s32, s32, 0
    s_min_i32 s59, s32, 6
L_pcV:
    s_nop 1
    s_bitcmp1_b64 s[70:71], s30
    s_cbranch_scc0 L_evretV
    s_cmp_eq_u32 s30, 16
    s_cbranch_scc0 L_gxtv264
    s_memrealtime s[36:37]
    s_mov_b32 s6, 0x100000
L_wgtv264:
    s_nop 1
    ds_read_b32 v10, v53 offset:220
    s_sub_u32 s6, s6, 1
    s_cbranch_scc1 L_exit1
    s_waitcnt lgkmcnt(0)
    v_readfirstlane_b32 s32, v10
    s_cmp_eq_u32 s32, 0
    s_cbranch_scc1 L_wgtv264
    s_and_b32 s32, s32, 0xffff
    s_cbranch_scc0 L_gxtv264
    s_add_u32 s32, s32, s36
L_gltv264:
    s_nop 1
    s_memrealtime s[36:37]
    s_waitcnt lgkmcnt(0)
    s_sub_u32 s36, s36, s32
    s_cmp_lt_i32 s36, 0
    s_cbranch_scc1 L_gltv264
L_gxtv264:
    s_nop 1
    s_cmp_eq_u32 s30, 32
    s_cbranch_scc0 L_gxtv280
    s_memrealtime s[36:37]
    s_mov_b32 s6, 0x100000
L_wgtv280:
    s_nop 1
    ds_read_b32 v10, v53 offset:224
    s_sub_u32 s6, s6, 1
    s_cbranch_scc1 L_exit1
    s_waitcnt lgkmcnt(0)
    v_readfirstlane_b32 s32, v10
    s_cmp_eq_u32 s32, 0
    s_cbranch_scc1 L_wgtv280
    s_and_b32 s32, s32, 0xffff
    s_cbranch_scc0 L_gxtv280
    s_add_u32 s32, s32, s36
L_gltv280:
    s_nop 1
    s_memrealtime s[36:37]
    s_waitcnt lgkmcnt(0)
    s_sub_u32 s36, s36, s32
    s_cmp_lt_i32 s36, 0
    s_cbranch_scc1 L_gltv280
L_gxtv280:
    s_nop 1
    s_lshr_b32 s33, s30, 4
    s_lshl_b32 s34, s33, 2
    v_mov_b32 v11, s34
    s_mov_b32 s6, 0x100000
L_wtv2:
    s_nop 1
    ds_read_b32 v10, v11 offset:24
    s_sub_u32 s6, s6, 1
    s_cbranch_scc1 L_exit1
    s_waitcnt lgkmcnt(0)
    v_readfirstlane_b32 s32, v10
    s_cmp_eq_u32 s32, 0
    s_cbranch_scc1 L_wtv2
    s_and_b32 s5, s32, 7
    s_xor_b32 s5, s5, s48
    s_bitcmp1_b32 s32, 3
    s_cselect_b64 vcc, -1, 0
    v_cndmask_b32 v50, v62, v63, vcc
    s_branch L_evretV
L_evKB:
    s_nop 1
    s_bitcmp1_b64 s[64:65], s30
    s_cbranch_scc0 L_paKB
    s_memrealtime s[60:61]
    s_mov_b32 s72, s59
    v_mov_b32 v11, 1
    s_mov_b64 exec, 1
    ds_add_u32 v53, v11 offset:128
    s_mov_b64 exec, -1
L_paKB:
    s_nop 1
    s_bitcmp1_b64 s[66:67], s30
    s_cbranch_scc0 L_pbKB
    v_mov_b32 v11, 1
    s_mov_b64 exec, 1
    ds_add_u32 v53, v11 offset:128
    s_mov_b64 exec, -1
L_pbKB:
    s_nop 1
    s_bitcmp1_b64 s[68:69], s30
    s_cbranch_scc0 L_pcKB
    v_mov_b32 v11, s62
    ds_read_b32 v10, v11
    v_mov_b32 v11, 1
    s_mov_b64 exec, 1
    ds_add_u32 v53, v11 offset:128
    s_mov_b64 exec, -1
    s_add_u32 s62, s62, 4
    s_waitcnt lgkmcnt(0)
    v_readfirstlane_b32 s32, v10
    s_cmp_eq_u32 s32, 0
    s_cbranch_scc1 L_pcKB
    s_sub_u32 s32, s60, s32
    s_max_i32 s32, s32, -4096
    s_min_i32 s32, s32, 4096
    s_mul_i32 s32, s32, 8
    s_add_u32 s32, s32, 512
    s_ashr_i32 s32, s32, 10
    s_sub_u32 s32, s32, s72
    s_add_u32 s32, s32, s59
    s_max_i32 s32, s32, 0
    s_min_i32 s59, s32, 6
L_pcKB:
    s_nop 1
    s_bitcmp1_b64 s[70:71], s30
    s_cbranch_scc0 L_evretKB
    s_and_b32 s32, s30, 15
    s_cbranch_scc0 L_evK2B
    s_cmp_eq_u32 s30, 3
    s_cbranch_scc1 L_evK2B
    s_lshr_b32 s33, s30, 2
    s_andn2_b32 s33, s33, 3
    s_add_u32 s33, s33, 36
    s_cmp_eq_u32 s32, 1
    s_cselect_b32 s32, s33, 60
    s_cselect_b32 s33, 5376, 0
    v_add_u32 v4, s33, v4
    s_cmp_eq_u32 s30, 2
    s_cselect_b32 s32, 56, s32
    v_mov_b32 v10, s32
    v_mov_b32 v11, 1
    s_mov_b64 exec, 1
    ds_add_u32 v10, v11 offset:0
    s_mov_b64 exec, -1
    s_branch L_evretKB
L_evK2B:
    s_nop 1
    s_cmp_eq_u32 s30, 16
    s_cbranch_scc0 L_gxtkB16
    s_memrealtime s[36:37]
    s_mov_b32 s6, 0x100000
L_wgtkB16:
    s_nop 1
    ds_read_b32 v10, v53 offset:208
    s_sub_u32 s6, s6, 1
    s_cbranch_scc1 L_exit1
    s_waitcnt lgkmcnt(0)
    v_readfirstlane_b32 s32, v10
    s_cmp_eq_u32 s32, 0
    s_cbranch_scc1 L_wgtkB16
    s_and_b32 s32, s32, 0xffff
    s_cbranch_scc0 L_gxtkB16
    s_add_u32 s32, s32, s36
L_gltkB16:
    s_nop 1
    s_memrealtime s[36:37]
    s_waitcnt lgkmcnt(0)
    s_sub_u32 s36, s36, s32
    s_cmp_lt_i32 s36, 0
    s_cbranch_scc1 L_gltkB16
L_gxtkB16:
    s_nop 1
    s_cmp_eq_u32 s30, 32
    s_cbranch_scc0 L_gxtkB32
    s_memrealtime s[36:37]
    s_mov_b32 s6, 0x100000
L_wgtkB32:
    s_nop 1
    ds_read_b32 v10, v53 offset:212
    s_sub_u32 s6, s6, 1
    s_cbranch_scc1 L_exit1
    s_waitcnt lgkmcnt(0)
    v_readfirstlane_b32 s32, v10
    s_cmp_eq_u32 s32, 0
    s_cbranch_scc1 L_wgtkB32
    s_and_b32 s32, s32, 0xffff
    s_cbranch_scc0 L_gxtkB32
    s_add_u32 s32, s32, s36
L_gltkB32:
    s_nop 1
    s_memrealtime s[36:37]
    s_waitcnt lgkmcnt(0)
    s_sub_u32 s36, s36, s32
    s_cmp_lt_i32 s36, 0
    s_cbranch_scc1 L_gltkB32
L_gxtkB32:
    s_nop 1
    s_lshr_b32 s33, s30, 4
    s_lshl_b32 s34, s33, 2
    v_mov_b32 v11, s34
    s_lshl_b32 s31, s33, 5
    s_add_u32 s31, s31, s3
    s_mul_i32 s31, s31, 171
    s_lshr_b32 s31, s31, 9
    s_mul_i32 s31, s31, 384
    buffer_load_dwordx2 v[36:37], v3, s[20:23], s31 offen offset:0
    buffer_load_dwordx2 v[38:39], v3, s[20:23], s31 offen offset:128
    buffer_load_dwordx2 v[40:41], v3, s[20:23], s31 offen offset:256
    s_mov_b32 s6, 0x100000
L_wtkB:
    s_nop 1
    ds_read_b32 v10, v11 offset:0
    s_sub_u32 s6, s6, 1
    s_cbranch_scc1 L_exit1
    s_waitcnt lgkmcnt(0)
    v_readfirstlane_b32 s32, v10
    s_cmp_eq_u32 s32, 0
    s_cbranch_scc1 L_wtkB
    s_and_b32 s5, s32, 7
    s_xor_b32 s5, s5, s48
    s_bitcmp1_b32 s32, 3
    s_cselect_b64 vcc, -1, 0
    v_cndmask_b32 v50, v62, v63, vcc
    s_branch L_evretKB
L_evVB:
    s_nop 1
    s_bitcmp1_b64 s[64:65], s30
    s_cbranch_scc0 L_paVB
    s_memrealtime s[60:61]
    s_mov_b32 s72, s59
    v_mov_b32 v11, 1
    s_mov_b64 exec, 1
    ds_add_u32 v53, v11 offset:128
    s_mov_b64 exec, -1
L_paVB:
    s_nop 1
    s_bitcmp1_b64 s[66:67], s30
    s_cbranch_scc0 L_pbVB
    v_mov_b32 v11, 1
    s_mov_b64 exec, 1
    ds_add_u32 v53, v11 offset:128
    s_mov_b64 exec, -1
L_pbVB:
    s_nop 1
    s_bitcmp1_b64 s[68:69], s30
    s_cbranch_scc0 L_pcVB
    v_mov_b32 v11, s62
    ds_read_b32 v10, v11
    v_mov_b32 v11, 1
    s_mov_b64 exec, 1
    ds_add_u32 v53, v11 offset:128
    s_mov_b64 exec, -1
    s_add_u32 s62, s62, 4
    s_waitcnt lgkmcnt(0)
    v_readfirstlane_b32 s32, v10
    s_cmp_eq_u32 s32, 0
    s_cbranch_scc1 L_pcVB
    s_sub_u32 s32, s60, s32
    s_max_i32 s32, s32, -4096
    s_min_i32 s32, s32, 4096
    s_cmp_eq_u32 s30, 44
    s_cbranch_scc0 L_pdB
    s_mul_i32 s32, s32, 9
    s_add_u32 s32, s32, 2048
    s_ashr_i32 s32, s32, 10
    s_max_i32 s32, s32, 0
    s_min_i32 s32, s32, 4
    s_sub_u32 s49, 48, s32
    s_cmp_eq_u32 s49, 48
    s_cselect_b32 s49, 255, s49
    s_mov_b32 s59, 0
    s_branch L_pcVB
L_pdB:
    s_nop 1
    s_mul_i32 s32, s32, 8
    s_add_u32 s32, s32, 512
    s_ashr_i32 s32, s32, 10
    s_sub_u32 s32, s32, s72
    s_add_u32 s32, s32, s59
    s_max_i32 s32, s32, 0
    s_min_i32 s59, s32, 6
L_pcVB:
    s_nop 1
    s_bitcmp1_b64 s[70:71], s30
    s_cbranch_scc0 L_evretVB
    s_cmp_eq_u32 s30, 16
    s_cbranch_scc0 L_gxtv2B64
    s_memrealtime s[36:37]
    s_mov_b32 s6, 0x100000
L_wgtv2B64:
    s_nop 1
    ds_read_b32 v10, v53 offset:220
    s_sub_u32 s6, s6, 1
    s_cbranch_scc1 L_exit1
    s_waitcnt lgkmcnt(0)
    v_readfirstlane_b32 s32, v10
    s_cmp_eq_u32 s32, 0
    s_cbranch_scc1 L_wgtv2B64
    s_and_b32 s32, s32, 0xffff
    s_cbranch_scc0 L_gxtv2B64
    s_add_u32 s32, s32, s36
L_gltv2B64:
    s_nop 1
    s_memrealtime s[36:37]
    s_waitcnt lgkmcnt(0)
    s_sub_u32 s36, s36, s32
    s_cmp_lt_i32 s36, 0
    s_cbranch_scc1 L_gltv2B64
L_gxtv2B64:
    s_nop 1
    s_cmp_eq_u32 s30, 32
    s_cbranch_scc0 L_gxtv2B80
    s_memrealtime s[36:37]
    s_mov_b32 s6, 0x100000
L_wgtv2B80:
    s_nop 1
    ds_read_b32 v10, v53 offset:224
    s_sub_u32 s6, s6, 1
    s_cbranch_scc1 L_exit1
    s_waitcnt lgkmcnt(0)
    v_readfirstlane_b32 s32, v10
    s_cmp_eq_u32 s32, 0
    s_cbranch_scc1 L_wgtv2B80
    s_and_b32 s32, s32, 0xffff
    s_cbranch_scc0 L_gxtv2B80
    s_add_u32 s32, s32, s36
L_gltv2B80:
    s_nop 1
    s_memrealtime s[36:37]
    s_waitcnt lgkmcnt(0)
    s_sub_u32 s36, s36, s32
    s_cmp_lt_i32 s36, 0
    s_cbranch_scc1 L_gltv2B80
L_gxtv2B80:
    s_nop 1
    s_lshr_b32 s33, s30, 4
    s_lshl_b32 s34, s33, 2
    v_mov_b32 v11, s34
    s_mov_b32 s6, 0x100000
L_wtv2B:
    s_nop 1
    ds_read_b32 v10, v11 offset:24
    s_sub_u32 s6, s6, 1
    s_cbranch_scc1 L_exit1
    s_waitcnt lgkmcnt(0)
    v_readfirstlane_b32 s32, v10
    s_cmp_eq_u32 s32, 0
    s_cbranch_scc1 L_wtv2B
    s_and_b32 s5, s32, 7
    s_xor_b32 s5, s5, s48
    s_bitcmp1_b32 s32, 3
    s_cselect_b64 vcc, -1, 0
    v_cndmask_b32 v50, v62, v63, vcc
    s_branch L_evretVB
L_helper:
    s_nop 1
    s_sub_u32 s6, s28, 4
    s_mov_b32 s5, s48
    v_and_b32 v1, 63, v0
    v_mov_b32 v2, 0
    s_mul_i32 s59, s3, 34816
    s_add_u32 s59, s59, 8388608
    s_cmp_eq_u32 s6, 3
    s_cbranch_scc1 L_h3
    s_mul_i32 s48, s6, 25
    s_sub_u32 s48, s48, 22
    s_cmp_lt_i32 s3, s48
    s_cselect_b32 s90, 1, 0
    s_cbranch_scc0 L_noprobe1
    s_add_u32 s49, s3, 2
    s_mul_i32 s48, s49, 205
    s_lshr_b32 s48, s48, 10
    s_mul_i32 s7, s48, 5
    s_sub_u32 s7, s49, s7
    s_add_u32 s7, s7, 1
    s_lshl_b32 s49, s3, 1
    s_add_u32 s49, s49, s6
    s_sub_u32 s49, s49, 1
    s_cmp_lt_u32 s3, 3
    s_cselect_b32 s7, 0, s7
    s_cselect_b32 s49, s49, s48
    s_and_b32 s48, s49, 1
    s_mul_i32 s20, s49, 20
    s_add_u32 s20, s20, s48
    s_add_u32 s20, s20, 2
    s_lshr_b32 s91, s20, 5
    s_xor_b32 s91, s91, s4
    s_lshl_b32 s20, s20, 21
    s_xor_b32 s21, s4, s6
    s_and_b32 s21, s21, 1
    s_lshr_b32 s49, s4, 2
    s_xor_b32 s48, s48, s49
    s_xor_b32 s48, s48, s21
    s_lshl_b32 s48, s48, 13
    s_lshl_b32 s49, s6, 14
    s_and_b32 s49, s49, 0x4000
    s_or_b32 s48, s48, s49
    s_xor_b32 s32, s48, 0x0
    s_xor_b32 s33, s48, 0x2000
    s_xor_b32 s34, s48, 0x1000
    s_xor_b32 s35, s48, 0x3000
    s_xor_b32 s36, s48, 0x4000
    s_xor_b32 s37, s48, 0x6000
    s_xor_b32 s38, s48, 0x5000
    s_xor_b32 s39, s48, 0x7000
    v_and_b32 v3, 7, v1
    v_lshlrev_b32 v3, 12, v3
    s_lshl_b32 s48, s4, 8
    v_add_u32 v3, s48, v3
    s_mov_b32 s10, 805306368
    s_mov_b32 s11, 0x00020000
    s_cmp_ge_u32 s7, 3
    s_cselect_b32 s48, 3, 0
    s_sub_u32 s48, s7, s48
    s_lshl_b32 s48, s48, 28
    s_add_u32 s20, s20, s48
    s_cmp_ge_u32 s7, 3
    s_waitcnt lgkmcnt(0)
    s_cselect_b32 s8, s68, s66
    s_cselect_b32 s23, s69, s67
    s_and_b32 s9, s23, 0xffff
    s_add_u32 s22, s8, s20
    s_addc_u32 s23, s23, 0
    s_lshl_b32 s48, s4, 8
    s_add_u32 s56, s22, s48
    s_addc_u32 s57, s23, 0
    s_load_dword s24, s[56:57], 0x0
    s_load_dword s25, s[56:57], 0x1000
    s_load_dword s26, s[56:57], 0x2000
    s_load_dword s27, s[56:57], 0x3000
    s_load_dword s28, s[56:57], 0x4000
    s_load_dword s29, s[56:57], 0x5000
    s_load_dword s30, s[56:57], 0x6000
    s_load_dword s31, s[56:57], 0x7000
    s_mov_b32 s12, s82
    s_and_b32 s13, s83, 0xffff
    s_mov_b32 s14, 10485760
    s_mov_b32 s15, 0x00020000
    s_lshl_b32 s48, s2, 1
    s_add_u32 s48, s48, s6
    s_mul_i32 s48, s48, 26112
    s_add_u32 s48, s48, 8362496
    v_mul_u32_u24 v5, 4352, v1
    v_mov_b32 v3, 0
    v_mov_b32 v4, 0
    s_cmp_eq_u32 s7, 0
    s_cselect_b64 exec, 0x3f, 0
    buffer_store_dwordx3 v[2:4], v5, s[12:15], s48 offen sc1
    s_mov_b64 exec, -1
    s_cmp_lg_u32 s7, 0
    s_cbranch_scc1 L_noprobe2
L_noprobe1:
    s_nop 1
    s_waitcnt lgkmcnt(0)
L_noprobe2:
    s_nop 1
    s_mov_b32 s12, s82
    s_and_b32 s13, s83, 0xffff
    s_mov_b32 s14, 10485760
    s_mov_b32 s15, 0x00020000
    s_mov_b32 s16, s80
    s_and_b32 s17, s81, 0xffff
    s_mov_b32 s18, 256
    s_mov_b32 s19, 0x00020000
    s_cmp_lg_u32 s6, 0
    s_cbranch_scc1 L_hbar
    v_lshlrev_b32 v5, 2, v1
    ds_write_b32 v5, v2
    s_waitcnt lgkmcnt(0)
L_hbar:
    s_nop 1
    s_barrier
    s_cmp_eq_u32 s90, 0
    s_cbranch_scc1 L_role
    s_mov_b32 s46, 1
    s_mov_b32 s58, 0
    s_mov_b32 s61, 0
    s_mov_b32 s62, 0
    s_mov_b32 s63, 0
    s_cmp_eq_u32 s7, 0
    s_cselect_b32 s47, 1, 7
    s_waitcnt lgkmcnt(0)
L_round:
    s_nop 1
    s_add_u32 s48, s4, s46
    s_and_b32 s48, s48, 7
    s_lshl_b32 s48, s48, 8
    s_add_u32 s56, s22, s48
    s_addc_u32 s57, s23, 0
    s_mov_b32 s44, -1
    s_memtime s[40:41]
    s_waitcnt lgkmcnt(0)
    s_load_dword s45, s[56:57], s32
    s_waitcnt lgkmcnt(0)
    s_memtime s[42:43]
    s_waitcnt lgkmcnt(0)
    s_sub_u32 s24, s42, s40
    s_load_dword s45, s[56:57], s33
    s_waitcnt lgkmcnt(0)
    s_memtime s[40:41]
    s_waitcnt lgkmcnt(0)
    s_sub_u32 s25, s40, s42
    s_load_dword s45, s[56:57], s34
    s_waitcnt lgkmcnt(0)
    s_memtime s[42:43]
    s_waitcnt lgkmcnt(0)
    s_sub_u32 s26, s42, s40
    s_load_dword s45, s[56:57], s35
    s_waitcnt lgkmcnt(0)
    s_memtime s[40:41]
    s_waitcnt lgkmcnt(0)
    s_sub_u32 s27, s40, s42
    s_mov_b32 s28, -1
    s_mov_b32 s29, -1
    s_mov_b32 s30, -1
    s_mov_b32 s31, -1
    s_cmp_eq_u32 s7, 0
    s_cbranch_scc1 L_few
    s_load_dword s45, s[56:57], s36
    s_waitcnt lgkmcnt(0)
    s_memtime s[42:43]
    s_waitcnt lgkmcnt(0)
    s_sub_u32 s28, s42, s40
    s_load_dword s45, s[56:57], s37
    s_waitcnt lgkmcnt(0)
    s_memtime s[40:41]
    s_waitcnt lgkmcnt(0)
    s_sub_u32 s29, s40, s42
    s_load_dword s45, s[56:57], s38
    s_waitcnt lgkmcnt(0)
    s_memtime s[42:43]
    s_waitcnt lgkmcnt(0)
    s_sub_u32 s30, s42, s40
    s_load_dword s45, s[56:57], s39
    s_waitcnt lgkmcnt(0)
    s_memtime s[40:41]
    s_waitcnt lgkmcnt(0)
    s_sub_u32 s31, s40, s42
L_few:
    s_nop 1
    s_min_u32 s24, s24, 1400
    s_min_u32 s44, s44, s24
    s_min_u32 s25, s25, 1400
    s_min_u32 s44, s44, s25
    s_min_u32 s26, s26, 1400
    s_min_u32 s44, s44, s26
    s_min_u32 s27, s27, 1400
    s_min_u32 s44, s44, s27
    s_min_u32 s28, s28, 1400
    s_min_u32 s44, s44, s28
    s_min_u32 s29, s29, 1400
    s_min_u32 s44, s44, s29
    s_min_u32 s30, s30, 1400
    s_min_u32 s44, s44, s30
    s_min_u32 s31, s31, 1400
    s_min_u32 s44, s44, s31
    s_cmp_lt_u32 s44, 290
    s_cbranch_scc1 L_skip
    s_sub_u32 s58, s58, s24
    s_add_u32 s58, s58, s25
    s_sub_u32 s58, s58, s26
    s_add_u32 s58, s58, s27
    s_sub_u32 s58, s58, s28
    s_add_u32 s58, s58, s29
    s_sub_u32 s58, s58, s30
    s_add_u32 s58, s58, s31
    s_cmp_eq_u32 s7, 0
    s_cbranch_scc1 L_skip
    s_min_u32 s48, s24, s26
    s_min_u32 s50, s28, s30
    s_min_u32 s48, s48, s50
    s_add_u32 s48, s48, 100
    s_min_u32 s49, s25, s27
    s_min_u32 s50, s29, s31
    s_min_u32 s49, s49, s50
    s_add_u32 s49, s49, 100
    s_min_u32 s24, s24, s48
    s_min_u32 s25, s25, s49
    s_min_u32 s26, s26, s48
    s_min_u32 s27, s27, s49
    s_min_u32 s28, s28, s48
    s_min_u32 s29, s29, s49
    s_min_u32 s30, s30, s48
    s_min_u32 s31, s31, s49
    s_sub_u32 s61, s61, s24
    s_sub_u32 s62, s62, s24
    s_sub_u32 s63, s63, s24
    s_add_u32 s61, s61, s25
    s_sub_u32 s62, s62, s25
    s_add_u32 s63, s63, s25
    s_add_u32 s61, s61, s26
    s_sub_u32 s62, s62, s26
    s_sub_u32 s63, s63, s26
    s_sub_u32 s61, s61, s27
    s_sub_u32 s62, s62, s27
    s_add_u32 s63, s63, s27
    s_sub_u32 s61, s61, s28
    s_add_u32 s62, s62, s28
    s_add_u32 s63, s63, s28
    s_add_u32 s61, s61, s29
    s_add_u32 s62, s62, s29
    s_sub_u32 s63, s63, s29
    s_add_u32 s61, s61, s30
    s_add_u32 s62, s62, s30
    s_add_u32 s63, s63, s30
    s_sub_u32 s61, s61, s31
    s_add_u32 s62, s62, s31
    s_sub_u32 s63, s63, s31
L_skip:
    s_nop 1
    s_add_u32 s46, s46, 1
    s_cmp_le_u32 s46, s47
    s_cbranch_scc1 L_round
    s_sub_u32 s48, 0, s58
    s_cmp_eq_u32 s21, 0
    s_cselect_b32 s58, s58, s48
    s_add_u32 s58, s58, 0x1010000
    v_mov_b32 v4, s58
    s_mov_b64 exec, 1
    s_lshl_b32 s48, s7, 2
    s_add_u32 s48, s48, 124
    s_cmp_eq_u32 s7, 0
    s_cbranch_scc0 L_post
    s_waitcnt vmcnt(0)
    ds_add_rtn_u32 v5, v2, v4 offset:36
    s_mov_b32 s48, 0
    s_waitcnt lgkmcnt(0)
    v_add_u32 v4, v4, v5
    v_cmp_ne_u32 vcc, 0, v5
    s_and_b64 exec, exec, vcc
    buffer_atomic_add v4, off, s[16:19], s48
    s_branch L_posted
L_post:
    s_nop 1
    s_mov_b32 s60, 0x100000
L_wvw:
    s_nop 1
    ds_read_b32 v10, v2 offset:0
    s_sub_u32 s60, s60, 1
    s_cbranch_scc1 L_exit1
    s_waitcnt lgkmcnt(0)
    v_readfirstlane_b32 s48, v10
    s_cmp_eq_u32 s48, 0
    s_cbranch_scc1 L_wvw
    s_lshr_b32 s48, s91, 1
    s_xor_b32 s48, s48, s21
    s_sub_u32 s49, 0, s61
    s_bitcmp1_b32 s48, 0
    s_cselect_b32 s61, s49, s61
    s_xor_b32 s48, s91, s21
    s_bitcmp1_b32 s4, 0
    s_cselect_b32 s48, s91, s48
    s_cselect_b32 s62, s62, s63
    s_sub_u32 s49, 0, s62
    s_bitcmp1_b32 s48, 0
    s_cselect_b32 s62, s49, s62
    s_add_u32 s61, s61, 0x1010000
    v_writelane_b32 v4, s61, 1
    s_add_u32 s62, s62, 0x1010000
    v_writelane_b32 v4, s62, 2
    s_lshl_b32 s48, s7, 2
    s_and_b32 s49, s4, 1
    s_or_b32 s48, s48, s49
    s_lshr_b32 s49, s4, 1
    s_and_b32 s49, s49, 2
    s_or_b32 s48, s48, s49
    s_mul_i32 s48, s48, 4352
    s_add_u32 s48, s48, 9485312
    s_mov_b64 exec, 7
    v_lshlrev_b32 v5, 2, v1
    buffer_atomic_add v4, v5, s[12:15], s48 offen
L_posted:
    s_nop 1
    s_mov_b64 exec, -1
L_role:
    s_nop 1
    s_cmp_eq_u32 s6, 0
    s_cbranch_scc1 L_h0
    s_cmp_eq_u32 s6, 2
    s_cbranch_scc1 L_h2
    v_lshlrev_b32 v5, 2, v1
    s_mov_b32 s60, 0x100000
L_wea:
    s_nop 1
    ds_read_b32 v10, v2 offset:56
    s_sub_u32 s60, s60, 1
    s_cbranch_scc1 L_exit1
    s_waitcnt lgkmcnt(0)
    v_readfirstlane_b32 s48, v10
    s_cmp_lt_u32 s48, 4
    s_cbranch_scc1 L_wea
    s_mov_b64 exec, 0x1
    s_mov_b32 s60, 0x40000
L_polla:
    s_nop 1
    buffer_load_dword v4, v5, s[16:19], 0 offen offset:0 sc1
    s_sub_u32 s60, s60, 1
    s_cbranch_scc1 L_exit1
L_pollwa:
    s_waitcnt vmcnt(0)
    v_lshrrev_b32 v6, 24, v4
    v_cmp_ne_u32 vcc, 48, v6
    s_cbranch_vccnz L_polla
    v_and_b32 v4, 0xffffff, v4
    v_subrev_u32 v4, 3145728, v4
    v_lshrrev_b32 v6, 30, v4
    v_and_b32 v6, 2, v6
    v_add_u32 v4, 4800, v4
    v_cmp_gt_u32 vcc, 9600, v4
    s_nop 1
    v_cndmask_b32 v6, v6, 8, vcc
    v_or_b32 v6, 16, v6
    ds_write_b32 v5, v6 offset:0
    s_mov_b64 exec, -1
    s_mov_b32 s60, 0x100000
L_web:
    s_nop 1
    ds_read_b32 v10, v2 offset:60
    s_sub_u32 s60, s60, 1
    s_cbranch_scc1 L_exit1
    s_waitcnt lgkmcnt(0)
    v_readfirstlane_b32 s48, v10
    s_cmp_eq_u32 s48, 0
    s_cbranch_scc1 L_web
    v_mul_u32_u24 v7, 4352, v1
    s_mov_b32 s48, 9502720
    s_mov_b64 exec, 0xfffff
    s_mov_b32 s60, 0x40000
L_pollb:
    s_nop 1
    buffer_load_dwordx3 v[16:18], v7, s[12:15], s48 offen sc1
    s_sub_u32 s60, s60, 1
    s_cbranch_scc1 L_exit1
    s_waitcnt vmcnt(0)
    v_min3_u32 v6, v16, v17, v18
    v_lshrrev_b32 v6, 24, v6
    v_cmp_ne_u32 vcc, 10, v6
    s_cbranch_vccnz L_pollb
    v_subrev_u32 v16, 0xa0a0000, v16
    v_subrev_u32 v17, 0xa0a0000, v17
    v_subrev_u32 v18, 0xa0a0000, v18
    v_add_u32_dpp v16, v16, v16 quad_perm:[1,0,3,2] row_mask:0xf bank_mask:0xf
    v_add_u32_dpp v17, v17, v17 quad_perm:[1,0,3,2] row_mask:0xf bank_mask:0xf
    s_nop 0
    v_add_u32_dpp v16, v16, v16 quad_perm:[2,3,0,1] row_mask:0xf bank_mask:0xf
    v_add_u32_dpp v17, v17, v17 quad_perm:[2,3,0,1] row_mask:0xf bank_mask:0xf
    v_ashrrev_i32 v6, 31, v16
    v_xor_b32 v17, v17, v6
    v_xor_b32 v4, v18, v6
    s_mov_b64 vcc, 0x55555
    v_cndmask_b32 v18, v18, v4, vcc
    s_nop 1
    v_add_u32_dpp v18, v18, v18 quad_perm:[1,0,3,2] row_mask:0xf bank_mask:0xf
    s_nop 1
    v_add_u32_dpp v18, v18, v18 quad_perm:[2,3,0,1] row_mask:0xf bank_mask:0xf
    v_and_b32 v20, 2, v6
    v_or_b32 v4, 1, v20
    v_cmp_gt_i32 vcc, -2800, v17
    s_nop 1
    v_cndmask_b32 v20, v20, v4, vcc
    v_or_b32 v4, 4, v20
    v_cmp_gt_i32 vcc, -2800, v18
    s_nop 1
    v_cndmask_b32 v20, v20, v4, vcc
    v_add_u32 v4, 56000, v16
    v_cmp_gt_u32 vcc, 112000, v4
    s_nop 1
    v_cndmask_b32 v20, v20, 8, vcc
    v_and_b32 v20, 15, v20
    s_nop 0
    v_readlane_b32 s24, v20, 0
    v_readlane_b32 s25, v20, 4
    v_readlane_b32 s26, v20, 8
    v_readlane_b32 s27, v20, 12
    v_readlane_b32 s28, v20, 16
    s_xor_b32 s48, s24, s27
    s_and_b32 s48, s48, 10
    s_cselect_b32 s24, s24, s27
    s_xor_b32 s48, s25, s28
    s_and_b32 s48, s48, 10
    s_cselect_b32 s25, s25, s28
    s_or_b32 s24, s24, 16
    v_writelane_b32 v6, s24, 0
    s_or_b32 s25, s25, 16
    v_writelane_b32 v6, s25, 1
    s_or_b32 s26, s26, 16
    v_writelane_b32 v6, s26, 2
    s_or_b32 s27, s27, 16
    v_writelane_b32 v6, s27, 3
    s_or_b32 s28, s28, 16
    v_writelane_b32 v6, s28, 4
    s_mov_b64 exec, 0x1f
    ds_write_b32 v5, v6 offset:4
    s_mov_b64 exec, -1
    s_and_b32 s48, s3, 7
    s_cmp_lg_u32 s48, s4
    s_cbranch_scc1 L_exit1
    s_mul_i32 s48, s3, 3
    s_add_u32 s48, s48, 2
    s_lshr_b32 s48, s48, 5
    s_lshl_b32 s48, s48, 2
    v_mov_b32 v3, s48
    s_mul_i32 s57, s3, 24
    v_add_u32 v13, s57, v1
    v_and_b32 v12, 255, v13
    v_mul_u32_u24 v12, 4352, v12
    v_lshlrev_b32 v13, 6, v13
    s_mov_b32 s49, 8388608
    s_mov_b32 s50, 917504
    v_mov_b32 v4, 0xf149f2ca
    v_mov_b32 v5, 0
    s_mov_b32 s51, 93
    s_cmp_eq_u32 s48, 4
    s_cselect_b32 s51, 117, s51
    s_cmp_eq_u32 s48, 8
    s_cselect_b32 s51, 81, s51
    s_mov_b32 s60, 0x100000
L_wcg:
    s_nop 1
    ds_read_b32 v10, v2 offset:128
    s_sub_u32 s60, s60, 1
    s_cbranch_scc1 L_exit1
    s_waitcnt lgkmcnt(0)
    v_readfirstlane_b32 s48, v10
    s_cmp_lt_u32 s48, s51
    s_cbranch_scc1 L_wcg
    s_mov_b64 exec, 0xffffff
    s_mov_b32 s60, 0x40000
L_cpf:
    s_nop 1
    buffer_load_dword v7, v12, s[12:15], s49 offen sc1
    s_sub_u32 s60, s60, 1
    s_cbranch_scc1 L_exit1
    s_waitcnt vmcnt(0)
    v_cmpx_eq_u32 vcc, 0, v7
    s_cbranch_execnz L_cpf
    s_mov_b64 exec, 0xffffff
    s_mov_b32 s60, 0x40000
L_cpm:
    s_nop 1
    buffer_load_dwordx4 v[4:7], v13, s[12:15], s50 offen sc1
    s_sub_u32 s60, s60, 1
    s_cbranch_scc1 L_exit1
    s_waitcnt vmcnt(0)
    v_cmpx_eq_u32 vcc, 0, v7
    s_cbranch_execnz L_cpm
    s_mov_b64 exec, -1
    v_mov_b32 v6, v4
    s_nop 1
    v_max_f32_dpp v6, v6, v6 row_ror:8 row_mask:0xf bank_mask:0xf
    s_nop 1
    v_max_f32_dpp v6, v6, v6 row_ror:4 row_mask:0xf bank_mask:0xf
    s_nop 1
    v_max_f32_dpp v6, v6, v6 row_ror:2 row_mask:0xf bank_mask:0xf
    s_nop 1
    v_max_f32_dpp v6, v6, v6 row_ror:1 row_mask:0xf bank_mask:0xf
    v_mov_b32 v7, v6
    s_nop 1
    v_permlane32_swap_b32 v6, v7
    v_max_f32 v6, v6, v7
    v_mov_b32 v7, v6
    s_nop 1
    v_permlane16_swap_b32 v6, v7
    v_max_f32 v6, v6, v7
    v_sub_f32 v4, v4, v6
    v_exp_f32 v4, v4
    s_nop 0
    v_mul_f32 v5, v5, v4
    s_nop 1
    v_add_f32_dpp v5, v5, v5 row_ror:8 row_mask:0xf bank_mask:0xf
    s_nop 1
    v_add_f32_dpp v5, v5, v5 row_ror:4 row_mask:0xf bank_mask:0xf
    s_nop 1
    v_add_f32_dpp v5, v5, v5 row_ror:2 row_mask:0xf bank_mask:0xf
    s_nop 1
    v_add_f32_dpp v5, v5, v5 row_ror:1 row_mask:0xf bank_mask:0xf
    v_mov_b32 v7, v5
    s_nop 1
    v_permlane32_swap_b32 v5, v7
    v_add_f32 v5, v5, v7
    v_mov_b32 v7, v5
    s_nop 1
    v_permlane16_swap_b32 v5, v7
    v_add_f32 v5, v5, v7
    v_rcp_f32 v5, v5
    s_nop 0
    v_mul_f32 v4, v4, v5
    s_cmp_lt_u32 s3, 21
    s_cbranch_scc1 L_cown
    s_mul_i32 s48, s3, 4352
    s_add_u32 s48, s48, 9498368
    v_lshlrev_b32 v12, 2, v1
    v_mov_b32 v5, 1
    s_mov_b64 exec, 0xffffff
    buffer_store_dword v4, v12, s[12:15], s48 offen offset:128 sc1
    s_mov_b64 exec, 1
    s_waitcnt vmcnt(0)
    buffer_store_dword v5, off, s[12:15], s48 offset:4 sc1
    s_endpgm
L_cown:
    s_nop 1
    v_readlane_b32 s24, v4, 0
    v_readlane_b32 s25, v4, 1
    v_readlane_b32 s26, v4, 2
    v_readlane_b32 s27, v4, 3
    v_readlane_b32 s28, v4, 4
    v_readlane_b32 s29, v4, 5
    v_readlane_b32 s30, v4, 6
    v_readlane_b32 s31, v4, 7
    v_readlane_b32 s32, v4, 8
    v_readlane_b32 s33, v4, 9
    v_readlane_b32 s34, v4, 10
    v_readlane_b32 s35, v4, 11
    v_readlane_b32 s36, v4, 12
    v_readlane_b32 s37, v4, 13
    v_readlane_b32 s38, v4, 14
    v_readlane_b32 s39, v4, 15
    v_readlane_b32 s40, v4, 16
    v_readlane_b32 s41, v4, 17
    v_readlane_b32 s42, v4, 18
    v_readlane_b32 s43, v4, 19
    v_readlane_b32 s44, v4, 20
    v_readlane_b32 s45, v4, 21
    v_readlane_b32 s46, v4, 22
    v_readlane_b32 s47, v4, 23
    s_mov_b32 s92, s78
    s_and_b32 s93, s79, 0xffff
    s_mov_b32 s94, 12288
    s_mov_b32 s95, 0x00020000
    s_lshl_b32 s57, s57, 10
    v_lshlrev_b32 v13, 4, v1
    v_add_u32 v13, s57, v13
    s_mov_b32 s49, 4096
    s_mov_b32 s50, 8192
    s_mov_b32 s51, 12288
    s_mov_b32 s52, 16384
    s_mov_b32 s53, 20480
    v_mov_b32 v4, 0
    v_mov_b32 v5, 0
    v_mov_b32 v6, 0
    s_mov_b32 s56, 0xffffff
    v_lshlrev_b32 v12, 1, v1
    s_mul_i32 s57, s3, 384
    s_mov_b32 s60, 0x100000
L_wcc:
    s_nop 1
    ds_read_b32 v10, v3 offset:64
    s_sub_u32 s60, s60, 1
    s_cbranch_scc1 L_exit1
    s_waitcnt lgkmcnt(0)
    v_readfirstlane_b32 s48, v10
    s_cmp_lt_u32 s48, 1
    s_cbranch_scc1 L_wcc
    s_mov_b32 s60, 0x40000
L_cr:
    s_nop 1
    s_bitcmp0_b32 s56, 0
    s_cbranch_scc1 L_cl0
    buffer_load_dwordx4 v[16:19], v13, s[12:15], 0 offen offset:0 sc1
L_cl0:
    s_bitcmp0_b32 s56, 1
    s_cbranch_scc1 L_cl1
    buffer_load_dwordx4 v[20:23], v13, s[12:15], 0 offen offset:1024 sc1
L_cl1:
    s_bitcmp0_b32 s56, 2
    s_cbranch_scc1 L_cl2
    buffer_load_dwordx4 v[24:27], v13, s[12:15], 0 offen offset:2048 sc1
L_cl2:
    s_bitcmp0_b32 s56, 3
    s_cbranch_scc1 L_cl3
    buffer_load_dwordx4 v[28:31], v13, s[12:15], 0 offen offset:3072 sc1
L_cl3:
    s_bitcmp0_b32 s56, 4
    s_cbranch_scc1 L_cl4
    buffer_load_dwordx4 v[32:35], v13, s[12:15], s49 offen offset:0 sc1
L_cl4:
    s_bitcmp0_b32 s56, 5
    s_cbranch_scc1 L_cl5
    buffer_load_dwordx4 v[36:39], v13, s[12:15], s49 offen offset:1024 sc1
L_cl5:
    s_bitcmp0_b32 s56, 6
    s_cbranch_scc1 L_cl6
    buffer_load_dwordx4 v[40:43], v13, s[12:15], s49 offen offset:2048 sc1
L_cl6:
    s_bitcmp0_b32 s56, 7
    s_cbranch_scc1 L_cl7
    buffer_load_dwordx4 v[44:47], v13, s[12:15], s49 offen offset:3072 sc1
L_cl7:
    s_bitcmp0_b32 s56, 8
    s_cbranch_scc1 L_cl8
    buffer_load_dwordx4 v[48:51], v13, s[12:15], s50 offen offset:0 sc1
L_cl8:
    s_bitcmp0_b32 s56, 9
    s_cbranch_scc1 L_cl9
    buffer_load_dwordx4 v[52:55], v13, s[12:15], s50 offen offset:1024 sc1
L_cl9:
    s_bitcmp0_b32 s56, 10
    s_cbranch_scc1 L_cl10
    buffer_load_dwordx4 v[56:59], v13, s[12:15], s50 offen offset:2048 sc1
L_cl10:
    s_bitcmp0_b32 s56, 11
    s_cbranch_scc1 L_cl11
    buffer_load_dwordx4 v[60:63], v13, s[12:15], s50 offen offset:3072 sc1
L_cl11:
    s_bitcmp0_b32 s56, 12
    s_cbranch_scc1 L_cl12
    buffer_load_dwordx4 v[64:67], v13, s[12:15], s51 offen offset:0 sc1
L_cl12:
    s_bitcmp0_b32 s56, 13
    s_cbranch_scc1 L_cl13
    buffer_load_dwordx4 v[68:71], v13, s[12:15], s51 offen offset:1024 sc1
L_cl13:
    s_bitcmp0_b32 s56, 14
    s_cbranch_scc1 L_cl14
    buffer_load_dwordx4 v[72:75], v13, s[12:15], s51 offen offset:2048 sc1
L_cl14:
    s_bitcmp0_b32 s56, 15
    s_cbranch_scc1 L_cl15
    buffer_load_dwordx4 v[76:79], v13, s[12:15], s51 offen offset:3072 sc1
L_cl15:
    s_bitcmp0_b32 s56, 16
    s_cbranch_scc1 L_cl16
    buffer_load_dwordx4 v[80:83], v13, s[12:15], s52 offen offset:0 sc1
L_cl16:
    s_bitcmp0_b32 s56, 17
    s_cbranch_scc1 L_cl17
    buffer_load_dwordx4 v[84:87], v13, s[12:15], s52 offen offset:1024 sc1
L_cl17:
    s_bitcmp0_b32 s56, 18
    s_cbranch_scc1 L_cl18
    buffer_load_dwordx4 v[88:91], v13, s[12:15], s52 offen offset:2048 sc1
L_cl18:
    s_bitcmp0_b32 s56, 19
    s_cbranch_scc1 L_cl19
    buffer_load_dwordx4 v[92:95], v13, s[12:15], s52 offen offset:3072 sc1
L_cl19:
    s_bitcmp0_b32 s56, 20
    s_cbranch_scc1 L_cl20
    buffer_load_dwordx4 v[96:99], v13, s[12:15], s53 offen offset:0 sc1
L_cl20:
    s_bitcmp0_b32 s56, 21
    s_cbranch_scc1 L_cl21
    buffer_load_dwordx4 v[100:103], v13, s[12:15], s53 offen offset:1024 sc1
L_cl21:
    s_bitcmp0_b32 s56, 22
    s_cbranch_scc1 L_cl22
    buffer_load_dwordx4 v[104:107], v13, s[12:15], s53 offen offset:2048 sc1
L_cl22:
    s_bitcmp0_b32 s56, 23
    s_cbranch_scc1 L_cl23
    buffer_load_dwordx4 v[108:111], v13, s[12:15], s53 offen offset:3072 sc1
L_cl23:
    s_sub_u32 s60, s60, 1
    s_cbranch_scc1 L_exit1
    s_waitcnt vmcnt(0)
    s_bitcmp0_b32 s56, 0
    s_cbranch_scc1 L_cv0
    v_cmp_eq_u32 vcc, 0, v19
    s_cbranch_vccnz L_cv0
    v_fmac_f32 v4, s24, v16
    v_fmac_f32 v5, s24, v17
    v_fmac_f32 v6, s24, v18
    s_bitset0_b32 s56, 0
L_cv0:
    s_bitcmp0_b32 s56, 1
    s_cbranch_scc1 L_cv1
    v_cmp_eq_u32 vcc, 0, v23
    s_cbranch_vccnz L_cv1
    v_fmac_f32 v4, s25, v20
    v_fmac_f32 v5, s25, v21
    v_fmac_f32 v6, s25, v22
    s_bitset0_b32 s56, 1
L_cv1:
    s_bitcmp0_b32 s56, 2
    s_cbranch_scc1 L_cv2
    v_cmp_eq_u32 vcc, 0, v27
    s_cbranch_vccnz L_cv2
    v_fmac_f32 v4, s26, v24
    v_fmac_f32 v5, s26, v25
    v_fmac_f32 v6, s26, v26
    s_bitset0_b32 s56, 2
L_cv2:
    s_bitcmp0_b32 s56, 3
    s_cbranch_scc1 L_cv3
    v_cmp_eq_u32 vcc, 0, v31
    s_cbranch_vccnz L_cv3
    v_fmac_f32 v4, s27, v28
    v_fmac_f32 v5, s27, v29
    v_fmac_f32 v6, s27, v30
    s_bitset0_b32 s56, 3
L_cv3:
    s_bitcmp0_b32 s56, 4
    s_cbranch_scc1 L_cv4
    v_cmp_eq_u32 vcc, 0, v35
    s_cbranch_vccnz L_cv4
    v_fmac_f32 v4, s28, v32
    v_fmac_f32 v5, s28, v33
    v_fmac_f32 v6, s28, v34
    s_bitset0_b32 s56, 4
L_cv4:
    s_bitcmp0_b32 s56, 5
    s_cbranch_scc1 L_cv5
    v_cmp_eq_u32 vcc, 0, v39
    s_cbranch_vccnz L_cv5
    v_fmac_f32 v4, s29, v36
    v_fmac_f32 v5, s29, v37
    v_fmac_f32 v6, s29, v38
    s_bitset0_b32 s56, 5
L_cv5:
    s_bitcmp0_b32 s56, 6
    s_cbranch_scc1 L_cv6
    v_cmp_eq_u32 vcc, 0, v43
    s_cbranch_vccnz L_cv6
    v_fmac_f32 v4, s30, v40
    v_fmac_f32 v5, s30, v41
    v_fmac_f32 v6, s30, v42
    s_bitset0_b32 s56, 6
L_cv6:
    s_bitcmp0_b32 s56, 7
    s_cbranch_scc1 L_cv7
    v_cmp_eq_u32 vcc, 0, v47
    s_cbranch_vccnz L_cv7
    v_fmac_f32 v4, s31, v44
    v_fmac_f32 v5, s31, v45
    v_fmac_f32 v6, s31, v46
    s_bitset0_b32 s56, 7
L_cv7:
    s_bitcmp0_b32 s56, 8
    s_cbranch_scc1 L_cv8
    v_cmp_eq_u32 vcc, 0, v51
    s_cbranch_vccnz L_cv8
    v_fmac_f32 v4, s32, v48
    v_fmac_f32 v5, s32, v49
    v_fmac_f32 v6, s32, v50
    s_bitset0_b32 s56, 8
L_cv8:
    s_bitcmp0_b32 s56, 9
    s_cbranch_scc1 L_cv9
    v_cmp_eq_u32 vcc, 0, v55
    s_cbranch_vccnz L_cv9
    v_fmac_f32 v4, s33, v52
    v_fmac_f32 v5, s33, v53
    v_fmac_f32 v6, s33, v54
    s_bitset0_b32 s56, 9
L_cv9:
    s_bitcmp0_b32 s56, 10
    s_cbranch_scc1 L_cv10
    v_cmp_eq_u32 vcc, 0, v59
    s_cbranch_vccnz L_cv10
    v_fmac_f32 v4, s34, v56
    v_fmac_f32 v5, s34, v57
    v_fmac_f32 v6, s34, v58
    s_bitset0_b32 s56, 10
L_cv10:
    s_bitcmp0_b32 s56, 11
    s_cbranch_scc1 L_cv11
    v_cmp_eq_u32 vcc, 0, v63
    s_cbranch_vccnz L_cv11
    v_fmac_f32 v4, s35, v60
    v_fmac_f32 v5, s35, v61
    v_fmac_f32 v6, s35, v62
    s_bitset0_b32 s56, 11
L_cv11:
    s_bitcmp0_b32 s56, 12
    s_cbranch_scc1 L_cv12
    v_cmp_eq_u32 vcc, 0, v67
    s_cbranch_vccnz L_cv12
    v_fmac_f32 v4, s36, v64
    v_fmac_f32 v5, s36, v65
    v_fmac_f32 v6, s36, v66
    s_bitset0_b32 s56, 12
L_cv12:
    s_bitcmp0_b32 s56, 13
    s_cbranch_scc1 L_cv13
    v_cmp_eq_u32 vcc, 0, v71
    s_cbranch_vccnz L_cv13
    v_fmac_f32 v4, s37, v68
    v_fmac_f32 v5, s37, v69
    v_fmac_f32 v6, s37, v70
    s_bitset0_b32 s56, 13
L_cv13:
    s_bitcmp0_b32 s56, 14
    s_cbranch_scc1 L_cv14
    v_cmp_eq_u32 vcc, 0, v75
    s_cbranch_vccnz L_cv14
    v_fmac_f32 v4, s38, v72
    v_fmac_f32 v5, s38, v73
    v_fmac_f32 v6, s38, v74
    s_bitset0_b32 s56, 14
L_cv14:
    s_bitcmp0_b32 s56, 15
    s_cbranch_scc1 L_cv15
    v_cmp_eq_u32 vcc, 0, v79
    s_cbranch_vccnz L_cv15
    v_fmac_f32 v4, s39, v76
    v_fmac_f32 v5, s39, v77
    v_fmac_f32 v6, s39, v78
    s_bitset0_b32 s56, 15
L_cv15:
    s_bitcmp0_b32 s56, 16
    s_cbranch_scc1 L_cv16
    v_cmp_eq_u32 vcc, 0, v83
    s_cbranch_vccnz L_cv16
    v_fmac_f32 v4, s40, v80
    v_fmac_f32 v5, s40, v81
    v_fmac_f32 v6, s40, v82
    s_bitset0_b32 s56, 16
L_cv16:
    s_bitcmp0_b32 s56, 17
    s_cbranch_scc1 L_cv17
    v_cmp_eq_u32 vcc, 0, v87
    s_cbranch_vccnz L_cv17
    v_fmac_f32 v4, s41, v84
    v_fmac_f32 v5, s41, v85
    v_fmac_f32 v6, s41, v86
    s_bitset0_b32 s56, 17
L_cv17:
    s_bitcmp0_b32 s56, 18
    s_cbranch_scc1 L_cv18
    v_cmp_eq_u32 vcc, 0, v91
    s_cbranch_vccnz L_cv18
    v_fmac_f32 v4, s42, v88
    v_fmac_f32 v5, s42, v89
    v_fmac_f32 v6, s42, v90
    s_bitset0_b32 s56, 18
L_cv18:
    s_bitcmp0_b32 s56, 19
    s_cbranch_scc1 L_cv19
    v_cmp_eq_u32 vcc, 0, v95
    s_cbranch_vccnz L_cv19
    v_fmac_f32 v4, s43, v92
    v_fmac_f32 v5, s43, v93
    v_fmac_f32 v6, s43, v94
    s_bitset0_b32 s56, 19
L_cv19:
    s_bitcmp0_b32 s56, 20
    s_cbranch_scc1 L_cv20
    v_cmp_eq_u32 vcc, 0, v99
    s_cbranch_vccnz L_cv20
    v_fmac_f32 v4, s44, v96
    v_fmac_f32 v5, s44, v97
    v_fmac_f32 v6, s44, v98
    s_bitset0_b32 s56, 20
L_cv20:
    s_bitcmp0_b32 s56, 21
    s_cbranch_scc1 L_cv21
    v_cmp_eq_u32 vcc, 0, v103
    s_cbranch_vccnz L_cv21
    v_fmac_f32 v4, s45, v100
    v_fmac_f32 v5, s45, v101
    v_fmac_f32 v6, s45, v102
    s_bitset0_b32 s56, 21
L_cv21:
    s_bitcmp0_b32 s56, 22
    s_cbranch_scc1 L_cv22
    v_cmp_eq_u32 vcc, 0, v107
    s_cbranch_vccnz L_cv22
    v_fmac_f32 v4, s46, v104
    v_fmac_f32 v5, s46, v105
    v_fmac_f32 v6, s46, v106
    s_bitset0_b32 s56, 22
L_cv22:
    s_bitcmp0_b32 s56, 23
    s_cbranch_scc1 L_cv23
    v_cmp_eq_u32 vcc, 0, v111
    s_cbranch_vccnz L_cv23
    v_fmac_f32 v4, s47, v108
    v_fmac_f32 v5, s47, v109
    v_fmac_f32 v6, s47, v110
    s_bitset0_b32 s56, 23
L_cv23:
    s_cmp_lg_u32 s56, 0
    s_cbranch_scc1 L_cr
    v_cvt_pk_bf16_f32 v4, v4, v4
    buffer_store_short v4, v12, s[92:95], s57 offen offset:0
    v_cvt_pk_bf16_f32 v5, v5, v5
    buffer_store_short v5, v12, s[92:95], s57 offen offset:128
    v_cvt_pk_bf16_f32 v6, v6, v6
    buffer_store_short v6, v12, s[92:95], s57 offen offset:256
    s_endpgm
L_h0:
    s_nop 1
    s_mov_b32 s8, s64
    s_and_b32 s9, s65, 0xffff
    s_mov_b32 s10, 12288
    s_mov_b32 s11, 0x00020000
    s_mov_b32 s92, s70
    s_and_b32 s93, s71, 0xffff
    s_mov_b32 s94, 6291456
    s_mov_b32 s95, 0x00020000
    s_mov_b32 s96, s72
    s_and_b32 s97, s73, 0xffff
    s_mov_b32 s98, 6291456
    s_mov_b32 s99, 0x00020000
    v_lshrrev_b32 v4, 4, v1
    v_and_b32 v5, 15, v1
    v_lshlrev_b32 v6, 3, v5
    v_mul_u32_u24 v7, 384, v4
    v_add_u32 v7, v7, v6
    v_lshl_add_u32 v13, v5, 2, v4
    v_lshlrev_b32 v13, 2, v13
    v_lshlrev_b32 v4, 4, v1
    s_mul_i32 s32, s5, 4352
    s_add_u32 s32, s32, s59
    s_lshl_b32 s33, s3, 3
    s_add_u32 s33, s33, s5
    v_and_b32 v14, 7, v1
    v_lshrrev_b32 v10, 3, v1
    v_mul_u32_u24 v8, 24, v10
    v_mov_b32 v11, 768
    v_mad_u32_u24 v8, v14, v11, v8
    v_lshlrev_b32 v14, 7, v14
    v_lshl_add_u32 v14, v10, 4, v14
    s_mul_i32 s33, s33, 4096
    s_add_u32 s33, s33, 2097152
    v_mov_b32 v16, 0
    v_mov_b32 v17, 0
    v_mov_b32 v18, 0
    v_mov_b32 v19, 0
    s_add_u32 s48, s2, 0
    s_lshl_b32 s49, s48, 10
    s_lshl_b32 s48, s48, 6
    s_add_u32 s48, s48, 917504
    buffer_store_dwordx4 v[16:19], v4, s[12:15], s49 offen sc1
    s_mov_b64 exec, 15
    buffer_store_dwordx4 v[16:19], v4, s[12:15], s48 offen sc1
    s_mov_b64 exec, -1
    s_add_u32 s48, s2, 256
    s_lshl_b32 s49, s48, 10
    s_lshl_b32 s48, s48, 6
    s_add_u32 s48, s48, 917504
    buffer_store_dwordx4 v[16:19], v4, s[12:15], s49 offen sc1
    s_mov_b64 exec, 15
    buffer_store_dwordx4 v[16:19], v4, s[12:15], s48 offen sc1
    s_mov_b64 exec, -1
    s_add_u32 s48, s2, 512
    s_lshl_b32 s49, s48, 10
    s_lshl_b32 s48, s48, 6
    s_add_u32 s48, s48, 917504
    buffer_store_dwordx4 v[16:19], v4, s[12:15], s49 offen sc1
    s_mov_b64 exec, 15
    buffer_store_dwordx4 v[16:19], v4, s[12:15], s48 offen sc1
    s_mov_b64 exec, -1
    s_mov_b32 s61, 0
    s_lshl_b32 s62, s61, 5
    s_add_u32 s62, s62, s3
    s_lshl_b32 s63, s62, 15
    s_add_u32 s63, s63, 1
    s_mul_hi_u32 s63, s63, 0xaaaaaaab
    s_lshr_b32 s63, s63, 7
    s_mul_i32 s48, s62, 171
    s_lshr_b32 s48, s48, 9
    s_mul_i32 s48, s48, 384
    s_mul_i32 s49, s4, 24
    s_add_u32 s50, s49, s63
    s_mul_i32 s50, s50, 384
    v_add_u32 v10, s50, v7
    v_add_u32 v11, 3072, v10
    v_add_u32 v12, 6144, v10
    buffer_load_dwordx2 v[100:101], v6, s[8:11], s48 offen offset:0
    buffer_load_dwordx2 v[102:103], v6, s[8:11], s48 offen offset:128
    buffer_load_dwordx2 v[104:105], v6, s[8:11], s48 offen offset:256
    buffer_load_dwordx2 v[28:29], v10, s[92:95], 0 offen offset:0
    buffer_load_dwordx2 v[30:31], v10, s[92:95], 0 offen offset:128
    buffer_load_dwordx2 v[32:33], v10, s[92:95], 0 offen offset:256
    buffer_load_dwordx2 v[64:65], v10, s[96:99], 0 offen offset:0
    buffer_load_dwordx2 v[66:67], v10, s[96:99], 0 offen offset:128
    buffer_load_dwordx2 v[68:69], v10, s[96:99], 0 offen offset:256
    buffer_load_dwordx2 v[34:35], v10, s[92:95], 0 offen offset:1536
    buffer_load_dwordx2 v[36:37], v10, s[92:95], 0 offen offset:1664
    buffer_load_dwordx2 v[38:39], v10, s[92:95], 0 offen offset:1792
    buffer_load_dwordx2 v[70:71], v10, s[96:99], 0 offen offset:1536
    buffer_load_dwordx2 v[72:73], v10, s[96:99], 0 offen offset:1664
    buffer_load_dwordx2 v[74:75], v10, s[96:99], 0 offen offset:1792
    buffer_load_dwordx2 v[40:41], v11, s[92:95], 0 offen offset:0
    buffer_load_dwordx2 v[42:43], v11, s[92:95], 0 offen offset:128
    buffer_load_dwordx2 v[44:45], v11, s[92:95], 0 offen offset:256
    buffer_load_dwordx2 v[76:77], v11, s[96:99], 0 offen offset:0
    buffer_load_dwordx2 v[78:79], v11, s[96:99], 0 offen offset:128
    buffer_load_dwordx2 v[80:81], v11, s[96:99], 0 offen offset:256
    buffer_load_dwordx2 v[46:47], v11, s[92:95], 0 offen offset:1536
    buffer_load_dwordx2 v[48:49], v11, s[92:95], 0 offen offset:1664
    buffer_load_dwordx2 v[50:51], v11, s[92:95], 0 offen offset:1792
    buffer_load_dwordx2 v[82:83], v11, s[96:99], 0 offen offset:1536
    buffer_load_dwordx2 v[84:85], v11, s[96:99], 0 offen offset:1664
    buffer_load_dwordx2 v[86:87], v11, s[96:99], 0 offen offset:1792
    buffer_load_dwordx2 v[52:53], v12, s[92:95], 0 offen offset:0
    buffer_load_dwordx2 v[54:55], v12, s[92:95], 0 offen offset:128
    buffer_load_dwordx2 v[56:57], v12, s[92:95], 0 offen offset:256
    buffer_load_dwordx2 v[88:89], v12, s[96:99], 0 offen offset:0
    buffer_load_dwordx2 v[90:91], v12, s[96:99], 0 offen offset:128
    buffer_load_dwordx2 v[92:93], v12, s[96:99], 0 offen offset:256
    buffer_load_dwordx2 v[58:59], v12, s[92:95], 0 offen offset:1536
    buffer_load_dwordx2 v[60:61], v12, s[92:95], 0 offen offset:1664
    buffer_load_dwordx2 v[62:63], v12, s[92:95], 0 offen offset:1792
    buffer_load_dwordx2 v[94:95], v12, s[96:99], 0 offen offset:1536
    buffer_load_dwordx2 v[96:97], v12, s[96:99], 0 offen offset:1664
    buffer_load_dwordx2 v[98:99], v12, s[96:99], 0 offen offset:1792
    s_waitcnt vmcnt(0)
    v_lshlrev_b32 v16, 16, v100
    v_and_b32 v17, 0xffff0000, v100
    v_lshlrev_b32 v18, 16, v101
    v_and_b32 v19, 0xffff0000, v101
    v_lshlrev_b32 v20, 16, v102
    v_and_b32 v21, 0xffff0000, v102
    v_lshlrev_b32 v22, 16, v103
    v_and_b32 v23, 0xffff0000, v103
    v_lshlrev_b32 v24, 16, v104
    v_and_b32 v25, 0xffff0000, v104
    v_lshlrev_b32 v26, 16, v105
    v_and_b32 v27, 0xffff0000, v105
    v_lshlrev_b32 v10, 16, v28
    v_lshlrev_b32 v11, 16, v64
    v_and_b32 v28, 0xffff0000, v28
    v_and_b32 v64, 0xffff0000, v64
    v_mul_f32 v10, v10, v16
    v_mul_f32 v28, v28, v17
    v_mul_f32 v100, v10, v11
    v_fmac_f32 v100, v28, v64
    v_lshlrev_b32 v10, 16, v29
    v_lshlrev_b32 v11, 16, v65
    v_and_b32 v29, 0xffff0000, v29
    v_and_b32 v65, 0xffff0000, v65
    v_mul_f32 v10, v10, v18
    v_mul_f32 v29, v29, v19
    v_fmac_f32 v100, v10, v11
    v_fmac_f32 v100, v29, v65
    v_lshlrev_b32 v10, 16, v30
    v_lshlrev_b32 v11, 16, v66
    v_and_b32 v30, 0xffff0000, v30
    v_and_b32 v66, 0xffff0000, v66
    v_mul_f32 v10, v10, v20
    v_mul_f32 v30, v30, v21
    v_fmac_f32 v100, v10, v11
    v_fmac_f32 v100, v30, v66
    v_lshlrev_b32 v10, 16, v31
    v_lshlrev_b32 v11, 16, v67
    v_and_b32 v31, 0xffff0000, v31
    v_and_b32 v67, 0xffff0000, v67
    v_mul_f32 v10, v10, v22
    v_mul_f32 v31, v31, v23
    v_fmac_f32 v100, v10, v11
    v_fmac_f32 v100, v31, v67
    v_lshlrev_b32 v10, 16, v32
    v_lshlrev_b32 v11, 16, v68
    v_and_b32 v32, 0xffff0000, v32
    v_and_b32 v68, 0xffff0000, v68
    v_mul_f32 v10, v10, v24
    v_mul_f32 v32, v32, v25
    v_fmac_f32 v100, v10, v11
    v_fmac_f32 v100, v32, v68
    v_lshlrev_b32 v10, 16, v33
    v_lshlrev_b32 v11, 16, v69
    v_and_b32 v33, 0xffff0000, v33
    v_and_b32 v69, 0xffff0000, v69
    v_mul_f32 v10, v10, v26
    v_mul_f32 v33, v33, v27
    v_fmac_f32 v100, v10, v11
    v_fmac_f32 v100, v33, v69
    v_lshlrev_b32 v10, 16, v34
    v_lshlrev_b32 v11, 16, v70
    v_and_b32 v34, 0xffff0000, v34
    v_and_b32 v70, 0xffff0000, v70
    v_mul_f32 v10, v10, v16
    v_mul_f32 v34, v34, v17
    v_mul_f32 v101, v10, v11
    v_fmac_f32 v101, v34, v70
    v_lshlrev_b32 v10, 16, v35
    v_lshlrev_b32 v11, 16, v71
    v_and_b32 v35, 0xffff0000, v35
    v_and_b32 v71, 0xffff0000, v71
    v_mul_f32 v10, v10, v18
    v_mul_f32 v35, v35, v19
    v_fmac_f32 v101, v10, v11
    v_fmac_f32 v101, v35, v71
    v_lshlrev_b32 v10, 16, v36
    v_lshlrev_b32 v11, 16, v72
    v_and_b32 v36, 0xffff0000, v36
    v_and_b32 v72, 0xffff0000, v72
    v_mul_f32 v10, v10, v20
    v_mul_f32 v36, v36, v21
    v_fmac_f32 v101, v10, v11
    v_fmac_f32 v101, v36, v72
    v_lshlrev_b32 v10, 16, v37
    v_lshlrev_b32 v11, 16, v73
    v_and_b32 v37, 0xffff0000, v37
    v_and_b32 v73, 0xffff0000, v73
    v_mul_f32 v10, v10, v22
    v_mul_f32 v37, v37, v23
    v_fmac_f32 v101, v10, v11
    v_fmac_f32 v101, v37, v73
    v_lshlrev_b32 v10, 16, v38
    v_lshlrev_b32 v11, 16, v74
    v_and_b32 v38, 0xffff0000, v38
    v_and_b32 v74, 0xffff0000, v74
    v_mul_f32 v10, v10, v24
    v_mul_f32 v38, v38, v25
    v_fmac_f32 v101, v10, v11
    v_fmac_f32 v101, v38, v74
    v_lshlrev_b32 v10, 16, v39
    v_lshlrev_b32 v11, 16, v75
    v_and_b32 v39, 0xffff0000, v39
    v_and_b32 v75, 0xffff0000, v75
    v_mul_f32 v10, v10, v26
    v_mul_f32 v39, v39, v27
    v_fmac_f32 v101, v10, v11
    v_fmac_f32 v101, v39, v75
    v_lshlrev_b32 v10, 16, v40
    v_lshlrev_b32 v11, 16, v76
    v_and_b32 v40, 0xffff0000, v40
    v_and_b32 v76, 0xffff0000, v76
    v_mul_f32 v10, v10, v16
    v_mul_f32 v40, v40, v17
    v_mul_f32 v102, v10, v11
    v_fmac_f32 v102, v40, v76
    v_lshlrev_b32 v10, 16, v41
    v_lshlrev_b32 v11, 16, v77
    v_and_b32 v41, 0xffff0000, v41
    v_and_b32 v77, 0xffff0000, v77
    v_mul_f32 v10, v10, v18
    v_mul_f32 v41, v41, v19
    v_fmac_f32 v102, v10, v11
    v_fmac_f32 v102, v41, v77
    v_lshlrev_b32 v10, 16, v42
    v_lshlrev_b32 v11, 16, v78
    v_and_b32 v42, 0xffff0000, v42
    v_and_b32 v78, 0xffff0000, v78
    v_mul_f32 v10, v10, v20
    v_mul_f32 v42, v42, v21
    v_fmac_f32 v102, v10, v11
    v_fmac_f32 v102, v42, v78
    v_lshlrev_b32 v10, 16, v43
    v_lshlrev_b32 v11, 16, v79
    v_and_b32 v43, 0xffff0000, v43
    v_and_b32 v79, 0xffff0000, v79
    v_mul_f32 v10, v10, v22
    v_mul_f32 v43, v43, v23
    v_fmac_f32 v102, v10, v11
    v_fmac_f32 v102, v43, v79
    v_lshlrev_b32 v10, 16, v44
    v_lshlrev_b32 v11, 16, v80
    v_and_b32 v44, 0xffff0000, v44
    v_and_b32 v80, 0xffff0000, v80
    v_mul_f32 v10, v10, v24
    v_mul_f32 v44, v44, v25
    v_fmac_f32 v102, v10, v11
    v_fmac_f32 v102, v44, v80
    v_lshlrev_b32 v10, 16, v45
    v_lshlrev_b32 v11, 16, v81
    v_and_b32 v45, 0xffff0000, v45
    v_and_b32 v81, 0xffff0000, v81
    v_mul_f32 v10, v10, v26
    v_mul_f32 v45, v45, v27
    v_fmac_f32 v102, v10, v11
    v_fmac_f32 v102, v45, v81
    v_lshlrev_b32 v10, 16, v46
    v_lshlrev_b32 v11, 16, v82
    v_and_b32 v46, 0xffff0000, v46
    v_and_b32 v82, 0xffff0000, v82
    v_mul_f32 v10, v10, v16
    v_mul_f32 v46, v46, v17
    v_mul_f32 v103, v10, v11
    v_fmac_f32 v103, v46, v82
    v_lshlrev_b32 v10, 16, v47
    v_lshlrev_b32 v11, 16, v83
    v_and_b32 v47, 0xffff0000, v47
    v_and_b32 v83, 0xffff0000, v83
    v_mul_f32 v10, v10, v18
    v_mul_f32 v47, v47, v19
    v_fmac_f32 v103, v10, v11
    v_fmac_f32 v103, v47, v83
    v_lshlrev_b32 v10, 16, v48
    v_lshlrev_b32 v11, 16, v84
    v_and_b32 v48, 0xffff0000, v48
    v_and_b32 v84, 0xffff0000, v84
    v_mul_f32 v10, v10, v20
    v_mul_f32 v48, v48, v21
    v_fmac_f32 v103, v10, v11
    v_fmac_f32 v103, v48, v84
    v_lshlrev_b32 v10, 16, v49
    v_lshlrev_b32 v11, 16, v85
    v_and_b32 v49, 0xffff0000, v49
    v_and_b32 v85, 0xffff0000, v85
    v_mul_f32 v10, v10, v22
    v_mul_f32 v49, v49, v23
    v_fmac_f32 v103, v10, v11
    v_fmac_f32 v103, v49, v85
    v_lshlrev_b32 v10, 16, v50
    v_lshlrev_b32 v11, 16, v86
    v_and_b32 v50, 0xffff0000, v50
    v_and_b32 v86, 0xffff0000, v86
    v_mul_f32 v10, v10, v24
    v_mul_f32 v50, v50, v25
    v_fmac_f32 v103, v10, v11
    v_fmac_f32 v103, v50, v86
    v_lshlrev_b32 v10, 16, v51
    v_lshlrev_b32 v11, 16, v87
    v_and_b32 v51, 0xffff0000, v51
    v_and_b32 v87, 0xffff0000, v87
    v_mul_f32 v10, v10, v26
    v_mul_f32 v51, v51, v27
    v_fmac_f32 v103, v10, v11
    v_fmac_f32 v103, v51, v87
    v_lshlrev_b32 v10, 16, v52
    v_lshlrev_b32 v11, 16, v88
    v_and_b32 v52, 0xffff0000, v52
    v_and_b32 v88, 0xffff0000, v88
    v_mul_f32 v10, v10, v16
    v_mul_f32 v52, v52, v17
    v_mul_f32 v104, v10, v11
    v_fmac_f32 v104, v52, v88
    v_lshlrev_b32 v10, 16, v53
    v_lshlrev_b32 v11, 16, v89
    v_and_b32 v53, 0xffff0000, v53
    v_and_b32 v89, 0xffff0000, v89
    v_mul_f32 v10, v10, v18
    v_mul_f32 v53, v53, v19
    v_fmac_f32 v104, v10, v11
    v_fmac_f32 v104, v53, v89
    v_lshlrev_b32 v10, 16, v54
    v_lshlrev_b32 v11, 16, v90
    v_and_b32 v54, 0xffff0000, v54
    v_and_b32 v90, 0xffff0000, v90
    v_mul_f32 v10, v10, v20
    v_mul_f32 v54, v54, v21
    v_fmac_f32 v104, v10, v11
    v_fmac_f32 v104, v54, v90
    v_lshlrev_b32 v10, 16, v55
    v_lshlrev_b32 v11, 16, v91
    v_and_b32 v55, 0xffff0000, v55
    v_and_b32 v91, 0xffff0000, v91
    v_mul_f32 v10, v10, v22
    v_mul_f32 v55, v55, v23
    v_fmac_f32 v104, v10, v11
    v_fmac_f32 v104, v55, v91
    v_lshlrev_b32 v10, 16, v56
    v_lshlrev_b32 v11, 16, v92
    v_and_b32 v56, 0xffff0000, v56
    v_and_b32 v92, 0xffff0000, v92
    v_mul_f32 v10, v10, v24
    v_mul_f32 v56, v56, v25
    v_fmac_f32 v104, v10, v11
    v_fmac_f32 v104, v56, v92
    v_lshlrev_b32 v10, 16, v57
    v_lshlrev_b32 v11, 16, v93
    v_and_b32 v57, 0xffff0000, v57
    v_and_b32 v93, 0xffff0000, v93
    v_mul_f32 v10, v10, v26
    v_mul_f32 v57, v57, v27
    v_fmac_f32 v104, v10, v11
    v_fmac_f32 v104, v57, v93
    v_lshlrev_b32 v10, 16, v58
    v_lshlrev_b32 v11, 16, v94
    v_and_b32 v58, 0xffff0000, v58
    v_and_b32 v94, 0xffff0000, v94
    v_mul_f32 v10, v10, v16
    v_mul_f32 v58, v58, v17
    v_mul_f32 v105, v10, v11
    v_fmac_f32 v105, v58, v94
    v_lshlrev_b32 v10, 16, v59
    v_lshlrev_b32 v11, 16, v95
    v_and_b32 v59, 0xffff0000, v59
    v_and_b32 v95, 0xffff0000, v95
    v_mul_f32 v10, v10, v18
    v_mul_f32 v59, v59, v19
    v_fmac_f32 v105, v10, v11
    v_fmac_f32 v105, v59, v95
    v_lshlrev_b32 v10, 16, v60
    v_lshlrev_b32 v11, 16, v96
    v_and_b32 v60, 0xffff0000, v60
    v_and_b32 v96, 0xffff0000, v96
    v_mul_f32 v10, v10, v20
    v_mul_f32 v60, v60, v21
    v_fmac_f32 v105, v10, v11
    v_fmac_f32 v105, v60, v96
    v_lshlrev_b32 v10, 16, v61
    v_lshlrev_b32 v11, 16, v97
    v_and_b32 v61, 0xffff0000, v61
    v_and_b32 v97, 0xffff0000, v97
    v_mul_f32 v10, v10, v22
    v_mul_f32 v61, v61, v23
    v_fmac_f32 v105, v10, v11
    v_fmac_f32 v105, v61, v97
    v_lshlrev_b32 v10, 16, v62
    v_lshlrev_b32 v11, 16, v98
    v_and_b32 v62, 0xffff0000, v62
    v_and_b32 v98, 0xffff0000, v98
    v_mul_f32 v10, v10, v24
    v_mul_f32 v62, v62, v25
    v_fmac_f32 v105, v10, v11
    v_fmac_f32 v105, v62, v98
    v_lshlrev_b32 v10, 16, v63
    v_lshlrev_b32 v11, 16, v99
    v_and_b32 v63, 0xffff0000, v63
    v_and_b32 v99, 0xffff0000, v99
    v_mul_f32 v10, v10, v26
    v_mul_f32 v63, v63, v27
    v_fmac_f32 v105, v10, v11
    v_fmac_f32 v105, v63, v99
    v_add_f32_dpp v100, v100, v100 row_ror:8 row_mask:0xf bank_mask:0xf
    v_add_f32_dpp v101, v101, v101 row_ror:8 row_mask:0xf bank_mask:0xf
    v_add_f32_dpp v102, v102, v102 row_ror:8 row_mask:0xf bank_mask:0xf
    v_add_f32_dpp v103, v103, v103 row_ror:8 row_mask:0xf bank_mask:0xf
    v_add_f32_dpp v104, v104, v104 row_ror:8 row_mask:0xf bank_mask:0xf
    v_add_f32_dpp v105, v105, v105 row_ror:8 row_mask:0xf bank_mask:0xf
    v_add_f32_dpp v100, v100, v100 row_ror:4 row_mask:0xf bank_mask:0xf
    v_add_f32_dpp v101, v101, v101 row_ror:4 row_mask:0xf bank_mask:0xf
    v_add_f32_dpp v102, v102, v102 row_ror:4 row_mask:0xf bank_mask:0xf
    v_add_f32_dpp v103, v103, v103 row_ror:4 row_mask:0xf bank_mask:0xf
    v_add_f32_dpp v104, v104, v104 row_ror:4 row_mask:0xf bank_mask:0xf
    v_add_f32_dpp v105, v105, v105 row_ror:4 row_mask:0xf bank_mask:0xf
    v_add_f32_dpp v100, v100, v100 row_ror:2 row_mask:0xf bank_mask:0xf
    v_add_f32_dpp v101, v101, v101 row_ror:2 row_mask:0xf bank_mask:0xf
    v_add_f32_dpp v102, v102, v102 row_ror:2 row_mask:0xf bank_mask:0xf
    v_add_f32_dpp v103, v103, v103 row_ror:2 row_mask:0xf bank_mask:0xf
    v_add_f32_dpp v104, v104, v104 row_ror:2 row_mask:0xf bank_mask:0xf
    v_add_f32_dpp v105, v105, v105 row_ror:2 row_mask:0xf bank_mask:0xf
    v_add_f32_dpp v100, v100, v100 row_ror:1 row_mask:0xf bank_mask:0xf
    v_add_f32_dpp v101, v101, v101 row_ror:1 row_mask:0xf bank_mask:0xf
    v_add_f32_dpp v102, v102, v102 row_ror:1 row_mask:0xf bank_mask:0xf
    v_add_f32_dpp v103, v103, v103 row_ror:1 row_mask:0xf bank_mask:0xf
    v_add_f32_dpp v104, v104, v104 row_ror:1 row_mask:0xf bank_mask:0xf
    v_add_f32_dpp v105, v105, v105 row_ror:1 row_mask:0xf bank_mask:0xf
    v_cmp_eq_u32 vcc, 1, v5
    s_nop 1
    v_cndmask_b32 v100, v100, v101, vcc
    v_cmp_eq_u32 vcc, 2, v5
    s_nop 1
    v_cndmask_b32 v100, v100, v102, vcc
    v_cmp_eq_u32 vcc, 3, v5
    s_nop 1
    v_cndmask_b32 v100, v100, v103, vcc
    v_cmp_eq_u32 vcc, 4, v5
    s_nop 1
    v_cndmask_b32 v100, v100, v104, vcc
    v_cmp_eq_u32 vcc, 5, v5
    s_nop 1
    v_cndmask_b32 v100, v100, v105, vcc
    s_mul_i32 s48, s62, 768
    s_lshl_b32 s49, s49, 2
    s_add_u32 s48, s48, s49
    s_add_u32 s48, s48, 1179648
    s_mov_b32 exec_lo, 0x003f003f
    s_mov_b32 exec_hi, 0x003f003f
    buffer_store_dword v100, v13, s[12:15], s48 offen sc1
    s_mov_b64 exec, -1
    s_mov_b32 s60, 0x100000
L_wb1:
    s_nop 1
    ds_read_b32 v10, v2 offset:60
    s_sub_u32 s60, s60, 1
    s_cbranch_scc1 L_exit1
    s_waitcnt lgkmcnt(0)
    v_readfirstlane_b32 s48, v10
    s_cmp_lt_u32 s48, 1
    s_cbranch_scc1 L_wb1
    s_mov_b32 s61, 1
    s_lshl_b32 s62, s61, 5
    s_add_u32 s62, s62, s3
    s_lshl_b32 s63, s62, 15
    s_add_u32 s63, s63, 1
    s_mul_hi_u32 s63, s63, 0xaaaaaaab
    s_lshr_b32 s63, s63, 7
    s_mul_i32 s48, s62, 171
    s_lshr_b32 s48, s48, 9
    s_mul_i32 s48, s48, 384
    s_mul_i32 s49, s4, 24
    s_add_u32 s50, s49, s63
    s_mul_i32 s50, s50, 384
    v_add_u32 v10, s50, v7
    v_add_u32 v11, 3072, v10
    v_add_u32 v12, 6144, v10
    buffer_load_dwordx2 v[100:101], v6, s[8:11], s48 offen offset:0
    buffer_load_dwordx2 v[102:103], v6, s[8:11], s48 offen offset:128
    buffer_load_dwordx2 v[104:105], v6, s[8:11], s48 offen offset:256
    buffer_load_dwordx2 v[28:29], v10, s[92:95], 0 offen offset:0
    buffer_load_dwordx2 v[30:31], v10, s[92:95], 0 offen offset:128
    buffer_load_dwordx2 v[32:33], v10, s[92:95], 0 offen offset:256
    buffer_load_dwordx2 v[64:65], v10, s[96:99], 0 offen offset:0
    buffer_load_dwordx2 v[66:67], v10, s[96:99], 0 offen offset:128
    buffer_load_dwordx2 v[68:69], v10, s[96:99], 0 offen offset:256
    buffer_load_dwordx2 v[34:35], v10, s[92:95], 0 offen offset:1536
    buffer_load_dwordx2 v[36:37], v10, s[92:95], 0 offen offset:1664
    buffer_load_dwordx2 v[38:39], v10, s[92:95], 0 offen offset:1792
    buffer_load_dwordx2 v[70:71], v10, s[96:99], 0 offen offset:1536
    buffer_load_dwordx2 v[72:73], v10, s[96:99], 0 offen offset:1664
    buffer_load_dwordx2 v[74:75], v10, s[96:99], 0 offen offset:1792
    buffer_load_dwordx2 v[40:41], v11, s[92:95], 0 offen offset:0
    buffer_load_dwordx2 v[42:43], v11, s[92:95], 0 offen offset:128
    buffer_load_dwordx2 v[44:45], v11, s[92:95], 0 offen offset:256
    buffer_load_dwordx2 v[76:77], v11, s[96:99], 0 offen offset:0
    buffer_load_dwordx2 v[78:79], v11, s[96:99], 0 offen offset:128
    buffer_load_dwordx2 v[80:81], v11, s[96:99], 0 offen offset:256
    buffer_load_dwordx2 v[46:47], v11, s[92:95], 0 offen offset:1536
    buffer_load_dwordx2 v[48:49], v11, s[92:95], 0 offen offset:1664
    buffer_load_dwordx2 v[50:51], v11, s[92:95], 0 offen offset:1792
    buffer_load_dwordx2 v[82:83], v11, s[96:99], 0 offen offset:1536
    buffer_load_dwordx2 v[84:85], v11, s[96:99], 0 offen offset:1664
    buffer_load_dwordx2 v[86:87], v11, s[96:99], 0 offen offset:1792
    buffer_load_dwordx2 v[52:53], v12, s[92:95], 0 offen offset:0
    buffer_load_dwordx2 v[54:55], v12, s[92:95], 0 offen offset:128
    buffer_load_dwordx2 v[56:57], v12, s[92:95], 0 offen offset:256
    buffer_load_dwordx2 v[88:89], v12, s[96:99], 0 offen offset:0
    buffer_load_dwordx2 v[90:91], v12, s[96:99], 0 offen offset:128
    buffer_load_dwordx2 v[92:93], v12, s[96:99], 0 offen offset:256
    buffer_load_dwordx2 v[58:59], v12, s[92:95], 0 offen offset:1536
    buffer_load_dwordx2 v[60:61], v12, s[92:95], 0 offen offset:1664
    buffer_load_dwordx2 v[62:63], v12, s[92:95], 0 offen offset:1792
    buffer_load_dwordx2 v[94:95], v12, s[96:99], 0 offen offset:1536
    buffer_load_dwordx2 v[96:97], v12, s[96:99], 0 offen offset:1664
    buffer_load_dwordx2 v[98:99], v12, s[96:99], 0 offen offset:1792
    s_waitcnt vmcnt(0)
    v_lshlrev_b32 v16, 16, v100
    v_and_b32 v17, 0xffff0000, v100
    v_lshlrev_b32 v18, 16, v101
    v_and_b32 v19, 0xffff0000, v101
    v_lshlrev_b32 v20, 16, v102
    v_and_b32 v21, 0xffff0000, v102
    v_lshlrev_b32 v22, 16, v103
    v_and_b32 v23, 0xffff0000, v103
    v_lshlrev_b32 v24, 16, v104
    v_and_b32 v25, 0xffff0000, v104
    v_lshlrev_b32 v26, 16, v105
    v_and_b32 v27, 0xffff0000, v105
    v_lshlrev_b32 v10, 16, v28
    v_lshlrev_b32 v11, 16, v64
    v_and_b32 v28, 0xffff0000, v28
    v_and_b32 v64, 0xffff0000, v64
    v_mul_f32 v10, v10, v16
    v_mul_f32 v28, v28, v17
    v_mul_f32 v100, v10, v11
    v_fmac_f32 v100, v28, v64
    v_lshlrev_b32 v10, 16, v29
    v_lshlrev_b32 v11, 16, v65
    v_and_b32 v29, 0xffff0000, v29
    v_and_b32 v65, 0xffff0000, v65
    v_mul_f32 v10, v10, v18
    v_mul_f32 v29, v29, v19
    v_fmac_f32 v100, v10, v11
    v_fmac_f32 v100, v29, v65
    v_lshlrev_b32 v10, 16, v30
    v_lshlrev_b32 v11, 16, v66
    v_and_b32 v30, 0xffff0000, v30
    v_and_b32 v66, 0xffff0000, v66
    v_mul_f32 v10, v10, v20
    v_mul_f32 v30, v30, v21
    v_fmac_f32 v100, v10, v11
    v_fmac_f32 v100, v30, v66
    v_lshlrev_b32 v10, 16, v31
    v_lshlrev_b32 v11, 16, v67
    v_and_b32 v31, 0xffff0000, v31
    v_and_b32 v67, 0xffff0000, v67
    v_mul_f32 v10, v10, v22
    v_mul_f32 v31, v31, v23
    v_fmac_f32 v100, v10, v11
    v_fmac_f32 v100, v31, v67
    v_lshlrev_b32 v10, 16, v32
    v_lshlrev_b32 v11, 16, v68
    v_and_b32 v32, 0xffff0000, v32
    v_and_b32 v68, 0xffff0000, v68
    v_mul_f32 v10, v10, v24
    v_mul_f32 v32, v32, v25
    v_fmac_f32 v100, v10, v11
    v_fmac_f32 v100, v32, v68
    v_lshlrev_b32 v10, 16, v33
    v_lshlrev_b32 v11, 16, v69
    v_and_b32 v33, 0xffff0000, v33
    v_and_b32 v69, 0xffff0000, v69
    v_mul_f32 v10, v10, v26
    v_mul_f32 v33, v33, v27
    v_fmac_f32 v100, v10, v11
    v_fmac_f32 v100, v33, v69
    v_lshlrev_b32 v10, 16, v34
    v_lshlrev_b32 v11, 16, v70
    v_and_b32 v34, 0xffff0000, v34
    v_and_b32 v70, 0xffff0000, v70
    v_mul_f32 v10, v10, v16
    v_mul_f32 v34, v34, v17
    v_mul_f32 v101, v10, v11
    v_fmac_f32 v101, v34, v70
    v_lshlrev_b32 v10, 16, v35
    v_lshlrev_b32 v11, 16, v71
    v_and_b32 v35, 0xffff0000, v35
    v_and_b32 v71, 0xffff0000, v71
    v_mul_f32 v10, v10, v18
    v_mul_f32 v35, v35, v19
    v_fmac_f32 v101, v10, v11
    v_fmac_f32 v101, v35, v71
    v_lshlrev_b32 v10, 16, v36
    v_lshlrev_b32 v11, 16, v72
    v_and_b32 v36, 0xffff0000, v36
    v_and_b32 v72, 0xffff0000, v72
    v_mul_f32 v10, v10, v20
    v_mul_f32 v36, v36, v21
    v_fmac_f32 v101, v10, v11
    v_fmac_f32 v101, v36, v72
    v_lshlrev_b32 v10, 16, v37
    v_lshlrev_b32 v11, 16, v73
    v_and_b32 v37, 0xffff0000, v37
    v_and_b32 v73, 0xffff0000, v73
    v_mul_f32 v10, v10, v22
    v_mul_f32 v37, v37, v23
    v_fmac_f32 v101, v10, v11
    v_fmac_f32 v101, v37, v73
    v_lshlrev_b32 v10, 16, v38
    v_lshlrev_b32 v11, 16, v74
    v_and_b32 v38, 0xffff0000, v38
    v_and_b32 v74, 0xffff0000, v74
    v_mul_f32 v10, v10, v24
    v_mul_f32 v38, v38, v25
    v_fmac_f32 v101, v10, v11
    v_fmac_f32 v101, v38, v74
    v_lshlrev_b32 v10, 16, v39
    v_lshlrev_b32 v11, 16, v75
    v_and_b32 v39, 0xffff0000, v39
    v_and_b32 v75, 0xffff0000, v75
    v_mul_f32 v10, v10, v26
    v_mul_f32 v39, v39, v27
    v_fmac_f32 v101, v10, v11
    v_fmac_f32 v101, v39, v75
    v_lshlrev_b32 v10, 16, v40
    v_lshlrev_b32 v11, 16, v76
    v_and_b32 v40, 0xffff0000, v40
    v_and_b32 v76, 0xffff0000, v76
    v_mul_f32 v10, v10, v16
    v_mul_f32 v40, v40, v17
    v_mul_f32 v102, v10, v11
    v_fmac_f32 v102, v40, v76
    v_lshlrev_b32 v10, 16, v41
    v_lshlrev_b32 v11, 16, v77
    v_and_b32 v41, 0xffff0000, v41
    v_and_b32 v77, 0xffff0000, v77
    v_mul_f32 v10, v10, v18
    v_mul_f32 v41, v41, v19
    v_fmac_f32 v102, v10, v11
    v_fmac_f32 v102, v41, v77
    v_lshlrev_b32 v10, 16, v42
    v_lshlrev_b32 v11, 16, v78
    v_and_b32 v42, 0xffff0000, v42
    v_and_b32 v78, 0xffff0000, v78
    v_mul_f32 v10, v10, v20
    v_mul_f32 v42, v42, v21
    v_fmac_f32 v102, v10, v11
    v_fmac_f32 v102, v42, v78
    v_lshlrev_b32 v10, 16, v43
    v_lshlrev_b32 v11, 16, v79
    v_and_b32 v43, 0xffff0000, v43
    v_and_b32 v79, 0xffff0000, v79
    v_mul_f32 v10, v10, v22
    v_mul_f32 v43, v43, v23
    v_fmac_f32 v102, v10, v11
    v_fmac_f32 v102, v43, v79
    v_lshlrev_b32 v10, 16, v44
    v_lshlrev_b32 v11, 16, v80
    v_and_b32 v44, 0xffff0000, v44
    v_and_b32 v80, 0xffff0000, v80
    v_mul_f32 v10, v10, v24
    v_mul_f32 v44, v44, v25
    v_fmac_f32 v102, v10, v11
    v_fmac_f32 v102, v44, v80
    v_lshlrev_b32 v10, 16, v45
    v_lshlrev_b32 v11, 16, v81
    v_and_b32 v45, 0xffff0000, v45
    v_and_b32 v81, 0xffff0000, v81
    v_mul_f32 v10, v10, v26
    v_mul_f32 v45, v45, v27
    v_fmac_f32 v102, v10, v11
    v_fmac_f32 v102, v45, v81
    v_lshlrev_b32 v10, 16, v46
    v_lshlrev_b32 v11, 16, v82
    v_and_b32 v46, 0xffff0000, v46
    v_and_b32 v82, 0xffff0000, v82
    v_mul_f32 v10, v10, v16
    v_mul_f32 v46, v46, v17
    v_mul_f32 v103, v10, v11
    v_fmac_f32 v103, v46, v82
    v_lshlrev_b32 v10, 16, v47
    v_lshlrev_b32 v11, 16, v83
    v_and_b32 v47, 0xffff0000, v47
    v_and_b32 v83, 0xffff0000, v83
    v_mul_f32 v10, v10, v18
    v_mul_f32 v47, v47, v19
    v_fmac_f32 v103, v10, v11
    v_fmac_f32 v103, v47, v83
    v_lshlrev_b32 v10, 16, v48
    v_lshlrev_b32 v11, 16, v84
    v_and_b32 v48, 0xffff0000, v48
    v_and_b32 v84, 0xffff0000, v84
    v_mul_f32 v10, v10, v20
    v_mul_f32 v48, v48, v21
    v_fmac_f32 v103, v10, v11
    v_fmac_f32 v103, v48, v84
    v_lshlrev_b32 v10, 16, v49
    v_lshlrev_b32 v11, 16, v85
    v_and_b32 v49, 0xffff0000, v49
    v_and_b32 v85, 0xffff0000, v85
    v_mul_f32 v10, v10, v22
    v_mul_f32 v49, v49, v23
    v_fmac_f32 v103, v10, v11
    v_fmac_f32 v103, v49, v85
    v_lshlrev_b32 v10, 16, v50
    v_lshlrev_b32 v11, 16, v86
    v_and_b32 v50, 0xffff0000, v50
    v_and_b32 v86, 0xffff0000, v86
    v_mul_f32 v10, v10, v24
    v_mul_f32 v50, v50, v25
    v_fmac_f32 v103, v10, v11
    v_fmac_f32 v103, v50, v86
    v_lshlrev_b32 v10, 16, v51
    v_lshlrev_b32 v11, 16, v87
    v_and_b32 v51, 0xffff0000, v51
    v_and_b32 v87, 0xffff0000, v87
    v_mul_f32 v10, v10, v26
    v_mul_f32 v51, v51, v27
    v_fmac_f32 v103, v10, v11
    v_fmac_f32 v103, v51, v87
    v_lshlrev_b32 v10, 16, v52
    v_lshlrev_b32 v11, 16, v88
    v_and_b32 v52, 0xffff0000, v52
    v_and_b32 v88, 0xffff0000, v88
    v_mul_f32 v10, v10, v16
    v_mul_f32 v52, v52, v17
    v_mul_f32 v104, v10, v11
    v_fmac_f32 v104, v52, v88
    v_lshlrev_b32 v10, 16, v53
    v_lshlrev_b32 v11, 16, v89
    v_and_b32 v53, 0xffff0000, v53
    v_and_b32 v89, 0xffff0000, v89
    v_mul_f32 v10, v10, v18
    v_mul_f32 v53, v53, v19
    v_fmac_f32 v104, v10, v11
    v_fmac_f32 v104, v53, v89
    v_lshlrev_b32 v10, 16, v54
    v_lshlrev_b32 v11, 16, v90
    v_and_b32 v54, 0xffff0000, v54
    v_and_b32 v90, 0xffff0000, v90
    v_mul_f32 v10, v10, v20
    v_mul_f32 v54, v54, v21
    v_fmac_f32 v104, v10, v11
    v_fmac_f32 v104, v54, v90
    v_lshlrev_b32 v10, 16, v55
    v_lshlrev_b32 v11, 16, v91
    v_and_b32 v55, 0xffff0000, v55
    v_and_b32 v91, 0xffff0000, v91
    v_mul_f32 v10, v10, v22
    v_mul_f32 v55, v55, v23
    v_fmac_f32 v104, v10, v11
    v_fmac_f32 v104, v55, v91
    v_lshlrev_b32 v10, 16, v56
    v_lshlrev_b32 v11, 16, v92
    v_and_b32 v56, 0xffff0000, v56
    v_and_b32 v92, 0xffff0000, v92
    v_mul_f32 v10, v10, v24
    v_mul_f32 v56, v56, v25
    v_fmac_f32 v104, v10, v11
    v_fmac_f32 v104, v56, v92
    v_lshlrev_b32 v10, 16, v57
    v_lshlrev_b32 v11, 16, v93
    v_and_b32 v57, 0xffff0000, v57
    v_and_b32 v93, 0xffff0000, v93
    v_mul_f32 v10, v10, v26
    v_mul_f32 v57, v57, v27
    v_fmac_f32 v104, v10, v11
    v_fmac_f32 v104, v57, v93
    v_lshlrev_b32 v10, 16, v58
    v_lshlrev_b32 v11, 16, v94
    v_and_b32 v58, 0xffff0000, v58
    v_and_b32 v94, 0xffff0000, v94
    v_mul_f32 v10, v10, v16
    v_mul_f32 v58, v58, v17
    v_mul_f32 v105, v10, v11
    v_fmac_f32 v105, v58, v94
    v_lshlrev_b32 v10, 16, v59
    v_lshlrev_b32 v11, 16, v95
    v_and_b32 v59, 0xffff0000, v59
    v_and_b32 v95, 0xffff0000, v95
    v_mul_f32 v10, v10, v18
    v_mul_f32 v59, v59, v19
    v_fmac_f32 v105, v10, v11
    v_fmac_f32 v105, v59, v95
    v_lshlrev_b32 v10, 16, v60
    v_lshlrev_b32 v11, 16, v96
    v_and_b32 v60, 0xffff0000, v60
    v_and_b32 v96, 0xffff0000, v96
    v_mul_f32 v10, v10, v20
    v_mul_f32 v60, v60, v21
    v_fmac_f32 v105, v10, v11
    v_fmac_f32 v105, v60, v96
    v_lshlrev_b32 v10, 16, v61
    v_lshlrev_b32 v11, 16, v97
    v_and_b32 v61, 0xffff0000, v61
    v_and_b32 v97, 0xffff0000, v97
    v_mul_f32 v10, v10, v22
    v_mul_f32 v61, v61, v23
    v_fmac_f32 v105, v10, v11
    v_fmac_f32 v105, v61, v97
    v_lshlrev_b32 v10, 16, v62
    v_lshlrev_b32 v11, 16, v98
    v_and_b32 v62, 0xffff0000, v62
    v_and_b32 v98, 0xffff0000, v98
    v_mul_f32 v10, v10, v24
    v_mul_f32 v62, v62, v25
    v_fmac_f32 v105, v10, v11
    v_fmac_f32 v105, v62, v98
    v_lshlrev_b32 v10, 16, v63
    v_lshlrev_b32 v11, 16, v99
    v_and_b32 v63, 0xffff0000, v63
    v_and_b32 v99, 0xffff0000, v99
    v_mul_f32 v10, v10, v26
    v_mul_f32 v63, v63, v27
    v_fmac_f32 v105, v10, v11
    v_fmac_f32 v105, v63, v99
    v_add_f32_dpp v100, v100, v100 row_ror:8 row_mask:0xf bank_mask:0xf
    v_add_f32_dpp v101, v101, v101 row_ror:8 row_mask:0xf bank_mask:0xf
    v_add_f32_dpp v102, v102, v102 row_ror:8 row_mask:0xf bank_mask:0xf
    v_add_f32_dpp v103, v103, v103 row_ror:8 row_mask:0xf bank_mask:0xf
    v_add_f32_dpp v104, v104, v104 row_ror:8 row_mask:0xf bank_mask:0xf
    v_add_f32_dpp v105, v105, v105 row_ror:8 row_mask:0xf bank_mask:0xf
    v_add_f32_dpp v100, v100, v100 row_ror:4 row_mask:0xf bank_mask:0xf
    v_add_f32_dpp v101, v101, v101 row_ror:4 row_mask:0xf bank_mask:0xf
    v_add_f32_dpp v102, v102, v102 row_ror:4 row_mask:0xf bank_mask:0xf
    v_add_f32_dpp v103, v103, v103 row_ror:4 row_mask:0xf bank_mask:0xf
    v_add_f32_dpp v104, v104, v104 row_ror:4 row_mask:0xf bank_mask:0xf
    v_add_f32_dpp v105, v105, v105 row_ror:4 row_mask:0xf bank_mask:0xf
    v_add_f32_dpp v100, v100, v100 row_ror:2 row_mask:0xf bank_mask:0xf
    v_add_f32_dpp v101, v101, v101 row_ror:2 row_mask:0xf bank_mask:0xf
    v_add_f32_dpp v102, v102, v102 row_ror:2 row_mask:0xf bank_mask:0xf
    v_add_f32_dpp v103, v103, v103 row_ror:2 row_mask:0xf bank_mask:0xf
    v_add_f32_dpp v104, v104, v104 row_ror:2 row_mask:0xf bank_mask:0xf
    v_add_f32_dpp v105, v105, v105 row_ror:2 row_mask:0xf bank_mask:0xf
    v_add_f32_dpp v100, v100, v100 row_ror:1 row_mask:0xf bank_mask:0xf
    v_add_f32_dpp v101, v101, v101 row_ror:1 row_mask:0xf bank_mask:0xf
    v_add_f32_dpp v102, v102, v102 row_ror:1 row_mask:0xf bank_mask:0xf
    v_add_f32_dpp v103, v103, v103 row_ror:1 row_mask:0xf bank_mask:0xf
    v_add_f32_dpp v104, v104, v104 row_ror:1 row_mask:0xf bank_mask:0xf
    v_add_f32_dpp v105, v105, v105 row_ror:1 row_mask:0xf bank_mask:0xf
    v_cmp_eq_u32 vcc, 1, v5
    s_nop 1
    v_cndmask_b32 v100, v100, v101, vcc
    v_cmp_eq_u32 vcc, 2, v5
    s_nop 1
    v_cndmask_b32 v100, v100, v102, vcc
    v_cmp_eq_u32 vcc, 3, v5
    s_nop 1
    v_cndmask_b32 v100, v100, v103, vcc
    v_cmp_eq_u32 vcc, 4, v5
    s_nop 1
    v_cndmask_b32 v100, v100, v104, vcc
    v_cmp_eq_u32 vcc, 5, v5
    s_nop 1
    v_cndmask_b32 v100, v100, v105, vcc
    s_mul_i32 s48, s62, 768
    s_lshl_b32 s49, s49, 2
    s_add_u32 s48, s48, s49
    s_add_u32 s48, s48, 1179648
    s_mov_b32 exec_lo, 0x003f003f
    s_mov_b32 exec_hi, 0x003f003f
    buffer_store_dword v100, v13, s[12:15], s48 offen sc1
    s_mov_b64 exec, -1
    s_mov_b32 s60, 0x100000
L_wd0:
    s_nop 1
    ds_read_b32 v10, v2 offset:20
    s_sub_u32 s60, s60, 1
    s_cbranch_scc1 L_exit1
    s_waitcnt lgkmcnt(0)
    v_readfirstlane_b32 s48, v10
    s_cmp_eq_u32 s48, 0
    s_cbranch_scc1 L_wd0
    ds_read_b128 v[16:19], v2 offset:0
    ds_read_b64 v[20:21], v2 offset:16
    s_waitcnt lgkmcnt(0)
    v_readfirstlane_b32 s84, v16
    v_readfirstlane_b32 s85, v17
    v_readfirstlane_b32 s86, v18
    v_readfirstlane_b32 s87, v19
    v_readfirstlane_b32 s88, v20
    v_readfirstlane_b32 s89, v21
    s_mov_b32 s60, 0x100000
L_wf0:
    s_nop 1
    ds_read_b32 v10, v2 offset:40
    s_sub_u32 s60, s60, 1
    s_cbranch_scc1 L_exit1
    s_waitcnt lgkmcnt(0)
    v_readfirstlane_b32 s48, v10
    s_cmp_lt_u32 s48, 4
    s_cbranch_scc1 L_wf0
    s_cmp_eq_u32 s84, s87
    ds_read_b64 v[16:17], v8 offset:256
    ds_read_b64 v[18:19], v8 offset:264
    ds_read_b64 v[20:21], v8 offset:272
    ds_read_b64 v[28:29], v8 offset:448
    ds_read_b64 v[30:31], v8 offset:456
    ds_read_b64 v[32:33], v8 offset:464
    ds_read_b64 v[40:41], v8 offset:640
    ds_read_b64 v[42:43], v8 offset:648
    ds_read_b64 v[44:45], v8 offset:656
    ds_read_b64 v[52:53], v8 offset:832
    ds_read_b64 v[54:55], v8 offset:840
    ds_read_b64 v[56:57], v8 offset:848
    s_add_u32 s54, s33, 0
    s_cmp_eq_u32 s84, s87
    s_waitcnt lgkmcnt(0)
    v_cmp_eq_f32 vcc, 0, v21
    v_max3_f32 v25, v16, v17, v18
    s_nop 0
    v_cndmask_b32 v24, v21, v20, vcc
    v_max3_f32 v25, v25, v19, v20
    v_max_f32 v24, v24, v25
    v_sub_f32 v16, v16, v24
    v_sub_f32 v17, v17, v24
    v_sub_f32 v18, v18, v24
    v_sub_f32 v19, v19, v24
    v_sub_f32 v20, v20, v24
    v_sub_f32 v21, v21, v24
    v_cvt_pk_f16_f32 v25, v16, v17
    v_cvt_pk_f16_f32 v26, v18, v19
    v_cvt_pk_f16_f32 v27, v20, v21
    buffer_store_dwordx4 v[24:27], v14, s[12:15], s54 offen offset:0 sc1
    s_cbranch_scc1 L_fl0
    v_cmp_eq_f32 vcc, 0, v33
    v_max3_f32 v37, v28, v29, v30
    s_nop 0
    v_cndmask_b32 v36, v33, v32, vcc
    v_max3_f32 v37, v37, v31, v32
    v_max_f32 v36, v36, v37
    v_sub_f32 v28, v28, v36
    v_sub_f32 v29, v29, v36
    v_sub_f32 v30, v30, v36
    v_sub_f32 v31, v31, v36
    v_sub_f32 v32, v32, v36
    v_sub_f32 v33, v33, v36
    v_cvt_pk_f16_f32 v37, v28, v29
    v_cvt_pk_f16_f32 v38, v30, v31
    v_cvt_pk_f16_f32 v39, v32, v33
    buffer_store_dwordx4 v[36:39], v14, s[12:15], s54 offen offset:1024 sc1
    v_cmp_eq_f32 vcc, 0, v45
    v_max3_f32 v49, v40, v41, v42
    s_nop 0
    v_cndmask_b32 v48, v45, v44, vcc
    v_max3_f32 v49, v49, v43, v44
    v_max_f32 v48, v48, v49
    v_sub_f32 v40, v40, v48
    v_sub_f32 v41, v41, v48
    v_sub_f32 v42, v42, v48
    v_sub_f32 v43, v43, v48
    v_sub_f32 v44, v44, v48
    v_sub_f32 v45, v45, v48
    v_cvt_pk_f16_f32 v49, v40, v41
    v_cvt_pk_f16_f32 v50, v42, v43
    v_cvt_pk_f16_f32 v51, v44, v45
    buffer_store_dwordx4 v[48:51], v14, s[12:15], s54 offen offset:2048 sc1
    v_cmp_eq_f32 vcc, 0, v57
    v_max3_f32 v61, v52, v53, v54
    s_nop 0
    v_cndmask_b32 v60, v57, v56, vcc
    v_max3_f32 v61, v61, v55, v56
    v_max_f32 v60, v60, v61
    v_sub_f32 v52, v52, v60
    v_sub_f32 v53, v53, v60
    v_sub_f32 v54, v54, v60
    v_sub_f32 v55, v55, v60
    v_sub_f32 v56, v56, v60
    v_sub_f32 v57, v57, v60
    v_cvt_pk_f16_f32 v61, v52, v53
    v_cvt_pk_f16_f32 v62, v54, v55
    v_cvt_pk_f16_f32 v63, v56, v57
    buffer_store_dwordx4 v[60:63], v14, s[12:15], s54 offen offset:3072 sc1
L_fl0:
    s_nop 1
    v_mov_b32 v10, 1
    s_waitcnt vmcnt(0)
    s_mov_b64 exec, 1
    buffer_store_dword v10, off, s[12:15], s32 sc1
    ds_write_b32 v2, v10 offset:52
    s_mov_b64 exec, -1
    s_mov_b32 s60, 0x100000
L_wb2:
    s_nop 1
    ds_read_b32 v10, v2 offset:60
    s_sub_u32 s60, s60, 1
    s_cbranch_scc1 L_exit1
    s_waitcnt lgkmcnt(0)
    v_readfirstlane_b32 s48, v10
    s_cmp_lt_u32 s48, 9
    s_cbranch_scc1 L_wb2
    s_mov_b32 s61, 2
    s_lshl_b32 s62, s61, 5
    s_add_u32 s62, s62, s3
    s_lshl_b32 s63, s62, 15
    s_add_u32 s63, s63, 1
    s_mul_hi_u32 s63, s63, 0xaaaaaaab
    s_lshr_b32 s63, s63, 7
    s_mul_i32 s48, s62, 171
    s_lshr_b32 s48, s48, 9
    s_mul_i32 s48, s48, 384
    s_mul_i32 s49, s4, 24
    s_add_u32 s50, s49, s63
    s_mul_i32 s50, s50, 384
    v_add_u32 v10, s50, v7
    v_add_u32 v11, 3072, v10
    v_add_u32 v12, 6144, v10
    buffer_load_dwordx2 v[100:101], v6, s[8:11], s48 offen offset:0
    buffer_load_dwordx2 v[102:103], v6, s[8:11], s48 offen offset:128
    buffer_load_dwordx2 v[104:105], v6, s[8:11], s48 offen offset:256
    buffer_load_dwordx2 v[28:29], v10, s[92:95], 0 offen offset:0
    buffer_load_dwordx2 v[30:31], v10, s[92:95], 0 offen offset:128
    buffer_load_dwordx2 v[32:33], v10, s[92:95], 0 offen offset:256
    buffer_load_dwordx2 v[64:65], v10, s[96:99], 0 offen offset:0
    buffer_load_dwordx2 v[66:67], v10, s[96:99], 0 offen offset:128
    buffer_load_dwordx2 v[68:69], v10, s[96:99], 0 offen offset:256
    buffer_load_dwordx2 v[34:35], v10, s[92:95], 0 offen offset:1536
    buffer_load_dwordx2 v[36:37], v10, s[92:95], 0 offen offset:1664
    buffer_load_dwordx2 v[38:39], v10, s[92:95], 0 offen offset:1792
    buffer_load_dwordx2 v[70:71], v10, s[96:99], 0 offen offset:1536
    buffer_load_dwordx2 v[72:73], v10, s[96:99], 0 offen offset:1664
    buffer_load_dwordx2 v[74:75], v10, s[96:99], 0 offen offset:1792
    buffer_load_dwordx2 v[40:41], v11, s[92:95], 0 offen offset:0
    buffer_load_dwordx2 v[42:43], v11, s[92:95], 0 offen offset:128
    buffer_load_dwordx2 v[44:45], v11, s[92:95], 0 offen offset:256
    buffer_load_dwordx2 v[76:77], v11, s[96:99], 0 offen offset:0
    buffer_load_dwordx2 v[78:79], v11, s[96:99], 0 offen offset:128
    buffer_load_dwordx2 v[80:81], v11, s[96:99], 0 offen offset:256
    buffer_load_dwordx2 v[46:47], v11, s[92:95], 0 offen offset:1536
    buffer_load_dwordx2 v[48:49], v11, s[92:95], 0 offen offset:1664
    buffer_load_dwordx2 v[50:51], v11, s[92:95], 0 offen offset:1792
    buffer_load_dwordx2 v[82:83], v11, s[96:99], 0 offen offset:1536
    buffer_load_dwordx2 v[84:85], v11, s[96:99], 0 offen offset:1664
    buffer_load_dwordx2 v[86:87], v11, s[96:99], 0 offen offset:1792
    buffer_load_dwordx2 v[52:53], v12, s[92:95], 0 offen offset:0
    buffer_load_dwordx2 v[54:55], v12, s[92:95], 0 offen offset:128
    buffer_load_dwordx2 v[56:57], v12, s[92:95], 0 offen offset:256
    buffer_load_dwordx2 v[88:89], v12, s[96:99], 0 offen offset:0
    buffer_load_dwordx2 v[90:91], v12, s[96:99], 0 offen offset:128
    buffer_load_dwordx2 v[92:93], v12, s[96:99], 0 offen offset:256
    buffer_load_dwordx2 v[58:59], v12, s[92:95], 0 offen offset:1536
    buffer_load_dwordx2 v[60:61], v12, s[92:95], 0 offen offset:1664
    buffer_load_dwordx2 v[62:63], v12, s[92:95], 0 offen offset:1792
    buffer_load_dwordx2 v[94:95], v12, s[96:99], 0 offen offset:1536
    buffer_load_dwordx2 v[96:97], v12, s[96:99], 0 offen offset:1664
    buffer_load_dwordx2 v[98:99], v12, s[96:99], 0 offen offset:1792
    s_waitcnt vmcnt(0)
    v_lshlrev_b32 v16, 16, v100
    v_and_b32 v17, 0xffff0000, v100
    v_lshlrev_b32 v18, 16, v101
    v_and_b32 v19, 0xffff0000, v101
    v_lshlrev_b32 v20, 16, v102
    v_and_b32 v21, 0xffff0000, v102
    v_lshlrev_b32 v22, 16, v103
    v_and_b32 v23, 0xffff0000, v103
    v_lshlrev_b32 v24, 16, v104
    v_and_b32 v25, 0xffff0000, v104
    v_lshlrev_b32 v26, 16, v105
    v_and_b32 v27, 0xffff0000, v105
    v_lshlrev_b32 v10, 16, v28
    v_lshlrev_b32 v11, 16, v64
    v_and_b32 v28, 0xffff0000, v28
    v_and_b32 v64, 0xffff0000, v64
    v_mul_f32 v10, v10, v16
    v_mul_f32 v28, v28, v17
    v_mul_f32 v100, v10, v11
    v_fmac_f32 v100, v28, v64
    v_lshlrev_b32 v10, 16, v29
    v_lshlrev_b32 v11, 16, v65
    v_and_b32 v29, 0xffff0000, v29
    v_and_b32 v65, 0xffff0000, v65
    v_mul_f32 v10, v10, v18
    v_mul_f32 v29, v29, v19
    v_fmac_f32 v100, v10, v11
    v_fmac_f32 v100, v29, v65
    v_lshlrev_b32 v10, 16, v30
    v_lshlrev_b32 v11, 16, v66
    v_and_b32 v30, 0xffff0000, v30
    v_and_b32 v66, 0xffff0000, v66
    v_mul_f32 v10, v10, v20
    v_mul_f32 v30, v30, v21
    v_fmac_f32 v100, v10, v11
    v_fmac_f32 v100, v30, v66
    v_lshlrev_b32 v10, 16, v31
    v_lshlrev_b32 v11, 16, v67
    v_and_b32 v31, 0xffff0000, v31
    v_and_b32 v67, 0xffff0000, v67
    v_mul_f32 v10, v10, v22
    v_mul_f32 v31, v31, v23
    v_fmac_f32 v100, v10, v11
    v_fmac_f32 v100, v31, v67
    v_lshlrev_b32 v10, 16, v32
    v_lshlrev_b32 v11, 16, v68
    v_and_b32 v32, 0xffff0000, v32
    v_and_b32 v68, 0xffff0000, v68
    v_mul_f32 v10, v10, v24
    v_mul_f32 v32, v32, v25
    v_fmac_f32 v100, v10, v11
    v_fmac_f32 v100, v32, v68
    v_lshlrev_b32 v10, 16, v33
    v_lshlrev_b32 v11, 16, v69
    v_and_b32 v33, 0xffff0000, v33
    v_and_b32 v69, 0xffff0000, v69
    v_mul_f32 v10, v10, v26
    v_mul_f32 v33, v33, v27
    v_fmac_f32 v100, v10, v11
    v_fmac_f32 v100, v33, v69
    v_lshlrev_b32 v10, 16, v34
    v_lshlrev_b32 v11, 16, v70
    v_and_b32 v34, 0xffff0000, v34
    v_and_b32 v70, 0xffff0000, v70
    v_mul_f32 v10, v10, v16
    v_mul_f32 v34, v34, v17
    v_mul_f32 v101, v10, v11
    v_fmac_f32 v101, v34, v70
    v_lshlrev_b32 v10, 16, v35
    v_lshlrev_b32 v11, 16, v71
    v_and_b32 v35, 0xffff0000, v35
    v_and_b32 v71, 0xffff0000, v71
    v_mul_f32 v10, v10, v18
    v_mul_f32 v35, v35, v19
    v_fmac_f32 v101, v10, v11
    v_fmac_f32 v101, v35, v71
    v_lshlrev_b32 v10, 16, v36
    v_lshlrev_b32 v11, 16, v72
    v_and_b32 v36, 0xffff0000, v36
    v_and_b32 v72, 0xffff0000, v72
    v_mul_f32 v10, v10, v20
    v_mul_f32 v36, v36, v21
    v_fmac_f32 v101, v10, v11
    v_fmac_f32 v101, v36, v72
    v_lshlrev_b32 v10, 16, v37
    v_lshlrev_b32 v11, 16, v73
    v_and_b32 v37, 0xffff0000, v37
    v_and_b32 v73, 0xffff0000, v73
    v_mul_f32 v10, v10, v22
    v_mul_f32 v37, v37, v23
    v_fmac_f32 v101, v10, v11
    v_fmac_f32 v101, v37, v73
    v_lshlrev_b32 v10, 16, v38
    v_lshlrev_b32 v11, 16, v74
    v_and_b32 v38, 0xffff0000, v38
    v_and_b32 v74, 0xffff0000, v74
    v_mul_f32 v10, v10, v24
    v_mul_f32 v38, v38, v25
    v_fmac_f32 v101, v10, v11
    v_fmac_f32 v101, v38, v74
    v_lshlrev_b32 v10, 16, v39
    v_lshlrev_b32 v11, 16, v75
    v_and_b32 v39, 0xffff0000, v39
    v_and_b32 v75, 0xffff0000, v75
    v_mul_f32 v10, v10, v26
    v_mul_f32 v39, v39, v27
    v_fmac_f32 v101, v10, v11
    v_fmac_f32 v101, v39, v75
    v_lshlrev_b32 v10, 16, v40
    v_lshlrev_b32 v11, 16, v76
    v_and_b32 v40, 0xffff0000, v40
    v_and_b32 v76, 0xffff0000, v76
    v_mul_f32 v10, v10, v16
    v_mul_f32 v40, v40, v17
    v_mul_f32 v102, v10, v11
    v_fmac_f32 v102, v40, v76
    v_lshlrev_b32 v10, 16, v41
    v_lshlrev_b32 v11, 16, v77
    v_and_b32 v41, 0xffff0000, v41
    v_and_b32 v77, 0xffff0000, v77
    v_mul_f32 v10, v10, v18
    v_mul_f32 v41, v41, v19
    v_fmac_f32 v102, v10, v11
    v_fmac_f32 v102, v41, v77
    v_lshlrev_b32 v10, 16, v42
    v_lshlrev_b32 v11, 16, v78
    v_and_b32 v42, 0xffff0000, v42
    v_and_b32 v78, 0xffff0000, v78
    v_mul_f32 v10, v10, v20
    v_mul_f32 v42, v42, v21
    v_fmac_f32 v102, v10, v11
    v_fmac_f32 v102, v42, v78
    v_lshlrev_b32 v10, 16, v43
    v_lshlrev_b32 v11, 16, v79
    v_and_b32 v43, 0xffff0000, v43
    v_and_b32 v79, 0xffff0000, v79
    v_mul_f32 v10, v10, v22
    v_mul_f32 v43, v43, v23
    v_fmac_f32 v102, v10, v11
    v_fmac_f32 v102, v43, v79
    v_lshlrev_b32 v10, 16, v44
    v_lshlrev_b32 v11, 16, v80
    v_and_b32 v44, 0xffff0000, v44
    v_and_b32 v80, 0xffff0000, v80
    v_mul_f32 v10, v10, v24
    v_mul_f32 v44, v44, v25
    v_fmac_f32 v102, v10, v11
    v_fmac_f32 v102, v44, v80
    v_lshlrev_b32 v10, 16, v45
    v_lshlrev_b32 v11, 16, v81
    v_and_b32 v45, 0xffff0000, v45
    v_and_b32 v81, 0xffff0000, v81
    v_mul_f32 v10, v10, v26
    v_mul_f32 v45, v45, v27
    v_fmac_f32 v102, v10, v11
    v_fmac_f32 v102, v45, v81
    v_lshlrev_b32 v10, 16, v46
    v_lshlrev_b32 v11, 16, v82
    v_and_b32 v46, 0xffff0000, v46
    v_and_b32 v82, 0xffff0000, v82
    v_mul_f32 v10, v10, v16
    v_mul_f32 v46, v46, v17
    v_mul_f32 v103, v10, v11
    v_fmac_f32 v103, v46, v82
    v_lshlrev_b32 v10, 16, v47
    v_lshlrev_b32 v11, 16, v83
    v_and_b32 v47, 0xffff0000, v47
    v_and_b32 v83, 0xffff0000, v83
    v_mul_f32 v10, v10, v18
    v_mul_f32 v47, v47, v19
    v_fmac_f32 v103, v10, v11
    v_fmac_f32 v103, v47, v83
    v_lshlrev_b32 v10, 16, v48
    v_lshlrev_b32 v11, 16, v84
    v_and_b32 v48, 0xffff0000, v48
    v_and_b32 v84, 0xffff0000, v84
    v_mul_f32 v10, v10, v20
    v_mul_f32 v48, v48, v21
    v_fmac_f32 v103, v10, v11
    v_fmac_f32 v103, v48, v84
    v_lshlrev_b32 v10, 16, v49
    v_lshlrev_b32 v11, 16, v85
    v_and_b32 v49, 0xffff0000, v49
    v_and_b32 v85, 0xffff0000, v85
    v_mul_f32 v10, v10, v22
    v_mul_f32 v49, v49, v23
    v_fmac_f32 v103, v10, v11
    v_fmac_f32 v103, v49, v85
    v_lshlrev_b32 v10, 16, v50
    v_lshlrev_b32 v11, 16, v86
    v_and_b32 v50, 0xffff0000, v50
    v_and_b32 v86, 0xffff0000, v86
    v_mul_f32 v10, v10, v24
    v_mul_f32 v50, v50, v25
    v_fmac_f32 v103, v10, v11
    v_fmac_f32 v103, v50, v86
    v_lshlrev_b32 v10, 16, v51
    v_lshlrev_b32 v11, 16, v87
    v_and_b32 v51, 0xffff0000, v51
    v_and_b32 v87, 0xffff0000, v87
    v_mul_f32 v10, v10, v26
    v_mul_f32 v51, v51, v27
    v_fmac_f32 v103, v10, v11
    v_fmac_f32 v103, v51, v87
    v_lshlrev_b32 v10, 16, v52
    v_lshlrev_b32 v11, 16, v88
    v_and_b32 v52, 0xffff0000, v52
    v_and_b32 v88, 0xffff0000, v88
    v_mul_f32 v10, v10, v16
    v_mul_f32 v52, v52, v17
    v_mul_f32 v104, v10, v11
    v_fmac_f32 v104, v52, v88
    v_lshlrev_b32 v10, 16, v53
    v_lshlrev_b32 v11, 16, v89
    v_and_b32 v53, 0xffff0000, v53
    v_and_b32 v89, 0xffff0000, v89
    v_mul_f32 v10, v10, v18
    v_mul_f32 v53, v53, v19
    v_fmac_f32 v104, v10, v11
    v_fmac_f32 v104, v53, v89
    v_lshlrev_b32 v10, 16, v54
    v_lshlrev_b32 v11, 16, v90
    v_and_b32 v54, 0xffff0000, v54
    v_and_b32 v90, 0xffff0000, v90
    v_mul_f32 v10, v10, v20
    v_mul_f32 v54, v54, v21
    v_fmac_f32 v104, v10, v11
    v_fmac_f32 v104, v54, v90
    v_lshlrev_b32 v10, 16, v55
    v_lshlrev_b32 v11, 16, v91
    v_and_b32 v55, 0xffff0000, v55
    v_and_b32 v91, 0xffff0000, v91
    v_mul_f32 v10, v10, v22
    v_mul_f32 v55, v55, v23
    v_fmac_f32 v104, v10, v11
    v_fmac_f32 v104, v55, v91
    v_lshlrev_b32 v10, 16, v56
    v_lshlrev_b32 v11, 16, v92
    v_and_b32 v56, 0xffff0000, v56
    v_and_b32 v92, 0xffff0000, v92
    v_mul_f32 v10, v10, v24
    v_mul_f32 v56, v56, v25
    v_fmac_f32 v104, v10, v11
    v_fmac_f32 v104, v56, v92
    v_lshlrev_b32 v10, 16, v57
    v_lshlrev_b32 v11, 16, v93
    v_and_b32 v57, 0xffff0000, v57
    v_and_b32 v93, 0xffff0000, v93
    v_mul_f32 v10, v10, v26
    v_mul_f32 v57, v57, v27
    v_fmac_f32 v104, v10, v11
    v_fmac_f32 v104, v57, v93
    v_lshlrev_b32 v10, 16, v58
    v_lshlrev_b32 v11, 16, v94
    v_and_b32 v58, 0xffff0000, v58
    v_and_b32 v94, 0xffff0000, v94
    v_mul_f32 v10, v10, v16
    v_mul_f32 v58, v58, v17
    v_mul_f32 v105, v10, v11
    v_fmac_f32 v105, v58, v94
    v_lshlrev_b32 v10, 16, v59
    v_lshlrev_b32 v11, 16, v95
    v_and_b32 v59, 0xffff0000, v59
    v_and_b32 v95, 0xffff0000, v95
    v_mul_f32 v10, v10, v18
    v_mul_f32 v59, v59, v19
    v_fmac_f32 v105, v10, v11
    v_fmac_f32 v105, v59, v95
    v_lshlrev_b32 v10, 16, v60
    v_lshlrev_b32 v11, 16, v96
    v_and_b32 v60, 0xffff0000, v60
    v_and_b32 v96, 0xffff0000, v96
    v_mul_f32 v10, v10, v20
    v_mul_f32 v60, v60, v21
    v_fmac_f32 v105, v10, v11
    v_fmac_f32 v105, v60, v96
    v_lshlrev_b32 v10, 16, v61
    v_lshlrev_b32 v11, 16, v97
    v_and_b32 v61, 0xffff0000, v61
    v_and_b32 v97, 0xffff0000, v97
    v_mul_f32 v10, v10, v22
    v_mul_f32 v61, v61, v23
    v_fmac_f32 v105, v10, v11
    v_fmac_f32 v105, v61, v97
    v_lshlrev_b32 v10, 16, v62
    v_lshlrev_b32 v11, 16, v98
    v_and_b32 v62, 0xffff0000, v62
    v_and_b32 v98, 0xffff0000, v98
    v_mul_f32 v10, v10, v24
    v_mul_f32 v62, v62, v25
    v_fmac_f32 v105, v10, v11
    v_fmac_f32 v105, v62, v98
    v_lshlrev_b32 v10, 16, v63
    v_lshlrev_b32 v11, 16, v99
    v_and_b32 v63, 0xffff0000, v63
    v_and_b32 v99, 0xffff0000, v99
    v_mul_f32 v10, v10, v26
    v_mul_f32 v63, v63, v27
    v_fmac_f32 v105, v10, v11
    v_fmac_f32 v105, v63, v99
    v_add_f32_dpp v100, v100, v100 row_ror:8 row_mask:0xf bank_mask:0xf
    v_add_f32_dpp v101, v101, v101 row_ror:8 row_mask:0xf bank_mask:0xf
    v_add_f32_dpp v102, v102, v102 row_ror:8 row_mask:0xf bank_mask:0xf
    v_add_f32_dpp v103, v103, v103 row_ror:8 row_mask:0xf bank_mask:0xf
    v_add_f32_dpp v104, v104, v104 row_ror:8 row_mask:0xf bank_mask:0xf
    v_add_f32_dpp v105, v105, v105 row_ror:8 row_mask:0xf bank_mask:0xf
    v_add_f32_dpp v100, v100, v100 row_ror:4 row_mask:0xf bank_mask:0xf
    v_add_f32_dpp v101, v101, v101 row_ror:4 row_mask:0xf bank_mask:0xf
    v_add_f32_dpp v102, v102, v102 row_ror:4 row_mask:0xf bank_mask:0xf
    v_add_f32_dpp v103, v103, v103 row_ror:4 row_mask:0xf bank_mask:0xf
    v_add_f32_dpp v104, v104, v104 row_ror:4 row_mask:0xf bank_mask:0xf
    v_add_f32_dpp v105, v105, v105 row_ror:4 row_mask:0xf bank_mask:0xf
    v_add_f32_dpp v100, v100, v100 row_ror:2 row_mask:0xf bank_mask:0xf
    v_add_f32_dpp v101, v101, v101 row_ror:2 row_mask:0xf bank_mask:0xf
    v_add_f32_dpp v102, v102, v102 row_ror:2 row_mask:0xf bank_mask:0xf
    v_add_f32_dpp v103, v103, v103 row_ror:2 row_mask:0xf bank_mask:0xf
    v_add_f32_dpp v104, v104, v104 row_ror:2 row_mask:0xf bank_mask:0xf
    v_add_f32_dpp v105, v105, v105 row_ror:2 row_mask:0xf bank_mask:0xf
    v_add_f32_dpp v100, v100, v100 row_ror:1 row_mask:0xf bank_mask:0xf
    v_add_f32_dpp v101, v101, v101 row_ror:1 row_mask:0xf bank_mask:0xf
    v_add_f32_dpp v102, v102, v102 row_ror:1 row_mask:0xf bank_mask:0xf
    v_add_f32_dpp v103, v103, v103 row_ror:1 row_mask:0xf bank_mask:0xf
    v_add_f32_dpp v104, v104, v104 row_ror:1 row_mask:0xf bank_mask:0xf
    v_add_f32_dpp v105, v105, v105 row_ror:1 row_mask:0xf bank_mask:0xf
    v_cmp_eq_u32 vcc, 1, v5
    s_nop 1
    v_cndmask_b32 v100, v100, v101, vcc
    v_cmp_eq_u32 vcc, 2, v5
    s_nop 1
    v_cndmask_b32 v100, v100, v102, vcc
    v_cmp_eq_u32 vcc, 3, v5
    s_nop 1
    v_cndmask_b32 v100, v100, v103, vcc
    v_cmp_eq_u32 vcc, 4, v5
    s_nop 1
    v_cndmask_b32 v100, v100, v104, vcc
    v_cmp_eq_u32 vcc, 5, v5
    s_nop 1
    v_cndmask_b32 v100, v100, v105, vcc
    s_mul_i32 s48, s62, 768
    s_lshl_b32 s49, s49, 2
    s_add_u32 s48, s48, s49
    s_add_u32 s48, s48, 1179648
    s_mov_b32 exec_lo, 0x003f003f
    s_mov_b32 exec_hi, 0x003f003f
    buffer_store_dword v100, v13, s[12:15], s48 offen sc1
    s_mov_b64 exec, -1
    s_mov_b32 s60, 0x100000
L_wf1:
    s_nop 1
    ds_read_b32 v10, v2 offset:44
    s_sub_u32 s60, s60, 1
    s_cbranch_scc1 L_exit1
    s_waitcnt lgkmcnt(0)
    v_readfirstlane_b32 s48, v10
    s_cmp_lt_u32 s48, 4
    s_cbranch_scc1 L_wf1
    s_cmp_eq_u32 s85, s88
    s_cbranch_scc1 L_fl1
    ds_read_b64 v[16:17], v8 offset:6400
    ds_read_b64 v[18:19], v8 offset:6408
    ds_read_b64 v[20:21], v8 offset:6416
    ds_read_b64 v[28:29], v8 offset:6592
    ds_read_b64 v[30:31], v8 offset:6600
    ds_read_b64 v[32:33], v8 offset:6608
    ds_read_b64 v[40:41], v8 offset:6784
    ds_read_b64 v[42:43], v8 offset:6792
    ds_read_b64 v[44:45], v8 offset:6800
    ds_read_b64 v[52:53], v8 offset:6976
    ds_read_b64 v[54:55], v8 offset:6984
    ds_read_b64 v[56:57], v8 offset:6992
    s_add_u32 s54, s33, 1048576
    s_cmp_eq_u32 s85, s88
    s_waitcnt lgkmcnt(0)
    v_cmp_eq_f32 vcc, 0, v21
    v_max3_f32 v25, v16, v17, v18
    s_nop 0
    v_cndmask_b32 v24, v21, v20, vcc
    v_max3_f32 v25, v25, v19, v20
    v_max_f32 v24, v24, v25
    v_sub_f32 v16, v16, v24
    v_sub_f32 v17, v17, v24
    v_sub_f32 v18, v18, v24
    v_sub_f32 v19, v19, v24
    v_sub_f32 v20, v20, v24
    v_sub_f32 v21, v21, v24
    v_cvt_pk_f16_f32 v25, v16, v17
    v_cvt_pk_f16_f32 v26, v18, v19
    v_cvt_pk_f16_f32 v27, v20, v21
    buffer_store_dwordx4 v[24:27], v14, s[12:15], s54 offen offset:0 sc1
    v_cmp_eq_f32 vcc, 0, v33
    v_max3_f32 v37, v28, v29, v30
    s_nop 0
    v_cndmask_b32 v36, v33, v32, vcc
    v_max3_f32 v37, v37, v31, v32
    v_max_f32 v36, v36, v37
    v_sub_f32 v28, v28, v36
    v_sub_f32 v29, v29, v36
    v_sub_f32 v30, v30, v36
    v_sub_f32 v31, v31, v36
    v_sub_f32 v32, v32, v36
    v_sub_f32 v33, v33, v36
    v_cvt_pk_f16_f32 v37, v28, v29
    v_cvt_pk_f16_f32 v38, v30, v31
    v_cvt_pk_f16_f32 v39, v32, v33
    buffer_store_dwordx4 v[36:39], v14, s[12:15], s54 offen offset:1024 sc1
    v_cmp_eq_f32 vcc, 0, v45
    v_max3_f32 v49, v40, v41, v42
    s_nop 0
    v_cndmask_b32 v48, v45, v44, vcc
    v_max3_f32 v49, v49, v43, v44
    v_max_f32 v48, v48, v49
    v_sub_f32 v40, v40, v48
    v_sub_f32 v41, v41, v48
    v_sub_f32 v42, v42, v48
    v_sub_f32 v43, v43, v48
    v_sub_f32 v44, v44, v48
    v_sub_f32 v45, v45, v48
    v_cvt_pk_f16_f32 v49, v40, v41
    v_cvt_pk_f16_f32 v50, v42, v43
    v_cvt_pk_f16_f32 v51, v44, v45
    buffer_store_dwordx4 v[48:51], v14, s[12:15], s54 offen offset:2048 sc1
    v_cmp_eq_f32 vcc, 0, v57
    v_max3_f32 v61, v52, v53, v54
    s_nop 0
    v_cndmask_b32 v60, v57, v56, vcc
    v_max3_f32 v61, v61, v55, v56
    v_max_f32 v60, v60, v61
    v_sub_f32 v52, v52, v60
    v_sub_f32 v53, v53, v60
    v_sub_f32 v54, v54, v60
    v_sub_f32 v55, v55, v60
    v_sub_f32 v56, v56, v60
    v_sub_f32 v57, v57, v60
    v_cvt_pk_f16_f32 v61, v52, v53
    v_cvt_pk_f16_f32 v62, v54, v55
    v_cvt_pk_f16_f32 v63, v56, v57
    buffer_store_dwordx4 v[60:63], v14, s[12:15], s54 offen offset:3072 sc1
L_fl1:
    s_nop 1
    v_mov_b32 v10, 2
    s_waitcnt vmcnt(0)
    s_mov_b64 exec, 1
    buffer_store_dword v10, off, s[12:15], s32 sc1
    ds_write_b32 v2, v10 offset:52
    s_mov_b64 exec, -1
    s_mov_b32 s60, 0x100000
L_wf2:
    s_nop 1
    ds_read_b32 v10, v2 offset:48
    s_sub_u32 s60, s60, 1
    s_cbranch_scc1 L_exit1
    s_waitcnt lgkmcnt(0)
    v_readfirstlane_b32 s48, v10
    s_cmp_lt_u32 s48, 4
    s_cbranch_scc1 L_wf2
    s_cmp_eq_u32 s86, s89
    s_cbranch_scc1 L_fl2
    ds_read_b64 v[16:17], v8 offset:12544
    ds_read_b64 v[18:19], v8 offset:12552
    ds_read_b64 v[20:21], v8 offset:12560
    ds_read_b64 v[28:29], v8 offset:12736
    ds_read_b64 v[30:31], v8 offset:12744
    ds_read_b64 v[32:33], v8 offset:12752
    ds_read_b64 v[40:41], v8 offset:12928
    ds_read_b64 v[42:43], v8 offset:12936
    ds_read_b64 v[44:45], v8 offset:12944
    ds_read_b64 v[52:53], v8 offset:13120
    ds_read_b64 v[54:55], v8 offset:13128
    ds_read_b64 v[56:57], v8 offset:13136
    s_add_u32 s54, s33, 2097152
    s_cmp_eq_u32 s86, s89
    s_waitcnt lgkmcnt(0)
    v_cmp_eq_f32 vcc, 0, v21
    v_max3_f32 v25, v16, v17, v18
    s_nop 0
    v_cndmask_b32 v24, v21, v20, vcc
    v_max3_f32 v25, v25, v19, v20
    v_max_f32 v24, v24, v25
    v_sub_f32 v16, v16, v24
    v_sub_f32 v17, v17, v24
    v_sub_f32 v18, v18, v24
    v_sub_f32 v19, v19, v24
    v_sub_f32 v20, v20, v24
    v_sub_f32 v21, v21, v24
    v_cvt_pk_f16_f32 v25, v16, v17
    v_cvt_pk_f16_f32 v26, v18, v19
    v_cvt_pk_f16_f32 v27, v20, v21
    buffer_store_dwordx4 v[24:27], v14, s[12:15], s54 offen offset:0 sc1
    v_cmp_eq_f32 vcc, 0, v33
    v_max3_f32 v37, v28, v29, v30
    s_nop 0
    v_cndmask_b32 v36, v33, v32, vcc
    v_max3_f32 v37, v37, v31, v32
    v_max_f32 v36, v36, v37
    v_sub_f32 v28, v28, v36
    v_sub_f32 v29, v29, v36
    v_sub_f32 v30, v30, v36
    v_sub_f32 v31, v31, v36
    v_sub_f32 v32, v32, v36
    v_sub_f32 v33, v33, v36
    v_cvt_pk_f16_f32 v37, v28, v29
    v_cvt_pk_f16_f32 v38, v30, v31
    v_cvt_pk_f16_f32 v39, v32, v33
    buffer_store_dwordx4 v[36:39], v14, s[12:15], s54 offen offset:1024 sc1
    v_cmp_eq_f32 vcc, 0, v45
    v_max3_f32 v49, v40, v41, v42
    s_nop 0
    v_cndmask_b32 v48, v45, v44, vcc
    v_max3_f32 v49, v49, v43, v44
    v_max_f32 v48, v48, v49
    v_sub_f32 v40, v40, v48
    v_sub_f32 v41, v41, v48
    v_sub_f32 v42, v42, v48
    v_sub_f32 v43, v43, v48
    v_sub_f32 v44, v44, v48
    v_sub_f32 v45, v45, v48
    v_cvt_pk_f16_f32 v49, v40, v41
    v_cvt_pk_f16_f32 v50, v42, v43
    v_cvt_pk_f16_f32 v51, v44, v45
    buffer_store_dwordx4 v[48:51], v14, s[12:15], s54 offen offset:2048 sc1
    v_cmp_eq_f32 vcc, 0, v57
    v_max3_f32 v61, v52, v53, v54
    s_nop 0
    v_cndmask_b32 v60, v57, v56, vcc
    v_max3_f32 v61, v61, v55, v56
    v_max_f32 v60, v60, v61
    v_sub_f32 v52, v52, v60
    v_sub_f32 v53, v53, v60
    v_sub_f32 v54, v54, v60
    v_sub_f32 v55, v55, v60
    v_sub_f32 v56, v56, v60
    v_sub_f32 v57, v57, v60
    v_cvt_pk_f16_f32 v61, v52, v53
    v_cvt_pk_f16_f32 v62, v54, v55
    v_cvt_pk_f16_f32 v63, v56, v57
    buffer_store_dwordx4 v[60:63], v14, s[12:15], s54 offen offset:3072 sc1
L_fl2:
    s_nop 1
    v_mov_b32 v10, 3
    s_waitcnt vmcnt(0)
    s_mov_b64 exec, 1
    s_cbranch_scc1 L_fn2
    buffer_store_dword v10, off, s[12:15], s32 sc1
L_fn2:
    s_nop 1
    ds_write_b32 v2, v10 offset:52
    s_mov_b64 exec, -1
    s_endpgm
L_h3:
    s_nop 1
    s_waitcnt lgkmcnt(0)
    s_mov_b32 s12, s82
    s_and_b32 s13, s83, 0xffff
    s_mov_b32 s14, 10485760
    s_mov_b32 s15, 0x00020000
    s_barrier
    v_lshlrev_b32 v7, 2, v1
    s_mul_i32 s20, s4, 4352
    s_add_u32 s20, s20, 10223616
    s_lshl_b32 s21, s3, 2
    s_add_u32 s21, s21, s20
    s_mov_b32 s46, 0x155
    v_lshrrev_b32 v13, 2, v1
    v_mul_u32_u24 v13, 4352, v13
    v_and_or_b32 v13, v7, 12, v13
    s_and_b32 s7, s4, 3
    s_mul_i32 s47, s7, 4352
    s_lshl_b32 s7, s7, 2
    v_mov_b32 v8, 208
    s_mov_b32 s45, 2
    v_mov_b32 v3, 144
    v_bfrev_b32 v6, -2
    s_mov_b32 exec_hi, 0
L_h3loop:
    s_nop 1
    s_mov_b32 s60, 0x100000
L_wp1:
    s_nop 1
    ds_read_b32 v10, v2 offset:128
    s_sub_u32 s60, s60, 1
    s_cbranch_scc1 L_exit1
    s_waitcnt lgkmcnt(0)
    v_readfirstlane_b32 s48, v10
    s_cmp_lt_u32 s48, s45
    s_cbranch_scc1 L_wp1
    s_memrealtime s[40:41]
    s_add_u32 s45, s45, 3
    s_mov_b32 exec_lo, 1
    s_waitcnt lgkmcnt(0)
    v_mov_b32 v5, s40
    buffer_store_dword v5, off, s[12:15], s21
    s_mov_b32 exec_lo, -1
    s_mov_b32 s60, 0x100000
L_wp2:
    s_nop 1
    ds_read_b32 v10, v2 offset:128
    s_sub_u32 s60, s60, 1
    s_cbranch_scc1 L_exit1
    s_waitcnt lgkmcnt(0)
    v_readfirstlane_b32 s48, v10
    s_cmp_lt_u32 s48, s45
    s_cbranch_scc1 L_wp2
    buffer_load_dword v5, v7, s[12:15], s20 offen sc0
    s_add_u32 s45, s45, 4
    s_sub_u32 s40, s40, 4096
    s_waitcnt vmcnt(0)
    v_subrev_u32 v5, s40, v5
    v_cmp_gt_u32 vcc, 8192, v5
    s_nop 1
    v_cndmask_b32 v5, v6, v5, vcc
    s_mov_b32 s48, 2048
    s_add_u32 s49, s48, 2048
    v_cmp_gt_u32 vcc, s49, v5
    s_bcnt1_i32_b64 s50, vcc
    s_cmp_lt_u32 s50, 16
    s_cselect_b32 s48, s49, s48
    s_add_u32 s49, s48, 1024
    v_cmp_gt_u32 vcc, s49, v5
    s_bcnt1_i32_b64 s50, vcc
    s_cmp_lt_u32 s50, 16
    s_cselect_b32 s48, s49, s48
    s_add_u32 s49, s48, 512
    v_cmp_gt_u32 vcc, s49, v5
    s_bcnt1_i32_b64 s50, vcc
    s_cmp_lt_u32 s50, 16
    s_cselect_b32 s48, s49, s48
    s_add_u32 s49, s48, 256
    v_cmp_gt_u32 vcc, s49, v5
    s_bcnt1_i32_b64 s50, vcc
    s_cmp_lt_u32 s50, 16
    s_cselect_b32 s48, s49, s48
    s_add_u32 s49, s48, 128
    v_cmp_gt_u32 vcc, s49, v5
    s_bcnt1_i32_b64 s50, vcc
    s_cmp_lt_u32 s50, 16
    s_cselect_b32 s48, s49, s48
    s_add_u32 s49, s48, 64
    v_cmp_gt_u32 vcc, s49, v5
    s_bcnt1_i32_b64 s50, vcc
    s_cmp_lt_u32 s50, 16
    s_cselect_b32 s48, s49, s48
    s_add_u32 s49, s48, 32
    v_cmp_gt_u32 vcc, s49, v5
    s_bcnt1_i32_b64 s50, vcc
    s_cmp_lt_u32 s50, 16
    s_cselect_b32 s48, s49, s48
    s_add_u32 s49, s48, 16
    v_cmp_gt_u32 vcc, s49, v5
    s_bcnt1_i32_b64 s50, vcc
    s_cmp_lt_u32 s50, 16
    s_cselect_b32 s48, s49, s48
    s_add_u32 s49, s48, 8
    v_cmp_gt_u32 vcc, s49, v5
    s_bcnt1_i32_b64 s50, vcc
    s_cmp_lt_u32 s50, 16
    s_cselect_b32 s48, s49, s48
    s_add_u32 s49, s48, s40
    s_or_b32 s49, s49, 1
    v_mov_b32 v5, s49
    ds_write_b32 v3, v5
    v_add_u32 v3, 4, v3
    s_bitcmp1_b32 s46, 0
    s_cbranch_scc0 L_h3ng
    s_cmp_lt_u32 s48, 6136
    s_cselect_b32 exec_lo, 1, 0
    s_cmp_lt_u32 s3, 4
    s_cselect_b32 exec_lo, exec_lo, 0
    buffer_store_dword v5, off, s[12:15], s21 offset:2048 sc1
    s_mov_b32 exec_lo, 0xffff
    s_add_u32 s51, s45, 0
    s_mov_b32 s60, 0x100000
L_wp3:
    s_nop 1
    ds_read_b32 v10, v2 offset:128
    s_sub_u32 s60, s60, 1
    s_cbranch_scc1 L_exit1
    s_waitcnt lgkmcnt(0)
    v_readfirstlane_b32 s48, v10
    s_cmp_lt_u32 s48, s51
    s_cbranch_scc1 L_wp3
    s_sub_u32 s51, s20, s47
    s_mov_b32 s60, 8
    s_mov_b32 s48, 0
L_h3gp:
    s_nop 1
    buffer_load_dword v4, v13, s[12:15], s51 offen offset:2048 sc1
    s_sub_u32 s60, s60, 1
    s_cbranch_scc1 L_h3gw
L_h3gq:
    s_waitcnt vmcnt(0)
    v_subrev_u32 v4, s40, v4
    v_cmp_gt_u32 vcc, 8192, v4
    s_nop 1
    v_cndmask_b32 v4, v6, v4, vcc
    s_nop 1
    v_min_u32_dpp v4, v4, v4 quad_perm:[1,0,3,2] row_mask:0xf bank_mask:0xf
    s_nop 1
    v_min_u32_dpp v4, v4, v4 quad_perm:[2,3,0,1] row_mask:0xf bank_mask:0xf
    v_cmp_eq_u32 vcc, v6, v4
    s_cbranch_vccnz L_h3gp
    v_readlane_b32 s52, v4, 0
    v_readlane_b32 s53, v4, 4
    v_readlane_b32 s54, v4, 8
    v_readlane_b32 s55, v4, 12
    v_readlane_b32 s49, v4, s7
    s_max_u32 s52, s52, s53
    s_max_u32 s54, s54, s55
    s_max_u32 s48, s52, s54
    s_sub_u32 s48, s48, s49
    s_sub_u32 s48, s48, 10
    s_max_i32 s48, s48, 0
    s_min_i32 s48, s48, 1000
L_h3gw:
    s_nop 1
    s_or_b32 s48, s48, 0x10000
    v_mov_b32 v5, s48
    ds_write_b32 v8, v5
    s_mov_b32 exec_lo, -1
    v_add_u32 v8, 4, v8
    s_waitcnt vmcnt(0)
L_h3ng:
    s_nop 1
    s_lshr_b32 s46, s46, 1
    s_add_u32 s45, s45, 5
    s_add_u32 s20, s20, 128
    s_add_u32 s21, s21, 128
    s_cmp_lt_u32 s45, 132
    s_cbranch_scc1 L_h3loop
    s_mov_b64 exec, -1
    v_lshlrev_b32 v12, 2, v1
    v_add_u32 v13, 49408, v12
    v_lshlrev_b32 v8, 4, v1
    s_add_u32 s48, s3, 64
    s_mul_i32 s48, s48, 171
    s_lshr_b32 s48, s48, 9
    s_mul_i32 s58, s48, 4352
    s_add_u32 s58, s58, 9498368
    s_mul_i32 s59, s48, 384
    s_cmp_eq_u32 s48, 21
    s_cselect_b32 s20, 15, 23
    s_mul_i32 s48, s48, 24
    s_add_u32 s62, s2, 512
    s_sub_u32 s56, s62, s48
    s_lshl_b32 s62, s62, 10
    s_mov_b32 s60, 0x40000
L_fs:
    s_nop 1
    buffer_load_dword v4, off, s[12:15], s58 offset:4 sc1
    s_sub_u32 s60, s60, 1
    s_cbranch_scc1 L_exit1
    s_waitcnt vmcnt(0)
    v_cmp_eq_u32 vcc, 0, v4
    s_cbranch_vccnz L_fs
    buffer_load_dword v10, v12, s[12:15], s58 offen offset:128 sc1
    ds_read_b128 v[4:7], v2 offset:112
    v_xor_b32 v11, 1, v1
    v_cmp_eq_u32 vcc, s56, v1
    s_nop 1
    v_cndmask_b32 v11, v1, v11, vcc
    v_add_u32 v11, s48, v11
    v_lshlrev_b32 v11, 10, v11
    s_nop 0
    v_readlane_b32 s64, v11, 0
    v_readlane_b32 s65, v11, 1
    v_readlane_b32 s66, v11, 2
    v_readlane_b32 s67, v11, 3
    v_readlane_b32 s68, v11, 4
    v_readlane_b32 s69, v11, 5
    v_readlane_b32 s70, v11, 6
    v_readlane_b32 s71, v11, 7
    v_readlane_b32 s72, v11, 8
    v_readlane_b32 s73, v11, 9
    v_readlane_b32 s74, v11, 10
    v_readlane_b32 s75, v11, 11
    v_readlane_b32 s84, v11, 12
    v_readlane_b32 s85, v11, 13
    v_readlane_b32 s86, v11, 14
    v_readlane_b32 s87, v11, 15
    v_readlane_b32 s88, v11, 16
    v_readlane_b32 s89, v11, 17
    v_readlane_b32 s90, v11, 18
    v_readlane_b32 s91, v11, 19
    v_readlane_b32 s92, v11, 20
    v_readlane_b32 s93, v11, 21
    v_readlane_b32 s94, v11, 22
    v_readlane_b32 s95, v11, 23
    s_mov_b32 s96, s78
    s_and_b32 s97, s79, 0xffff
    s_mov_b32 s98, 12288
    s_mov_b32 s99, 0x00020000
    v_lshlrev_b32 v12, 1, v1
    s_waitcnt vmcnt(0)
    v_readlane_b32 s57, v10, s56
    v_cndmask_b32 v10, v10, v2, vcc
    s_nop 0
    v_readlane_b32 s24, v10, 0
    v_readlane_b32 s25, v10, 1
    v_readlane_b32 s26, v10, 2
    v_readlane_b32 s27, v10, 3
    v_readlane_b32 s28, v10, 4
    v_readlane_b32 s29, v10, 5
    v_readlane_b32 s30, v10, 6
    v_readlane_b32 s31, v10, 7
    v_readlane_b32 s32, v10, 8
    v_readlane_b32 s33, v10, 9
    v_readlane_b32 s34, v10, 10
    v_readlane_b32 s35, v10, 11
    v_readlane_b32 s36, v10, 12
    v_readlane_b32 s37, v10, 13
    v_readlane_b32 s38, v10, 14
    v_readlane_b32 s39, v10, 15
    v_readlane_b32 s40, v10, 16
    v_readlane_b32 s41, v10, 17
    v_readlane_b32 s42, v10, 18
    v_readlane_b32 s43, v10, 19
    v_readlane_b32 s44, v10, 20
    v_readlane_b32 s45, v10, 21
    v_readlane_b32 s46, v10, 22
    v_readlane_b32 s47, v10, 23
    v_mov_b32 v9, 1
    s_mov_b64 exec, 1
    s_mov_b32 s60, 0x100000
L_wel:
    s_nop 1
    ds_read_b32 v10, v2 offset:136
    s_sub_u32 s60, s60, 1
    s_cbranch_scc1 L_exit1
    s_waitcnt lgkmcnt(0)
    v_readfirstlane_b32 s48, v10
    s_cmp_lt_u32 s48, 4
    s_cbranch_scc1 L_wel
    buffer_atomic_add v9, off, s[12:15], s58 sc0
    s_mov_b64 exec, -1
    s_waitcnt vmcnt(0)
    v_readfirstlane_b32 s48, v9
    s_cmp_lg_u32 s48, s20
    s_cbranch_scc1 L_exit1
    buffer_load_dwordx4 v[32:35], v8, s[12:15], s64 offen sc1
    buffer_load_dwordx4 v[36:39], v8, s[12:15], s65 offen sc1
    buffer_load_dwordx4 v[40:43], v8, s[12:15], s66 offen sc1
    buffer_load_dwordx4 v[44:47], v8, s[12:15], s67 offen sc1
    buffer_load_dwordx4 v[48:51], v8, s[12:15], s68 offen sc1
    buffer_load_dwordx4 v[52:55], v8, s[12:15], s69 offen sc1
    buffer_load_dwordx4 v[56:59], v8, s[12:15], s70 offen sc1
    buffer_load_dwordx4 v[60:63], v8, s[12:15], s71 offen sc1
    buffer_load_dwordx4 v[64:67], v8, s[12:15], s72 offen sc1
    buffer_load_dwordx4 v[68:71], v8, s[12:15], s73 offen sc1
    buffer_load_dwordx4 v[72:75], v8, s[12:15], s74 offen sc1
    buffer_load_dwordx4 v[76:79], v8, s[12:15], s75 offen sc1
    buffer_load_dwordx4 v[80:83], v8, s[12:15], s84 offen sc1
    buffer_load_dwordx4 v[84:87], v8, s[12:15], s85 offen sc1
    buffer_load_dwordx4 v[88:91], v8, s[12:15], s86 offen sc1
    buffer_load_dwordx4 v[92:95], v8, s[12:15], s87 offen sc1
    buffer_load_dwordx4 v[96:99], v8, s[12:15], s88 offen sc1
    buffer_load_dwordx4 v[100:103], v8, s[12:15], s89 offen sc1
    buffer_load_dwordx4 v[104:107], v8, s[12:15], s90 offen sc1
    buffer_load_dwordx4 v[108:111], v8, s[12:15], s91 offen sc1
    buffer_load_dwordx4 v[112:115], v8, s[12:15], s92 offen sc1
    buffer_load_dwordx4 v[116:119], v8, s[12:15], s93 offen sc1
    buffer_load_dwordx4 v[120:123], v8, s[12:15], s94 offen sc1
    buffer_load_dwordx4 v[124:127], v8, s[12:15], s95 offen sc1
    s_mov_b32 s60, 0x100000
L_wn:
    s_nop 1
    ds_read_b32 v10, v2 offset:72
    s_sub_u32 s60, s60, 1
    s_cbranch_scc1 L_exit1
    s_waitcnt lgkmcnt(0)
    v_readfirstlane_b32 s48, v10
    s_cmp_lt_u32 s48, 4
    s_cbranch_scc1 L_wn
    ds_read_b32 v16, v13 offset:0
    ds_read_b32 v17, v13 offset:768
    ds_read_b32 v18, v13 offset:1536
    ds_read_b32 v19, v13 offset:2304
    ds_read_b32 v20, v13 offset:256
    ds_read_b32 v21, v13 offset:1024
    ds_read_b32 v22, v13 offset:1792
    ds_read_b32 v23, v13 offset:2560
    ds_read_b32 v24, v13 offset:512
    ds_read_b32 v25, v13 offset:1280
    ds_read_b32 v26, v13 offset:2048
    ds_read_b32 v27, v13 offset:2816
    s_mov_b32 s60, 0x40000
    s_waitcnt lgkmcnt(8)
    v_add_f32 v16, v16, v17
    v_add_f32 v18, v18, v19
    v_sub_f32 v16, v16, v6
    v_add_f32 v28, v16, v18
    s_waitcnt lgkmcnt(4)
    v_add_f32 v20, v20, v21
    v_add_f32 v22, v22, v23
    v_sub_f32 v20, v20, v6
    v_add_f32 v29, v20, v22
    s_waitcnt lgkmcnt(0)
    v_add_f32 v24, v24, v25
    v_add_f32 v26, v26, v27
    v_sub_f32 v24, v24, v6
    v_add_f32 v30, v24, v26
    s_branch L_fr2
L_fr:
    s_nop 1
    buffer_load_dwordx4 v[32:35], v8, s[12:15], s64 offen sc1
    buffer_load_dwordx4 v[36:39], v8, s[12:15], s65 offen sc1
    buffer_load_dwordx4 v[40:43], v8, s[12:15], s66 offen sc1
    buffer_load_dwordx4 v[44:47], v8, s[12:15], s67 offen sc1
    buffer_load_dwordx4 v[48:51], v8, s[12:15], s68 offen sc1
    buffer_load_dwordx4 v[52:55], v8, s[12:15], s69 offen sc1
    buffer_load_dwordx4 v[56:59], v8, s[12:15], s70 offen sc1
    buffer_load_dwordx4 v[60:63], v8, s[12:15], s71 offen sc1
    buffer_load_dwordx4 v[64:67], v8, s[12:15], s72 offen sc1
    buffer_load_dwordx4 v[68:71], v8, s[12:15], s73 offen sc1
    buffer_load_dwordx4 v[72:75], v8, s[12:15], s74 offen sc1
    buffer_load_dwordx4 v[76:79], v8, s[12:15], s75 offen sc1
    buffer_load_dwordx4 v[80:83], v8, s[12:15], s84 offen sc1
    buffer_load_dwordx4 v[84:87], v8, s[12:15], s85 offen sc1
    buffer_load_dwordx4 v[88:91], v8, s[12:15], s86 offen sc1
    buffer_load_dwordx4 v[92:95], v8, s[12:15], s87 offen sc1
    buffer_load_dwordx4 v[96:99], v8, s[12:15], s88 offen sc1
    buffer_load_dwordx4 v[100:103], v8, s[12:15], s89 offen sc1
    buffer_load_dwordx4 v[104:107], v8, s[12:15], s90 offen sc1
    buffer_load_dwordx4 v[108:111], v8, s[12:15], s91 offen sc1
    buffer_load_dwordx4 v[112:115], v8, s[12:15], s92 offen sc1
    buffer_load_dwordx4 v[116:119], v8, s[12:15], s93 offen sc1
    buffer_load_dwordx4 v[120:123], v8, s[12:15], s94 offen sc1
    buffer_load_dwordx4 v[124:127], v8, s[12:15], s95 offen sc1
L_fr2:
    v_mul_f32 v4, s57, v28
    v_mul_f32 v5, s57, v29
    v_mul_f32 v6, s57, v30
    v_mov_b32 v7, 1
    s_sub_u32 s60, s60, 1
    s_cbranch_scc1 L_exit1
    s_waitcnt vmcnt(22)
    v_fmac_f32 v4, s24, v32
    v_fmac_f32 v5, s24, v33
    v_fmac_f32 v6, s24, v34
    v_fmac_f32 v4, s25, v36
    v_fmac_f32 v5, s25, v37
    v_fmac_f32 v6, s25, v38
    v_min3_u32 v7, v7, v35, v39
    s_waitcnt vmcnt(20)
    v_fmac_f32 v4, s26, v40
    v_fmac_f32 v5, s26, v41
    v_fmac_f32 v6, s26, v42
    v_fmac_f32 v4, s27, v44
    v_fmac_f32 v5, s27, v45
    v_fmac_f32 v6, s27, v46
    v_min3_u32 v7, v7, v43, v47
    s_waitcnt vmcnt(18)
    v_fmac_f32 v4, s28, v48
    v_fmac_f32 v5, s28, v49
    v_fmac_f32 v6, s28, v50
    v_fmac_f32 v4, s29, v52
    v_fmac_f32 v5, s29, v53
    v_fmac_f32 v6, s29, v54
    v_min3_u32 v7, v7, v51, v55
    s_waitcnt vmcnt(16)
    v_fmac_f32 v4, s30, v56
    v_fmac_f32 v5, s30, v57
    v_fmac_f32 v6, s30, v58
    v_fmac_f32 v4, s31, v60
    v_fmac_f32 v5, s31, v61
    v_fmac_f32 v6, s31, v62
    v_min3_u32 v7, v7, v59, v63
    s_waitcnt vmcnt(14)
    v_fmac_f32 v4, s32, v64
    v_fmac_f32 v5, s32, v65
    v_fmac_f32 v6, s32, v66
    v_fmac_f32 v4, s33, v68
    v_fmac_f32 v5, s33, v69
    v_fmac_f32 v6, s33, v70
    v_min3_u32 v7, v7, v67, v71
    s_waitcnt vmcnt(12)
    v_fmac_f32 v4, s34, v72
    v_fmac_f32 v5, s34, v73
    v_fmac_f32 v6, s34, v74
    v_fmac_f32 v4, s35, v76
    v_fmac_f32 v5, s35, v77
    v_fmac_f32 v6, s35, v78
    v_min3_u32 v7, v7, v75, v79
    s_waitcnt vmcnt(10)
    v_fmac_f32 v4, s36, v80
    v_fmac_f32 v5, s36, v81
    v_fmac_f32 v6, s36, v82
    v_fmac_f32 v4, s37, v84
    v_fmac_f32 v5, s37, v85
    v_fmac_f32 v6, s37, v86
    v_min3_u32 v7, v7, v83, v87
    s_waitcnt vmcnt(8)
    v_fmac_f32 v4, s38, v88
    v_fmac_f32 v5, s38, v89
    v_fmac_f32 v6, s38, v90
    v_fmac_f32 v4, s39, v92
    v_fmac_f32 v5, s39, v93
    v_fmac_f32 v6, s39, v94
    v_min3_u32 v7, v7, v91, v95
    s_waitcnt vmcnt(6)
    v_fmac_f32 v4, s40, v96
    v_fmac_f32 v5, s40, v97
    v_fmac_f32 v6, s40, v98
    v_fmac_f32 v4, s41, v100
    v_fmac_f32 v5, s41, v101
    v_fmac_f32 v6, s41, v102
    v_min3_u32 v7, v7, v99, v103
    s_waitcnt vmcnt(4)
    v_fmac_f32 v4, s42, v104
    v_fmac_f32 v5, s42, v105
    v_fmac_f32 v6, s42, v106
    v_fmac_f32 v4, s43, v108
    v_fmac_f32 v5, s43, v109
    v_fmac_f32 v6, s43, v110
    v_min3_u32 v7, v7, v107, v111
    s_waitcnt vmcnt(2)
    v_fmac_f32 v4, s44, v112
    v_fmac_f32 v5, s44, v113
    v_fmac_f32 v6, s44, v114
    v_fmac_f32 v4, s45, v116
    v_fmac_f32 v5, s45, v117
    v_fmac_f32 v6, s45, v118
    v_min3_u32 v7, v7, v115, v119
    s_waitcnt vmcnt(0)
    v_fmac_f32 v4, s46, v120
    v_fmac_f32 v5, s46, v121
    v_fmac_f32 v6, s46, v122
    v_fmac_f32 v4, s47, v124
    v_fmac_f32 v5, s47, v125
    v_fmac_f32 v6, s47, v126
    v_min3_u32 v7, v7, v123, v127
    v_cmp_eq_u32 vcc, 0, v7
    v_cvt_pk_bf16_f32 v4, v4, v4
    v_cvt_pk_bf16_f32 v5, v5, v5
    v_cvt_pk_bf16_f32 v6, v6, v6
    s_cbranch_vccnz L_fr
    buffer_store_short v4, v12, s[96:99], s59 offen offset:0
    buffer_store_short v5, v12, s[96:99], s59 offen offset:128
    buffer_store_short v6, v12, s[96:99], s59 offen offset:256
L_fx:
    s_endpgm
L_h2:
    s_nop 1
    s_mov_b32 s92, s74
    s_and_b32 s93, s75, 0xffff
    s_mov_b32 s94, 2097152
    s_mov_b32 s95, 0x00020000
    s_mov_b32 s96, s76
    s_and_b32 s97, s77, 0xffff
    s_mov_b32 s98, 2097152
    s_mov_b32 s99, 0x00020000
    s_mov_b32 s60, 0x100000
L_wd2:
    s_nop 1
    ds_read_b32 v10, v2 offset:20
    s_sub_u32 s60, s60, 1
    s_cbranch_scc1 L_exit1
    s_waitcnt lgkmcnt(0)
    v_readfirstlane_b32 s48, v10
    s_cmp_eq_u32 s48, 0
    s_cbranch_scc1 L_wd2
    ds_read_b128 v[16:19], v2 offset:0
    ds_read_b64 v[20:21], v2 offset:16
    s_waitcnt lgkmcnt(0)
    v_readfirstlane_b32 s84, v16
    v_readfirstlane_b32 s85, v17
    v_readfirstlane_b32 s86, v18
    v_readfirstlane_b32 s87, v19
    v_readfirstlane_b32 s88, v20
    v_readfirstlane_b32 s89, v21
    v_and_b32 v3, 3, v1
    v_and_b32 v15, 7, v1
    v_lshrrev_b32 v12, 2, v1
    s_mov_b32 s37, 0x3dd53b95
    s_mov_b32 s38, 0xaaaaaaab
    s_mov_b32 s61, 0
    s_mul_i32 s35, s3, 32768
    s_add_u32 s35, s35, 2097152
    s_mov_b32 s40, 4096
    v_lshlrev_b32 v14, 5, v1
    v_lshrrev_b32 v8, 3, v1
    v_mul_u32_u24 v8, 24, v8
    v_mov_b32 v4, 768
    v_mad_u32_u24 v8, v15, v4, v8
    v_lshrrev_b32 v4, 3, v1
    v_lshlrev_b32 v104, 7, v15
    v_lshl_add_u32 v104, v4, 4, v104
    s_mov_b32 s34, 6
L_prep:
    s_nop 1
    s_lshl_b32 s62, s61, 5
    s_add_u32 s62, s62, s3
    s_lshl_b32 s63, s62, 15
    s_add_u32 s63, s63, 1
    s_mul_hi_u32 s63, s63, 0xaaaaaaab
    s_lshr_b32 s63, s63, 7
    s_mov_b32 s32, s84
    s_mov_b32 s39, s87
    s_mov_b32 s84, s85
    s_mov_b32 s85, s86
    s_mov_b32 s87, s88
    s_mov_b32 s88, s89
    s_lshl_b32 s33, s61, 3
    s_add_u32 s33, s33, 1
    s_mov_b32 s60, 0x100000
L_wpf:
    s_nop 1
    ds_read_b32 v10, v2 offset:60
    s_sub_u32 s60, s60, 1
    s_cbranch_scc1 L_exit1
    s_waitcnt lgkmcnt(0)
    v_readfirstlane_b32 s48, v10
    s_cmp_lt_u32 s48, s33
    s_cbranch_scc1 L_wpf
    v_lshlrev_b32 v4, 4, v1
    s_mul_i32 s49, s4, 2736
    s_lshl_b32 s48, s62, 16
    s_mul_hi_u32 s48, s48, 0xaaaaaaab
    s_lshr_b32 s48, s48, 5
    s_lshl_b32 s48, s48, 4
    s_add_u32 s48, s48, s49
    buffer_load_dwordx4 v[80:83], v4, s[92:95], s48 offen offset:0
    buffer_load_dwordx4 v[84:87], v4, s[92:95], s48 offen offset:1024
    buffer_load_dwordx4 v[88:91], v4, s[92:95], s48 offen offset:2048
    buffer_load_dwordx4 v[92:95], v4, s[96:99], s48 offen offset:0
    buffer_load_dwordx4 v[96:99], v4, s[96:99], s48 offen offset:1024
    buffer_load_dwordx4 v[100:103], v4, s[96:99], s48 offen offset:2048
    s_and_b32 s48, s39, 7
    v_mov_b32 v9, s48
    s_bitcmp1_b32 s39, 3
    s_cselect_b64 vcc, -1, 0
    v_cndmask_b32 v9, v9, v15, vcc
    v_xor_b32 v13, s5, v9
    v_lshl_or_b32 v13, v3, 3, v13
    s_lshl_b32 s36, s62, 6
    s_mul_i32 s49, s62, 768
    s_lshl_b32 s50, s63, 2
    s_sub_u32 s49, s49, s50
    s_add_u32 s49, s49, 1179648
    s_add_u32 s33, s33, 4
    s_mov_b32 s60, 0x100000
L_wga:
    s_nop 1
    ds_read_b32 v10, v2 offset:60
    s_sub_u32 s60, s60, 1
    s_cbranch_scc1 L_exit1
    s_waitcnt lgkmcnt(0)
    v_readfirstlane_b32 s48, v10
    s_cmp_lt_u32 s48, s33
    s_cbranch_scc1 L_wga
    v_add_u32 v4, 0, v12
    v_bfe_u32 v5, v4, 3, 2
    v_and_or_b32 v5, v4, 4, v5
    v_xor_b32 v5, v13, v5
    v_add_u32 v4, s36, v4
    v_lshl_add_u32 v6, v4, 5, v5
    v_lshl_add_u32 v6, v6, 4, 1
    v_mul_hi_u32 v6, v6, s38
    v_lshrrev_b32 v6, 1, v6
    v_lshrrev_b32 v22, 6, v6
    v_lshl_add_u32 v22, v22, 2, s49
    v_and_b32 v7, 15, v6
    v_cmp_eq_u32 s[24:25], 5, v7
    v_and_b32 v23, 1, v6
    v_lshlrev_b32 v23, 4, v23
    s_waitcnt vmcnt(0)
    v_add_u32 v4, 16, v12
    v_bfe_u32 v5, v4, 3, 2
    v_and_or_b32 v5, v4, 4, v5
    v_xor_b32 v5, v13, v5
    v_add_u32 v4, s36, v4
    v_lshl_add_u32 v6, v4, 5, v5
    v_lshl_add_u32 v6, v6, 4, 1
    v_mul_hi_u32 v6, v6, s38
    v_lshrrev_b32 v6, 1, v6
    v_lshrrev_b32 v38, 6, v6
    v_lshl_add_u32 v38, v38, 2, s49
    v_and_b32 v7, 15, v6
    v_cmp_eq_u32 s[26:27], 5, v7
    v_and_b32 v39, 1, v6
    v_lshlrev_b32 v39, 4, v39
    s_waitcnt vmcnt(0)
    v_add_u32 v4, 32, v12
    v_bfe_u32 v5, v4, 3, 2
    v_and_or_b32 v5, v4, 4, v5
    v_xor_b32 v5, v13, v5
    v_add_u32 v4, s36, v4
    v_lshl_add_u32 v6, v4, 5, v5
    v_lshl_add_u32 v6, v6, 4, 1
    v_mul_hi_u32 v6, v6, s38
    v_lshrrev_b32 v6, 1, v6
    v_lshrrev_b32 v54, 6, v6
    v_lshl_add_u32 v54, v54, 2, s49
    v_and_b32 v7, 15, v6
    v_cmp_eq_u32 s[28:29], 5, v7
    v_and_b32 v55, 1, v6
    v_lshlrev_b32 v55, 4, v55
    s_waitcnt vmcnt(0)
    v_add_u32 v4, 48, v12
    v_bfe_u32 v5, v4, 3, 2
    v_and_or_b32 v5, v4, 4, v5
    v_xor_b32 v5, v13, v5
    v_add_u32 v4, s36, v4
    v_lshl_add_u32 v6, v4, 5, v5
    v_lshl_add_u32 v6, v6, 4, 1
    v_mul_hi_u32 v6, v6, s38
    v_lshrrev_b32 v6, 1, v6
    v_lshrrev_b32 v70, 6, v6
    v_lshl_add_u32 v70, v70, 2, s49
    v_and_b32 v7, 15, v6
    v_cmp_eq_u32 s[30:31], 5, v7
    v_and_b32 v71, 1, v6
    v_lshlrev_b32 v71, 4, v71
    s_waitcnt vmcnt(0)
    s_add_u32 s33, s61, 1
    s_mov_b32 s60, 0x100000
L_wfd:
    s_nop 1
    ds_read_b32 v10, v2 offset:52
    s_sub_u32 s60, s60, 1
    s_cbranch_scc1 L_exit1
    s_waitcnt lgkmcnt(0)
    v_readfirstlane_b32 s48, v10
    s_cmp_lt_u32 s48, s33
    s_cbranch_scc1 L_wfd
    v_mul_u32_u24 v4, 4352, v1
    s_xor_b32 s48, s32, s39
    s_xor_b32 s48, s48, s5
    s_and_b32 s48, s48, 7
    v_mov_b32 v6, s33
    s_lshl_b64 vcc, 1, s48
    s_or_b32 s48, s32, s39
    s_bitcmp1_b32 s48, 3
    s_cselect_b64 vcc, 0xff, vcc
    s_cmp_eq_u32 s32, s39
    s_cselect_b64 vcc, 0, vcc
    s_max_u32 s48, s61, 1
    v_mov_b32 v7, s48
    v_cndmask_b32 v6, v7, v6, vcc
    s_cmp_eq_u32 s61, 1
    s_cselect_b64 exec, vcc, 0xff
    s_mov_b32 s60, 0x40000
    s_cbranch_execz L_noflags
L_flags:
    s_nop 1
    buffer_load_dword v5, v4, s[12:15], s59 offen sc1
    s_sub_u32 s60, s60, 1
    s_cbranch_scc1 L_exit1
    s_waitcnt vmcnt(0)
    v_cmpx_gt_u32 vcc, v6, v5
    s_cbranch_execnz L_flags
L_noflags:
    s_nop 1
    s_mov_b64 exec, -1
    buffer_load_dword v22, v22, s[12:15], 0 offen sc1
    buffer_load_dword v38, v38, s[12:15], 0 offen sc1
    buffer_load_dword v54, v54, s[12:15], 0 offen sc1
    buffer_load_dword v70, v70, s[12:15], 0 offen sc1
    s_bitcmp1_b32 s39, 3
    s_cselect_b32 s49, 0, 7
    s_xor_b32 s50, s32, s39
    s_bitcmp1_b32 s50, 3
    s_cselect_b32 s51, 7, 0
    s_and_b32 s50, s50, 7
    s_and_b32 s52, s39, 7
    v_lshrrev_b32 v4, 3, v1
    v_cmp_gt_u32 vcc, s34, v4
    v_and_b32 v6, s51, v15
    v_xor_b32 v6, s50, v6
    v_and_b32 v5, s49, v15
    v_xor_b32 v5, s52, v5
    v_cndmask_b32 v5, v6, v5, vcc
    v_cmp_ne_u32 s[64:65], 0, v5
    v_xor_b32 v5, s5, v5
    v_mad_u32_u24 v5, v5, s40, v104
    v_cmp_ne_u32 s[66:67], 0, v6
    v_xor_b32 v6, s5, v6
    v_mad_u32_u24 v6, v6, s40, v104
    s_mov_b64 exec, s[64:65]
    buffer_load_dwordx4 v[80:83], v5, s[12:15], s35 offen offset:0 sc1
    s_mov_b64 exec, s[66:67]
    buffer_load_dwordx4 v[84:87], v6, s[12:15], s35 offen offset:1024 sc1
    buffer_load_dwordx4 v[88:91], v6, s[12:15], s35 offen offset:2048 sc1
    buffer_load_dwordx4 v[92:95], v6, s[12:15], s35 offen offset:3072 sc1
    s_mov_b64 exec, -1
    v_add_u32 v4, 0, v12
    v_bfe_u32 v5, v4, 3, 2
    v_and_or_b32 v5, v4, 4, v5
    v_xor_b32 v5, v13, v5
    v_add_u32 v4, s36, v4
    v_lshl_add_u32 v6, v4, 5, v5
    v_lshl_add_u32 v6, v6, 4, 1
    v_mul_hi_u32 v6, v6, s38
    v_lshrrev_b32 v6, 1, v6
    v_lshrrev_b32 v11, 1, v6
    v_lshlrev_b32 v11, 2, v11
    s_memrealtime s[42:43]
    s_waitcnt lgkmcnt(0)
L_tw1:
    s_nop 1
    s_memrealtime s[44:45]
    s_waitcnt lgkmcnt(0)
    s_sub_u32 s45, s44, s42
    s_cmp_lt_i32 s45, 0
    s_cbranch_scc1 L_tw1
    s_add_u32 s42, s44, 140
    s_mov_b32 exec_lo, 0xffffffff
    s_mov_b32 exec_hi, 0x0
    buffer_load_dwordx3 v[24:26], v11, s[92:95], 0 offen
    buffer_load_dword v27, v11, s[92:95], 0 offen offset:12
L_tw2:
    s_nop 1
    s_memrealtime s[44:45]
    s_waitcnt lgkmcnt(0)
    s_sub_u32 s45, s44, s42
    s_cmp_lt_i32 s45, 0
    s_cbranch_scc1 L_tw2
    s_add_u32 s42, s44, 140
    s_mov_b32 exec_lo, 0x0
    s_mov_b32 exec_hi, 0xffffffff
    buffer_load_dwordx3 v[24:26], v11, s[92:95], 0 offen
    buffer_load_dword v27, v11, s[92:95], 0 offen offset:12
    s_mov_b64 exec, -1
L_tw3:
    s_nop 1
    s_memrealtime s[44:45]
    s_waitcnt lgkmcnt(0)
    s_sub_u32 s45, s44, s42
    s_cmp_lt_i32 s45, 0
    s_cbranch_scc1 L_tw3
    s_add_u32 s42, s44, 140
    s_mov_b32 exec_lo, 0xffffffff
    s_mov_b32 exec_hi, 0x0
    buffer_load_dwordx3 v[28:30], v11, s[96:99], 0 offen
    buffer_load_dword v31, v11, s[96:99], 0 offen offset:12
L_tw4:
    s_nop 1
    s_memrealtime s[44:45]
    s_waitcnt lgkmcnt(0)
    s_sub_u32 s45, s44, s42
    s_cmp_lt_i32 s45, 0
    s_cbranch_scc1 L_tw4
    s_add_u32 s42, s44, 140
    s_mov_b32 exec_lo, 0x0
    s_mov_b32 exec_hi, 0xffffffff
    buffer_load_dwordx3 v[28:30], v11, s[96:99], 0 offen
    buffer_load_dword v31, v11, s[96:99], 0 offen offset:12
    s_mov_b64 exec, -1
    v_add_u32 v4, 16, v12
    v_bfe_u32 v5, v4, 3, 2
    v_and_or_b32 v5, v4, 4, v5
    v_xor_b32 v5, v13, v5
    v_add_u32 v4, s36, v4
    v_lshl_add_u32 v6, v4, 5, v5
    v_lshl_add_u32 v6, v6, 4, 1
    v_mul_hi_u32 v6, v6, s38
    v_lshrrev_b32 v6, 1, v6
    v_lshrrev_b32 v11, 1, v6
    v_lshlrev_b32 v11, 2, v11
L_tw5:
    s_nop 1
    s_memrealtime s[44:45]
    s_waitcnt lgkmcnt(0)
    s_sub_u32 s45, s44, s42
    s_cmp_lt_i32 s45, 0
    s_cbranch_scc1 L_tw5
    s_add_u32 s42, s44, 140
    s_mov_b32 exec_lo, 0xffffffff
    s_mov_b32 exec_hi, 0x0
    buffer_load_dwordx3 v[40:42], v11, s[92:95], 0 offen
    buffer_load_dword v43, v11, s[92:95], 0 offen offset:12
L_tw6:
    s_nop 1
    s_memrealtime s[44:45]
    s_waitcnt lgkmcnt(0)
    s_sub_u32 s45, s44, s42
    s_cmp_lt_i32 s45, 0
    s_cbranch_scc1 L_tw6
    s_add_u32 s42, s44, 140
    s_mov_b32 exec_lo, 0x0
    s_mov_b32 exec_hi, 0xffffffff
    buffer_load_dwordx3 v[40:42], v11, s[92:95], 0 offen
    buffer_load_dword v43, v11, s[92:95], 0 offen offset:12
    s_mov_b64 exec, -1
L_tw7:
    s_nop 1
    s_memrealtime s[44:45]
    s_waitcnt lgkmcnt(0)
    s_sub_u32 s45, s44, s42
    s_cmp_lt_i32 s45, 0
    s_cbranch_scc1 L_tw7
    s_add_u32 s42, s44, 140
    s_mov_b32 exec_lo, 0xffffffff
    s_mov_b32 exec_hi, 0x0
    buffer_load_dwordx3 v[44:46], v11, s[96:99], 0 offen
    buffer_load_dword v47, v11, s[96:99], 0 offen offset:12
L_tw8:
    s_nop 1
    s_memrealtime s[44:45]
    s_waitcnt lgkmcnt(0)
    s_sub_u32 s45, s44, s42
    s_cmp_lt_i32 s45, 0
    s_cbranch_scc1 L_tw8
    s_add_u32 s42, s44, 140
    s_mov_b32 exec_lo, 0x0
    s_mov_b32 exec_hi, 0xffffffff
    buffer_load_dwordx3 v[44:46], v11, s[96:99], 0 offen
    buffer_load_dword v47, v11, s[96:99], 0 offen offset:12
    s_mov_b64 exec, -1
    v_add_u32 v4, 32, v12
    v_bfe_u32 v5, v4, 3, 2
    v_and_or_b32 v5, v4, 4, v5
    v_xor_b32 v5, v13, v5
    v_add_u32 v4, s36, v4
    v_lshl_add_u32 v6, v4, 5, v5
    v_lshl_add_u32 v6, v6, 4, 1
    v_mul_hi_u32 v6, v6, s38
    v_lshrrev_b32 v6, 1, v6
    v_lshrrev_b32 v11, 1, v6
    v_lshlrev_b32 v11, 2, v11
L_tw9:
    s_nop 1
    s_memrealtime s[44:45]
    s_waitcnt lgkmcnt(0)
    s_sub_u32 s45, s44, s42
    s_cmp_lt_i32 s45, 0
    s_cbranch_scc1 L_tw9
    s_add_u32 s42, s44, 140
    s_mov_b32 exec_lo, 0xffffffff
    s_mov_b32 exec_hi, 0x0
    buffer_load_dwordx3 v[56:58], v11, s[92:95], 0 offen
    buffer_load_dword v59, v11, s[92:95], 0 offen offset:12
L_tw10:
    s_nop 1
    s_memrealtime s[44:45]
    s_waitcnt lgkmcnt(0)
    s_sub_u32 s45, s44, s42
    s_cmp_lt_i32 s45, 0
    s_cbranch_scc1 L_tw10
    s_add_u32 s42, s44, 140
    s_mov_b32 exec_lo, 0x0
    s_mov_b32 exec_hi, 0xffffffff
    buffer_load_dwordx3 v[56:58], v11, s[92:95], 0 offen
    buffer_load_dword v59, v11, s[92:95], 0 offen offset:12
    s_mov_b64 exec, -1
L_tw11:
    s_nop 1
    s_memrealtime s[44:45]
    s_waitcnt lgkmcnt(0)
    s_sub_u32 s45, s44, s42
    s_cmp_lt_i32 s45, 0
    s_cbranch_scc1 L_tw11
    s_add_u32 s42, s44, 140
    s_mov_b32 exec_lo, 0xffffffff
    s_mov_b32 exec_hi, 0x0
    buffer_load_dwordx3 v[60:62], v11, s[96:99], 0 offen
    buffer_load_dword v63, v11, s[96:99], 0 offen offset:12
L_tw12:
    s_nop 1
    s_memrealtime s[44:45]
    s_waitcnt lgkmcnt(0)
    s_sub_u32 s45, s44, s42
    s_cmp_lt_i32 s45, 0
    s_cbranch_scc1 L_tw12
    s_add_u32 s42, s44, 140
    s_mov_b32 exec_lo, 0x0
    s_mov_b32 exec_hi, 0xffffffff
    buffer_load_dwordx3 v[60:62], v11, s[96:99], 0 offen
    buffer_load_dword v63, v11, s[96:99], 0 offen offset:12
    s_mov_b64 exec, -1
    v_add_u32 v4, 48, v12
    v_bfe_u32 v5, v4, 3, 2
    v_and_or_b32 v5, v4, 4, v5
    v_xor_b32 v5, v13, v5
    v_add_u32 v4, s36, v4
    v_lshl_add_u32 v6, v4, 5, v5
    v_lshl_add_u32 v6, v6, 4, 1
    v_mul_hi_u32 v6, v6, s38
    v_lshrrev_b32 v6, 1, v6
    v_lshrrev_b32 v11, 1, v6
    v_lshlrev_b32 v11, 2, v11
L_tw13:
    s_nop 1
    s_memrealtime s[44:45]
    s_waitcnt lgkmcnt(0)
    s_sub_u32 s45, s44, s42
    s_cmp_lt_i32 s45, 0
    s_cbranch_scc1 L_tw13
    s_add_u32 s42, s44, 140
    s_mov_b32 exec_lo, 0xffffffff
    s_mov_b32 exec_hi, 0x0
    buffer_load_dwordx3 v[72:74], v11, s[92:95], 0 offen
    buffer_load_dword v75, v11, s[92:95], 0 offen offset:12
L_tw14:
    s_nop 1
    s_memrealtime s[44:45]
    s_waitcnt lgkmcnt(0)
    s_sub_u32 s45, s44, s42
    s_cmp_lt_i32 s45, 0
    s_cbranch_scc1 L_tw14
    s_add_u32 s42, s44, 140
    s_mov_b32 exec_lo, 0x0
    s_mov_b32 exec_hi, 0xffffffff
    buffer_load_dwordx3 v[72:74], v11, s[92:95], 0 offen
    buffer_load_dword v75, v11, s[92:95], 0 offen offset:12
    s_mov_b64 exec, -1
L_tw15:
    s_nop 1
    s_memrealtime s[44:45]
    s_waitcnt lgkmcnt(0)
    s_sub_u32 s45, s44, s42
    s_cmp_lt_i32 s45, 0
    s_cbranch_scc1 L_tw15
    s_add_u32 s42, s44, 140
    s_mov_b32 exec_lo, 0xffffffff
    s_mov_b32 exec_hi, 0x0
    buffer_load_dwordx3 v[76:78], v11, s[96:99], 0 offen
    buffer_load_dword v79, v11, s[96:99], 0 offen offset:12
L_tw16:
    s_nop 1
    s_memrealtime s[44:45]
    s_waitcnt lgkmcnt(0)
    s_sub_u32 s45, s44, s42
    s_cmp_lt_i32 s45, 0
    s_cbranch_scc1 L_tw16
    s_add_u32 s42, s44, 140
    s_mov_b32 exec_lo, 0x0
    s_mov_b32 exec_hi, 0xffffffff
    buffer_load_dwordx3 v[76:78], v11, s[96:99], 0 offen
    buffer_load_dword v79, v11, s[96:99], 0 offen offset:12
    s_mov_b64 exec, -1
    ds_read_b64 v[16:17], v8 offset:256
    ds_read_b64 v[18:19], v8 offset:264
    ds_read_b64 v[20:21], v8 offset:272
    ds_read_b64 v[32:33], v8 offset:448
    ds_read_b64 v[34:35], v8 offset:456
    ds_read_b64 v[36:37], v8 offset:464
    ds_read_b64 v[48:49], v8 offset:640
    ds_read_b64 v[50:51], v8 offset:648
    ds_read_b64 v[52:53], v8 offset:656
    ds_read_b64 v[64:65], v8 offset:832
    ds_read_b64 v[66:67], v8 offset:840
    ds_read_b64 v[68:69], v8 offset:848
    s_mov_b32 s34, 0
    v_mov_b32 v5, 0xf149f2ca
    v_mov_b32 v4, 0xf149f2ca
    s_waitcnt vmcnt(0) lgkmcnt(0)
    s_mov_b64 exec, s[64:65]
    v_fma_mix_f32 v16, v81, 1.0, v80 op_sel:[0,0,0] op_sel_hi:[1,0,0]
    v_fma_mix_f32 v17, v81, 1.0, v80 op_sel:[1,0,0] op_sel_hi:[1,0,0]
    v_fma_mix_f32 v18, v82, 1.0, v80 op_sel:[0,0,0] op_sel_hi:[1,0,0]
    v_fma_mix_f32 v19, v82, 1.0, v80 op_sel:[1,0,0] op_sel_hi:[1,0,0]
    v_fma_mix_f32 v20, v83, 1.0, v80 op_sel:[0,0,0] op_sel_hi:[1,0,0]
    v_fma_mix_f32 v21, v83, 1.0, v80 op_sel:[1,0,0] op_sel_hi:[1,0,0]
    v_cmp_lt_f32 vcc, v80, v21
    s_nop 1
    v_cndmask_b32 v21, v21, v2, vcc
    s_mov_b64 exec, s[66:67]
    v_fma_mix_f32 v32, v85, 1.0, v84 op_sel:[0,0,0] op_sel_hi:[1,0,0]
    v_fma_mix_f32 v33, v85, 1.0, v84 op_sel:[1,0,0] op_sel_hi:[1,0,0]
    v_fma_mix_f32 v34, v86, 1.0, v84 op_sel:[0,0,0] op_sel_hi:[1,0,0]
    v_fma_mix_f32 v35, v86, 1.0, v84 op_sel:[1,0,0] op_sel_hi:[1,0,0]
    v_fma_mix_f32 v36, v87, 1.0, v84 op_sel:[0,0,0] op_sel_hi:[1,0,0]
    v_fma_mix_f32 v37, v87, 1.0, v84 op_sel:[1,0,0] op_sel_hi:[1,0,0]
    v_cmp_lt_f32 vcc, v84, v37
    s_nop 1
    v_cndmask_b32 v37, v37, v2, vcc
    v_fma_mix_f32 v48, v89, 1.0, v88 op_sel:[0,0,0] op_sel_hi:[1,0,0]
    v_fma_mix_f32 v49, v89, 1.0, v88 op_sel:[1,0,0] op_sel_hi:[1,0,0]
    v_fma_mix_f32 v50, v90, 1.0, v88 op_sel:[0,0,0] op_sel_hi:[1,0,0]
    v_fma_mix_f32 v51, v90, 1.0, v88 op_sel:[1,0,0] op_sel_hi:[1,0,0]
    v_fma_mix_f32 v52, v91, 1.0, v88 op_sel:[0,0,0] op_sel_hi:[1,0,0]
    v_fma_mix_f32 v53, v91, 1.0, v88 op_sel:[1,0,0] op_sel_hi:[1,0,0]
    v_cmp_lt_f32 vcc, v88, v53
    s_nop 1
    v_cndmask_b32 v53, v53, v2, vcc
    v_fma_mix_f32 v64, v93, 1.0, v92 op_sel:[0,0,0] op_sel_hi:[1,0,0]
    v_fma_mix_f32 v65, v93, 1.0, v92 op_sel:[1,0,0] op_sel_hi:[1,0,0]
    v_fma_mix_f32 v66, v94, 1.0, v92 op_sel:[0,0,0] op_sel_hi:[1,0,0]
    v_fma_mix_f32 v67, v94, 1.0, v92 op_sel:[1,0,0] op_sel_hi:[1,0,0]
    v_fma_mix_f32 v68, v95, 1.0, v92 op_sel:[0,0,0] op_sel_hi:[1,0,0]
    v_fma_mix_f32 v69, v95, 1.0, v92 op_sel:[1,0,0] op_sel_hi:[1,0,0]
    v_cmp_lt_f32 vcc, v92, v69
    s_nop 1
    v_cndmask_b32 v69, v69, v2, vcc
    s_mov_b64 exec, -1
    v_sub_f32 v16, v16, v22
    v_sub_f32 v17, v17, v22
    v_sub_f32 v18, v18, v22
    v_sub_f32 v19, v19, v22
    v_sub_f32 v20, v20, v22
    v_sub_f32 v21, v21, v22
    v_mul_f32 v16, s37, v16
    v_mul_f32 v17, s37, v17
    v_mul_f32 v18, s37, v18
    v_mul_f32 v19, s37, v19
    v_mul_f32 v20, s37, v20
    v_mul_f32 v21, s37, v21
    v_cndmask_b32 v21, v5, v21, s[24:25]
    v_max3_f32 v4, v4, v16, v17
    v_max3_f32 v4, v4, v18, v19
    v_max3_f32 v4, v4, v20, v21
    v_alignbit_b32 v24, v25, v24, v23
    v_alignbit_b32 v25, v26, v25, v23
    v_alignbit_b32 v26, v27, v26, v23
    v_alignbit_b32 v28, v29, v28, v23
    v_alignbit_b32 v29, v30, v29, v23
    v_alignbit_b32 v30, v31, v30, v23
    v_sub_f32 v32, v32, v38
    v_sub_f32 v33, v33, v38
    v_sub_f32 v34, v34, v38
    v_sub_f32 v35, v35, v38
    v_sub_f32 v36, v36, v38
    v_sub_f32 v37, v37, v38
    v_mul_f32 v32, s37, v32
    v_mul_f32 v33, s37, v33
    v_mul_f32 v34, s37, v34
    v_mul_f32 v35, s37, v35
    v_mul_f32 v36, s37, v36
    v_mul_f32 v37, s37, v37
    v_cndmask_b32 v37, v5, v37, s[26:27]
    v_max3_f32 v4, v4, v32, v33
    v_max3_f32 v4, v4, v34, v35
    v_max3_f32 v4, v4, v36, v37
    v_alignbit_b32 v40, v41, v40, v39
    v_alignbit_b32 v41, v42, v41, v39
    v_alignbit_b32 v42, v43, v42, v39
    v_alignbit_b32 v44, v45, v44, v39
    v_alignbit_b32 v45, v46, v45, v39
    v_alignbit_b32 v46, v47, v46, v39
    v_sub_f32 v48, v48, v54
    v_sub_f32 v49, v49, v54
    v_sub_f32 v50, v50, v54
    v_sub_f32 v51, v51, v54
    v_sub_f32 v52, v52, v54
    v_sub_f32 v53, v53, v54
    v_mul_f32 v48, s37, v48
    v_mul_f32 v49, s37, v49
    v_mul_f32 v50, s37, v50
    v_mul_f32 v51, s37, v51
    v_mul_f32 v52, s37, v52
    v_mul_f32 v53, s37, v53
    v_cndmask_b32 v53, v5, v53, s[28:29]
    v_max3_f32 v4, v4, v48, v49
    v_max3_f32 v4, v4, v50, v51
    v_max3_f32 v4, v4, v52, v53
    v_alignbit_b32 v56, v57, v56, v55
    v_alignbit_b32 v57, v58, v57, v55
    v_alignbit_b32 v58, v59, v58, v55
    v_alignbit_b32 v60, v61, v60, v55
    v_alignbit_b32 v61, v62, v61, v55
    v_alignbit_b32 v62, v63, v62, v55
    v_sub_f32 v64, v64, v70
    v_sub_f32 v65, v65, v70
    v_sub_f32 v66, v66, v70
    v_sub_f32 v67, v67, v70
    v_sub_f32 v68, v68, v70
    v_sub_f32 v69, v69, v70
    v_mul_f32 v64, s37, v64
    v_mul_f32 v65, s37, v65
    v_mul_f32 v66, s37, v66
    v_mul_f32 v67, s37, v67
    v_mul_f32 v68, s37, v68
    v_mul_f32 v69, s37, v69
    v_cndmask_b32 v69, v5, v69, s[30:31]
    v_max3_f32 v4, v4, v64, v65
    v_max3_f32 v4, v4, v66, v67
    v_max3_f32 v4, v4, v68, v69
    v_alignbit_b32 v72, v73, v72, v71
    v_alignbit_b32 v73, v74, v73, v71
    v_alignbit_b32 v74, v75, v74, v71
    v_alignbit_b32 v76, v77, v76, v71
    v_alignbit_b32 v77, v78, v77, v71
    v_alignbit_b32 v78, v79, v78, v71
    v_max_f32_dpp v4, v4, v4 row_ror:8 row_mask:0xf bank_mask:0xf
    s_nop 1
    v_max_f32_dpp v4, v4, v4 row_ror:4 row_mask:0xf bank_mask:0xf
    s_nop 1
    v_max_f32_dpp v4, v4, v4 row_ror:2 row_mask:0xf bank_mask:0xf
    s_nop 1
    v_max_f32_dpp v4, v4, v4 row_ror:1 row_mask:0xf bank_mask:0xf
    v_mov_b32 v5, v4
    s_nop 1
    v_permlane32_swap_b32 v4, v5
    v_max_f32 v4, v4, v5
    v_mov_b32 v5, v4
    s_nop 1
    v_permlane16_swap_b32 v4, v5
    v_max_f32 v4, v4, v5
    v_mov_b32 v5, 0
    v_mov_b32 v6, 0
    v_sub_f32 v16, v16, v4
    v_sub_f32 v17, v17, v4
    v_sub_f32 v18, v18, v4
    v_sub_f32 v19, v19, v4
    v_sub_f32 v20, v20, v4
    v_sub_f32 v21, v21, v4
    v_exp_f32 v16, v16
    v_exp_f32 v17, v17
    v_exp_f32 v18, v18
    v_exp_f32 v19, v19
    v_exp_f32 v20, v20
    v_exp_f32 v21, v21
    v_add_f32 v5, v5, v16
    v_lshlrev_b32 v10, 16, v24
    v_lshlrev_b32 v11, 16, v28
    v_mul_f32 v16, v16, v10
    v_fmac_f32 v6, v16, v11
    v_add_f32 v5, v5, v17
    v_and_b32 v10, 0xffff0000, v24
    v_and_b32 v11, 0xffff0000, v28
    v_mul_f32 v17, v17, v10
    v_fmac_f32 v6, v17, v11
    v_add_f32 v5, v5, v18
    v_lshlrev_b32 v10, 16, v25
    v_lshlrev_b32 v11, 16, v29
    v_mul_f32 v18, v18, v10
    v_fmac_f32 v6, v18, v11
    v_add_f32 v5, v5, v19
    v_and_b32 v10, 0xffff0000, v25
    v_and_b32 v11, 0xffff0000, v29
    v_mul_f32 v19, v19, v10
    v_fmac_f32 v6, v19, v11
    v_add_f32 v5, v5, v20
    v_lshlrev_b32 v10, 16, v26
    v_lshlrev_b32 v11, 16, v30
    v_mul_f32 v20, v20, v10
    v_fmac_f32 v6, v20, v11
    v_add_f32 v5, v5, v21
    v_and_b32 v10, 0xffff0000, v26
    v_and_b32 v11, 0xffff0000, v30
    v_mul_f32 v21, v21, v10
    v_fmac_f32 v6, v21, v11
    ds_write_b128 v14, v[16:19] offset:18688
    ds_write_b64 v14, v[20:21] offset:18704
    v_sub_f32 v32, v32, v4
    v_sub_f32 v33, v33, v4
    v_sub_f32 v34, v34, v4
    v_sub_f32 v35, v35, v4
    v_sub_f32 v36, v36, v4
    v_sub_f32 v37, v37, v4
    v_exp_f32 v32, v32
    v_exp_f32 v33, v33
    v_exp_f32 v34, v34
    v_exp_f32 v35, v35
    v_exp_f32 v36, v36
    v_exp_f32 v37, v37
    v_add_f32 v5, v5, v32
    v_lshlrev_b32 v10, 16, v40
    v_lshlrev_b32 v11, 16, v44
    v_mul_f32 v32, v32, v10
    v_fmac_f32 v6, v32, v11
    v_add_f32 v5, v5, v33
    v_and_b32 v10, 0xffff0000, v40
    v_and_b32 v11, 0xffff0000, v44
    v_mul_f32 v33, v33, v10
    v_fmac_f32 v6, v33, v11
    v_add_f32 v5, v5, v34
    v_lshlrev_b32 v10, 16, v41
    v_lshlrev_b32 v11, 16, v45
    v_mul_f32 v34, v34, v10
    v_fmac_f32 v6, v34, v11
    v_add_f32 v5, v5, v35
    v_and_b32 v10, 0xffff0000, v41
    v_and_b32 v11, 0xffff0000, v45
    v_mul_f32 v35, v35, v10
    v_fmac_f32 v6, v35, v11
    v_add_f32 v5, v5, v36
    v_lshlrev_b32 v10, 16, v42
    v_lshlrev_b32 v11, 16, v46
    v_mul_f32 v36, v36, v10
    v_fmac_f32 v6, v36, v11
    v_add_f32 v5, v5, v37
    v_and_b32 v10, 0xffff0000, v42
    v_and_b32 v11, 0xffff0000, v46
    v_mul_f32 v37, v37, v10
    v_fmac_f32 v6, v37, v11
    ds_write_b128 v14, v[32:35] offset:20736
    ds_write_b64 v14, v[36:37] offset:20752
    v_sub_f32 v48, v48, v4
    v_sub_f32 v49, v49, v4
    v_sub_f32 v50, v50, v4
    v_sub_f32 v51, v51, v4
    v_sub_f32 v52, v52, v4
    v_sub_f32 v53, v53, v4
    v_exp_f32 v48, v48
    v_exp_f32 v49, v49
    v_exp_f32 v50, v50
    v_exp_f32 v51, v51
    v_exp_f32 v52, v52
    v_exp_f32 v53, v53
    v_add_f32 v5, v5, v48
    v_lshlrev_b32 v10, 16, v56
    v_lshlrev_b32 v11, 16, v60
    v_mul_f32 v48, v48, v10
    v_fmac_f32 v6, v48, v11
    v_add_f32 v5, v5, v49
    v_and_b32 v10, 0xffff0000, v56
    v_and_b32 v11, 0xffff0000, v60
    v_mul_f32 v49, v49, v10
    v_fmac_f32 v6, v49, v11
    v_add_f32 v5, v5, v50
    v_lshlrev_b32 v10, 16, v57
    v_lshlrev_b32 v11, 16, v61
    v_mul_f32 v50, v50, v10
    v_fmac_f32 v6, v50, v11
    v_add_f32 v5, v5, v51
    v_and_b32 v10, 0xffff0000, v57
    v_and_b32 v11, 0xffff0000, v61
    v_mul_f32 v51, v51, v10
    v_fmac_f32 v6, v51, v11
    v_add_f32 v5, v5, v52
    v_lshlrev_b32 v10, 16, v58
    v_lshlrev_b32 v11, 16, v62
    v_mul_f32 v52, v52, v10
    v_fmac_f32 v6, v52, v11
    v_add_f32 v5, v5, v53
    v_and_b32 v10, 0xffff0000, v58
    v_and_b32 v11, 0xffff0000, v62
    v_mul_f32 v53, v53, v10
    v_fmac_f32 v6, v53, v11
    ds_write_b128 v14, v[48:51] offset:22784
    ds_write_b64 v14, v[52:53] offset:22800
    v_sub_f32 v64, v64, v4
    v_sub_f32 v65, v65, v4
    v_sub_f32 v66, v66, v4
    v_sub_f32 v67, v67, v4
    v_sub_f32 v68, v68, v4
    v_sub_f32 v69, v69, v4
    v_exp_f32 v64, v64
    v_exp_f32 v65, v65
    v_exp_f32 v66, v66
    v_exp_f32 v67, v67
    v_exp_f32 v68, v68
    v_exp_f32 v69, v69
    v_add_f32 v5, v5, v64
    v_lshlrev_b32 v10, 16, v72
    v_lshlrev_b32 v11, 16, v76
    v_mul_f32 v64, v64, v10
    v_fmac_f32 v6, v64, v11
    v_add_f32 v5, v5, v65
    v_and_b32 v10, 0xffff0000, v72
    v_and_b32 v11, 0xffff0000, v76
    v_mul_f32 v65, v65, v10
    v_fmac_f32 v6, v65, v11
    v_add_f32 v5, v5, v66
    v_lshlrev_b32 v10, 16, v73
    v_lshlrev_b32 v11, 16, v77
    v_mul_f32 v66, v66, v10
    v_fmac_f32 v6, v66, v11
    v_add_f32 v5, v5, v67
    v_and_b32 v10, 0xffff0000, v73
    v_and_b32 v11, 0xffff0000, v77
    v_mul_f32 v67, v67, v10
    v_fmac_f32 v6, v67, v11
    v_add_f32 v5, v5, v68
    v_lshlrev_b32 v10, 16, v74
    v_lshlrev_b32 v11, 16, v78
    v_mul_f32 v68, v68, v10
    v_fmac_f32 v6, v68, v11
    v_add_f32 v5, v5, v69
    v_and_b32 v10, 0xffff0000, v74
    v_and_b32 v11, 0xffff0000, v78
    v_mul_f32 v69, v69, v10
    v_fmac_f32 v6, v69, v11
    ds_write_b128 v14, v[64:67] offset:24832
    ds_write_b64 v14, v[68:69] offset:24848
    v_add_f32_dpp v5, v5, v5 row_ror:8 row_mask:0xf bank_mask:0xf
    v_add_f32_dpp v6, v6, v6 row_ror:8 row_mask:0xf bank_mask:0xf
    s_nop 0
    v_add_f32_dpp v5, v5, v5 row_ror:4 row_mask:0xf bank_mask:0xf
    v_add_f32_dpp v6, v6, v6 row_ror:4 row_mask:0xf bank_mask:0xf
    s_nop 0
    v_add_f32_dpp v5, v5, v5 row_ror:2 row_mask:0xf bank_mask:0xf
    v_add_f32_dpp v6, v6, v6 row_ror:2 row_mask:0xf bank_mask:0xf
    s_nop 0
    v_add_f32_dpp v5, v5, v5 row_ror:1 row_mask:0xf bank_mask:0xf
    v_add_f32_dpp v6, v6, v6 row_ror:1 row_mask:0xf bank_mask:0xf
    v_mov_b32 v10, v5
    v_mov_b32 v11, v6
    s_nop 0
    v_permlane32_swap_b32 v5, v10
    v_permlane32_swap_b32 v6, v11
    v_add_f32 v5, v5, v10
    v_add_f32 v6, v6, v11
    v_mov_b32 v10, v5
    v_mov_b32 v11, v6
    s_nop 0
    v_permlane16_swap_b32 v5, v10
    v_permlane16_swap_b32 v6, v11
    v_add_f32 v5, v5, v10
    v_add_f32 v6, v6, v11
    s_lshl_b32 s48, s61, 2
    v_mov_b32 v10, s48
    v_lshlrev_b32 v11, 2, v10
    v_mov_b32 v7, s39
    s_mov_b64 exec, 1
    ds_write_b128 v11, v[4:7] offset:80
    ds_write_b32 v10, v7 offset:24
    s_lshl_b32 s48, s61, 8
    s_add_u32 s48, s48, s2
    s_lshl_b32 s48, s48, 6
    s_add_u32 s48, s48, 917504
    buffer_store_dwordx4 v[4:7], off, s[12:15], s48 sc1
    s_mov_b64 exec, -1
    v_add_u32 v14, 8192, v14
    v_add_u32 v8, 6144, v8
    s_add_u32 s35, s35, 1048576
    s_add_u32 s61, s61, 1
    s_cmp_lt_u32 s61, 3
    s_cbranch_scc1 L_prep
    s_mov_b32 s61, 0
    v_lshlrev_b32 v12, 2, v1
    v_add_u32 v13, 43264, v12
    v_lshlrev_b32 v8, 4, v1
    v_mov_b32 v31, 1
L_merge:
    s_nop 1
    s_lshl_b32 s48, s61, 2
    v_mov_b32 v3, s48
    v_lshlrev_b32 v11, 2, v3
    ds_read_b128 v[4:7], v11 offset:80
    s_lshl_b32 s62, s61, 8
    s_add_u32 s62, s62, s2
    s_lshl_b32 s62, s62, 10
    s_mov_b32 s60, 0x100000
L_wm:
    s_nop 1
    ds_read_b32 v10, v3 offset:64
    s_sub_u32 s60, s60, 1
    s_cbranch_scc1 L_exit1
    s_waitcnt lgkmcnt(0)
    v_readfirstlane_b32 s48, v10
    s_cmp_lt_u32 s48, 4
    s_cbranch_scc1 L_wm
    ds_read_b32 v16, v13 offset:0
    ds_read_b32 v17, v13 offset:768
    ds_read_b32 v18, v13 offset:1536
    ds_read_b32 v19, v13 offset:2304
    ds_read_b32 v20, v13 offset:256
    ds_read_b32 v21, v13 offset:1024
    ds_read_b32 v22, v13 offset:1792
    ds_read_b32 v23, v13 offset:2560
    ds_read_b32 v24, v13 offset:512
    ds_read_b32 v25, v13 offset:1280
    ds_read_b32 v26, v13 offset:2048
    ds_read_b32 v27, v13 offset:2816
    s_waitcnt lgkmcnt(8)
    v_add_f32 v16, v16, v17
    v_add_f32 v18, v18, v19
    v_sub_f32 v16, v16, v6
    v_add_f32 v28, v16, v18
    s_waitcnt lgkmcnt(4)
    v_add_f32 v20, v20, v21
    v_add_f32 v22, v22, v23
    v_sub_f32 v20, v20, v6
    v_add_f32 v29, v20, v22
    s_waitcnt lgkmcnt(0)
    v_add_f32 v24, v24, v25
    v_add_f32 v26, v26, v27
    v_sub_f32 v24, v24, v6
    v_add_f32 v30, v24, v26
    buffer_store_dwordx4 v[28:31], v8, s[12:15], s62 offen sc1
    v_add_u32 v13, 3072, v13
    s_add_u32 s61, s61, 1
    s_cmp_lt_u32 s61, 3
    s_cbranch_scc1 L_merge
    s_endpgm
.section .rodata,"a"
.p2align 6
.amdhsa_kernel standalone__kv_cache_quant_int4_int2_kv_with_per_channel_or_per_token_scales__decode_kernel
  .amdhsa_next_free_vgpr 136
  .amdhsa_next_free_sgpr 102
  .amdhsa_accum_offset 136
  .amdhsa_group_segment_fixed_size 0
  .amdhsa_kernarg_size 80
  .amdhsa_user_sgpr_count 2
  .amdhsa_user_sgpr_kernarg_segment_ptr 1
  .amdhsa_system_sgpr_workgroup_id_x 1
.end_amdhsa_kernel
```

```asm
; @launch kernel=standalone__kv_cache_quant_int4_int2_kv_with_per_channel_or_per_token_scales__decode_kernel grid=(256,1,1) block=(512,1,1) lds=52480
.amdgcn_target "amdgcn-amd-amdhsa--gfx950"
.text
.globl standalone__kv_cache_quant_int4_int2_kv_with_per_channel_or_per_token_scales__decode_kernel
.p2align 8
.type standalone__kv_cache_quant_int4_int2_kv_with_per_channel_or_per_token_scales__decode_kernel,@function
standalone__kv_cache_quant_int4_int2_kv_with_per_channel_or_per_token_scales__decode_kernel:
    s_cmp_ge_u32 s2, 256
    s_cbranch_scc1 L_exit1
    s_load_dwordx16 s[64:79], s[0:1], 0
    s_load_dwordx4 s[80:83], s[0:1], 64
    v_lshrrev_b32 v10, 6, v0
    v_and_b32 v11, 63, v0
    v_readfirstlane_b32 s28, v10
    s_lshr_b32 s3, s2, 3
    s_and_b32 s4, s2, 7
    s_lshr_b32 s32, s2, 6
    s_xor_b32 s32, s32, s4
    s_lshr_b32 s48, s32, 1
    s_and_b32 s32, s32, 1
    s_lshl_b32 s32, s32, 2
    s_or_b32 s48, s48, s32
    s_cmp_ge_u32 s28, 4
    s_cbranch_scc1 L_helper
    v_lshrrev_b32 v1, 4, v11
    v_and_b32 v52, 15, v11
    v_lshlrev_b32 v2, 4, v52
    v_lshlrev_b32 v3, 3, v52
    v_lshlrev_b32 v62, 7, v1
    v_and_b32 v63, 0x70, v0
    v_or_b32 v63, v63, v62
    v_mov_b32 v50, v63
    s_mov_b32 s45, 768
    s_mov_b32 s46, 384
    s_mov_b32 s47, 0xaaaaaaab
    v_mov_b32 v51, 0xc0000000
    s_lshl_b32 s44, s3, 6
    s_mov_b32 s5, s48
    s_mov_b32 s29, s28
    s_lshr_b32 s33, s29, 6
    s_lshl_b32 s33, s33, 11
    s_and_b32 s32, s29, 63
    s_add_u32 s32, s32, s33
    s_add_u32 s32, s32, s44
    s_bfe_u32 s33, s32, 0x20003
    s_and_b32 s34, s32, 4
    s_or_b32 s33, s33, s34
    s_xor_b32 s33, s33, s5
    s_lshl_b32 s50, s32, 5
    s_or_b32 s50, s50, s33
    s_lshl_b32 s50, s50, 4
    s_or_b32 s50, s50, 1
    v_xor_b32 v10, s50, v50
    v_mul_hi_u32 v10, v10, s47
    v_lshrrev_b32 v10, 1, v10
    v_and_b32 v11, 15, v10
    v_cmp_eq_u32 vcc, 5, v11
    v_mad_u32_u24 v48, v10, s45, v2
    v_add_u32 v11, 3840, v48
    v_cndmask_b32 v49, v51, v11, vcc
    v_lshrrev_b32 v10, 6, v10
    v_mad_u32_u24 v9, v10, s46, v3
    s_waitcnt lgkmcnt(0)
    s_mov_b32 s30, 0
    s_mov_b32 s8, s66
    s_and_b32 s9, s67, 0xffff
    s_mov_b32 s10, 805306368
    s_mov_b32 s11, 0x00020000
    buffer_load_dwordx4 v[64:67], v48, s[8:11], 0 offen offset:0 nt
    buffer_load_dwordx4 v[68:71], v48, s[8:11], 0 offen offset:256 nt
    buffer_load_dwordx4 v[72:75], v48, s[8:11], 0 offen offset:512 nt
    buffer_load_dwordx4 v[76:79], v48, s[8:11], 0 offen offset:768 nt
    buffer_load_dwordx4 v[80:83], v48, s[8:11], 0 offen offset:1024 nt
    buffer_load_dwordx4 v[84:87], v48, s[8:11], 0 offen offset:1280 nt
    s_mov_b32 s20, s64
    s_and_b32 s21, s65, 0xffff
    s_mov_b32 s22, 12288
    s_mov_b32 s23, 0x00020000
    s_lshl_b32 s31, s30, 5
    s_add_u32 s31, s31, s3
    s_mul_i32 s31, s31, 171
    s_lshr_b32 s31, s31, 9
    s_mul_i32 s31, s31, 384
    buffer_load_dwordx2 v[36:37], v3, s[20:23], s31 offen offset:0
    buffer_load_dwordx2 v[38:39], v3, s[20:23], s31 offen offset:128
    buffer_load_dwordx2 v[40:41], v3, s[20:23], s31 offen offset:256
    s_mov_b32 s16, s70
    s_and_b32 s17, s71, 0xffff
    s_mov_b32 s18, 6291456
    s_mov_b32 s19, 0x00020000
    buffer_load_dwordx2 v[42:43], v9, s[16:19], 0 offen offset:0
    buffer_load_dwordx2 v[44:45], v9, s[16:19], 0 offen offset:128
    buffer_load_dwordx2 v[46:47], v9, s[16:19], 0 offen offset:256
    buffer_load_dwordx4 v[88:91], v48, s[8:11], 0 offen offset:1536 nt
    buffer_load_dwordx4 v[92:95], v48, s[8:11], 0 offen offset:1792 nt
    buffer_load_dwordx4 v[96:99], v48, s[8:11], 0 offen offset:2048 nt
    buffer_load_dwordx4 v[100:103], v48, s[8:11], 0 offen offset:2304 nt
    buffer_load_dwordx4 v[104:107], v48, s[8:11], 0 offen offset:2560 nt
    buffer_load_dwordx4 v[108:111], v48, s[8:11], 0 offen offset:2816 nt
    buffer_load_dwordx4 v[112:115], v48, s[8:11], 0 offen offset:3072 nt
    buffer_load_dwordx4 v[116:119], v48, s[8:11], 0 offen offset:3328 nt
    buffer_load_dwordx4 v[120:123], v48, s[8:11], 0 offen offset:3584 nt
    buffer_load_dwordx4 v[124:127], v49, s[8:11], 0 offen offset:0 nt
    buffer_load_dwordx4 v[128:131], v49, s[8:11], 0 offen offset:256 nt
    buffer_load_dwordx4 v[132:135], v49, s[8:11], 0 offen offset:512 nt
    s_mov_b32 s12, s68
    s_and_b32 s13, s69, 0xffff
    s_mov_b32 s14, 805306368
    s_mov_b32 s15, 0x00020000
    v_lshlrev_b32 v11, 5, v1
    v_bfe_u32 v4, v0, 4, 3
    v_mul_u32_u24 v4, s45, v4
    v_lshl_add_u32 v4, v52, 1, v4
    s_lshr_b32 s32, s28, 1
    s_mul_i32 s32, s32, 24
    s_add_u32 s32, s32, 256
    v_add_u32 v4, s32, v4
    v_and_b32 v5, 7, v52
    v_lshl_add_u32 v5, v5, 2, v11
    v_add_u32 v5, 18688, v5
    v_lshlrev_b32 v8, 2, v1
    v_add_u32 v8, v2, v8
    s_mul_i32 s32, s28, 768
    s_add_u32 s32, s32, 43264
    v_add_u32 v8, s32, v8
    v_mov_b32 v53, 0
    v_mov_b32 v60, 0
    v_mov_b32 v61, 0
    s_mov_b32 s42, 0x01110111
    s_mov_b32 s43, 0x01110111
    s_mov_b32 s40, 0xea2bea0c
    s_mov_b32 s41, 0xea2b
    s_mov_b32 s64, 0x2020200
    s_mov_b32 s65, 0x202
    s_mov_b32 s66, 0x8080800
    s_mov_b32 s67, 0x808
    s_mov_b32 s68, 0x20202000
    s_mov_b32 s69, 0x2020
    s_mov_b32 s70, 0xc003c00c
    s_mov_b32 s71, 0xc003
    s_mov_b32 s59, 0
    s_mov_b32 s63, 0
    s_mov_b32 s7, 0
    s_mov_b32 s62, 144
    v_mov_b32 v12, 0
    v_mov_b32 v13, 0
    v_mov_b32 v14, 0
    v_mov_b32 v15, 0
    v_mov_b32 v16, 0
    v_mov_b32 v17, 0
    v_mov_b32 v18, 0
    v_mov_b32 v19, 0
    v_mov_b32 v20, 0
    v_mov_b32 v21, 0
    v_mov_b32 v22, 0
    v_mov_b32 v23, 0
    s_barrier
    s_waitcnt vmcnt(12)
    v_lshlrev_b32 v10, 16, v36
    v_lshlrev_b32 v24, 16, v42
    v_and_b32 v11, 0xffff0000, v36
    v_and_b32 v25, 0xffff0000, v42
    v_mul_f32 v24, v24, v10
    v_mul_f32 v25, v25, v11
    v_lshlrev_b32 v10, 16, v37
    v_lshlrev_b32 v26, 16, v43
    v_and_b32 v11, 0xffff0000, v37
    v_and_b32 v27, 0xffff0000, v43
    v_mul_f32 v26, v26, v10
    v_mul_f32 v27, v27, v11
    v_lshlrev_b32 v10, 16, v38
    v_lshlrev_b32 v28, 16, v44
    v_and_b32 v11, 0xffff0000, v38
    v_and_b32 v29, 0xffff0000, v44
    v_mul_f32 v28, v28, v10
    v_mul_f32 v29, v29, v11
    v_lshlrev_b32 v10, 16, v39
    v_lshlrev_b32 v30, 16, v45
    v_and_b32 v11, 0xffff0000, v39
    v_and_b32 v31, 0xffff0000, v45
    v_mul_f32 v30, v30, v10
    v_mul_f32 v31, v31, v11
    v_lshlrev_b32 v10, 16, v40
    v_lshlrev_b32 v32, 16, v46
    v_and_b32 v11, 0xffff0000, v40
    v_and_b32 v33, 0xffff0000, v46
    v_mul_f32 v32, v32, v10
    v_mul_f32 v33, v33, v11
    v_lshlrev_b32 v10, 16, v41
    v_lshlrev_b32 v34, 16, v47
    v_and_b32 v11, 0xffff0000, v41
    v_and_b32 v35, 0xffff0000, v47
    v_mul_f32 v34, v34, v10
    v_mul_f32 v35, v35, v11
    v_cvt_f32_i32 v64, v64
    v_cvt_f32_i32 v65, v65
    v_cvt_f32_i32 v66, v66
    v_cvt_f32_i32 v67, v67
    v_mul_f32 v54, v64, v24
    v_fmac_f32 v54, v65, v25
    v_fmac_f32 v54, v66, v26
    v_fmac_f32 v54, v67, v27
    v_cvt_f32_i32 v68, v68
    v_cvt_f32_i32 v69, v69
    v_cvt_f32_i32 v70, v70
    v_cvt_f32_i32 v71, v71
    v_fmac_f32 v54, v68, v28
    v_fmac_f32 v54, v69, v29
    v_fmac_f32 v54, v70, v30
    v_fmac_f32 v54, v71, v31
    v_cvt_f32_i32 v72, v72
    v_cvt_f32_i32 v73, v73
    v_cvt_f32_i32 v74, v74
    v_cvt_f32_i32 v75, v75
    v_fmac_f32 v54, v72, v32
    v_fmac_f32 v54, v73, v33
    v_fmac_f32 v54, v74, v34
    v_fmac_f32 v54, v75, v35
    v_cvt_f32_i32 v76, v76
    v_cvt_f32_i32 v77, v77
    v_add_f32_dpp v54, v54, v54 row_ror:8 row_mask:0xf bank_mask:0xf
    v_cvt_f32_i32 v78, v78
    v_cvt_f32_i32 v79, v79
    v_add_f32_dpp v54, v54, v54 row_ror:4 row_mask:0xf bank_mask:0xf
    v_mul_f32 v55, v76, v24
    v_fmac_f32 v55, v77, v25
    v_add_f32_dpp v54, v54, v54 row_ror:2 row_mask:0xf bank_mask:0xf
    v_fmac_f32 v55, v78, v26
    v_fmac_f32 v55, v79, v27
    v_add_f32_dpp v60, v54, v54 row_ror:1 row_mask:0xf bank_mask:0x1
    v_cvt_f32_i32 v80, v80
    v_cvt_f32_i32 v81, v81
    v_cvt_f32_i32 v82, v82
    v_cvt_f32_i32 v83, v83
    v_fmac_f32 v55, v80, v28
    v_fmac_f32 v55, v81, v29
    v_fmac_f32 v55, v82, v30
    v_fmac_f32 v55, v83, v31
    v_cvt_f32_i32 v84, v84
    v_cvt_f32_i32 v85, v85
    v_cvt_f32_i32 v86, v86
    v_cvt_f32_i32 v87, v87
    v_fmac_f32 v55, v84, v32
    v_fmac_f32 v55, v85, v33
    v_fmac_f32 v55, v86, v34
    v_fmac_f32 v55, v87, v35
    s_nop 1
    v_add_f32_dpp v55, v55, v55 row_ror:8 row_mask:0xf bank_mask:0xf
    s_nop 1
    v_add_f32_dpp v55, v55, v55 row_ror:4 row_mask:0xf bank_mask:0xf
    s_nop 1
    v_add_f32_dpp v55, v55, v55 row_ror:2 row_mask:0xf bank_mask:0xf
    s_nop 1
    v_add_f32_dpp v61, v55, v55 row_ror:1 row_mask:0xf bank_mask:0x1
    s_waitcnt vmcnt(6)
    s_add_u32 s29, s29, 4
    s_add_u32 s30, s30, 1
    s_lshr_b32 s33, s29, 6
    s_lshl_b32 s33, s33, 11
    s_and_b32 s32, s29, 63
    s_add_u32 s32, s32, s33
    s_add_u32 s32, s32, s44
    s_bfe_u32 s33, s32, 0x20003
    s_and_b32 s34, s32, 4
    s_or_b32 s33, s33, s34
    s_xor_b32 s33, s33, s5
    s_lshl_b32 s50, s32, 5
    s_or_b32 s50, s50, s33
    s_lshl_b32 s50, s50, 4
    s_or_b32 s50, s50, 1
    v_xor_b32 v10, s50, v50
    v_mul_hi_u32 v10, v10, s47
    v_lshrrev_b32 v10, 1, v10
    v_and_b32 v11, 15, v10
    v_cmp_eq_u32 vcc, 5, v11
    v_mad_u32_u24 v48, v10, s45, v2
    v_add_u32 v11, 3840, v48
    v_cndmask_b32 v49, v51, v11, vcc
    v_lshrrev_b32 v10, 6, v10
    v_mad_u32_u24 v9, v10, s46, v3
    buffer_load_dwordx2 v[42:43], v9, s[16:19], 0 offen offset:0
    buffer_load_dwordx2 v[44:45], v9, s[16:19], 0 offen offset:128
    buffer_load_dwordx2 v[46:47], v9, s[16:19], 0 offen offset:256
    v_cvt_f32_i32 v88, v88
    v_cvt_f32_i32 v89, v89
    v_cvt_f32_i32 v90, v90
    v_cvt_f32_i32 v91, v91
    v_mul_f32 v56, v88, v24
    v_fmac_f32 v56, v89, v25
    v_fmac_f32 v56, v90, v26
    v_fmac_f32 v56, v91, v27
    v_cvt_f32_i32 v92, v92
    v_cvt_f32_i32 v93, v93
    v_cvt_f32_i32 v94, v94
    v_cvt_f32_i32 v95, v95
    v_fmac_f32 v56, v92, v28
    v_fmac_f32 v56, v93, v29
    v_fmac_f32 v56, v94, v30
    v_fmac_f32 v56, v95, v31
    v_cvt_f32_i32 v96, v96
    v_cvt_f32_i32 v97, v97
    v_cvt_f32_i32 v98, v98
    v_cvt_f32_i32 v99, v99
    v_fmac_f32 v56, v96, v32
    v_fmac_f32 v56, v97, v33
    v_fmac_f32 v56, v98, v34
    v_fmac_f32 v56, v99, v35
    v_cvt_f32_i32 v100, v100
    v_cvt_f32_i32 v101, v101
    v_add_f32_dpp v56, v56, v56 row_ror:8 row_mask:0xf bank_mask:0xf
    v_cvt_f32_i32 v102, v102
    v_cvt_f32_i32 v103, v103
    v_add_f32_dpp v56, v56, v56 row_ror:4 row_mask:0xf bank_mask:0xf
    v_mul_f32 v57, v100, v24
    v_fmac_f32 v57, v101, v25
    v_add_f32_dpp v56, v56, v56 row_ror:2 row_mask:0xf bank_mask:0xf
    v_fmac_f32 v57, v102, v26
    v_fmac_f32 v57, v103, v27
    v_add_f32_dpp v60, v56, v56 row_ror:1 row_mask:0xf bank_mask:0x2
    v_cvt_f32_i32 v104, v104
    v_cvt_f32_i32 v105, v105
    v_cvt_f32_i32 v106, v106
    v_cvt_f32_i32 v107, v107
    v_fmac_f32 v57, v104, v28
    v_fmac_f32 v57, v105, v29
    v_fmac_f32 v57, v106, v30
    v_fmac_f32 v57, v107, v31
    v_cvt_f32_i32 v108, v108
    v_cvt_f32_i32 v109, v109
    v_cvt_f32_i32 v110, v110
    v_cvt_f32_i32 v111, v111
    v_fmac_f32 v57, v108, v32
    v_fmac_f32 v57, v109, v33
    v_fmac_f32 v57, v110, v34
    v_fmac_f32 v57, v111, v35
    s_nop 1
    v_add_f32_dpp v57, v57, v57 row_ror:8 row_mask:0xf bank_mask:0xf
    s_nop 1
    v_add_f32_dpp v57, v57, v57 row_ror:4 row_mask:0xf bank_mask:0xf
    s_nop 1
    v_add_f32_dpp v57, v57, v57 row_ror:2 row_mask:0xf bank_mask:0xf
    s_nop 1
    v_add_f32_dpp v61, v57, v57 row_ror:1 row_mask:0xf bank_mask:0x2
    s_waitcnt vmcnt(3)
    buffer_load_dwordx4 v[64:67], v48, s[8:11], 0 offen offset:0 nt
    buffer_load_dwordx4 v[68:71], v48, s[8:11], 0 offen offset:256 nt
    buffer_load_dwordx4 v[72:75], v48, s[8:11], 0 offen offset:512 nt
    buffer_load_dwordx4 v[76:79], v48, s[8:11], 0 offen offset:768 nt
    buffer_load_dwordx4 v[80:83], v48, s[8:11], 0 offen offset:1024 nt
    buffer_load_dwordx4 v[84:87], v48, s[8:11], 0 offen offset:1280 nt
    v_cvt_f32_i32 v112, v112
    v_cvt_f32_i32 v113, v113
    v_cvt_f32_i32 v114, v114
    v_cvt_f32_i32 v115, v115
    v_mul_f32 v58, v112, v24
    v_fmac_f32 v58, v113, v25
    v_fmac_f32 v58, v114, v26
    v_fmac_f32 v58, v115, v27
    v_cvt_f32_i32 v116, v116
    v_cvt_f32_i32 v117, v117
    v_cvt_f32_i32 v118, v118
    v_cvt_f32_i32 v119, v119
    v_fmac_f32 v58, v116, v28
    v_fmac_f32 v58, v117, v29
    v_fmac_f32 v58, v118, v30
    v_fmac_f32 v58, v119, v31
    v_cvt_f32_i32 v120, v120
    v_cvt_f32_i32 v121, v121
    v_cvt_f32_i32 v122, v122
    v_cvt_f32_i32 v123, v123
    v_fmac_f32 v58, v120, v32
    v_fmac_f32 v58, v121, v33
    v_fmac_f32 v58, v122, v34
    v_fmac_f32 v58, v123, v35
    v_cvt_f32_i32 v124, v124
    v_cvt_f32_i32 v125, v125
    v_add_f32_dpp v58, v58, v58 row_ror:8 row_mask:0xf bank_mask:0xf
    v_cvt_f32_i32 v126, v126
    v_cvt_f32_i32 v127, v127
    v_add_f32_dpp v58, v58, v58 row_ror:4 row_mask:0xf bank_mask:0xf
    v_mul_f32 v59, v124, v24
    v_fmac_f32 v59, v125, v25
    v_add_f32_dpp v58, v58, v58 row_ror:2 row_mask:0xf bank_mask:0xf
    v_fmac_f32 v59, v126, v26
    v_fmac_f32 v59, v127, v27
    v_add_f32_dpp v60, v58, v58 row_ror:1 row_mask:0xf bank_mask:0x4
    v_cvt_f32_i32 v128, v128
    v_cvt_f32_i32 v129, v129
    v_cvt_f32_i32 v130, v130
    v_cvt_f32_i32 v131, v131
    v_fmac_f32 v59, v128, v28
    v_fmac_f32 v59, v129, v29
    v_fmac_f32 v59, v130, v30
    v_fmac_f32 v59, v131, v31
    v_cvt_f32_i32 v132, v132
    v_cvt_f32_i32 v133, v133
    v_cvt_f32_i32 v134, v134
    v_cvt_f32_i32 v135, v135
    v_fmac_f32 v59, v132, v32
    v_fmac_f32 v59, v133, v33
    v_fmac_f32 v59, v134, v34
    v_fmac_f32 v59, v135, v35
    s_nop 1
    v_add_f32_dpp v59, v59, v59 row_ror:8 row_mask:0xf bank_mask:0xf
    s_nop 1
    v_add_f32_dpp v59, v59, v59 row_ror:4 row_mask:0xf bank_mask:0xf
    s_nop 1
    v_add_f32_dpp v59, v59, v59 row_ror:2 row_mask:0xf bank_mask:0xf
    s_nop 1
    v_add_f32_dpp v61, v59, v59 row_ror:1 row_mask:0xf bank_mask:0x4
    s_mov_b64 exec, s[42:43]
    ds_write_b64 v4, v[60:61]
    s_mov_b64 exec, -1
    v_add_u32 v4, 48, v4
    s_waitcnt vmcnt(6)
    v_lshlrev_b32 v10, 16, v36
    v_lshlrev_b32 v24, 16, v42
    v_and_b32 v11, 0xffff0000, v36
    v_and_b32 v25, 0xffff0000, v42
    v_mul_f32 v24, v24, v10
    v_mul_f32 v25, v25, v11
    v_lshlrev_b32 v10, 16, v37
    v_lshlrev_b32 v26, 16, v43
    v_and_b32 v11, 0xffff0000, v37
    v_and_b32 v27, 0xffff0000, v43
    v_mul_f32 v26, v26, v10
    v_mul_f32 v27, v27, v11
    v_lshlrev_b32 v10, 16, v38
    v_lshlrev_b32 v28, 16, v44
    v_and_b32 v11, 0xffff0000, v38
    v_and_b32 v29, 0xffff0000, v44
    v_mul_f32 v28, v28, v10
    v_mul_f32 v29, v29, v11
    v_lshlrev_b32 v10, 16, v39
    v_lshlrev_b32 v30, 16, v45
    v_and_b32 v11, 0xffff0000, v39
    v_and_b32 v31, 0xffff0000, v45
    v_mul_f32 v30, v30, v10
    v_mul_f32 v31, v31, v11
    v_lshlrev_b32 v10, 16, v40
    v_lshlrev_b32 v32, 16, v46
    v_and_b32 v11, 0xffff0000, v40
    v_and_b32 v33, 0xffff0000, v46
    v_mul_f32 v32, v32, v10
    v_mul_f32 v33, v33, v11
    v_lshlrev_b32 v10, 16, v41
    v_lshlrev_b32 v34, 16, v47
    v_and_b32 v11, 0xffff0000, v41
    v_and_b32 v35, 0xffff0000, v47
    v_mul_f32 v34, v34, v10
    v_mul_f32 v35, v35, v11
.p2align 6
L_kloop:
    s_nop 1
    s_waitcnt vmcnt(0)
    buffer_load_dwordx4 v[88:91], v48, s[8:11], 0 offen offset:1536 nt
    buffer_load_dwordx4 v[92:95], v48, s[8:11], 0 offen offset:1792 nt
    buffer_load_dwordx4 v[96:99], v48, s[8:11], 0 offen offset:2048 nt
    buffer_load_dwordx4 v[100:103], v48, s[8:11], 0 offen offset:2304 nt
    buffer_load_dwordx4 v[104:107], v48, s[8:11], 0 offen offset:2560 nt
    buffer_load_dwordx4 v[108:111], v48, s[8:11], 0 offen offset:2816 nt
    v_cvt_f32_i32 v64, v64
    v_cvt_f32_i32 v65, v65
    v_cvt_f32_i32 v66, v66
    v_cvt_f32_i32 v67, v67
    v_mul_f32 v54, v64, v24
    v_fmac_f32 v54, v65, v25
    v_fmac_f32 v54, v66, v26
    v_fmac_f32 v54, v67, v27
    v_cvt_f32_i32 v68, v68
    v_cvt_f32_i32 v69, v69
    v_cvt_f32_i32 v70, v70
    v_cvt_f32_i32 v71, v71
    v_fmac_f32 v54, v68, v28
    v_fmac_f32 v54, v69, v29
    v_fmac_f32 v54, v70, v30
    v_fmac_f32 v54, v71, v31
    v_cvt_f32_i32 v72, v72
    v_cvt_f32_i32 v73, v73
    v_cvt_f32_i32 v74, v74
    v_cvt_f32_i32 v75, v75
    v_fmac_f32 v54, v72, v32
    v_fmac_f32 v54, v73, v33
    v_fmac_f32 v54, v74, v34
    v_fmac_f32 v54, v75, v35
    v_cvt_f32_i32 v76, v76
    v_cvt_f32_i32 v77, v77
    v_add_f32_dpp v54, v54, v54 row_ror:8 row_mask:0xf bank_mask:0xf
    v_cvt_f32_i32 v78, v78
    v_cvt_f32_i32 v79, v79
    v_add_f32_dpp v54, v54, v54 row_ror:4 row_mask:0xf bank_mask:0xf
    v_mul_f32 v55, v76, v24
    v_fmac_f32 v55, v77, v25
    v_add_f32_dpp v54, v54, v54 row_ror:2 row_mask:0xf bank_mask:0xf
    v_fmac_f32 v55, v78, v26
    v_fmac_f32 v55, v79, v27
    v_add_f32_dpp v60, v54, v54 row_ror:1 row_mask:0xf bank_mask:0x1
    v_cvt_f32_i32 v80, v80
    v_cvt_f32_i32 v81, v81
    v_cvt_f32_i32 v82, v82
    v_cvt_f32_i32 v83, v83
    v_fmac_f32 v55, v80, v28
    v_fmac_f32 v55, v81, v29
    v_fmac_f32 v55, v82, v30
    v_fmac_f32 v55, v83, v31
    v_cvt_f32_i32 v84, v84
    v_cvt_f32_i32 v85, v85
    v_cvt_f32_i32 v86, v86
    v_cvt_f32_i32 v87, v87
    v_fmac_f32 v55, v84, v32
    v_fmac_f32 v55, v85, v33
    v_fmac_f32 v55, v86, v34
    v_fmac_f32 v55, v87, v35
    s_nop 1
    v_add_f32_dpp v55, v55, v55 row_ror:8 row_mask:0xf bank_mask:0xf
    s_nop 1
    v_add_f32_dpp v55, v55, v55 row_ror:4 row_mask:0xf bank_mask:0xf
    s_nop 1
    v_add_f32_dpp v55, v55, v55 row_ror:2 row_mask:0xf bank_mask:0xf
    s_nop 1
    v_add_f32_dpp v61, v55, v55 row_ror:1 row_mask:0xf bank_mask:0x1
    s_waitcnt vmcnt(0)
    buffer_load_dwordx4 v[112:115], v48, s[8:11], 0 offen offset:3072 nt
    buffer_load_dwordx4 v[116:119], v48, s[8:11], 0 offen offset:3328 nt
    buffer_load_dwordx4 v[120:123], v48, s[8:11], 0 offen offset:3584 nt
    buffer_load_dwordx4 v[124:127], v49, s[8:11], 0 offen offset:0 nt
    buffer_load_dwordx4 v[128:131], v49, s[8:11], 0 offen offset:256 nt
    buffer_load_dwordx4 v[132:135], v49, s[8:11], 0 offen offset:512 nt
    s_add_u32 s29, s29, 4
    s_add_u32 s30, s30, 1
    s_bitcmp1_b64 s[40:41], s30
    s_cbranch_scc1 L_evK
L_evretK:
    s_nop 1
    s_lshr_b32 s33, s29, 6
    s_lshl_b32 s33, s33, 11
    s_and_b32 s32, s29, 63
    s_add_u32 s32, s32, s33
    s_add_u32 s32, s32, s44
    s_bfe_u32 s33, s32, 0x20003
    s_and_b32 s34, s32, 4
    s_or_b32 s33, s33, s34
    s_xor_b32 s33, s33, s5
    s_lshl_b32 s50, s32, 5
    s_or_b32 s50, s50, s33
    s_lshl_b32 s50, s50, 4
    s_or_b32 s50, s50, 1
    v_xor_b32 v10, s50, v50
    v_mul_hi_u32 v10, v10, s47
    v_lshrrev_b32 v10, 1, v10
    v_and_b32 v11, 15, v10
    v_cmp_eq_u32 vcc, 5, v11
    v_mad_u32_u24 v48, v10, s45, v2
    v_add_u32 v11, 3840, v48
    v_cndmask_b32 v49, v51, v11, vcc
    v_lshrrev_b32 v10, 6, v10
    v_mad_u32_u24 v9, v10, s46, v3
    buffer_load_dwordx2 v[42:43], v9, s[16:19], 0 offen offset:0
    buffer_load_dwordx2 v[44:45], v9, s[16:19], 0 offen offset:128
    buffer_load_dwordx2 v[46:47], v9, s[16:19], 0 offen offset:256
    v_cvt_f32_i32 v88, v88
    v_cvt_f32_i32 v89, v89
    v_cvt_f32_i32 v90, v90
    v_cvt_f32_i32 v91, v91
    v_mul_f32 v56, v88, v24
    v_fmac_f32 v56, v89, v25
    v_fmac_f32 v56, v90, v26
    v_fmac_f32 v56, v91, v27
    v_cvt_f32_i32 v92, v92
    v_cvt_f32_i32 v93, v93
    v_cvt_f32_i32 v94, v94
    v_cvt_f32_i32 v95, v95
    v_fmac_f32 v56, v92, v28
    v_fmac_f32 v56, v93, v29
    v_fmac_f32 v56, v94, v30
    v_fmac_f32 v56, v95, v31
    v_cvt_f32_i32 v96, v96
    v_cvt_f32_i32 v97, v97
    v_cvt_f32_i32 v98, v98
    v_cvt_f32_i32 v99, v99
    v_fmac_f32 v56, v96, v32
    v_fmac_f32 v56, v97, v33
    v_fmac_f32 v56, v98, v34
    v_fmac_f32 v56, v99, v35
    v_cvt_f32_i32 v100, v100
    v_cvt_f32_i32 v101, v101
    v_add_f32_dpp v56, v56, v56 row_ror:8 row_mask:0xf bank_mask:0xf
    v_cvt_f32_i32 v102, v102
    v_cvt_f32_i32 v103, v103
    v_add_f32_dpp v56, v56, v56 row_ror:4 row_mask:0xf bank_mask:0xf
    v_mul_f32 v57, v100, v24
    v_fmac_f32 v57, v101, v25
    v_add_f32_dpp v56, v56, v56 row_ror:2 row_mask:0xf bank_mask:0xf
    v_fmac_f32 v57, v102, v26
    v_fmac_f32 v57, v103, v27
    v_add_f32_dpp v60, v56, v56 row_ror:1 row_mask:0xf bank_mask:0x2
    v_cvt_f32_i32 v104, v104
    v_cvt_f32_i32 v105, v105
    v_cvt_f32_i32 v106, v106
    v_cvt_f32_i32 v107, v107
    v_fmac_f32 v57, v104, v28
    v_fmac_f32 v57, v105, v29
    v_fmac_f32 v57, v106, v30
    v_fmac_f32 v57, v107, v31
    v_cvt_f32_i32 v108, v108
    v_cvt_f32_i32 v109, v109
    v_cvt_f32_i32 v110, v110
    v_cvt_f32_i32 v111, v111
    v_fmac_f32 v57, v108, v32
    v_fmac_f32 v57, v109, v33
    v_fmac_f32 v57, v110, v34
    v_fmac_f32 v57, v111, v35
    s_nop 1
    v_add_f32_dpp v57, v57, v57 row_ror:8 row_mask:0xf bank_mask:0xf
    s_nop 1
    v_add_f32_dpp v57, v57, v57 row_ror:4 row_mask:0xf bank_mask:0xf
    s_nop 1
    v_add_f32_dpp v57, v57, v57 row_ror:2 row_mask:0xf bank_mask:0xf
    s_nop 1
    v_add_f32_dpp v61, v57, v57 row_ror:1 row_mask:0xf bank_mask:0x2
    s_waitcnt vmcnt(3)
    buffer_load_dwordx4 v[64:67], v48, s[8:11], 0 offen offset:0 nt
    buffer_load_dwordx4 v[68:71], v48, s[8:11], 0 offen offset:256 nt
    buffer_load_dwordx4 v[72:75], v48, s[8:11], 0 offen offset:512 nt
    buffer_load_dwordx4 v[76:79], v48, s[8:11], 0 offen offset:768 nt
    buffer_load_dwordx4 v[80:83], v48, s[8:11], 0 offen offset:1024 nt
    buffer_load_dwordx4 v[84:87], v48, s[8:11], 0 offen offset:1280 nt
    v_cvt_f32_i32 v112, v112
    v_cvt_f32_i32 v113, v113
    v_cvt_f32_i32 v114, v114
    v_cvt_f32_i32 v115, v115
    v_mul_f32 v58, v112, v24
    v_fmac_f32 v58, v113, v25
    v_fmac_f32 v58, v114, v26
    v_fmac_f32 v58, v115, v27
    v_cvt_f32_i32 v116, v116
    v_cvt_f32_i32 v117, v117
    v_cvt_f32_i32 v118, v118
    v_cvt_f32_i32 v119, v119
    v_fmac_f32 v58, v116, v28
    v_fmac_f32 v58, v117, v29
    v_fmac_f32 v58, v118, v30
    v_fmac_f32 v58, v119, v31
    v_cvt_f32_i32 v120, v120
    v_cvt_f32_i32 v121, v121
    v_cvt_f32_i32 v122, v122
    v_cvt_f32_i32 v123, v123
    v_fmac_f32 v58, v120, v32
    v_fmac_f32 v58, v121, v33
    v_fmac_f32 v58, v122, v34
    v_fmac_f32 v58, v123, v35
    v_cvt_f32_i32 v124, v124
    v_cvt_f32_i32 v125, v125
    v_add_f32_dpp v58, v58, v58 row_ror:8 row_mask:0xf bank_mask:0xf
    v_cvt_f32_i32 v126, v126
    v_cvt_f32_i32 v127, v127
    v_add_f32_dpp v58, v58, v58 row_ror:4 row_mask:0xf bank_mask:0xf
    v_mul_f32 v59, v124, v24
    v_fmac_f32 v59, v125, v25
    v_add_f32_dpp v58, v58, v58 row_ror:2 row_mask:0xf bank_mask:0xf
    v_fmac_f32 v59, v126, v26
    v_fmac_f32 v59, v127, v27
    v_add_f32_dpp v60, v58, v58 row_ror:1 row_mask:0xf bank_mask:0x4
    v_cvt_f32_i32 v128, v128
    v_cvt_f32_i32 v129, v129
    v_cvt_f32_i32 v130, v130
    v_cvt_f32_i32 v131, v131
    v_fmac_f32 v59, v128, v28
    v_fmac_f32 v59, v129, v29
    v_fmac_f32 v59, v130, v30
    v_fmac_f32 v59, v131, v31
    v_cvt_f32_i32 v132, v132
    v_cvt_f32_i32 v133, v133
    v_cvt_f32_i32 v134, v134
    v_cvt_f32_i32 v135, v135
    v_fmac_f32 v59, v132, v32
    v_fmac_f32 v59, v133, v33
    v_fmac_f32 v59, v134, v34
    v_fmac_f32 v59, v135, v35
    s_nop 1
    v_add_f32_dpp v59, v59, v59 row_ror:8 row_mask:0xf bank_mask:0xf
    s_nop 1
    v_add_f32_dpp v59, v59, v59 row_ror:4 row_mask:0xf bank_mask:0xf
    s_nop 1
    v_add_f32_dpp v59, v59, v59 row_ror:2 row_mask:0xf bank_mask:0xf
    s_nop 1
    v_add_f32_dpp v61, v59, v59 row_ror:1 row_mask:0xf bank_mask:0x4
    s_mov_b64 exec, s[42:43]
    ds_write_b64 v4, v[60:61]
    s_mov_b64 exec, -1
    v_add_u32 v4, 48, v4
    s_waitcnt vmcnt(6)
    v_lshlrev_b32 v10, 16, v36
    v_lshlrev_b32 v24, 16, v42
    v_and_b32 v11, 0xffff0000, v36
    v_and_b32 v25, 0xffff0000, v42
    v_mul_f32 v24, v24, v10
    v_mul_f32 v25, v25, v11
    v_lshlrev_b32 v10, 16, v37
    v_lshlrev_b32 v26, 16, v43
    v_and_b32 v11, 0xffff0000, v37
    v_and_b32 v27, 0xffff0000, v43
    v_mul_f32 v26, v26, v10
    v_mul_f32 v27, v27, v11
    v_lshlrev_b32 v10, 16, v38
    v_lshlrev_b32 v28, 16, v44
    v_and_b32 v11, 0xffff0000, v38
    v_and_b32 v29, 0xffff0000, v44
    v_mul_f32 v28, v28, v10
    v_mul_f32 v29, v29, v11
    v_lshlrev_b32 v10, 16, v39
    v_lshlrev_b32 v30, 16, v45
    v_and_b32 v11, 0xffff0000, v39
    v_and_b32 v31, 0xffff0000, v45
    v_mul_f32 v30, v30, v10
    v_mul_f32 v31, v31, v11
    v_lshlrev_b32 v10, 16, v40
    v_lshlrev_b32 v32, 16, v46
    v_and_b32 v11, 0xffff0000, v40
    v_and_b32 v33, 0xffff0000, v46
    v_mul_f32 v32, v32, v10
    v_mul_f32 v33, v33, v11
    v_lshlrev_b32 v10, 16, v41
    v_lshlrev_b32 v34, 16, v47
    v_and_b32 v11, 0xffff0000, v41
    v_and_b32 v35, 0xffff0000, v47
    v_mul_f32 v34, v34, v10
    v_mul_f32 v35, v35, v11
L_kchk:
    s_nop 1
    s_cmp_lg_u32 s59, 0
    s_cbranch_scc1 L_kboost
L_kchk2:
    s_nop 1
    s_cmp_lg_u32 s30, 47
    s_cbranch_scc1 L_kloop
    s_waitcnt vmcnt(0)
    buffer_load_dwordx4 v[88:91], v48, s[8:11], 0 offen offset:1536 nt
    buffer_load_dwordx4 v[92:95], v48, s[8:11], 0 offen offset:1792 nt
    buffer_load_dwordx4 v[96:99], v48, s[8:11], 0 offen offset:2048 nt
    buffer_load_dwordx4 v[100:103], v48, s[8:11], 0 offen offset:2304 nt
    buffer_load_dwordx4 v[104:107], v48, s[8:11], 0 offen offset:2560 nt
    buffer_load_dwordx4 v[108:111], v48, s[8:11], 0 offen offset:2816 nt
    v_cvt_f32_i32 v64, v64
    v_cvt_f32_i32 v65, v65
    v_cvt_f32_i32 v66, v66
    v_cvt_f32_i32 v67, v67
    v_mul_f32 v54, v64, v24
    v_fmac_f32 v54, v65, v25
    v_fmac_f32 v54, v66, v26
    v_fmac_f32 v54, v67, v27
    v_cvt_f32_i32 v68, v68
    v_cvt_f32_i32 v69, v69
    v_cvt_f32_i32 v70, v70
    v_cvt_f32_i32 v71, v71
    v_fmac_f32 v54, v68, v28
    v_fmac_f32 v54, v69, v29
    v_fmac_f32 v54, v70, v30
    v_fmac_f32 v54, v71, v31
    v_cvt_f32_i32 v72, v72
    v_cvt_f32_i32 v73, v73
    v_cvt_f32_i32 v74, v74
    v_cvt_f32_i32 v75, v75
    v_fmac_f32 v54, v72, v32
    v_fmac_f32 v54, v73, v33
    v_fmac_f32 v54, v74, v34
    v_fmac_f32 v54, v75, v35
    v_cvt_f32_i32 v76, v76
    v_cvt_f32_i32 v77, v77
    v_add_f32_dpp v54, v54, v54 row_ror:8 row_mask:0xf bank_mask:0xf
    v_cvt_f32_i32 v78, v78
    v_cvt_f32_i32 v79, v79
    v_add_f32_dpp v54, v54, v54 row_ror:4 row_mask:0xf bank_mask:0xf
    v_mul_f32 v55, v76, v24
    v_fmac_f32 v55, v77, v25
    v_add_f32_dpp v54, v54, v54 row_ror:2 row_mask:0xf bank_mask:0xf
    v_fmac_f32 v55, v78, v26
    v_fmac_f32 v55, v79, v27
    v_add_f32_dpp v60, v54, v54 row_ror:1 row_mask:0xf bank_mask:0x1
    v_cvt_f32_i32 v80, v80
    v_cvt_f32_i32 v81, v81
    v_cvt_f32_i32 v82, v82
    v_cvt_f32_i32 v83, v83
    v_fmac_f32 v55, v80, v28
    v_fmac_f32 v55, v81, v29
    v_fmac_f32 v55, v82, v30
    v_fmac_f32 v55, v83, v31
    v_cvt_f32_i32 v84, v84
    v_cvt_f32_i32 v85, v85
    v_cvt_f32_i32 v86, v86
    v_cvt_f32_i32 v87, v87
    v_fmac_f32 v55, v84, v32
    v_fmac_f32 v55, v85, v33
    v_fmac_f32 v55, v86, v34
    v_fmac_f32 v55, v87, v35
    s_nop 1
    v_add_f32_dpp v55, v55, v55 row_ror:8 row_mask:0xf bank_mask:0xf
    s_nop 1
    v_add_f32_dpp v55, v55, v55 row_ror:4 row_mask:0xf bank_mask:0xf
    s_nop 1
    v_add_f32_dpp v55, v55, v55 row_ror:2 row_mask:0xf bank_mask:0xf
    s_nop 1
    v_add_f32_dpp v61, v55, v55 row_ror:1 row_mask:0xf bank_mask:0x1
    s_waitcnt vmcnt(0)
    buffer_load_dwordx4 v[112:115], v48, s[8:11], 0 offen offset:3072 nt
    buffer_load_dwordx4 v[116:119], v48, s[8:11], 0 offen offset:3328 nt
    buffer_load_dwordx4 v[120:123], v48, s[8:11], 0 offen offset:3584 nt
    buffer_load_dwordx4 v[124:127], v49, s[8:11], 0 offen offset:0 nt
    buffer_load_dwordx4 v[128:131], v49, s[8:11], 0 offen offset:256 nt
    buffer_load_dwordx4 v[132:135], v49, s[8:11], 0 offen offset:512 nt
    s_mov_b32 s29, s28
    s_mov_b32 s30, 0
    s_memrealtime s[36:37]
    s_mov_b32 s6, 0x100000
L_wgtv:
    s_nop 1
    ds_read_b32 v10, v53 offset:216
    s_sub_u32 s6, s6, 1
    s_cbranch_scc1 L_exit1
    s_waitcnt lgkmcnt(0)
    v_readfirstlane_b32 s32, v10
    s_cmp_eq_u32 s32, 0
    s_cbranch_scc1 L_wgtv
    s_and_b32 s32, s32, 0xffff
    s_cbranch_scc0 L_gxtv
    s_add_u32 s32, s32, s36
L_gltv:
    s_nop 1
    s_memrealtime s[36:37]
    s_waitcnt lgkmcnt(0)
    s_sub_u32 s36, s36, s32
    s_cmp_lt_i32 s36, 0
    s_cbranch_scc1 L_gltv
L_gxtv:
    s_nop 1
    s_lshr_b32 s33, s30, 4
    s_lshl_b32 s34, s33, 2
    v_mov_b32 v11, s34
    s_mov_b32 s6, 0x100000
L_wtv:
    s_nop 1
    ds_read_b32 v10, v11 offset:24
    s_sub_u32 s6, s6, 1
    s_cbranch_scc1 L_exit1
    s_waitcnt lgkmcnt(0)
    v_readfirstlane_b32 s32, v10
    s_cmp_eq_u32 s32, 0
    s_cbranch_scc1 L_wtv
    s_and_b32 s5, s32, 7
    s_xor_b32 s5, s5, s48
    s_bitcmp1_b32 s32, 3
    s_cselect_b64 vcc, -1, 0
    v_cndmask_b32 v50, v62, v63, vcc
    s_mov_b32 s49, 45
    s_mov_b32 s40, 0x2a2b2a2a
    s_mov_b32 s41, 0x152b
    s_mov_b32 s64, 0x2020202
    s_mov_b32 s65, 0x102
    s_mov_b32 s66, 0x8080808
    s_mov_b32 s67, 0x408
    s_mov_b32 s68, 0x20202020
    s_mov_b32 s69, 0x1020
    s_mov_b32 s70, 0x10000
    s_mov_b32 s71, 0x1
    s_lshr_b32 s33, s29, 6
    s_lshl_b32 s33, s33, 11
    s_and_b32 s32, s29, 63
    s_add_u32 s32, s32, s33
    s_add_u32 s32, s32, s44
    s_bfe_u32 s33, s32, 0x20003
    s_and_b32 s34, s32, 4
    s_or_b32 s33, s33, s34
    s_xor_b32 s33, s33, s5
    s_lshl_b32 s50, s32, 5
    s_or_b32 s50, s50, s33
    s_lshl_b32 s50, s50, 4
    s_or_b32 s50, s50, 1
    s_lshl_b32 s53, s29, 7
    v_xor_b32 v10, s50, v50
    v_mul_hi_u32 v10, v10, s47
    v_lshrrev_b32 v10, 1, v10
    v_and_b32 v11, 15, v10
    v_cmp_eq_u32 vcc, 5, v11
    v_mad_u32_u24 v48, v10, s45, v2
    v_add_u32 v11, 3840, v48
    v_cndmask_b32 v49, v51, v11, vcc
    v_add_u32 v10, s53, v5
    ds_read_b32 v7, v10
    v_cvt_f32_i32 v88, v88
    v_cvt_f32_i32 v89, v89
    v_cvt_f32_i32 v90, v90
    v_cvt_f32_i32 v91, v91
    v_mul_f32 v56, v88, v24
    v_fmac_f32 v56, v89, v25
    v_fmac_f32 v56, v90, v26
    v_fmac_f32 v56, v91, v27
    v_cvt_f32_i32 v92, v92
    v_cvt_f32_i32 v93, v93
    v_cvt_f32_i32 v94, v94
    v_cvt_f32_i32 v95, v95
    v_fmac_f32 v56, v92, v28
    v_fmac_f32 v56, v93, v29
    v_fmac_f32 v56, v94, v30
    v_fmac_f32 v56, v95, v31
    v_cvt_f32_i32 v96, v96
    v_cvt_f32_i32 v97, v97
    v_cvt_f32_i32 v98, v98
    v_cvt_f32_i32 v99, v99
    v_fmac_f32 v56, v96, v32
    v_fmac_f32 v56, v97, v33
    v_fmac_f32 v56, v98, v34
    v_fmac_f32 v56, v99, v35
    v_cvt_f32_i32 v100, v100
    v_cvt_f32_i32 v101, v101
    v_add_f32_dpp v56, v56, v56 row_ror:8 row_mask:0xf bank_mask:0xf
    v_cvt_f32_i32 v102, v102
    v_cvt_f32_i32 v103, v103
    v_add_f32_dpp v56, v56, v56 row_ror:4 row_mask:0xf bank_mask:0xf
    v_mul_f32 v57, v100, v24
    v_fmac_f32 v57, v101, v25
    v_add_f32_dpp v56, v56, v56 row_ror:2 row_mask:0xf bank_mask:0xf
    v_fmac_f32 v57, v102, v26
    v_fmac_f32 v57, v103, v27
    v_add_f32_dpp v60, v56, v56 row_ror:1 row_mask:0xf bank_mask:0x2
    v_cvt_f32_i32 v104, v104
    v_cvt_f32_i32 v105, v105
    v_cvt_f32_i32 v106, v106
    v_cvt_f32_i32 v107, v107
    v_fmac_f32 v57, v104, v28
    v_fmac_f32 v57, v105, v29
    v_fmac_f32 v57, v106, v30
    v_fmac_f32 v57, v107, v31
    v_cvt_f32_i32 v108, v108
    v_cvt_f32_i32 v109, v109
    v_cvt_f32_i32 v110, v110
    v_cvt_f32_i32 v111, v111
    v_fmac_f32 v57, v108, v32
    v_fmac_f32 v57, v109, v33
    v_fmac_f32 v57, v110, v34
    v_fmac_f32 v57, v111, v35
    s_nop 1
    v_add_f32_dpp v57, v57, v57 row_ror:8 row_mask:0xf bank_mask:0xf
    s_nop 1
    v_add_f32_dpp v57, v57, v57 row_ror:4 row_mask:0xf bank_mask:0xf
    s_nop 1
    v_add_f32_dpp v57, v57, v57 row_ror:2 row_mask:0xf bank_mask:0xf
    s_nop 1
    v_add_f32_dpp v61, v57, v57 row_ror:1 row_mask:0xf bank_mask:0x2
    s_waitcnt vmcnt(0)
    buffer_load_dwordx4 v[64:67], v48, s[12:15], 0 offen offset:0 nt
    buffer_load_dwordx4 v[68:71], v48, s[12:15], 0 offen offset:256 nt
    buffer_load_dwordx4 v[72:75], v48, s[12:15], 0 offen offset:512 nt
    buffer_load_dwordx4 v[76:79], v48, s[12:15], 0 offen offset:768 nt
    buffer_load_dwordx4 v[80:83], v48, s[12:15], 0 offen offset:1024 nt
    buffer_load_dwordx4 v[84:87], v48, s[12:15], 0 offen offset:1280 nt
    v_cvt_f32_i32 v112, v112
    v_cvt_f32_i32 v113, v113
    v_cvt_f32_i32 v114, v114
    v_cvt_f32_i32 v115, v115
    v_mul_f32 v58, v112, v24
    v_fmac_f32 v58, v113, v25
    v_fmac_f32 v58, v114, v26
    v_fmac_f32 v58, v115, v27
    v_cvt_f32_i32 v116, v116
    v_cvt_f32_i32 v117, v117
    v_cvt_f32_i32 v118, v118
    v_cvt_f32_i32 v119, v119
    v_fmac_f32 v58, v116, v28
    v_fmac_f32 v58, v117, v29
    v_fmac_f32 v58, v118, v30
    v_fmac_f32 v58, v119, v31
    v_cvt_f32_i32 v120, v120
    v_cvt_f32_i32 v121, v121
    v_cvt_f32_i32 v122, v122
    v_cvt_f32_i32 v123, v123
    v_fmac_f32 v58, v120, v32
    v_fmac_f32 v58, v121, v33
    v_fmac_f32 v58, v122, v34
    v_fmac_f32 v58, v123, v35
    v_cvt_f32_i32 v124, v124
    v_cvt_f32_i32 v125, v125
    v_add_f32_dpp v58, v58, v58 row_ror:8 row_mask:0xf bank_mask:0xf
    v_cvt_f32_i32 v126, v126
    v_cvt_f32_i32 v127, v127
    v_add_f32_dpp v58, v58, v58 row_ror:4 row_mask:0xf bank_mask:0xf
    v_mul_f32 v59, v124, v24
    v_fmac_f32 v59, v125, v25
    v_add_f32_dpp v58, v58, v58 row_ror:2 row_mask:0xf bank_mask:0xf
    v_fmac_f32 v59, v126, v26
    v_fmac_f32 v59, v127, v27
    v_add_f32_dpp v60, v58, v58 row_ror:1 row_mask:0xf bank_mask:0x4
    v_cvt_f32_i32 v128, v128
    v_cvt_f32_i32 v129, v129
    v_cvt_f32_i32 v130, v130
    v_cvt_f32_i32 v131, v131
    v_fmac_f32 v59, v128, v28
    v_fmac_f32 v59, v129, v29
    v_fmac_f32 v59, v130, v30
    v_fmac_f32 v59, v131, v31
    v_cvt_f32_i32 v132, v132
    v_cvt_f32_i32 v133, v133
    v_cvt_f32_i32 v134, v134
    v_cvt_f32_i32 v135, v135
    v_fmac_f32 v59, v132, v32
    v_fmac_f32 v59, v133, v33
    v_fmac_f32 v59, v134, v34
    v_fmac_f32 v59, v135, v35
    s_nop 1
    v_add_f32_dpp v59, v59, v59 row_ror:8 row_mask:0xf bank_mask:0xf
    s_nop 1
    v_add_f32_dpp v59, v59, v59 row_ror:4 row_mask:0xf bank_mask:0xf
    s_nop 1
    v_add_f32_dpp v59, v59, v59 row_ror:2 row_mask:0xf bank_mask:0xf
    s_nop 1
    v_add_f32_dpp v61, v59, v59 row_ror:1 row_mask:0xf bank_mask:0x4
    s_mov_b64 exec, s[42:43]
    ds_write_b64 v4, v[60:61]
    s_mov_b64 exec, -1
    s_waitcnt lgkmcnt(0)
    v_mov_b32 v6, v7
    v_mov_b32 v11, 1
    s_mov_b64 exec, 1
    ds_add_u32 v53, v11 offset:48
    s_mov_b64 exec, -1
.p2align 6
L_vloop:
    s_nop 1
    s_waitcnt vmcnt(0)
    buffer_load_dwordx4 v[88:91], v48, s[12:15], 0 offen offset:1536 nt
    buffer_load_dwordx4 v[92:95], v48, s[12:15], 0 offen offset:1792 nt
    buffer_load_dwordx4 v[96:99], v48, s[12:15], 0 offen offset:2048 nt
    buffer_load_dwordx4 v[100:103], v48, s[12:15], 0 offen offset:2304 nt
    buffer_load_dwordx4 v[104:107], v48, s[12:15], 0 offen offset:2560 nt
    buffer_load_dwordx4 v[108:111], v48, s[12:15], 0 offen offset:2816 nt
    v_cvt_f32_i32 v64, v64
    v_cvt_f32_i32 v65, v65
    v_cvt_f32_i32 v66, v66
    v_cvt_f32_i32 v67, v67
    v_fmac_f32_dpp v12, v6, v64 row_newbcast:0 row_mask:0xf bank_mask:0xf
    v_fmac_f32_dpp v13, v6, v65 row_newbcast:0 row_mask:0xf bank_mask:0xf
    v_fmac_f32_dpp v14, v6, v66 row_newbcast:0 row_mask:0xf bank_mask:0xf
    v_fmac_f32_dpp v15, v6, v67 row_newbcast:0 row_mask:0xf bank_mask:0xf
    v_cvt_f32_i32 v68, v68
    v_cvt_f32_i32 v69, v69
    v_cvt_f32_i32 v70, v70
    v_cvt_f32_i32 v71, v71
    v_fmac_f32_dpp v16, v6, v68 row_newbcast:0 row_mask:0xf bank_mask:0xf
    v_fmac_f32_dpp v17, v6, v69 row_newbcast:0 row_mask:0xf bank_mask:0xf
    v_fmac_f32_dpp v18, v6, v70 row_newbcast:0 row_mask:0xf bank_mask:0xf
    v_fmac_f32_dpp v19, v6, v71 row_newbcast:0 row_mask:0xf bank_mask:0xf
    v_cvt_f32_i32 v72, v72
    v_cvt_f32_i32 v73, v73
    v_cvt_f32_i32 v74, v74
    v_cvt_f32_i32 v75, v75
    v_fmac_f32_dpp v20, v6, v72 row_newbcast:0 row_mask:0xf bank_mask:0xf
    v_fmac_f32_dpp v21, v6, v73 row_newbcast:0 row_mask:0xf bank_mask:0xf
    v_fmac_f32_dpp v22, v6, v74 row_newbcast:0 row_mask:0xf bank_mask:0xf
    v_fmac_f32_dpp v23, v6, v75 row_newbcast:0 row_mask:0xf bank_mask:0xf
    v_cvt_f32_i32 v76, v76
    v_cvt_f32_i32 v77, v77
    v_cvt_f32_i32 v78, v78
    v_cvt_f32_i32 v79, v79
    v_fmac_f32_dpp v12, v6, v76 row_newbcast:1 row_mask:0xf bank_mask:0xf
    v_fmac_f32_dpp v13, v6, v77 row_newbcast:1 row_mask:0xf bank_mask:0xf
    v_fmac_f32_dpp v14, v6, v78 row_newbcast:1 row_mask:0xf bank_mask:0xf
    v_fmac_f32_dpp v15, v6, v79 row_newbcast:1 row_mask:0xf bank_mask:0xf
    v_cvt_f32_i32 v80, v80
    v_cvt_f32_i32 v81, v81
    v_cvt_f32_i32 v82, v82
    v_cvt_f32_i32 v83, v83
    v_fmac_f32_dpp v16, v6, v80 row_newbcast:1 row_mask:0xf bank_mask:0xf
    v_fmac_f32_dpp v17, v6, v81 row_newbcast:1 row_mask:0xf bank_mask:0xf
    v_fmac_f32_dpp v18, v6, v82 row_newbcast:1 row_mask:0xf bank_mask:0xf
    v_fmac_f32_dpp v19, v6, v83 row_newbcast:1 row_mask:0xf bank_mask:0xf
    v_cvt_f32_i32 v84, v84
    v_cvt_f32_i32 v85, v85
    v_cvt_f32_i32 v86, v86
    v_cvt_f32_i32 v87, v87
    v_fmac_f32_dpp v20, v6, v84 row_newbcast:1 row_mask:0xf bank_mask:0xf
    v_fmac_f32_dpp v21, v6, v85 row_newbcast:1 row_mask:0xf bank_mask:0xf
    v_fmac_f32_dpp v22, v6, v86 row_newbcast:1 row_mask:0xf bank_mask:0xf
    v_fmac_f32_dpp v23, v6, v87 row_newbcast:1 row_mask:0xf bank_mask:0xf
    s_waitcnt vmcnt(0)
    buffer_load_dwordx4 v[112:115], v48, s[12:15], 0 offen offset:3072 nt
    buffer_load_dwordx4 v[116:119], v48, s[12:15], 0 offen offset:3328 nt
    buffer_load_dwordx4 v[120:123], v48, s[12:15], 0 offen offset:3584 nt
    buffer_load_dwordx4 v[124:127], v49, s[12:15], 0 offen offset:0 nt
    buffer_load_dwordx4 v[128:131], v49, s[12:15], 0 offen offset:256 nt
    buffer_load_dwordx4 v[132:135], v49, s[12:15], 0 offen offset:512 nt
    s_add_u32 s29, s29, 4
    s_add_u32 s30, s30, 1
    s_bitcmp1_b64 s[40:41], s30
    s_cbranch_scc1 L_evV
L_evretV:
    s_nop 1
    s_lshr_b32 s33, s29, 6
    s_lshl_b32 s33, s33, 11
    s_and_b32 s32, s29, 63
    s_add_u32 s32, s32, s33
    s_add_u32 s32, s32, s44
    s_bfe_u32 s33, s32, 0x20003
    s_and_b32 s34, s32, 4
    s_or_b32 s33, s33, s34
    s_xor_b32 s33, s33, s5
    s_lshl_b32 s50, s32, 5
    s_or_b32 s50, s50, s33
    s_lshl_b32 s50, s50, 4
    s_or_b32 s50, s50, 1
    s_lshl_b32 s53, s29, 7
    v_xor_b32 v10, s50, v50
    v_mul_hi_u32 v10, v10, s47
    v_lshrrev_b32 v10, 1, v10
    v_and_b32 v11, 15, v10
    v_cmp_eq_u32 vcc, 5, v11
    v_mad_u32_u24 v48, v10, s45, v2
    v_add_u32 v11, 3840, v48
    v_cndmask_b32 v49, v51, v11, vcc
    v_add_u32 v10, s53, v5
    ds_read_b32 v7, v10
    s_cmp_eq_u32 s30, 48
    s_cbranch_scc1 L_el0
L_el0r:
    v_cvt_f32_i32 v88, v88
    v_cvt_f32_i32 v89, v89
    v_cvt_f32_i32 v90, v90
    v_cvt_f32_i32 v91, v91
    v_fmac_f32_dpp v12, v6, v88 row_newbcast:2 row_mask:0xf bank_mask:0xf
    v_fmac_f32_dpp v13, v6, v89 row_newbcast:2 row_mask:0xf bank_mask:0xf
    v_fmac_f32_dpp v14, v6, v90 row_newbcast:2 row_mask:0xf bank_mask:0xf
    v_fmac_f32_dpp v15, v6, v91 row_newbcast:2 row_mask:0xf bank_mask:0xf
    v_cvt_f32_i32 v92, v92
    v_cvt_f32_i32 v93, v93
    v_cvt_f32_i32 v94, v94
    v_cvt_f32_i32 v95, v95
    v_fmac_f32_dpp v16, v6, v92 row_newbcast:2 row_mask:0xf bank_mask:0xf
    v_fmac_f32_dpp v17, v6, v93 row_newbcast:2 row_mask:0xf bank_mask:0xf
    v_fmac_f32_dpp v18, v6, v94 row_newbcast:2 row_mask:0xf bank_mask:0xf
    v_fmac_f32_dpp v19, v6, v95 row_newbcast:2 row_mask:0xf bank_mask:0xf
    v_cvt_f32_i32 v96, v96
    v_cvt_f32_i32 v97, v97
    v_cvt_f32_i32 v98, v98
    v_cvt_f32_i32 v99, v99
    v_fmac_f32_dpp v20, v6, v96 row_newbcast:2 row_mask:0xf bank_mask:0xf
    v_fmac_f32_dpp v21, v6, v97 row_newbcast:2 row_mask:0xf bank_mask:0xf
    v_fmac_f32_dpp v22, v6, v98 row_newbcast:2 row_mask:0xf bank_mask:0xf
    v_fmac_f32_dpp v23, v6, v99 row_newbcast:2 row_mask:0xf bank_mask:0xf
    v_cvt_f32_i32 v100, v100
    v_cvt_f32_i32 v101, v101
    v_cvt_f32_i32 v102, v102
    v_cvt_f32_i32 v103, v103
    v_fmac_f32_dpp v12, v6, v100 row_newbcast:3 row_mask:0xf bank_mask:0xf
    v_fmac_f32_dpp v13, v6, v101 row_newbcast:3 row_mask:0xf bank_mask:0xf
    v_fmac_f32_dpp v14, v6, v102 row_newbcast:3 row_mask:0xf bank_mask:0xf
    v_fmac_f32_dpp v15, v6, v103 row_newbcast:3 row_mask:0xf bank_mask:0xf
    v_cvt_f32_i32 v104, v104
    v_cvt_f32_i32 v105, v105
    v_cvt_f32_i32 v106, v106
    v_cvt_f32_i32 v107, v107
    v_fmac_f32_dpp v16, v6, v104 row_newbcast:3 row_mask:0xf bank_mask:0xf
    v_fmac_f32_dpp v17, v6, v105 row_newbcast:3 row_mask:0xf bank_mask:0xf
    v_fmac_f32_dpp v18, v6, v106 row_newbcast:3 row_mask:0xf bank_mask:0xf
    v_fmac_f32_dpp v19, v6, v107 row_newbcast:3 row_mask:0xf bank_mask:0xf
    v_cvt_f32_i32 v108, v108
    v_cvt_f32_i32 v109, v109
    v_cvt_f32_i32 v110, v110
    v_cvt_f32_i32 v111, v111
    v_fmac_f32_dpp v20, v6, v108 row_newbcast:3 row_mask:0xf bank_mask:0xf
    v_fmac_f32_dpp v21, v6, v109 row_newbcast:3 row_mask:0xf bank_mask:0xf
    v_fmac_f32_dpp v22, v6, v110 row_newbcast:3 row_mask:0xf bank_mask:0xf
    v_fmac_f32_dpp v23, v6, v111 row_newbcast:3 row_mask:0xf bank_mask:0xf
    s_waitcnt vmcnt(0)
    buffer_load_dwordx4 v[64:67], v48, s[12:15], 0 offen offset:0 nt
    buffer_load_dwordx4 v[68:71], v48, s[12:15], 0 offen offset:256 nt
    buffer_load_dwordx4 v[72:75], v48, s[12:15], 0 offen offset:512 nt
    buffer_load_dwordx4 v[76:79], v48, s[12:15], 0 offen offset:768 nt
    buffer_load_dwordx4 v[80:83], v48, s[12:15], 0 offen offset:1024 nt
    buffer_load_dwordx4 v[84:87], v48, s[12:15], 0 offen offset:1280 nt
    v_cvt_f32_i32 v112, v112
    v_cvt_f32_i32 v113, v113
    v_cvt_f32_i32 v114, v114
    v_cvt_f32_i32 v115, v115
    v_fmac_f32_dpp v12, v6, v112 row_newbcast:4 row_mask:0xf bank_mask:0xf
    v_fmac_f32_dpp v13, v6, v113 row_newbcast:4 row_mask:0xf bank_mask:0xf
    v_fmac_f32_dpp v14, v6, v114 row_newbcast:4 row_mask:0xf bank_mask:0xf
    v_fmac_f32_dpp v15, v6, v115 row_newbcast:4 row_mask:0xf bank_mask:0xf
    v_cvt_f32_i32 v116, v116
    v_cvt_f32_i32 v117, v117
    v_cvt_f32_i32 v118, v118
    v_cvt_f32_i32 v119, v119
    v_fmac_f32_dpp v16, v6, v116 row_newbcast:4 row_mask:0xf bank_mask:0xf
    v_fmac_f32_dpp v17, v6, v117 row_newbcast:4 row_mask:0xf bank_mask:0xf
    v_fmac_f32_dpp v18, v6, v118 row_newbcast:4 row_mask:0xf bank_mask:0xf
    v_fmac_f32_dpp v19, v6, v119 row_newbcast:4 row_mask:0xf bank_mask:0xf
    v_cvt_f32_i32 v120, v120
    v_cvt_f32_i32 v121, v121
    v_cvt_f32_i32 v122, v122
    v_cvt_f32_i32 v123, v123
    v_fmac_f32_dpp v20, v6, v120 row_newbcast:4 row_mask:0xf bank_mask:0xf
    v_fmac_f32_dpp v21, v6, v121 row_newbcast:4 row_mask:0xf bank_mask:0xf
    v_fmac_f32_dpp v22, v6, v122 row_newbcast:4 row_mask:0xf bank_mask:0xf
    v_fmac_f32_dpp v23, v6, v123 row_newbcast:4 row_mask:0xf bank_mask:0xf
    v_cvt_f32_i32 v124, v124
    v_cvt_f32_i32 v125, v125
    v_cvt_f32_i32 v126, v126
    v_cvt_f32_i32 v127, v127
    v_fmac_f32_dpp v12, v6, v124 row_newbcast:5 row_mask:0xf bank_mask:0xf
    v_fmac_f32_dpp v13, v6, v125 row_newbcast:5 row_mask:0xf bank_mask:0xf
    v_fmac_f32_dpp v14, v6, v126 row_newbcast:5 row_mask:0xf bank_mask:0xf
    v_fmac_f32_dpp v15, v6, v127 row_newbcast:5 row_mask:0xf bank_mask:0xf
    v_cvt_f32_i32 v128, v128
    v_cvt_f32_i32 v129, v129
    v_cvt_f32_i32 v130, v130
    v_cvt_f32_i32 v131, v131
    v_fmac_f32_dpp v16, v6, v128 row_newbcast:5 row_mask:0xf bank_mask:0xf
    v_fmac_f32_dpp v17, v6, v129 row_newbcast:5 row_mask:0xf bank_mask:0xf
    v_fmac_f32_dpp v18, v6, v130 row_newbcast:5 row_mask:0xf bank_mask:0xf
    v_fmac_f32_dpp v19, v6, v131 row_newbcast:5 row_mask:0xf bank_mask:0xf
    v_cvt_f32_i32 v132, v132
    v_cvt_f32_i32 v133, v133
    v_cvt_f32_i32 v134, v134
    v_cvt_f32_i32 v135, v135
    v_fmac_f32_dpp v20, v6, v132 row_newbcast:5 row_mask:0xf bank_mask:0xf
    v_fmac_f32_dpp v21, v6, v133 row_newbcast:5 row_mask:0xf bank_mask:0xf
    v_fmac_f32_dpp v22, v6, v134 row_newbcast:5 row_mask:0xf bank_mask:0xf
    v_fmac_f32_dpp v23, v6, v135 row_newbcast:5 row_mask:0xf bank_mask:0xf
    s_waitcnt lgkmcnt(0)
    v_mov_b32 v6, v7
L_vchk:
    s_nop 1
    s_cmp_eq_u32 s30, s49
    s_cbranch_scc1 L_deep
    s_cmp_lg_u32 s59, 0
    s_cbranch_scc1 L_vboost
    s_and_b32 s32, s30, 15
    s_cbranch_scc1 L_vloop
L_vend:
    s_nop 1
    v_permlane32_swap_b32 v12, v14
    v_permlane32_swap_b32 v13, v15
    v_permlane32_swap_b32 v16, v18
    v_permlane32_swap_b32 v17, v19
    v_permlane32_swap_b32 v20, v22
    v_permlane32_swap_b32 v21, v23
    v_add_f32 v12, v12, v14
    v_add_f32 v13, v13, v15
    v_add_f32 v16, v16, v18
    v_add_f32 v17, v17, v19
    v_add_f32 v20, v20, v22
    v_add_f32 v21, v21, v23
    v_permlane16_swap_b32 v12, v13
    v_permlane16_swap_b32 v16, v17
    v_permlane16_swap_b32 v20, v21
    s_lshr_b32 s32, s30, 2
    v_mov_b32 v10, s32
    v_add_f32 v12, v12, v13
    ds_write_b32 v8, v12 offset:0
    v_add_f32 v16, v16, v17
    ds_write_b32 v8, v16 offset:256
    v_add_f32 v20, v20, v21
    ds_write_b32 v8, v20 offset:512
    v_mov_b32 v11, 1
    s_mov_b64 exec, 1
    ds_add_u32 v10, v11 offset:60
    s_mov_b64 exec, -1
    v_add_u32 v8, 3072, v8
    v_mov_b32 v12, 0
    v_mov_b32 v13, 0
    v_mov_b32 v14, 0
    v_mov_b32 v15, 0
    v_mov_b32 v16, 0
    v_mov_b32 v17, 0
    v_mov_b32 v18, 0
    v_mov_b32 v19, 0
    v_mov_b32 v20, 0
    v_mov_b32 v21, 0
    v_mov_b32 v22, 0
    v_mov_b32 v23, 0
    s_cmp_lg_u32 s59, 0
    s_cbranch_scc1 L_vboost2
L_vend2:
    s_nop 1
    s_cmp_lg_u32 s30, 48
    s_cbranch_scc1 L_vloop
L_exit1:
    s_endpgm
L_deep:
    s_nop 1
    buffer_load_dwordx4 v[88:91], v48, s[12:15], 0 offen offset:1536 nt
    buffer_load_dwordx4 v[92:95], v48, s[12:15], 0 offen offset:1792 nt
    buffer_load_dwordx4 v[96:99], v48, s[12:15], 0 offen offset:2048 nt
    buffer_load_dwordx4 v[100:103], v48, s[12:15], 0 offen offset:2304 nt
    buffer_load_dwordx4 v[104:107], v48, s[12:15], 0 offen offset:2560 nt
    buffer_load_dwordx4 v[108:111], v48, s[12:15], 0 offen offset:2816 nt
    buffer_load_dwordx4 v[112:115], v48, s[12:15], 0 offen offset:3072 nt
    buffer_load_dwordx4 v[116:119], v48, s[12:15], 0 offen offset:3328 nt
    buffer_load_dwordx4 v[120:123], v48, s[12:15], 0 offen offset:3584 nt
    buffer_load_dwordx4 v[124:127], v49, s[12:15], 0 offen offset:0 nt
    buffer_load_dwordx4 v[128:131], v49, s[12:15], 0 offen offset:256 nt
    buffer_load_dwordx4 v[132:135], v49, s[12:15], 0 offen offset:512 nt
.p2align 6
L_dloop:
    s_nop 1
    s_add_u32 s29, s29, 4
    s_add_u32 s30, s30, 1
    s_lshr_b32 s33, s29, 6
    s_lshl_b32 s33, s33, 11
    s_and_b32 s32, s29, 63
    s_add_u32 s32, s32, s33
    s_add_u32 s32, s32, s44
    s_bfe_u32 s33, s32, 0x20003
    s_and_b32 s34, s32, 4
    s_or_b32 s33, s33, s34
    s_xor_b32 s33, s33, s5
    s_lshl_b32 s50, s32, 5
    s_or_b32 s50, s50, s33
    s_lshl_b32 s50, s50, 4
    s_or_b32 s50, s50, 1
    s_lshl_b32 s53, s29, 7
    v_xor_b32 v10, s50, v50
    v_mul_hi_u32 v10, v10, s47
    v_lshrrev_b32 v10, 1, v10
    v_and_b32 v11, 15, v10
    v_cmp_eq_u32 vcc, 5, v11
    v_mad_u32_u24 v48, v10, s45, v2
    v_add_u32 v11, 3840, v48
    v_cndmask_b32 v49, v51, v11, vcc
    v_add_u32 v10, s53, v5
    ds_read_b32 v7, v10
    s_waitcnt vmcnt(12)
    v_cvt_f32_i32 v64, v64
    v_cvt_f32_i32 v65, v65
    v_cvt_f32_i32 v66, v66
    v_cvt_f32_i32 v67, v67
    v_fmac_f32_dpp v12, v6, v64 row_newbcast:0 row_mask:0xf bank_mask:0xf
    v_fmac_f32_dpp v13, v6, v65 row_newbcast:0 row_mask:0xf bank_mask:0xf
    v_fmac_f32_dpp v14, v6, v66 row_newbcast:0 row_mask:0xf bank_mask:0xf
    v_fmac_f32_dpp v15, v6, v67 row_newbcast:0 row_mask:0xf bank_mask:0xf
    v_cvt_f32_i32 v68, v68
    v_cvt_f32_i32 v69, v69
    v_cvt_f32_i32 v70, v70
    v_cvt_f32_i32 v71, v71
    v_fmac_f32_dpp v16, v6, v68 row_newbcast:0 row_mask:0xf bank_mask:0xf
    v_fmac_f32_dpp v17, v6, v69 row_newbcast:0 row_mask:0xf bank_mask:0xf
    v_fmac_f32_dpp v18, v6, v70 row_newbcast:0 row_mask:0xf bank_mask:0xf
    v_fmac_f32_dpp v19, v6, v71 row_newbcast:0 row_mask:0xf bank_mask:0xf
    v_cvt_f32_i32 v72, v72
    v_cvt_f32_i32 v73, v73
    v_cvt_f32_i32 v74, v74
    v_cvt_f32_i32 v75, v75
    v_fmac_f32_dpp v20, v6, v72 row_newbcast:0 row_mask:0xf bank_mask:0xf
    v_fmac_f32_dpp v21, v6, v73 row_newbcast:0 row_mask:0xf bank_mask:0xf
    v_fmac_f32_dpp v22, v6, v74 row_newbcast:0 row_mask:0xf bank_mask:0xf
    v_fmac_f32_dpp v23, v6, v75 row_newbcast:0 row_mask:0xf bank_mask:0xf
    v_cvt_f32_i32 v76, v76
    v_cvt_f32_i32 v77, v77
    v_cvt_f32_i32 v78, v78
    v_cvt_f32_i32 v79, v79
    v_fmac_f32_dpp v12, v6, v76 row_newbcast:1 row_mask:0xf bank_mask:0xf
    v_fmac_f32_dpp v13, v6, v77 row_newbcast:1 row_mask:0xf bank_mask:0xf
    v_fmac_f32_dpp v14, v6, v78 row_newbcast:1 row_mask:0xf bank_mask:0xf
    v_fmac_f32_dpp v15, v6, v79 row_newbcast:1 row_mask:0xf bank_mask:0xf
    v_cvt_f32_i32 v80, v80
    v_cvt_f32_i32 v81, v81
    v_cvt_f32_i32 v82, v82
    v_cvt_f32_i32 v83, v83
    v_fmac_f32_dpp v16, v6, v80 row_newbcast:1 row_mask:0xf bank_mask:0xf
    v_fmac_f32_dpp v17, v6, v81 row_newbcast:1 row_mask:0xf bank_mask:0xf
    v_fmac_f32_dpp v18, v6, v82 row_newbcast:1 row_mask:0xf bank_mask:0xf
    v_fmac_f32_dpp v19, v6, v83 row_newbcast:1 row_mask:0xf bank_mask:0xf
    v_cvt_f32_i32 v84, v84
    v_cvt_f32_i32 v85, v85
    v_cvt_f32_i32 v86, v86
    v_cvt_f32_i32 v87, v87
    v_fmac_f32_dpp v20, v6, v84 row_newbcast:1 row_mask:0xf bank_mask:0xf
    v_fmac_f32_dpp v21, v6, v85 row_newbcast:1 row_mask:0xf bank_mask:0xf
    v_fmac_f32_dpp v22, v6, v86 row_newbcast:1 row_mask:0xf bank_mask:0xf
    v_fmac_f32_dpp v23, v6, v87 row_newbcast:1 row_mask:0xf bank_mask:0xf
    buffer_load_dwordx4 v[64:67], v48, s[12:15], 0 offen offset:0 nt
    buffer_load_dwordx4 v[68:71], v48, s[12:15], 0 offen offset:256 nt
    buffer_load_dwordx4 v[72:75], v48, s[12:15], 0 offen offset:512 nt
    buffer_load_dwordx4 v[76:79], v48, s[12:15], 0 offen offset:768 nt
    buffer_load_dwordx4 v[80:83], v48, s[12:15], 0 offen offset:1024 nt
    buffer_load_dwordx4 v[84:87], v48, s[12:15], 0 offen offset:1280 nt
    s_waitcnt vmcnt(12)
    s_cmp_eq_u32 s30, 48
    s_cbranch_scc1 L_el1
L_el1r:
    v_cvt_f32_i32 v88, v88
    v_cvt_f32_i32 v89, v89
    v_cvt_f32_i32 v90, v90
    v_cvt_f32_i32 v91, v91
    v_fmac_f32_dpp v12, v6, v88 row_newbcast:2 row_mask:0xf bank_mask:0xf
    v_fmac_f32_dpp v13, v6, v89 row_newbcast:2 row_mask:0xf bank_mask:0xf
    v_fmac_f32_dpp v14, v6, v90 row_newbcast:2 row_mask:0xf bank_mask:0xf
    v_fmac_f32_dpp v15, v6, v91 row_newbcast:2 row_mask:0xf bank_mask:0xf
    v_cvt_f32_i32 v92, v92
    v_cvt_f32_i32 v93, v93
    v_cvt_f32_i32 v94, v94
    v_cvt_f32_i32 v95, v95
    v_fmac_f32_dpp v16, v6, v92 row_newbcast:2 row_mask:0xf bank_mask:0xf
    v_fmac_f32_dpp v17, v6, v93 row_newbcast:2 row_mask:0xf bank_mask:0xf
    v_fmac_f32_dpp v18, v6, v94 row_newbcast:2 row_mask:0xf bank_mask:0xf
    v_fmac_f32_dpp v19, v6, v95 row_newbcast:2 row_mask:0xf bank_mask:0xf
    v_cvt_f32_i32 v96, v96
    v_cvt_f32_i32 v97, v97
    v_cvt_f32_i32 v98, v98
    v_cvt_f32_i32 v99, v99
    v_fmac_f32_dpp v20, v6, v96 row_newbcast:2 row_mask:0xf bank_mask:0xf
    v_fmac_f32_dpp v21, v6, v97 row_newbcast:2 row_mask:0xf bank_mask:0xf
    v_fmac_f32_dpp v22, v6, v98 row_newbcast:2 row_mask:0xf bank_mask:0xf
    v_fmac_f32_dpp v23, v6, v99 row_newbcast:2 row_mask:0xf bank_mask:0xf
    v_cvt_f32_i32 v100, v100
    v_cvt_f32_i32 v101, v101
    v_cvt_f32_i32 v102, v102
    v_cvt_f32_i32 v103, v103
    v_fmac_f32_dpp v12, v6, v100 row_newbcast:3 row_mask:0xf bank_mask:0xf
    v_fmac_f32_dpp v13, v6, v101 row_newbcast:3 row_mask:0xf bank_mask:0xf
    v_fmac_f32_dpp v14, v6, v102 row_newbcast:3 row_mask:0xf bank_mask:0xf
    v_fmac_f32_dpp v15, v6, v103 row_newbcast:3 row_mask:0xf bank_mask:0xf
    v_cvt_f32_i32 v104, v104
    v_cvt_f32_i32 v105, v105
    v_cvt_f32_i32 v106, v106
    v_cvt_f32_i32 v107, v107
    v_fmac_f32_dpp v16, v6, v104 row_newbcast:3 row_mask:0xf bank_mask:0xf
    v_fmac_f32_dpp v17, v6, v105 row_newbcast:3 row_mask:0xf bank_mask:0xf
    v_fmac_f32_dpp v18, v6, v106 row_newbcast:3 row_mask:0xf bank_mask:0xf
    v_fmac_f32_dpp v19, v6, v107 row_newbcast:3 row_mask:0xf bank_mask:0xf
    v_cvt_f32_i32 v108, v108
    v_cvt_f32_i32 v109, v109
    v_cvt_f32_i32 v110, v110
    v_cvt_f32_i32 v111, v111
    v_fmac_f32_dpp v20, v6, v108 row_newbcast:3 row_mask:0xf bank_mask:0xf
    v_fmac_f32_dpp v21, v6, v109 row_newbcast:3 row_mask:0xf bank_mask:0xf
    v_fmac_f32_dpp v22, v6, v110 row_newbcast:3 row_mask:0xf bank_mask:0xf
    v_fmac_f32_dpp v23, v6, v111 row_newbcast:3 row_mask:0xf bank_mask:0xf
    buffer_load_dwordx4 v[88:91], v48, s[12:15], 0 offen offset:1536 nt
    buffer_load_dwordx4 v[92:95], v48, s[12:15], 0 offen offset:1792 nt
    buffer_load_dwordx4 v[96:99], v48, s[12:15], 0 offen offset:2048 nt
    buffer_load_dwordx4 v[100:103], v48, s[12:15], 0 offen offset:2304 nt
    buffer_load_dwordx4 v[104:107], v48, s[12:15], 0 offen offset:2560 nt
    buffer_load_dwordx4 v[108:111], v48, s[12:15], 0 offen offset:2816 nt
    s_waitcnt vmcnt(12)
    v_cvt_f32_i32 v112, v112
    v_cvt_f32_i32 v113, v113
    v_cvt_f32_i32 v114, v114
    v_cvt_f32_i32 v115, v115
    v_fmac_f32_dpp v12, v6, v112 row_newbcast:4 row_mask:0xf bank_mask:0xf
    v_fmac_f32_dpp v13, v6, v113 row_newbcast:4 row_mask:0xf bank_mask:0xf
    v_fmac_f32_dpp v14, v6, v114 row_newbcast:4 row_mask:0xf bank_mask:0xf
    v_fmac_f32_dpp v15, v6, v115 row_newbcast:4 row_mask:0xf bank_mask:0xf
    v_cvt_f32_i32 v116, v116
    v_cvt_f32_i32 v117, v117
    v_cvt_f32_i32 v118, v118
    v_cvt_f32_i32 v119, v119
    v_fmac_f32_dpp v16, v6, v116 row_newbcast:4 row_mask:0xf bank_mask:0xf
    v_fmac_f32_dpp v17, v6, v117 row_newbcast:4 row_mask:0xf bank_mask:0xf
    v_fmac_f32_dpp v18, v6, v118 row_newbcast:4 row_mask:0xf bank_mask:0xf
    v_fmac_f32_dpp v19, v6, v119 row_newbcast:4 row_mask:0xf bank_mask:0xf
    v_cvt_f32_i32 v120, v120
    v_cvt_f32_i32 v121, v121
    v_cvt_f32_i32 v122, v122
    v_cvt_f32_i32 v123, v123
    v_fmac_f32_dpp v20, v6, v120 row_newbcast:4 row_mask:0xf bank_mask:0xf
    v_fmac_f32_dpp v21, v6, v121 row_newbcast:4 row_mask:0xf bank_mask:0xf
    v_fmac_f32_dpp v22, v6, v122 row_newbcast:4 row_mask:0xf bank_mask:0xf
    v_fmac_f32_dpp v23, v6, v123 row_newbcast:4 row_mask:0xf bank_mask:0xf
    v_cvt_f32_i32 v124, v124
    v_cvt_f32_i32 v125, v125
    v_cvt_f32_i32 v126, v126
    v_cvt_f32_i32 v127, v127
    v_fmac_f32_dpp v12, v6, v124 row_newbcast:5 row_mask:0xf bank_mask:0xf
    v_fmac_f32_dpp v13, v6, v125 row_newbcast:5 row_mask:0xf bank_mask:0xf
    v_fmac_f32_dpp v14, v6, v126 row_newbcast:5 row_mask:0xf bank_mask:0xf
    v_fmac_f32_dpp v15, v6, v127 row_newbcast:5 row_mask:0xf bank_mask:0xf
    v_cvt_f32_i32 v128, v128
    v_cvt_f32_i32 v129, v129
    v_cvt_f32_i32 v130, v130
    v_cvt_f32_i32 v131, v131
    v_fmac_f32_dpp v16, v6, v128 row_newbcast:5 row_mask:0xf bank_mask:0xf
    v_fmac_f32_dpp v17, v6, v129 row_newbcast:5 row_mask:0xf bank_mask:0xf
    v_fmac_f32_dpp v18, v6, v130 row_newbcast:5 row_mask:0xf bank_mask:0xf
    v_fmac_f32_dpp v19, v6, v131 row_newbcast:5 row_mask:0xf bank_mask:0xf
    v_cvt_f32_i32 v132, v132
    v_cvt_f32_i32 v133, v133
    v_cvt_f32_i32 v134, v134
    v_cvt_f32_i32 v135, v135
    v_fmac_f32_dpp v20, v6, v132 row_newbcast:5 row_mask:0xf bank_mask:0xf
    v_fmac_f32_dpp v21, v6, v133 row_newbcast:5 row_mask:0xf bank_mask:0xf
    v_fmac_f32_dpp v22, v6, v134 row_newbcast:5 row_mask:0xf bank_mask:0xf
    v_fmac_f32_dpp v23, v6, v135 row_newbcast:5 row_mask:0xf bank_mask:0xf
    buffer_load_dwordx4 v[112:115], v48, s[12:15], 0 offen offset:3072 nt
    buffer_load_dwordx4 v[116:119], v48, s[12:15], 0 offen offset:3328 nt
    buffer_load_dwordx4 v[120:123], v48, s[12:15], 0 offen offset:3584 nt
    buffer_load_dwordx4 v[124:127], v49, s[12:15], 0 offen offset:0 nt
    buffer_load_dwordx4 v[128:131], v49, s[12:15], 0 offen offset:256 nt
    buffer_load_dwordx4 v[132:135], v49, s[12:15], 0 offen offset:512 nt
    s_waitcnt lgkmcnt(0)
    v_mov_b32 v6, v7
    s_cmp_lg_u32 s30, 48
    s_cbranch_scc1 L_dloop
    s_branch L_vend
L_kboost:
    s_nop 1
    s_cmp_eq_u32 s30, 47
    s_cbranch_scc1 L_kchk2
    buffer_load_dwordx4 v[88:91], v48, s[8:11], 0 offen offset:1536 nt
    buffer_load_dwordx4 v[92:95], v48, s[8:11], 0 offen offset:1792 nt
    buffer_load_dwordx4 v[96:99], v48, s[8:11], 0 offen offset:2048 nt
    buffer_load_dwordx4 v[100:103], v48, s[8:11], 0 offen offset:2304 nt
    buffer_load_dwordx4 v[104:107], v48, s[8:11], 0 offen offset:2560 nt
    buffer_load_dwordx4 v[108:111], v48, s[8:11], 0 offen offset:2816 nt
    buffer_load_dwordx4 v[112:115], v48, s[8:11], 0 offen offset:3072 nt
    buffer_load_dwordx4 v[116:119], v48, s[8:11], 0 offen offset:3328 nt
    buffer_load_dwordx4 v[120:123], v48, s[8:11], 0 offen offset:3584 nt
    buffer_load_dwordx4 v[124:127], v49, s[8:11], 0 offen offset:0 nt
    buffer_load_dwordx4 v[128:131], v49, s[8:11], 0 offen offset:256 nt
    buffer_load_dwordx4 v[132:135], v49, s[8:11], 0 offen offset:512 nt
    s_sub_u32 s59, s59, 1
    s_add_u32 s29, s29, 4
    s_add_u32 s30, s30, 1
    s_bitcmp1_b64 s[40:41], s30
    s_cbranch_scc1 L_evKB
L_evretKB:
    s_nop 1
    s_lshr_b32 s33, s29, 6
    s_lshl_b32 s33, s33, 11
    s_and_b32 s32, s29, 63
    s_add_u32 s32, s32, s33
    s_add_u32 s32, s32, s44
    s_bfe_u32 s33, s32, 0x20003
    s_and_b32 s34, s32, 4
    s_or_b32 s33, s33, s34
    s_xor_b32 s33, s33, s5
    s_lshl_b32 s50, s32, 5
    s_or_b32 s50, s50, s33
    s_lshl_b32 s50, s50, 4
    s_or_b32 s50, s50, 1
    v_xor_b32 v10, s50, v50
    v_mul_hi_u32 v10, v10, s47
    v_lshrrev_b32 v10, 1, v10
    v_and_b32 v11, 15, v10
    v_cmp_eq_u32 vcc, 5, v11
    v_mad_u32_u24 v48, v10, s45, v2
    v_add_u32 v11, 3840, v48
    v_cndmask_b32 v49, v51, v11, vcc
    v_lshrrev_b32 v10, 6, v10
    v_mad_u32_u24 v9, v10, s46, v3
    buffer_load_dwordx2 v[42:43], v9, s[16:19], 0 offen offset:0
    buffer_load_dwordx2 v[44:45], v9, s[16:19], 0 offen offset:128
    buffer_load_dwordx2 v[46:47], v9, s[16:19], 0 offen offset:256
    s_waitcnt vmcnt(15)
    v_cvt_f32_i32 v64, v64
    v_cvt_f32_i32 v65, v65
    v_cvt_f32_i32 v66, v66
    v_cvt_f32_i32 v67, v67
    v_mul_f32 v54, v64, v24
    v_fmac_f32 v54, v65, v25
    v_fmac_f32 v54, v66, v26
    v_fmac_f32 v54, v67, v27
    v_cvt_f32_i32 v68, v68
    v_cvt_f32_i32 v69, v69
    v_cvt_f32_i32 v70, v70
    v_cvt_f32_i32 v71, v71
    v_fmac_f32 v54, v68, v28
    v_fmac_f32 v54, v69, v29
    v_fmac_f32 v54, v70, v30
    v_fmac_f32 v54, v71, v31
    v_cvt_f32_i32 v72, v72
    v_cvt_f32_i32 v73, v73
    v_cvt_f32_i32 v74, v74
    v_cvt_f32_i32 v75, v75
    v_fmac_f32 v54, v72, v32
    v_fmac_f32 v54, v73, v33
    v_fmac_f32 v54, v74, v34
    v_fmac_f32 v54, v75, v35
    v_cvt_f32_i32 v76, v76
    v_cvt_f32_i32 v77, v77
    v_add_f32_dpp v54, v54, v54 row_ror:8 row_mask:0xf bank_mask:0xf
    v_cvt_f32_i32 v78, v78
    v_cvt_f32_i32 v79, v79
    v_add_f32_dpp v54, v54, v54 row_ror:4 row_mask:0xf bank_mask:0xf
    v_mul_f32 v55, v76, v24
    v_fmac_f32 v55, v77, v25
    v_add_f32_dpp v54, v54, v54 row_ror:2 row_mask:0xf bank_mask:0xf
    v_fmac_f32 v55, v78, v26
    v_fmac_f32 v55, v79, v27
    v_add_f32_dpp v60, v54, v54 row_ror:1 row_mask:0xf bank_mask:0x1
    v_cvt_f32_i32 v80, v80
    v_cvt_f32_i32 v81, v81
    v_cvt_f32_i32 v82, v82
    v_cvt_f32_i32 v83, v83
    v_fmac_f32 v55, v80, v28
    v_fmac_f32 v55, v81, v29
    v_fmac_f32 v55, v82, v30
    v_fmac_f32 v55, v83, v31
    v_cvt_f32_i32 v84, v84
    v_cvt_f32_i32 v85, v85
    v_cvt_f32_i32 v86, v86
    v_cvt_f32_i32 v87, v87
    v_fmac_f32 v55, v84, v32
    v_fmac_f32 v55, v85, v33
    v_fmac_f32 v55, v86, v34
    v_fmac_f32 v55, v87, v35
    s_nop 1
    v_add_f32_dpp v55, v55, v55 row_ror:8 row_mask:0xf bank_mask:0xf
    s_nop 1
    v_add_f32_dpp v55, v55, v55 row_ror:4 row_mask:0xf bank_mask:0xf
    s_nop 1
    v_add_f32_dpp v55, v55, v55 row_ror:2 row_mask:0xf bank_mask:0xf
    s_nop 1
    v_add_f32_dpp v61, v55, v55 row_ror:1 row_mask:0xf bank_mask:0x1
    buffer_load_dwordx4 v[64:67], v48, s[8:11], 0 offen offset:0 nt
    buffer_load_dwordx4 v[68:71], v48, s[8:11], 0 offen offset:256 nt
    buffer_load_dwordx4 v[72:75], v48, s[8:11], 0 offen offset:512 nt
    buffer_load_dwordx4 v[76:79], v48, s[8:11], 0 offen offset:768 nt
    buffer_load_dwordx4 v[80:83], v48, s[8:11], 0 offen offset:1024 nt
    buffer_load_dwordx4 v[84:87], v48, s[8:11], 0 offen offset:1280 nt
    s_waitcnt vmcnt(15)
    v_cvt_f32_i32 v88, v88
    v_cvt_f32_i32 v89, v89
    v_cvt_f32_i32 v90, v90
    v_cvt_f32_i32 v91, v91
    v_mul_f32 v56, v88, v24
    v_fmac_f32 v56, v89, v25
    v_fmac_f32 v56, v90, v26
    v_fmac_f32 v56, v91, v27
    v_cvt_f32_i32 v92, v92
    v_cvt_f32_i32 v93, v93
    v_cvt_f32_i32 v94, v94
    v_cvt_f32_i32 v95, v95
    v_fmac_f32 v56, v92, v28
    v_fmac_f32 v56, v93, v29
    v_fmac_f32 v56, v94, v30
    v_fmac_f32 v56, v95, v31
    v_cvt_f32_i32 v96, v96
    v_cvt_f32_i32 v97, v97
    v_cvt_f32_i32 v98, v98
    v_cvt_f32_i32 v99, v99
    v_fmac_f32 v56, v96, v32
    v_fmac_f32 v56, v97, v33
    v_fmac_f32 v56, v98, v34
    v_fmac_f32 v56, v99, v35
    v_cvt_f32_i32 v100, v100
    v_cvt_f32_i32 v101, v101
    v_add_f32_dpp v56, v56, v56 row_ror:8 row_mask:0xf bank_mask:0xf
    v_cvt_f32_i32 v102, v102
    v_cvt_f32_i32 v103, v103
    v_add_f32_dpp v56, v56, v56 row_ror:4 row_mask:0xf bank_mask:0xf
    v_mul_f32 v57, v100, v24
    v_fmac_f32 v57, v101, v25
    v_add_f32_dpp v56, v56, v56 row_ror:2 row_mask:0xf bank_mask:0xf
    v_fmac_f32 v57, v102, v26
    v_fmac_f32 v57, v103, v27
    v_add_f32_dpp v60, v56, v56 row_ror:1 row_mask:0xf bank_mask:0x2
    v_cvt_f32_i32 v104, v104
    v_cvt_f32_i32 v105, v105
    v_cvt_f32_i32 v106, v106
    v_cvt_f32_i32 v107, v107
    v_fmac_f32 v57, v104, v28
    v_fmac_f32 v57, v105, v29
    v_fmac_f32 v57, v106, v30
    v_fmac_f32 v57, v107, v31
    v_cvt_f32_i32 v108, v108
    v_cvt_f32_i32 v109, v109
    v_cvt_f32_i32 v110, v110
    v_cvt_f32_i32 v111, v111
    v_fmac_f32 v57, v108, v32
    v_fmac_f32 v57, v109, v33
    v_fmac_f32 v57, v110, v34
    v_fmac_f32 v57, v111, v35
    s_nop 1
    v_add_f32_dpp v57, v57, v57 row_ror:8 row_mask:0xf bank_mask:0xf
    s_nop 1
    v_add_f32_dpp v57, v57, v57 row_ror:4 row_mask:0xf bank_mask:0xf
    s_nop 1
    v_add_f32_dpp v57, v57, v57 row_ror:2 row_mask:0xf bank_mask:0xf
    s_nop 1
    v_add_f32_dpp v61, v57, v57 row_ror:1 row_mask:0xf bank_mask:0x2
    s_waitcnt vmcnt(9)
    v_cvt_f32_i32 v112, v112
    v_cvt_f32_i32 v113, v113
    v_cvt_f32_i32 v114, v114
    v_cvt_f32_i32 v115, v115
    v_mul_f32 v58, v112, v24
    v_fmac_f32 v58, v113, v25
    v_fmac_f32 v58, v114, v26
    v_fmac_f32 v58, v115, v27
    v_cvt_f32_i32 v116, v116
    v_cvt_f32_i32 v117, v117
    v_cvt_f32_i32 v118, v118
    v_cvt_f32_i32 v119, v119
    v_fmac_f32 v58, v116, v28
    v_fmac_f32 v58, v117, v29
    v_fmac_f32 v58, v118, v30
    v_fmac_f32 v58, v119, v31
    v_cvt_f32_i32 v120, v120
    v_cvt_f32_i32 v121, v121
    v_cvt_f32_i32 v122, v122
    v_cvt_f32_i32 v123, v123
    v_fmac_f32 v58, v120, v32
    v_fmac_f32 v58, v121, v33
    v_fmac_f32 v58, v122, v34
    v_fmac_f32 v58, v123, v35
    v_cvt_f32_i32 v124, v124
    v_cvt_f32_i32 v125, v125
    v_add_f32_dpp v58, v58, v58 row_ror:8 row_mask:0xf bank_mask:0xf
    v_cvt_f32_i32 v126, v126
    v_cvt_f32_i32 v127, v127
    v_add_f32_dpp v58, v58, v58 row_ror:4 row_mask:0xf bank_mask:0xf
    v_mul_f32 v59, v124, v24
    v_fmac_f32 v59, v125, v25
    v_add_f32_dpp v58, v58, v58 row_ror:2 row_mask:0xf bank_mask:0xf
    v_fmac_f32 v59, v126, v26
    v_fmac_f32 v59, v127, v27
    v_add_f32_dpp v60, v58, v58 row_ror:1 row_mask:0xf bank_mask:0x4
    v_cvt_f32_i32 v128, v128
    v_cvt_f32_i32 v129, v129
    v_cvt_f32_i32 v130, v130
    v_cvt_f32_i32 v131, v131
    v_fmac_f32 v59, v128, v28
    v_fmac_f32 v59, v129, v29
    v_fmac_f32 v59, v130, v30
    v_fmac_f32 v59, v131, v31
    v_cvt_f32_i32 v132, v132
    v_cvt_f32_i32 v133, v133
    v_cvt_f32_i32 v134, v134
    v_cvt_f32_i32 v135, v135
    v_fmac_f32 v59, v132, v32
    v_fmac_f32 v59, v133, v33
    v_fmac_f32 v59, v134, v34
    v_fmac_f32 v59, v135, v35
    s_nop 1
    v_add_f32_dpp v59, v59, v59 row_ror:8 row_mask:0xf bank_mask:0xf
    s_nop 1
    v_add_f32_dpp v59, v59, v59 row_ror:4 row_mask:0xf bank_mask:0xf
    s_nop 1
    v_add_f32_dpp v59, v59, v59 row_ror:2 row_mask:0xf bank_mask:0xf
    s_nop 1
    v_add_f32_dpp v61, v59, v59 row_ror:1 row_mask:0xf bank_mask:0x4
    s_mov_b64 exec, s[42:43]
    ds_write_b64 v4, v[60:61]
    s_mov_b64 exec, -1
    v_add_u32 v4, 48, v4
    s_waitcnt vmcnt(6)
    v_lshlrev_b32 v10, 16, v36
    v_lshlrev_b32 v24, 16, v42
    v_and_b32 v11, 0xffff0000, v36
    v_and_b32 v25, 0xffff0000, v42
    v_mul_f32 v24, v24, v10
    v_mul_f32 v25, v25, v11
    v_lshlrev_b32 v10, 16, v37
    v_lshlrev_b32 v26, 16, v43
    v_and_b32 v11, 0xffff0000, v37
    v_and_b32 v27, 0xffff0000, v43
    v_mul_f32 v26, v26, v10
    v_mul_f32 v27, v27, v11
    v_lshlrev_b32 v10, 16, v38
    v_lshlrev_b32 v28, 16, v44
    v_and_b32 v11, 0xffff0000, v38
    v_and_b32 v29, 0xffff0000, v44
    v_mul_f32 v28, v28, v10
    v_mul_f32 v29, v29, v11
    v_lshlrev_b32 v10, 16, v39
    v_lshlrev_b32 v30, 16, v45
    v_and_b32 v11, 0xffff0000, v39
    v_and_b32 v31, 0xffff0000, v45
    v_mul_f32 v30, v30, v10
    v_mul_f32 v31, v31, v11
    v_lshlrev_b32 v10, 16, v40
    v_lshlrev_b32 v32, 16, v46
    v_and_b32 v11, 0xffff0000, v40
    v_and_b32 v33, 0xffff0000, v46
    v_mul_f32 v32, v32, v10
    v_mul_f32 v33, v33, v11
    v_lshlrev_b32 v10, 16, v41
    v_lshlrev_b32 v34, 16, v47
    v_and_b32 v11, 0xffff0000, v41
    v_and_b32 v35, 0xffff0000, v47
    v_mul_f32 v34, v34, v10
    v_mul_f32 v35, v35, v11
    s_branch L_kchk
L_vboost:
    s_nop 1
    s_and_b32 s32, s30, 15
    s_cbranch_scc0 L_vend
L_vboost2:
    s_nop 1
    s_cmp_eq_u32 s30, 48
    s_cbranch_scc1 L_vend2
    buffer_load_dwordx4 v[88:91], v48, s[12:15], 0 offen offset:1536 nt
    buffer_load_dwordx4 v[92:95], v48, s[12:15], 0 offen offset:1792 nt
    buffer_load_dwordx4 v[96:99], v48, s[12:15], 0 offen offset:2048 nt
    buffer_load_dwordx4 v[100:103], v48, s[12:15], 0 offen offset:2304 nt
    buffer_load_dwordx4 v[104:107], v48, s[12:15], 0 offen offset:2560 nt
    buffer_load_dwordx4 v[108:111], v48, s[12:15], 0 offen offset:2816 nt
    buffer_load_dwordx4 v[112:115], v48, s[12:15], 0 offen offset:3072 nt
    buffer_load_dwordx4 v[116:119], v48, s[12:15], 0 offen offset:3328 nt
    buffer_load_dwordx4 v[120:123], v48, s[12:15], 0 offen offset:3584 nt
    buffer_load_dwordx4 v[124:127], v49, s[12:15], 0 offen offset:0 nt
    buffer_load_dwordx4 v[128:131], v49, s[12:15], 0 offen offset:256 nt
    buffer_load_dwordx4 v[132:135], v49, s[12:15], 0 offen offset:512 nt
    s_sub_u32 s59, s59, 1
    s_add_u32 s29, s29, 4
    s_add_u32 s30, s30, 1
    s_bitcmp1_b64 s[40:41], s30
    s_cbranch_scc1 L_evVB
L_evretVB:
    s_nop 1
    s_lshr_b32 s33, s29, 6
    s_lshl_b32 s33, s33, 11
    s_and_b32 s32, s29, 63
    s_add_u32 s32, s32, s33
    s_add_u32 s32, s32, s44
    s_bfe_u32 s33, s32, 0x20003
    s_and_b32 s34, s32, 4
    s_or_b32 s33, s33, s34
    s_xor_b32 s33, s33, s5
    s_lshl_b32 s50, s32, 5
    s_or_b32 s50, s50, s33
    s_lshl_b32 s50, s50, 4
    s_or_b32 s50, s50, 1
    s_lshl_b32 s53, s29, 7
    v_xor_b32 v10, s50, v50
    v_mul_hi_u32 v10, v10, s47
    v_lshrrev_b32 v10, 1, v10
    v_and_b32 v11, 15, v10
    v_cmp_eq_u32 vcc, 5, v11
    v_mad_u32_u24 v48, v10, s45, v2
    v_add_u32 v11, 3840, v48
    v_cndmask_b32 v49, v51, v11, vcc
    v_add_u32 v10, s53, v5
    ds_read_b32 v7, v10
    s_waitcnt vmcnt(12)
    v_cvt_f32_i32 v64, v64
    v_cvt_f32_i32 v65, v65
    v_cvt_f32_i32 v66, v66
    v_cvt_f32_i32 v67, v67
    v_fmac_f32_dpp v12, v6, v64 row_newbcast:0 row_mask:0xf bank_mask:0xf
    v_fmac_f32_dpp v13, v6, v65 row_newbcast:0 row_mask:0xf bank_mask:0xf
    v_fmac_f32_dpp v14, v6, v66 row_newbcast:0 row_mask:0xf bank_mask:0xf
    v_fmac_f32_dpp v15, v6, v67 row_newbcast:0 row_mask:0xf bank_mask:0xf
    v_cvt_f32_i32 v68, v68
    v_cvt_f32_i32 v69, v69
    v_cvt_f32_i32 v70, v70
    v_cvt_f32_i32 v71, v71
    v_fmac_f32_dpp v16, v6, v68 row_newbcast:0 row_mask:0xf bank_mask:0xf
    v_fmac_f32_dpp v17, v6, v69 row_newbcast:0 row_mask:0xf bank_mask:0xf
    v_fmac_f32_dpp v18, v6, v70 row_newbcast:0 row_mask:0xf bank_mask:0xf
    v_fmac_f32_dpp v19, v6, v71 row_newbcast:0 row_mask:0xf bank_mask:0xf
    v_cvt_f32_i32 v72, v72
    v_cvt_f32_i32 v73, v73
    v_cvt_f32_i32 v74, v74
    v_cvt_f32_i32 v75, v75
    v_fmac_f32_dpp v20, v6, v72 row_newbcast:0 row_mask:0xf bank_mask:0xf
    v_fmac_f32_dpp v21, v6, v73 row_newbcast:0 row_mask:0xf bank_mask:0xf
    v_fmac_f32_dpp v22, v6, v74 row_newbcast:0 row_mask:0xf bank_mask:0xf
    v_fmac_f32_dpp v23, v6, v75 row_newbcast:0 row_mask:0xf bank_mask:0xf
    v_cvt_f32_i32 v76, v76
    v_cvt_f32_i32 v77, v77
    v_cvt_f32_i32 v78, v78
    v_cvt_f32_i32 v79, v79
    v_fmac_f32_dpp v12, v6, v76 row_newbcast:1 row_mask:0xf bank_mask:0xf
    v_fmac_f32_dpp v13, v6, v77 row_newbcast:1 row_mask:0xf bank_mask:0xf
    v_fmac_f32_dpp v14, v6, v78 row_newbcast:1 row_mask:0xf bank_mask:0xf
    v_fmac_f32_dpp v15, v6, v79 row_newbcast:1 row_mask:0xf bank_mask:0xf
    v_cvt_f32_i32 v80, v80
    v_cvt_f32_i32 v81, v81
    v_cvt_f32_i32 v82, v82
    v_cvt_f32_i32 v83, v83
    v_fmac_f32_dpp v16, v6, v80 row_newbcast:1 row_mask:0xf bank_mask:0xf
    v_fmac_f32_dpp v17, v6, v81 row_newbcast:1 row_mask:0xf bank_mask:0xf
    v_fmac_f32_dpp v18, v6, v82 row_newbcast:1 row_mask:0xf bank_mask:0xf
    v_fmac_f32_dpp v19, v6, v83 row_newbcast:1 row_mask:0xf bank_mask:0xf
    v_cvt_f32_i32 v84, v84
    v_cvt_f32_i32 v85, v85
    v_cvt_f32_i32 v86, v86
    v_cvt_f32_i32 v87, v87
    v_fmac_f32_dpp v20, v6, v84 row_newbcast:1 row_mask:0xf bank_mask:0xf
    v_fmac_f32_dpp v21, v6, v85 row_newbcast:1 row_mask:0xf bank_mask:0xf
    v_fmac_f32_dpp v22, v6, v86 row_newbcast:1 row_mask:0xf bank_mask:0xf
    v_fmac_f32_dpp v23, v6, v87 row_newbcast:1 row_mask:0xf bank_mask:0xf
    buffer_load_dwordx4 v[64:67], v48, s[12:15], 0 offen offset:0 nt
    buffer_load_dwordx4 v[68:71], v48, s[12:15], 0 offen offset:256 nt
    buffer_load_dwordx4 v[72:75], v48, s[12:15], 0 offen offset:512 nt
    buffer_load_dwordx4 v[76:79], v48, s[12:15], 0 offen offset:768 nt
    buffer_load_dwordx4 v[80:83], v48, s[12:15], 0 offen offset:1024 nt
    buffer_load_dwordx4 v[84:87], v48, s[12:15], 0 offen offset:1280 nt
    s_waitcnt vmcnt(12)
    s_cmp_eq_u32 s30, 48
    s_cbranch_scc1 L_el2
L_el2r:
    v_cvt_f32_i32 v88, v88
    v_cvt_f32_i32 v89, v89
    v_cvt_f32_i32 v90, v90
    v_cvt_f32_i32 v91, v91
    v_fmac_f32_dpp v12, v6, v88 row_newbcast:2 row_mask:0xf bank_mask:0xf
    v_fmac_f32_dpp v13, v6, v89 row_newbcast:2 row_mask:0xf bank_mask:0xf
    v_fmac_f32_dpp v14, v6, v90 row_newbcast:2 row_mask:0xf bank_mask:0xf
    v_fmac_f32_dpp v15, v6, v91 row_newbcast:2 row_mask:0xf bank_mask:0xf
    v_cvt_f32_i32 v92, v92
    v_cvt_f32_i32 v93, v93
    v_cvt_f32_i32 v94, v94
    v_cvt_f32_i32 v95, v95
    v_fmac_f32_dpp v16, v6, v92 row_newbcast:2 row_mask:0xf bank_mask:0xf
    v_fmac_f32_dpp v17, v6, v93 row_newbcast:2 row_mask:0xf bank_mask:0xf
    v_fmac_f32_dpp v18, v6, v94 row_newbcast:2 row_mask:0xf bank_mask:0xf
    v_fmac_f32_dpp v19, v6, v95 row_newbcast:2 row_mask:0xf bank_mask:0xf
    v_cvt_f32_i32 v96, v96
    v_cvt_f32_i32 v97, v97
    v_cvt_f32_i32 v98, v98
    v_cvt_f32_i32 v99, v99
    v_fmac_f32_dpp v20, v6, v96 row_newbcast:2 row_mask:0xf bank_mask:0xf
    v_fmac_f32_dpp v21, v6, v97 row_newbcast:2 row_mask:0xf bank_mask:0xf
    v_fmac_f32_dpp v22, v6, v98 row_newbcast:2 row_mask:0xf bank_mask:0xf
    v_fmac_f32_dpp v23, v6, v99 row_newbcast:2 row_mask:0xf bank_mask:0xf
    v_cvt_f32_i32 v100, v100
    v_cvt_f32_i32 v101, v101
    v_cvt_f32_i32 v102, v102
    v_cvt_f32_i32 v103, v103
    v_fmac_f32_dpp v12, v6, v100 row_newbcast:3 row_mask:0xf bank_mask:0xf
    v_fmac_f32_dpp v13, v6, v101 row_newbcast:3 row_mask:0xf bank_mask:0xf
    v_fmac_f32_dpp v14, v6, v102 row_newbcast:3 row_mask:0xf bank_mask:0xf
    v_fmac_f32_dpp v15, v6, v103 row_newbcast:3 row_mask:0xf bank_mask:0xf
    v_cvt_f32_i32 v104, v104
    v_cvt_f32_i32 v105, v105
    v_cvt_f32_i32 v106, v106
    v_cvt_f32_i32 v107, v107
    v_fmac_f32_dpp v16, v6, v104 row_newbcast:3 row_mask:0xf bank_mask:0xf
    v_fmac_f32_dpp v17, v6, v105 row_newbcast:3 row_mask:0xf bank_mask:0xf
    v_fmac_f32_dpp v18, v6, v106 row_newbcast:3 row_mask:0xf bank_mask:0xf
    v_fmac_f32_dpp v19, v6, v107 row_newbcast:3 row_mask:0xf bank_mask:0xf
    v_cvt_f32_i32 v108, v108
    v_cvt_f32_i32 v109, v109
    v_cvt_f32_i32 v110, v110
    v_cvt_f32_i32 v111, v111
    v_fmac_f32_dpp v20, v6, v108 row_newbcast:3 row_mask:0xf bank_mask:0xf
    v_fmac_f32_dpp v21, v6, v109 row_newbcast:3 row_mask:0xf bank_mask:0xf
    v_fmac_f32_dpp v22, v6, v110 row_newbcast:3 row_mask:0xf bank_mask:0xf
    v_fmac_f32_dpp v23, v6, v111 row_newbcast:3 row_mask:0xf bank_mask:0xf
    s_waitcnt vmcnt(6)
    v_cvt_f32_i32 v112, v112
    v_cvt_f32_i32 v113, v113
    v_cvt_f32_i32 v114, v114
    v_cvt_f32_i32 v115, v115
    v_fmac_f32_dpp v12, v6, v112 row_newbcast:4 row_mask:0xf bank_mask:0xf
    v_fmac_f32_dpp v13, v6, v113 row_newbcast:4 row_mask:0xf bank_mask:0xf
    v_fmac_f32_dpp v14, v6, v114 row_newbcast:4 row_mask:0xf bank_mask:0xf
    v_fmac_f32_dpp v15, v6, v115 row_newbcast:4 row_mask:0xf bank_mask:0xf
    v_cvt_f32_i32 v116, v116
    v_cvt_f32_i32 v117, v117
    v_cvt_f32_i32 v118, v118
    v_cvt_f32_i32 v119, v119
    v_fmac_f32_dpp v16, v6, v116 row_newbcast:4 row_mask:0xf bank_mask:0xf
    v_fmac_f32_dpp v17, v6, v117 row_newbcast:4 row_mask:0xf bank_mask:0xf
    v_fmac_f32_dpp v18, v6, v118 row_newbcast:4 row_mask:0xf bank_mask:0xf
    v_fmac_f32_dpp v19, v6, v119 row_newbcast:4 row_mask:0xf bank_mask:0xf
    v_cvt_f32_i32 v120, v120
    v_cvt_f32_i32 v121, v121
    v_cvt_f32_i32 v122, v122
    v_cvt_f32_i32 v123, v123
    v_fmac_f32_dpp v20, v6, v120 row_newbcast:4 row_mask:0xf bank_mask:0xf
    v_fmac_f32_dpp v21, v6, v121 row_newbcast:4 row_mask:0xf bank_mask:0xf
    v_fmac_f32_dpp v22, v6, v122 row_newbcast:4 row_mask:0xf bank_mask:0xf
    v_fmac_f32_dpp v23, v6, v123 row_newbcast:4 row_mask:0xf bank_mask:0xf
    v_cvt_f32_i32 v124, v124
    v_cvt_f32_i32 v125, v125
    v_cvt_f32_i32 v126, v126
    v_cvt_f32_i32 v127, v127
    v_fmac_f32_dpp v12, v6, v124 row_newbcast:5 row_mask:0xf bank_mask:0xf
    v_fmac_f32_dpp v13, v6, v125 row_newbcast:5 row_mask:0xf bank_mask:0xf
    v_fmac_f32_dpp v14, v6, v126 row_newbcast:5 row_mask:0xf bank_mask:0xf
    v_fmac_f32_dpp v15, v6, v127 row_newbcast:5 row_mask:0xf bank_mask:0xf
    v_cvt_f32_i32 v128, v128
    v_cvt_f32_i32 v129, v129
    v_cvt_f32_i32 v130, v130
    v_cvt_f32_i32 v131, v131
    v_fmac_f32_dpp v16, v6, v128 row_newbcast:5 row_mask:0xf bank_mask:0xf
    v_fmac_f32_dpp v17, v6, v129 row_newbcast:5 row_mask:0xf bank_mask:0xf
    v_fmac_f32_dpp v18, v6, v130 row_newbcast:5 row_mask:0xf bank_mask:0xf
    v_fmac_f32_dpp v19, v6, v131 row_newbcast:5 row_mask:0xf bank_mask:0xf
    v_cvt_f32_i32 v132, v132
    v_cvt_f32_i32 v133, v133
    v_cvt_f32_i32 v134, v134
    v_cvt_f32_i32 v135, v135
    v_fmac_f32_dpp v20, v6, v132 row_newbcast:5 row_mask:0xf bank_mask:0xf
    v_fmac_f32_dpp v21, v6, v133 row_newbcast:5 row_mask:0xf bank_mask:0xf
    v_fmac_f32_dpp v22, v6, v134 row_newbcast:5 row_mask:0xf bank_mask:0xf
    v_fmac_f32_dpp v23, v6, v135 row_newbcast:5 row_mask:0xf bank_mask:0xf
    s_waitcnt lgkmcnt(0)
    v_mov_b32 v6, v7
    s_branch L_vchk
L_el0:
    s_nop 1
    v_mov_b32 v11, 1
    s_mov_b64 exec, 1
    ds_add_u32 v53, v11 offset:136
    s_mov_b64 exec, -1
    s_branch L_el0r
L_el1:
    s_nop 1
    v_mov_b32 v11, 1
    s_mov_b64 exec, 1
    ds_add_u32 v53, v11 offset:136
    s_mov_b64 exec, -1
    s_branch L_el1r
L_el2:
    s_nop 1
    v_mov_b32 v11, 1
    s_mov_b64 exec, 1
    ds_add_u32 v53, v11 offset:136
    s_mov_b64 exec, -1
    s_branch L_el2r
L_evK:
    s_nop 1
    s_bitcmp1_b64 s[64:65], s30
    s_cbranch_scc0 L_paK
    s_memrealtime s[60:61]
    s_mov_b32 s72, s59
    v_mov_b32 v11, 1
    s_mov_b64 exec, 1
    ds_add_u32 v53, v11 offset:128
    s_mov_b64 exec, -1
L_paK:
    s_nop 1
    s_bitcmp1_b64 s[66:67], s30
    s_cbranch_scc0 L_pbK
    v_mov_b32 v11, 1
    s_mov_b64 exec, 1
    ds_add_u32 v53, v11 offset:128
    s_mov_b64 exec, -1
L_pbK:
    s_nop 1
    s_bitcmp1_b64 s[68:69], s30
    s_cbranch_scc0 L_pcK
    v_mov_b32 v11, s62
    ds_read_b32 v10, v11
    v_mov_b32 v11, 1
    s_mov_b64 exec, 1
    ds_add_u32 v53, v11 offset:128
    s_mov_b64 exec, -1
    s_add_u32 s62, s62, 4
    s_waitcnt lgkmcnt(0)
    v_readfirstlane_b32 s32, v10
    s_cmp_eq_u32 s32, 0
    s_cbranch_scc1 L_pcK
    s_sub_u32 s32, s60, s32
    s_max_i32 s32, s32, -4096
    s_min_i32 s32, s32, 4096
    s_mul_i32 s32, s32, 8
    s_add_u32 s32, s32, 512
    s_ashr_i32 s32, s32, 10
    s_sub_u32 s32, s32, s72
    s_add_u32 s32, s32, s59
    s_max_i32 s32, s32, 0
    s_min_i32 s59, s32, 6
L_pcK:
    s_nop 1
    s_bitcmp1_b64 s[70:71], s30
    s_cbranch_scc0 L_evretK
    s_and_b32 s32, s30, 15
    s_cbranch_scc0 L_evK2
    s_cmp_eq_u32 s30, 3
    s_cbranch_scc1 L_evK2
    s_lshr_b32 s33, s30, 2
    s_andn2_b32 s33, s33, 3
    s_add_u32 s33, s33, 36
    s_cmp_eq_u32 s32, 1
    s_cselect_b32 s32, s33, 60
    s_cselect_b32 s33, 5376, 0
    v_add_u32 v4, s33, v4
    s_cmp_eq_u32 s30, 2
    s_cselect_b32 s32, 56, s32
    v_mov_b32 v10, s32
    v_mov_b32 v11, 1
    s_mov_b64 exec, 1
    ds_add_u32 v10, v11 offset:0
    s_mov_b64 exec, -1
    s_branch L_evretK
L_evK2:
    s_nop 1
    s_cmp_eq_u32 s30, 16
    s_cbranch_scc0 L_gxtk16
    s_memrealtime s[36:37]
    s_mov_b32 s6, 0x100000
L_wgtk16:
    s_nop 1
    ds_read_b32 v10, v53 offset:208
    s_sub_u32 s6, s6, 1
    s_cbranch_scc1 L_exit1
    s_waitcnt lgkmcnt(0)
    v_readfirstlane_b32 s32, v10
    s_cmp_eq_u32 s32, 0
    s_cbranch_scc1 L_wgtk16
    s_and_b32 s32, s32, 0xffff
    s_cbranch_scc0 L_gxtk16
    s_add_u32 s32, s32, s36
L_gltk16:
    s_nop 1
    s_memrealtime s[36:37]
    s_waitcnt lgkmcnt(0)
    s_sub_u32 s36, s36, s32
    s_cmp_lt_i32 s36, 0
    s_cbranch_scc1 L_gltk16
L_gxtk16:
    s_nop 1
    s_cmp_eq_u32 s30, 32
    s_cbranch_scc0 L_gxtk32
    s_memrealtime s[36:37]
    s_mov_b32 s6, 0x100000
L_wgtk32:
    s_nop 1
    ds_read_b32 v10, v53 offset:212
    s_sub_u32 s6, s6, 1
    s_cbranch_scc1 L_exit1
    s_waitcnt lgkmcnt(0)
    v_readfirstlane_b32 s32, v10
    s_cmp_eq_u32 s32, 0
    s_cbranch_scc1 L_wgtk32
    s_and_b32 s32, s32, 0xffff
    s_cbranch_scc0 L_gxtk32
    s_add_u32 s32, s32, s36
L_gltk32:
    s_nop 1
    s_memrealtime s[36:37]
    s_waitcnt lgkmcnt(0)
    s_sub_u32 s36, s36, s32
    s_cmp_lt_i32 s36, 0
    s_cbranch_scc1 L_gltk32
L_gxtk32:
    s_nop 1
    s_lshr_b32 s33, s30, 4
    s_lshl_b32 s34, s33, 2
    v_mov_b32 v11, s34
    s_lshl_b32 s31, s33, 5
    s_add_u32 s31, s31, s3
    s_mul_i32 s31, s31, 171
    s_lshr_b32 s31, s31, 9
    s_mul_i32 s31, s31, 384
    buffer_load_dwordx2 v[36:37], v3, s[20:23], s31 offen offset:0
    buffer_load_dwordx2 v[38:39], v3, s[20:23], s31 offen offset:128
    buffer_load_dwordx2 v[40:41], v3, s[20:23], s31 offen offset:256
    s_mov_b32 s6, 0x100000
L_wtk:
    s_nop 1
    ds_read_b32 v10, v11 offset:0
    s_sub_u32 s6, s6, 1
    s_cbranch_scc1 L_exit1
    s_waitcnt lgkmcnt(0)
    v_readfirstlane_b32 s32, v10
    s_cmp_eq_u32 s32, 0
    s_cbranch_scc1 L_wtk
    s_and_b32 s5, s32, 7
    s_xor_b32 s5, s5, s48
    s_bitcmp1_b32 s32, 3
    s_cselect_b64 vcc, -1, 0
    v_cndmask_b32 v50, v62, v63, vcc
    s_branch L_evretK
L_evV:
    s_nop 1
    s_bitcmp1_b64 s[64:65], s30
    s_cbranch_scc0 L_paV
    s_memrealtime s[60:61]
    s_mov_b32 s72, s59
    v_mov_b32 v11, 1
    s_mov_b64 exec, 1
    ds_add_u32 v53, v11 offset:128
    s_mov_b64 exec, -1
L_paV:
    s_nop 1
    s_bitcmp1_b64 s[66:67], s30
    s_cbranch_scc0 L_pbV
    v_mov_b32 v11, 1
    s_mov_b64 exec, 1
    ds_add_u32 v53, v11 offset:128
    s_mov_b64 exec, -1
L_pbV:
    s_nop 1
    s_bitcmp1_b64 s[68:69], s30
    s_cbranch_scc0 L_pcV
    v_mov_b32 v11, s62
    ds_read_b32 v10, v11
    v_mov_b32 v11, 1
    s_mov_b64 exec, 1
    ds_add_u32 v53, v11 offset:128
    s_mov_b64 exec, -1
    s_add_u32 s62, s62, 4
    s_waitcnt lgkmcnt(0)
    v_readfirstlane_b32 s32, v10
    s_cmp_eq_u32 s32, 0
    s_cbranch_scc1 L_pcV
    s_sub_u32 s32, s60, s32
    s_max_i32 s32, s32, -4096
    s_min_i32 s32, s32, 4096
    s_cmp_eq_u32 s30, 44
    s_cbranch_scc0 L_pd
    s_mul_i32 s32, s32, 9
    s_add_u32 s32, s32, 2048
    s_ashr_i32 s32, s32, 10
    s_max_i32 s32, s32, 0
    s_min_i32 s32, s32, 4
    s_sub_u32 s49, 48, s32
    s_cmp_eq_u32 s49, 48
    s_cselect_b32 s49, 255, s49
    s_mov_b32 s59, 0
    s_branch L_pcV
L_pd:
    s_nop 1
    s_mul_i32 s32, s32, 8
    s_add_u32 s32, s32, 512
    s_ashr_i32 s32, s32, 10
    s_sub_u32 s32, s32, s72
    s_add_u32 s32, s32, s59
    s_max_i32 s32, s32, 0
    s_min_i32 s59, s32, 6
L_pcV:
    s_nop 1
    s_bitcmp1_b64 s[70:71], s30
    s_cbranch_scc0 L_evretV
    s_cmp_eq_u32 s30, 16
    s_cbranch_scc0 L_gxtv264
    s_memrealtime s[36:37]
    s_mov_b32 s6, 0x100000
L_wgtv264:
    s_nop 1
    ds_read_b32 v10, v53 offset:220
    s_sub_u32 s6, s6, 1
    s_cbranch_scc1 L_exit1
    s_waitcnt lgkmcnt(0)
    v_readfirstlane_b32 s32, v10
    s_cmp_eq_u32 s32, 0
    s_cbranch_scc1 L_wgtv264
    s_and_b32 s32, s32, 0xffff
    s_cbranch_scc0 L_gxtv264
    s_add_u32 s32, s32, s36
L_gltv264:
    s_nop 1
    s_memrealtime s[36:37]
    s_waitcnt lgkmcnt(0)
    s_sub_u32 s36, s36, s32
    s_cmp_lt_i32 s36, 0
    s_cbranch_scc1 L_gltv264
L_gxtv264:
    s_nop 1
    s_cmp_eq_u32 s30, 32
    s_cbranch_scc0 L_gxtv280
    s_memrealtime s[36:37]
    s_mov_b32 s6, 0x100000
L_wgtv280:
    s_nop 1
    ds_read_b32 v10, v53 offset:224
    s_sub_u32 s6, s6, 1
    s_cbranch_scc1 L_exit1
    s_waitcnt lgkmcnt(0)
    v_readfirstlane_b32 s32, v10
    s_cmp_eq_u32 s32, 0
    s_cbranch_scc1 L_wgtv280
    s_and_b32 s32, s32, 0xffff
    s_cbranch_scc0 L_gxtv280
    s_add_u32 s32, s32, s36
L_gltv280:
    s_nop 1
    s_memrealtime s[36:37]
    s_waitcnt lgkmcnt(0)
    s_sub_u32 s36, s36, s32
    s_cmp_lt_i32 s36, 0
    s_cbranch_scc1 L_gltv280
L_gxtv280:
    s_nop 1
    s_lshr_b32 s33, s30, 4
    s_lshl_b32 s34, s33, 2
    v_mov_b32 v11, s34
    s_mov_b32 s6, 0x100000
L_wtv2:
    s_nop 1
    ds_read_b32 v10, v11 offset:24
    s_sub_u32 s6, s6, 1
    s_cbranch_scc1 L_exit1
    s_waitcnt lgkmcnt(0)
    v_readfirstlane_b32 s32, v10
    s_cmp_eq_u32 s32, 0
    s_cbranch_scc1 L_wtv2
    s_and_b32 s5, s32, 7
    s_xor_b32 s5, s5, s48
    s_bitcmp1_b32 s32, 3
    s_cselect_b64 vcc, -1, 0
    v_cndmask_b32 v50, v62, v63, vcc
    s_branch L_evretV
L_evKB:
    s_nop 1
    s_bitcmp1_b64 s[64:65], s30
    s_cbranch_scc0 L_paKB
    s_memrealtime s[60:61]
    s_mov_b32 s72, s59
    v_mov_b32 v11, 1
    s_mov_b64 exec, 1
    ds_add_u32 v53, v11 offset:128
    s_mov_b64 exec, -1
L_paKB:
    s_nop 1
    s_bitcmp1_b64 s[66:67], s30
    s_cbranch_scc0 L_pbKB
    v_mov_b32 v11, 1
    s_mov_b64 exec, 1
    ds_add_u32 v53, v11 offset:128
    s_mov_b64 exec, -1
L_pbKB:
    s_nop 1
    s_bitcmp1_b64 s[68:69], s30
    s_cbranch_scc0 L_pcKB
    v_mov_b32 v11, s62
    ds_read_b32 v10, v11
    v_mov_b32 v11, 1
    s_mov_b64 exec, 1
    ds_add_u32 v53, v11 offset:128
    s_mov_b64 exec, -1
    s_add_u32 s62, s62, 4
    s_waitcnt lgkmcnt(0)
    v_readfirstlane_b32 s32, v10
    s_cmp_eq_u32 s32, 0
    s_cbranch_scc1 L_pcKB
    s_sub_u32 s32, s60, s32
    s_max_i32 s32, s32, -4096
    s_min_i32 s32, s32, 4096
    s_mul_i32 s32, s32, 8
    s_add_u32 s32, s32, 512
    s_ashr_i32 s32, s32, 10
    s_sub_u32 s32, s32, s72
    s_add_u32 s32, s32, s59
    s_max_i32 s32, s32, 0
    s_min_i32 s59, s32, 6
L_pcKB:
    s_nop 1
    s_bitcmp1_b64 s[70:71], s30
    s_cbranch_scc0 L_evretKB
    s_and_b32 s32, s30, 15
    s_cbranch_scc0 L_evK2B
    s_cmp_eq_u32 s30, 3
    s_cbranch_scc1 L_evK2B
    s_lshr_b32 s33, s30, 2
    s_andn2_b32 s33, s33, 3
    s_add_u32 s33, s33, 36
    s_cmp_eq_u32 s32, 1
    s_cselect_b32 s32, s33, 60
    s_cselect_b32 s33, 5376, 0
    v_add_u32 v4, s33, v4
    s_cmp_eq_u32 s30, 2
    s_cselect_b32 s32, 56, s32
    v_mov_b32 v10, s32
    v_mov_b32 v11, 1
    s_mov_b64 exec, 1
    ds_add_u32 v10, v11 offset:0
    s_mov_b64 exec, -1
    s_branch L_evretKB
L_evK2B:
    s_nop 1
    s_cmp_eq_u32 s30, 16
    s_cbranch_scc0 L_gxtkB16
    s_memrealtime s[36:37]
    s_mov_b32 s6, 0x100000
L_wgtkB16:
    s_nop 1
    ds_read_b32 v10, v53 offset:208
    s_sub_u32 s6, s6, 1
    s_cbranch_scc1 L_exit1
    s_waitcnt lgkmcnt(0)
    v_readfirstlane_b32 s32, v10
    s_cmp_eq_u32 s32, 0
    s_cbranch_scc1 L_wgtkB16
    s_and_b32 s32, s32, 0xffff
    s_cbranch_scc0 L_gxtkB16
    s_add_u32 s32, s32, s36
L_gltkB16:
    s_nop 1
    s_memrealtime s[36:37]
    s_waitcnt lgkmcnt(0)
    s_sub_u32 s36, s36, s32
    s_cmp_lt_i32 s36, 0
    s_cbranch_scc1 L_gltkB16
L_gxtkB16:
    s_nop 1
    s_cmp_eq_u32 s30, 32
    s_cbranch_scc0 L_gxtkB32
    s_memrealtime s[36:37]
    s_mov_b32 s6, 0x100000
L_wgtkB32:
    s_nop 1
    ds_read_b32 v10, v53 offset:212
    s_sub_u32 s6, s6, 1
    s_cbranch_scc1 L_exit1
    s_waitcnt lgkmcnt(0)
    v_readfirstlane_b32 s32, v10
    s_cmp_eq_u32 s32, 0
    s_cbranch_scc1 L_wgtkB32
    s_and_b32 s32, s32, 0xffff
    s_cbranch_scc0 L_gxtkB32
    s_add_u32 s32, s32, s36
L_gltkB32:
    s_nop 1
    s_memrealtime s[36:37]
    s_waitcnt lgkmcnt(0)
    s_sub_u32 s36, s36, s32
    s_cmp_lt_i32 s36, 0
    s_cbranch_scc1 L_gltkB32
L_gxtkB32:
    s_nop 1
    s_lshr_b32 s33, s30, 4
    s_lshl_b32 s34, s33, 2
    v_mov_b32 v11, s34
    s_lshl_b32 s31, s33, 5
    s_add_u32 s31, s31, s3
    s_mul_i32 s31, s31, 171
    s_lshr_b32 s31, s31, 9
    s_mul_i32 s31, s31, 384
    buffer_load_dwordx2 v[36:37], v3, s[20:23], s31 offen offset:0
    buffer_load_dwordx2 v[38:39], v3, s[20:23], s31 offen offset:128
    buffer_load_dwordx2 v[40:41], v3, s[20:23], s31 offen offset:256
    s_mov_b32 s6, 0x100000
L_wtkB:
    s_nop 1
    ds_read_b32 v10, v11 offset:0
    s_sub_u32 s6, s6, 1
    s_cbranch_scc1 L_exit1
    s_waitcnt lgkmcnt(0)
    v_readfirstlane_b32 s32, v10
    s_cmp_eq_u32 s32, 0
    s_cbranch_scc1 L_wtkB
    s_and_b32 s5, s32, 7
    s_xor_b32 s5, s5, s48
    s_bitcmp1_b32 s32, 3
    s_cselect_b64 vcc, -1, 0
    v_cndmask_b32 v50, v62, v63, vcc
    s_branch L_evretKB
L_evVB:
    s_nop 1
    s_bitcmp1_b64 s[64:65], s30
    s_cbranch_scc0 L_paVB
    s_memrealtime s[60:61]
    s_mov_b32 s72, s59
    v_mov_b32 v11, 1
    s_mov_b64 exec, 1
    ds_add_u32 v53, v11 offset:128
    s_mov_b64 exec, -1
L_paVB:
    s_nop 1
    s_bitcmp1_b64 s[66:67], s30
    s_cbranch_scc0 L_pbVB
    v_mov_b32 v11, 1
    s_mov_b64 exec, 1
    ds_add_u32 v53, v11 offset:128
    s_mov_b64 exec, -1
L_pbVB:
    s_nop 1
    s_bitcmp1_b64 s[68:69], s30
    s_cbranch_scc0 L_pcVB
    v_mov_b32 v11, s62
    ds_read_b32 v10, v11
    v_mov_b32 v11, 1
    s_mov_b64 exec, 1
    ds_add_u32 v53, v11 offset:128
    s_mov_b64 exec, -1
    s_add_u32 s62, s62, 4
    s_waitcnt lgkmcnt(0)
    v_readfirstlane_b32 s32, v10
    s_cmp_eq_u32 s32, 0
    s_cbranch_scc1 L_pcVB
    s_sub_u32 s32, s60, s32
    s_max_i32 s32, s32, -4096
    s_min_i32 s32, s32, 4096
    s_cmp_eq_u32 s30, 44
    s_cbranch_scc0 L_pdB
    s_mul_i32 s32, s32, 9
    s_add_u32 s32, s32, 2048
    s_ashr_i32 s32, s32, 10
    s_max_i32 s32, s32, 0
    s_min_i32 s32, s32, 4
    s_sub_u32 s49, 48, s32
    s_cmp_eq_u32 s49, 48
    s_cselect_b32 s49, 255, s49
    s_mov_b32 s59, 0
    s_branch L_pcVB
L_pdB:
    s_nop 1
    s_mul_i32 s32, s32, 8
    s_add_u32 s32, s32, 512
    s_ashr_i32 s32, s32, 10
    s_sub_u32 s32, s32, s72
    s_add_u32 s32, s32, s59
    s_max_i32 s32, s32, 0
    s_min_i32 s59, s32, 6
L_pcVB:
    s_nop 1
    s_bitcmp1_b64 s[70:71], s30
    s_cbranch_scc0 L_evretVB
    s_cmp_eq_u32 s30, 16
    s_cbranch_scc0 L_gxtv2B64
    s_memrealtime s[36:37]
    s_mov_b32 s6, 0x100000
L_wgtv2B64:
    s_nop 1
    ds_read_b32 v10, v53 offset:220
    s_sub_u32 s6, s6, 1
    s_cbranch_scc1 L_exit1
    s_waitcnt lgkmcnt(0)
    v_readfirstlane_b32 s32, v10
    s_cmp_eq_u32 s32, 0
    s_cbranch_scc1 L_wgtv2B64
    s_and_b32 s32, s32, 0xffff
    s_cbranch_scc0 L_gxtv2B64
    s_add_u32 s32, s32, s36
L_gltv2B64:
    s_nop 1
    s_memrealtime s[36:37]
    s_waitcnt lgkmcnt(0)
    s_sub_u32 s36, s36, s32
    s_cmp_lt_i32 s36, 0
    s_cbranch_scc1 L_gltv2B64
L_gxtv2B64:
    s_nop 1
    s_cmp_eq_u32 s30, 32
    s_cbranch_scc0 L_gxtv2B80
    s_memrealtime s[36:37]
    s_mov_b32 s6, 0x100000
L_wgtv2B80:
    s_nop 1
    ds_read_b32 v10, v53 offset:224
    s_sub_u32 s6, s6, 1
    s_cbranch_scc1 L_exit1
    s_waitcnt lgkmcnt(0)
    v_readfirstlane_b32 s32, v10
    s_cmp_eq_u32 s32, 0
    s_cbranch_scc1 L_wgtv2B80
    s_and_b32 s32, s32, 0xffff
    s_cbranch_scc0 L_gxtv2B80
    s_add_u32 s32, s32, s36
L_gltv2B80:
    s_nop 1
    s_memrealtime s[36:37]
    s_waitcnt lgkmcnt(0)
    s_sub_u32 s36, s36, s32
    s_cmp_lt_i32 s36, 0
    s_cbranch_scc1 L_gltv2B80
L_gxtv2B80:
    s_nop 1
    s_lshr_b32 s33, s30, 4
    s_lshl_b32 s34, s33, 2
    v_mov_b32 v11, s34
    s_mov_b32 s6, 0x100000
L_wtv2B:
    s_nop 1
    ds_read_b32 v10, v11 offset:24
    s_sub_u32 s6, s6, 1
    s_cbranch_scc1 L_exit1
    s_waitcnt lgkmcnt(0)
    v_readfirstlane_b32 s32, v10
    s_cmp_eq_u32 s32, 0
    s_cbranch_scc1 L_wtv2B
    s_and_b32 s5, s32, 7
    s_xor_b32 s5, s5, s48
    s_bitcmp1_b32 s32, 3
    s_cselect_b64 vcc, -1, 0
    v_cndmask_b32 v50, v62, v63, vcc
    s_branch L_evretVB
L_helper:
    s_nop 1
    s_sub_u32 s6, s28, 4
    s_mov_b32 s5, s48
    v_and_b32 v1, 63, v0
    v_mov_b32 v2, 0
    s_mul_i32 s59, s3, 34816
    s_add_u32 s59, s59, 8388608
    s_cmp_eq_u32 s6, 3
    s_cbranch_scc1 L_h3
    s_mul_i32 s48, s6, 25
    s_sub_u32 s48, s48, 22
    s_cmp_lt_i32 s3, s48
    s_cselect_b32 s90, 1, 0
    s_cbranch_scc0 L_noprobe1
    s_add_u32 s49, s3, 2
    s_mul_i32 s48, s49, 205
    s_lshr_b32 s48, s48, 10
    s_mul_i32 s7, s48, 5
    s_sub_u32 s7, s49, s7
    s_add_u32 s7, s7, 1
    s_lshl_b32 s49, s3, 1
    s_add_u32 s49, s49, s6
    s_sub_u32 s49, s49, 1
    s_cmp_lt_u32 s3, 3
    s_cselect_b32 s7, 0, s7
    s_cselect_b32 s49, s49, s48
    s_and_b32 s48, s49, 1
    s_mul_i32 s20, s49, 20
    s_add_u32 s20, s20, s48
    s_add_u32 s20, s20, 2
    s_lshr_b32 s91, s20, 5
    s_xor_b32 s91, s91, s4
    s_lshl_b32 s20, s20, 21
    s_xor_b32 s21, s4, s6
    s_and_b32 s21, s21, 1
    s_lshr_b32 s49, s4, 2
    s_xor_b32 s48, s48, s49
    s_xor_b32 s48, s48, s21
    s_lshl_b32 s48, s48, 13
    s_lshl_b32 s49, s6, 14
    s_and_b32 s49, s49, 0x4000
    s_or_b32 s48, s48, s49
    s_xor_b32 s32, s48, 0x0
    s_xor_b32 s33, s48, 0x2000
    s_xor_b32 s34, s48, 0x1000
    s_xor_b32 s35, s48, 0x3000
    s_xor_b32 s36, s48, 0x4000
    s_xor_b32 s37, s48, 0x6000
    s_xor_b32 s38, s48, 0x5000
    s_xor_b32 s39, s48, 0x7000
    v_and_b32 v3, 7, v1
    v_lshlrev_b32 v3, 12, v3
    s_lshl_b32 s48, s4, 8
    v_add_u32 v3, s48, v3
    s_mov_b32 s10, 805306368
    s_mov_b32 s11, 0x00020000
    s_cmp_ge_u32 s7, 3
    s_cselect_b32 s48, 3, 0
    s_sub_u32 s48, s7, s48
    s_lshl_b32 s48, s48, 28
    s_add_u32 s20, s20, s48
    s_cmp_ge_u32 s7, 3
    s_waitcnt lgkmcnt(0)
    s_cselect_b32 s8, s68, s66
    s_cselect_b32 s23, s69, s67
    s_and_b32 s9, s23, 0xffff
    s_add_u32 s22, s8, s20
    s_addc_u32 s23, s23, 0
    s_lshl_b32 s48, s4, 8
    s_add_u32 s56, s22, s48
    s_addc_u32 s57, s23, 0
    s_load_dword s24, s[56:57], 0x0
    s_load_dword s25, s[56:57], 0x1000
    s_load_dword s26, s[56:57], 0x2000
    s_load_dword s27, s[56:57], 0x3000
    s_load_dword s28, s[56:57], 0x4000
    s_load_dword s29, s[56:57], 0x5000
    s_load_dword s30, s[56:57], 0x6000
    s_load_dword s31, s[56:57], 0x7000
    s_mov_b32 s12, s82
    s_and_b32 s13, s83, 0xffff
    s_mov_b32 s14, 10485760
    s_mov_b32 s15, 0x00020000
    s_lshl_b32 s48, s2, 1
    s_add_u32 s48, s48, s6
    s_mul_i32 s48, s48, 26112
    s_add_u32 s48, s48, 8362496
    v_mul_u32_u24 v5, 4352, v1
    v_mov_b32 v3, 0
    v_mov_b32 v4, 0
    s_cmp_eq_u32 s7, 0
    s_cselect_b64 exec, 0x3f, 0
    buffer_store_dwordx3 v[2:4], v5, s[12:15], s48 offen sc1
    s_mov_b64 exec, -1
    s_cmp_lg_u32 s7, 0
    s_cbranch_scc1 L_noprobe2
L_noprobe1:
    s_nop 1
    s_waitcnt lgkmcnt(0)
L_noprobe2:
    s_nop 1
    s_mov_b32 s12, s82
    s_and_b32 s13, s83, 0xffff
    s_mov_b32 s14, 10485760
    s_mov_b32 s15, 0x00020000
    s_mov_b32 s16, s80
    s_and_b32 s17, s81, 0xffff
    s_mov_b32 s18, 256
    s_mov_b32 s19, 0x00020000
    s_cmp_lg_u32 s6, 0
    s_cbranch_scc1 L_hbar
    v_lshlrev_b32 v5, 2, v1
    ds_write_b32 v5, v2
    s_waitcnt lgkmcnt(0)
L_hbar:
    s_nop 1
    s_barrier
    s_cmp_eq_u32 s90, 0
    s_cbranch_scc1 L_role
    s_mov_b32 s46, 1
    s_mov_b32 s58, 0
    s_mov_b32 s61, 0
    s_mov_b32 s62, 0
    s_mov_b32 s63, 0
    s_cmp_eq_u32 s7, 0
    s_cselect_b32 s47, 1, 7
    s_waitcnt lgkmcnt(0)
L_round:
    s_nop 1
    s_add_u32 s48, s4, s46
    s_and_b32 s48, s48, 7
    s_lshl_b32 s48, s48, 8
    s_add_u32 s56, s22, s48
    s_addc_u32 s57, s23, 0
    s_mov_b32 s44, -1
    s_memtime s[40:41]
    s_waitcnt lgkmcnt(0)
    s_load_dword s45, s[56:57], s32
    s_waitcnt lgkmcnt(0)
    s_memtime s[42:43]
    s_waitcnt lgkmcnt(0)
    s_sub_u32 s24, s42, s40
    s_load_dword s45, s[56:57], s33
    s_waitcnt lgkmcnt(0)
    s_memtime s[40:41]
    s_waitcnt lgkmcnt(0)
    s_sub_u32 s25, s40, s42
    s_load_dword s45, s[56:57], s34
    s_waitcnt lgkmcnt(0)
    s_memtime s[42:43]
    s_waitcnt lgkmcnt(0)
    s_sub_u32 s26, s42, s40
    s_load_dword s45, s[56:57], s35
    s_waitcnt lgkmcnt(0)
    s_memtime s[40:41]
    s_waitcnt lgkmcnt(0)
    s_sub_u32 s27, s40, s42
    s_mov_b32 s28, -1
    s_mov_b32 s29, -1
    s_mov_b32 s30, -1
    s_mov_b32 s31, -1
    s_cmp_eq_u32 s7, 0
    s_cbranch_scc1 L_few
    s_load_dword s45, s[56:57], s36
    s_waitcnt lgkmcnt(0)
    s_memtime s[42:43]
    s_waitcnt lgkmcnt(0)
    s_sub_u32 s28, s42, s40
    s_load_dword s45, s[56:57], s37
    s_waitcnt lgkmcnt(0)
    s_memtime s[40:41]
    s_waitcnt lgkmcnt(0)
    s_sub_u32 s29, s40, s42
    s_load_dword s45, s[56:57], s38
    s_waitcnt lgkmcnt(0)
    s_memtime s[42:43]
    s_waitcnt lgkmcnt(0)
    s_sub_u32 s30, s42, s40
    s_load_dword s45, s[56:57], s39
    s_waitcnt lgkmcnt(0)
    s_memtime s[40:41]
    s_waitcnt lgkmcnt(0)
    s_sub_u32 s31, s40, s42
L_few:
    s_nop 1
    s_min_u32 s24, s24, 1400
    s_min_u32 s44, s44, s24
    s_min_u32 s25, s25, 1400
    s_min_u32 s44, s44, s25
    s_min_u32 s26, s26, 1400
    s_min_u32 s44, s44, s26
    s_min_u32 s27, s27, 1400
    s_min_u32 s44, s44, s27
    s_min_u32 s28, s28, 1400
    s_min_u32 s44, s44, s28
    s_min_u32 s29, s29, 1400
    s_min_u32 s44, s44, s29
    s_min_u32 s30, s30, 1400
    s_min_u32 s44, s44, s30
    s_min_u32 s31, s31, 1400
    s_min_u32 s44, s44, s31
    s_cmp_lt_u32 s44, 290
    s_cbranch_scc1 L_skip
    s_sub_u32 s58, s58, s24
    s_add_u32 s58, s58, s25
    s_sub_u32 s58, s58, s26
    s_add_u32 s58, s58, s27
    s_sub_u32 s58, s58, s28
    s_add_u32 s58, s58, s29
    s_sub_u32 s58, s58, s30
    s_add_u32 s58, s58, s31
    s_cmp_eq_u32 s7, 0
    s_cbranch_scc1 L_skip
    s_min_u32 s48, s24, s26
    s_min_u32 s50, s28, s30
    s_min_u32 s48, s48, s50
    s_add_u32 s48, s48, 100
    s_min_u32 s49, s25, s27
    s_min_u32 s50, s29, s31
    s_min_u32 s49, s49, s50
    s_add_u32 s49, s49, 100
    s_min_u32 s24, s24, s48
    s_min_u32 s25, s25, s49
    s_min_u32 s26, s26, s48
    s_min_u32 s27, s27, s49
    s_min_u32 s28, s28, s48
    s_min_u32 s29, s29, s49
    s_min_u32 s30, s30, s48
    s_min_u32 s31, s31, s49
    s_sub_u32 s61, s61, s24
    s_sub_u32 s62, s62, s24
    s_sub_u32 s63, s63, s24
    s_add_u32 s61, s61, s25
    s_sub_u32 s62, s62, s25
    s_add_u32 s63, s63, s25
    s_add_u32 s61, s61, s26
    s_sub_u32 s62, s62, s26
    s_sub_u32 s63, s63, s26
    s_sub_u32 s61, s61, s27
    s_sub_u32 s62, s62, s27
    s_add_u32 s63, s63, s27
    s_sub_u32 s61, s61, s28
    s_add_u32 s62, s62, s28
    s_add_u32 s63, s63, s28
    s_add_u32 s61, s61, s29
    s_add_u32 s62, s62, s29
    s_sub_u32 s63, s63, s29
    s_add_u32 s61, s61, s30
    s_add_u32 s62, s62, s30
    s_add_u32 s63, s63, s30
    s_sub_u32 s61, s61, s31
    s_add_u32 s62, s62, s31
    s_sub_u32 s63, s63, s31
L_skip:
    s_nop 1
    s_add_u32 s46, s46, 1
    s_cmp_le_u32 s46, s47
    s_cbranch_scc1 L_round
    s_sub_u32 s48, 0, s58
    s_cmp_eq_u32 s21, 0
    s_cselect_b32 s58, s58, s48
    s_add_u32 s58, s58, 0x1010000
    v_mov_b32 v4, s58
    s_mov_b64 exec, 1
    s_lshl_b32 s48, s7, 2
    s_add_u32 s48, s48, 124
    s_cmp_eq_u32 s7, 0
    s_cbranch_scc0 L_post
    s_waitcnt vmcnt(0)
    ds_add_rtn_u32 v5, v2, v4 offset:36
    s_mov_b32 s48, 0
    s_waitcnt lgkmcnt(0)
    v_add_u32 v4, v4, v5
    v_cmp_ne_u32 vcc, 0, v5
    s_and_b64 exec, exec, vcc
    buffer_atomic_add v4, off, s[16:19], s48
    s_branch L_posted
L_post:
    s_nop 1
    s_mov_b32 s60, 0x100000
L_wvw:
    s_nop 1
    ds_read_b32 v10, v2 offset:0
    s_sub_u32 s60, s60, 1
    s_cbranch_scc1 L_exit1
    s_waitcnt lgkmcnt(0)
    v_readfirstlane_b32 s48, v10
    s_cmp_eq_u32 s48, 0
    s_cbranch_scc1 L_wvw
    s_lshr_b32 s48, s91, 1
    s_xor_b32 s48, s48, s21
    s_sub_u32 s49, 0, s61
    s_bitcmp1_b32 s48, 0
    s_cselect_b32 s61, s49, s61
    s_xor_b32 s48, s91, s21
    s_bitcmp1_b32 s4, 0
    s_cselect_b32 s48, s91, s48
    s_cselect_b32 s62, s62, s63
    s_sub_u32 s49, 0, s62
    s_bitcmp1_b32 s48, 0
    s_cselect_b32 s62, s49, s62
    s_add_u32 s61, s61, 0x1010000
    v_writelane_b32 v4, s61, 1
    s_add_u32 s62, s62, 0x1010000
    v_writelane_b32 v4, s62, 2
    s_lshl_b32 s48, s7, 2
    s_and_b32 s49, s4, 1
    s_or_b32 s48, s48, s49
    s_lshr_b32 s49, s4, 1
    s_and_b32 s49, s49, 2
    s_or_b32 s48, s48, s49
    s_mul_i32 s48, s48, 4352
    s_add_u32 s48, s48, 9485312
    s_mov_b64 exec, 7
    v_lshlrev_b32 v5, 2, v1
    buffer_atomic_add v4, v5, s[12:15], s48 offen
L_posted:
    s_nop 1
    s_mov_b64 exec, -1
L_role:
    s_nop 1
    s_cmp_eq_u32 s6, 0
    s_cbranch_scc1 L_h0
    s_cmp_eq_u32 s6, 2
    s_cbranch_scc1 L_h2
    v_lshlrev_b32 v5, 2, v1
    s_mov_b32 s60, 0x100000
L_wea:
    s_nop 1
    ds_read_b32 v10, v2 offset:56
    s_sub_u32 s60, s60, 1
    s_cbranch_scc1 L_exit1
    s_waitcnt lgkmcnt(0)
    v_readfirstlane_b32 s48, v10
    s_cmp_lt_u32 s48, 4
    s_cbranch_scc1 L_wea
    s_mov_b64 exec, 0x1
    s_mov_b32 s60, 0x40000
L_polla:
    s_nop 1
    buffer_load_dword v4, v5, s[16:19], 0 offen offset:0 sc1
    s_sub_u32 s60, s60, 1
    s_cbranch_scc1 L_exit1
L_pollwa:
    s_waitcnt vmcnt(0)
    v_lshrrev_b32 v6, 24, v4
    v_cmp_ne_u32 vcc, 48, v6
    s_cbranch_vccnz L_polla
    v_and_b32 v4, 0xffffff, v4
    v_subrev_u32 v4, 3145728, v4
    v_lshrrev_b32 v6, 30, v4
    v_and_b32 v6, 2, v6
    v_add_u32 v4, 4800, v4
    v_cmp_gt_u32 vcc, 9600, v4
    s_nop 1
    v_cndmask_b32 v6, v6, 8, vcc
    v_or_b32 v6, 16, v6
    ds_write_b32 v5, v6 offset:0
    s_mov_b64 exec, -1
    v_readfirstlane_b32 s44, v6
    s_mov_b32 s60, 0x100000
L_web:
    s_nop 1
    ds_read_b32 v10, v2 offset:60
    s_sub_u32 s60, s60, 1
    s_cbranch_scc1 L_exit1
    s_waitcnt lgkmcnt(0)
    v_readfirstlane_b32 s48, v10
    s_cmp_eq_u32 s48, 0
    s_cbranch_scc1 L_web
    v_mul_u32_u24 v7, 4352, v1
    s_mov_b32 s48, 9502720
    s_mov_b64 exec, 0xfffff
    s_mov_b32 s60, 0x40000
L_pollb:
    s_nop 1
    buffer_load_dwordx3 v[16:18], v7, s[12:15], s48 offen sc1
    s_sub_u32 s60, s60, 1
    s_cbranch_scc1 L_exit1
    s_waitcnt vmcnt(0)
    v_min3_u32 v6, v16, v17, v18
    v_lshrrev_b32 v6, 24, v6
    v_cmp_ne_u32 vcc, 10, v6
    s_cbranch_vccnz L_pollb
    v_subrev_u32 v16, 0xa0a0000, v16
    v_subrev_u32 v17, 0xa0a0000, v17
    v_subrev_u32 v18, 0xa0a0000, v18
    v_add_u32_dpp v16, v16, v16 quad_perm:[1,0,3,2] row_mask:0xf bank_mask:0xf
    v_add_u32_dpp v17, v17, v17 quad_perm:[1,0,3,2] row_mask:0xf bank_mask:0xf
    s_nop 0
    v_add_u32_dpp v16, v16, v16 quad_perm:[2,3,0,1] row_mask:0xf bank_mask:0xf
    v_add_u32_dpp v17, v17, v17 quad_perm:[2,3,0,1] row_mask:0xf bank_mask:0xf
    v_ashrrev_i32 v6, 31, v16
    v_xor_b32 v17, v17, v6
    v_xor_b32 v4, v18, v6
    s_mov_b64 vcc, 0x55555
    v_cndmask_b32 v18, v18, v4, vcc
    s_nop 1
    v_add_u32_dpp v18, v18, v18 quad_perm:[1,0,3,2] row_mask:0xf bank_mask:0xf
    s_nop 1
    v_add_u32_dpp v18, v18, v18 quad_perm:[2,3,0,1] row_mask:0xf bank_mask:0xf
    v_and_b32 v20, 2, v6
    v_or_b32 v4, 1, v20
    v_cmp_gt_i32 vcc, -2800, v17
    s_nop 1
    v_cndmask_b32 v20, v20, v4, vcc
    v_or_b32 v4, 4, v20
    v_cmp_gt_i32 vcc, -2800, v18
    s_nop 1
    v_cndmask_b32 v20, v20, v4, vcc
    v_add_u32 v4, 56000, v16
    v_cmp_gt_u32 vcc, 112000, v4
    s_nop 1
    v_cndmask_b32 v20, v20, 8, vcc
    v_and_b32 v20, 15, v20
    s_nop 0
    v_readlane_b32 s24, v20, 0
    v_readlane_b32 s25, v20, 4
    v_readlane_b32 s26, v20, 8
    v_readlane_b32 s27, v20, 12
    v_readlane_b32 s28, v20, 16
    s_xor_b32 s48, s44, s26
    s_and_b32 s48, s48, 15
    s_and_b32 s49, s48, 14
    s_cselect_b32 s48, 0, s48
    s_xor_b32 s49, s24, s48
    s_bitcmp1_b32 s24, 3
    s_cselect_b32 s24, s24, s49
    s_xor_b32 s49, s25, s48
    s_bitcmp1_b32 s25, 3
    s_cselect_b32 s25, s25, s49
    s_xor_b32 s49, s26, s48
    s_bitcmp1_b32 s26, 3
    s_cselect_b32 s26, s26, s49
    s_xor_b32 s49, s27, s48
    s_bitcmp1_b32 s27, 3
    s_cselect_b32 s27, s27, s49
    s_xor_b32 s49, s28, s48
    s_bitcmp1_b32 s28, 3
    s_cselect_b32 s28, s28, s49
    s_xor_b32 s48, s24, s27
    s_and_b32 s48, s48, 10
    s_cselect_b32 s24, s24, s27
    s_xor_b32 s48, s25, s28
    s_and_b32 s48, s48, 10
    s_cselect_b32 s25, s25, s28
    s_or_b32 s24, s24, 16
    v_writelane_b32 v6, s24, 0
    s_or_b32 s25, s25, 16
    v_writelane_b32 v6, s25, 1
    s_or_b32 s26, s26, 16
    v_writelane_b32 v6, s26, 2
    s_or_b32 s27, s27, 16
    v_writelane_b32 v6, s27, 3
    s_or_b32 s28, s28, 16
    v_writelane_b32 v6, s28, 4
    s_mov_b64 exec, 0x1f
    ds_write_b32 v5, v6 offset:4
    s_mov_b64 exec, -1
    s_and_b32 s48, s3, 7
    s_cmp_lg_u32 s48, s4
    s_cbranch_scc1 L_exit1
    s_mul_i32 s48, s3, 3
    s_add_u32 s48, s48, 2
    s_lshr_b32 s48, s48, 5
    s_lshl_b32 s48, s48, 2
    v_mov_b32 v3, s48
    s_mul_i32 s57, s3, 24
    v_add_u32 v13, s57, v1
    v_and_b32 v12, 255, v13
    v_mul_u32_u24 v12, 4352, v12
    v_lshlrev_b32 v13, 6, v13
    s_mov_b32 s49, 8388608
    s_mov_b32 s50, 917504
    v_mov_b32 v4, 0xf149f2ca
    v_mov_b32 v5, 0
    s_mov_b32 s51, 93
    s_cmp_eq_u32 s48, 4
    s_cselect_b32 s51, 117, s51
    s_cmp_eq_u32 s48, 8
    s_cselect_b32 s51, 81, s51
    s_mov_b32 s60, 0x100000
L_wcg:
    s_nop 1
    ds_read_b32 v10, v2 offset:128
    s_sub_u32 s60, s60, 1
    s_cbranch_scc1 L_exit1
    s_waitcnt lgkmcnt(0)
    v_readfirstlane_b32 s48, v10
    s_cmp_lt_u32 s48, s51
    s_cbranch_scc1 L_wcg
    s_mov_b64 exec, 0xffffff
    s_mov_b32 s60, 0x40000
L_cpf:
    s_nop 1
    buffer_load_dword v7, v12, s[12:15], s49 offen sc1
    s_sub_u32 s60, s60, 1
    s_cbranch_scc1 L_exit1
    s_waitcnt vmcnt(0)
    v_cmpx_eq_u32 vcc, 0, v7
    s_cbranch_execnz L_cpf
    s_mov_b64 exec, 0xffffff
    s_mov_b32 s60, 0x40000
L_cpm:
    s_nop 1
    buffer_load_dwordx4 v[4:7], v13, s[12:15], s50 offen sc1
    s_sub_u32 s60, s60, 1
    s_cbranch_scc1 L_exit1
    s_waitcnt vmcnt(0)
    v_cmpx_eq_u32 vcc, 0, v7
    s_cbranch_execnz L_cpm
    s_mov_b64 exec, -1
    v_mov_b32 v6, v4
    s_nop 1
    v_max_f32_dpp v6, v6, v6 row_ror:8 row_mask:0xf bank_mask:0xf
    s_nop 1
    v_max_f32_dpp v6, v6, v6 row_ror:4 row_mask:0xf bank_mask:0xf
    s_nop 1
    v_max_f32_dpp v6, v6, v6 row_ror:2 row_mask:0xf bank_mask:0xf
    s_nop 1
    v_max_f32_dpp v6, v6, v6 row_ror:1 row_mask:0xf bank_mask:0xf
    v_mov_b32 v7, v6
    s_nop 1
    v_permlane32_swap_b32 v6, v7
    v_max_f32 v6, v6, v7
    v_mov_b32 v7, v6
    s_nop 1
    v_permlane16_swap_b32 v6, v7
    v_max_f32 v6, v6, v7
    v_sub_f32 v4, v4, v6
    v_exp_f32 v4, v4
    s_nop 0
    v_mul_f32 v5, v5, v4
    s_nop 1
    v_add_f32_dpp v5, v5, v5 row_ror:8 row_mask:0xf bank_mask:0xf
    s_nop 1
    v_add_f32_dpp v5, v5, v5 row_ror:4 row_mask:0xf bank_mask:0xf
    s_nop 1
    v_add_f32_dpp v5, v5, v5 row_ror:2 row_mask:0xf bank_mask:0xf
    s_nop 1
    v_add_f32_dpp v5, v5, v5 row_ror:1 row_mask:0xf bank_mask:0xf
    v_mov_b32 v7, v5
    s_nop 1
    v_permlane32_swap_b32 v5, v7
    v_add_f32 v5, v5, v7
    v_mov_b32 v7, v5
    s_nop 1
    v_permlane16_swap_b32 v5, v7
    v_add_f32 v5, v5, v7
    v_rcp_f32 v5, v5
    s_nop 0
    v_mul_f32 v4, v4, v5
    s_cmp_lt_u32 s3, 21
    s_cbranch_scc1 L_cown
    s_mul_i32 s48, s3, 4352
    s_add_u32 s48, s48, 9498368
    v_lshlrev_b32 v12, 2, v1
    v_mov_b32 v5, 1
    s_mov_b64 exec, 0xffffff
    buffer_store_dword v4, v12, s[12:15], s48 offen offset:128 sc1
    s_mov_b64 exec, 1
    s_waitcnt vmcnt(0)
    buffer_store_dword v5, off, s[12:15], s48 offset:4 sc1
    s_endpgm
L_cown:
    s_nop 1
    v_readlane_b32 s24, v4, 0
    v_readlane_b32 s25, v4, 1
    v_readlane_b32 s26, v4, 2
    v_readlane_b32 s27, v4, 3
    v_readlane_b32 s28, v4, 4
    v_readlane_b32 s29, v4, 5
    v_readlane_b32 s30, v4, 6
    v_readlane_b32 s31, v4, 7
    v_readlane_b32 s32, v4, 8
    v_readlane_b32 s33, v4, 9
    v_readlane_b32 s34, v4, 10
    v_readlane_b32 s35, v4, 11
    v_readlane_b32 s36, v4, 12
    v_readlane_b32 s37, v4, 13
    v_readlane_b32 s38, v4, 14
    v_readlane_b32 s39, v4, 15
    v_readlane_b32 s40, v4, 16
    v_readlane_b32 s41, v4, 17
    v_readlane_b32 s42, v4, 18
    v_readlane_b32 s43, v4, 19
    v_readlane_b32 s44, v4, 20
    v_readlane_b32 s45, v4, 21
    v_readlane_b32 s46, v4, 22
    v_readlane_b32 s47, v4, 23
    s_mov_b32 s92, s78
    s_and_b32 s93, s79, 0xffff
    s_mov_b32 s94, 12288
    s_mov_b32 s95, 0x00020000
    s_lshl_b32 s57, s57, 10
    v_lshlrev_b32 v13, 4, v1
    v_add_u32 v13, s57, v13
    s_mov_b32 s49, 4096
    s_mov_b32 s50, 8192
    s_mov_b32 s51, 12288
    s_mov_b32 s52, 16384
    s_mov_b32 s53, 20480
    v_mov_b32 v4, 0
    v_mov_b32 v5, 0
    v_mov_b32 v6, 0
    s_mov_b32 s56, 0xffffff
    v_lshlrev_b32 v12, 1, v1
    s_mul_i32 s57, s3, 384
    s_mov_b32 s60, 0x100000
L_wcc:
    s_nop 1
    ds_read_b32 v10, v3 offset:64
    s_sub_u32 s60, s60, 1
    s_cbranch_scc1 L_exit1
    s_waitcnt lgkmcnt(0)
    v_readfirstlane_b32 s48, v10
    s_cmp_lt_u32 s48, 1
    s_cbranch_scc1 L_wcc
    s_mov_b32 s60, 0x40000
L_cr:
    s_nop 1
    s_bitcmp0_b32 s56, 0
    s_cbranch_scc1 L_cl0
    buffer_load_dwordx4 v[16:19], v13, s[12:15], 0 offen offset:0 sc1
L_cl0:
    s_bitcmp0_b32 s56, 1
    s_cbranch_scc1 L_cl1
    buffer_load_dwordx4 v[20:23], v13, s[12:15], 0 offen offset:1024 sc1
L_cl1:
    s_bitcmp0_b32 s56, 2
    s_cbranch_scc1 L_cl2
    buffer_load_dwordx4 v[24:27], v13, s[12:15], 0 offen offset:2048 sc1
L_cl2:
    s_bitcmp0_b32 s56, 3
    s_cbranch_scc1 L_cl3
    buffer_load_dwordx4 v[28:31], v13, s[12:15], 0 offen offset:3072 sc1
L_cl3:
    s_bitcmp0_b32 s56, 4
    s_cbranch_scc1 L_cl4
    buffer_load_dwordx4 v[32:35], v13, s[12:15], s49 offen offset:0 sc1
L_cl4:
    s_bitcmp0_b32 s56, 5
    s_cbranch_scc1 L_cl5
    buffer_load_dwordx4 v[36:39], v13, s[12:15], s49 offen offset:1024 sc1
L_cl5:
    s_bitcmp0_b32 s56, 6
    s_cbranch_scc1 L_cl6
    buffer_load_dwordx4 v[40:43], v13, s[12:15], s49 offen offset:2048 sc1
L_cl6:
    s_bitcmp0_b32 s56, 7
    s_cbranch_scc1 L_cl7
    buffer_load_dwordx4 v[44:47], v13, s[12:15], s49 offen offset:3072 sc1
L_cl7:
    s_bitcmp0_b32 s56, 8
    s_cbranch_scc1 L_cl8
    buffer_load_dwordx4 v[48:51], v13, s[12:15], s50 offen offset:0 sc1
L_cl8:
    s_bitcmp0_b32 s56, 9
    s_cbranch_scc1 L_cl9
    buffer_load_dwordx4 v[52:55], v13, s[12:15], s50 offen offset:1024 sc1
L_cl9:
    s_bitcmp0_b32 s56, 10
    s_cbranch_scc1 L_cl10
    buffer_load_dwordx4 v[56:59], v13, s[12:15], s50 offen offset:2048 sc1
L_cl10:
    s_bitcmp0_b32 s56, 11
    s_cbranch_scc1 L_cl11
    buffer_load_dwordx4 v[60:63], v13, s[12:15], s50 offen offset:3072 sc1
L_cl11:
    s_bitcmp0_b32 s56, 12
    s_cbranch_scc1 L_cl12
    buffer_load_dwordx4 v[64:67], v13, s[12:15], s51 offen offset:0 sc1
L_cl12:
    s_bitcmp0_b32 s56, 13
    s_cbranch_scc1 L_cl13
    buffer_load_dwordx4 v[68:71], v13, s[12:15], s51 offen offset:1024 sc1
L_cl13:
    s_bitcmp0_b32 s56, 14
    s_cbranch_scc1 L_cl14
    buffer_load_dwordx4 v[72:75], v13, s[12:15], s51 offen offset:2048 sc1
L_cl14:
    s_bitcmp0_b32 s56, 15
    s_cbranch_scc1 L_cl15
    buffer_load_dwordx4 v[76:79], v13, s[12:15], s51 offen offset:3072 sc1
L_cl15:
    s_bitcmp0_b32 s56, 16
    s_cbranch_scc1 L_cl16
    buffer_load_dwordx4 v[80:83], v13, s[12:15], s52 offen offset:0 sc1
L_cl16:
    s_bitcmp0_b32 s56, 17
    s_cbranch_scc1 L_cl17
    buffer_load_dwordx4 v[84:87], v13, s[12:15], s52 offen offset:1024 sc1
L_cl17:
    s_bitcmp0_b32 s56, 18
    s_cbranch_scc1 L_cl18
    buffer_load_dwordx4 v[88:91], v13, s[12:15], s52 offen offset:2048 sc1
L_cl18:
    s_bitcmp0_b32 s56, 19
    s_cbranch_scc1 L_cl19
    buffer_load_dwordx4 v[92:95], v13, s[12:15], s52 offen offset:3072 sc1
L_cl19:
    s_bitcmp0_b32 s56, 20
    s_cbranch_scc1 L_cl20
    buffer_load_dwordx4 v[96:99], v13, s[12:15], s53 offen offset:0 sc1
L_cl20:
    s_bitcmp0_b32 s56, 21
    s_cbranch_scc1 L_cl21
    buffer_load_dwordx4 v[100:103], v13, s[12:15], s53 offen offset:1024 sc1
L_cl21:
    s_bitcmp0_b32 s56, 22
    s_cbranch_scc1 L_cl22
    buffer_load_dwordx4 v[104:107], v13, s[12:15], s53 offen offset:2048 sc1
L_cl22:
    s_bitcmp0_b32 s56, 23
    s_cbranch_scc1 L_cl23
    buffer_load_dwordx4 v[108:111], v13, s[12:15], s53 offen offset:3072 sc1
L_cl23:
    s_sub_u32 s60, s60, 1
    s_cbranch_scc1 L_exit1
    s_waitcnt vmcnt(0)
    s_bitcmp0_b32 s56, 0
    s_cbranch_scc1 L_cv0
    v_cmp_eq_u32 vcc, 0, v19
    s_cbranch_vccnz L_cv0
    v_fmac_f32 v4, s24, v16
    v_fmac_f32 v5, s24, v17
    v_fmac_f32 v6, s24, v18
    s_bitset0_b32 s56, 0
L_cv0:
    s_bitcmp0_b32 s56, 1
    s_cbranch_scc1 L_cv1
    v_cmp_eq_u32 vcc, 0, v23
    s_cbranch_vccnz L_cv1
    v_fmac_f32 v4, s25, v20
    v_fmac_f32 v5, s25, v21
    v_fmac_f32 v6, s25, v22
    s_bitset0_b32 s56, 1
L_cv1:
    s_bitcmp0_b32 s56, 2
    s_cbranch_scc1 L_cv2
    v_cmp_eq_u32 vcc, 0, v27
    s_cbranch_vccnz L_cv2
    v_fmac_f32 v4, s26, v24
    v_fmac_f32 v5, s26, v25
    v_fmac_f32 v6, s26, v26
    s_bitset0_b32 s56, 2
L_cv2:
    s_bitcmp0_b32 s56, 3
    s_cbranch_scc1 L_cv3
    v_cmp_eq_u32 vcc, 0, v31
    s_cbranch_vccnz L_cv3
    v_fmac_f32 v4, s27, v28
    v_fmac_f32 v5, s27, v29
    v_fmac_f32 v6, s27, v30
    s_bitset0_b32 s56, 3
L_cv3:
    s_bitcmp0_b32 s56, 4
    s_cbranch_scc1 L_cv4
    v_cmp_eq_u32 vcc, 0, v35
    s_cbranch_vccnz L_cv4
    v_fmac_f32 v4, s28, v32
    v_fmac_f32 v5, s28, v33
    v_fmac_f32 v6, s28, v34
    s_bitset0_b32 s56, 4
L_cv4:
    s_bitcmp0_b32 s56, 5
    s_cbranch_scc1 L_cv5
    v_cmp_eq_u32 vcc, 0, v39
    s_cbranch_vccnz L_cv5
    v_fmac_f32 v4, s29, v36
    v_fmac_f32 v5, s29, v37
    v_fmac_f32 v6, s29, v38
    s_bitset0_b32 s56, 5
L_cv5:
    s_bitcmp0_b32 s56, 6
    s_cbranch_scc1 L_cv6
    v_cmp_eq_u32 vcc, 0, v43
    s_cbranch_vccnz L_cv6
    v_fmac_f32 v4, s30, v40
    v_fmac_f32 v5, s30, v41
    v_fmac_f32 v6, s30, v42
    s_bitset0_b32 s56, 6
L_cv6:
    s_bitcmp0_b32 s56, 7
    s_cbranch_scc1 L_cv7
    v_cmp_eq_u32 vcc, 0, v47
    s_cbranch_vccnz L_cv7
    v_fmac_f32 v4, s31, v44
    v_fmac_f32 v5, s31, v45
    v_fmac_f32 v6, s31, v46
    s_bitset0_b32 s56, 7
L_cv7:
    s_bitcmp0_b32 s56, 8
    s_cbranch_scc1 L_cv8
    v_cmp_eq_u32 vcc, 0, v51
    s_cbranch_vccnz L_cv8
    v_fmac_f32 v4, s32, v48
    v_fmac_f32 v5, s32, v49
    v_fmac_f32 v6, s32, v50
    s_bitset0_b32 s56, 8
L_cv8:
    s_bitcmp0_b32 s56, 9
    s_cbranch_scc1 L_cv9
    v_cmp_eq_u32 vcc, 0, v55
    s_cbranch_vccnz L_cv9
    v_fmac_f32 v4, s33, v52
    v_fmac_f32 v5, s33, v53
    v_fmac_f32 v6, s33, v54
    s_bitset0_b32 s56, 9
L_cv9:
    s_bitcmp0_b32 s56, 10
    s_cbranch_scc1 L_cv10
    v_cmp_eq_u32 vcc, 0, v59
    s_cbranch_vccnz L_cv10
    v_fmac_f32 v4, s34, v56
    v_fmac_f32 v5, s34, v57
    v_fmac_f32 v6, s34, v58
    s_bitset0_b32 s56, 10
L_cv10:
    s_bitcmp0_b32 s56, 11
    s_cbranch_scc1 L_cv11
    v_cmp_eq_u32 vcc, 0, v63
    s_cbranch_vccnz L_cv11
    v_fmac_f32 v4, s35, v60
    v_fmac_f32 v5, s35, v61
    v_fmac_f32 v6, s35, v62
    s_bitset0_b32 s56, 11
L_cv11:
    s_bitcmp0_b32 s56, 12
    s_cbranch_scc1 L_cv12
    v_cmp_eq_u32 vcc, 0, v67
    s_cbranch_vccnz L_cv12
    v_fmac_f32 v4, s36, v64
    v_fmac_f32 v5, s36, v65
    v_fmac_f32 v6, s36, v66
    s_bitset0_b32 s56, 12
L_cv12:
    s_bitcmp0_b32 s56, 13
    s_cbranch_scc1 L_cv13
    v_cmp_eq_u32 vcc, 0, v71
    s_cbranch_vccnz L_cv13
    v_fmac_f32 v4, s37, v68
    v_fmac_f32 v5, s37, v69
    v_fmac_f32 v6, s37, v70
    s_bitset0_b32 s56, 13
L_cv13:
    s_bitcmp0_b32 s56, 14
    s_cbranch_scc1 L_cv14
    v_cmp_eq_u32 vcc, 0, v75
    s_cbranch_vccnz L_cv14
    v_fmac_f32 v4, s38, v72
    v_fmac_f32 v5, s38, v73
    v_fmac_f32 v6, s38, v74
    s_bitset0_b32 s56, 14
L_cv14:
    s_bitcmp0_b32 s56, 15
    s_cbranch_scc1 L_cv15
    v_cmp_eq_u32 vcc, 0, v79
    s_cbranch_vccnz L_cv15
    v_fmac_f32 v4, s39, v76
    v_fmac_f32 v5, s39, v77
    v_fmac_f32 v6, s39, v78
    s_bitset0_b32 s56, 15
L_cv15:
    s_bitcmp0_b32 s56, 16
    s_cbranch_scc1 L_cv16
    v_cmp_eq_u32 vcc, 0, v83
    s_cbranch_vccnz L_cv16
    v_fmac_f32 v4, s40, v80
    v_fmac_f32 v5, s40, v81
    v_fmac_f32 v6, s40, v82
    s_bitset0_b32 s56, 16
L_cv16:
    s_bitcmp0_b32 s56, 17
    s_cbranch_scc1 L_cv17
    v_cmp_eq_u32 vcc, 0, v87
    s_cbranch_vccnz L_cv17
    v_fmac_f32 v4, s41, v84
    v_fmac_f32 v5, s41, v85
    v_fmac_f32 v6, s41, v86
    s_bitset0_b32 s56, 17
L_cv17:
    s_bitcmp0_b32 s56, 18
    s_cbranch_scc1 L_cv18
    v_cmp_eq_u32 vcc, 0, v91
    s_cbranch_vccnz L_cv18
    v_fmac_f32 v4, s42, v88
    v_fmac_f32 v5, s42, v89
    v_fmac_f32 v6, s42, v90
    s_bitset0_b32 s56, 18
L_cv18:
    s_bitcmp0_b32 s56, 19
    s_cbranch_scc1 L_cv19
    v_cmp_eq_u32 vcc, 0, v95
    s_cbranch_vccnz L_cv19
    v_fmac_f32 v4, s43, v92
    v_fmac_f32 v5, s43, v93
    v_fmac_f32 v6, s43, v94
    s_bitset0_b32 s56, 19
L_cv19:
    s_bitcmp0_b32 s56, 20
    s_cbranch_scc1 L_cv20
    v_cmp_eq_u32 vcc, 0, v99
    s_cbranch_vccnz L_cv20
    v_fmac_f32 v4, s44, v96
    v_fmac_f32 v5, s44, v97
    v_fmac_f32 v6, s44, v98
    s_bitset0_b32 s56, 20
L_cv20:
    s_bitcmp0_b32 s56, 21
    s_cbranch_scc1 L_cv21
    v_cmp_eq_u32 vcc, 0, v103
    s_cbranch_vccnz L_cv21
    v_fmac_f32 v4, s45, v100
    v_fmac_f32 v5, s45, v101
    v_fmac_f32 v6, s45, v102
    s_bitset0_b32 s56, 21
L_cv21:
    s_bitcmp0_b32 s56, 22
    s_cbranch_scc1 L_cv22
    v_cmp_eq_u32 vcc, 0, v107
    s_cbranch_vccnz L_cv22
    v_fmac_f32 v4, s46, v104
    v_fmac_f32 v5, s46, v105
    v_fmac_f32 v6, s46, v106
    s_bitset0_b32 s56, 22
L_cv22:
    s_bitcmp0_b32 s56, 23
    s_cbranch_scc1 L_cv23
    v_cmp_eq_u32 vcc, 0, v111
    s_cbranch_vccnz L_cv23
    v_fmac_f32 v4, s47, v108
    v_fmac_f32 v5, s47, v109
    v_fmac_f32 v6, s47, v110
    s_bitset0_b32 s56, 23
L_cv23:
    s_cmp_lg_u32 s56, 0
    s_cbranch_scc1 L_cr
    v_cvt_pk_bf16_f32 v4, v4, v4
    buffer_store_short v4, v12, s[92:95], s57 offen offset:0
    v_cvt_pk_bf16_f32 v5, v5, v5
    buffer_store_short v5, v12, s[92:95], s57 offen offset:128
    v_cvt_pk_bf16_f32 v6, v6, v6
    buffer_store_short v6, v12, s[92:95], s57 offen offset:256
    s_endpgm
L_h0:
    s_nop 1
    s_mov_b32 s8, s64
    s_and_b32 s9, s65, 0xffff
    s_mov_b32 s10, 12288
    s_mov_b32 s11, 0x00020000
    s_mov_b32 s92, s70
    s_and_b32 s93, s71, 0xffff
    s_mov_b32 s94, 6291456
    s_mov_b32 s95, 0x00020000
    s_mov_b32 s96, s72
    s_and_b32 s97, s73, 0xffff
    s_mov_b32 s98, 6291456
    s_mov_b32 s99, 0x00020000
    v_lshrrev_b32 v4, 4, v1
    v_and_b32 v5, 15, v1
    v_lshlrev_b32 v6, 3, v5
    v_mul_u32_u24 v7, 384, v4
    v_add_u32 v7, v7, v6
    v_lshl_add_u32 v13, v5, 2, v4
    v_lshlrev_b32 v13, 2, v13
    v_lshlrev_b32 v4, 4, v1
    s_mul_i32 s32, s5, 4352
    s_add_u32 s32, s32, s59
    s_lshl_b32 s33, s3, 3
    s_add_u32 s33, s33, s5
    v_and_b32 v14, 7, v1
    v_lshrrev_b32 v10, 3, v1
    v_mul_u32_u24 v8, 24, v10
    v_mov_b32 v11, 768
    v_mad_u32_u24 v8, v14, v11, v8
    v_lshlrev_b32 v14, 7, v14
    v_lshl_add_u32 v14, v10, 4, v14
    s_mul_i32 s33, s33, 4096
    s_add_u32 s33, s33, 2097152
    v_mov_b32 v16, 0
    v_mov_b32 v17, 0
    v_mov_b32 v18, 0
    v_mov_b32 v19, 0
    s_add_u32 s48, s2, 0
    s_lshl_b32 s49, s48, 10
    s_lshl_b32 s48, s48, 6
    s_add_u32 s48, s48, 917504
    buffer_store_dwordx4 v[16:19], v4, s[12:15], s49 offen sc1
    s_mov_b64 exec, 15
    buffer_store_dwordx4 v[16:19], v4, s[12:15], s48 offen sc1
    s_mov_b64 exec, -1
    s_add_u32 s48, s2, 256
    s_lshl_b32 s49, s48, 10
    s_lshl_b32 s48, s48, 6
    s_add_u32 s48, s48, 917504
    buffer_store_dwordx4 v[16:19], v4, s[12:15], s49 offen sc1
    s_mov_b64 exec, 15
    buffer_store_dwordx4 v[16:19], v4, s[12:15], s48 offen sc1
    s_mov_b64 exec, -1
    s_add_u32 s48, s2, 512
    s_lshl_b32 s49, s48, 10
    s_lshl_b32 s48, s48, 6
    s_add_u32 s48, s48, 917504
    buffer_store_dwordx4 v[16:19], v4, s[12:15], s49 offen sc1
    s_mov_b64 exec, 15
    buffer_store_dwordx4 v[16:19], v4, s[12:15], s48 offen sc1
    s_mov_b64 exec, -1
    s_mov_b32 s61, 0
    s_lshl_b32 s62, s61, 5
    s_add_u32 s62, s62, s3
    s_lshl_b32 s63, s62, 15
    s_add_u32 s63, s63, 1
    s_mul_hi_u32 s63, s63, 0xaaaaaaab
    s_lshr_b32 s63, s63, 7
    s_mul_i32 s48, s62, 171
    s_lshr_b32 s48, s48, 9
    s_mul_i32 s48, s48, 384
    s_mul_i32 s49, s4, 24
    s_add_u32 s50, s49, s63
    s_mul_i32 s50, s50, 384
    v_add_u32 v10, s50, v7
    v_add_u32 v11, 3072, v10
    v_add_u32 v12, 6144, v10
    buffer_load_dwordx2 v[100:101], v6, s[8:11], s48 offen offset:0
    buffer_load_dwordx2 v[102:103], v6, s[8:11], s48 offen offset:128
    buffer_load_dwordx2 v[104:105], v6, s[8:11], s48 offen offset:256
    buffer_load_dwordx2 v[28:29], v10, s[92:95], 0 offen offset:0
    buffer_load_dwordx2 v[30:31], v10, s[92:95], 0 offen offset:128
    buffer_load_dwordx2 v[32:33], v10, s[92:95], 0 offen offset:256
    buffer_load_dwordx2 v[64:65], v10, s[96:99], 0 offen offset:0
    buffer_load_dwordx2 v[66:67], v10, s[96:99], 0 offen offset:128
    buffer_load_dwordx2 v[68:69], v10, s[96:99], 0 offen offset:256
    buffer_load_dwordx2 v[34:35], v10, s[92:95], 0 offen offset:1536
    buffer_load_dwordx2 v[36:37], v10, s[92:95], 0 offen offset:1664
    buffer_load_dwordx2 v[38:39], v10, s[92:95], 0 offen offset:1792
    buffer_load_dwordx2 v[70:71], v10, s[96:99], 0 offen offset:1536
    buffer_load_dwordx2 v[72:73], v10, s[96:99], 0 offen offset:1664
    buffer_load_dwordx2 v[74:75], v10, s[96:99], 0 offen offset:1792
    buffer_load_dwordx2 v[40:41], v11, s[92:95], 0 offen offset:0
    buffer_load_dwordx2 v[42:43], v11, s[92:95], 0 offen offset:128
    buffer_load_dwordx2 v[44:45], v11, s[92:95], 0 offen offset:256
    buffer_load_dwordx2 v[76:77], v11, s[96:99], 0 offen offset:0
    buffer_load_dwordx2 v[78:79], v11, s[96:99], 0 offen offset:128
    buffer_load_dwordx2 v[80:81], v11, s[96:99], 0 offen offset:256
    buffer_load_dwordx2 v[46:47], v11, s[92:95], 0 offen offset:1536
    buffer_load_dwordx2 v[48:49], v11, s[92:95], 0 offen offset:1664
    buffer_load_dwordx2 v[50:51], v11, s[92:95], 0 offen offset:1792
    buffer_load_dwordx2 v[82:83], v11, s[96:99], 0 offen offset:1536
    buffer_load_dwordx2 v[84:85], v11, s[96:99], 0 offen offset:1664
    buffer_load_dwordx2 v[86:87], v11, s[96:99], 0 offen offset:1792
    buffer_load_dwordx2 v[52:53], v12, s[92:95], 0 offen offset:0
    buffer_load_dwordx2 v[54:55], v12, s[92:95], 0 offen offset:128
    buffer_load_dwordx2 v[56:57], v12, s[92:95], 0 offen offset:256
    buffer_load_dwordx2 v[88:89], v12, s[96:99], 0 offen offset:0
    buffer_load_dwordx2 v[90:91], v12, s[96:99], 0 offen offset:128
    buffer_load_dwordx2 v[92:93], v12, s[96:99], 0 offen offset:256
    buffer_load_dwordx2 v[58:59], v12, s[92:95], 0 offen offset:1536
    buffer_load_dwordx2 v[60:61], v12, s[92:95], 0 offen offset:1664
    buffer_load_dwordx2 v[62:63], v12, s[92:95], 0 offen offset:1792
    buffer_load_dwordx2 v[94:95], v12, s[96:99], 0 offen offset:1536
    buffer_load_dwordx2 v[96:97], v12, s[96:99], 0 offen offset:1664
    buffer_load_dwordx2 v[98:99], v12, s[96:99], 0 offen offset:1792
    s_waitcnt vmcnt(0)
    v_lshlrev_b32 v16, 16, v100
    v_and_b32 v17, 0xffff0000, v100
    v_lshlrev_b32 v18, 16, v101
    v_and_b32 v19, 0xffff0000, v101
    v_lshlrev_b32 v20, 16, v102
    v_and_b32 v21, 0xffff0000, v102
    v_lshlrev_b32 v22, 16, v103
    v_and_b32 v23, 0xffff0000, v103
    v_lshlrev_b32 v24, 16, v104
    v_and_b32 v25, 0xffff0000, v104
    v_lshlrev_b32 v26, 16, v105
    v_and_b32 v27, 0xffff0000, v105
    v_lshlrev_b32 v10, 16, v28
    v_lshlrev_b32 v11, 16, v64
    v_and_b32 v28, 0xffff0000, v28
    v_and_b32 v64, 0xffff0000, v64
    v_mul_f32 v10, v10, v16
    v_mul_f32 v28, v28, v17
    v_mul_f32 v100, v10, v11
    v_fmac_f32 v100, v28, v64
    v_lshlrev_b32 v10, 16, v29
    v_lshlrev_b32 v11, 16, v65
    v_and_b32 v29, 0xffff0000, v29
    v_and_b32 v65, 0xffff0000, v65
    v_mul_f32 v10, v10, v18
    v_mul_f32 v29, v29, v19
    v_fmac_f32 v100, v10, v11
    v_fmac_f32 v100, v29, v65
    v_lshlrev_b32 v10, 16, v30
    v_lshlrev_b32 v11, 16, v66
    v_and_b32 v30, 0xffff0000, v30
    v_and_b32 v66, 0xffff0000, v66
    v_mul_f32 v10, v10, v20
    v_mul_f32 v30, v30, v21
    v_fmac_f32 v100, v10, v11
    v_fmac_f32 v100, v30, v66
    v_lshlrev_b32 v10, 16, v31
    v_lshlrev_b32 v11, 16, v67
    v_and_b32 v31, 0xffff0000, v31
    v_and_b32 v67, 0xffff0000, v67
    v_mul_f32 v10, v10, v22
    v_mul_f32 v31, v31, v23
    v_fmac_f32 v100, v10, v11
    v_fmac_f32 v100, v31, v67
    v_lshlrev_b32 v10, 16, v32
    v_lshlrev_b32 v11, 16, v68
    v_and_b32 v32, 0xffff0000, v32
    v_and_b32 v68, 0xffff0000, v68
    v_mul_f32 v10, v10, v24
    v_mul_f32 v32, v32, v25
    v_fmac_f32 v100, v10, v11
    v_fmac_f32 v100, v32, v68
    v_lshlrev_b32 v10, 16, v33
    v_lshlrev_b32 v11, 16, v69
    v_and_b32 v33, 0xffff0000, v33
    v_and_b32 v69, 0xffff0000, v69
    v_mul_f32 v10, v10, v26
    v_mul_f32 v33, v33, v27
    v_fmac_f32 v100, v10, v11
    v_fmac_f32 v100, v33, v69
    v_lshlrev_b32 v10, 16, v34
    v_lshlrev_b32 v11, 16, v70
    v_and_b32 v34, 0xffff0000, v34
    v_and_b32 v70, 0xffff0000, v70
    v_mul_f32 v10, v10, v16
    v_mul_f32 v34, v34, v17
    v_mul_f32 v101, v10, v11
    v_fmac_f32 v101, v34, v70
    v_lshlrev_b32 v10, 16, v35
    v_lshlrev_b32 v11, 16, v71
    v_and_b32 v35, 0xffff0000, v35
    v_and_b32 v71, 0xffff0000, v71
    v_mul_f32 v10, v10, v18
    v_mul_f32 v35, v35, v19
    v_fmac_f32 v101, v10, v11
    v_fmac_f32 v101, v35, v71
    v_lshlrev_b32 v10, 16, v36
    v_lshlrev_b32 v11, 16, v72
    v_and_b32 v36, 0xffff0000, v36
    v_and_b32 v72, 0xffff0000, v72
    v_mul_f32 v10, v10, v20
    v_mul_f32 v36, v36, v21
    v_fmac_f32 v101, v10, v11
    v_fmac_f32 v101, v36, v72
    v_lshlrev_b32 v10, 16, v37
    v_lshlrev_b32 v11, 16, v73
    v_and_b32 v37, 0xffff0000, v37
    v_and_b32 v73, 0xffff0000, v73
    v_mul_f32 v10, v10, v22
    v_mul_f32 v37, v37, v23
    v_fmac_f32 v101, v10, v11
    v_fmac_f32 v101, v37, v73
    v_lshlrev_b32 v10, 16, v38
    v_lshlrev_b32 v11, 16, v74
    v_and_b32 v38, 0xffff0000, v38
    v_and_b32 v74, 0xffff0000, v74
    v_mul_f32 v10, v10, v24
    v_mul_f32 v38, v38, v25
    v_fmac_f32 v101, v10, v11
    v_fmac_f32 v101, v38, v74
    v_lshlrev_b32 v10, 16, v39
    v_lshlrev_b32 v11, 16, v75
    v_and_b32 v39, 0xffff0000, v39
    v_and_b32 v75, 0xffff0000, v75
    v_mul_f32 v10, v10, v26
    v_mul_f32 v39, v39, v27
    v_fmac_f32 v101, v10, v11
    v_fmac_f32 v101, v39, v75
    v_lshlrev_b32 v10, 16, v40
    v_lshlrev_b32 v11, 16, v76
    v_and_b32 v40, 0xffff0000, v40
    v_and_b32 v76, 0xffff0000, v76
    v_mul_f32 v10, v10, v16
    v_mul_f32 v40, v40, v17
    v_mul_f32 v102, v10, v11
    v_fmac_f32 v102, v40, v76
    v_lshlrev_b32 v10, 16, v41
    v_lshlrev_b32 v11, 16, v77
    v_and_b32 v41, 0xffff0000, v41
    v_and_b32 v77, 0xffff0000, v77
    v_mul_f32 v10, v10, v18
    v_mul_f32 v41, v41, v19
    v_fmac_f32 v102, v10, v11
    v_fmac_f32 v102, v41, v77
    v_lshlrev_b32 v10, 16, v42
    v_lshlrev_b32 v11, 16, v78
    v_and_b32 v42, 0xffff0000, v42
    v_and_b32 v78, 0xffff0000, v78
    v_mul_f32 v10, v10, v20
    v_mul_f32 v42, v42, v21
    v_fmac_f32 v102, v10, v11
    v_fmac_f32 v102, v42, v78
    v_lshlrev_b32 v10, 16, v43
    v_lshlrev_b32 v11, 16, v79
    v_and_b32 v43, 0xffff0000, v43
    v_and_b32 v79, 0xffff0000, v79
    v_mul_f32 v10, v10, v22
    v_mul_f32 v43, v43, v23
    v_fmac_f32 v102, v10, v11
    v_fmac_f32 v102, v43, v79
    v_lshlrev_b32 v10, 16, v44
    v_lshlrev_b32 v11, 16, v80
    v_and_b32 v44, 0xffff0000, v44
    v_and_b32 v80, 0xffff0000, v80
    v_mul_f32 v10, v10, v24
    v_mul_f32 v44, v44, v25
    v_fmac_f32 v102, v10, v11
    v_fmac_f32 v102, v44, v80
    v_lshlrev_b32 v10, 16, v45
    v_lshlrev_b32 v11, 16, v81
    v_and_b32 v45, 0xffff0000, v45
    v_and_b32 v81, 0xffff0000, v81
    v_mul_f32 v10, v10, v26
    v_mul_f32 v45, v45, v27
    v_fmac_f32 v102, v10, v11
    v_fmac_f32 v102, v45, v81
    v_lshlrev_b32 v10, 16, v46
    v_lshlrev_b32 v11, 16, v82
    v_and_b32 v46, 0xffff0000, v46
    v_and_b32 v82, 0xffff0000, v82
    v_mul_f32 v10, v10, v16
    v_mul_f32 v46, v46, v17
    v_mul_f32 v103, v10, v11
    v_fmac_f32 v103, v46, v82
    v_lshlrev_b32 v10, 16, v47
    v_lshlrev_b32 v11, 16, v83
    v_and_b32 v47, 0xffff0000, v47
    v_and_b32 v83, 0xffff0000, v83
    v_mul_f32 v10, v10, v18
    v_mul_f32 v47, v47, v19
    v_fmac_f32 v103, v10, v11
    v_fmac_f32 v103, v47, v83
    v_lshlrev_b32 v10, 16, v48
    v_lshlrev_b32 v11, 16, v84
    v_and_b32 v48, 0xffff0000, v48
    v_and_b32 v84, 0xffff0000, v84
    v_mul_f32 v10, v10, v20
    v_mul_f32 v48, v48, v21
    v_fmac_f32 v103, v10, v11
    v_fmac_f32 v103, v48, v84
    v_lshlrev_b32 v10, 16, v49
    v_lshlrev_b32 v11, 16, v85
    v_and_b32 v49, 0xffff0000, v49
    v_and_b32 v85, 0xffff0000, v85
    v_mul_f32 v10, v10, v22
    v_mul_f32 v49, v49, v23
    v_fmac_f32 v103, v10, v11
    v_fmac_f32 v103, v49, v85
    v_lshlrev_b32 v10, 16, v50
    v_lshlrev_b32 v11, 16, v86
    v_and_b32 v50, 0xffff0000, v50
    v_and_b32 v86, 0xffff0000, v86
    v_mul_f32 v10, v10, v24
    v_mul_f32 v50, v50, v25
    v_fmac_f32 v103, v10, v11
    v_fmac_f32 v103, v50, v86
    v_lshlrev_b32 v10, 16, v51
    v_lshlrev_b32 v11, 16, v87
    v_and_b32 v51, 0xffff0000, v51
    v_and_b32 v87, 0xffff0000, v87
    v_mul_f32 v10, v10, v26
    v_mul_f32 v51, v51, v27
    v_fmac_f32 v103, v10, v11
    v_fmac_f32 v103, v51, v87
    v_lshlrev_b32 v10, 16, v52
    v_lshlrev_b32 v11, 16, v88
    v_and_b32 v52, 0xffff0000, v52
    v_and_b32 v88, 0xffff0000, v88
    v_mul_f32 v10, v10, v16
    v_mul_f32 v52, v52, v17
    v_mul_f32 v104, v10, v11
    v_fmac_f32 v104, v52, v88
    v_lshlrev_b32 v10, 16, v53
    v_lshlrev_b32 v11, 16, v89
    v_and_b32 v53, 0xffff0000, v53
    v_and_b32 v89, 0xffff0000, v89
    v_mul_f32 v10, v10, v18
    v_mul_f32 v53, v53, v19
    v_fmac_f32 v104, v10, v11
    v_fmac_f32 v104, v53, v89
    v_lshlrev_b32 v10, 16, v54
    v_lshlrev_b32 v11, 16, v90
    v_and_b32 v54, 0xffff0000, v54
    v_and_b32 v90, 0xffff0000, v90
    v_mul_f32 v10, v10, v20
    v_mul_f32 v54, v54, v21
    v_fmac_f32 v104, v10, v11
    v_fmac_f32 v104, v54, v90
    v_lshlrev_b32 v10, 16, v55
    v_lshlrev_b32 v11, 16, v91
    v_and_b32 v55, 0xffff0000, v55
    v_and_b32 v91, 0xffff0000, v91
    v_mul_f32 v10, v10, v22
    v_mul_f32 v55, v55, v23
    v_fmac_f32 v104, v10, v11
    v_fmac_f32 v104, v55, v91
    v_lshlrev_b32 v10, 16, v56
    v_lshlrev_b32 v11, 16, v92
    v_and_b32 v56, 0xffff0000, v56
    v_and_b32 v92, 0xffff0000, v92
    v_mul_f32 v10, v10, v24
    v_mul_f32 v56, v56, v25
    v_fmac_f32 v104, v10, v11
    v_fmac_f32 v104, v56, v92
    v_lshlrev_b32 v10, 16, v57
    v_lshlrev_b32 v11, 16, v93
    v_and_b32 v57, 0xffff0000, v57
    v_and_b32 v93, 0xffff0000, v93
    v_mul_f32 v10, v10, v26
    v_mul_f32 v57, v57, v27
    v_fmac_f32 v104, v10, v11
    v_fmac_f32 v104, v57, v93
    v_lshlrev_b32 v10, 16, v58
    v_lshlrev_b32 v11, 16, v94
    v_and_b32 v58, 0xffff0000, v58
    v_and_b32 v94, 0xffff0000, v94
    v_mul_f32 v10, v10, v16
    v_mul_f32 v58, v58, v17
    v_mul_f32 v105, v10, v11
    v_fmac_f32 v105, v58, v94
    v_lshlrev_b32 v10, 16, v59
    v_lshlrev_b32 v11, 16, v95
    v_and_b32 v59, 0xffff0000, v59
    v_and_b32 v95, 0xffff0000, v95
    v_mul_f32 v10, v10, v18
    v_mul_f32 v59, v59, v19
    v_fmac_f32 v105, v10, v11
    v_fmac_f32 v105, v59, v95
    v_lshlrev_b32 v10, 16, v60
    v_lshlrev_b32 v11, 16, v96
    v_and_b32 v60, 0xffff0000, v60
    v_and_b32 v96, 0xffff0000, v96
    v_mul_f32 v10, v10, v20
    v_mul_f32 v60, v60, v21
    v_fmac_f32 v105, v10, v11
    v_fmac_f32 v105, v60, v96
    v_lshlrev_b32 v10, 16, v61
    v_lshlrev_b32 v11, 16, v97
    v_and_b32 v61, 0xffff0000, v61
    v_and_b32 v97, 0xffff0000, v97
    v_mul_f32 v10, v10, v22
    v_mul_f32 v61, v61, v23
    v_fmac_f32 v105, v10, v11
    v_fmac_f32 v105, v61, v97
    v_lshlrev_b32 v10, 16, v62
    v_lshlrev_b32 v11, 16, v98
    v_and_b32 v62, 0xffff0000, v62
    v_and_b32 v98, 0xffff0000, v98
    v_mul_f32 v10, v10, v24
    v_mul_f32 v62, v62, v25
    v_fmac_f32 v105, v10, v11
    v_fmac_f32 v105, v62, v98
    v_lshlrev_b32 v10, 16, v63
    v_lshlrev_b32 v11, 16, v99
    v_and_b32 v63, 0xffff0000, v63
    v_and_b32 v99, 0xffff0000, v99
    v_mul_f32 v10, v10, v26
    v_mul_f32 v63, v63, v27
    v_fmac_f32 v105, v10, v11
    v_fmac_f32 v105, v63, v99
    v_add_f32_dpp v100, v100, v100 row_ror:8 row_mask:0xf bank_mask:0xf
    v_add_f32_dpp v101, v101, v101 row_ror:8 row_mask:0xf bank_mask:0xf
    v_add_f32_dpp v102, v102, v102 row_ror:8 row_mask:0xf bank_mask:0xf
    v_add_f32_dpp v103, v103, v103 row_ror:8 row_mask:0xf bank_mask:0xf
    v_add_f32_dpp v104, v104, v104 row_ror:8 row_mask:0xf bank_mask:0xf
    v_add_f32_dpp v105, v105, v105 row_ror:8 row_mask:0xf bank_mask:0xf
    v_add_f32_dpp v100, v100, v100 row_ror:4 row_mask:0xf bank_mask:0xf
    v_add_f32_dpp v101, v101, v101 row_ror:4 row_mask:0xf bank_mask:0xf
    v_add_f32_dpp v102, v102, v102 row_ror:4 row_mask:0xf bank_mask:0xf
    v_add_f32_dpp v103, v103, v103 row_ror:4 row_mask:0xf bank_mask:0xf
    v_add_f32_dpp v104, v104, v104 row_ror:4 row_mask:0xf bank_mask:0xf
    v_add_f32_dpp v105, v105, v105 row_ror:4 row_mask:0xf bank_mask:0xf
    v_add_f32_dpp v100, v100, v100 row_ror:2 row_mask:0xf bank_mask:0xf
    v_add_f32_dpp v101, v101, v101 row_ror:2 row_mask:0xf bank_mask:0xf
    v_add_f32_dpp v102, v102, v102 row_ror:2 row_mask:0xf bank_mask:0xf
    v_add_f32_dpp v103, v103, v103 row_ror:2 row_mask:0xf bank_mask:0xf
    v_add_f32_dpp v104, v104, v104 row_ror:2 row_mask:0xf bank_mask:0xf
    v_add_f32_dpp v105, v105, v105 row_ror:2 row_mask:0xf bank_mask:0xf
    v_add_f32_dpp v100, v100, v100 row_ror:1 row_mask:0xf bank_mask:0xf
    v_add_f32_dpp v101, v101, v101 row_ror:1 row_mask:0xf bank_mask:0xf
    v_add_f32_dpp v102, v102, v102 row_ror:1 row_mask:0xf bank_mask:0xf
    v_add_f32_dpp v103, v103, v103 row_ror:1 row_mask:0xf bank_mask:0xf
    v_add_f32_dpp v104, v104, v104 row_ror:1 row_mask:0xf bank_mask:0xf
    v_add_f32_dpp v105, v105, v105 row_ror:1 row_mask:0xf bank_mask:0xf
    v_cmp_eq_u32 vcc, 1, v5
    s_nop 1
    v_cndmask_b32 v100, v100, v101, vcc
    v_cmp_eq_u32 vcc, 2, v5
    s_nop 1
    v_cndmask_b32 v100, v100, v102, vcc
    v_cmp_eq_u32 vcc, 3, v5
    s_nop 1
    v_cndmask_b32 v100, v100, v103, vcc
    v_cmp_eq_u32 vcc, 4, v5
    s_nop 1
    v_cndmask_b32 v100, v100, v104, vcc
    v_cmp_eq_u32 vcc, 5, v5
    s_nop 1
    v_cndmask_b32 v100, v100, v105, vcc
    s_mul_i32 s48, s62, 768
    s_lshl_b32 s49, s49, 2
    s_add_u32 s48, s48, s49
    s_add_u32 s48, s48, 1179648
    s_mov_b32 exec_lo, 0x003f003f
    s_mov_b32 exec_hi, 0x003f003f
    buffer_store_dword v100, v13, s[12:15], s48 offen sc1
    s_mov_b64 exec, -1
    s_mov_b32 s60, 0x100000
L_wb1:
    s_nop 1
    ds_read_b32 v10, v2 offset:60
    s_sub_u32 s60, s60, 1
    s_cbranch_scc1 L_exit1
    s_waitcnt lgkmcnt(0)
    v_readfirstlane_b32 s48, v10
    s_cmp_lt_u32 s48, 1
    s_cbranch_scc1 L_wb1
    s_mov_b32 s61, 1
    s_lshl_b32 s62, s61, 5
    s_add_u32 s62, s62, s3
    s_lshl_b32 s63, s62, 15
    s_add_u32 s63, s63, 1
    s_mul_hi_u32 s63, s63, 0xaaaaaaab
    s_lshr_b32 s63, s63, 7
    s_mul_i32 s48, s62, 171
    s_lshr_b32 s48, s48, 9
    s_mul_i32 s48, s48, 384
    s_mul_i32 s49, s4, 24
    s_add_u32 s50, s49, s63
    s_mul_i32 s50, s50, 384
    v_add_u32 v10, s50, v7
    v_add_u32 v11, 3072, v10
    v_add_u32 v12, 6144, v10
    buffer_load_dwordx2 v[100:101], v6, s[8:11], s48 offen offset:0
    buffer_load_dwordx2 v[102:103], v6, s[8:11], s48 offen offset:128
    buffer_load_dwordx2 v[104:105], v6, s[8:11], s48 offen offset:256
    buffer_load_dwordx2 v[28:29], v10, s[92:95], 0 offen offset:0
    buffer_load_dwordx2 v[30:31], v10, s[92:95], 0 offen offset:128
    buffer_load_dwordx2 v[32:33], v10, s[92:95], 0 offen offset:256
    buffer_load_dwordx2 v[64:65], v10, s[96:99], 0 offen offset:0
    buffer_load_dwordx2 v[66:67], v10, s[96:99], 0 offen offset:128
    buffer_load_dwordx2 v[68:69], v10, s[96:99], 0 offen offset:256
    buffer_load_dwordx2 v[34:35], v10, s[92:95], 0 offen offset:1536
    buffer_load_dwordx2 v[36:37], v10, s[92:95], 0 offen offset:1664
    buffer_load_dwordx2 v[38:39], v10, s[92:95], 0 offen offset:1792
    buffer_load_dwordx2 v[70:71], v10, s[96:99], 0 offen offset:1536
    buffer_load_dwordx2 v[72:73], v10, s[96:99], 0 offen offset:1664
    buffer_load_dwordx2 v[74:75], v10, s[96:99], 0 offen offset:1792
    buffer_load_dwordx2 v[40:41], v11, s[92:95], 0 offen offset:0
    buffer_load_dwordx2 v[42:43], v11, s[92:95], 0 offen offset:128
    buffer_load_dwordx2 v[44:45], v11, s[92:95], 0 offen offset:256
    buffer_load_dwordx2 v[76:77], v11, s[96:99], 0 offen offset:0
    buffer_load_dwordx2 v[78:79], v11, s[96:99], 0 offen offset:128
    buffer_load_dwordx2 v[80:81], v11, s[96:99], 0 offen offset:256
    buffer_load_dwordx2 v[46:47], v11, s[92:95], 0 offen offset:1536
    buffer_load_dwordx2 v[48:49], v11, s[92:95], 0 offen offset:1664
    buffer_load_dwordx2 v[50:51], v11, s[92:95], 0 offen offset:1792
    buffer_load_dwordx2 v[82:83], v11, s[96:99], 0 offen offset:1536
    buffer_load_dwordx2 v[84:85], v11, s[96:99], 0 offen offset:1664
    buffer_load_dwordx2 v[86:87], v11, s[96:99], 0 offen offset:1792
    buffer_load_dwordx2 v[52:53], v12, s[92:95], 0 offen offset:0
    buffer_load_dwordx2 v[54:55], v12, s[92:95], 0 offen offset:128
    buffer_load_dwordx2 v[56:57], v12, s[92:95], 0 offen offset:256
    buffer_load_dwordx2 v[88:89], v12, s[96:99], 0 offen offset:0
    buffer_load_dwordx2 v[90:91], v12, s[96:99], 0 offen offset:128
    buffer_load_dwordx2 v[92:93], v12, s[96:99], 0 offen offset:256
    buffer_load_dwordx2 v[58:59], v12, s[92:95], 0 offen offset:1536
    buffer_load_dwordx2 v[60:61], v12, s[92:95], 0 offen offset:1664
    buffer_load_dwordx2 v[62:63], v12, s[92:95], 0 offen offset:1792
    buffer_load_dwordx2 v[94:95], v12, s[96:99], 0 offen offset:1536
    buffer_load_dwordx2 v[96:97], v12, s[96:99], 0 offen offset:1664
    buffer_load_dwordx2 v[98:99], v12, s[96:99], 0 offen offset:1792
    s_waitcnt vmcnt(0)
    v_lshlrev_b32 v16, 16, v100
    v_and_b32 v17, 0xffff0000, v100
    v_lshlrev_b32 v18, 16, v101
    v_and_b32 v19, 0xffff0000, v101
    v_lshlrev_b32 v20, 16, v102
    v_and_b32 v21, 0xffff0000, v102
    v_lshlrev_b32 v22, 16, v103
    v_and_b32 v23, 0xffff0000, v103
    v_lshlrev_b32 v24, 16, v104
    v_and_b32 v25, 0xffff0000, v104
    v_lshlrev_b32 v26, 16, v105
    v_and_b32 v27, 0xffff0000, v105
    v_lshlrev_b32 v10, 16, v28
    v_lshlrev_b32 v11, 16, v64
    v_and_b32 v28, 0xffff0000, v28
    v_and_b32 v64, 0xffff0000, v64
    v_mul_f32 v10, v10, v16
    v_mul_f32 v28, v28, v17
    v_mul_f32 v100, v10, v11
    v_fmac_f32 v100, v28, v64
    v_lshlrev_b32 v10, 16, v29
    v_lshlrev_b32 v11, 16, v65
    v_and_b32 v29, 0xffff0000, v29
    v_and_b32 v65, 0xffff0000, v65
    v_mul_f32 v10, v10, v18
    v_mul_f32 v29, v29, v19
    v_fmac_f32 v100, v10, v11
    v_fmac_f32 v100, v29, v65
    v_lshlrev_b32 v10, 16, v30
    v_lshlrev_b32 v11, 16, v66
    v_and_b32 v30, 0xffff0000, v30
    v_and_b32 v66, 0xffff0000, v66
    v_mul_f32 v10, v10, v20
    v_mul_f32 v30, v30, v21
    v_fmac_f32 v100, v10, v11
    v_fmac_f32 v100, v30, v66
    v_lshlrev_b32 v10, 16, v31
    v_lshlrev_b32 v11, 16, v67
    v_and_b32 v31, 0xffff0000, v31
    v_and_b32 v67, 0xffff0000, v67
    v_mul_f32 v10, v10, v22
    v_mul_f32 v31, v31, v23
    v_fmac_f32 v100, v10, v11
    v_fmac_f32 v100, v31, v67
    v_lshlrev_b32 v10, 16, v32
    v_lshlrev_b32 v11, 16, v68
    v_and_b32 v32, 0xffff0000, v32
    v_and_b32 v68, 0xffff0000, v68
    v_mul_f32 v10, v10, v24
    v_mul_f32 v32, v32, v25
    v_fmac_f32 v100, v10, v11
    v_fmac_f32 v100, v32, v68
    v_lshlrev_b32 v10, 16, v33
    v_lshlrev_b32 v11, 16, v69
    v_and_b32 v33, 0xffff0000, v33
    v_and_b32 v69, 0xffff0000, v69
    v_mul_f32 v10, v10, v26
    v_mul_f32 v33, v33, v27
    v_fmac_f32 v100, v10, v11
    v_fmac_f32 v100, v33, v69
    v_lshlrev_b32 v10, 16, v34
    v_lshlrev_b32 v11, 16, v70
    v_and_b32 v34, 0xffff0000, v34
    v_and_b32 v70, 0xffff0000, v70
    v_mul_f32 v10, v10, v16
    v_mul_f32 v34, v34, v17
    v_mul_f32 v101, v10, v11
    v_fmac_f32 v101, v34, v70
    v_lshlrev_b32 v10, 16, v35
    v_lshlrev_b32 v11, 16, v71
    v_and_b32 v35, 0xffff0000, v35
    v_and_b32 v71, 0xffff0000, v71
    v_mul_f32 v10, v10, v18
    v_mul_f32 v35, v35, v19
    v_fmac_f32 v101, v10, v11
    v_fmac_f32 v101, v35, v71
    v_lshlrev_b32 v10, 16, v36
    v_lshlrev_b32 v11, 16, v72
    v_and_b32 v36, 0xffff0000, v36
    v_and_b32 v72, 0xffff0000, v72
    v_mul_f32 v10, v10, v20
    v_mul_f32 v36, v36, v21
    v_fmac_f32 v101, v10, v11
    v_fmac_f32 v101, v36, v72
    v_lshlrev_b32 v10, 16, v37
    v_lshlrev_b32 v11, 16, v73
    v_and_b32 v37, 0xffff0000, v37
    v_and_b32 v73, 0xffff0000, v73
    v_mul_f32 v10, v10, v22
    v_mul_f32 v37, v37, v23
    v_fmac_f32 v101, v10, v11
    v_fmac_f32 v101, v37, v73
    v_lshlrev_b32 v10, 16, v38
    v_lshlrev_b32 v11, 16, v74
    v_and_b32 v38, 0xffff0000, v38
    v_and_b32 v74, 0xffff0000, v74
    v_mul_f32 v10, v10, v24
    v_mul_f32 v38, v38, v25
    v_fmac_f32 v101, v10, v11
    v_fmac_f32 v101, v38, v74
    v_lshlrev_b32 v10, 16, v39
    v_lshlrev_b32 v11, 16, v75
    v_and_b32 v39, 0xffff0000, v39
    v_and_b32 v75, 0xffff0000, v75
    v_mul_f32 v10, v10, v26
    v_mul_f32 v39, v39, v27
    v_fmac_f32 v101, v10, v11
    v_fmac_f32 v101, v39, v75
    v_lshlrev_b32 v10, 16, v40
    v_lshlrev_b32 v11, 16, v76
    v_and_b32 v40, 0xffff0000, v40
    v_and_b32 v76, 0xffff0000, v76
    v_mul_f32 v10, v10, v16
    v_mul_f32 v40, v40, v17
    v_mul_f32 v102, v10, v11
    v_fmac_f32 v102, v40, v76
    v_lshlrev_b32 v10, 16, v41
    v_lshlrev_b32 v11, 16, v77
    v_and_b32 v41, 0xffff0000, v41
    v_and_b32 v77, 0xffff0000, v77
    v_mul_f32 v10, v10, v18
    v_mul_f32 v41, v41, v19
    v_fmac_f32 v102, v10, v11
    v_fmac_f32 v102, v41, v77
    v_lshlrev_b32 v10, 16, v42
    v_lshlrev_b32 v11, 16, v78
    v_and_b32 v42, 0xffff0000, v42
    v_and_b32 v78, 0xffff0000, v78
    v_mul_f32 v10, v10, v20
    v_mul_f32 v42, v42, v21
    v_fmac_f32 v102, v10, v11
    v_fmac_f32 v102, v42, v78
    v_lshlrev_b32 v10, 16, v43
    v_lshlrev_b32 v11, 16, v79
    v_and_b32 v43, 0xffff0000, v43
    v_and_b32 v79, 0xffff0000, v79
    v_mul_f32 v10, v10, v22
    v_mul_f32 v43, v43, v23
    v_fmac_f32 v102, v10, v11
    v_fmac_f32 v102, v43, v79
    v_lshlrev_b32 v10, 16, v44
    v_lshlrev_b32 v11, 16, v80
    v_and_b32 v44, 0xffff0000, v44
    v_and_b32 v80, 0xffff0000, v80
    v_mul_f32 v10, v10, v24
    v_mul_f32 v44, v44, v25
    v_fmac_f32 v102, v10, v11
    v_fmac_f32 v102, v44, v80
    v_lshlrev_b32 v10, 16, v45
    v_lshlrev_b32 v11, 16, v81
    v_and_b32 v45, 0xffff0000, v45
    v_and_b32 v81, 0xffff0000, v81
    v_mul_f32 v10, v10, v26
    v_mul_f32 v45, v45, v27
    v_fmac_f32 v102, v10, v11
    v_fmac_f32 v102, v45, v81
    v_lshlrev_b32 v10, 16, v46
    v_lshlrev_b32 v11, 16, v82
    v_and_b32 v46, 0xffff0000, v46
    v_and_b32 v82, 0xffff0000, v82
    v_mul_f32 v10, v10, v16
    v_mul_f32 v46, v46, v17
    v_mul_f32 v103, v10, v11
    v_fmac_f32 v103, v46, v82
    v_lshlrev_b32 v10, 16, v47
    v_lshlrev_b32 v11, 16, v83
    v_and_b32 v47, 0xffff0000, v47
    v_and_b32 v83, 0xffff0000, v83
    v_mul_f32 v10, v10, v18
    v_mul_f32 v47, v47, v19
    v_fmac_f32 v103, v10, v11
    v_fmac_f32 v103, v47, v83
    v_lshlrev_b32 v10, 16, v48
    v_lshlrev_b32 v11, 16, v84
    v_and_b32 v48, 0xffff0000, v48
    v_and_b32 v84, 0xffff0000, v84
    v_mul_f32 v10, v10, v20
    v_mul_f32 v48, v48, v21
    v_fmac_f32 v103, v10, v11
    v_fmac_f32 v103, v48, v84
    v_lshlrev_b32 v10, 16, v49
    v_lshlrev_b32 v11, 16, v85
    v_and_b32 v49, 0xffff0000, v49
    v_and_b32 v85, 0xffff0000, v85
    v_mul_f32 v10, v10, v22
    v_mul_f32 v49, v49, v23
    v_fmac_f32 v103, v10, v11
    v_fmac_f32 v103, v49, v85
    v_lshlrev_b32 v10, 16, v50
    v_lshlrev_b32 v11, 16, v86
    v_and_b32 v50, 0xffff0000, v50
    v_and_b32 v86, 0xffff0000, v86
    v_mul_f32 v10, v10, v24
    v_mul_f32 v50, v50, v25
    v_fmac_f32 v103, v10, v11
    v_fmac_f32 v103, v50, v86
    v_lshlrev_b32 v10, 16, v51
    v_lshlrev_b32 v11, 16, v87
    v_and_b32 v51, 0xffff0000, v51
    v_and_b32 v87, 0xffff0000, v87
    v_mul_f32 v10, v10, v26
    v_mul_f32 v51, v51, v27
    v_fmac_f32 v103, v10, v11
    v_fmac_f32 v103, v51, v87
    v_lshlrev_b32 v10, 16, v52
    v_lshlrev_b32 v11, 16, v88
    v_and_b32 v52, 0xffff0000, v52
    v_and_b32 v88, 0xffff0000, v88
    v_mul_f32 v10, v10, v16
    v_mul_f32 v52, v52, v17
    v_mul_f32 v104, v10, v11
    v_fmac_f32 v104, v52, v88
    v_lshlrev_b32 v10, 16, v53
    v_lshlrev_b32 v11, 16, v89
    v_and_b32 v53, 0xffff0000, v53
    v_and_b32 v89, 0xffff0000, v89
    v_mul_f32 v10, v10, v18
    v_mul_f32 v53, v53, v19
    v_fmac_f32 v104, v10, v11
    v_fmac_f32 v104, v53, v89
    v_lshlrev_b32 v10, 16, v54
    v_lshlrev_b32 v11, 16, v90
    v_and_b32 v54, 0xffff0000, v54
    v_and_b32 v90, 0xffff0000, v90
    v_mul_f32 v10, v10, v20
    v_mul_f32 v54, v54, v21
    v_fmac_f32 v104, v10, v11
    v_fmac_f32 v104, v54, v90
    v_lshlrev_b32 v10, 16, v55
    v_lshlrev_b32 v11, 16, v91
    v_and_b32 v55, 0xffff0000, v55
    v_and_b32 v91, 0xffff0000, v91
    v_mul_f32 v10, v10, v22
    v_mul_f32 v55, v55, v23
    v_fmac_f32 v104, v10, v11
    v_fmac_f32 v104, v55, v91
    v_lshlrev_b32 v10, 16, v56
    v_lshlrev_b32 v11, 16, v92
    v_and_b32 v56, 0xffff0000, v56
    v_and_b32 v92, 0xffff0000, v92
    v_mul_f32 v10, v10, v24
    v_mul_f32 v56, v56, v25
    v_fmac_f32 v104, v10, v11
    v_fmac_f32 v104, v56, v92
    v_lshlrev_b32 v10, 16, v57
    v_lshlrev_b32 v11, 16, v93
    v_and_b32 v57, 0xffff0000, v57
    v_and_b32 v93, 0xffff0000, v93
    v_mul_f32 v10, v10, v26
    v_mul_f32 v57, v57, v27
    v_fmac_f32 v104, v10, v11
    v_fmac_f32 v104, v57, v93
    v_lshlrev_b32 v10, 16, v58
    v_lshlrev_b32 v11, 16, v94
    v_and_b32 v58, 0xffff0000, v58
    v_and_b32 v94, 0xffff0000, v94
    v_mul_f32 v10, v10, v16
    v_mul_f32 v58, v58, v17
    v_mul_f32 v105, v10, v11
    v_fmac_f32 v105, v58, v94
    v_lshlrev_b32 v10, 16, v59
    v_lshlrev_b32 v11, 16, v95
    v_and_b32 v59, 0xffff0000, v59
    v_and_b32 v95, 0xffff0000, v95
    v_mul_f32 v10, v10, v18
    v_mul_f32 v59, v59, v19
    v_fmac_f32 v105, v10, v11
    v_fmac_f32 v105, v59, v95
    v_lshlrev_b32 v10, 16, v60
    v_lshlrev_b32 v11, 16, v96
    v_and_b32 v60, 0xffff0000, v60
    v_and_b32 v96, 0xffff0000, v96
    v_mul_f32 v10, v10, v20
    v_mul_f32 v60, v60, v21
    v_fmac_f32 v105, v10, v11
    v_fmac_f32 v105, v60, v96
    v_lshlrev_b32 v10, 16, v61
    v_lshlrev_b32 v11, 16, v97
    v_and_b32 v61, 0xffff0000, v61
    v_and_b32 v97, 0xffff0000, v97
    v_mul_f32 v10, v10, v22
    v_mul_f32 v61, v61, v23
    v_fmac_f32 v105, v10, v11
    v_fmac_f32 v105, v61, v97
    v_lshlrev_b32 v10, 16, v62
    v_lshlrev_b32 v11, 16, v98
    v_and_b32 v62, 0xffff0000, v62
    v_and_b32 v98, 0xffff0000, v98
    v_mul_f32 v10, v10, v24
    v_mul_f32 v62, v62, v25
    v_fmac_f32 v105, v10, v11
    v_fmac_f32 v105, v62, v98
    v_lshlrev_b32 v10, 16, v63
    v_lshlrev_b32 v11, 16, v99
    v_and_b32 v63, 0xffff0000, v63
    v_and_b32 v99, 0xffff0000, v99
    v_mul_f32 v10, v10, v26
    v_mul_f32 v63, v63, v27
    v_fmac_f32 v105, v10, v11
    v_fmac_f32 v105, v63, v99
    v_add_f32_dpp v100, v100, v100 row_ror:8 row_mask:0xf bank_mask:0xf
    v_add_f32_dpp v101, v101, v101 row_ror:8 row_mask:0xf bank_mask:0xf
    v_add_f32_dpp v102, v102, v102 row_ror:8 row_mask:0xf bank_mask:0xf
    v_add_f32_dpp v103, v103, v103 row_ror:8 row_mask:0xf bank_mask:0xf
    v_add_f32_dpp v104, v104, v104 row_ror:8 row_mask:0xf bank_mask:0xf
    v_add_f32_dpp v105, v105, v105 row_ror:8 row_mask:0xf bank_mask:0xf
    v_add_f32_dpp v100, v100, v100 row_ror:4 row_mask:0xf bank_mask:0xf
    v_add_f32_dpp v101, v101, v101 row_ror:4 row_mask:0xf bank_mask:0xf
    v_add_f32_dpp v102, v102, v102 row_ror:4 row_mask:0xf bank_mask:0xf
    v_add_f32_dpp v103, v103, v103 row_ror:4 row_mask:0xf bank_mask:0xf
    v_add_f32_dpp v104, v104, v104 row_ror:4 row_mask:0xf bank_mask:0xf
    v_add_f32_dpp v105, v105, v105 row_ror:4 row_mask:0xf bank_mask:0xf
    v_add_f32_dpp v100, v100, v100 row_ror:2 row_mask:0xf bank_mask:0xf
    v_add_f32_dpp v101, v101, v101 row_ror:2 row_mask:0xf bank_mask:0xf
    v_add_f32_dpp v102, v102, v102 row_ror:2 row_mask:0xf bank_mask:0xf
    v_add_f32_dpp v103, v103, v103 row_ror:2 row_mask:0xf bank_mask:0xf
    v_add_f32_dpp v104, v104, v104 row_ror:2 row_mask:0xf bank_mask:0xf
    v_add_f32_dpp v105, v105, v105 row_ror:2 row_mask:0xf bank_mask:0xf
    v_add_f32_dpp v100, v100, v100 row_ror:1 row_mask:0xf bank_mask:0xf
    v_add_f32_dpp v101, v101, v101 row_ror:1 row_mask:0xf bank_mask:0xf
    v_add_f32_dpp v102, v102, v102 row_ror:1 row_mask:0xf bank_mask:0xf
    v_add_f32_dpp v103, v103, v103 row_ror:1 row_mask:0xf bank_mask:0xf
    v_add_f32_dpp v104, v104, v104 row_ror:1 row_mask:0xf bank_mask:0xf
    v_add_f32_dpp v105, v105, v105 row_ror:1 row_mask:0xf bank_mask:0xf
    v_cmp_eq_u32 vcc, 1, v5
    s_nop 1
    v_cndmask_b32 v100, v100, v101, vcc
    v_cmp_eq_u32 vcc, 2, v5
    s_nop 1
    v_cndmask_b32 v100, v100, v102, vcc
    v_cmp_eq_u32 vcc, 3, v5
    s_nop 1
    v_cndmask_b32 v100, v100, v103, vcc
    v_cmp_eq_u32 vcc, 4, v5
    s_nop 1
    v_cndmask_b32 v100, v100, v104, vcc
    v_cmp_eq_u32 vcc, 5, v5
    s_nop 1
    v_cndmask_b32 v100, v100, v105, vcc
    s_mul_i32 s48, s62, 768
    s_lshl_b32 s49, s49, 2
    s_add_u32 s48, s48, s49
    s_add_u32 s48, s48, 1179648
    s_mov_b32 exec_lo, 0x003f003f
    s_mov_b32 exec_hi, 0x003f003f
    buffer_store_dword v100, v13, s[12:15], s48 offen sc1
    s_mov_b64 exec, -1
    s_mov_b32 s60, 0x100000
L_wd0:
    s_nop 1
    ds_read_b32 v10, v2 offset:20
    s_sub_u32 s60, s60, 1
    s_cbranch_scc1 L_exit1
    s_waitcnt lgkmcnt(0)
    v_readfirstlane_b32 s48, v10
    s_cmp_eq_u32 s48, 0
    s_cbranch_scc1 L_wd0
    ds_read_b128 v[16:19], v2 offset:0
    ds_read_b64 v[20:21], v2 offset:16
    s_waitcnt lgkmcnt(0)
    v_readfirstlane_b32 s84, v16
    v_readfirstlane_b32 s85, v17
    v_readfirstlane_b32 s86, v18
    v_readfirstlane_b32 s87, v19
    v_readfirstlane_b32 s88, v20
    v_readfirstlane_b32 s89, v21
    s_mov_b32 s60, 0x100000
L_wf0:
    s_nop 1
    ds_read_b32 v10, v2 offset:40
    s_sub_u32 s60, s60, 1
    s_cbranch_scc1 L_exit1
    s_waitcnt lgkmcnt(0)
    v_readfirstlane_b32 s48, v10
    s_cmp_lt_u32 s48, 4
    s_cbranch_scc1 L_wf0
    s_cmp_eq_u32 s84, s87
    ds_read_b64 v[16:17], v8 offset:256
    ds_read_b64 v[18:19], v8 offset:264
    ds_read_b64 v[20:21], v8 offset:272
    ds_read_b64 v[28:29], v8 offset:448
    ds_read_b64 v[30:31], v8 offset:456
    ds_read_b64 v[32:33], v8 offset:464
    ds_read_b64 v[40:41], v8 offset:640
    ds_read_b64 v[42:43], v8 offset:648
    ds_read_b64 v[44:45], v8 offset:656
    ds_read_b64 v[52:53], v8 offset:832
    ds_read_b64 v[54:55], v8 offset:840
    ds_read_b64 v[56:57], v8 offset:848
    s_add_u32 s54, s33, 0
    s_cmp_eq_u32 s84, s87
    s_waitcnt lgkmcnt(0)
    v_cmp_eq_f32 vcc, 0, v21
    v_max3_f32 v25, v16, v17, v18
    s_nop 0
    v_cndmask_b32 v24, v21, v20, vcc
    v_max3_f32 v25, v25, v19, v20
    v_max_f32 v24, v24, v25
    v_sub_f32 v16, v16, v24
    v_sub_f32 v17, v17, v24
    v_sub_f32 v18, v18, v24
    v_sub_f32 v19, v19, v24
    v_sub_f32 v20, v20, v24
    v_sub_f32 v21, v21, v24
    v_cvt_pk_f16_f32 v25, v16, v17
    v_cvt_pk_f16_f32 v26, v18, v19
    v_cvt_pk_f16_f32 v27, v20, v21
    buffer_store_dwordx4 v[24:27], v14, s[12:15], s54 offen offset:0 sc1
    s_cbranch_scc1 L_fl0
    v_cmp_eq_f32 vcc, 0, v33
    v_max3_f32 v37, v28, v29, v30
    s_nop 0
    v_cndmask_b32 v36, v33, v32, vcc
    v_max3_f32 v37, v37, v31, v32
    v_max_f32 v36, v36, v37
    v_sub_f32 v28, v28, v36
    v_sub_f32 v29, v29, v36
    v_sub_f32 v30, v30, v36
    v_sub_f32 v31, v31, v36
    v_sub_f32 v32, v32, v36
    v_sub_f32 v33, v33, v36
    v_cvt_pk_f16_f32 v37, v28, v29
    v_cvt_pk_f16_f32 v38, v30, v31
    v_cvt_pk_f16_f32 v39, v32, v33
    buffer_store_dwordx4 v[36:39], v14, s[12:15], s54 offen offset:1024 sc1
    v_cmp_eq_f32 vcc, 0, v45
    v_max3_f32 v49, v40, v41, v42
    s_nop 0
    v_cndmask_b32 v48, v45, v44, vcc
    v_max3_f32 v49, v49, v43, v44
    v_max_f32 v48, v48, v49
    v_sub_f32 v40, v40, v48
    v_sub_f32 v41, v41, v48
    v_sub_f32 v42, v42, v48
    v_sub_f32 v43, v43, v48
    v_sub_f32 v44, v44, v48
    v_sub_f32 v45, v45, v48
    v_cvt_pk_f16_f32 v49, v40, v41
    v_cvt_pk_f16_f32 v50, v42, v43
    v_cvt_pk_f16_f32 v51, v44, v45
    buffer_store_dwordx4 v[48:51], v14, s[12:15], s54 offen offset:2048 sc1
    v_cmp_eq_f32 vcc, 0, v57
    v_max3_f32 v61, v52, v53, v54
    s_nop 0
    v_cndmask_b32 v60, v57, v56, vcc
    v_max3_f32 v61, v61, v55, v56
    v_max_f32 v60, v60, v61
    v_sub_f32 v52, v52, v60
    v_sub_f32 v53, v53, v60
    v_sub_f32 v54, v54, v60
    v_sub_f32 v55, v55, v60
    v_sub_f32 v56, v56, v60
    v_sub_f32 v57, v57, v60
    v_cvt_pk_f16_f32 v61, v52, v53
    v_cvt_pk_f16_f32 v62, v54, v55
    v_cvt_pk_f16_f32 v63, v56, v57
    buffer_store_dwordx4 v[60:63], v14, s[12:15], s54 offen offset:3072 sc1
L_fl0:
    s_nop 1
    v_mov_b32 v10, 1
    s_waitcnt vmcnt(0)
    s_mov_b64 exec, 1
    buffer_store_dword v10, off, s[12:15], s32 sc1
    ds_write_b32 v2, v10 offset:52
    s_mov_b64 exec, -1
    s_mov_b32 s60, 0x100000
L_wb2:
    s_nop 1
    ds_read_b32 v10, v2 offset:60
    s_sub_u32 s60, s60, 1
    s_cbranch_scc1 L_exit1
    s_waitcnt lgkmcnt(0)
    v_readfirstlane_b32 s48, v10
    s_cmp_lt_u32 s48, 9
    s_cbranch_scc1 L_wb2
    s_mov_b32 s61, 2
    s_lshl_b32 s62, s61, 5
    s_add_u32 s62, s62, s3
    s_lshl_b32 s63, s62, 15
    s_add_u32 s63, s63, 1
    s_mul_hi_u32 s63, s63, 0xaaaaaaab
    s_lshr_b32 s63, s63, 7
    s_mul_i32 s48, s62, 171
    s_lshr_b32 s48, s48, 9
    s_mul_i32 s48, s48, 384
    s_mul_i32 s49, s4, 24
    s_add_u32 s50, s49, s63
    s_mul_i32 s50, s50, 384
    v_add_u32 v10, s50, v7
    v_add_u32 v11, 3072, v10
    v_add_u32 v12, 6144, v10
    buffer_load_dwordx2 v[100:101], v6, s[8:11], s48 offen offset:0
    buffer_load_dwordx2 v[102:103], v6, s[8:11], s48 offen offset:128
    buffer_load_dwordx2 v[104:105], v6, s[8:11], s48 offen offset:256
    buffer_load_dwordx2 v[28:29], v10, s[92:95], 0 offen offset:0
    buffer_load_dwordx2 v[30:31], v10, s[92:95], 0 offen offset:128
    buffer_load_dwordx2 v[32:33], v10, s[92:95], 0 offen offset:256
    buffer_load_dwordx2 v[64:65], v10, s[96:99], 0 offen offset:0
    buffer_load_dwordx2 v[66:67], v10, s[96:99], 0 offen offset:128
    buffer_load_dwordx2 v[68:69], v10, s[96:99], 0 offen offset:256
    buffer_load_dwordx2 v[34:35], v10, s[92:95], 0 offen offset:1536
    buffer_load_dwordx2 v[36:37], v10, s[92:95], 0 offen offset:1664
    buffer_load_dwordx2 v[38:39], v10, s[92:95], 0 offen offset:1792
    buffer_load_dwordx2 v[70:71], v10, s[96:99], 0 offen offset:1536
    buffer_load_dwordx2 v[72:73], v10, s[96:99], 0 offen offset:1664
    buffer_load_dwordx2 v[74:75], v10, s[96:99], 0 offen offset:1792
    buffer_load_dwordx2 v[40:41], v11, s[92:95], 0 offen offset:0
    buffer_load_dwordx2 v[42:43], v11, s[92:95], 0 offen offset:128
    buffer_load_dwordx2 v[44:45], v11, s[92:95], 0 offen offset:256
    buffer_load_dwordx2 v[76:77], v11, s[96:99], 0 offen offset:0
    buffer_load_dwordx2 v[78:79], v11, s[96:99], 0 offen offset:128
    buffer_load_dwordx2 v[80:81], v11, s[96:99], 0 offen offset:256
    buffer_load_dwordx2 v[46:47], v11, s[92:95], 0 offen offset:1536
    buffer_load_dwordx2 v[48:49], v11, s[92:95], 0 offen offset:1664
    buffer_load_dwordx2 v[50:51], v11, s[92:95], 0 offen offset:1792
    buffer_load_dwordx2 v[82:83], v11, s[96:99], 0 offen offset:1536
    buffer_load_dwordx2 v[84:85], v11, s[96:99], 0 offen offset:1664
    buffer_load_dwordx2 v[86:87], v11, s[96:99], 0 offen offset:1792
    buffer_load_dwordx2 v[52:53], v12, s[92:95], 0 offen offset:0
    buffer_load_dwordx2 v[54:55], v12, s[92:95], 0 offen offset:128
    buffer_load_dwordx2 v[56:57], v12, s[92:95], 0 offen offset:256
    buffer_load_dwordx2 v[88:89], v12, s[96:99], 0 offen offset:0
    buffer_load_dwordx2 v[90:91], v12, s[96:99], 0 offen offset:128
    buffer_load_dwordx2 v[92:93], v12, s[96:99], 0 offen offset:256
    buffer_load_dwordx2 v[58:59], v12, s[92:95], 0 offen offset:1536
    buffer_load_dwordx2 v[60:61], v12, s[92:95], 0 offen offset:1664
    buffer_load_dwordx2 v[62:63], v12, s[92:95], 0 offen offset:1792
    buffer_load_dwordx2 v[94:95], v12, s[96:99], 0 offen offset:1536
    buffer_load_dwordx2 v[96:97], v12, s[96:99], 0 offen offset:1664
    buffer_load_dwordx2 v[98:99], v12, s[96:99], 0 offen offset:1792
    s_waitcnt vmcnt(0)
    v_lshlrev_b32 v16, 16, v100
    v_and_b32 v17, 0xffff0000, v100
    v_lshlrev_b32 v18, 16, v101
    v_and_b32 v19, 0xffff0000, v101
    v_lshlrev_b32 v20, 16, v102
    v_and_b32 v21, 0xffff0000, v102
    v_lshlrev_b32 v22, 16, v103
    v_and_b32 v23, 0xffff0000, v103
    v_lshlrev_b32 v24, 16, v104
    v_and_b32 v25, 0xffff0000, v104
    v_lshlrev_b32 v26, 16, v105
    v_and_b32 v27, 0xffff0000, v105
    v_lshlrev_b32 v10, 16, v28
    v_lshlrev_b32 v11, 16, v64
    v_and_b32 v28, 0xffff0000, v28
    v_and_b32 v64, 0xffff0000, v64
    v_mul_f32 v10, v10, v16
    v_mul_f32 v28, v28, v17
    v_mul_f32 v100, v10, v11
    v_fmac_f32 v100, v28, v64
    v_lshlrev_b32 v10, 16, v29
    v_lshlrev_b32 v11, 16, v65
    v_and_b32 v29, 0xffff0000, v29
    v_and_b32 v65, 0xffff0000, v65
    v_mul_f32 v10, v10, v18
    v_mul_f32 v29, v29, v19
    v_fmac_f32 v100, v10, v11
    v_fmac_f32 v100, v29, v65
    v_lshlrev_b32 v10, 16, v30
    v_lshlrev_b32 v11, 16, v66
    v_and_b32 v30, 0xffff0000, v30
    v_and_b32 v66, 0xffff0000, v66
    v_mul_f32 v10, v10, v20
    v_mul_f32 v30, v30, v21
    v_fmac_f32 v100, v10, v11
    v_fmac_f32 v100, v30, v66
    v_lshlrev_b32 v10, 16, v31
    v_lshlrev_b32 v11, 16, v67
    v_and_b32 v31, 0xffff0000, v31
    v_and_b32 v67, 0xffff0000, v67
    v_mul_f32 v10, v10, v22
    v_mul_f32 v31, v31, v23
    v_fmac_f32 v100, v10, v11
    v_fmac_f32 v100, v31, v67
    v_lshlrev_b32 v10, 16, v32
    v_lshlrev_b32 v11, 16, v68
    v_and_b32 v32, 0xffff0000, v32
    v_and_b32 v68, 0xffff0000, v68
    v_mul_f32 v10, v10, v24
    v_mul_f32 v32, v32, v25
    v_fmac_f32 v100, v10, v11
    v_fmac_f32 v100, v32, v68
    v_lshlrev_b32 v10, 16, v33
    v_lshlrev_b32 v11, 16, v69
    v_and_b32 v33, 0xffff0000, v33
    v_and_b32 v69, 0xffff0000, v69
    v_mul_f32 v10, v10, v26
    v_mul_f32 v33, v33, v27
    v_fmac_f32 v100, v10, v11
    v_fmac_f32 v100, v33, v69
    v_lshlrev_b32 v10, 16, v34
    v_lshlrev_b32 v11, 16, v70
    v_and_b32 v34, 0xffff0000, v34
    v_and_b32 v70, 0xffff0000, v70
    v_mul_f32 v10, v10, v16
    v_mul_f32 v34, v34, v17
    v_mul_f32 v101, v10, v11
    v_fmac_f32 v101, v34, v70
    v_lshlrev_b32 v10, 16, v35
    v_lshlrev_b32 v11, 16, v71
    v_and_b32 v35, 0xffff0000, v35
    v_and_b32 v71, 0xffff0000, v71
    v_mul_f32 v10, v10, v18
    v_mul_f32 v35, v35, v19
    v_fmac_f32 v101, v10, v11
    v_fmac_f32 v101, v35, v71
    v_lshlrev_b32 v10, 16, v36
    v_lshlrev_b32 v11, 16, v72
    v_and_b32 v36, 0xffff0000, v36
    v_and_b32 v72, 0xffff0000, v72
    v_mul_f32 v10, v10, v20
    v_mul_f32 v36, v36, v21
    v_fmac_f32 v101, v10, v11
    v_fmac_f32 v101, v36, v72
    v_lshlrev_b32 v10, 16, v37
    v_lshlrev_b32 v11, 16, v73
    v_and_b32 v37, 0xffff0000, v37
    v_and_b32 v73, 0xffff0000, v73
    v_mul_f32 v10, v10, v22
    v_mul_f32 v37, v37, v23
    v_fmac_f32 v101, v10, v11
    v_fmac_f32 v101, v37, v73
    v_lshlrev_b32 v10, 16, v38
    v_lshlrev_b32 v11, 16, v74
    v_and_b32 v38, 0xffff0000, v38
    v_and_b32 v74, 0xffff0000, v74
    v_mul_f32 v10, v10, v24
    v_mul_f32 v38, v38, v25
    v_fmac_f32 v101, v10, v11
    v_fmac_f32 v101, v38, v74
    v_lshlrev_b32 v10, 16, v39
    v_lshlrev_b32 v11, 16, v75
    v_and_b32 v39, 0xffff0000, v39
    v_and_b32 v75, 0xffff0000, v75
    v_mul_f32 v10, v10, v26
    v_mul_f32 v39, v39, v27
    v_fmac_f32 v101, v10, v11
    v_fmac_f32 v101, v39, v75
    v_lshlrev_b32 v10, 16, v40
    v_lshlrev_b32 v11, 16, v76
    v_and_b32 v40, 0xffff0000, v40
    v_and_b32 v76, 0xffff0000, v76
    v_mul_f32 v10, v10, v16
    v_mul_f32 v40, v40, v17
    v_mul_f32 v102, v10, v11
    v_fmac_f32 v102, v40, v76
    v_lshlrev_b32 v10, 16, v41
    v_lshlrev_b32 v11, 16, v77
    v_and_b32 v41, 0xffff0000, v41
    v_and_b32 v77, 0xffff0000, v77
    v_mul_f32 v10, v10, v18
    v_mul_f32 v41, v41, v19
    v_fmac_f32 v102, v10, v11
    v_fmac_f32 v102, v41, v77
    v_lshlrev_b32 v10, 16, v42
    v_lshlrev_b32 v11, 16, v78
    v_and_b32 v42, 0xffff0000, v42
    v_and_b32 v78, 0xffff0000, v78
    v_mul_f32 v10, v10, v20
    v_mul_f32 v42, v42, v21
    v_fmac_f32 v102, v10, v11
    v_fmac_f32 v102, v42, v78
    v_lshlrev_b32 v10, 16, v43
    v_lshlrev_b32 v11, 16, v79
    v_and_b32 v43, 0xffff0000, v43
    v_and_b32 v79, 0xffff0000, v79
    v_mul_f32 v10, v10, v22
    v_mul_f32 v43, v43, v23
    v_fmac_f32 v102, v10, v11
    v_fmac_f32 v102, v43, v79
    v_lshlrev_b32 v10, 16, v44
    v_lshlrev_b32 v11, 16, v80
    v_and_b32 v44, 0xffff0000, v44
    v_and_b32 v80, 0xffff0000, v80
    v_mul_f32 v10, v10, v24
    v_mul_f32 v44, v44, v25
    v_fmac_f32 v102, v10, v11
    v_fmac_f32 v102, v44, v80
    v_lshlrev_b32 v10, 16, v45
    v_lshlrev_b32 v11, 16, v81
    v_and_b32 v45, 0xffff0000, v45
    v_and_b32 v81, 0xffff0000, v81
    v_mul_f32 v10, v10, v26
    v_mul_f32 v45, v45, v27
    v_fmac_f32 v102, v10, v11
    v_fmac_f32 v102, v45, v81
    v_lshlrev_b32 v10, 16, v46
    v_lshlrev_b32 v11, 16, v82
    v_and_b32 v46, 0xffff0000, v46
    v_and_b32 v82, 0xffff0000, v82
    v_mul_f32 v10, v10, v16
    v_mul_f32 v46, v46, v17
    v_mul_f32 v103, v10, v11
    v_fmac_f32 v103, v46, v82
    v_lshlrev_b32 v10, 16, v47
    v_lshlrev_b32 v11, 16, v83
    v_and_b32 v47, 0xffff0000, v47
    v_and_b32 v83, 0xffff0000, v83
    v_mul_f32 v10, v10, v18
    v_mul_f32 v47, v47, v19
    v_fmac_f32 v103, v10, v11
    v_fmac_f32 v103, v47, v83
    v_lshlrev_b32 v10, 16, v48
    v_lshlrev_b32 v11, 16, v84
    v_and_b32 v48, 0xffff0000, v48
    v_and_b32 v84, 0xffff0000, v84
    v_mul_f32 v10, v10, v20
    v_mul_f32 v48, v48, v21
    v_fmac_f32 v103, v10, v11
    v_fmac_f32 v103, v48, v84
    v_lshlrev_b32 v10, 16, v49
    v_lshlrev_b32 v11, 16, v85
    v_and_b32 v49, 0xffff0000, v49
    v_and_b32 v85, 0xffff0000, v85
    v_mul_f32 v10, v10, v22
    v_mul_f32 v49, v49, v23
    v_fmac_f32 v103, v10, v11
    v_fmac_f32 v103, v49, v85
    v_lshlrev_b32 v10, 16, v50
    v_lshlrev_b32 v11, 16, v86
    v_and_b32 v50, 0xffff0000, v50
    v_and_b32 v86, 0xffff0000, v86
    v_mul_f32 v10, v10, v24
    v_mul_f32 v50, v50, v25
    v_fmac_f32 v103, v10, v11
    v_fmac_f32 v103, v50, v86
    v_lshlrev_b32 v10, 16, v51
    v_lshlrev_b32 v11, 16, v87
    v_and_b32 v51, 0xffff0000, v51
    v_and_b32 v87, 0xffff0000, v87
    v_mul_f32 v10, v10, v26
    v_mul_f32 v51, v51, v27
    v_fmac_f32 v103, v10, v11
    v_fmac_f32 v103, v51, v87
    v_lshlrev_b32 v10, 16, v52
    v_lshlrev_b32 v11, 16, v88
    v_and_b32 v52, 0xffff0000, v52
    v_and_b32 v88, 0xffff0000, v88
    v_mul_f32 v10, v10, v16
    v_mul_f32 v52, v52, v17
    v_mul_f32 v104, v10, v11
    v_fmac_f32 v104, v52, v88
    v_lshlrev_b32 v10, 16, v53
    v_lshlrev_b32 v11, 16, v89
    v_and_b32 v53, 0xffff0000, v53
    v_and_b32 v89, 0xffff0000, v89
    v_mul_f32 v10, v10, v18
    v_mul_f32 v53, v53, v19
    v_fmac_f32 v104, v10, v11
    v_fmac_f32 v104, v53, v89
    v_lshlrev_b32 v10, 16, v54
    v_lshlrev_b32 v11, 16, v90
    v_and_b32 v54, 0xffff0000, v54
    v_and_b32 v90, 0xffff0000, v90
    v_mul_f32 v10, v10, v20
    v_mul_f32 v54, v54, v21
    v_fmac_f32 v104, v10, v11
    v_fmac_f32 v104, v54, v90
    v_lshlrev_b32 v10, 16, v55
    v_lshlrev_b32 v11, 16, v91
    v_and_b32 v55, 0xffff0000, v55
    v_and_b32 v91, 0xffff0000, v91
    v_mul_f32 v10, v10, v22
    v_mul_f32 v55, v55, v23
    v_fmac_f32 v104, v10, v11
    v_fmac_f32 v104, v55, v91
    v_lshlrev_b32 v10, 16, v56
    v_lshlrev_b32 v11, 16, v92
    v_and_b32 v56, 0xffff0000, v56
    v_and_b32 v92, 0xffff0000, v92
    v_mul_f32 v10, v10, v24
    v_mul_f32 v56, v56, v25
    v_fmac_f32 v104, v10, v11
    v_fmac_f32 v104, v56, v92
    v_lshlrev_b32 v10, 16, v57
    v_lshlrev_b32 v11, 16, v93
    v_and_b32 v57, 0xffff0000, v57
    v_and_b32 v93, 0xffff0000, v93
    v_mul_f32 v10, v10, v26
    v_mul_f32 v57, v57, v27
    v_fmac_f32 v104, v10, v11
    v_fmac_f32 v104, v57, v93
    v_lshlrev_b32 v10, 16, v58
    v_lshlrev_b32 v11, 16, v94
    v_and_b32 v58, 0xffff0000, v58
    v_and_b32 v94, 0xffff0000, v94
    v_mul_f32 v10, v10, v16
    v_mul_f32 v58, v58, v17
    v_mul_f32 v105, v10, v11
    v_fmac_f32 v105, v58, v94
    v_lshlrev_b32 v10, 16, v59
    v_lshlrev_b32 v11, 16, v95
    v_and_b32 v59, 0xffff0000, v59
    v_and_b32 v95, 0xffff0000, v95
    v_mul_f32 v10, v10, v18
    v_mul_f32 v59, v59, v19
    v_fmac_f32 v105, v10, v11
    v_fmac_f32 v105, v59, v95
    v_lshlrev_b32 v10, 16, v60
    v_lshlrev_b32 v11, 16, v96
    v_and_b32 v60, 0xffff0000, v60
    v_and_b32 v96, 0xffff0000, v96
    v_mul_f32 v10, v10, v20
    v_mul_f32 v60, v60, v21
    v_fmac_f32 v105, v10, v11
    v_fmac_f32 v105, v60, v96
    v_lshlrev_b32 v10, 16, v61
    v_lshlrev_b32 v11, 16, v97
    v_and_b32 v61, 0xffff0000, v61
    v_and_b32 v97, 0xffff0000, v97
    v_mul_f32 v10, v10, v22
    v_mul_f32 v61, v61, v23
    v_fmac_f32 v105, v10, v11
    v_fmac_f32 v105, v61, v97
    v_lshlrev_b32 v10, 16, v62
    v_lshlrev_b32 v11, 16, v98
    v_and_b32 v62, 0xffff0000, v62
    v_and_b32 v98, 0xffff0000, v98
    v_mul_f32 v10, v10, v24
    v_mul_f32 v62, v62, v25
    v_fmac_f32 v105, v10, v11
    v_fmac_f32 v105, v62, v98
    v_lshlrev_b32 v10, 16, v63
    v_lshlrev_b32 v11, 16, v99
    v_and_b32 v63, 0xffff0000, v63
    v_and_b32 v99, 0xffff0000, v99
    v_mul_f32 v10, v10, v26
    v_mul_f32 v63, v63, v27
    v_fmac_f32 v105, v10, v11
    v_fmac_f32 v105, v63, v99
    v_add_f32_dpp v100, v100, v100 row_ror:8 row_mask:0xf bank_mask:0xf
    v_add_f32_dpp v101, v101, v101 row_ror:8 row_mask:0xf bank_mask:0xf
    v_add_f32_dpp v102, v102, v102 row_ror:8 row_mask:0xf bank_mask:0xf
    v_add_f32_dpp v103, v103, v103 row_ror:8 row_mask:0xf bank_mask:0xf
    v_add_f32_dpp v104, v104, v104 row_ror:8 row_mask:0xf bank_mask:0xf
    v_add_f32_dpp v105, v105, v105 row_ror:8 row_mask:0xf bank_mask:0xf
    v_add_f32_dpp v100, v100, v100 row_ror:4 row_mask:0xf bank_mask:0xf
    v_add_f32_dpp v101, v101, v101 row_ror:4 row_mask:0xf bank_mask:0xf
    v_add_f32_dpp v102, v102, v102 row_ror:4 row_mask:0xf bank_mask:0xf
    v_add_f32_dpp v103, v103, v103 row_ror:4 row_mask:0xf bank_mask:0xf
    v_add_f32_dpp v104, v104, v104 row_ror:4 row_mask:0xf bank_mask:0xf
    v_add_f32_dpp v105, v105, v105 row_ror:4 row_mask:0xf bank_mask:0xf
    v_add_f32_dpp v100, v100, v100 row_ror:2 row_mask:0xf bank_mask:0xf
    v_add_f32_dpp v101, v101, v101 row_ror:2 row_mask:0xf bank_mask:0xf
    v_add_f32_dpp v102, v102, v102 row_ror:2 row_mask:0xf bank_mask:0xf
    v_add_f32_dpp v103, v103, v103 row_ror:2 row_mask:0xf bank_mask:0xf
    v_add_f32_dpp v104, v104, v104 row_ror:2 row_mask:0xf bank_mask:0xf
    v_add_f32_dpp v105, v105, v105 row_ror:2 row_mask:0xf bank_mask:0xf
    v_add_f32_dpp v100, v100, v100 row_ror:1 row_mask:0xf bank_mask:0xf
    v_add_f32_dpp v101, v101, v101 row_ror:1 row_mask:0xf bank_mask:0xf
    v_add_f32_dpp v102, v102, v102 row_ror:1 row_mask:0xf bank_mask:0xf
    v_add_f32_dpp v103, v103, v103 row_ror:1 row_mask:0xf bank_mask:0xf
    v_add_f32_dpp v104, v104, v104 row_ror:1 row_mask:0xf bank_mask:0xf
    v_add_f32_dpp v105, v105, v105 row_ror:1 row_mask:0xf bank_mask:0xf
    v_cmp_eq_u32 vcc, 1, v5
    s_nop 1
    v_cndmask_b32 v100, v100, v101, vcc
    v_cmp_eq_u32 vcc, 2, v5
    s_nop 1
    v_cndmask_b32 v100, v100, v102, vcc
    v_cmp_eq_u32 vcc, 3, v5
    s_nop 1
    v_cndmask_b32 v100, v100, v103, vcc
    v_cmp_eq_u32 vcc, 4, v5
    s_nop 1
    v_cndmask_b32 v100, v100, v104, vcc
    v_cmp_eq_u32 vcc, 5, v5
    s_nop 1
    v_cndmask_b32 v100, v100, v105, vcc
    s_mul_i32 s48, s62, 768
    s_lshl_b32 s49, s49, 2
    s_add_u32 s48, s48, s49
    s_add_u32 s48, s48, 1179648
    s_mov_b32 exec_lo, 0x003f003f
    s_mov_b32 exec_hi, 0x003f003f
    buffer_store_dword v100, v13, s[12:15], s48 offen sc1
    s_mov_b64 exec, -1
    s_mov_b32 s60, 0x100000
L_wf1:
    s_nop 1
    ds_read_b32 v10, v2 offset:44
    s_sub_u32 s60, s60, 1
    s_cbranch_scc1 L_exit1
    s_waitcnt lgkmcnt(0)
    v_readfirstlane_b32 s48, v10
    s_cmp_lt_u32 s48, 4
    s_cbranch_scc1 L_wf1
    s_cmp_eq_u32 s85, s88
    s_cbranch_scc1 L_fl1
    ds_read_b64 v[16:17], v8 offset:6400
    ds_read_b64 v[18:19], v8 offset:6408
    ds_read_b64 v[20:21], v8 offset:6416
    ds_read_b64 v[28:29], v8 offset:6592
    ds_read_b64 v[30:31], v8 offset:6600
    ds_read_b64 v[32:33], v8 offset:6608
    ds_read_b64 v[40:41], v8 offset:6784
    ds_read_b64 v[42:43], v8 offset:6792
    ds_read_b64 v[44:45], v8 offset:6800
    ds_read_b64 v[52:53], v8 offset:6976
    ds_read_b64 v[54:55], v8 offset:6984
    ds_read_b64 v[56:57], v8 offset:6992
    s_add_u32 s54, s33, 1048576
    s_cmp_eq_u32 s85, s88
    s_waitcnt lgkmcnt(0)
    v_cmp_eq_f32 vcc, 0, v21
    v_max3_f32 v25, v16, v17, v18
    s_nop 0
    v_cndmask_b32 v24, v21, v20, vcc
    v_max3_f32 v25, v25, v19, v20
    v_max_f32 v24, v24, v25
    v_sub_f32 v16, v16, v24
    v_sub_f32 v17, v17, v24
    v_sub_f32 v18, v18, v24
    v_sub_f32 v19, v19, v24
    v_sub_f32 v20, v20, v24
    v_sub_f32 v21, v21, v24
    v_cvt_pk_f16_f32 v25, v16, v17
    v_cvt_pk_f16_f32 v26, v18, v19
    v_cvt_pk_f16_f32 v27, v20, v21
    buffer_store_dwordx4 v[24:27], v14, s[12:15], s54 offen offset:0 sc1
    v_cmp_eq_f32 vcc, 0, v33
    v_max3_f32 v37, v28, v29, v30
    s_nop 0
    v_cndmask_b32 v36, v33, v32, vcc
    v_max3_f32 v37, v37, v31, v32
    v_max_f32 v36, v36, v37
    v_sub_f32 v28, v28, v36
    v_sub_f32 v29, v29, v36
    v_sub_f32 v30, v30, v36
    v_sub_f32 v31, v31, v36
    v_sub_f32 v32, v32, v36
    v_sub_f32 v33, v33, v36
    v_cvt_pk_f16_f32 v37, v28, v29
    v_cvt_pk_f16_f32 v38, v30, v31
    v_cvt_pk_f16_f32 v39, v32, v33
    buffer_store_dwordx4 v[36:39], v14, s[12:15], s54 offen offset:1024 sc1
    v_cmp_eq_f32 vcc, 0, v45
    v_max3_f32 v49, v40, v41, v42
    s_nop 0
    v_cndmask_b32 v48, v45, v44, vcc
    v_max3_f32 v49, v49, v43, v44
    v_max_f32 v48, v48, v49
    v_sub_f32 v40, v40, v48
    v_sub_f32 v41, v41, v48
    v_sub_f32 v42, v42, v48
    v_sub_f32 v43, v43, v48
    v_sub_f32 v44, v44, v48
    v_sub_f32 v45, v45, v48
    v_cvt_pk_f16_f32 v49, v40, v41
    v_cvt_pk_f16_f32 v50, v42, v43
    v_cvt_pk_f16_f32 v51, v44, v45
    buffer_store_dwordx4 v[48:51], v14, s[12:15], s54 offen offset:2048 sc1
    v_cmp_eq_f32 vcc, 0, v57
    v_max3_f32 v61, v52, v53, v54
    s_nop 0
    v_cndmask_b32 v60, v57, v56, vcc
    v_max3_f32 v61, v61, v55, v56
    v_max_f32 v60, v60, v61
    v_sub_f32 v52, v52, v60
    v_sub_f32 v53, v53, v60
    v_sub_f32 v54, v54, v60
    v_sub_f32 v55, v55, v60
    v_sub_f32 v56, v56, v60
    v_sub_f32 v57, v57, v60
    v_cvt_pk_f16_f32 v61, v52, v53
    v_cvt_pk_f16_f32 v62, v54, v55
    v_cvt_pk_f16_f32 v63, v56, v57
    buffer_store_dwordx4 v[60:63], v14, s[12:15], s54 offen offset:3072 sc1
L_fl1:
    s_nop 1
    v_mov_b32 v10, 2
    s_waitcnt vmcnt(0)
    s_mov_b64 exec, 1
    buffer_store_dword v10, off, s[12:15], s32 sc1
    ds_write_b32 v2, v10 offset:52
    s_mov_b64 exec, -1
    s_mov_b32 s60, 0x100000
L_wf2:
    s_nop 1
    ds_read_b32 v10, v2 offset:48
    s_sub_u32 s60, s60, 1
    s_cbranch_scc1 L_exit1
    s_waitcnt lgkmcnt(0)
    v_readfirstlane_b32 s48, v10
    s_cmp_lt_u32 s48, 4
    s_cbranch_scc1 L_wf2
    s_cmp_eq_u32 s86, s89
    s_cbranch_scc1 L_fl2
    ds_read_b64 v[16:17], v8 offset:12544
    ds_read_b64 v[18:19], v8 offset:12552
    ds_read_b64 v[20:21], v8 offset:12560
    ds_read_b64 v[28:29], v8 offset:12736
    ds_read_b64 v[30:31], v8 offset:12744
    ds_read_b64 v[32:33], v8 offset:12752
    ds_read_b64 v[40:41], v8 offset:12928
    ds_read_b64 v[42:43], v8 offset:12936
    ds_read_b64 v[44:45], v8 offset:12944
    ds_read_b64 v[52:53], v8 offset:13120
    ds_read_b64 v[54:55], v8 offset:13128
    ds_read_b64 v[56:57], v8 offset:13136
    s_add_u32 s54, s33, 2097152
    s_cmp_eq_u32 s86, s89
    s_waitcnt lgkmcnt(0)
    v_cmp_eq_f32 vcc, 0, v21
    v_max3_f32 v25, v16, v17, v18
    s_nop 0
    v_cndmask_b32 v24, v21, v20, vcc
    v_max3_f32 v25, v25, v19, v20
    v_max_f32 v24, v24, v25
    v_sub_f32 v16, v16, v24
    v_sub_f32 v17, v17, v24
    v_sub_f32 v18, v18, v24
    v_sub_f32 v19, v19, v24
    v_sub_f32 v20, v20, v24
    v_sub_f32 v21, v21, v24
    v_cvt_pk_f16_f32 v25, v16, v17
    v_cvt_pk_f16_f32 v26, v18, v19
    v_cvt_pk_f16_f32 v27, v20, v21
    buffer_store_dwordx4 v[24:27], v14, s[12:15], s54 offen offset:0 sc1
    v_cmp_eq_f32 vcc, 0, v33
    v_max3_f32 v37, v28, v29, v30
    s_nop 0
    v_cndmask_b32 v36, v33, v32, vcc
    v_max3_f32 v37, v37, v31, v32
    v_max_f32 v36, v36, v37
    v_sub_f32 v28, v28, v36
    v_sub_f32 v29, v29, v36
    v_sub_f32 v30, v30, v36
    v_sub_f32 v31, v31, v36
    v_sub_f32 v32, v32, v36
    v_sub_f32 v33, v33, v36
    v_cvt_pk_f16_f32 v37, v28, v29
    v_cvt_pk_f16_f32 v38, v30, v31
    v_cvt_pk_f16_f32 v39, v32, v33
    buffer_store_dwordx4 v[36:39], v14, s[12:15], s54 offen offset:1024 sc1
    v_cmp_eq_f32 vcc, 0, v45
    v_max3_f32 v49, v40, v41, v42
    s_nop 0
    v_cndmask_b32 v48, v45, v44, vcc
    v_max3_f32 v49, v49, v43, v44
    v_max_f32 v48, v48, v49
    v_sub_f32 v40, v40, v48
    v_sub_f32 v41, v41, v48
    v_sub_f32 v42, v42, v48
    v_sub_f32 v43, v43, v48
    v_sub_f32 v44, v44, v48
    v_sub_f32 v45, v45, v48
    v_cvt_pk_f16_f32 v49, v40, v41
    v_cvt_pk_f16_f32 v50, v42, v43
    v_cvt_pk_f16_f32 v51, v44, v45
    buffer_store_dwordx4 v[48:51], v14, s[12:15], s54 offen offset:2048 sc1
    v_cmp_eq_f32 vcc, 0, v57
    v_max3_f32 v61, v52, v53, v54
    s_nop 0
    v_cndmask_b32 v60, v57, v56, vcc
    v_max3_f32 v61, v61, v55, v56
    v_max_f32 v60, v60, v61
    v_sub_f32 v52, v52, v60
    v_sub_f32 v53, v53, v60
    v_sub_f32 v54, v54, v60
    v_sub_f32 v55, v55, v60
    v_sub_f32 v56, v56, v60
    v_sub_f32 v57, v57, v60
    v_cvt_pk_f16_f32 v61, v52, v53
    v_cvt_pk_f16_f32 v62, v54, v55
    v_cvt_pk_f16_f32 v63, v56, v57
    buffer_store_dwordx4 v[60:63], v14, s[12:15], s54 offen offset:3072 sc1
L_fl2:
    s_nop 1
    v_mov_b32 v10, 3
    s_waitcnt vmcnt(0)
    s_mov_b64 exec, 1
    s_cbranch_scc1 L_fn2
    buffer_store_dword v10, off, s[12:15], s32 sc1
L_fn2:
    s_nop 1
    ds_write_b32 v2, v10 offset:52
    s_mov_b64 exec, -1
    s_endpgm
L_h3:
    s_nop 1
    s_waitcnt lgkmcnt(0)
    s_mov_b32 s12, s82
    s_and_b32 s13, s83, 0xffff
    s_mov_b32 s14, 10485760
    s_mov_b32 s15, 0x00020000
    s_barrier
    v_lshlrev_b32 v7, 2, v1
    s_mul_i32 s20, s4, 4352
    s_add_u32 s20, s20, 10223616
    s_lshl_b32 s21, s3, 2
    s_add_u32 s21, s21, s20
    s_mov_b32 s46, 0x155
    v_lshrrev_b32 v13, 2, v1
    v_mul_u32_u24 v13, 4352, v13
    v_and_or_b32 v13, v7, 12, v13
    s_and_b32 s7, s4, 3
    s_mul_i32 s47, s7, 4352
    s_lshl_b32 s7, s7, 2
    v_mov_b32 v8, 208
    s_mov_b32 s45, 2
    v_mov_b32 v3, 144
    v_bfrev_b32 v6, -2
    s_mov_b32 exec_hi, 0
L_h3loop:
    s_nop 1
    s_mov_b32 s60, 0x100000
L_wp1:
    s_nop 1
    ds_read_b32 v10, v2 offset:128
    s_sub_u32 s60, s60, 1
    s_cbranch_scc1 L_exit1
    s_waitcnt lgkmcnt(0)
    v_readfirstlane_b32 s48, v10
    s_cmp_lt_u32 s48, s45
    s_cbranch_scc1 L_wp1
    s_memrealtime s[40:41]
    s_add_u32 s45, s45, 3
    s_mov_b32 exec_lo, 1
    s_waitcnt lgkmcnt(0)
    v_mov_b32 v5, s40
    buffer_store_dword v5, off, s[12:15], s21
    s_mov_b32 exec_lo, -1
    s_mov_b32 s60, 0x100000
L_wp2:
    s_nop 1
    ds_read_b32 v10, v2 offset:128
    s_sub_u32 s60, s60, 1
    s_cbranch_scc1 L_exit1
    s_waitcnt lgkmcnt(0)
    v_readfirstlane_b32 s48, v10
    s_cmp_lt_u32 s48, s45
    s_cbranch_scc1 L_wp2
    buffer_load_dword v5, v7, s[12:15], s20 offen sc0
    s_add_u32 s45, s45, 4
    s_sub_u32 s40, s40, 4096
    s_waitcnt vmcnt(0)
    v_subrev_u32 v5, s40, v5
    v_cmp_gt_u32 vcc, 8192, v5
    s_nop 1
    v_cndmask_b32 v5, v6, v5, vcc
    s_mov_b32 s48, 2048
    s_add_u32 s49, s48, 2048
    v_cmp_gt_u32 vcc, s49, v5
    s_bcnt1_i32_b64 s50, vcc
    s_cmp_lt_u32 s50, 16
    s_cselect_b32 s48, s49, s48
    s_add_u32 s49, s48, 1024
    v_cmp_gt_u32 vcc, s49, v5
    s_bcnt1_i32_b64 s50, vcc
    s_cmp_lt_u32 s50, 16
    s_cselect_b32 s48, s49, s48
    s_add_u32 s49, s48, 512
    v_cmp_gt_u32 vcc, s49, v5
    s_bcnt1_i32_b64 s50, vcc
    s_cmp_lt_u32 s50, 16
    s_cselect_b32 s48, s49, s48
    s_add_u32 s49, s48, 256
    v_cmp_gt_u32 vcc, s49, v5
    s_bcnt1_i32_b64 s50, vcc
    s_cmp_lt_u32 s50, 16
    s_cselect_b32 s48, s49, s48
    s_add_u32 s49, s48, 128
    v_cmp_gt_u32 vcc, s49, v5
    s_bcnt1_i32_b64 s50, vcc
    s_cmp_lt_u32 s50, 16
    s_cselect_b32 s48, s49, s48
    s_add_u32 s49, s48, 64
    v_cmp_gt_u32 vcc, s49, v5
    s_bcnt1_i32_b64 s50, vcc
    s_cmp_lt_u32 s50, 16
    s_cselect_b32 s48, s49, s48
    s_add_u32 s49, s48, 32
    v_cmp_gt_u32 vcc, s49, v5
    s_bcnt1_i32_b64 s50, vcc
    s_cmp_lt_u32 s50, 16
    s_cselect_b32 s48, s49, s48
    s_add_u32 s49, s48, 16
    v_cmp_gt_u32 vcc, s49, v5
    s_bcnt1_i32_b64 s50, vcc
    s_cmp_lt_u32 s50, 16
    s_cselect_b32 s48, s49, s48
    s_add_u32 s49, s48, 8
    v_cmp_gt_u32 vcc, s49, v5
    s_bcnt1_i32_b64 s50, vcc
    s_cmp_lt_u32 s50, 16
    s_cselect_b32 s48, s49, s48
    s_add_u32 s49, s48, s40
    s_or_b32 s49, s49, 1
    v_mov_b32 v5, s49
    ds_write_b32 v3, v5
    v_add_u32 v3, 4, v3
    s_bitcmp1_b32 s46, 0
    s_cbranch_scc0 L_h3ng
    s_cmp_lt_u32 s48, 6136
    s_cselect_b32 exec_lo, 1, 0
    s_cmp_lt_u32 s3, 4
    s_cselect_b32 exec_lo, exec_lo, 0
    buffer_store_dword v5, off, s[12:15], s21 offset:2048 sc1
    s_mov_b32 exec_lo, 0xffff
    s_add_u32 s51, s45, 0
    s_mov_b32 s60, 0x100000
L_wp3:
    s_nop 1
    ds_read_b32 v10, v2 offset:128
    s_sub_u32 s60, s60, 1
    s_cbranch_scc1 L_exit1
    s_waitcnt lgkmcnt(0)
    v_readfirstlane_b32 s48, v10
    s_cmp_lt_u32 s48, s51
    s_cbranch_scc1 L_wp3
    s_sub_u32 s51, s20, s47
    s_mov_b32 s60, 8
    s_mov_b32 s48, 0
L_h3gp:
    s_nop 1
    buffer_load_dword v4, v13, s[12:15], s51 offen offset:2048 sc1
    s_sub_u32 s60, s60, 1
    s_cbranch_scc1 L_h3gw
L_h3gq:
    s_waitcnt vmcnt(0)
    v_subrev_u32 v4, s40, v4
    v_cmp_gt_u32 vcc, 8192, v4
    s_nop 1
    v_cndmask_b32 v4, v6, v4, vcc
    s_nop 1
    v_min_u32_dpp v4, v4, v4 quad_perm:[1,0,3,2] row_mask:0xf bank_mask:0xf
    s_nop 1
    v_min_u32_dpp v4, v4, v4 quad_perm:[2,3,0,1] row_mask:0xf bank_mask:0xf
    v_cmp_eq_u32 vcc, v6, v4
    s_cbranch_vccnz L_h3gp
    v_readlane_b32 s52, v4, 0
    v_readlane_b32 s53, v4, 4
    v_readlane_b32 s54, v4, 8
    v_readlane_b32 s55, v4, 12
    v_readlane_b32 s49, v4, s7
    s_max_u32 s52, s52, s53
    s_max_u32 s54, s54, s55
    s_max_u32 s48, s52, s54
    s_sub_u32 s48, s48, s49
    s_sub_u32 s48, s48, 10
    s_max_i32 s48, s48, 0
    s_min_i32 s48, s48, 1000
L_h3gw:
    s_nop 1
    s_or_b32 s48, s48, 0x10000
    v_mov_b32 v5, s48
    ds_write_b32 v8, v5
    s_mov_b32 exec_lo, -1
    v_add_u32 v8, 4, v8
    s_waitcnt vmcnt(0)
L_h3ng:
    s_nop 1
    s_lshr_b32 s46, s46, 1
    s_add_u32 s45, s45, 5
    s_add_u32 s20, s20, 128
    s_add_u32 s21, s21, 128
    s_cmp_lt_u32 s45, 132
    s_cbranch_scc1 L_h3loop
    s_mov_b64 exec, -1
    v_lshlrev_b32 v12, 2, v1
    v_add_u32 v13, 49408, v12
    v_lshlrev_b32 v8, 4, v1
    s_add_u32 s48, s3, 64
    s_mul_i32 s48, s48, 171
    s_lshr_b32 s48, s48, 9
    s_mul_i32 s58, s48, 4352
    s_add_u32 s58, s58, 9498368
    s_mul_i32 s59, s48, 384
    s_cmp_eq_u32 s48, 21
    s_cselect_b32 s20, 15, 23
    s_mul_i32 s48, s48, 24
    s_add_u32 s62, s2, 512
    s_sub_u32 s56, s62, s48
    s_lshl_b32 s62, s62, 10
    s_mov_b32 s60, 0x40000
L_fs:
    s_nop 1
    buffer_load_dword v4, off, s[12:15], s58 offset:4 sc1
    s_sub_u32 s60, s60, 1
    s_cbranch_scc1 L_exit1
    s_waitcnt vmcnt(0)
    v_cmp_eq_u32 vcc, 0, v4
    s_cbranch_vccnz L_fs
    buffer_load_dword v10, v12, s[12:15], s58 offen offset:128 sc1
    ds_read_b128 v[4:7], v2 offset:112
    v_xor_b32 v11, 1, v1
    v_cmp_eq_u32 vcc, s56, v1
    s_nop 1
    v_cndmask_b32 v11, v1, v11, vcc
    v_add_u32 v11, s48, v11
    v_lshlrev_b32 v11, 10, v11
    s_nop 0
    v_readlane_b32 s64, v11, 0
    v_readlane_b32 s65, v11, 1
    v_readlane_b32 s66, v11, 2
    v_readlane_b32 s67, v11, 3
    v_readlane_b32 s68, v11, 4
    v_readlane_b32 s69, v11, 5
    v_readlane_b32 s70, v11, 6
    v_readlane_b32 s71, v11, 7
    v_readlane_b32 s72, v11, 8
    v_readlane_b32 s73, v11, 9
    v_readlane_b32 s74, v11, 10
    v_readlane_b32 s75, v11, 11
    v_readlane_b32 s84, v11, 12
    v_readlane_b32 s85, v11, 13
    v_readlane_b32 s86, v11, 14
    v_readlane_b32 s87, v11, 15
    v_readlane_b32 s88, v11, 16
    v_readlane_b32 s89, v11, 17
    v_readlane_b32 s90, v11, 18
    v_readlane_b32 s91, v11, 19
    v_readlane_b32 s92, v11, 20
    v_readlane_b32 s93, v11, 21
    v_readlane_b32 s94, v11, 22
    v_readlane_b32 s95, v11, 23
    s_mov_b32 s96, s78
    s_and_b32 s97, s79, 0xffff
    s_mov_b32 s98, 12288
    s_mov_b32 s99, 0x00020000
    v_lshlrev_b32 v12, 1, v1
    s_waitcnt vmcnt(0)
    v_readlane_b32 s57, v10, s56
    v_cndmask_b32 v10, v10, v2, vcc
    s_nop 0
    v_readlane_b32 s24, v10, 0
    v_readlane_b32 s25, v10, 1
    v_readlane_b32 s26, v10, 2
    v_readlane_b32 s27, v10, 3
    v_readlane_b32 s28, v10, 4
    v_readlane_b32 s29, v10, 5
    v_readlane_b32 s30, v10, 6
    v_readlane_b32 s31, v10, 7
    v_readlane_b32 s32, v10, 8
    v_readlane_b32 s33, v10, 9
    v_readlane_b32 s34, v10, 10
    v_readlane_b32 s35, v10, 11
    v_readlane_b32 s36, v10, 12
    v_readlane_b32 s37, v10, 13
    v_readlane_b32 s38, v10, 14
    v_readlane_b32 s39, v10, 15
    v_readlane_b32 s40, v10, 16
    v_readlane_b32 s41, v10, 17
    v_readlane_b32 s42, v10, 18
    v_readlane_b32 s43, v10, 19
    v_readlane_b32 s44, v10, 20
    v_readlane_b32 s45, v10, 21
    v_readlane_b32 s46, v10, 22
    v_readlane_b32 s47, v10, 23
    v_mov_b32 v9, 1
    s_mov_b64 exec, 1
    s_mov_b32 s60, 0x100000
L_wel:
    s_nop 1
    ds_read_b32 v10, v2 offset:136
    s_sub_u32 s60, s60, 1
    s_cbranch_scc1 L_exit1
    s_waitcnt lgkmcnt(0)
    v_readfirstlane_b32 s48, v10
    s_cmp_lt_u32 s48, 4
    s_cbranch_scc1 L_wel
    buffer_atomic_add v9, off, s[12:15], s58 sc0
    s_mov_b64 exec, -1
    s_waitcnt vmcnt(0)
    v_readfirstlane_b32 s48, v9
    s_cmp_lg_u32 s48, s20
    s_cbranch_scc1 L_exit1
    buffer_load_dwordx4 v[32:35], v8, s[12:15], s64 offen sc1
    buffer_load_dwordx4 v[36:39], v8, s[12:15], s65 offen sc1
    buffer_load_dwordx4 v[40:43], v8, s[12:15], s66 offen sc1
    buffer_load_dwordx4 v[44:47], v8, s[12:15], s67 offen sc1
    buffer_load_dwordx4 v[48:51], v8, s[12:15], s68 offen sc1
    buffer_load_dwordx4 v[52:55], v8, s[12:15], s69 offen sc1
    buffer_load_dwordx4 v[56:59], v8, s[12:15], s70 offen sc1
    buffer_load_dwordx4 v[60:63], v8, s[12:15], s71 offen sc1
    buffer_load_dwordx4 v[64:67], v8, s[12:15], s72 offen sc1
    buffer_load_dwordx4 v[68:71], v8, s[12:15], s73 offen sc1
    buffer_load_dwordx4 v[72:75], v8, s[12:15], s74 offen sc1
    buffer_load_dwordx4 v[76:79], v8, s[12:15], s75 offen sc1
    buffer_load_dwordx4 v[80:83], v8, s[12:15], s84 offen sc1
    buffer_load_dwordx4 v[84:87], v8, s[12:15], s85 offen sc1
    buffer_load_dwordx4 v[88:91], v8, s[12:15], s86 offen sc1
    buffer_load_dwordx4 v[92:95], v8, s[12:15], s87 offen sc1
    buffer_load_dwordx4 v[96:99], v8, s[12:15], s88 offen sc1
    buffer_load_dwordx4 v[100:103], v8, s[12:15], s89 offen sc1
    buffer_load_dwordx4 v[104:107], v8, s[12:15], s90 offen sc1
    buffer_load_dwordx4 v[108:111], v8, s[12:15], s91 offen sc1
    buffer_load_dwordx4 v[112:115], v8, s[12:15], s92 offen sc1
    buffer_load_dwordx4 v[116:119], v8, s[12:15], s93 offen sc1
    buffer_load_dwordx4 v[120:123], v8, s[12:15], s94 offen sc1
    buffer_load_dwordx4 v[124:127], v8, s[12:15], s95 offen sc1
    s_mov_b32 s60, 0x100000
L_wn:
    s_nop 1
    ds_read_b32 v10, v2 offset:72
    s_sub_u32 s60, s60, 1
    s_cbranch_scc1 L_exit1
    s_waitcnt lgkmcnt(0)
    v_readfirstlane_b32 s48, v10
    s_cmp_lt_u32 s48, 4
    s_cbranch_scc1 L_wn
    ds_read_b32 v16, v13 offset:0
    ds_read_b32 v17, v13 offset:768
    ds_read_b32 v18, v13 offset:1536
    ds_read_b32 v19, v13 offset:2304
    ds_read_b32 v20, v13 offset:256
    ds_read_b32 v21, v13 offset:1024
    ds_read_b32 v22, v13 offset:1792
    ds_read_b32 v23, v13 offset:2560
    ds_read_b32 v24, v13 offset:512
    ds_read_b32 v25, v13 offset:1280
    ds_read_b32 v26, v13 offset:2048
    ds_read_b32 v27, v13 offset:2816
    s_mov_b32 s60, 0x40000
    s_waitcnt lgkmcnt(8)
    v_add_f32 v16, v16, v17
    v_add_f32 v18, v18, v19
    v_sub_f32 v16, v16, v6
    v_add_f32 v28, v16, v18
    s_waitcnt lgkmcnt(4)
    v_add_f32 v20, v20, v21
    v_add_f32 v22, v22, v23
    v_sub_f32 v20, v20, v6
    v_add_f32 v29, v20, v22
    s_waitcnt lgkmcnt(0)
    v_add_f32 v24, v24, v25
    v_add_f32 v26, v26, v27
    v_sub_f32 v24, v24, v6
    v_add_f32 v30, v24, v26
    s_branch L_fr2
L_fr:
    s_nop 1
    buffer_load_dwordx4 v[32:35], v8, s[12:15], s64 offen sc1
    buffer_load_dwordx4 v[36:39], v8, s[12:15], s65 offen sc1
    buffer_load_dwordx4 v[40:43], v8, s[12:15], s66 offen sc1
    buffer_load_dwordx4 v[44:47], v8, s[12:15], s67 offen sc1
    buffer_load_dwordx4 v[48:51], v8, s[12:15], s68 offen sc1
    buffer_load_dwordx4 v[52:55], v8, s[12:15], s69 offen sc1
    buffer_load_dwordx4 v[56:59], v8, s[12:15], s70 offen sc1
    buffer_load_dwordx4 v[60:63], v8, s[12:15], s71 offen sc1
    buffer_load_dwordx4 v[64:67], v8, s[12:15], s72 offen sc1
    buffer_load_dwordx4 v[68:71], v8, s[12:15], s73 offen sc1
    buffer_load_dwordx4 v[72:75], v8, s[12:15], s74 offen sc1
    buffer_load_dwordx4 v[76:79], v8, s[12:15], s75 offen sc1
    buffer_load_dwordx4 v[80:83], v8, s[12:15], s84 offen sc1
    buffer_load_dwordx4 v[84:87], v8, s[12:15], s85 offen sc1
    buffer_load_dwordx4 v[88:91], v8, s[12:15], s86 offen sc1
    buffer_load_dwordx4 v[92:95], v8, s[12:15], s87 offen sc1
    buffer_load_dwordx4 v[96:99], v8, s[12:15], s88 offen sc1
    buffer_load_dwordx4 v[100:103], v8, s[12:15], s89 offen sc1
    buffer_load_dwordx4 v[104:107], v8, s[12:15], s90 offen sc1
    buffer_load_dwordx4 v[108:111], v8, s[12:15], s91 offen sc1
    buffer_load_dwordx4 v[112:115], v8, s[12:15], s92 offen sc1
    buffer_load_dwordx4 v[116:119], v8, s[12:15], s93 offen sc1
    buffer_load_dwordx4 v[120:123], v8, s[12:15], s94 offen sc1
    buffer_load_dwordx4 v[124:127], v8, s[12:15], s95 offen sc1
L_fr2:
    v_mul_f32 v4, s57, v28
    v_mul_f32 v5, s57, v29
    v_mul_f32 v6, s57, v30
    v_mov_b32 v7, 1
    s_sub_u32 s60, s60, 1
    s_cbranch_scc1 L_exit1
    s_waitcnt vmcnt(22)
    v_fmac_f32 v4, s24, v32
    v_fmac_f32 v5, s24, v33
    v_fmac_f32 v6, s24, v34
    v_fmac_f32 v4, s25, v36
    v_fmac_f32 v5, s25, v37
    v_fmac_f32 v6, s25, v38
    v_min3_u32 v7, v7, v35, v39
    s_waitcnt vmcnt(20)
    v_fmac_f32 v4, s26, v40
    v_fmac_f32 v5, s26, v41
    v_fmac_f32 v6, s26, v42
    v_fmac_f32 v4, s27, v44
    v_fmac_f32 v5, s27, v45
    v_fmac_f32 v6, s27, v46
    v_min3_u32 v7, v7, v43, v47
    s_waitcnt vmcnt(18)
    v_fmac_f32 v4, s28, v48
    v_fmac_f32 v5, s28, v49
    v_fmac_f32 v6, s28, v50
    v_fmac_f32 v4, s29, v52
    v_fmac_f32 v5, s29, v53
    v_fmac_f32 v6, s29, v54
    v_min3_u32 v7, v7, v51, v55
    s_waitcnt vmcnt(16)
    v_fmac_f32 v4, s30, v56
    v_fmac_f32 v5, s30, v57
    v_fmac_f32 v6, s30, v58
    v_fmac_f32 v4, s31, v60
    v_fmac_f32 v5, s31, v61
    v_fmac_f32 v6, s31, v62
    v_min3_u32 v7, v7, v59, v63
    s_waitcnt vmcnt(14)
    v_fmac_f32 v4, s32, v64
    v_fmac_f32 v5, s32, v65
    v_fmac_f32 v6, s32, v66
    v_fmac_f32 v4, s33, v68
    v_fmac_f32 v5, s33, v69
    v_fmac_f32 v6, s33, v70
    v_min3_u32 v7, v7, v67, v71
    s_waitcnt vmcnt(12)
    v_fmac_f32 v4, s34, v72
    v_fmac_f32 v5, s34, v73
    v_fmac_f32 v6, s34, v74
    v_fmac_f32 v4, s35, v76
    v_fmac_f32 v5, s35, v77
    v_fmac_f32 v6, s35, v78
    v_min3_u32 v7, v7, v75, v79
    s_waitcnt vmcnt(10)
    v_fmac_f32 v4, s36, v80
    v_fmac_f32 v5, s36, v81
    v_fmac_f32 v6, s36, v82
    v_fmac_f32 v4, s37, v84
    v_fmac_f32 v5, s37, v85
    v_fmac_f32 v6, s37, v86
    v_min3_u32 v7, v7, v83, v87
    s_waitcnt vmcnt(8)
    v_fmac_f32 v4, s38, v88
    v_fmac_f32 v5, s38, v89
    v_fmac_f32 v6, s38, v90
    v_fmac_f32 v4, s39, v92
    v_fmac_f32 v5, s39, v93
    v_fmac_f32 v6, s39, v94
    v_min3_u32 v7, v7, v91, v95
    s_waitcnt vmcnt(6)
    v_fmac_f32 v4, s40, v96
    v_fmac_f32 v5, s40, v97
    v_fmac_f32 v6, s40, v98
    v_fmac_f32 v4, s41, v100
    v_fmac_f32 v5, s41, v101
    v_fmac_f32 v6, s41, v102
    v_min3_u32 v7, v7, v99, v103
    s_waitcnt vmcnt(4)
    v_fmac_f32 v4, s42, v104
    v_fmac_f32 v5, s42, v105
    v_fmac_f32 v6, s42, v106
    v_fmac_f32 v4, s43, v108
    v_fmac_f32 v5, s43, v109
    v_fmac_f32 v6, s43, v110
    v_min3_u32 v7, v7, v107, v111
    s_waitcnt vmcnt(2)
    v_fmac_f32 v4, s44, v112
    v_fmac_f32 v5, s44, v113
    v_fmac_f32 v6, s44, v114
    v_fmac_f32 v4, s45, v116
    v_fmac_f32 v5, s45, v117
    v_fmac_f32 v6, s45, v118
    v_min3_u32 v7, v7, v115, v119
    s_waitcnt vmcnt(0)
    v_fmac_f32 v4, s46, v120
    v_fmac_f32 v5, s46, v121
    v_fmac_f32 v6, s46, v122
    v_fmac_f32 v4, s47, v124
    v_fmac_f32 v5, s47, v125
    v_fmac_f32 v6, s47, v126
    v_min3_u32 v7, v7, v123, v127
    v_cmp_eq_u32 vcc, 0, v7
    v_cvt_pk_bf16_f32 v4, v4, v4
    v_cvt_pk_bf16_f32 v5, v5, v5
    v_cvt_pk_bf16_f32 v6, v6, v6
    s_cbranch_vccnz L_fr
    buffer_store_short v4, v12, s[96:99], s59 offen offset:0
    buffer_store_short v5, v12, s[96:99], s59 offen offset:128
    buffer_store_short v6, v12, s[96:99], s59 offen offset:256
L_fx:
    s_endpgm
L_h2:
    s_nop 1
    s_mov_b32 s92, s74
    s_and_b32 s93, s75, 0xffff
    s_mov_b32 s94, 2097152
    s_mov_b32 s95, 0x00020000
    s_mov_b32 s96, s76
    s_and_b32 s97, s77, 0xffff
    s_mov_b32 s98, 2097152
    s_mov_b32 s99, 0x00020000
    s_mov_b32 s60, 0x100000
L_wd2:
    s_nop 1
    ds_read_b32 v10, v2 offset:20
    s_sub_u32 s60, s60, 1
    s_cbranch_scc1 L_exit1
    s_waitcnt lgkmcnt(0)
    v_readfirstlane_b32 s48, v10
    s_cmp_eq_u32 s48, 0
    s_cbranch_scc1 L_wd2
    ds_read_b128 v[16:19], v2 offset:0
    ds_read_b64 v[20:21], v2 offset:16
    s_waitcnt lgkmcnt(0)
    v_readfirstlane_b32 s84, v16
    v_readfirstlane_b32 s85, v17
    v_readfirstlane_b32 s86, v18
    v_readfirstlane_b32 s87, v19
    v_readfirstlane_b32 s88, v20
    v_readfirstlane_b32 s89, v21
    v_and_b32 v3, 3, v1
    v_and_b32 v15, 7, v1
    v_lshrrev_b32 v12, 2, v1
    s_mov_b32 s37, 0x3dd53b95
    s_mov_b32 s38, 0xaaaaaaab
    s_mov_b32 s61, 0
    s_mul_i32 s35, s3, 32768
    s_add_u32 s35, s35, 2097152
    s_mov_b32 s40, 4096
    v_lshlrev_b32 v14, 5, v1
    v_lshrrev_b32 v8, 3, v1
    v_mul_u32_u24 v8, 24, v8
    v_mov_b32 v4, 768
    v_mad_u32_u24 v8, v15, v4, v8
    v_lshrrev_b32 v4, 3, v1
    v_lshlrev_b32 v104, 7, v15
    v_lshl_add_u32 v104, v4, 4, v104
    s_mov_b32 s34, 6
L_prep:
    s_nop 1
    s_lshl_b32 s62, s61, 5
    s_add_u32 s62, s62, s3
    s_lshl_b32 s63, s62, 15
    s_add_u32 s63, s63, 1
    s_mul_hi_u32 s63, s63, 0xaaaaaaab
    s_lshr_b32 s63, s63, 7
    s_mov_b32 s32, s84
    s_mov_b32 s39, s87
    s_mov_b32 s84, s85
    s_mov_b32 s85, s86
    s_mov_b32 s87, s88
    s_mov_b32 s88, s89
    s_lshl_b32 s33, s61, 3
    s_add_u32 s33, s33, 1
    s_mov_b32 s60, 0x100000
L_wpf:
    s_nop 1
    ds_read_b32 v10, v2 offset:60
    s_sub_u32 s60, s60, 1
    s_cbranch_scc1 L_exit1
    s_waitcnt lgkmcnt(0)
    v_readfirstlane_b32 s48, v10
    s_cmp_lt_u32 s48, s33
    s_cbranch_scc1 L_wpf
    v_lshlrev_b32 v4, 4, v1
    s_mul_i32 s49, s4, 2736
    s_lshl_b32 s48, s62, 16
    s_mul_hi_u32 s48, s48, 0xaaaaaaab
    s_lshr_b32 s48, s48, 5
    s_lshl_b32 s48, s48, 4
    s_add_u32 s48, s48, s49
    buffer_load_dwordx4 v[80:83], v4, s[92:95], s48 offen offset:0
    buffer_load_dwordx4 v[84:87], v4, s[92:95], s48 offen offset:1024
    buffer_load_dwordx4 v[88:91], v4, s[92:95], s48 offen offset:2048
    buffer_load_dwordx4 v[92:95], v4, s[96:99], s48 offen offset:0
    buffer_load_dwordx4 v[96:99], v4, s[96:99], s48 offen offset:1024
    buffer_load_dwordx4 v[100:103], v4, s[96:99], s48 offen offset:2048
    s_and_b32 s48, s39, 7
    v_mov_b32 v9, s48
    s_bitcmp1_b32 s39, 3
    s_cselect_b64 vcc, -1, 0
    v_cndmask_b32 v9, v9, v15, vcc
    v_xor_b32 v13, s5, v9
    v_lshl_or_b32 v13, v3, 3, v13
    s_lshl_b32 s36, s62, 6
    s_mul_i32 s49, s62, 768
    s_lshl_b32 s50, s63, 2
    s_sub_u32 s49, s49, s50
    s_add_u32 s49, s49, 1179648
    s_add_u32 s33, s33, 4
    s_mov_b32 s60, 0x100000
L_wga:
    s_nop 1
    ds_read_b32 v10, v2 offset:60
    s_sub_u32 s60, s60, 1
    s_cbranch_scc1 L_exit1
    s_waitcnt lgkmcnt(0)
    v_readfirstlane_b32 s48, v10
    s_cmp_lt_u32 s48, s33
    s_cbranch_scc1 L_wga
    v_add_u32 v4, 0, v12
    v_bfe_u32 v5, v4, 3, 2
    v_and_or_b32 v5, v4, 4, v5
    v_xor_b32 v5, v13, v5
    v_add_u32 v4, s36, v4
    v_lshl_add_u32 v6, v4, 5, v5
    v_lshl_add_u32 v6, v6, 4, 1
    v_mul_hi_u32 v6, v6, s38
    v_lshrrev_b32 v6, 1, v6
    v_lshrrev_b32 v22, 6, v6
    v_lshl_add_u32 v22, v22, 2, s49
    v_and_b32 v7, 15, v6
    v_cmp_eq_u32 s[24:25], 5, v7
    v_and_b32 v23, 1, v6
    v_lshlrev_b32 v23, 4, v23
    s_waitcnt vmcnt(0)
    v_add_u32 v4, 16, v12
    v_bfe_u32 v5, v4, 3, 2
    v_and_or_b32 v5, v4, 4, v5
    v_xor_b32 v5, v13, v5
    v_add_u32 v4, s36, v4
    v_lshl_add_u32 v6, v4, 5, v5
    v_lshl_add_u32 v6, v6, 4, 1
    v_mul_hi_u32 v6, v6, s38
    v_lshrrev_b32 v6, 1, v6
    v_lshrrev_b32 v38, 6, v6
    v_lshl_add_u32 v38, v38, 2, s49
    v_and_b32 v7, 15, v6
    v_cmp_eq_u32 s[26:27], 5, v7
    v_and_b32 v39, 1, v6
    v_lshlrev_b32 v39, 4, v39
    s_waitcnt vmcnt(0)
    v_add_u32 v4, 32, v12
    v_bfe_u32 v5, v4, 3, 2
    v_and_or_b32 v5, v4, 4, v5
    v_xor_b32 v5, v13, v5
    v_add_u32 v4, s36, v4
    v_lshl_add_u32 v6, v4, 5, v5
    v_lshl_add_u32 v6, v6, 4, 1
    v_mul_hi_u32 v6, v6, s38
    v_lshrrev_b32 v6, 1, v6
    v_lshrrev_b32 v54, 6, v6
    v_lshl_add_u32 v54, v54, 2, s49
    v_and_b32 v7, 15, v6
    v_cmp_eq_u32 s[28:29], 5, v7
    v_and_b32 v55, 1, v6
    v_lshlrev_b32 v55, 4, v55
    s_waitcnt vmcnt(0)
    v_add_u32 v4, 48, v12
    v_bfe_u32 v5, v4, 3, 2
    v_and_or_b32 v5, v4, 4, v5
    v_xor_b32 v5, v13, v5
    v_add_u32 v4, s36, v4
    v_lshl_add_u32 v6, v4, 5, v5
    v_lshl_add_u32 v6, v6, 4, 1
    v_mul_hi_u32 v6, v6, s38
    v_lshrrev_b32 v6, 1, v6
    v_lshrrev_b32 v70, 6, v6
    v_lshl_add_u32 v70, v70, 2, s49
    v_and_b32 v7, 15, v6
    v_cmp_eq_u32 s[30:31], 5, v7
    v_and_b32 v71, 1, v6
    v_lshlrev_b32 v71, 4, v71
    s_waitcnt vmcnt(0)
    s_add_u32 s33, s61, 1
    s_mov_b32 s60, 0x100000
L_wfd:
    s_nop 1
    ds_read_b32 v10, v2 offset:52
    s_sub_u32 s60, s60, 1
    s_cbranch_scc1 L_exit1
    s_waitcnt lgkmcnt(0)
    v_readfirstlane_b32 s48, v10
    s_cmp_lt_u32 s48, s33
    s_cbranch_scc1 L_wfd
    v_mul_u32_u24 v4, 4352, v1
    s_xor_b32 s48, s32, s39
    s_xor_b32 s48, s48, s5
    s_and_b32 s48, s48, 7
    v_mov_b32 v6, s33
    s_lshl_b64 vcc, 1, s48
    s_or_b32 s48, s32, s39
    s_bitcmp1_b32 s48, 3
    s_cselect_b64 vcc, 0xff, vcc
    s_cmp_eq_u32 s32, s39
    s_cselect_b64 vcc, 0, vcc
    s_max_u32 s48, s61, 1
    v_mov_b32 v7, s48
    v_cndmask_b32 v6, v7, v6, vcc
    s_cmp_eq_u32 s61, 1
    s_cselect_b64 exec, vcc, 0xff
    s_mov_b32 s60, 0x40000
    s_cbranch_execz L_noflags
L_flags:
    s_nop 1
    buffer_load_dword v5, v4, s[12:15], s59 offen sc1
    s_sub_u32 s60, s60, 1
    s_cbranch_scc1 L_exit1
    s_waitcnt vmcnt(0)
    v_cmpx_gt_u32 vcc, v6, v5
    s_cbranch_execnz L_flags
L_noflags:
    s_nop 1
    s_mov_b64 exec, -1
    buffer_load_dword v22, v22, s[12:15], 0 offen sc1
    buffer_load_dword v38, v38, s[12:15], 0 offen sc1
    buffer_load_dword v54, v54, s[12:15], 0 offen sc1
    buffer_load_dword v70, v70, s[12:15], 0 offen sc1
    s_bitcmp1_b32 s39, 3
    s_cselect_b32 s49, 0, 7
    s_xor_b32 s50, s32, s39
    s_bitcmp1_b32 s50, 3
    s_cselect_b32 s51, 7, 0
    s_and_b32 s50, s50, 7
    s_and_b32 s52, s39, 7
    v_lshrrev_b32 v4, 3, v1
    v_cmp_gt_u32 vcc, s34, v4
    v_and_b32 v6, s51, v15
    v_xor_b32 v6, s50, v6
    v_and_b32 v5, s49, v15
    v_xor_b32 v5, s52, v5
    v_cndmask_b32 v5, v6, v5, vcc
    v_cmp_ne_u32 s[64:65], 0, v5
    v_xor_b32 v5, s5, v5
    v_mad_u32_u24 v5, v5, s40, v104
    v_cmp_ne_u32 s[66:67], 0, v6
    v_xor_b32 v6, s5, v6
    v_mad_u32_u24 v6, v6, s40, v104
    s_mov_b64 exec, s[64:65]
    buffer_load_dwordx4 v[80:83], v5, s[12:15], s35 offen offset:0 sc1
    s_mov_b64 exec, s[66:67]
    buffer_load_dwordx4 v[84:87], v6, s[12:15], s35 offen offset:1024 sc1
    buffer_load_dwordx4 v[88:91], v6, s[12:15], s35 offen offset:2048 sc1
    buffer_load_dwordx4 v[92:95], v6, s[12:15], s35 offen offset:3072 sc1
    s_mov_b64 exec, -1
    v_add_u32 v4, 0, v12
    v_bfe_u32 v5, v4, 3, 2
    v_and_or_b32 v5, v4, 4, v5
    v_xor_b32 v5, v13, v5
    v_add_u32 v4, s36, v4
    v_lshl_add_u32 v6, v4, 5, v5
    v_lshl_add_u32 v6, v6, 4, 1
    v_mul_hi_u32 v6, v6, s38
    v_lshrrev_b32 v6, 1, v6
    v_lshrrev_b32 v11, 1, v6
    v_lshlrev_b32 v11, 2, v11
    s_memrealtime s[42:43]
    s_waitcnt lgkmcnt(0)
L_tw1:
    s_nop 1
    s_memrealtime s[44:45]
    s_waitcnt lgkmcnt(0)
    s_sub_u32 s45, s44, s42
    s_cmp_lt_i32 s45, 0
    s_cbranch_scc1 L_tw1
    s_add_u32 s42, s44, 140
    s_mov_b32 exec_lo, 0xffffffff
    s_mov_b32 exec_hi, 0x0
    buffer_load_dwordx3 v[24:26], v11, s[92:95], 0 offen
    buffer_load_dword v27, v11, s[92:95], 0 offen offset:12
L_tw2:
    s_nop 1
    s_memrealtime s[44:45]
    s_waitcnt lgkmcnt(0)
    s_sub_u32 s45, s44, s42
    s_cmp_lt_i32 s45, 0
    s_cbranch_scc1 L_tw2
    s_add_u32 s42, s44, 140
    s_mov_b32 exec_lo, 0x0
    s_mov_b32 exec_hi, 0xffffffff
    buffer_load_dwordx3 v[24:26], v11, s[92:95], 0 offen
    buffer_load_dword v27, v11, s[92:95], 0 offen offset:12
    s_mov_b64 exec, -1
L_tw3:
    s_nop 1
    s_memrealtime s[44:45]
    s_waitcnt lgkmcnt(0)
    s_sub_u32 s45, s44, s42
    s_cmp_lt_i32 s45, 0
    s_cbranch_scc1 L_tw3
    s_add_u32 s42, s44, 140
    s_mov_b32 exec_lo, 0xffffffff
    s_mov_b32 exec_hi, 0x0
    buffer_load_dwordx3 v[28:30], v11, s[96:99], 0 offen
    buffer_load_dword v31, v11, s[96:99], 0 offen offset:12
L_tw4:
    s_nop 1
    s_memrealtime s[44:45]
    s_waitcnt lgkmcnt(0)
    s_sub_u32 s45, s44, s42
    s_cmp_lt_i32 s45, 0
    s_cbranch_scc1 L_tw4
    s_add_u32 s42, s44, 140
    s_mov_b32 exec_lo, 0x0
    s_mov_b32 exec_hi, 0xffffffff
    buffer_load_dwordx3 v[28:30], v11, s[96:99], 0 offen
    buffer_load_dword v31, v11, s[96:99], 0 offen offset:12
    s_mov_b64 exec, -1
    v_add_u32 v4, 16, v12
    v_bfe_u32 v5, v4, 3, 2
    v_and_or_b32 v5, v4, 4, v5
    v_xor_b32 v5, v13, v5
    v_add_u32 v4, s36, v4
    v_lshl_add_u32 v6, v4, 5, v5
    v_lshl_add_u32 v6, v6, 4, 1
    v_mul_hi_u32 v6, v6, s38
    v_lshrrev_b32 v6, 1, v6
    v_lshrrev_b32 v11, 1, v6
    v_lshlrev_b32 v11, 2, v11
L_tw5:
    s_nop 1
    s_memrealtime s[44:45]
    s_waitcnt lgkmcnt(0)
    s_sub_u32 s45, s44, s42
    s_cmp_lt_i32 s45, 0
    s_cbranch_scc1 L_tw5
    s_add_u32 s42, s44, 140
    s_mov_b32 exec_lo, 0xffffffff
    s_mov_b32 exec_hi, 0x0
    buffer_load_dwordx3 v[40:42], v11, s[92:95], 0 offen
    buffer_load_dword v43, v11, s[92:95], 0 offen offset:12
L_tw6:
    s_nop 1
    s_memrealtime s[44:45]
    s_waitcnt lgkmcnt(0)
    s_sub_u32 s45, s44, s42
    s_cmp_lt_i32 s45, 0
    s_cbranch_scc1 L_tw6
    s_add_u32 s42, s44, 140
    s_mov_b32 exec_lo, 0x0
    s_mov_b32 exec_hi, 0xffffffff
    buffer_load_dwordx3 v[40:42], v11, s[92:95], 0 offen
    buffer_load_dword v43, v11, s[92:95], 0 offen offset:12
    s_mov_b64 exec, -1
L_tw7:
    s_nop 1
    s_memrealtime s[44:45]
    s_waitcnt lgkmcnt(0)
    s_sub_u32 s45, s44, s42
    s_cmp_lt_i32 s45, 0
    s_cbranch_scc1 L_tw7
    s_add_u32 s42, s44, 140
    s_mov_b32 exec_lo, 0xffffffff
    s_mov_b32 exec_hi, 0x0
    buffer_load_dwordx3 v[44:46], v11, s[96:99], 0 offen
    buffer_load_dword v47, v11, s[96:99], 0 offen offset:12
L_tw8:
    s_nop 1
    s_memrealtime s[44:45]
    s_waitcnt lgkmcnt(0)
    s_sub_u32 s45, s44, s42
    s_cmp_lt_i32 s45, 0
    s_cbranch_scc1 L_tw8
    s_add_u32 s42, s44, 140
    s_mov_b32 exec_lo, 0x0
    s_mov_b32 exec_hi, 0xffffffff
    buffer_load_dwordx3 v[44:46], v11, s[96:99], 0 offen
    buffer_load_dword v47, v11, s[96:99], 0 offen offset:12
    s_mov_b64 exec, -1
    v_add_u32 v4, 32, v12
    v_bfe_u32 v5, v4, 3, 2
    v_and_or_b32 v5, v4, 4, v5
    v_xor_b32 v5, v13, v5
    v_add_u32 v4, s36, v4
    v_lshl_add_u32 v6, v4, 5, v5
    v_lshl_add_u32 v6, v6, 4, 1
    v_mul_hi_u32 v6, v6, s38
    v_lshrrev_b32 v6, 1, v6
    v_lshrrev_b32 v11, 1, v6
    v_lshlrev_b32 v11, 2, v11
L_tw9:
    s_nop 1
    s_memrealtime s[44:45]
    s_waitcnt lgkmcnt(0)
    s_sub_u32 s45, s44, s42
    s_cmp_lt_i32 s45, 0
    s_cbranch_scc1 L_tw9
    s_add_u32 s42, s44, 140
    s_mov_b32 exec_lo, 0xffffffff
    s_mov_b32 exec_hi, 0x0
    buffer_load_dwordx3 v[56:58], v11, s[92:95], 0 offen
    buffer_load_dword v59, v11, s[92:95], 0 offen offset:12
L_tw10:
    s_nop 1
    s_memrealtime s[44:45]
    s_waitcnt lgkmcnt(0)
    s_sub_u32 s45, s44, s42
    s_cmp_lt_i32 s45, 0
    s_cbranch_scc1 L_tw10
    s_add_u32 s42, s44, 140
    s_mov_b32 exec_lo, 0x0
    s_mov_b32 exec_hi, 0xffffffff
    buffer_load_dwordx3 v[56:58], v11, s[92:95], 0 offen
    buffer_load_dword v59, v11, s[92:95], 0 offen offset:12
    s_mov_b64 exec, -1
L_tw11:
    s_nop 1
    s_memrealtime s[44:45]
    s_waitcnt lgkmcnt(0)
    s_sub_u32 s45, s44, s42
    s_cmp_lt_i32 s45, 0
    s_cbranch_scc1 L_tw11
    s_add_u32 s42, s44, 140
    s_mov_b32 exec_lo, 0xffffffff
    s_mov_b32 exec_hi, 0x0
    buffer_load_dwordx3 v[60:62], v11, s[96:99], 0 offen
    buffer_load_dword v63, v11, s[96:99], 0 offen offset:12
L_tw12:
    s_nop 1
    s_memrealtime s[44:45]
    s_waitcnt lgkmcnt(0)
    s_sub_u32 s45, s44, s42
    s_cmp_lt_i32 s45, 0
    s_cbranch_scc1 L_tw12
    s_add_u32 s42, s44, 140
    s_mov_b32 exec_lo, 0x0
    s_mov_b32 exec_hi, 0xffffffff
    buffer_load_dwordx3 v[60:62], v11, s[96:99], 0 offen
    buffer_load_dword v63, v11, s[96:99], 0 offen offset:12
    s_mov_b64 exec, -1
    v_add_u32 v4, 48, v12
    v_bfe_u32 v5, v4, 3, 2
    v_and_or_b32 v5, v4, 4, v5
    v_xor_b32 v5, v13, v5
    v_add_u32 v4, s36, v4
    v_lshl_add_u32 v6, v4, 5, v5
    v_lshl_add_u32 v6, v6, 4, 1
    v_mul_hi_u32 v6, v6, s38
    v_lshrrev_b32 v6, 1, v6
    v_lshrrev_b32 v11, 1, v6
    v_lshlrev_b32 v11, 2, v11
L_tw13:
    s_nop 1
    s_memrealtime s[44:45]
    s_waitcnt lgkmcnt(0)
    s_sub_u32 s45, s44, s42
    s_cmp_lt_i32 s45, 0
    s_cbranch_scc1 L_tw13
    s_add_u32 s42, s44, 140
    s_mov_b32 exec_lo, 0xffffffff
    s_mov_b32 exec_hi, 0x0
    buffer_load_dwordx3 v[72:74], v11, s[92:95], 0 offen
    buffer_load_dword v75, v11, s[92:95], 0 offen offset:12
L_tw14:
    s_nop 1
    s_memrealtime s[44:45]
    s_waitcnt lgkmcnt(0)
    s_sub_u32 s45, s44, s42
    s_cmp_lt_i32 s45, 0
    s_cbranch_scc1 L_tw14
    s_add_u32 s42, s44, 140
    s_mov_b32 exec_lo, 0x0
    s_mov_b32 exec_hi, 0xffffffff
    buffer_load_dwordx3 v[72:74], v11, s[92:95], 0 offen
    buffer_load_dword v75, v11, s[92:95], 0 offen offset:12
    s_mov_b64 exec, -1
L_tw15:
    s_nop 1
    s_memrealtime s[44:45]
    s_waitcnt lgkmcnt(0)
    s_sub_u32 s45, s44, s42
    s_cmp_lt_i32 s45, 0
    s_cbranch_scc1 L_tw15
    s_add_u32 s42, s44, 140
    s_mov_b32 exec_lo, 0xffffffff
    s_mov_b32 exec_hi, 0x0
    buffer_load_dwordx3 v[76:78], v11, s[96:99], 0 offen
    buffer_load_dword v79, v11, s[96:99], 0 offen offset:12
L_tw16:
    s_nop 1
    s_memrealtime s[44:45]
    s_waitcnt lgkmcnt(0)
    s_sub_u32 s45, s44, s42
    s_cmp_lt_i32 s45, 0
    s_cbranch_scc1 L_tw16
    s_add_u32 s42, s44, 140
    s_mov_b32 exec_lo, 0x0
    s_mov_b32 exec_hi, 0xffffffff
    buffer_load_dwordx3 v[76:78], v11, s[96:99], 0 offen
    buffer_load_dword v79, v11, s[96:99], 0 offen offset:12
    s_mov_b64 exec, -1
    ds_read_b64 v[16:17], v8 offset:256
    ds_read_b64 v[18:19], v8 offset:264
    ds_read_b64 v[20:21], v8 offset:272
    ds_read_b64 v[32:33], v8 offset:448
    ds_read_b64 v[34:35], v8 offset:456
    ds_read_b64 v[36:37], v8 offset:464
    ds_read_b64 v[48:49], v8 offset:640
    ds_read_b64 v[50:51], v8 offset:648
    ds_read_b64 v[52:53], v8 offset:656
    ds_read_b64 v[64:65], v8 offset:832
    ds_read_b64 v[66:67], v8 offset:840
    ds_read_b64 v[68:69], v8 offset:848
    s_mov_b32 s34, 0
    v_mov_b32 v5, 0xf149f2ca
    v_mov_b32 v4, 0xf149f2ca
    s_waitcnt vmcnt(0) lgkmcnt(0)
    s_mov_b64 exec, s[64:65]
    v_fma_mix_f32 v16, v81, 1.0, v80 op_sel:[0,0,0] op_sel_hi:[1,0,0]
    v_fma_mix_f32 v17, v81, 1.0, v80 op_sel:[1,0,0] op_sel_hi:[1,0,0]
    v_fma_mix_f32 v18, v82, 1.0, v80 op_sel:[0,0,0] op_sel_hi:[1,0,0]
    v_fma_mix_f32 v19, v82, 1.0, v80 op_sel:[1,0,0] op_sel_hi:[1,0,0]
    v_fma_mix_f32 v20, v83, 1.0, v80 op_sel:[0,0,0] op_sel_hi:[1,0,0]
    v_fma_mix_f32 v21, v83, 1.0, v80 op_sel:[1,0,0] op_sel_hi:[1,0,0]
    v_cmp_lt_f32 vcc, v80, v21
    s_nop 1
    v_cndmask_b32 v21, v21, v2, vcc
    s_mov_b64 exec, s[66:67]
    v_fma_mix_f32 v32, v85, 1.0, v84 op_sel:[0,0,0] op_sel_hi:[1,0,0]
    v_fma_mix_f32 v33, v85, 1.0, v84 op_sel:[1,0,0] op_sel_hi:[1,0,0]
    v_fma_mix_f32 v34, v86, 1.0, v84 op_sel:[0,0,0] op_sel_hi:[1,0,0]
    v_fma_mix_f32 v35, v86, 1.0, v84 op_sel:[1,0,0] op_sel_hi:[1,0,0]
    v_fma_mix_f32 v36, v87, 1.0, v84 op_sel:[0,0,0] op_sel_hi:[1,0,0]
    v_fma_mix_f32 v37, v87, 1.0, v84 op_sel:[1,0,0] op_sel_hi:[1,0,0]
    v_cmp_lt_f32 vcc, v84, v37
    s_nop 1
    v_cndmask_b32 v37, v37, v2, vcc
    v_fma_mix_f32 v48, v89, 1.0, v88 op_sel:[0,0,0] op_sel_hi:[1,0,0]
    v_fma_mix_f32 v49, v89, 1.0, v88 op_sel:[1,0,0] op_sel_hi:[1,0,0]
    v_fma_mix_f32 v50, v90, 1.0, v88 op_sel:[0,0,0] op_sel_hi:[1,0,0]
    v_fma_mix_f32 v51, v90, 1.0, v88 op_sel:[1,0,0] op_sel_hi:[1,0,0]
    v_fma_mix_f32 v52, v91, 1.0, v88 op_sel:[0,0,0] op_sel_hi:[1,0,0]
    v_fma_mix_f32 v53, v91, 1.0, v88 op_sel:[1,0,0] op_sel_hi:[1,0,0]
    v_cmp_lt_f32 vcc, v88, v53
    s_nop 1
    v_cndmask_b32 v53, v53, v2, vcc
    v_fma_mix_f32 v64, v93, 1.0, v92 op_sel:[0,0,0] op_sel_hi:[1,0,0]
    v_fma_mix_f32 v65, v93, 1.0, v92 op_sel:[1,0,0] op_sel_hi:[1,0,0]
    v_fma_mix_f32 v66, v94, 1.0, v92 op_sel:[0,0,0] op_sel_hi:[1,0,0]
    v_fma_mix_f32 v67, v94, 1.0, v92 op_sel:[1,0,0] op_sel_hi:[1,0,0]
    v_fma_mix_f32 v68, v95, 1.0, v92 op_sel:[0,0,0] op_sel_hi:[1,0,0]
    v_fma_mix_f32 v69, v95, 1.0, v92 op_sel:[1,0,0] op_sel_hi:[1,0,0]
    v_cmp_lt_f32 vcc, v92, v69
    s_nop 1
    v_cndmask_b32 v69, v69, v2, vcc
    s_mov_b64 exec, -1
    v_sub_f32 v16, v16, v22
    v_sub_f32 v17, v17, v22
    v_sub_f32 v18, v18, v22
    v_sub_f32 v19, v19, v22
    v_sub_f32 v20, v20, v22
    v_sub_f32 v21, v21, v22
    v_mul_f32 v16, s37, v16
    v_mul_f32 v17, s37, v17
    v_mul_f32 v18, s37, v18
    v_mul_f32 v19, s37, v19
    v_mul_f32 v20, s37, v20
    v_mul_f32 v21, s37, v21
    v_cndmask_b32 v21, v5, v21, s[24:25]
    v_max3_f32 v4, v4, v16, v17
    v_max3_f32 v4, v4, v18, v19
    v_max3_f32 v4, v4, v20, v21
    v_alignbit_b32 v24, v25, v24, v23
    v_alignbit_b32 v25, v26, v25, v23
    v_alignbit_b32 v26, v27, v26, v23
    v_alignbit_b32 v28, v29, v28, v23
    v_alignbit_b32 v29, v30, v29, v23
    v_alignbit_b32 v30, v31, v30, v23
    v_sub_f32 v32, v32, v38
    v_sub_f32 v33, v33, v38
    v_sub_f32 v34, v34, v38
    v_sub_f32 v35, v35, v38
    v_sub_f32 v36, v36, v38
    v_sub_f32 v37, v37, v38
    v_mul_f32 v32, s37, v32
    v_mul_f32 v33, s37, v33
    v_mul_f32 v34, s37, v34
    v_mul_f32 v35, s37, v35
    v_mul_f32 v36, s37, v36
    v_mul_f32 v37, s37, v37
    v_cndmask_b32 v37, v5, v37, s[26:27]
    v_max3_f32 v4, v4, v32, v33
    v_max3_f32 v4, v4, v34, v35
    v_max3_f32 v4, v4, v36, v37
    v_alignbit_b32 v40, v41, v40, v39
    v_alignbit_b32 v41, v42, v41, v39
    v_alignbit_b32 v42, v43, v42, v39
    v_alignbit_b32 v44, v45, v44, v39
    v_alignbit_b32 v45, v46, v45, v39
    v_alignbit_b32 v46, v47, v46, v39
    v_sub_f32 v48, v48, v54
    v_sub_f32 v49, v49, v54
    v_sub_f32 v50, v50, v54
    v_sub_f32 v51, v51, v54
    v_sub_f32 v52, v52, v54
    v_sub_f32 v53, v53, v54
    v_mul_f32 v48, s37, v48
    v_mul_f32 v49, s37, v49
    v_mul_f32 v50, s37, v50
    v_mul_f32 v51, s37, v51
    v_mul_f32 v52, s37, v52
    v_mul_f32 v53, s37, v53
    v_cndmask_b32 v53, v5, v53, s[28:29]
    v_max3_f32 v4, v4, v48, v49
    v_max3_f32 v4, v4, v50, v51
    v_max3_f32 v4, v4, v52, v53
    v_alignbit_b32 v56, v57, v56, v55
    v_alignbit_b32 v57, v58, v57, v55
    v_alignbit_b32 v58, v59, v58, v55
    v_alignbit_b32 v60, v61, v60, v55
    v_alignbit_b32 v61, v62, v61, v55
    v_alignbit_b32 v62, v63, v62, v55
    v_sub_f32 v64, v64, v70
    v_sub_f32 v65, v65, v70
    v_sub_f32 v66, v66, v70
    v_sub_f32 v67, v67, v70
    v_sub_f32 v68, v68, v70
    v_sub_f32 v69, v69, v70
    v_mul_f32 v64, s37, v64
    v_mul_f32 v65, s37, v65
    v_mul_f32 v66, s37, v66
    v_mul_f32 v67, s37, v67
    v_mul_f32 v68, s37, v68
    v_mul_f32 v69, s37, v69
    v_cndmask_b32 v69, v5, v69, s[30:31]
    v_max3_f32 v4, v4, v64, v65
    v_max3_f32 v4, v4, v66, v67
    v_max3_f32 v4, v4, v68, v69
    v_alignbit_b32 v72, v73, v72, v71
    v_alignbit_b32 v73, v74, v73, v71
    v_alignbit_b32 v74, v75, v74, v71
    v_alignbit_b32 v76, v77, v76, v71
    v_alignbit_b32 v77, v78, v77, v71
    v_alignbit_b32 v78, v79, v78, v71
    v_max_f32_dpp v4, v4, v4 row_ror:8 row_mask:0xf bank_mask:0xf
    s_nop 1
    v_max_f32_dpp v4, v4, v4 row_ror:4 row_mask:0xf bank_mask:0xf
    s_nop 1
    v_max_f32_dpp v4, v4, v4 row_ror:2 row_mask:0xf bank_mask:0xf
    s_nop 1
    v_max_f32_dpp v4, v4, v4 row_ror:1 row_mask:0xf bank_mask:0xf
    v_mov_b32 v5, v4
    s_nop 1
    v_permlane32_swap_b32 v4, v5
    v_max_f32 v4, v4, v5
    v_mov_b32 v5, v4
    s_nop 1
    v_permlane16_swap_b32 v4, v5
    v_max_f32 v4, v4, v5
    v_mov_b32 v5, 0
    v_mov_b32 v6, 0
    v_sub_f32 v16, v16, v4
    v_sub_f32 v17, v17, v4
    v_sub_f32 v18, v18, v4
    v_sub_f32 v19, v19, v4
    v_sub_f32 v20, v20, v4
    v_sub_f32 v21, v21, v4
    v_exp_f32 v16, v16
    v_exp_f32 v17, v17
    v_exp_f32 v18, v18
    v_exp_f32 v19, v19
    v_exp_f32 v20, v20
    v_exp_f32 v21, v21
    v_add_f32 v5, v5, v16
    v_lshlrev_b32 v10, 16, v24
    v_lshlrev_b32 v11, 16, v28
    v_mul_f32 v16, v16, v10
    v_fmac_f32 v6, v16, v11
    v_add_f32 v5, v5, v17
    v_and_b32 v10, 0xffff0000, v24
    v_and_b32 v11, 0xffff0000, v28
    v_mul_f32 v17, v17, v10
    v_fmac_f32 v6, v17, v11
    v_add_f32 v5, v5, v18
    v_lshlrev_b32 v10, 16, v25
    v_lshlrev_b32 v11, 16, v29
    v_mul_f32 v18, v18, v10
    v_fmac_f32 v6, v18, v11
    v_add_f32 v5, v5, v19
    v_and_b32 v10, 0xffff0000, v25
    v_and_b32 v11, 0xffff0000, v29
    v_mul_f32 v19, v19, v10
    v_fmac_f32 v6, v19, v11
    v_add_f32 v5, v5, v20
    v_lshlrev_b32 v10, 16, v26
    v_lshlrev_b32 v11, 16, v30
    v_mul_f32 v20, v20, v10
    v_fmac_f32 v6, v20, v11
    v_add_f32 v5, v5, v21
    v_and_b32 v10, 0xffff0000, v26
    v_and_b32 v11, 0xffff0000, v30
    v_mul_f32 v21, v21, v10
    v_fmac_f32 v6, v21, v11
    ds_write_b128 v14, v[16:19] offset:18688
    ds_write_b64 v14, v[20:21] offset:18704
    v_sub_f32 v32, v32, v4
    v_sub_f32 v33, v33, v4
    v_sub_f32 v34, v34, v4
    v_sub_f32 v35, v35, v4
    v_sub_f32 v36, v36, v4
    v_sub_f32 v37, v37, v4
    v_exp_f32 v32, v32
    v_exp_f32 v33, v33
    v_exp_f32 v34, v34
    v_exp_f32 v35, v35
    v_exp_f32 v36, v36
    v_exp_f32 v37, v37
    v_add_f32 v5, v5, v32
    v_lshlrev_b32 v10, 16, v40
    v_lshlrev_b32 v11, 16, v44
    v_mul_f32 v32, v32, v10
    v_fmac_f32 v6, v32, v11
    v_add_f32 v5, v5, v33
    v_and_b32 v10, 0xffff0000, v40
    v_and_b32 v11, 0xffff0000, v44
    v_mul_f32 v33, v33, v10
    v_fmac_f32 v6, v33, v11
    v_add_f32 v5, v5, v34
    v_lshlrev_b32 v10, 16, v41
    v_lshlrev_b32 v11, 16, v45
    v_mul_f32 v34, v34, v10
    v_fmac_f32 v6, v34, v11
    v_add_f32 v5, v5, v35
    v_and_b32 v10, 0xffff0000, v41
    v_and_b32 v11, 0xffff0000, v45
    v_mul_f32 v35, v35, v10
    v_fmac_f32 v6, v35, v11
    v_add_f32 v5, v5, v36
    v_lshlrev_b32 v10, 16, v42
    v_lshlrev_b32 v11, 16, v46
    v_mul_f32 v36, v36, v10
    v_fmac_f32 v6, v36, v11
    v_add_f32 v5, v5, v37
    v_and_b32 v10, 0xffff0000, v42
    v_and_b32 v11, 0xffff0000, v46
    v_mul_f32 v37, v37, v10
    v_fmac_f32 v6, v37, v11
    ds_write_b128 v14, v[32:35] offset:20736
    ds_write_b64 v14, v[36:37] offset:20752
    v_sub_f32 v48, v48, v4
    v_sub_f32 v49, v49, v4
    v_sub_f32 v50, v50, v4
    v_sub_f32 v51, v51, v4
    v_sub_f32 v52, v52, v4
    v_sub_f32 v53, v53, v4
    v_exp_f32 v48, v48
    v_exp_f32 v49, v49
    v_exp_f32 v50, v50
    v_exp_f32 v51, v51
    v_exp_f32 v52, v52
    v_exp_f32 v53, v53
    v_add_f32 v5, v5, v48
    v_lshlrev_b32 v10, 16, v56
    v_lshlrev_b32 v11, 16, v60
    v_mul_f32 v48, v48, v10
    v_fmac_f32 v6, v48, v11
    v_add_f32 v5, v5, v49
    v_and_b32 v10, 0xffff0000, v56
    v_and_b32 v11, 0xffff0000, v60
    v_mul_f32 v49, v49, v10
    v_fmac_f32 v6, v49, v11
    v_add_f32 v5, v5, v50
    v_lshlrev_b32 v10, 16, v57
    v_lshlrev_b32 v11, 16, v61
    v_mul_f32 v50, v50, v10
    v_fmac_f32 v6, v50, v11
    v_add_f32 v5, v5, v51
    v_and_b32 v10, 0xffff0000, v57
    v_and_b32 v11, 0xffff0000, v61
    v_mul_f32 v51, v51, v10
    v_fmac_f32 v6, v51, v11
    v_add_f32 v5, v5, v52
    v_lshlrev_b32 v10, 16, v58
    v_lshlrev_b32 v11, 16, v62
    v_mul_f32 v52, v52, v10
    v_fmac_f32 v6, v52, v11
    v_add_f32 v5, v5, v53
    v_and_b32 v10, 0xffff0000, v58
    v_and_b32 v11, 0xffff0000, v62
    v_mul_f32 v53, v53, v10
    v_fmac_f32 v6, v53, v11
    ds_write_b128 v14, v[48:51] offset:22784
    ds_write_b64 v14, v[52:53] offset:22800
    v_sub_f32 v64, v64, v4
    v_sub_f32 v65, v65, v4
    v_sub_f32 v66, v66, v4
    v_sub_f32 v67, v67, v4
    v_sub_f32 v68, v68, v4
    v_sub_f32 v69, v69, v4
    v_exp_f32 v64, v64
    v_exp_f32 v65, v65
    v_exp_f32 v66, v66
    v_exp_f32 v67, v67
    v_exp_f32 v68, v68
    v_exp_f32 v69, v69
    v_add_f32 v5, v5, v64
    v_lshlrev_b32 v10, 16, v72
    v_lshlrev_b32 v11, 16, v76
    v_mul_f32 v64, v64, v10
    v_fmac_f32 v6, v64, v11
    v_add_f32 v5, v5, v65
    v_and_b32 v10, 0xffff0000, v72
    v_and_b32 v11, 0xffff0000, v76
    v_mul_f32 v65, v65, v10
    v_fmac_f32 v6, v65, v11
    v_add_f32 v5, v5, v66
    v_lshlrev_b32 v10, 16, v73
    v_lshlrev_b32 v11, 16, v77
    v_mul_f32 v66, v66, v10
    v_fmac_f32 v6, v66, v11
    v_add_f32 v5, v5, v67
    v_and_b32 v10, 0xffff0000, v73
    v_and_b32 v11, 0xffff0000, v77
    v_mul_f32 v67, v67, v10
    v_fmac_f32 v6, v67, v11
    v_add_f32 v5, v5, v68
    v_lshlrev_b32 v10, 16, v74
    v_lshlrev_b32 v11, 16, v78
    v_mul_f32 v68, v68, v10
    v_fmac_f32 v6, v68, v11
    v_add_f32 v5, v5, v69
    v_and_b32 v10, 0xffff0000, v74
    v_and_b32 v11, 0xffff0000, v78
    v_mul_f32 v69, v69, v10
    v_fmac_f32 v6, v69, v11
    ds_write_b128 v14, v[64:67] offset:24832
    ds_write_b64 v14, v[68:69] offset:24848
    v_add_f32_dpp v5, v5, v5 row_ror:8 row_mask:0xf bank_mask:0xf
    v_add_f32_dpp v6, v6, v6 row_ror:8 row_mask:0xf bank_mask:0xf
    s_nop 0
    v_add_f32_dpp v5, v5, v5 row_ror:4 row_mask:0xf bank_mask:0xf
    v_add_f32_dpp v6, v6, v6 row_ror:4 row_mask:0xf bank_mask:0xf
    s_nop 0
    v_add_f32_dpp v5, v5, v5 row_ror:2 row_mask:0xf bank_mask:0xf
    v_add_f32_dpp v6, v6, v6 row_ror:2 row_mask:0xf bank_mask:0xf
    s_nop 0
    v_add_f32_dpp v5, v5, v5 row_ror:1 row_mask:0xf bank_mask:0xf
    v_add_f32_dpp v6, v6, v6 row_ror:1 row_mask:0xf bank_mask:0xf
    v_mov_b32 v10, v5
    v_mov_b32 v11, v6
    s_nop 0
    v_permlane32_swap_b32 v5, v10
    v_permlane32_swap_b32 v6, v11
    v_add_f32 v5, v5, v10
    v_add_f32 v6, v6, v11
    v_mov_b32 v10, v5
    v_mov_b32 v11, v6
    s_nop 0
    v_permlane16_swap_b32 v5, v10
    v_permlane16_swap_b32 v6, v11
    v_add_f32 v5, v5, v10
    v_add_f32 v6, v6, v11
    s_lshl_b32 s48, s61, 2
    v_mov_b32 v10, s48
    v_lshlrev_b32 v11, 2, v10
    v_mov_b32 v7, s39
    s_mov_b64 exec, 1
    ds_write_b128 v11, v[4:7] offset:80
    ds_write_b32 v10, v7 offset:24
    s_lshl_b32 s48, s61, 8
    s_add_u32 s48, s48, s2
    s_lshl_b32 s48, s48, 6
    s_add_u32 s48, s48, 917504
    buffer_store_dwordx4 v[4:7], off, s[12:15], s48 sc1
    s_mov_b64 exec, -1
    v_add_u32 v14, 8192, v14
    v_add_u32 v8, 6144, v8
    s_add_u32 s35, s35, 1048576
    s_add_u32 s61, s61, 1
    s_cmp_lt_u32 s61, 3
    s_cbranch_scc1 L_prep
    s_mov_b32 s61, 0
    v_lshlrev_b32 v12, 2, v1
    v_add_u32 v13, 43264, v12
    v_lshlrev_b32 v8, 4, v1
    v_mov_b32 v31, 1
L_merge:
    s_nop 1
    s_lshl_b32 s48, s61, 2
    v_mov_b32 v3, s48
    v_lshlrev_b32 v11, 2, v3
    ds_read_b128 v[4:7], v11 offset:80
    s_lshl_b32 s62, s61, 8
    s_add_u32 s62, s62, s2
    s_lshl_b32 s62, s62, 10
    s_mov_b32 s60, 0x100000
L_wm:
    s_nop 1
    ds_read_b32 v10, v3 offset:64
    s_sub_u32 s60, s60, 1
    s_cbranch_scc1 L_exit1
    s_waitcnt lgkmcnt(0)
    v_readfirstlane_b32 s48, v10
    s_cmp_lt_u32 s48, 4
    s_cbranch_scc1 L_wm
    ds_read_b32 v16, v13 offset:0
    ds_read_b32 v17, v13 offset:768
    ds_read_b32 v18, v13 offset:1536
    ds_read_b32 v19, v13 offset:2304
    ds_read_b32 v20, v13 offset:256
    ds_read_b32 v21, v13 offset:1024
    ds_read_b32 v22, v13 offset:1792
    ds_read_b32 v23, v13 offset:2560
    ds_read_b32 v24, v13 offset:512
    ds_read_b32 v25, v13 offset:1280
    ds_read_b32 v26, v13 offset:2048
    ds_read_b32 v27, v13 offset:2816
    s_waitcnt lgkmcnt(8)
    v_add_f32 v16, v16, v17
    v_add_f32 v18, v18, v19
    v_sub_f32 v16, v16, v6
    v_add_f32 v28, v16, v18
    s_waitcnt lgkmcnt(4)
    v_add_f32 v20, v20, v21
    v_add_f32 v22, v22, v23
    v_sub_f32 v20, v20, v6
    v_add_f32 v29, v20, v22
    s_waitcnt lgkmcnt(0)
    v_add_f32 v24, v24, v25
    v_add_f32 v26, v26, v27
    v_sub_f32 v24, v24, v6
    v_add_f32 v30, v24, v26
    buffer_store_dwordx4 v[28:31], v8, s[12:15], s62 offen sc1
    v_add_u32 v13, 3072, v13
    s_add_u32 s61, s61, 1
    s_cmp_lt_u32 s61, 3
    s_cbranch_scc1 L_merge
    s_endpgm
.section .rodata,"a"
.p2align 6
.amdhsa_kernel standalone__kv_cache_quant_int4_int2_kv_with_per_channel_or_per_token_scales__decode_kernel
  .amdhsa_next_free_vgpr 136
  .amdhsa_next_free_sgpr 102
  .amdhsa_accum_offset 136
  .amdhsa_group_segment_fixed_size 0
  .amdhsa_kernarg_size 80
  .amdhsa_user_sgpr_count 2
  .amdhsa_user_sgpr_kernarg_segment_ptr 1
  .amdhsa_system_sgpr_workgroup_id_x 1
.end_amdhsa_kernel
```

```asm
; @launch kernel=standalone__kv_cache_quant_int4_int2_kv_with_per_channel_or_per_token_scales__decode_kernel grid=(256,1,1) block=(512,1,1) lds=52480
.amdgcn_target "amdgcn-amd-amdhsa--gfx950"
.text
.globl standalone__kv_cache_quant_int4_int2_kv_with_per_channel_or_per_token_scales__decode_kernel
.p2align 8
.type standalone__kv_cache_quant_int4_int2_kv_with_per_channel_or_per_token_scales__decode_kernel,@function
standalone__kv_cache_quant_int4_int2_kv_with_per_channel_or_per_token_scales__decode_kernel:
    s_cmp_ge_u32 s2, 256
    s_cbranch_scc1 L_exit1
    s_load_dwordx16 s[64:79], s[0:1], 0
    s_load_dwordx4 s[80:83], s[0:1], 64
    v_lshrrev_b32 v10, 6, v0
    v_and_b32 v11, 63, v0
    v_readfirstlane_b32 s28, v10
    s_lshr_b32 s3, s2, 3
    s_and_b32 s4, s2, 7
    s_lshr_b32 s32, s2, 6
    s_xor_b32 s32, s32, s4
    s_lshr_b32 s48, s32, 1
    s_and_b32 s32, s32, 1
    s_lshl_b32 s32, s32, 2
    s_or_b32 s48, s48, s32
    s_cmp_ge_u32 s28, 4
    s_cbranch_scc1 L_helper
    v_lshrrev_b32 v1, 4, v11
    v_and_b32 v52, 15, v11
    v_lshlrev_b32 v2, 4, v52
    v_lshlrev_b32 v3, 3, v52
    v_lshlrev_b32 v62, 7, v1
    v_and_b32 v63, 0x70, v0
    v_or_b32 v63, v63, v62
    v_mov_b32 v50, v63
    s_mov_b32 s45, 768
    s_mov_b32 s46, 384
    s_mov_b32 s47, 0xaaaaaaab
    v_mov_b32 v51, 0xc0000000
    s_lshl_b32 s44, s3, 6
    s_mov_b32 s5, s48
    s_mov_b32 s29, s28
    s_lshr_b32 s33, s29, 6
    s_lshl_b32 s33, s33, 11
    s_and_b32 s32, s29, 63
    s_add_u32 s32, s32, s33
    s_add_u32 s32, s32, s44
    s_bfe_u32 s33, s32, 0x20003
    s_and_b32 s34, s32, 4
    s_or_b32 s33, s33, s34
    s_xor_b32 s33, s33, s5
    s_lshl_b32 s50, s32, 5
    s_or_b32 s50, s50, s33
    s_lshl_b32 s50, s50, 4
    s_or_b32 s50, s50, 1
    v_xor_b32 v10, s50, v50
    v_mul_hi_u32 v10, v10, s47
    v_lshrrev_b32 v10, 1, v10
    v_and_b32 v11, 15, v10
    v_cmp_eq_u32 vcc, 5, v11
    v_mad_u32_u24 v48, v10, s45, v2
    v_add_u32 v11, 3840, v48
    v_cndmask_b32 v49, v51, v11, vcc
    v_lshrrev_b32 v10, 6, v10
    v_mad_u32_u24 v9, v10, s46, v3
    s_waitcnt lgkmcnt(0)
    s_mov_b32 s30, 0
    s_mov_b32 s8, s66
    s_and_b32 s9, s67, 0xffff
    s_mov_b32 s10, 805306368
    s_mov_b32 s11, 0x00020000
    buffer_load_dwordx4 v[64:67], v48, s[8:11], 0 offen offset:0 nt
    buffer_load_dwordx4 v[68:71], v48, s[8:11], 0 offen offset:256 nt
    buffer_load_dwordx4 v[72:75], v48, s[8:11], 0 offen offset:512 nt
    buffer_load_dwordx4 v[76:79], v48, s[8:11], 0 offen offset:768 nt
    buffer_load_dwordx4 v[80:83], v48, s[8:11], 0 offen offset:1024 nt
    buffer_load_dwordx4 v[84:87], v48, s[8:11], 0 offen offset:1280 nt
    s_mov_b32 s20, s64
    s_and_b32 s21, s65, 0xffff
    s_mov_b32 s22, 12288
    s_mov_b32 s23, 0x00020000
    s_lshl_b32 s31, s30, 5
    s_add_u32 s31, s31, s3
    s_mul_i32 s31, s31, 171
    s_lshr_b32 s31, s31, 9
    s_mul_i32 s31, s31, 384
    buffer_load_dwordx2 v[36:37], v3, s[20:23], s31 offen offset:0
    buffer_load_dwordx2 v[38:39], v3, s[20:23], s31 offen offset:128
    buffer_load_dwordx2 v[40:41], v3, s[20:23], s31 offen offset:256
    s_mov_b32 s16, s70
    s_and_b32 s17, s71, 0xffff
    s_mov_b32 s18, 6291456
    s_mov_b32 s19, 0x00020000
    buffer_load_dwordx2 v[42:43], v9, s[16:19], 0 offen offset:0
    buffer_load_dwordx2 v[44:45], v9, s[16:19], 0 offen offset:128
    buffer_load_dwordx2 v[46:47], v9, s[16:19], 0 offen offset:256
    buffer_load_dwordx4 v[88:91], v48, s[8:11], 0 offen offset:1536 nt
    buffer_load_dwordx4 v[92:95], v48, s[8:11], 0 offen offset:1792 nt
    buffer_load_dwordx4 v[96:99], v48, s[8:11], 0 offen offset:2048 nt
    buffer_load_dwordx4 v[100:103], v48, s[8:11], 0 offen offset:2304 nt
    buffer_load_dwordx4 v[104:107], v48, s[8:11], 0 offen offset:2560 nt
    buffer_load_dwordx4 v[108:111], v48, s[8:11], 0 offen offset:2816 nt
    buffer_load_dwordx4 v[112:115], v48, s[8:11], 0 offen offset:3072 nt
    buffer_load_dwordx4 v[116:119], v48, s[8:11], 0 offen offset:3328 nt
    buffer_load_dwordx4 v[120:123], v48, s[8:11], 0 offen offset:3584 nt
    buffer_load_dwordx4 v[124:127], v49, s[8:11], 0 offen offset:0 nt
    buffer_load_dwordx4 v[128:131], v49, s[8:11], 0 offen offset:256 nt
    buffer_load_dwordx4 v[132:135], v49, s[8:11], 0 offen offset:512 nt
    s_mov_b32 s12, s68
    s_and_b32 s13, s69, 0xffff
    s_mov_b32 s14, 805306368
    s_mov_b32 s15, 0x00020000
    v_lshlrev_b32 v11, 5, v1
    v_bfe_u32 v4, v0, 4, 3
    v_mul_u32_u24 v4, s45, v4
    v_lshl_add_u32 v4, v52, 1, v4
    s_lshr_b32 s32, s28, 1
    s_mul_i32 s32, s32, 24
    s_add_u32 s32, s32, 256
    v_add_u32 v4, s32, v4
    v_and_b32 v5, 7, v52
    v_lshl_add_u32 v5, v5, 2, v11
    v_add_u32 v5, 18688, v5
    v_lshlrev_b32 v8, 2, v1
    v_add_u32 v8, v2, v8
    s_mul_i32 s32, s28, 768
    s_add_u32 s32, s32, 43264
    v_add_u32 v8, s32, v8
    v_mov_b32 v53, 0
    v_mov_b32 v60, 0
    v_mov_b32 v61, 0
    s_mov_b32 s42, 0x01110111
    s_mov_b32 s43, 0x01110111
    s_mov_b32 s40, 0xea2bea0c
    s_mov_b32 s41, 0xea2b
    s_mov_b32 s64, 0x2020200
    s_mov_b32 s65, 0x202
    s_mov_b32 s66, 0x8080800
    s_mov_b32 s67, 0x808
    s_mov_b32 s68, 0x20202000
    s_mov_b32 s69, 0x2020
    s_mov_b32 s70, 0xc003c00c
    s_mov_b32 s71, 0xc003
    s_mov_b32 s59, 0
    s_mov_b32 s63, 0
    s_mov_b32 s7, 0
    s_mov_b32 s62, 144
    v_mov_b32 v12, 0
    v_mov_b32 v13, 0
    v_mov_b32 v14, 0
    v_mov_b32 v15, 0
    v_mov_b32 v16, 0
    v_mov_b32 v17, 0
    v_mov_b32 v18, 0
    v_mov_b32 v19, 0
    v_mov_b32 v20, 0
    v_mov_b32 v21, 0
    v_mov_b32 v22, 0
    v_mov_b32 v23, 0
    s_barrier
    s_waitcnt vmcnt(12)
    v_lshlrev_b32 v10, 16, v36
    v_lshlrev_b32 v24, 16, v42
    v_and_b32 v11, 0xffff0000, v36
    v_and_b32 v25, 0xffff0000, v42
    v_mul_f32 v24, v24, v10
    v_mul_f32 v25, v25, v11
    v_lshlrev_b32 v10, 16, v37
    v_lshlrev_b32 v26, 16, v43
    v_and_b32 v11, 0xffff0000, v37
    v_and_b32 v27, 0xffff0000, v43
    v_mul_f32 v26, v26, v10
    v_mul_f32 v27, v27, v11
    v_lshlrev_b32 v10, 16, v38
    v_lshlrev_b32 v28, 16, v44
    v_and_b32 v11, 0xffff0000, v38
    v_and_b32 v29, 0xffff0000, v44
    v_mul_f32 v28, v28, v10
    v_mul_f32 v29, v29, v11
    v_lshlrev_b32 v10, 16, v39
    v_lshlrev_b32 v30, 16, v45
    v_and_b32 v11, 0xffff0000, v39
    v_and_b32 v31, 0xffff0000, v45
    v_mul_f32 v30, v30, v10
    v_mul_f32 v31, v31, v11
    v_lshlrev_b32 v10, 16, v40
    v_lshlrev_b32 v32, 16, v46
    v_and_b32 v11, 0xffff0000, v40
    v_and_b32 v33, 0xffff0000, v46
    v_mul_f32 v32, v32, v10
    v_mul_f32 v33, v33, v11
    v_lshlrev_b32 v10, 16, v41
    v_lshlrev_b32 v34, 16, v47
    v_and_b32 v11, 0xffff0000, v41
    v_and_b32 v35, 0xffff0000, v47
    v_mul_f32 v34, v34, v10
    v_mul_f32 v35, v35, v11
    v_cvt_f32_i32 v64, v64
    v_cvt_f32_i32 v65, v65
    v_cvt_f32_i32 v66, v66
    v_cvt_f32_i32 v67, v67
    v_mul_f32 v54, v64, v24
    v_fmac_f32 v54, v65, v25
    v_fmac_f32 v54, v66, v26
    v_fmac_f32 v54, v67, v27
    v_cvt_f32_i32 v68, v68
    v_cvt_f32_i32 v69, v69
    v_cvt_f32_i32 v70, v70
    v_cvt_f32_i32 v71, v71
    v_fmac_f32 v54, v68, v28
    v_fmac_f32 v54, v69, v29
    v_fmac_f32 v54, v70, v30
    v_fmac_f32 v54, v71, v31
    v_cvt_f32_i32 v72, v72
    v_cvt_f32_i32 v73, v73
    v_cvt_f32_i32 v74, v74
    v_cvt_f32_i32 v75, v75
    v_fmac_f32 v54, v72, v32
    v_fmac_f32 v54, v73, v33
    v_fmac_f32 v54, v74, v34
    v_fmac_f32 v54, v75, v35
    v_cvt_f32_i32 v76, v76
    v_cvt_f32_i32 v77, v77
    v_add_f32_dpp v54, v54, v54 row_ror:8 row_mask:0xf bank_mask:0xf
    v_cvt_f32_i32 v78, v78
    v_cvt_f32_i32 v79, v79
    v_add_f32_dpp v54, v54, v54 row_ror:4 row_mask:0xf bank_mask:0xf
    v_mul_f32 v55, v76, v24
    v_fmac_f32 v55, v77, v25
    v_add_f32_dpp v54, v54, v54 row_ror:2 row_mask:0xf bank_mask:0xf
    v_fmac_f32 v55, v78, v26
    v_fmac_f32 v55, v79, v27
    v_add_f32_dpp v60, v54, v54 row_ror:1 row_mask:0xf bank_mask:0x1
    v_cvt_f32_i32 v80, v80
    v_cvt_f32_i32 v81, v81
    v_cvt_f32_i32 v82, v82
    v_cvt_f32_i32 v83, v83
    v_fmac_f32 v55, v80, v28
    v_fmac_f32 v55, v81, v29
    v_fmac_f32 v55, v82, v30
    v_fmac_f32 v55, v83, v31
    v_cvt_f32_i32 v84, v84
    v_cvt_f32_i32 v85, v85
    v_cvt_f32_i32 v86, v86
    v_cvt_f32_i32 v87, v87
    v_fmac_f32 v55, v84, v32
    v_fmac_f32 v55, v85, v33
    v_fmac_f32 v55, v86, v34
    v_fmac_f32 v55, v87, v35
    s_nop 1
    v_add_f32_dpp v55, v55, v55 row_ror:8 row_mask:0xf bank_mask:0xf
    s_nop 1
    v_add_f32_dpp v55, v55, v55 row_ror:4 row_mask:0xf bank_mask:0xf
    s_nop 1
    v_add_f32_dpp v55, v55, v55 row_ror:2 row_mask:0xf bank_mask:0xf
    s_nop 1
    v_add_f32_dpp v61, v55, v55 row_ror:1 row_mask:0xf bank_mask:0x1
    s_waitcnt vmcnt(6)
    s_add_u32 s29, s29, 4
    s_add_u32 s30, s30, 1
    s_lshr_b32 s33, s29, 6
    s_lshl_b32 s33, s33, 11
    s_and_b32 s32, s29, 63
    s_add_u32 s32, s32, s33
    s_add_u32 s32, s32, s44
    s_bfe_u32 s33, s32, 0x20003
    s_and_b32 s34, s32, 4
    s_or_b32 s33, s33, s34
    s_xor_b32 s33, s33, s5
    s_lshl_b32 s50, s32, 5
    s_or_b32 s50, s50, s33
    s_lshl_b32 s50, s50, 4
    s_or_b32 s50, s50, 1
    v_xor_b32 v10, s50, v50
    v_mul_hi_u32 v10, v10, s47
    v_lshrrev_b32 v10, 1, v10
    v_and_b32 v11, 15, v10
    v_cmp_eq_u32 vcc, 5, v11
    v_mad_u32_u24 v48, v10, s45, v2
    v_add_u32 v11, 3840, v48
    v_cndmask_b32 v49, v51, v11, vcc
    v_lshrrev_b32 v10, 6, v10
    v_mad_u32_u24 v9, v10, s46, v3
    buffer_load_dwordx2 v[42:43], v9, s[16:19], 0 offen offset:0
    buffer_load_dwordx2 v[44:45], v9, s[16:19], 0 offen offset:128
    buffer_load_dwordx2 v[46:47], v9, s[16:19], 0 offen offset:256
    v_cvt_f32_i32 v88, v88
    v_cvt_f32_i32 v89, v89
    v_cvt_f32_i32 v90, v90
    v_cvt_f32_i32 v91, v91
    v_mul_f32 v56, v88, v24
    v_fmac_f32 v56, v89, v25
    v_fmac_f32 v56, v90, v26
    v_fmac_f32 v56, v91, v27
    v_cvt_f32_i32 v92, v92
    v_cvt_f32_i32 v93, v93
    v_cvt_f32_i32 v94, v94
    v_cvt_f32_i32 v95, v95
    v_fmac_f32 v56, v92, v28
    v_fmac_f32 v56, v93, v29
    v_fmac_f32 v56, v94, v30
    v_fmac_f32 v56, v95, v31
    v_cvt_f32_i32 v96, v96
    v_cvt_f32_i32 v97, v97
    v_cvt_f32_i32 v98, v98
    v_cvt_f32_i32 v99, v99
    v_fmac_f32 v56, v96, v32
    v_fmac_f32 v56, v97, v33
    v_fmac_f32 v56, v98, v34
    v_fmac_f32 v56, v99, v35
    v_cvt_f32_i32 v100, v100
    v_cvt_f32_i32 v101, v101
    v_add_f32_dpp v56, v56, v56 row_ror:8 row_mask:0xf bank_mask:0xf
    v_cvt_f32_i32 v102, v102
    v_cvt_f32_i32 v103, v103
    v_add_f32_dpp v56, v56, v56 row_ror:4 row_mask:0xf bank_mask:0xf
    v_mul_f32 v57, v100, v24
    v_fmac_f32 v57, v101, v25
    v_add_f32_dpp v56, v56, v56 row_ror:2 row_mask:0xf bank_mask:0xf
    v_fmac_f32 v57, v102, v26
    v_fmac_f32 v57, v103, v27
    v_add_f32_dpp v60, v56, v56 row_ror:1 row_mask:0xf bank_mask:0x2
    v_cvt_f32_i32 v104, v104
    v_cvt_f32_i32 v105, v105
    v_cvt_f32_i32 v106, v106
    v_cvt_f32_i32 v107, v107
    v_fmac_f32 v57, v104, v28
    v_fmac_f32 v57, v105, v29
    v_fmac_f32 v57, v106, v30
    v_fmac_f32 v57, v107, v31
    v_cvt_f32_i32 v108, v108
    v_cvt_f32_i32 v109, v109
    v_cvt_f32_i32 v110, v110
    v_cvt_f32_i32 v111, v111
    v_fmac_f32 v57, v108, v32
    v_fmac_f32 v57, v109, v33
    v_fmac_f32 v57, v110, v34
    v_fmac_f32 v57, v111, v35
    s_nop 1
    v_add_f32_dpp v57, v57, v57 row_ror:8 row_mask:0xf bank_mask:0xf
    s_nop 1
    v_add_f32_dpp v57, v57, v57 row_ror:4 row_mask:0xf bank_mask:0xf
    s_nop 1
    v_add_f32_dpp v57, v57, v57 row_ror:2 row_mask:0xf bank_mask:0xf
    s_nop 1
    v_add_f32_dpp v61, v57, v57 row_ror:1 row_mask:0xf bank_mask:0x2
    s_waitcnt vmcnt(3)
    buffer_load_dwordx4 v[64:67], v48, s[8:11], 0 offen offset:0 nt
    buffer_load_dwordx4 v[68:71], v48, s[8:11], 0 offen offset:256 nt
    buffer_load_dwordx4 v[72:75], v48, s[8:11], 0 offen offset:512 nt
    buffer_load_dwordx4 v[76:79], v48, s[8:11], 0 offen offset:768 nt
    buffer_load_dwordx4 v[80:83], v48, s[8:11], 0 offen offset:1024 nt
    buffer_load_dwordx4 v[84:87], v48, s[8:11], 0 offen offset:1280 nt
    v_cvt_f32_i32 v112, v112
    v_cvt_f32_i32 v113, v113
    v_cvt_f32_i32 v114, v114
    v_cvt_f32_i32 v115, v115
    v_mul_f32 v58, v112, v24
    v_fmac_f32 v58, v113, v25
    v_fmac_f32 v58, v114, v26
    v_fmac_f32 v58, v115, v27
    v_cvt_f32_i32 v116, v116
    v_cvt_f32_i32 v117, v117
    v_cvt_f32_i32 v118, v118
    v_cvt_f32_i32 v119, v119
    v_fmac_f32 v58, v116, v28
    v_fmac_f32 v58, v117, v29
    v_fmac_f32 v58, v118, v30
    v_fmac_f32 v58, v119, v31
    v_cvt_f32_i32 v120, v120
    v_cvt_f32_i32 v121, v121
    v_cvt_f32_i32 v122, v122
    v_cvt_f32_i32 v123, v123
    v_fmac_f32 v58, v120, v32
    v_fmac_f32 v58, v121, v33
    v_fmac_f32 v58, v122, v34
    v_fmac_f32 v58, v123, v35
    v_cvt_f32_i32 v124, v124
    v_cvt_f32_i32 v125, v125
    v_add_f32_dpp v58, v58, v58 row_ror:8 row_mask:0xf bank_mask:0xf
    v_cvt_f32_i32 v126, v126
    v_cvt_f32_i32 v127, v127
    v_add_f32_dpp v58, v58, v58 row_ror:4 row_mask:0xf bank_mask:0xf
    v_mul_f32 v59, v124, v24
    v_fmac_f32 v59, v125, v25
    v_add_f32_dpp v58, v58, v58 row_ror:2 row_mask:0xf bank_mask:0xf
    v_fmac_f32 v59, v126, v26
    v_fmac_f32 v59, v127, v27
    v_add_f32_dpp v60, v58, v58 row_ror:1 row_mask:0xf bank_mask:0x4
    v_cvt_f32_i32 v128, v128
    v_cvt_f32_i32 v129, v129
    v_cvt_f32_i32 v130, v130
    v_cvt_f32_i32 v131, v131
    v_fmac_f32 v59, v128, v28
    v_fmac_f32 v59, v129, v29
    v_fmac_f32 v59, v130, v30
    v_fmac_f32 v59, v131, v31
    v_cvt_f32_i32 v132, v132
    v_cvt_f32_i32 v133, v133
    v_cvt_f32_i32 v134, v134
    v_cvt_f32_i32 v135, v135
    v_fmac_f32 v59, v132, v32
    v_fmac_f32 v59, v133, v33
    v_fmac_f32 v59, v134, v34
    v_fmac_f32 v59, v135, v35
    s_nop 1
    v_add_f32_dpp v59, v59, v59 row_ror:8 row_mask:0xf bank_mask:0xf
    s_nop 1
    v_add_f32_dpp v59, v59, v59 row_ror:4 row_mask:0xf bank_mask:0xf
    s_nop 1
    v_add_f32_dpp v59, v59, v59 row_ror:2 row_mask:0xf bank_mask:0xf
    s_nop 1
    v_add_f32_dpp v61, v59, v59 row_ror:1 row_mask:0xf bank_mask:0x4
    s_mov_b64 exec, s[42:43]
    ds_write_b64 v4, v[60:61]
    s_mov_b64 exec, -1
    v_add_u32 v4, 48, v4
    s_waitcnt vmcnt(6)
    v_lshlrev_b32 v10, 16, v36
    v_lshlrev_b32 v24, 16, v42
    v_and_b32 v11, 0xffff0000, v36
    v_and_b32 v25, 0xffff0000, v42
    v_mul_f32 v24, v24, v10
    v_mul_f32 v25, v25, v11
    v_lshlrev_b32 v10, 16, v37
    v_lshlrev_b32 v26, 16, v43
    v_and_b32 v11, 0xffff0000, v37
    v_and_b32 v27, 0xffff0000, v43
    v_mul_f32 v26, v26, v10
    v_mul_f32 v27, v27, v11
    v_lshlrev_b32 v10, 16, v38
    v_lshlrev_b32 v28, 16, v44
    v_and_b32 v11, 0xffff0000, v38
    v_and_b32 v29, 0xffff0000, v44
    v_mul_f32 v28, v28, v10
    v_mul_f32 v29, v29, v11
    v_lshlrev_b32 v10, 16, v39
    v_lshlrev_b32 v30, 16, v45
    v_and_b32 v11, 0xffff0000, v39
    v_and_b32 v31, 0xffff0000, v45
    v_mul_f32 v30, v30, v10
    v_mul_f32 v31, v31, v11
    v_lshlrev_b32 v10, 16, v40
    v_lshlrev_b32 v32, 16, v46
    v_and_b32 v11, 0xffff0000, v40
    v_and_b32 v33, 0xffff0000, v46
    v_mul_f32 v32, v32, v10
    v_mul_f32 v33, v33, v11
    v_lshlrev_b32 v10, 16, v41
    v_lshlrev_b32 v34, 16, v47
    v_and_b32 v11, 0xffff0000, v41
    v_and_b32 v35, 0xffff0000, v47
    v_mul_f32 v34, v34, v10
    v_mul_f32 v35, v35, v11
.p2align 6
L_kloop:
    s_nop 1
    s_waitcnt vmcnt(0)
    buffer_load_dwordx4 v[88:91], v48, s[8:11], 0 offen offset:1536 nt
    buffer_load_dwordx4 v[92:95], v48, s[8:11], 0 offen offset:1792 nt
    buffer_load_dwordx4 v[96:99], v48, s[8:11], 0 offen offset:2048 nt
    buffer_load_dwordx4 v[100:103], v48, s[8:11], 0 offen offset:2304 nt
    buffer_load_dwordx4 v[104:107], v48, s[8:11], 0 offen offset:2560 nt
    buffer_load_dwordx4 v[108:111], v48, s[8:11], 0 offen offset:2816 nt
    v_cvt_f32_i32 v64, v64
    v_cvt_f32_i32 v65, v65
    v_cvt_f32_i32 v66, v66
    v_cvt_f32_i32 v67, v67
    v_mul_f32 v54, v64, v24
    v_fmac_f32 v54, v65, v25
    v_fmac_f32 v54, v66, v26
    v_fmac_f32 v54, v67, v27
    v_cvt_f32_i32 v68, v68
    v_cvt_f32_i32 v69, v69
    v_cvt_f32_i32 v70, v70
    v_cvt_f32_i32 v71, v71
    v_fmac_f32 v54, v68, v28
    v_fmac_f32 v54, v69, v29
    v_fmac_f32 v54, v70, v30
    v_fmac_f32 v54, v71, v31
    v_cvt_f32_i32 v72, v72
    v_cvt_f32_i32 v73, v73
    v_cvt_f32_i32 v74, v74
    v_cvt_f32_i32 v75, v75
    v_fmac_f32 v54, v72, v32
    v_fmac_f32 v54, v73, v33
    v_fmac_f32 v54, v74, v34
    v_fmac_f32 v54, v75, v35
    v_cvt_f32_i32 v76, v76
    v_cvt_f32_i32 v77, v77
    v_add_f32_dpp v54, v54, v54 row_ror:8 row_mask:0xf bank_mask:0xf
    v_cvt_f32_i32 v78, v78
    v_cvt_f32_i32 v79, v79
    v_add_f32_dpp v54, v54, v54 row_ror:4 row_mask:0xf bank_mask:0xf
    v_mul_f32 v55, v76, v24
    v_fmac_f32 v55, v77, v25
    v_add_f32_dpp v54, v54, v54 row_ror:2 row_mask:0xf bank_mask:0xf
    v_fmac_f32 v55, v78, v26
    v_fmac_f32 v55, v79, v27
    v_add_f32_dpp v60, v54, v54 row_ror:1 row_mask:0xf bank_mask:0x1
    v_cvt_f32_i32 v80, v80
    v_cvt_f32_i32 v81, v81
    v_cvt_f32_i32 v82, v82
    v_cvt_f32_i32 v83, v83
    v_fmac_f32 v55, v80, v28
    v_fmac_f32 v55, v81, v29
    v_fmac_f32 v55, v82, v30
    v_fmac_f32 v55, v83, v31
    v_cvt_f32_i32 v84, v84
    v_cvt_f32_i32 v85, v85
    v_cvt_f32_i32 v86, v86
    v_cvt_f32_i32 v87, v87
    v_fmac_f32 v55, v84, v32
    v_fmac_f32 v55, v85, v33
    v_fmac_f32 v55, v86, v34
    v_fmac_f32 v55, v87, v35
    s_nop 1
    v_add_f32_dpp v55, v55, v55 row_ror:8 row_mask:0xf bank_mask:0xf
    s_nop 1
    v_add_f32_dpp v55, v55, v55 row_ror:4 row_mask:0xf bank_mask:0xf
    s_nop 1
    v_add_f32_dpp v55, v55, v55 row_ror:2 row_mask:0xf bank_mask:0xf
    s_nop 1
    v_add_f32_dpp v61, v55, v55 row_ror:1 row_mask:0xf bank_mask:0x1
    s_waitcnt vmcnt(0)
    buffer_load_dwordx4 v[112:115], v48, s[8:11], 0 offen offset:3072 nt
    buffer_load_dwordx4 v[116:119], v48, s[8:11], 0 offen offset:3328 nt
    buffer_load_dwordx4 v[120:123], v48, s[8:11], 0 offen offset:3584 nt
    buffer_load_dwordx4 v[124:127], v49, s[8:11], 0 offen offset:0 nt
    buffer_load_dwordx4 v[128:131], v49, s[8:11], 0 offen offset:256 nt
    buffer_load_dwordx4 v[132:135], v49, s[8:11], 0 offen offset:512 nt
    s_add_u32 s29, s29, 4
    s_add_u32 s30, s30, 1
    s_bitcmp1_b64 s[40:41], s30
    s_cbranch_scc1 L_evK
L_evretK:
    s_nop 1
    s_lshr_b32 s33, s29, 6
    s_lshl_b32 s33, s33, 11
    s_and_b32 s32, s29, 63
    s_add_u32 s32, s32, s33
    s_add_u32 s32, s32, s44
    s_bfe_u32 s33, s32, 0x20003
    s_and_b32 s34, s32, 4
    s_or_b32 s33, s33, s34
    s_xor_b32 s33, s33, s5
    s_lshl_b32 s50, s32, 5
    s_or_b32 s50, s50, s33
    s_lshl_b32 s50, s50, 4
    s_or_b32 s50, s50, 1
    v_xor_b32 v10, s50, v50
    v_mul_hi_u32 v10, v10, s47
    v_lshrrev_b32 v10, 1, v10
    v_and_b32 v11, 15, v10
    v_cmp_eq_u32 vcc, 5, v11
    v_mad_u32_u24 v48, v10, s45, v2
    v_add_u32 v11, 3840, v48
    v_cndmask_b32 v49, v51, v11, vcc
    v_lshrrev_b32 v10, 6, v10
    v_mad_u32_u24 v9, v10, s46, v3
    buffer_load_dwordx2 v[42:43], v9, s[16:19], 0 offen offset:0
    buffer_load_dwordx2 v[44:45], v9, s[16:19], 0 offen offset:128
    buffer_load_dwordx2 v[46:47], v9, s[16:19], 0 offen offset:256
    v_cvt_f32_i32 v88, v88
    v_cvt_f32_i32 v89, v89
    v_cvt_f32_i32 v90, v90
    v_cvt_f32_i32 v91, v91
    v_mul_f32 v56, v88, v24
    v_fmac_f32 v56, v89, v25
    v_fmac_f32 v56, v90, v26
    v_fmac_f32 v56, v91, v27
    v_cvt_f32_i32 v92, v92
    v_cvt_f32_i32 v93, v93
    v_cvt_f32_i32 v94, v94
    v_cvt_f32_i32 v95, v95
    v_fmac_f32 v56, v92, v28
    v_fmac_f32 v56, v93, v29
    v_fmac_f32 v56, v94, v30
    v_fmac_f32 v56, v95, v31
    v_cvt_f32_i32 v96, v96
    v_cvt_f32_i32 v97, v97
    v_cvt_f32_i32 v98, v98
    v_cvt_f32_i32 v99, v99
    v_fmac_f32 v56, v96, v32
    v_fmac_f32 v56, v97, v33
    v_fmac_f32 v56, v98, v34
    v_fmac_f32 v56, v99, v35
    v_cvt_f32_i32 v100, v100
    v_cvt_f32_i32 v101, v101
    v_add_f32_dpp v56, v56, v56 row_ror:8 row_mask:0xf bank_mask:0xf
    v_cvt_f32_i32 v102, v102
    v_cvt_f32_i32 v103, v103
    v_add_f32_dpp v56, v56, v56 row_ror:4 row_mask:0xf bank_mask:0xf
    v_mul_f32 v57, v100, v24
    v_fmac_f32 v57, v101, v25
    v_add_f32_dpp v56, v56, v56 row_ror:2 row_mask:0xf bank_mask:0xf
    v_fmac_f32 v57, v102, v26
    v_fmac_f32 v57, v103, v27
    v_add_f32_dpp v60, v56, v56 row_ror:1 row_mask:0xf bank_mask:0x2
    v_cvt_f32_i32 v104, v104
    v_cvt_f32_i32 v105, v105
    v_cvt_f32_i32 v106, v106
    v_cvt_f32_i32 v107, v107
    v_fmac_f32 v57, v104, v28
    v_fmac_f32 v57, v105, v29
    v_fmac_f32 v57, v106, v30
    v_fmac_f32 v57, v107, v31
    v_cvt_f32_i32 v108, v108
    v_cvt_f32_i32 v109, v109
    v_cvt_f32_i32 v110, v110
    v_cvt_f32_i32 v111, v111
    v_fmac_f32 v57, v108, v32
    v_fmac_f32 v57, v109, v33
    v_fmac_f32 v57, v110, v34
    v_fmac_f32 v57, v111, v35
    s_nop 1
    v_add_f32_dpp v57, v57, v57 row_ror:8 row_mask:0xf bank_mask:0xf
    s_nop 1
    v_add_f32_dpp v57, v57, v57 row_ror:4 row_mask:0xf bank_mask:0xf
    s_nop 1
    v_add_f32_dpp v57, v57, v57 row_ror:2 row_mask:0xf bank_mask:0xf
    s_nop 1
    v_add_f32_dpp v61, v57, v57 row_ror:1 row_mask:0xf bank_mask:0x2
    s_waitcnt vmcnt(3)
    buffer_load_dwordx4 v[64:67], v48, s[8:11], 0 offen offset:0 nt
    buffer_load_dwordx4 v[68:71], v48, s[8:11], 0 offen offset:256 nt
    buffer_load_dwordx4 v[72:75], v48, s[8:11], 0 offen offset:512 nt
    buffer_load_dwordx4 v[76:79], v48, s[8:11], 0 offen offset:768 nt
    buffer_load_dwordx4 v[80:83], v48, s[8:11], 0 offen offset:1024 nt
    buffer_load_dwordx4 v[84:87], v48, s[8:11], 0 offen offset:1280 nt
    v_cvt_f32_i32 v112, v112
    v_cvt_f32_i32 v113, v113
    v_cvt_f32_i32 v114, v114
    v_cvt_f32_i32 v115, v115
    v_mul_f32 v58, v112, v24
    v_fmac_f32 v58, v113, v25
    v_fmac_f32 v58, v114, v26
    v_fmac_f32 v58, v115, v27
    v_cvt_f32_i32 v116, v116
    v_cvt_f32_i32 v117, v117
    v_cvt_f32_i32 v118, v118
    v_cvt_f32_i32 v119, v119
    v_fmac_f32 v58, v116, v28
    v_fmac_f32 v58, v117, v29
    v_fmac_f32 v58, v118, v30
    v_fmac_f32 v58, v119, v31
    v_cvt_f32_i32 v120, v120
    v_cvt_f32_i32 v121, v121
    v_cvt_f32_i32 v122, v122
    v_cvt_f32_i32 v123, v123
    v_fmac_f32 v58, v120, v32
    v_fmac_f32 v58, v121, v33
    v_fmac_f32 v58, v122, v34
    v_fmac_f32 v58, v123, v35
    v_cvt_f32_i32 v124, v124
    v_cvt_f32_i32 v125, v125
    v_add_f32_dpp v58, v58, v58 row_ror:8 row_mask:0xf bank_mask:0xf
    v_cvt_f32_i32 v126, v126
    v_cvt_f32_i32 v127, v127
    v_add_f32_dpp v58, v58, v58 row_ror:4 row_mask:0xf bank_mask:0xf
    v_mul_f32 v59, v124, v24
    v_fmac_f32 v59, v125, v25
    v_add_f32_dpp v58, v58, v58 row_ror:2 row_mask:0xf bank_mask:0xf
    v_fmac_f32 v59, v126, v26
    v_fmac_f32 v59, v127, v27
    v_add_f32_dpp v60, v58, v58 row_ror:1 row_mask:0xf bank_mask:0x4
    v_cvt_f32_i32 v128, v128
    v_cvt_f32_i32 v129, v129
    v_cvt_f32_i32 v130, v130
    v_cvt_f32_i32 v131, v131
    v_fmac_f32 v59, v128, v28
    v_fmac_f32 v59, v129, v29
    v_fmac_f32 v59, v130, v30
    v_fmac_f32 v59, v131, v31
    v_cvt_f32_i32 v132, v132
    v_cvt_f32_i32 v133, v133
    v_cvt_f32_i32 v134, v134
    v_cvt_f32_i32 v135, v135
    v_fmac_f32 v59, v132, v32
    v_fmac_f32 v59, v133, v33
    v_fmac_f32 v59, v134, v34
    v_fmac_f32 v59, v135, v35
    s_nop 1
    v_add_f32_dpp v59, v59, v59 row_ror:8 row_mask:0xf bank_mask:0xf
    s_nop 1
    v_add_f32_dpp v59, v59, v59 row_ror:4 row_mask:0xf bank_mask:0xf
    s_nop 1
    v_add_f32_dpp v59, v59, v59 row_ror:2 row_mask:0xf bank_mask:0xf
    s_nop 1
    v_add_f32_dpp v61, v59, v59 row_ror:1 row_mask:0xf bank_mask:0x4
    s_mov_b64 exec, s[42:43]
    ds_write_b64 v4, v[60:61]
    s_mov_b64 exec, -1
    v_add_u32 v4, 48, v4
    s_waitcnt vmcnt(6)
    v_lshlrev_b32 v10, 16, v36
    v_lshlrev_b32 v24, 16, v42
    v_and_b32 v11, 0xffff0000, v36
    v_and_b32 v25, 0xffff0000, v42
    v_mul_f32 v24, v24, v10
    v_mul_f32 v25, v25, v11
    v_lshlrev_b32 v10, 16, v37
    v_lshlrev_b32 v26, 16, v43
    v_and_b32 v11, 0xffff0000, v37
    v_and_b32 v27, 0xffff0000, v43
    v_mul_f32 v26, v26, v10
    v_mul_f32 v27, v27, v11
    v_lshlrev_b32 v10, 16, v38
    v_lshlrev_b32 v28, 16, v44
    v_and_b32 v11, 0xffff0000, v38
    v_and_b32 v29, 0xffff0000, v44
    v_mul_f32 v28, v28, v10
    v_mul_f32 v29, v29, v11
    v_lshlrev_b32 v10, 16, v39
    v_lshlrev_b32 v30, 16, v45
    v_and_b32 v11, 0xffff0000, v39
    v_and_b32 v31, 0xffff0000, v45
    v_mul_f32 v30, v30, v10
    v_mul_f32 v31, v31, v11
    v_lshlrev_b32 v10, 16, v40
    v_lshlrev_b32 v32, 16, v46
    v_and_b32 v11, 0xffff0000, v40
    v_and_b32 v33, 0xffff0000, v46
    v_mul_f32 v32, v32, v10
    v_mul_f32 v33, v33, v11
    v_lshlrev_b32 v10, 16, v41
    v_lshlrev_b32 v34, 16, v47
    v_and_b32 v11, 0xffff0000, v41
    v_and_b32 v35, 0xffff0000, v47
    v_mul_f32 v34, v34, v10
    v_mul_f32 v35, v35, v11
L_kchk:
    s_nop 1
    s_cmp_lg_u32 s59, 0
    s_cbranch_scc1 L_kboost
L_kchk2:
    s_nop 1
    s_cmp_lg_u32 s30, 47
    s_cbranch_scc1 L_kloop
    s_waitcnt vmcnt(0)
    buffer_load_dwordx4 v[88:91], v48, s[8:11], 0 offen offset:1536 nt
    buffer_load_dwordx4 v[92:95], v48, s[8:11], 0 offen offset:1792 nt
    buffer_load_dwordx4 v[96:99], v48, s[8:11], 0 offen offset:2048 nt
    buffer_load_dwordx4 v[100:103], v48, s[8:11], 0 offen offset:2304 nt
    buffer_load_dwordx4 v[104:107], v48, s[8:11], 0 offen offset:2560 nt
    buffer_load_dwordx4 v[108:111], v48, s[8:11], 0 offen offset:2816 nt
    v_cvt_f32_i32 v64, v64
    v_cvt_f32_i32 v65, v65
    v_cvt_f32_i32 v66, v66
    v_cvt_f32_i32 v67, v67
    v_mul_f32 v54, v64, v24
    v_fmac_f32 v54, v65, v25
    v_fmac_f32 v54, v66, v26
    v_fmac_f32 v54, v67, v27
    v_cvt_f32_i32 v68, v68
    v_cvt_f32_i32 v69, v69
    v_cvt_f32_i32 v70, v70
    v_cvt_f32_i32 v71, v71
    v_fmac_f32 v54, v68, v28
    v_fmac_f32 v54, v69, v29
    v_fmac_f32 v54, v70, v30
    v_fmac_f32 v54, v71, v31
    v_cvt_f32_i32 v72, v72
    v_cvt_f32_i32 v73, v73
    v_cvt_f32_i32 v74, v74
    v_cvt_f32_i32 v75, v75
    v_fmac_f32 v54, v72, v32
    v_fmac_f32 v54, v73, v33
    v_fmac_f32 v54, v74, v34
    v_fmac_f32 v54, v75, v35
    v_cvt_f32_i32 v76, v76
    v_cvt_f32_i32 v77, v77
    v_add_f32_dpp v54, v54, v54 row_ror:8 row_mask:0xf bank_mask:0xf
    v_cvt_f32_i32 v78, v78
    v_cvt_f32_i32 v79, v79
    v_add_f32_dpp v54, v54, v54 row_ror:4 row_mask:0xf bank_mask:0xf
    v_mul_f32 v55, v76, v24
    v_fmac_f32 v55, v77, v25
    v_add_f32_dpp v54, v54, v54 row_ror:2 row_mask:0xf bank_mask:0xf
    v_fmac_f32 v55, v78, v26
    v_fmac_f32 v55, v79, v27
    v_add_f32_dpp v60, v54, v54 row_ror:1 row_mask:0xf bank_mask:0x1
    v_cvt_f32_i32 v80, v80
    v_cvt_f32_i32 v81, v81
    v_cvt_f32_i32 v82, v82
    v_cvt_f32_i32 v83, v83
    v_fmac_f32 v55, v80, v28
    v_fmac_f32 v55, v81, v29
    v_fmac_f32 v55, v82, v30
    v_fmac_f32 v55, v83, v31
    v_cvt_f32_i32 v84, v84
    v_cvt_f32_i32 v85, v85
    v_cvt_f32_i32 v86, v86
    v_cvt_f32_i32 v87, v87
    v_fmac_f32 v55, v84, v32
    v_fmac_f32 v55, v85, v33
    v_fmac_f32 v55, v86, v34
    v_fmac_f32 v55, v87, v35
    s_nop 1
    v_add_f32_dpp v55, v55, v55 row_ror:8 row_mask:0xf bank_mask:0xf
    s_nop 1
    v_add_f32_dpp v55, v55, v55 row_ror:4 row_mask:0xf bank_mask:0xf
    s_nop 1
    v_add_f32_dpp v55, v55, v55 row_ror:2 row_mask:0xf bank_mask:0xf
    s_nop 1
    v_add_f32_dpp v61, v55, v55 row_ror:1 row_mask:0xf bank_mask:0x1
    s_waitcnt vmcnt(0)
    buffer_load_dwordx4 v[112:115], v48, s[8:11], 0 offen offset:3072 nt
    buffer_load_dwordx4 v[116:119], v48, s[8:11], 0 offen offset:3328 nt
    buffer_load_dwordx4 v[120:123], v48, s[8:11], 0 offen offset:3584 nt
    buffer_load_dwordx4 v[124:127], v49, s[8:11], 0 offen offset:0 nt
    buffer_load_dwordx4 v[128:131], v49, s[8:11], 0 offen offset:256 nt
    buffer_load_dwordx4 v[132:135], v49, s[8:11], 0 offen offset:512 nt
    s_mov_b32 s29, s28
    s_mov_b32 s30, 0
    s_memrealtime s[36:37]
    s_mov_b32 s6, 0x100000
L_wgtv:
    s_nop 1
    ds_read_b32 v10, v53 offset:216
    s_sub_u32 s6, s6, 1
    s_cbranch_scc1 L_exit1
    s_waitcnt lgkmcnt(0)
    v_readfirstlane_b32 s32, v10
    s_cmp_eq_u32 s32, 0
    s_cbranch_scc1 L_wgtv
    s_and_b32 s32, s32, 0xffff
    s_cbranch_scc0 L_gxtv
    s_add_u32 s32, s32, s36
L_gltv:
    s_nop 1
    s_memrealtime s[36:37]
    s_waitcnt lgkmcnt(0)
    s_sub_u32 s36, s36, s32
    s_cmp_lt_i32 s36, 0
    s_cbranch_scc1 L_gltv
L_gxtv:
    s_nop 1
    s_lshr_b32 s33, s30, 4
    s_lshl_b32 s34, s33, 2
    v_mov_b32 v11, s34
    s_mov_b32 s6, 0x100000
L_wtv:
    s_nop 1
    ds_read_b32 v10, v11 offset:24
    s_sub_u32 s6, s6, 1
    s_cbranch_scc1 L_exit1
    s_waitcnt lgkmcnt(0)
    v_readfirstlane_b32 s32, v10
    s_cmp_eq_u32 s32, 0
    s_cbranch_scc1 L_wtv
    s_and_b32 s5, s32, 7
    s_xor_b32 s5, s5, s48
    s_bitcmp1_b32 s32, 3
    s_cselect_b64 vcc, -1, 0
    v_cndmask_b32 v50, v62, v63, vcc
    s_mov_b32 s49, 45
    s_mov_b32 s40, 0x2a2b2a2a
    s_mov_b32 s41, 0x152b
    s_mov_b32 s64, 0x2020202
    s_mov_b32 s65, 0x102
    s_mov_b32 s66, 0x8080808
    s_mov_b32 s67, 0x408
    s_mov_b32 s68, 0x20202020
    s_mov_b32 s69, 0x1020
    s_mov_b32 s70, 0x10000
    s_mov_b32 s71, 0x1
    s_lshr_b32 s33, s29, 6
    s_lshl_b32 s33, s33, 11
    s_and_b32 s32, s29, 63
    s_add_u32 s32, s32, s33
    s_add_u32 s32, s32, s44
    s_bfe_u32 s33, s32, 0x20003
    s_and_b32 s34, s32, 4
    s_or_b32 s33, s33, s34
    s_xor_b32 s33, s33, s5
    s_lshl_b32 s50, s32, 5
    s_or_b32 s50, s50, s33
    s_lshl_b32 s50, s50, 4
    s_or_b32 s50, s50, 1
    s_lshl_b32 s53, s29, 7
    v_xor_b32 v10, s50, v50
    v_mul_hi_u32 v10, v10, s47
    v_lshrrev_b32 v10, 1, v10
    v_and_b32 v11, 15, v10
    v_cmp_eq_u32 vcc, 5, v11
    v_mad_u32_u24 v48, v10, s45, v2
    v_add_u32 v11, 3840, v48
    v_cndmask_b32 v49, v51, v11, vcc
    v_add_u32 v10, s53, v5
    ds_read_b32 v7, v10
    v_cvt_f32_i32 v88, v88
    v_cvt_f32_i32 v89, v89
    v_cvt_f32_i32 v90, v90
    v_cvt_f32_i32 v91, v91
    v_mul_f32 v56, v88, v24
    v_fmac_f32 v56, v89, v25
    v_fmac_f32 v56, v90, v26
    v_fmac_f32 v56, v91, v27
    v_cvt_f32_i32 v92, v92
    v_cvt_f32_i32 v93, v93
    v_cvt_f32_i32 v94, v94
    v_cvt_f32_i32 v95, v95
    v_fmac_f32 v56, v92, v28
    v_fmac_f32 v56, v93, v29
    v_fmac_f32 v56, v94, v30
    v_fmac_f32 v56, v95, v31
    v_cvt_f32_i32 v96, v96
    v_cvt_f32_i32 v97, v97
    v_cvt_f32_i32 v98, v98
    v_cvt_f32_i32 v99, v99
    v_fmac_f32 v56, v96, v32
    v_fmac_f32 v56, v97, v33
    v_fmac_f32 v56, v98, v34
    v_fmac_f32 v56, v99, v35
    v_cvt_f32_i32 v100, v100
    v_cvt_f32_i32 v101, v101
    v_add_f32_dpp v56, v56, v56 row_ror:8 row_mask:0xf bank_mask:0xf
    v_cvt_f32_i32 v102, v102
    v_cvt_f32_i32 v103, v103
    v_add_f32_dpp v56, v56, v56 row_ror:4 row_mask:0xf bank_mask:0xf
    v_mul_f32 v57, v100, v24
    v_fmac_f32 v57, v101, v25
    v_add_f32_dpp v56, v56, v56 row_ror:2 row_mask:0xf bank_mask:0xf
    v_fmac_f32 v57, v102, v26
    v_fmac_f32 v57, v103, v27
    v_add_f32_dpp v60, v56, v56 row_ror:1 row_mask:0xf bank_mask:0x2
    v_cvt_f32_i32 v104, v104
    v_cvt_f32_i32 v105, v105
    v_cvt_f32_i32 v106, v106
    v_cvt_f32_i32 v107, v107
    v_fmac_f32 v57, v104, v28
    v_fmac_f32 v57, v105, v29
    v_fmac_f32 v57, v106, v30
    v_fmac_f32 v57, v107, v31
    v_cvt_f32_i32 v108, v108
    v_cvt_f32_i32 v109, v109
    v_cvt_f32_i32 v110, v110
    v_cvt_f32_i32 v111, v111
    v_fmac_f32 v57, v108, v32
    v_fmac_f32 v57, v109, v33
    v_fmac_f32 v57, v110, v34
    v_fmac_f32 v57, v111, v35
    s_nop 1
    v_add_f32_dpp v57, v57, v57 row_ror:8 row_mask:0xf bank_mask:0xf
    s_nop 1
    v_add_f32_dpp v57, v57, v57 row_ror:4 row_mask:0xf bank_mask:0xf
    s_nop 1
    v_add_f32_dpp v57, v57, v57 row_ror:2 row_mask:0xf bank_mask:0xf
    s_nop 1
    v_add_f32_dpp v61, v57, v57 row_ror:1 row_mask:0xf bank_mask:0x2
    s_waitcnt vmcnt(0)
    buffer_load_dwordx4 v[64:67], v48, s[12:15], 0 offen offset:0 nt
    buffer_load_dwordx4 v[68:71], v48, s[12:15], 0 offen offset:256 nt
    buffer_load_dwordx4 v[72:75], v48, s[12:15], 0 offen offset:512 nt
    buffer_load_dwordx4 v[76:79], v48, s[12:15], 0 offen offset:768 nt
    buffer_load_dwordx4 v[80:83], v48, s[12:15], 0 offen offset:1024 nt
    buffer_load_dwordx4 v[84:87], v48, s[12:15], 0 offen offset:1280 nt
    v_cvt_f32_i32 v112, v112
    v_cvt_f32_i32 v113, v113
    v_cvt_f32_i32 v114, v114
    v_cvt_f32_i32 v115, v115
    v_mul_f32 v58, v112, v24
    v_fmac_f32 v58, v113, v25
    v_fmac_f32 v58, v114, v26
    v_fmac_f32 v58, v115, v27
    v_cvt_f32_i32 v116, v116
    v_cvt_f32_i32 v117, v117
    v_cvt_f32_i32 v118, v118
    v_cvt_f32_i32 v119, v119
    v_fmac_f32 v58, v116, v28
    v_fmac_f32 v58, v117, v29
    v_fmac_f32 v58, v118, v30
    v_fmac_f32 v58, v119, v31
    v_cvt_f32_i32 v120, v120
    v_cvt_f32_i32 v121, v121
    v_cvt_f32_i32 v122, v122
    v_cvt_f32_i32 v123, v123
    v_fmac_f32 v58, v120, v32
    v_fmac_f32 v58, v121, v33
    v_fmac_f32 v58, v122, v34
    v_fmac_f32 v58, v123, v35
    v_cvt_f32_i32 v124, v124
    v_cvt_f32_i32 v125, v125
    v_add_f32_dpp v58, v58, v58 row_ror:8 row_mask:0xf bank_mask:0xf
    v_cvt_f32_i32 v126, v126
    v_cvt_f32_i32 v127, v127
    v_add_f32_dpp v58, v58, v58 row_ror:4 row_mask:0xf bank_mask:0xf
    v_mul_f32 v59, v124, v24
    v_fmac_f32 v59, v125, v25
    v_add_f32_dpp v58, v58, v58 row_ror:2 row_mask:0xf bank_mask:0xf
    v_fmac_f32 v59, v126, v26
    v_fmac_f32 v59, v127, v27
    v_add_f32_dpp v60, v58, v58 row_ror:1 row_mask:0xf bank_mask:0x4
    v_cvt_f32_i32 v128, v128
    v_cvt_f32_i32 v129, v129
    v_cvt_f32_i32 v130, v130
    v_cvt_f32_i32 v131, v131
    v_fmac_f32 v59, v128, v28
    v_fmac_f32 v59, v129, v29
    v_fmac_f32 v59, v130, v30
    v_fmac_f32 v59, v131, v31
    v_cvt_f32_i32 v132, v132
    v_cvt_f32_i32 v133, v133
    v_cvt_f32_i32 v134, v134
    v_cvt_f32_i32 v135, v135
    v_fmac_f32 v59, v132, v32
    v_fmac_f32 v59, v133, v33
    v_fmac_f32 v59, v134, v34
    v_fmac_f32 v59, v135, v35
    s_nop 1
    v_add_f32_dpp v59, v59, v59 row_ror:8 row_mask:0xf bank_mask:0xf
    s_nop 1
    v_add_f32_dpp v59, v59, v59 row_ror:4 row_mask:0xf bank_mask:0xf
    s_nop 1
    v_add_f32_dpp v59, v59, v59 row_ror:2 row_mask:0xf bank_mask:0xf
    s_nop 1
    v_add_f32_dpp v61, v59, v59 row_ror:1 row_mask:0xf bank_mask:0x4
    s_mov_b64 exec, s[42:43]
    ds_write_b64 v4, v[60:61]
    s_mov_b64 exec, -1
    s_waitcnt lgkmcnt(0)
    v_mov_b32 v6, v7
    v_mov_b32 v11, 1
    s_mov_b64 exec, 1
    ds_add_u32 v53, v11 offset:48
    s_mov_b64 exec, -1
.p2align 6
L_vloop:
    s_nop 1
    s_waitcnt vmcnt(0)
    buffer_load_dwordx4 v[88:91], v48, s[12:15], 0 offen offset:1536 nt
    buffer_load_dwordx4 v[92:95], v48, s[12:15], 0 offen offset:1792 nt
    buffer_load_dwordx4 v[96:99], v48, s[12:15], 0 offen offset:2048 nt
    buffer_load_dwordx4 v[100:103], v48, s[12:15], 0 offen offset:2304 nt
    buffer_load_dwordx4 v[104:107], v48, s[12:15], 0 offen offset:2560 nt
    buffer_load_dwordx4 v[108:111], v48, s[12:15], 0 offen offset:2816 nt
    v_cvt_f32_i32 v64, v64
    v_cvt_f32_i32 v65, v65
    v_cvt_f32_i32 v66, v66
    v_cvt_f32_i32 v67, v67
    v_fmac_f32_dpp v12, v6, v64 row_newbcast:0 row_mask:0xf bank_mask:0xf
    v_fmac_f32_dpp v13, v6, v65 row_newbcast:0 row_mask:0xf bank_mask:0xf
    v_fmac_f32_dpp v14, v6, v66 row_newbcast:0 row_mask:0xf bank_mask:0xf
    v_fmac_f32_dpp v15, v6, v67 row_newbcast:0 row_mask:0xf bank_mask:0xf
    v_cvt_f32_i32 v68, v68
    v_cvt_f32_i32 v69, v69
    v_cvt_f32_i32 v70, v70
    v_cvt_f32_i32 v71, v71
    v_fmac_f32_dpp v16, v6, v68 row_newbcast:0 row_mask:0xf bank_mask:0xf
    v_fmac_f32_dpp v17, v6, v69 row_newbcast:0 row_mask:0xf bank_mask:0xf
    v_fmac_f32_dpp v18, v6, v70 row_newbcast:0 row_mask:0xf bank_mask:0xf
    v_fmac_f32_dpp v19, v6, v71 row_newbcast:0 row_mask:0xf bank_mask:0xf
    v_cvt_f32_i32 v72, v72
    v_cvt_f32_i32 v73, v73
    v_cvt_f32_i32 v74, v74
    v_cvt_f32_i32 v75, v75
    v_fmac_f32_dpp v20, v6, v72 row_newbcast:0 row_mask:0xf bank_mask:0xf
    v_fmac_f32_dpp v21, v6, v73 row_newbcast:0 row_mask:0xf bank_mask:0xf
    v_fmac_f32_dpp v22, v6, v74 row_newbcast:0 row_mask:0xf bank_mask:0xf
    v_fmac_f32_dpp v23, v6, v75 row_newbcast:0 row_mask:0xf bank_mask:0xf
    v_cvt_f32_i32 v76, v76
    v_cvt_f32_i32 v77, v77
    v_cvt_f32_i32 v78, v78
    v_cvt_f32_i32 v79, v79
    v_fmac_f32_dpp v12, v6, v76 row_newbcast:1 row_mask:0xf bank_mask:0xf
    v_fmac_f32_dpp v13, v6, v77 row_newbcast:1 row_mask:0xf bank_mask:0xf
    v_fmac_f32_dpp v14, v6, v78 row_newbcast:1 row_mask:0xf bank_mask:0xf
    v_fmac_f32_dpp v15, v6, v79 row_newbcast:1 row_mask:0xf bank_mask:0xf
    v_cvt_f32_i32 v80, v80
    v_cvt_f32_i32 v81, v81
    v_cvt_f32_i32 v82, v82
    v_cvt_f32_i32 v83, v83
    v_fmac_f32_dpp v16, v6, v80 row_newbcast:1 row_mask:0xf bank_mask:0xf
    v_fmac_f32_dpp v17, v6, v81 row_newbcast:1 row_mask:0xf bank_mask:0xf
    v_fmac_f32_dpp v18, v6, v82 row_newbcast:1 row_mask:0xf bank_mask:0xf
    v_fmac_f32_dpp v19, v6, v83 row_newbcast:1 row_mask:0xf bank_mask:0xf
    v_cvt_f32_i32 v84, v84
    v_cvt_f32_i32 v85, v85
    v_cvt_f32_i32 v86, v86
    v_cvt_f32_i32 v87, v87
    v_fmac_f32_dpp v20, v6, v84 row_newbcast:1 row_mask:0xf bank_mask:0xf
    v_fmac_f32_dpp v21, v6, v85 row_newbcast:1 row_mask:0xf bank_mask:0xf
    v_fmac_f32_dpp v22, v6, v86 row_newbcast:1 row_mask:0xf bank_mask:0xf
    v_fmac_f32_dpp v23, v6, v87 row_newbcast:1 row_mask:0xf bank_mask:0xf
    s_waitcnt vmcnt(0)
    buffer_load_dwordx4 v[112:115], v48, s[12:15], 0 offen offset:3072 nt
    buffer_load_dwordx4 v[116:119], v48, s[12:15], 0 offen offset:3328 nt
    buffer_load_dwordx4 v[120:123], v48, s[12:15], 0 offen offset:3584 nt
    buffer_load_dwordx4 v[124:127], v49, s[12:15], 0 offen offset:0 nt
    buffer_load_dwordx4 v[128:131], v49, s[12:15], 0 offen offset:256 nt
    buffer_load_dwordx4 v[132:135], v49, s[12:15], 0 offen offset:512 nt
    s_add_u32 s29, s29, 4
    s_add_u32 s30, s30, 1
    s_bitcmp1_b64 s[40:41], s30
    s_cbranch_scc1 L_evV
L_evretV:
    s_nop 1
    s_lshr_b32 s33, s29, 6
    s_lshl_b32 s33, s33, 11
    s_and_b32 s32, s29, 63
    s_add_u32 s32, s32, s33
    s_add_u32 s32, s32, s44
    s_bfe_u32 s33, s32, 0x20003
    s_and_b32 s34, s32, 4
    s_or_b32 s33, s33, s34
    s_xor_b32 s33, s33, s5
    s_lshl_b32 s50, s32, 5
    s_or_b32 s50, s50, s33
    s_lshl_b32 s50, s50, 4
    s_or_b32 s50, s50, 1
    s_lshl_b32 s53, s29, 7
    v_xor_b32 v10, s50, v50
    v_mul_hi_u32 v10, v10, s47
    v_lshrrev_b32 v10, 1, v10
    v_and_b32 v11, 15, v10
    v_cmp_eq_u32 vcc, 5, v11
    v_mad_u32_u24 v48, v10, s45, v2
    v_add_u32 v11, 3840, v48
    v_cndmask_b32 v49, v51, v11, vcc
    v_add_u32 v10, s53, v5
    ds_read_b32 v7, v10
    s_cmp_eq_u32 s30, 48
    s_cbranch_scc1 L_el0
L_el0r:
    v_cvt_f32_i32 v88, v88
    v_cvt_f32_i32 v89, v89
    v_cvt_f32_i32 v90, v90
    v_cvt_f32_i32 v91, v91
    v_fmac_f32_dpp v12, v6, v88 row_newbcast:2 row_mask:0xf bank_mask:0xf
    v_fmac_f32_dpp v13, v6, v89 row_newbcast:2 row_mask:0xf bank_mask:0xf
    v_fmac_f32_dpp v14, v6, v90 row_newbcast:2 row_mask:0xf bank_mask:0xf
    v_fmac_f32_dpp v15, v6, v91 row_newbcast:2 row_mask:0xf bank_mask:0xf
    v_cvt_f32_i32 v92, v92
    v_cvt_f32_i32 v93, v93
    v_cvt_f32_i32 v94, v94
    v_cvt_f32_i32 v95, v95
    v_fmac_f32_dpp v16, v6, v92 row_newbcast:2 row_mask:0xf bank_mask:0xf
    v_fmac_f32_dpp v17, v6, v93 row_newbcast:2 row_mask:0xf bank_mask:0xf
    v_fmac_f32_dpp v18, v6, v94 row_newbcast:2 row_mask:0xf bank_mask:0xf
    v_fmac_f32_dpp v19, v6, v95 row_newbcast:2 row_mask:0xf bank_mask:0xf
    v_cvt_f32_i32 v96, v96
    v_cvt_f32_i32 v97, v97
    v_cvt_f32_i32 v98, v98
    v_cvt_f32_i32 v99, v99
    v_fmac_f32_dpp v20, v6, v96 row_newbcast:2 row_mask:0xf bank_mask:0xf
    v_fmac_f32_dpp v21, v6, v97 row_newbcast:2 row_mask:0xf bank_mask:0xf
    v_fmac_f32_dpp v22, v6, v98 row_newbcast:2 row_mask:0xf bank_mask:0xf
    v_fmac_f32_dpp v23, v6, v99 row_newbcast:2 row_mask:0xf bank_mask:0xf
    v_cvt_f32_i32 v100, v100
    v_cvt_f32_i32 v101, v101
    v_cvt_f32_i32 v102, v102
    v_cvt_f32_i32 v103, v103
    v_fmac_f32_dpp v12, v6, v100 row_newbcast:3 row_mask:0xf bank_mask:0xf
    v_fmac_f32_dpp v13, v6, v101 row_newbcast:3 row_mask:0xf bank_mask:0xf
    v_fmac_f32_dpp v14, v6, v102 row_newbcast:3 row_mask:0xf bank_mask:0xf
    v_fmac_f32_dpp v15, v6, v103 row_newbcast:3 row_mask:0xf bank_mask:0xf
    v_cvt_f32_i32 v104, v104
    v_cvt_f32_i32 v105, v105
    v_cvt_f32_i32 v106, v106
    v_cvt_f32_i32 v107, v107
    v_fmac_f32_dpp v16, v6, v104 row_newbcast:3 row_mask:0xf bank_mask:0xf
    v_fmac_f32_dpp v17, v6, v105 row_newbcast:3 row_mask:0xf bank_mask:0xf
    v_fmac_f32_dpp v18, v6, v106 row_newbcast:3 row_mask:0xf bank_mask:0xf
    v_fmac_f32_dpp v19, v6, v107 row_newbcast:3 row_mask:0xf bank_mask:0xf
    v_cvt_f32_i32 v108, v108
    v_cvt_f32_i32 v109, v109
    v_cvt_f32_i32 v110, v110
    v_cvt_f32_i32 v111, v111
    v_fmac_f32_dpp v20, v6, v108 row_newbcast:3 row_mask:0xf bank_mask:0xf
    v_fmac_f32_dpp v21, v6, v109 row_newbcast:3 row_mask:0xf bank_mask:0xf
    v_fmac_f32_dpp v22, v6, v110 row_newbcast:3 row_mask:0xf bank_mask:0xf
    v_fmac_f32_dpp v23, v6, v111 row_newbcast:3 row_mask:0xf bank_mask:0xf
    s_waitcnt vmcnt(0)
    buffer_load_dwordx4 v[64:67], v48, s[12:15], 0 offen offset:0 nt
    buffer_load_dwordx4 v[68:71], v48, s[12:15], 0 offen offset:256 nt
    buffer_load_dwordx4 v[72:75], v48, s[12:15], 0 offen offset:512 nt
    buffer_load_dwordx4 v[76:79], v48, s[12:15], 0 offen offset:768 nt
    buffer_load_dwordx4 v[80:83], v48, s[12:15], 0 offen offset:1024 nt
    buffer_load_dwordx4 v[84:87], v48, s[12:15], 0 offen offset:1280 nt
    v_cvt_f32_i32 v112, v112
    v_cvt_f32_i32 v113, v113
    v_cvt_f32_i32 v114, v114
    v_cvt_f32_i32 v115, v115
    v_fmac_f32_dpp v12, v6, v112 row_newbcast:4 row_mask:0xf bank_mask:0xf
    v_fmac_f32_dpp v13, v6, v113 row_newbcast:4 row_mask:0xf bank_mask:0xf
    v_fmac_f32_dpp v14, v6, v114 row_newbcast:4 row_mask:0xf bank_mask:0xf
    v_fmac_f32_dpp v15, v6, v115 row_newbcast:4 row_mask:0xf bank_mask:0xf
    v_cvt_f32_i32 v116, v116
    v_cvt_f32_i32 v117, v117
    v_cvt_f32_i32 v118, v118
    v_cvt_f32_i32 v119, v119
    v_fmac_f32_dpp v16, v6, v116 row_newbcast:4 row_mask:0xf bank_mask:0xf
    v_fmac_f32_dpp v17, v6, v117 row_newbcast:4 row_mask:0xf bank_mask:0xf
    v_fmac_f32_dpp v18, v6, v118 row_newbcast:4 row_mask:0xf bank_mask:0xf
    v_fmac_f32_dpp v19, v6, v119 row_newbcast:4 row_mask:0xf bank_mask:0xf
    v_cvt_f32_i32 v120, v120
    v_cvt_f32_i32 v121, v121
    v_cvt_f32_i32 v122, v122
    v_cvt_f32_i32 v123, v123
    v_fmac_f32_dpp v20, v6, v120 row_newbcast:4 row_mask:0xf bank_mask:0xf
    v_fmac_f32_dpp v21, v6, v121 row_newbcast:4 row_mask:0xf bank_mask:0xf
    v_fmac_f32_dpp v22, v6, v122 row_newbcast:4 row_mask:0xf bank_mask:0xf
    v_fmac_f32_dpp v23, v6, v123 row_newbcast:4 row_mask:0xf bank_mask:0xf
    v_cvt_f32_i32 v124, v124
    v_cvt_f32_i32 v125, v125
    v_cvt_f32_i32 v126, v126
    v_cvt_f32_i32 v127, v127
    v_fmac_f32_dpp v12, v6, v124 row_newbcast:5 row_mask:0xf bank_mask:0xf
    v_fmac_f32_dpp v13, v6, v125 row_newbcast:5 row_mask:0xf bank_mask:0xf
    v_fmac_f32_dpp v14, v6, v126 row_newbcast:5 row_mask:0xf bank_mask:0xf
    v_fmac_f32_dpp v15, v6, v127 row_newbcast:5 row_mask:0xf bank_mask:0xf
    v_cvt_f32_i32 v128, v128
    v_cvt_f32_i32 v129, v129
    v_cvt_f32_i32 v130, v130
    v_cvt_f32_i32 v131, v131
    v_fmac_f32_dpp v16, v6, v128 row_newbcast:5 row_mask:0xf bank_mask:0xf
    v_fmac_f32_dpp v17, v6, v129 row_newbcast:5 row_mask:0xf bank_mask:0xf
    v_fmac_f32_dpp v18, v6, v130 row_newbcast:5 row_mask:0xf bank_mask:0xf
    v_fmac_f32_dpp v19, v6, v131 row_newbcast:5 row_mask:0xf bank_mask:0xf
    v_cvt_f32_i32 v132, v132
    v_cvt_f32_i32 v133, v133
    v_cvt_f32_i32 v134, v134
    v_cvt_f32_i32 v135, v135
    v_fmac_f32_dpp v20, v6, v132 row_newbcast:5 row_mask:0xf bank_mask:0xf
    v_fmac_f32_dpp v21, v6, v133 row_newbcast:5 row_mask:0xf bank_mask:0xf
    v_fmac_f32_dpp v22, v6, v134 row_newbcast:5 row_mask:0xf bank_mask:0xf
    v_fmac_f32_dpp v23, v6, v135 row_newbcast:5 row_mask:0xf bank_mask:0xf
    s_waitcnt lgkmcnt(0)
    v_mov_b32 v6, v7
L_vchk:
    s_nop 1
    s_cmp_eq_u32 s30, s49
    s_cbranch_scc1 L_deep
    s_cmp_lg_u32 s59, 0
    s_cbranch_scc1 L_vboost
    s_and_b32 s32, s30, 15
    s_cbranch_scc1 L_vloop
L_vend:
    s_nop 1
    v_permlane32_swap_b32 v12, v14
    v_permlane32_swap_b32 v13, v15
    v_permlane32_swap_b32 v16, v18
    v_permlane32_swap_b32 v17, v19
    v_permlane32_swap_b32 v20, v22
    v_permlane32_swap_b32 v21, v23
    v_add_f32 v12, v12, v14
    v_add_f32 v13, v13, v15
    v_add_f32 v16, v16, v18
    v_add_f32 v17, v17, v19
    v_add_f32 v20, v20, v22
    v_add_f32 v21, v21, v23
    v_permlane16_swap_b32 v12, v13
    v_permlane16_swap_b32 v16, v17
    v_permlane16_swap_b32 v20, v21
    s_lshr_b32 s32, s30, 2
    v_mov_b32 v10, s32
    v_add_f32 v12, v12, v13
    ds_write_b32 v8, v12 offset:0
    v_add_f32 v16, v16, v17
    ds_write_b32 v8, v16 offset:256
    v_add_f32 v20, v20, v21
    ds_write_b32 v8, v20 offset:512
    v_mov_b32 v11, 1
    s_mov_b64 exec, 1
    ds_add_u32 v10, v11 offset:60
    s_mov_b64 exec, -1
    v_add_u32 v8, 3072, v8
    v_mov_b32 v12, 0
    v_mov_b32 v13, 0
    v_mov_b32 v14, 0
    v_mov_b32 v15, 0
    v_mov_b32 v16, 0
    v_mov_b32 v17, 0
    v_mov_b32 v18, 0
    v_mov_b32 v19, 0
    v_mov_b32 v20, 0
    v_mov_b32 v21, 0
    v_mov_b32 v22, 0
    v_mov_b32 v23, 0
    s_cmp_lg_u32 s59, 0
    s_cbranch_scc1 L_vboost2
L_vend2:
    s_nop 1
    s_cmp_lg_u32 s30, 48
    s_cbranch_scc1 L_vloop
L_exit1:
    s_endpgm
L_deep:
    s_nop 1
    buffer_load_dwordx4 v[88:91], v48, s[12:15], 0 offen offset:1536 nt
    buffer_load_dwordx4 v[92:95], v48, s[12:15], 0 offen offset:1792 nt
    buffer_load_dwordx4 v[96:99], v48, s[12:15], 0 offen offset:2048 nt
    buffer_load_dwordx4 v[100:103], v48, s[12:15], 0 offen offset:2304 nt
    buffer_load_dwordx4 v[104:107], v48, s[12:15], 0 offen offset:2560 nt
    buffer_load_dwordx4 v[108:111], v48, s[12:15], 0 offen offset:2816 nt
    buffer_load_dwordx4 v[112:115], v48, s[12:15], 0 offen offset:3072 nt
    buffer_load_dwordx4 v[116:119], v48, s[12:15], 0 offen offset:3328 nt
    buffer_load_dwordx4 v[120:123], v48, s[12:15], 0 offen offset:3584 nt
    buffer_load_dwordx4 v[124:127], v49, s[12:15], 0 offen offset:0 nt
    buffer_load_dwordx4 v[128:131], v49, s[12:15], 0 offen offset:256 nt
    buffer_load_dwordx4 v[132:135], v49, s[12:15], 0 offen offset:512 nt
.p2align 6
L_dloop:
    s_nop 1
    s_add_u32 s29, s29, 4
    s_add_u32 s30, s30, 1
    s_lshr_b32 s33, s29, 6
    s_lshl_b32 s33, s33, 11
    s_and_b32 s32, s29, 63
    s_add_u32 s32, s32, s33
    s_add_u32 s32, s32, s44
    s_bfe_u32 s33, s32, 0x20003
    s_and_b32 s34, s32, 4
    s_or_b32 s33, s33, s34
    s_xor_b32 s33, s33, s5
    s_lshl_b32 s50, s32, 5
    s_or_b32 s50, s50, s33
    s_lshl_b32 s50, s50, 4
    s_or_b32 s50, s50, 1
    s_lshl_b32 s53, s29, 7
    v_xor_b32 v10, s50, v50
    v_mul_hi_u32 v10, v10, s47
    v_lshrrev_b32 v10, 1, v10
    v_and_b32 v11, 15, v10
    v_cmp_eq_u32 vcc, 5, v11
    v_mad_u32_u24 v48, v10, s45, v2
    v_add_u32 v11, 3840, v48
    v_cndmask_b32 v49, v51, v11, vcc
    v_add_u32 v10, s53, v5
    ds_read_b32 v7, v10
    s_waitcnt vmcnt(12)
    v_cvt_f32_i32 v64, v64
    v_cvt_f32_i32 v65, v65
    v_cvt_f32_i32 v66, v66
    v_cvt_f32_i32 v67, v67
    v_fmac_f32_dpp v12, v6, v64 row_newbcast:0 row_mask:0xf bank_mask:0xf
    v_fmac_f32_dpp v13, v6, v65 row_newbcast:0 row_mask:0xf bank_mask:0xf
    v_fmac_f32_dpp v14, v6, v66 row_newbcast:0 row_mask:0xf bank_mask:0xf
    v_fmac_f32_dpp v15, v6, v67 row_newbcast:0 row_mask:0xf bank_mask:0xf
    v_cvt_f32_i32 v68, v68
    v_cvt_f32_i32 v69, v69
    v_cvt_f32_i32 v70, v70
    v_cvt_f32_i32 v71, v71
    v_fmac_f32_dpp v16, v6, v68 row_newbcast:0 row_mask:0xf bank_mask:0xf
    v_fmac_f32_dpp v17, v6, v69 row_newbcast:0 row_mask:0xf bank_mask:0xf
    v_fmac_f32_dpp v18, v6, v70 row_newbcast:0 row_mask:0xf bank_mask:0xf
    v_fmac_f32_dpp v19, v6, v71 row_newbcast:0 row_mask:0xf bank_mask:0xf
    v_cvt_f32_i32 v72, v72
    v_cvt_f32_i32 v73, v73
    v_cvt_f32_i32 v74, v74
    v_cvt_f32_i32 v75, v75
    v_fmac_f32_dpp v20, v6, v72 row_newbcast:0 row_mask:0xf bank_mask:0xf
    v_fmac_f32_dpp v21, v6, v73 row_newbcast:0 row_mask:0xf bank_mask:0xf
    v_fmac_f32_dpp v22, v6, v74 row_newbcast:0 row_mask:0xf bank_mask:0xf
    v_fmac_f32_dpp v23, v6, v75 row_newbcast:0 row_mask:0xf bank_mask:0xf
    v_cvt_f32_i32 v76, v76
    v_cvt_f32_i32 v77, v77
    v_cvt_f32_i32 v78, v78
    v_cvt_f32_i32 v79, v79
    v_fmac_f32_dpp v12, v6, v76 row_newbcast:1 row_mask:0xf bank_mask:0xf
    v_fmac_f32_dpp v13, v6, v77 row_newbcast:1 row_mask:0xf bank_mask:0xf
    v_fmac_f32_dpp v14, v6, v78 row_newbcast:1 row_mask:0xf bank_mask:0xf
    v_fmac_f32_dpp v15, v6, v79 row_newbcast:1 row_mask:0xf bank_mask:0xf
    v_cvt_f32_i32 v80, v80
    v_cvt_f32_i32 v81, v81
    v_cvt_f32_i32 v82, v82
    v_cvt_f32_i32 v83, v83
    v_fmac_f32_dpp v16, v6, v80 row_newbcast:1 row_mask:0xf bank_mask:0xf
    v_fmac_f32_dpp v17, v6, v81 row_newbcast:1 row_mask:0xf bank_mask:0xf
    v_fmac_f32_dpp v18, v6, v82 row_newbcast:1 row_mask:0xf bank_mask:0xf
    v_fmac_f32_dpp v19, v6, v83 row_newbcast:1 row_mask:0xf bank_mask:0xf
    v_cvt_f32_i32 v84, v84
    v_cvt_f32_i32 v85, v85
    v_cvt_f32_i32 v86, v86
    v_cvt_f32_i32 v87, v87
    v_fmac_f32_dpp v20, v6, v84 row_newbcast:1 row_mask:0xf bank_mask:0xf
    v_fmac_f32_dpp v21, v6, v85 row_newbcast:1 row_mask:0xf bank_mask:0xf
    v_fmac_f32_dpp v22, v6, v86 row_newbcast:1 row_mask:0xf bank_mask:0xf
    v_fmac_f32_dpp v23, v6, v87 row_newbcast:1 row_mask:0xf bank_mask:0xf
    buffer_load_dwordx4 v[64:67], v48, s[12:15], 0 offen offset:0 nt
    buffer_load_dwordx4 v[68:71], v48, s[12:15], 0 offen offset:256 nt
    buffer_load_dwordx4 v[72:75], v48, s[12:15], 0 offen offset:512 nt
    buffer_load_dwordx4 v[76:79], v48, s[12:15], 0 offen offset:768 nt
    buffer_load_dwordx4 v[80:83], v48, s[12:15], 0 offen offset:1024 nt
    buffer_load_dwordx4 v[84:87], v48, s[12:15], 0 offen offset:1280 nt
    s_waitcnt vmcnt(12)
    s_cmp_eq_u32 s30, 48
    s_cbranch_scc1 L_el1
L_el1r:
    v_cvt_f32_i32 v88, v88
    v_cvt_f32_i32 v89, v89
    v_cvt_f32_i32 v90, v90
    v_cvt_f32_i32 v91, v91
    v_fmac_f32_dpp v12, v6, v88 row_newbcast:2 row_mask:0xf bank_mask:0xf
    v_fmac_f32_dpp v13, v6, v89 row_newbcast:2 row_mask:0xf bank_mask:0xf
    v_fmac_f32_dpp v14, v6, v90 row_newbcast:2 row_mask:0xf bank_mask:0xf
    v_fmac_f32_dpp v15, v6, v91 row_newbcast:2 row_mask:0xf bank_mask:0xf
    v_cvt_f32_i32 v92, v92
    v_cvt_f32_i32 v93, v93
    v_cvt_f32_i32 v94, v94
    v_cvt_f32_i32 v95, v95
    v_fmac_f32_dpp v16, v6, v92 row_newbcast:2 row_mask:0xf bank_mask:0xf
    v_fmac_f32_dpp v17, v6, v93 row_newbcast:2 row_mask:0xf bank_mask:0xf
    v_fmac_f32_dpp v18, v6, v94 row_newbcast:2 row_mask:0xf bank_mask:0xf
    v_fmac_f32_dpp v19, v6, v95 row_newbcast:2 row_mask:0xf bank_mask:0xf
    v_cvt_f32_i32 v96, v96
    v_cvt_f32_i32 v97, v97
    v_cvt_f32_i32 v98, v98
    v_cvt_f32_i32 v99, v99
    v_fmac_f32_dpp v20, v6, v96 row_newbcast:2 row_mask:0xf bank_mask:0xf
    v_fmac_f32_dpp v21, v6, v97 row_newbcast:2 row_mask:0xf bank_mask:0xf
    v_fmac_f32_dpp v22, v6, v98 row_newbcast:2 row_mask:0xf bank_mask:0xf
    v_fmac_f32_dpp v23, v6, v99 row_newbcast:2 row_mask:0xf bank_mask:0xf
    v_cvt_f32_i32 v100, v100
    v_cvt_f32_i32 v101, v101
    v_cvt_f32_i32 v102, v102
    v_cvt_f32_i32 v103, v103
    v_fmac_f32_dpp v12, v6, v100 row_newbcast:3 row_mask:0xf bank_mask:0xf
    v_fmac_f32_dpp v13, v6, v101 row_newbcast:3 row_mask:0xf bank_mask:0xf
    v_fmac_f32_dpp v14, v6, v102 row_newbcast:3 row_mask:0xf bank_mask:0xf
    v_fmac_f32_dpp v15, v6, v103 row_newbcast:3 row_mask:0xf bank_mask:0xf
    v_cvt_f32_i32 v104, v104
    v_cvt_f32_i32 v105, v105
    v_cvt_f32_i32 v106, v106
    v_cvt_f32_i32 v107, v107
    v_fmac_f32_dpp v16, v6, v104 row_newbcast:3 row_mask:0xf bank_mask:0xf
    v_fmac_f32_dpp v17, v6, v105 row_newbcast:3 row_mask:0xf bank_mask:0xf
    v_fmac_f32_dpp v18, v6, v106 row_newbcast:3 row_mask:0xf bank_mask:0xf
    v_fmac_f32_dpp v19, v6, v107 row_newbcast:3 row_mask:0xf bank_mask:0xf
    v_cvt_f32_i32 v108, v108
    v_cvt_f32_i32 v109, v109
    v_cvt_f32_i32 v110, v110
    v_cvt_f32_i32 v111, v111
    v_fmac_f32_dpp v20, v6, v108 row_newbcast:3 row_mask:0xf bank_mask:0xf
    v_fmac_f32_dpp v21, v6, v109 row_newbcast:3 row_mask:0xf bank_mask:0xf
    v_fmac_f32_dpp v22, v6, v110 row_newbcast:3 row_mask:0xf bank_mask:0xf
    v_fmac_f32_dpp v23, v6, v111 row_newbcast:3 row_mask:0xf bank_mask:0xf
    buffer_load_dwordx4 v[88:91], v48, s[12:15], 0 offen offset:1536 nt
    buffer_load_dwordx4 v[92:95], v48, s[12:15], 0 offen offset:1792 nt
    buffer_load_dwordx4 v[96:99], v48, s[12:15], 0 offen offset:2048 nt
    buffer_load_dwordx4 v[100:103], v48, s[12:15], 0 offen offset:2304 nt
    buffer_load_dwordx4 v[104:107], v48, s[12:15], 0 offen offset:2560 nt
    buffer_load_dwordx4 v[108:111], v48, s[12:15], 0 offen offset:2816 nt
    s_waitcnt vmcnt(12)
    v_cvt_f32_i32 v112, v112
    v_cvt_f32_i32 v113, v113
    v_cvt_f32_i32 v114, v114
    v_cvt_f32_i32 v115, v115
    v_fmac_f32_dpp v12, v6, v112 row_newbcast:4 row_mask:0xf bank_mask:0xf
    v_fmac_f32_dpp v13, v6, v113 row_newbcast:4 row_mask:0xf bank_mask:0xf
    v_fmac_f32_dpp v14, v6, v114 row_newbcast:4 row_mask:0xf bank_mask:0xf
    v_fmac_f32_dpp v15, v6, v115 row_newbcast:4 row_mask:0xf bank_mask:0xf
    v_cvt_f32_i32 v116, v116
    v_cvt_f32_i32 v117, v117
    v_cvt_f32_i32 v118, v118
    v_cvt_f32_i32 v119, v119
    v_fmac_f32_dpp v16, v6, v116 row_newbcast:4 row_mask:0xf bank_mask:0xf
    v_fmac_f32_dpp v17, v6, v117 row_newbcast:4 row_mask:0xf bank_mask:0xf
    v_fmac_f32_dpp v18, v6, v118 row_newbcast:4 row_mask:0xf bank_mask:0xf
    v_fmac_f32_dpp v19, v6, v119 row_newbcast:4 row_mask:0xf bank_mask:0xf
    v_cvt_f32_i32 v120, v120
    v_cvt_f32_i32 v121, v121
    v_cvt_f32_i32 v122, v122
    v_cvt_f32_i32 v123, v123
    v_fmac_f32_dpp v20, v6, v120 row_newbcast:4 row_mask:0xf bank_mask:0xf
    v_fmac_f32_dpp v21, v6, v121 row_newbcast:4 row_mask:0xf bank_mask:0xf
    v_fmac_f32_dpp v22, v6, v122 row_newbcast:4 row_mask:0xf bank_mask:0xf
    v_fmac_f32_dpp v23, v6, v123 row_newbcast:4 row_mask:0xf bank_mask:0xf
    v_cvt_f32_i32 v124, v124
    v_cvt_f32_i32 v125, v125
    v_cvt_f32_i32 v126, v126
    v_cvt_f32_i32 v127, v127
    v_fmac_f32_dpp v12, v6, v124 row_newbcast:5 row_mask:0xf bank_mask:0xf
    v_fmac_f32_dpp v13, v6, v125 row_newbcast:5 row_mask:0xf bank_mask:0xf
    v_fmac_f32_dpp v14, v6, v126 row_newbcast:5 row_mask:0xf bank_mask:0xf
    v_fmac_f32_dpp v15, v6, v127 row_newbcast:5 row_mask:0xf bank_mask:0xf
    v_cvt_f32_i32 v128, v128
    v_cvt_f32_i32 v129, v129
    v_cvt_f32_i32 v130, v130
    v_cvt_f32_i32 v131, v131
    v_fmac_f32_dpp v16, v6, v128 row_newbcast:5 row_mask:0xf bank_mask:0xf
    v_fmac_f32_dpp v17, v6, v129 row_newbcast:5 row_mask:0xf bank_mask:0xf
    v_fmac_f32_dpp v18, v6, v130 row_newbcast:5 row_mask:0xf bank_mask:0xf
    v_fmac_f32_dpp v19, v6, v131 row_newbcast:5 row_mask:0xf bank_mask:0xf
    v_cvt_f32_i32 v132, v132
    v_cvt_f32_i32 v133, v133
    v_cvt_f32_i32 v134, v134
    v_cvt_f32_i32 v135, v135
    v_fmac_f32_dpp v20, v6, v132 row_newbcast:5 row_mask:0xf bank_mask:0xf
    v_fmac_f32_dpp v21, v6, v133 row_newbcast:5 row_mask:0xf bank_mask:0xf
    v_fmac_f32_dpp v22, v6, v134 row_newbcast:5 row_mask:0xf bank_mask:0xf
    v_fmac_f32_dpp v23, v6, v135 row_newbcast:5 row_mask:0xf bank_mask:0xf
    buffer_load_dwordx4 v[112:115], v48, s[12:15], 0 offen offset:3072 nt
    buffer_load_dwordx4 v[116:119], v48, s[12:15], 0 offen offset:3328 nt
    buffer_load_dwordx4 v[120:123], v48, s[12:15], 0 offen offset:3584 nt
    buffer_load_dwordx4 v[124:127], v49, s[12:15], 0 offen offset:0 nt
    buffer_load_dwordx4 v[128:131], v49, s[12:15], 0 offen offset:256 nt
    buffer_load_dwordx4 v[132:135], v49, s[12:15], 0 offen offset:512 nt
    s_waitcnt lgkmcnt(0)
    v_mov_b32 v6, v7
    s_cmp_lg_u32 s30, 48
    s_cbranch_scc1 L_dloop
    s_branch L_vend
L_kboost:
    s_nop 1
    s_cmp_eq_u32 s30, 47
    s_cbranch_scc1 L_kchk2
    buffer_load_dwordx4 v[88:91], v48, s[8:11], 0 offen offset:1536 nt
    buffer_load_dwordx4 v[92:95], v48, s[8:11], 0 offen offset:1792 nt
    buffer_load_dwordx4 v[96:99], v48, s[8:11], 0 offen offset:2048 nt
    buffer_load_dwordx4 v[100:103], v48, s[8:11], 0 offen offset:2304 nt
    buffer_load_dwordx4 v[104:107], v48, s[8:11], 0 offen offset:2560 nt
    buffer_load_dwordx4 v[108:111], v48, s[8:11], 0 offen offset:2816 nt
    buffer_load_dwordx4 v[112:115], v48, s[8:11], 0 offen offset:3072 nt
    buffer_load_dwordx4 v[116:119], v48, s[8:11], 0 offen offset:3328 nt
    buffer_load_dwordx4 v[120:123], v48, s[8:11], 0 offen offset:3584 nt
    buffer_load_dwordx4 v[124:127], v49, s[8:11], 0 offen offset:0 nt
    buffer_load_dwordx4 v[128:131], v49, s[8:11], 0 offen offset:256 nt
    buffer_load_dwordx4 v[132:135], v49, s[8:11], 0 offen offset:512 nt
    s_sub_u32 s59, s59, 1
    s_add_u32 s29, s29, 4
    s_add_u32 s30, s30, 1
    s_bitcmp1_b64 s[40:41], s30
    s_cbranch_scc1 L_evKB
L_evretKB:
    s_nop 1
    s_lshr_b32 s33, s29, 6
    s_lshl_b32 s33, s33, 11
    s_and_b32 s32, s29, 63
    s_add_u32 s32, s32, s33
    s_add_u32 s32, s32, s44
    s_bfe_u32 s33, s32, 0x20003
    s_and_b32 s34, s32, 4
    s_or_b32 s33, s33, s34
    s_xor_b32 s33, s33, s5
    s_lshl_b32 s50, s32, 5
    s_or_b32 s50, s50, s33
    s_lshl_b32 s50, s50, 4
    s_or_b32 s50, s50, 1
    v_xor_b32 v10, s50, v50
    v_mul_hi_u32 v10, v10, s47
    v_lshrrev_b32 v10, 1, v10
    v_and_b32 v11, 15, v10
    v_cmp_eq_u32 vcc, 5, v11
    v_mad_u32_u24 v48, v10, s45, v2
    v_add_u32 v11, 3840, v48
    v_cndmask_b32 v49, v51, v11, vcc
    v_lshrrev_b32 v10, 6, v10
    v_mad_u32_u24 v9, v10, s46, v3
    buffer_load_dwordx2 v[42:43], v9, s[16:19], 0 offen offset:0
    buffer_load_dwordx2 v[44:45], v9, s[16:19], 0 offen offset:128
    buffer_load_dwordx2 v[46:47], v9, s[16:19], 0 offen offset:256
    s_waitcnt vmcnt(15)
    v_cvt_f32_i32 v64, v64
    v_cvt_f32_i32 v65, v65
    v_cvt_f32_i32 v66, v66
    v_cvt_f32_i32 v67, v67
    v_mul_f32 v54, v64, v24
    v_fmac_f32 v54, v65, v25
    v_fmac_f32 v54, v66, v26
    v_fmac_f32 v54, v67, v27
    v_cvt_f32_i32 v68, v68
    v_cvt_f32_i32 v69, v69
    v_cvt_f32_i32 v70, v70
    v_cvt_f32_i32 v71, v71
    v_fmac_f32 v54, v68, v28
    v_fmac_f32 v54, v69, v29
    v_fmac_f32 v54, v70, v30
    v_fmac_f32 v54, v71, v31
    v_cvt_f32_i32 v72, v72
    v_cvt_f32_i32 v73, v73
    v_cvt_f32_i32 v74, v74
    v_cvt_f32_i32 v75, v75
    v_fmac_f32 v54, v72, v32
    v_fmac_f32 v54, v73, v33
    v_fmac_f32 v54, v74, v34
    v_fmac_f32 v54, v75, v35
    v_cvt_f32_i32 v76, v76
    v_cvt_f32_i32 v77, v77
    v_add_f32_dpp v54, v54, v54 row_ror:8 row_mask:0xf bank_mask:0xf
    v_cvt_f32_i32 v78, v78
    v_cvt_f32_i32 v79, v79
    v_add_f32_dpp v54, v54, v54 row_ror:4 row_mask:0xf bank_mask:0xf
    v_mul_f32 v55, v76, v24
    v_fmac_f32 v55, v77, v25
    v_add_f32_dpp v54, v54, v54 row_ror:2 row_mask:0xf bank_mask:0xf
    v_fmac_f32 v55, v78, v26
    v_fmac_f32 v55, v79, v27
    v_add_f32_dpp v60, v54, v54 row_ror:1 row_mask:0xf bank_mask:0x1
    v_cvt_f32_i32 v80, v80
    v_cvt_f32_i32 v81, v81
    v_cvt_f32_i32 v82, v82
    v_cvt_f32_i32 v83, v83
    v_fmac_f32 v55, v80, v28
    v_fmac_f32 v55, v81, v29
    v_fmac_f32 v55, v82, v30
    v_fmac_f32 v55, v83, v31
    v_cvt_f32_i32 v84, v84
    v_cvt_f32_i32 v85, v85
    v_cvt_f32_i32 v86, v86
    v_cvt_f32_i32 v87, v87
    v_fmac_f32 v55, v84, v32
    v_fmac_f32 v55, v85, v33
    v_fmac_f32 v55, v86, v34
    v_fmac_f32 v55, v87, v35
    s_nop 1
    v_add_f32_dpp v55, v55, v55 row_ror:8 row_mask:0xf bank_mask:0xf
    s_nop 1
    v_add_f32_dpp v55, v55, v55 row_ror:4 row_mask:0xf bank_mask:0xf
    s_nop 1
    v_add_f32_dpp v55, v55, v55 row_ror:2 row_mask:0xf bank_mask:0xf
    s_nop 1
    v_add_f32_dpp v61, v55, v55 row_ror:1 row_mask:0xf bank_mask:0x1
    buffer_load_dwordx4 v[64:67], v48, s[8:11], 0 offen offset:0 nt
    buffer_load_dwordx4 v[68:71], v48, s[8:11], 0 offen offset:256 nt
    buffer_load_dwordx4 v[72:75], v48, s[8:11], 0 offen offset:512 nt
    buffer_load_dwordx4 v[76:79], v48, s[8:11], 0 offen offset:768 nt
    buffer_load_dwordx4 v[80:83], v48, s[8:11], 0 offen offset:1024 nt
    buffer_load_dwordx4 v[84:87], v48, s[8:11], 0 offen offset:1280 nt
    s_waitcnt vmcnt(15)
    v_cvt_f32_i32 v88, v88
    v_cvt_f32_i32 v89, v89
    v_cvt_f32_i32 v90, v90
    v_cvt_f32_i32 v91, v91
    v_mul_f32 v56, v88, v24
    v_fmac_f32 v56, v89, v25
    v_fmac_f32 v56, v90, v26
    v_fmac_f32 v56, v91, v27
    v_cvt_f32_i32 v92, v92
    v_cvt_f32_i32 v93, v93
    v_cvt_f32_i32 v94, v94
    v_cvt_f32_i32 v95, v95
    v_fmac_f32 v56, v92, v28
    v_fmac_f32 v56, v93, v29
    v_fmac_f32 v56, v94, v30
    v_fmac_f32 v56, v95, v31
    v_cvt_f32_i32 v96, v96
    v_cvt_f32_i32 v97, v97
    v_cvt_f32_i32 v98, v98
    v_cvt_f32_i32 v99, v99
    v_fmac_f32 v56, v96, v32
    v_fmac_f32 v56, v97, v33
    v_fmac_f32 v56, v98, v34
    v_fmac_f32 v56, v99, v35
    v_cvt_f32_i32 v100, v100
    v_cvt_f32_i32 v101, v101
    v_add_f32_dpp v56, v56, v56 row_ror:8 row_mask:0xf bank_mask:0xf
    v_cvt_f32_i32 v102, v102
    v_cvt_f32_i32 v103, v103
    v_add_f32_dpp v56, v56, v56 row_ror:4 row_mask:0xf bank_mask:0xf
    v_mul_f32 v57, v100, v24
    v_fmac_f32 v57, v101, v25
    v_add_f32_dpp v56, v56, v56 row_ror:2 row_mask:0xf bank_mask:0xf
    v_fmac_f32 v57, v102, v26
    v_fmac_f32 v57, v103, v27
    v_add_f32_dpp v60, v56, v56 row_ror:1 row_mask:0xf bank_mask:0x2
    v_cvt_f32_i32 v104, v104
    v_cvt_f32_i32 v105, v105
    v_cvt_f32_i32 v106, v106
    v_cvt_f32_i32 v107, v107
    v_fmac_f32 v57, v104, v28
    v_fmac_f32 v57, v105, v29
    v_fmac_f32 v57, v106, v30
    v_fmac_f32 v57, v107, v31
    v_cvt_f32_i32 v108, v108
    v_cvt_f32_i32 v109, v109
    v_cvt_f32_i32 v110, v110
    v_cvt_f32_i32 v111, v111
    v_fmac_f32 v57, v108, v32
    v_fmac_f32 v57, v109, v33
    v_fmac_f32 v57, v110, v34
    v_fmac_f32 v57, v111, v35
    s_nop 1
    v_add_f32_dpp v57, v57, v57 row_ror:8 row_mask:0xf bank_mask:0xf
    s_nop 1
    v_add_f32_dpp v57, v57, v57 row_ror:4 row_mask:0xf bank_mask:0xf
    s_nop 1
    v_add_f32_dpp v57, v57, v57 row_ror:2 row_mask:0xf bank_mask:0xf
    s_nop 1
    v_add_f32_dpp v61, v57, v57 row_ror:1 row_mask:0xf bank_mask:0x2
    s_waitcnt vmcnt(9)
    v_cvt_f32_i32 v112, v112
    v_cvt_f32_i32 v113, v113
    v_cvt_f32_i32 v114, v114
    v_cvt_f32_i32 v115, v115
    v_mul_f32 v58, v112, v24
    v_fmac_f32 v58, v113, v25
    v_fmac_f32 v58, v114, v26
    v_fmac_f32 v58, v115, v27
    v_cvt_f32_i32 v116, v116
    v_cvt_f32_i32 v117, v117
    v_cvt_f32_i32 v118, v118
    v_cvt_f32_i32 v119, v119
    v_fmac_f32 v58, v116, v28
    v_fmac_f32 v58, v117, v29
    v_fmac_f32 v58, v118, v30
    v_fmac_f32 v58, v119, v31
    v_cvt_f32_i32 v120, v120
    v_cvt_f32_i32 v121, v121
    v_cvt_f32_i32 v122, v122
    v_cvt_f32_i32 v123, v123
    v_fmac_f32 v58, v120, v32
    v_fmac_f32 v58, v121, v33
    v_fmac_f32 v58, v122, v34
    v_fmac_f32 v58, v123, v35
    v_cvt_f32_i32 v124, v124
    v_cvt_f32_i32 v125, v125
    v_add_f32_dpp v58, v58, v58 row_ror:8 row_mask:0xf bank_mask:0xf
    v_cvt_f32_i32 v126, v126
    v_cvt_f32_i32 v127, v127
    v_add_f32_dpp v58, v58, v58 row_ror:4 row_mask:0xf bank_mask:0xf
    v_mul_f32 v59, v124, v24
    v_fmac_f32 v59, v125, v25
    v_add_f32_dpp v58, v58, v58 row_ror:2 row_mask:0xf bank_mask:0xf
    v_fmac_f32 v59, v126, v26
    v_fmac_f32 v59, v127, v27
    v_add_f32_dpp v60, v58, v58 row_ror:1 row_mask:0xf bank_mask:0x4
    v_cvt_f32_i32 v128, v128
    v_cvt_f32_i32 v129, v129
    v_cvt_f32_i32 v130, v130
    v_cvt_f32_i32 v131, v131
    v_fmac_f32 v59, v128, v28
    v_fmac_f32 v59, v129, v29
    v_fmac_f32 v59, v130, v30
    v_fmac_f32 v59, v131, v31
    v_cvt_f32_i32 v132, v132
    v_cvt_f32_i32 v133, v133
    v_cvt_f32_i32 v134, v134
    v_cvt_f32_i32 v135, v135
    v_fmac_f32 v59, v132, v32
    v_fmac_f32 v59, v133, v33
    v_fmac_f32 v59, v134, v34
    v_fmac_f32 v59, v135, v35
    s_nop 1
    v_add_f32_dpp v59, v59, v59 row_ror:8 row_mask:0xf bank_mask:0xf
    s_nop 1
    v_add_f32_dpp v59, v59, v59 row_ror:4 row_mask:0xf bank_mask:0xf
    s_nop 1
    v_add_f32_dpp v59, v59, v59 row_ror:2 row_mask:0xf bank_mask:0xf
    s_nop 1
    v_add_f32_dpp v61, v59, v59 row_ror:1 row_mask:0xf bank_mask:0x4
    s_mov_b64 exec, s[42:43]
    ds_write_b64 v4, v[60:61]
    s_mov_b64 exec, -1
    v_add_u32 v4, 48, v4
    s_waitcnt vmcnt(6)
    v_lshlrev_b32 v10, 16, v36
    v_lshlrev_b32 v24, 16, v42
    v_and_b32 v11, 0xffff0000, v36
    v_and_b32 v25, 0xffff0000, v42
    v_mul_f32 v24, v24, v10
    v_mul_f32 v25, v25, v11
    v_lshlrev_b32 v10, 16, v37
    v_lshlrev_b32 v26, 16, v43
    v_and_b32 v11, 0xffff0000, v37
    v_and_b32 v27, 0xffff0000, v43
    v_mul_f32 v26, v26, v10
    v_mul_f32 v27, v27, v11
    v_lshlrev_b32 v10, 16, v38
    v_lshlrev_b32 v28, 16, v44
    v_and_b32 v11, 0xffff0000, v38
    v_and_b32 v29, 0xffff0000, v44
    v_mul_f32 v28, v28, v10
    v_mul_f32 v29, v29, v11
    v_lshlrev_b32 v10, 16, v39
    v_lshlrev_b32 v30, 16, v45
    v_and_b32 v11, 0xffff0000, v39
    v_and_b32 v31, 0xffff0000, v45
    v_mul_f32 v30, v30, v10
    v_mul_f32 v31, v31, v11
    v_lshlrev_b32 v10, 16, v40
    v_lshlrev_b32 v32, 16, v46
    v_and_b32 v11, 0xffff0000, v40
    v_and_b32 v33, 0xffff0000, v46
    v_mul_f32 v32, v32, v10
    v_mul_f32 v33, v33, v11
    v_lshlrev_b32 v10, 16, v41
    v_lshlrev_b32 v34, 16, v47
    v_and_b32 v11, 0xffff0000, v41
    v_and_b32 v35, 0xffff0000, v47
    v_mul_f32 v34, v34, v10
    v_mul_f32 v35, v35, v11
    s_branch L_kchk
L_vboost:
    s_nop 1
    s_and_b32 s32, s30, 15
    s_cbranch_scc0 L_vend
L_vboost2:
    s_nop 1
    s_cmp_eq_u32 s30, 48
    s_cbranch_scc1 L_vend2
    buffer_load_dwordx4 v[88:91], v48, s[12:15], 0 offen offset:1536 nt
    buffer_load_dwordx4 v[92:95], v48, s[12:15], 0 offen offset:1792 nt
    buffer_load_dwordx4 v[96:99], v48, s[12:15], 0 offen offset:2048 nt
    buffer_load_dwordx4 v[100:103], v48, s[12:15], 0 offen offset:2304 nt
    buffer_load_dwordx4 v[104:107], v48, s[12:15], 0 offen offset:2560 nt
    buffer_load_dwordx4 v[108:111], v48, s[12:15], 0 offen offset:2816 nt
    buffer_load_dwordx4 v[112:115], v48, s[12:15], 0 offen offset:3072 nt
    buffer_load_dwordx4 v[116:119], v48, s[12:15], 0 offen offset:3328 nt
    buffer_load_dwordx4 v[120:123], v48, s[12:15], 0 offen offset:3584 nt
    buffer_load_dwordx4 v[124:127], v49, s[12:15], 0 offen offset:0 nt
    buffer_load_dwordx4 v[128:131], v49, s[12:15], 0 offen offset:256 nt
    buffer_load_dwordx4 v[132:135], v49, s[12:15], 0 offen offset:512 nt
    s_sub_u32 s59, s59, 1
    s_add_u32 s29, s29, 4
    s_add_u32 s30, s30, 1
    s_bitcmp1_b64 s[40:41], s30
    s_cbranch_scc1 L_evVB
L_evretVB:
    s_nop 1
    s_lshr_b32 s33, s29, 6
    s_lshl_b32 s33, s33, 11
    s_and_b32 s32, s29, 63
    s_add_u32 s32, s32, s33
    s_add_u32 s32, s32, s44
    s_bfe_u32 s33, s32, 0x20003
    s_and_b32 s34, s32, 4
    s_or_b32 s33, s33, s34
    s_xor_b32 s33, s33, s5
    s_lshl_b32 s50, s32, 5
    s_or_b32 s50, s50, s33
    s_lshl_b32 s50, s50, 4
    s_or_b32 s50, s50, 1
    s_lshl_b32 s53, s29, 7
    v_xor_b32 v10, s50, v50
    v_mul_hi_u32 v10, v10, s47
    v_lshrrev_b32 v10, 1, v10
    v_and_b32 v11, 15, v10
    v_cmp_eq_u32 vcc, 5, v11
    v_mad_u32_u24 v48, v10, s45, v2
    v_add_u32 v11, 3840, v48
    v_cndmask_b32 v49, v51, v11, vcc
    v_add_u32 v10, s53, v5
    ds_read_b32 v7, v10
    s_waitcnt vmcnt(12)
    v_cvt_f32_i32 v64, v64
    v_cvt_f32_i32 v65, v65
    v_cvt_f32_i32 v66, v66
    v_cvt_f32_i32 v67, v67
    v_fmac_f32_dpp v12, v6, v64 row_newbcast:0 row_mask:0xf bank_mask:0xf
    v_fmac_f32_dpp v13, v6, v65 row_newbcast:0 row_mask:0xf bank_mask:0xf
    v_fmac_f32_dpp v14, v6, v66 row_newbcast:0 row_mask:0xf bank_mask:0xf
    v_fmac_f32_dpp v15, v6, v67 row_newbcast:0 row_mask:0xf bank_mask:0xf
    v_cvt_f32_i32 v68, v68
    v_cvt_f32_i32 v69, v69
    v_cvt_f32_i32 v70, v70
    v_cvt_f32_i32 v71, v71
    v_fmac_f32_dpp v16, v6, v68 row_newbcast:0 row_mask:0xf bank_mask:0xf
    v_fmac_f32_dpp v17, v6, v69 row_newbcast:0 row_mask:0xf bank_mask:0xf
    v_fmac_f32_dpp v18, v6, v70 row_newbcast:0 row_mask:0xf bank_mask:0xf
    v_fmac_f32_dpp v19, v6, v71 row_newbcast:0 row_mask:0xf bank_mask:0xf
    v_cvt_f32_i32 v72, v72
    v_cvt_f32_i32 v73, v73
    v_cvt_f32_i32 v74, v74
    v_cvt_f32_i32 v75, v75
    v_fmac_f32_dpp v20, v6, v72 row_newbcast:0 row_mask:0xf bank_mask:0xf
    v_fmac_f32_dpp v21, v6, v73 row_newbcast:0 row_mask:0xf bank_mask:0xf
    v_fmac_f32_dpp v22, v6, v74 row_newbcast:0 row_mask:0xf bank_mask:0xf
    v_fmac_f32_dpp v23, v6, v75 row_newbcast:0 row_mask:0xf bank_mask:0xf
    v_cvt_f32_i32 v76, v76
    v_cvt_f32_i32 v77, v77
    v_cvt_f32_i32 v78, v78
    v_cvt_f32_i32 v79, v79
    v_fmac_f32_dpp v12, v6, v76 row_newbcast:1 row_mask:0xf bank_mask:0xf
    v_fmac_f32_dpp v13, v6, v77 row_newbcast:1 row_mask:0xf bank_mask:0xf
    v_fmac_f32_dpp v14, v6, v78 row_newbcast:1 row_mask:0xf bank_mask:0xf
    v_fmac_f32_dpp v15, v6, v79 row_newbcast:1 row_mask:0xf bank_mask:0xf
    v_cvt_f32_i32 v80, v80
    v_cvt_f32_i32 v81, v81
    v_cvt_f32_i32 v82, v82
    v_cvt_f32_i32 v83, v83
    v_fmac_f32_dpp v16, v6, v80 row_newbcast:1 row_mask:0xf bank_mask:0xf
    v_fmac_f32_dpp v17, v6, v81 row_newbcast:1 row_mask:0xf bank_mask:0xf
    v_fmac_f32_dpp v18, v6, v82 row_newbcast:1 row_mask:0xf bank_mask:0xf
    v_fmac_f32_dpp v19, v6, v83 row_newbcast:1 row_mask:0xf bank_mask:0xf
    v_cvt_f32_i32 v84, v84
    v_cvt_f32_i32 v85, v85
    v_cvt_f32_i32 v86, v86
    v_cvt_f32_i32 v87, v87
    v_fmac_f32_dpp v20, v6, v84 row_newbcast:1 row_mask:0xf bank_mask:0xf
    v_fmac_f32_dpp v21, v6, v85 row_newbcast:1 row_mask:0xf bank_mask:0xf
    v_fmac_f32_dpp v22, v6, v86 row_newbcast:1 row_mask:0xf bank_mask:0xf
    v_fmac_f32_dpp v23, v6, v87 row_newbcast:1 row_mask:0xf bank_mask:0xf
    buffer_load_dwordx4 v[64:67], v48, s[12:15], 0 offen offset:0 nt
    buffer_load_dwordx4 v[68:71], v48, s[12:15], 0 offen offset:256 nt
    buffer_load_dwordx4 v[72:75], v48, s[12:15], 0 offen offset:512 nt
    buffer_load_dwordx4 v[76:79], v48, s[12:15], 0 offen offset:768 nt
    buffer_load_dwordx4 v[80:83], v48, s[12:15], 0 offen offset:1024 nt
    buffer_load_dwordx4 v[84:87], v48, s[12:15], 0 offen offset:1280 nt
    s_waitcnt vmcnt(12)
    s_cmp_eq_u32 s30, 48
    s_cbranch_scc1 L_el2
L_el2r:
    v_cvt_f32_i32 v88, v88
    v_cvt_f32_i32 v89, v89
    v_cvt_f32_i32 v90, v90
    v_cvt_f32_i32 v91, v91
    v_fmac_f32_dpp v12, v6, v88 row_newbcast:2 row_mask:0xf bank_mask:0xf
    v_fmac_f32_dpp v13, v6, v89 row_newbcast:2 row_mask:0xf bank_mask:0xf
    v_fmac_f32_dpp v14, v6, v90 row_newbcast:2 row_mask:0xf bank_mask:0xf
    v_fmac_f32_dpp v15, v6, v91 row_newbcast:2 row_mask:0xf bank_mask:0xf
    v_cvt_f32_i32 v92, v92
    v_cvt_f32_i32 v93, v93
    v_cvt_f32_i32 v94, v94
    v_cvt_f32_i32 v95, v95
    v_fmac_f32_dpp v16, v6, v92 row_newbcast:2 row_mask:0xf bank_mask:0xf
    v_fmac_f32_dpp v17, v6, v93 row_newbcast:2 row_mask:0xf bank_mask:0xf
    v_fmac_f32_dpp v18, v6, v94 row_newbcast:2 row_mask:0xf bank_mask:0xf
    v_fmac_f32_dpp v19, v6, v95 row_newbcast:2 row_mask:0xf bank_mask:0xf
    v_cvt_f32_i32 v96, v96
    v_cvt_f32_i32 v97, v97
    v_cvt_f32_i32 v98, v98
    v_cvt_f32_i32 v99, v99
    v_fmac_f32_dpp v20, v6, v96 row_newbcast:2 row_mask:0xf bank_mask:0xf
    v_fmac_f32_dpp v21, v6, v97 row_newbcast:2 row_mask:0xf bank_mask:0xf
    v_fmac_f32_dpp v22, v6, v98 row_newbcast:2 row_mask:0xf bank_mask:0xf
    v_fmac_f32_dpp v23, v6, v99 row_newbcast:2 row_mask:0xf bank_mask:0xf
    v_cvt_f32_i32 v100, v100
    v_cvt_f32_i32 v101, v101
    v_cvt_f32_i32 v102, v102
    v_cvt_f32_i32 v103, v103
    v_fmac_f32_dpp v12, v6, v100 row_newbcast:3 row_mask:0xf bank_mask:0xf
    v_fmac_f32_dpp v13, v6, v101 row_newbcast:3 row_mask:0xf bank_mask:0xf
    v_fmac_f32_dpp v14, v6, v102 row_newbcast:3 row_mask:0xf bank_mask:0xf
    v_fmac_f32_dpp v15, v6, v103 row_newbcast:3 row_mask:0xf bank_mask:0xf
    v_cvt_f32_i32 v104, v104
    v_cvt_f32_i32 v105, v105
    v_cvt_f32_i32 v106, v106
    v_cvt_f32_i32 v107, v107
    v_fmac_f32_dpp v16, v6, v104 row_newbcast:3 row_mask:0xf bank_mask:0xf
    v_fmac_f32_dpp v17, v6, v105 row_newbcast:3 row_mask:0xf bank_mask:0xf
    v_fmac_f32_dpp v18, v6, v106 row_newbcast:3 row_mask:0xf bank_mask:0xf
    v_fmac_f32_dpp v19, v6, v107 row_newbcast:3 row_mask:0xf bank_mask:0xf
    v_cvt_f32_i32 v108, v108
    v_cvt_f32_i32 v109, v109
    v_cvt_f32_i32 v110, v110
    v_cvt_f32_i32 v111, v111
    v_fmac_f32_dpp v20, v6, v108 row_newbcast:3 row_mask:0xf bank_mask:0xf
    v_fmac_f32_dpp v21, v6, v109 row_newbcast:3 row_mask:0xf bank_mask:0xf
    v_fmac_f32_dpp v22, v6, v110 row_newbcast:3 row_mask:0xf bank_mask:0xf
    v_fmac_f32_dpp v23, v6, v111 row_newbcast:3 row_mask:0xf bank_mask:0xf
    s_waitcnt vmcnt(6)
    v_cvt_f32_i32 v112, v112
    v_cvt_f32_i32 v113, v113
    v_cvt_f32_i32 v114, v114
    v_cvt_f32_i32 v115, v115
    v_fmac_f32_dpp v12, v6, v112 row_newbcast:4 row_mask:0xf bank_mask:0xf
    v_fmac_f32_dpp v13, v6, v113 row_newbcast:4 row_mask:0xf bank_mask:0xf
    v_fmac_f32_dpp v14, v6, v114 row_newbcast:4 row_mask:0xf bank_mask:0xf
    v_fmac_f32_dpp v15, v6, v115 row_newbcast:4 row_mask:0xf bank_mask:0xf
    v_cvt_f32_i32 v116, v116
    v_cvt_f32_i32 v117, v117
    v_cvt_f32_i32 v118, v118
    v_cvt_f32_i32 v119, v119
    v_fmac_f32_dpp v16, v6, v116 row_newbcast:4 row_mask:0xf bank_mask:0xf
    v_fmac_f32_dpp v17, v6, v117 row_newbcast:4 row_mask:0xf bank_mask:0xf
    v_fmac_f32_dpp v18, v6, v118 row_newbcast:4 row_mask:0xf bank_mask:0xf
    v_fmac_f32_dpp v19, v6, v119 row_newbcast:4 row_mask:0xf bank_mask:0xf
    v_cvt_f32_i32 v120, v120
    v_cvt_f32_i32 v121, v121
    v_cvt_f32_i32 v122, v122
    v_cvt_f32_i32 v123, v123
    v_fmac_f32_dpp v20, v6, v120 row_newbcast:4 row_mask:0xf bank_mask:0xf
    v_fmac_f32_dpp v21, v6, v121 row_newbcast:4 row_mask:0xf bank_mask:0xf
    v_fmac_f32_dpp v22, v6, v122 row_newbcast:4 row_mask:0xf bank_mask:0xf
    v_fmac_f32_dpp v23, v6, v123 row_newbcast:4 row_mask:0xf bank_mask:0xf
    v_cvt_f32_i32 v124, v124
    v_cvt_f32_i32 v125, v125
    v_cvt_f32_i32 v126, v126
    v_cvt_f32_i32 v127, v127
    v_fmac_f32_dpp v12, v6, v124 row_newbcast:5 row_mask:0xf bank_mask:0xf
    v_fmac_f32_dpp v13, v6, v125 row_newbcast:5 row_mask:0xf bank_mask:0xf
    v_fmac_f32_dpp v14, v6, v126 row_newbcast:5 row_mask:0xf bank_mask:0xf
    v_fmac_f32_dpp v15, v6, v127 row_newbcast:5 row_mask:0xf bank_mask:0xf
    v_cvt_f32_i32 v128, v128
    v_cvt_f32_i32 v129, v129
    v_cvt_f32_i32 v130, v130
    v_cvt_f32_i32 v131, v131
    v_fmac_f32_dpp v16, v6, v128 row_newbcast:5 row_mask:0xf bank_mask:0xf
    v_fmac_f32_dpp v17, v6, v129 row_newbcast:5 row_mask:0xf bank_mask:0xf
    v_fmac_f32_dpp v18, v6, v130 row_newbcast:5 row_mask:0xf bank_mask:0xf
    v_fmac_f32_dpp v19, v6, v131 row_newbcast:5 row_mask:0xf bank_mask:0xf
    v_cvt_f32_i32 v132, v132
    v_cvt_f32_i32 v133, v133
    v_cvt_f32_i32 v134, v134
    v_cvt_f32_i32 v135, v135
    v_fmac_f32_dpp v20, v6, v132 row_newbcast:5 row_mask:0xf bank_mask:0xf
    v_fmac_f32_dpp v21, v6, v133 row_newbcast:5 row_mask:0xf bank_mask:0xf
    v_fmac_f32_dpp v22, v6, v134 row_newbcast:5 row_mask:0xf bank_mask:0xf
    v_fmac_f32_dpp v23, v6, v135 row_newbcast:5 row_mask:0xf bank_mask:0xf
    s_waitcnt lgkmcnt(0)
    v_mov_b32 v6, v7
    s_branch L_vchk
L_el0:
    s_nop 1
    v_mov_b32 v11, 1
    s_mov_b64 exec, 1
    ds_add_u32 v53, v11 offset:136
    s_mov_b64 exec, -1
    s_branch L_el0r
L_el1:
    s_nop 1
    v_mov_b32 v11, 1
    s_mov_b64 exec, 1
    ds_add_u32 v53, v11 offset:136
    s_mov_b64 exec, -1
    s_branch L_el1r
L_el2:
    s_nop 1
    v_mov_b32 v11, 1
    s_mov_b64 exec, 1
    ds_add_u32 v53, v11 offset:136
    s_mov_b64 exec, -1
    s_branch L_el2r
L_evK:
    s_nop 1
    s_bitcmp1_b64 s[64:65], s30
    s_cbranch_scc0 L_paK
    s_memrealtime s[60:61]
    s_mov_b32 s72, s59
    v_mov_b32 v11, 1
    s_mov_b64 exec, 1
    ds_add_u32 v53, v11 offset:128
    s_mov_b64 exec, -1
L_paK:
    s_nop 1
    s_bitcmp1_b64 s[66:67], s30
    s_cbranch_scc0 L_pbK
    v_mov_b32 v11, 1
    s_mov_b64 exec, 1
    ds_add_u32 v53, v11 offset:128
    s_mov_b64 exec, -1
L_pbK:
    s_nop 1
    s_bitcmp1_b64 s[68:69], s30
    s_cbranch_scc0 L_pcK
    v_mov_b32 v11, s62
    ds_read_b32 v10, v11
    v_mov_b32 v11, 1
    s_mov_b64 exec, 1
    ds_add_u32 v53, v11 offset:128
    s_mov_b64 exec, -1
    s_add_u32 s62, s62, 4
    s_waitcnt lgkmcnt(0)
    v_readfirstlane_b32 s32, v10
    s_cmp_eq_u32 s32, 0
    s_cbranch_scc1 L_pcK
    s_sub_u32 s32, s60, s32
    s_max_i32 s32, s32, -4096
    s_min_i32 s32, s32, 4096
    s_mul_i32 s32, s32, 8
    s_add_u32 s32, s32, 512
    s_ashr_i32 s32, s32, 10
    s_sub_u32 s32, s32, s72
    s_add_u32 s32, s32, s59
    s_max_i32 s32, s32, 0
    s_min_i32 s59, s32, 6
L_pcK:
    s_nop 1
    s_bitcmp1_b64 s[70:71], s30
    s_cbranch_scc0 L_evretK
    s_and_b32 s32, s30, 15
    s_cbranch_scc0 L_evK2
    s_cmp_eq_u32 s30, 3
    s_cbranch_scc1 L_evK2
    s_lshr_b32 s33, s30, 2
    s_andn2_b32 s33, s33, 3
    s_add_u32 s33, s33, 36
    s_cmp_eq_u32 s32, 1
    s_cselect_b32 s32, s33, 60
    s_cselect_b32 s33, 5376, 0
    v_add_u32 v4, s33, v4
    s_cmp_eq_u32 s30, 2
    s_cselect_b32 s32, 56, s32
    v_mov_b32 v10, s32
    v_mov_b32 v11, 1
    s_mov_b64 exec, 1
    ds_add_u32 v10, v11 offset:0
    s_mov_b64 exec, -1
    s_branch L_evretK
L_evK2:
    s_nop 1
    s_cmp_eq_u32 s30, 16
    s_cbranch_scc0 L_gxtk16
    s_memrealtime s[36:37]
    s_mov_b32 s6, 0x100000
L_wgtk16:
    s_nop 1
    ds_read_b32 v10, v53 offset:208
    s_sub_u32 s6, s6, 1
    s_cbranch_scc1 L_exit1
    s_waitcnt lgkmcnt(0)
    v_readfirstlane_b32 s32, v10
    s_cmp_eq_u32 s32, 0
    s_cbranch_scc1 L_wgtk16
    s_and_b32 s32, s32, 0xffff
    s_cbranch_scc0 L_gxtk16
    s_add_u32 s32, s32, s36
L_gltk16:
    s_nop 1
    s_memrealtime s[36:37]
    s_waitcnt lgkmcnt(0)
    s_sub_u32 s36, s36, s32
    s_cmp_lt_i32 s36, 0
    s_cbranch_scc1 L_gltk16
L_gxtk16:
    s_nop 1
    s_cmp_eq_u32 s30, 32
    s_cbranch_scc0 L_gxtk32
    s_memrealtime s[36:37]
    s_mov_b32 s6, 0x100000
L_wgtk32:
    s_nop 1
    ds_read_b32 v10, v53 offset:212
    s_sub_u32 s6, s6, 1
    s_cbranch_scc1 L_exit1
    s_waitcnt lgkmcnt(0)
    v_readfirstlane_b32 s32, v10
    s_cmp_eq_u32 s32, 0
    s_cbranch_scc1 L_wgtk32
    s_and_b32 s32, s32, 0xffff
    s_cbranch_scc0 L_gxtk32
    s_add_u32 s32, s32, s36
L_gltk32:
    s_nop 1
    s_memrealtime s[36:37]
    s_waitcnt lgkmcnt(0)
    s_sub_u32 s36, s36, s32
    s_cmp_lt_i32 s36, 0
    s_cbranch_scc1 L_gltk32
L_gxtk32:
    s_nop 1
    s_lshr_b32 s33, s30, 4
    s_lshl_b32 s34, s33, 2
    v_mov_b32 v11, s34
    s_lshl_b32 s31, s33, 5
    s_add_u32 s31, s31, s3
    s_mul_i32 s31, s31, 171
    s_lshr_b32 s31, s31, 9
    s_mul_i32 s31, s31, 384
    buffer_load_dwordx2 v[36:37], v3, s[20:23], s31 offen offset:0
    buffer_load_dwordx2 v[38:39], v3, s[20:23], s31 offen offset:128
    buffer_load_dwordx2 v[40:41], v3, s[20:23], s31 offen offset:256
    s_mov_b32 s6, 0x100000
L_wtk:
    s_nop 1
    ds_read_b32 v10, v11 offset:0
    s_sub_u32 s6, s6, 1
    s_cbranch_scc1 L_exit1
    s_waitcnt lgkmcnt(0)
    v_readfirstlane_b32 s32, v10
    s_cmp_eq_u32 s32, 0
    s_cbranch_scc1 L_wtk
    s_and_b32 s5, s32, 7
    s_xor_b32 s5, s5, s48
    s_bitcmp1_b32 s32, 3
    s_cselect_b64 vcc, -1, 0
    v_cndmask_b32 v50, v62, v63, vcc
    s_branch L_evretK
L_evV:
    s_nop 1
    s_bitcmp1_b64 s[64:65], s30
    s_cbranch_scc0 L_paV
    s_memrealtime s[60:61]
    s_mov_b32 s72, s59
    v_mov_b32 v11, 1
    s_mov_b64 exec, 1
    ds_add_u32 v53, v11 offset:128
    s_mov_b64 exec, -1
L_paV:
    s_nop 1
    s_bitcmp1_b64 s[66:67], s30
    s_cbranch_scc0 L_pbV
    v_mov_b32 v11, 1
    s_mov_b64 exec, 1
    ds_add_u32 v53, v11 offset:128
    s_mov_b64 exec, -1
L_pbV:
    s_nop 1
    s_bitcmp1_b64 s[68:69], s30
    s_cbranch_scc0 L_pcV
    v_mov_b32 v11, s62
    ds_read_b32 v10, v11
    v_mov_b32 v11, 1
    s_mov_b64 exec, 1
    ds_add_u32 v53, v11 offset:128
    s_mov_b64 exec, -1
    s_add_u32 s62, s62, 4
    s_waitcnt lgkmcnt(0)
    v_readfirstlane_b32 s32, v10
    s_cmp_eq_u32 s32, 0
    s_cbranch_scc1 L_pcV
    s_sub_u32 s32, s60, s32
    s_max_i32 s32, s32, -4096
    s_min_i32 s32, s32, 4096
    s_cmp_eq_u32 s30, 44
    s_cbranch_scc0 L_pd
    s_mul_i32 s32, s32, 9
    s_add_u32 s32, s32, 2048
    s_ashr_i32 s32, s32, 10
    s_max_i32 s32, s32, 0
    s_min_i32 s32, s32, 4
    s_sub_u32 s49, 48, s32
    s_cmp_eq_u32 s49, 48
    s_cselect_b32 s49, 255, s49
    s_mov_b32 s59, 0
    s_branch L_pcV
L_pd:
    s_nop 1
    s_mul_i32 s32, s32, 8
    s_add_u32 s32, s32, 512
    s_ashr_i32 s32, s32, 10
    s_sub_u32 s32, s32, s72
    s_add_u32 s32, s32, s59
    s_max_i32 s32, s32, 0
    s_min_i32 s59, s32, 6
L_pcV:
    s_nop 1
    s_bitcmp1_b64 s[70:71], s30
    s_cbranch_scc0 L_evretV
    s_cmp_eq_u32 s30, 16
    s_cbranch_scc0 L_gxtv264
    s_memrealtime s[36:37]
    s_mov_b32 s6, 0x100000
L_wgtv264:
    s_nop 1
    ds_read_b32 v10, v53 offset:220
    s_sub_u32 s6, s6, 1
    s_cbranch_scc1 L_exit1
    s_waitcnt lgkmcnt(0)
    v_readfirstlane_b32 s32, v10
    s_cmp_eq_u32 s32, 0
    s_cbranch_scc1 L_wgtv264
    s_and_b32 s32, s32, 0xffff
    s_cbranch_scc0 L_gxtv264
    s_add_u32 s32, s32, s36
L_gltv264:
    s_nop 1
    s_memrealtime s[36:37]
    s_waitcnt lgkmcnt(0)
    s_sub_u32 s36, s36, s32
    s_cmp_lt_i32 s36, 0
    s_cbranch_scc1 L_gltv264
L_gxtv264:
    s_nop 1
    s_cmp_eq_u32 s30, 32
    s_cbranch_scc0 L_gxtv280
    s_memrealtime s[36:37]
    s_mov_b32 s6, 0x100000
L_wgtv280:
    s_nop 1
    ds_read_b32 v10, v53 offset:224
    s_sub_u32 s6, s6, 1
    s_cbranch_scc1 L_exit1
    s_waitcnt lgkmcnt(0)
    v_readfirstlane_b32 s32, v10
    s_cmp_eq_u32 s32, 0
    s_cbranch_scc1 L_wgtv280
    s_and_b32 s32, s32, 0xffff
    s_cbranch_scc0 L_gxtv280
    s_add_u32 s32, s32, s36
L_gltv280:
    s_nop 1
    s_memrealtime s[36:37]
    s_waitcnt lgkmcnt(0)
    s_sub_u32 s36, s36, s32
    s_cmp_lt_i32 s36, 0
    s_cbranch_scc1 L_gltv280
L_gxtv280:
    s_nop 1
    s_lshr_b32 s33, s30, 4
    s_lshl_b32 s34, s33, 2
    v_mov_b32 v11, s34
    s_mov_b32 s6, 0x100000
L_wtv2:
    s_nop 1
    ds_read_b32 v10, v11 offset:24
    s_sub_u32 s6, s6, 1
    s_cbranch_scc1 L_exit1
    s_waitcnt lgkmcnt(0)
    v_readfirstlane_b32 s32, v10
    s_cmp_eq_u32 s32, 0
    s_cbranch_scc1 L_wtv2
    s_and_b32 s5, s32, 7
    s_xor_b32 s5, s5, s48
    s_bitcmp1_b32 s32, 3
    s_cselect_b64 vcc, -1, 0
    v_cndmask_b32 v50, v62, v63, vcc
    s_branch L_evretV
L_evKB:
    s_nop 1
    s_bitcmp1_b64 s[64:65], s30
    s_cbranch_scc0 L_paKB
    s_memrealtime s[60:61]
    s_mov_b32 s72, s59
    v_mov_b32 v11, 1
    s_mov_b64 exec, 1
    ds_add_u32 v53, v11 offset:128
    s_mov_b64 exec, -1
L_paKB:
    s_nop 1
    s_bitcmp1_b64 s[66:67], s30
    s_cbranch_scc0 L_pbKB
    v_mov_b32 v11, 1
    s_mov_b64 exec, 1
    ds_add_u32 v53, v11 offset:128
    s_mov_b64 exec, -1
L_pbKB:
    s_nop 1
    s_bitcmp1_b64 s[68:69], s30
    s_cbranch_scc0 L_pcKB
    v_mov_b32 v11, s62
    ds_read_b32 v10, v11
    v_mov_b32 v11, 1
    s_mov_b64 exec, 1
    ds_add_u32 v53, v11 offset:128
    s_mov_b64 exec, -1
    s_add_u32 s62, s62, 4
    s_waitcnt lgkmcnt(0)
    v_readfirstlane_b32 s32, v10
    s_cmp_eq_u32 s32, 0
    s_cbranch_scc1 L_pcKB
    s_sub_u32 s32, s60, s32
    s_max_i32 s32, s32, -4096
    s_min_i32 s32, s32, 4096
    s_mul_i32 s32, s32, 8
    s_add_u32 s32, s32, 512
    s_ashr_i32 s32, s32, 10
    s_sub_u32 s32, s32, s72
    s_add_u32 s32, s32, s59
    s_max_i32 s32, s32, 0
    s_min_i32 s59, s32, 6
L_pcKB:
    s_nop 1
    s_bitcmp1_b64 s[70:71], s30
    s_cbranch_scc0 L_evretKB
    s_and_b32 s32, s30, 15
    s_cbranch_scc0 L_evK2B
    s_cmp_eq_u32 s30, 3
    s_cbranch_scc1 L_evK2B
    s_lshr_b32 s33, s30, 2
    s_andn2_b32 s33, s33, 3
    s_add_u32 s33, s33, 36
    s_cmp_eq_u32 s32, 1
    s_cselect_b32 s32, s33, 60
    s_cselect_b32 s33, 5376, 0
    v_add_u32 v4, s33, v4
    s_cmp_eq_u32 s30, 2
    s_cselect_b32 s32, 56, s32
    v_mov_b32 v10, s32
    v_mov_b32 v11, 1
    s_mov_b64 exec, 1
    ds_add_u32 v10, v11 offset:0
    s_mov_b64 exec, -1
    s_branch L_evretKB
L_evK2B:
    s_nop 1
    s_cmp_eq_u32 s30, 16
    s_cbranch_scc0 L_gxtkB16
    s_memrealtime s[36:37]
    s_mov_b32 s6, 0x100000
L_wgtkB16:
    s_nop 1
    ds_read_b32 v10, v53 offset:208
    s_sub_u32 s6, s6, 1
    s_cbranch_scc1 L_exit1
    s_waitcnt lgkmcnt(0)
    v_readfirstlane_b32 s32, v10
    s_cmp_eq_u32 s32, 0
    s_cbranch_scc1 L_wgtkB16
    s_and_b32 s32, s32, 0xffff
    s_cbranch_scc0 L_gxtkB16
    s_add_u32 s32, s32, s36
L_gltkB16:
    s_nop 1
    s_memrealtime s[36:37]
    s_waitcnt lgkmcnt(0)
    s_sub_u32 s36, s36, s32
    s_cmp_lt_i32 s36, 0
    s_cbranch_scc1 L_gltkB16
L_gxtkB16:
    s_nop 1
    s_cmp_eq_u32 s30, 32
    s_cbranch_scc0 L_gxtkB32
    s_memrealtime s[36:37]
    s_mov_b32 s6, 0x100000
L_wgtkB32:
    s_nop 1
    ds_read_b32 v10, v53 offset:212
    s_sub_u32 s6, s6, 1
    s_cbranch_scc1 L_exit1
    s_waitcnt lgkmcnt(0)
    v_readfirstlane_b32 s32, v10
    s_cmp_eq_u32 s32, 0
    s_cbranch_scc1 L_wgtkB32
    s_and_b32 s32, s32, 0xffff
    s_cbranch_scc0 L_gxtkB32
    s_add_u32 s32, s32, s36
L_gltkB32:
    s_nop 1
    s_memrealtime s[36:37]
    s_waitcnt lgkmcnt(0)
    s_sub_u32 s36, s36, s32
    s_cmp_lt_i32 s36, 0
    s_cbranch_scc1 L_gltkB32
L_gxtkB32:
    s_nop 1
    s_lshr_b32 s33, s30, 4
    s_lshl_b32 s34, s33, 2
    v_mov_b32 v11, s34
    s_lshl_b32 s31, s33, 5
    s_add_u32 s31, s31, s3
    s_mul_i32 s31, s31, 171
    s_lshr_b32 s31, s31, 9
    s_mul_i32 s31, s31, 384
    buffer_load_dwordx2 v[36:37], v3, s[20:23], s31 offen offset:0
    buffer_load_dwordx2 v[38:39], v3, s[20:23], s31 offen offset:128
    buffer_load_dwordx2 v[40:41], v3, s[20:23], s31 offen offset:256
    s_mov_b32 s6, 0x100000
L_wtkB:
    s_nop 1
    ds_read_b32 v10, v11 offset:0
    s_sub_u32 s6, s6, 1
    s_cbranch_scc1 L_exit1
    s_waitcnt lgkmcnt(0)
    v_readfirstlane_b32 s32, v10
    s_cmp_eq_u32 s32, 0
    s_cbranch_scc1 L_wtkB
    s_and_b32 s5, s32, 7
    s_xor_b32 s5, s5, s48
    s_bitcmp1_b32 s32, 3
    s_cselect_b64 vcc, -1, 0
    v_cndmask_b32 v50, v62, v63, vcc
    s_branch L_evretKB
L_evVB:
    s_nop 1
    s_bitcmp1_b64 s[64:65], s30
    s_cbranch_scc0 L_paVB
    s_memrealtime s[60:61]
    s_mov_b32 s72, s59
    v_mov_b32 v11, 1
    s_mov_b64 exec, 1
    ds_add_u32 v53, v11 offset:128
    s_mov_b64 exec, -1
L_paVB:
    s_nop 1
    s_bitcmp1_b64 s[66:67], s30
    s_cbranch_scc0 L_pbVB
    v_mov_b32 v11, 1
    s_mov_b64 exec, 1
    ds_add_u32 v53, v11 offset:128
    s_mov_b64 exec, -1
L_pbVB:
    s_nop 1
    s_bitcmp1_b64 s[68:69], s30
    s_cbranch_scc0 L_pcVB
    v_mov_b32 v11, s62
    ds_read_b32 v10, v11
    v_mov_b32 v11, 1
    s_mov_b64 exec, 1
    ds_add_u32 v53, v11 offset:128
    s_mov_b64 exec, -1
    s_add_u32 s62, s62, 4
    s_waitcnt lgkmcnt(0)
    v_readfirstlane_b32 s32, v10
    s_cmp_eq_u32 s32, 0
    s_cbranch_scc1 L_pcVB
    s_sub_u32 s32, s60, s32
    s_max_i32 s32, s32, -4096
    s_min_i32 s32, s32, 4096
    s_cmp_eq_u32 s30, 44
    s_cbranch_scc0 L_pdB
    s_mul_i32 s32, s32, 9
    s_add_u32 s32, s32, 2048
    s_ashr_i32 s32, s32, 10
    s_max_i32 s32, s32, 0
    s_min_i32 s32, s32, 4
    s_sub_u32 s49, 48, s32
    s_cmp_eq_u32 s49, 48
    s_cselect_b32 s49, 255, s49
    s_mov_b32 s59, 0
    s_branch L_pcVB
L_pdB:
    s_nop 1
    s_mul_i32 s32, s32, 8
    s_add_u32 s32, s32, 512
    s_ashr_i32 s32, s32, 10
    s_sub_u32 s32, s32, s72
    s_add_u32 s32, s32, s59
    s_max_i32 s32, s32, 0
    s_min_i32 s59, s32, 6
L_pcVB:
    s_nop 1
    s_bitcmp1_b64 s[70:71], s30
    s_cbranch_scc0 L_evretVB
    s_cmp_eq_u32 s30, 16
    s_cbranch_scc0 L_gxtv2B64
    s_memrealtime s[36:37]
    s_mov_b32 s6, 0x100000
L_wgtv2B64:
    s_nop 1
    ds_read_b32 v10, v53 offset:220
    s_sub_u32 s6, s6, 1
    s_cbranch_scc1 L_exit1
    s_waitcnt lgkmcnt(0)
    v_readfirstlane_b32 s32, v10
    s_cmp_eq_u32 s32, 0
    s_cbranch_scc1 L_wgtv2B64
    s_and_b32 s32, s32, 0xffff
    s_cbranch_scc0 L_gxtv2B64
    s_add_u32 s32, s32, s36
L_gltv2B64:
    s_nop 1
    s_memrealtime s[36:37]
    s_waitcnt lgkmcnt(0)
    s_sub_u32 s36, s36, s32
    s_cmp_lt_i32 s36, 0
    s_cbranch_scc1 L_gltv2B64
L_gxtv2B64:
    s_nop 1
    s_cmp_eq_u32 s30, 32
    s_cbranch_scc0 L_gxtv2B80
    s_memrealtime s[36:37]
    s_mov_b32 s6, 0x100000
L_wgtv2B80:
    s_nop 1
    ds_read_b32 v10, v53 offset:224
    s_sub_u32 s6, s6, 1
    s_cbranch_scc1 L_exit1
    s_waitcnt lgkmcnt(0)
    v_readfirstlane_b32 s32, v10
    s_cmp_eq_u32 s32, 0
    s_cbranch_scc1 L_wgtv2B80
    s_and_b32 s32, s32, 0xffff
    s_cbranch_scc0 L_gxtv2B80
    s_add_u32 s32, s32, s36
L_gltv2B80:
    s_nop 1
    s_memrealtime s[36:37]
    s_waitcnt lgkmcnt(0)
    s_sub_u32 s36, s36, s32
    s_cmp_lt_i32 s36, 0
    s_cbranch_scc1 L_gltv2B80
L_gxtv2B80:
    s_nop 1
    s_lshr_b32 s33, s30, 4
    s_lshl_b32 s34, s33, 2
    v_mov_b32 v11, s34
    s_mov_b32 s6, 0x100000
L_wtv2B:
    s_nop 1
    ds_read_b32 v10, v11 offset:24
    s_sub_u32 s6, s6, 1
    s_cbranch_scc1 L_exit1
    s_waitcnt lgkmcnt(0)
    v_readfirstlane_b32 s32, v10
    s_cmp_eq_u32 s32, 0
    s_cbranch_scc1 L_wtv2B
    s_and_b32 s5, s32, 7
    s_xor_b32 s5, s5, s48
    s_bitcmp1_b32 s32, 3
    s_cselect_b64 vcc, -1, 0
    v_cndmask_b32 v50, v62, v63, vcc
    s_branch L_evretVB
L_helper:
    s_nop 1
    s_sub_u32 s6, s28, 4
    s_mov_b32 s5, s48
    v_and_b32 v1, 63, v0
    v_mov_b32 v2, 0
    s_mul_i32 s59, s3, 34816
    s_add_u32 s59, s59, 8388608
    s_cmp_eq_u32 s6, 3
    s_cbranch_scc1 L_h3
    s_mul_i32 s48, s6, 25
    s_sub_u32 s48, s48, 22
    s_cmp_lt_i32 s3, s48
    s_cselect_b32 s90, 1, 0
    s_cbranch_scc0 L_noprobe1
    s_add_u32 s49, s3, 2
    s_mul_i32 s48, s49, 205
    s_lshr_b32 s48, s48, 10
    s_mul_i32 s7, s48, 5
    s_sub_u32 s7, s49, s7
    s_add_u32 s7, s7, 1
    s_lshl_b32 s49, s3, 1
    s_add_u32 s49, s49, s6
    s_sub_u32 s49, s49, 1
    s_cmp_lt_u32 s3, 3
    s_cselect_b32 s7, 0, s7
    s_cselect_b32 s49, s49, s48
    s_and_b32 s48, s49, 1
    s_mul_i32 s20, s49, 20
    s_add_u32 s20, s20, s48
    s_add_u32 s20, s20, 2
    s_lshr_b32 s91, s20, 5
    s_xor_b32 s91, s91, s4
    s_lshl_b32 s20, s20, 21
    s_xor_b32 s21, s4, s6
    s_and_b32 s21, s21, 1
    s_lshr_b32 s49, s4, 2
    s_xor_b32 s48, s48, s49
    s_xor_b32 s48, s48, s21
    s_lshl_b32 s48, s48, 13
    s_lshl_b32 s49, s6, 14
    s_and_b32 s49, s49, 0x4000
    s_or_b32 s48, s48, s49
    s_xor_b32 s32, s48, 0x0
    s_xor_b32 s33, s48, 0x2000
    s_xor_b32 s34, s48, 0x1000
    s_xor_b32 s35, s48, 0x3000
    s_xor_b32 s36, s48, 0x4000
    s_xor_b32 s37, s48, 0x6000
    s_xor_b32 s38, s48, 0x5000
    s_xor_b32 s39, s48, 0x7000
    v_and_b32 v3, 7, v1
    v_lshlrev_b32 v3, 12, v3
    s_lshl_b32 s48, s4, 8
    v_add_u32 v3, s48, v3
    s_mov_b32 s10, 805306368
    s_mov_b32 s11, 0x00020000
    s_cmp_ge_u32 s7, 3
    s_cselect_b32 s48, 3, 0
    s_sub_u32 s48, s7, s48
    s_lshl_b32 s48, s48, 28
    s_add_u32 s20, s20, s48
    s_cmp_ge_u32 s7, 3
    s_waitcnt lgkmcnt(0)
    s_cselect_b32 s8, s68, s66
    s_cselect_b32 s23, s69, s67
    s_and_b32 s9, s23, 0xffff
    s_add_u32 s22, s8, s20
    s_addc_u32 s23, s23, 0
    s_lshl_b32 s48, s4, 8
    s_add_u32 s56, s22, s48
    s_addc_u32 s57, s23, 0
    s_load_dword s24, s[56:57], 0x0
    s_load_dword s25, s[56:57], 0x1000
    s_load_dword s26, s[56:57], 0x2000
    s_load_dword s27, s[56:57], 0x3000
    s_load_dword s28, s[56:57], 0x4000
    s_load_dword s29, s[56:57], 0x5000
    s_load_dword s30, s[56:57], 0x6000
    s_load_dword s31, s[56:57], 0x7000
    s_mov_b32 s12, s82
    s_and_b32 s13, s83, 0xffff
    s_mov_b32 s14, 10485760
    s_mov_b32 s15, 0x00020000
    s_lshl_b32 s48, s2, 1
    s_add_u32 s48, s48, s6
    s_mul_i32 s48, s48, 26112
    s_add_u32 s48, s48, 8362496
    v_mul_u32_u24 v5, 4352, v1
    v_mov_b32 v3, 0
    v_mov_b32 v4, 0
    s_cmp_eq_u32 s7, 0
    s_cselect_b64 exec, 0x3f, 0
    buffer_store_dwordx3 v[2:4], v5, s[12:15], s48 offen sc1
    s_mov_b64 exec, -1
    s_cmp_lg_u32 s7, 0
    s_cbranch_scc1 L_noprobe2
L_noprobe1:
    s_nop 1
    s_waitcnt lgkmcnt(0)
L_noprobe2:
    s_nop 1
    s_mov_b32 s12, s82
    s_and_b32 s13, s83, 0xffff
    s_mov_b32 s14, 10485760
    s_mov_b32 s15, 0x00020000
    s_mov_b32 s16, s80
    s_and_b32 s17, s81, 0xffff
    s_mov_b32 s18, 256
    s_mov_b32 s19, 0x00020000
    s_cmp_lg_u32 s6, 0
    s_cbranch_scc1 L_hbar
    v_lshlrev_b32 v5, 2, v1
    ds_write_b32 v5, v2
    s_waitcnt lgkmcnt(0)
L_hbar:
    s_nop 1
    s_barrier
    s_cmp_eq_u32 s90, 0
    s_cbranch_scc1 L_role
    s_mov_b32 s46, 1
    s_mov_b32 s58, 0
    s_mov_b32 s61, 0
    s_mov_b32 s62, 0
    s_mov_b32 s63, 0
    s_cmp_eq_u32 s7, 0
    s_cselect_b32 s47, 1, 7
    s_waitcnt lgkmcnt(0)
L_round:
    s_nop 1
    s_add_u32 s48, s4, s46
    s_and_b32 s48, s48, 7
    s_lshl_b32 s48, s48, 8
    s_add_u32 s56, s22, s48
    s_addc_u32 s57, s23, 0
    s_mov_b32 s44, -1
    s_memtime s[40:41]
    s_waitcnt lgkmcnt(0)
    s_load_dword s45, s[56:57], s32
    s_waitcnt lgkmcnt(0)
    s_memtime s[42:43]
    s_waitcnt lgkmcnt(0)
    s_sub_u32 s24, s42, s40
    s_load_dword s45, s[56:57], s33
    s_waitcnt lgkmcnt(0)
    s_memtime s[40:41]
    s_waitcnt lgkmcnt(0)
    s_sub_u32 s25, s40, s42
    s_load_dword s45, s[56:57], s34
    s_waitcnt lgkmcnt(0)
    s_memtime s[42:43]
    s_waitcnt lgkmcnt(0)
    s_sub_u32 s26, s42, s40
    s_load_dword s45, s[56:57], s35
    s_waitcnt lgkmcnt(0)
    s_memtime s[40:41]
    s_waitcnt lgkmcnt(0)
    s_sub_u32 s27, s40, s42
    s_mov_b32 s28, -1
    s_mov_b32 s29, -1
    s_mov_b32 s30, -1
    s_mov_b32 s31, -1
    s_cmp_eq_u32 s7, 0
    s_cbranch_scc1 L_few
    s_load_dword s45, s[56:57], s36
    s_waitcnt lgkmcnt(0)
    s_memtime s[42:43]
    s_waitcnt lgkmcnt(0)
    s_sub_u32 s28, s42, s40
    s_load_dword s45, s[56:57], s37
    s_waitcnt lgkmcnt(0)
    s_memtime s[40:41]
    s_waitcnt lgkmcnt(0)
    s_sub_u32 s29, s40, s42
    s_load_dword s45, s[56:57], s38
    s_waitcnt lgkmcnt(0)
    s_memtime s[42:43]
    s_waitcnt lgkmcnt(0)
    s_sub_u32 s30, s42, s40
    s_load_dword s45, s[56:57], s39
    s_waitcnt lgkmcnt(0)
    s_memtime s[40:41]
    s_waitcnt lgkmcnt(0)
    s_sub_u32 s31, s40, s42
L_few:
    s_nop 1
    s_min_u32 s24, s24, 1400
    s_min_u32 s44, s44, s24
    s_min_u32 s25, s25, 1400
    s_min_u32 s44, s44, s25
    s_min_u32 s26, s26, 1400
    s_min_u32 s44, s44, s26
    s_min_u32 s27, s27, 1400
    s_min_u32 s44, s44, s27
    s_min_u32 s28, s28, 1400
    s_min_u32 s44, s44, s28
    s_min_u32 s29, s29, 1400
    s_min_u32 s44, s44, s29
    s_min_u32 s30, s30, 1400
    s_min_u32 s44, s44, s30
    s_min_u32 s31, s31, 1400
    s_min_u32 s44, s44, s31
    s_cmp_lt_u32 s44, 290
    s_cbranch_scc1 L_skip
    s_sub_u32 s58, s58, s24
    s_add_u32 s58, s58, s25
    s_sub_u32 s58, s58, s26
    s_add_u32 s58, s58, s27
    s_sub_u32 s58, s58, s28
    s_add_u32 s58, s58, s29
    s_sub_u32 s58, s58, s30
    s_add_u32 s58, s58, s31
    s_cmp_eq_u32 s7, 0
    s_cbranch_scc1 L_skip
    s_min_u32 s48, s24, s26
    s_min_u32 s50, s28, s30
    s_min_u32 s48, s48, s50
    s_add_u32 s48, s48, 100
    s_min_u32 s49, s25, s27
    s_min_u32 s50, s29, s31
    s_min_u32 s49, s49, s50
    s_add_u32 s49, s49, 100
    s_min_u32 s24, s24, s48
    s_min_u32 s25, s25, s49
    s_min_u32 s26, s26, s48
    s_min_u32 s27, s27, s49
    s_min_u32 s28, s28, s48
    s_min_u32 s29, s29, s49
    s_min_u32 s30, s30, s48
    s_min_u32 s31, s31, s49
    s_sub_u32 s61, s61, s24
    s_sub_u32 s62, s62, s24
    s_sub_u32 s63, s63, s24
    s_add_u32 s61, s61, s25
    s_sub_u32 s62, s62, s25
    s_add_u32 s63, s63, s25
    s_add_u32 s61, s61, s26
    s_sub_u32 s62, s62, s26
    s_sub_u32 s63, s63, s26
    s_sub_u32 s61, s61, s27
    s_sub_u32 s62, s62, s27
    s_add_u32 s63, s63, s27
    s_sub_u32 s61, s61, s28
    s_add_u32 s62, s62, s28
    s_add_u32 s63, s63, s28
    s_add_u32 s61, s61, s29
    s_add_u32 s62, s62, s29
    s_sub_u32 s63, s63, s29
    s_add_u32 s61, s61, s30
    s_add_u32 s62, s62, s30
    s_add_u32 s63, s63, s30
    s_sub_u32 s61, s61, s31
    s_add_u32 s62, s62, s31
    s_sub_u32 s63, s63, s31
L_skip:
    s_nop 1
    s_add_u32 s46, s46, 1
    s_cmp_le_u32 s46, s47
    s_cbranch_scc1 L_round
    s_sub_u32 s48, 0, s58
    s_cmp_eq_u32 s21, 0
    s_cselect_b32 s58, s58, s48
    s_add_u32 s58, s58, 0x1010000
    v_mov_b32 v4, s58
    s_mov_b64 exec, 1
    s_lshl_b32 s48, s7, 2
    s_add_u32 s48, s48, 124
    s_cmp_eq_u32 s7, 0
    s_cbranch_scc0 L_post
    s_waitcnt vmcnt(0)
    ds_add_rtn_u32 v5, v2, v4 offset:36
    s_mov_b32 s48, 0
    s_waitcnt lgkmcnt(0)
    v_add_u32 v4, v4, v5
    v_cmp_ne_u32 vcc, 0, v5
    s_and_b64 exec, exec, vcc
    buffer_atomic_add v4, off, s[16:19], s48
    s_branch L_posted
L_post:
    s_nop 1
    s_mov_b32 s60, 0x100000
L_wvw:
    s_nop 1
    ds_read_b32 v10, v2 offset:0
    s_sub_u32 s60, s60, 1
    s_cbranch_scc1 L_exit1
    s_waitcnt lgkmcnt(0)
    v_readfirstlane_b32 s48, v10
    s_cmp_eq_u32 s48, 0
    s_cbranch_scc1 L_wvw
    s_lshr_b32 s48, s91, 1
    s_xor_b32 s48, s48, s21
    s_sub_u32 s49, 0, s61
    s_bitcmp1_b32 s48, 0
    s_cselect_b32 s61, s49, s61
    s_xor_b32 s48, s91, s21
    s_bitcmp1_b32 s4, 0
    s_cselect_b32 s48, s91, s48
    s_cselect_b32 s62, s62, s63
    s_sub_u32 s49, 0, s62
    s_bitcmp1_b32 s48, 0
    s_cselect_b32 s62, s49, s62
    s_add_u32 s61, s61, 0x1010000
    v_writelane_b32 v4, s61, 1
    s_add_u32 s62, s62, 0x1010000
    v_writelane_b32 v4, s62, 2
    s_lshl_b32 s48, s7, 2
    s_and_b32 s49, s4, 1
    s_or_b32 s48, s48, s49
    s_lshr_b32 s49, s4, 1
    s_and_b32 s49, s49, 2
    s_or_b32 s48, s48, s49
    s_mul_i32 s48, s48, 4352
    s_add_u32 s48, s48, 9485312
    s_mov_b64 exec, 7
    v_lshlrev_b32 v5, 2, v1
    buffer_atomic_add v4, v5, s[12:15], s48 offen
L_posted:
    s_nop 1
    s_mov_b64 exec, -1
L_role:
    s_nop 1
    s_cmp_eq_u32 s6, 0
    s_cbranch_scc1 L_h0
    s_cmp_eq_u32 s6, 2
    s_cbranch_scc1 L_h2
    v_lshlrev_b32 v5, 2, v1
    s_mov_b32 s60, 0x100000
L_wea:
    s_nop 1
    ds_read_b32 v10, v2 offset:56
    s_sub_u32 s60, s60, 1
    s_cbranch_scc1 L_exit1
    s_waitcnt lgkmcnt(0)
    v_readfirstlane_b32 s48, v10
    s_cmp_lt_u32 s48, 4
    s_cbranch_scc1 L_wea
    s_mov_b64 exec, 0x1
    s_mov_b32 s60, 0x40000
L_polla:
    s_nop 1
    buffer_load_dword v4, v5, s[16:19], 0 offen offset:0 sc1
    s_sub_u32 s60, s60, 1
    s_cbranch_scc1 L_exit1
L_pollwa:
    s_waitcnt vmcnt(0)
    v_lshrrev_b32 v6, 24, v4
    v_cmp_ne_u32 vcc, 48, v6
    s_cbranch_vccnz L_polla
    v_and_b32 v4, 0xffffff, v4
    v_subrev_u32 v4, 3145728, v4
    v_lshrrev_b32 v6, 30, v4
    v_and_b32 v6, 2, v6
    v_add_u32 v4, 4800, v4
    v_cmp_gt_u32 vcc, 9600, v4
    s_nop 1
    v_cndmask_b32 v6, v6, 8, vcc
    v_or_b32 v6, 16, v6
    ds_write_b32 v5, v6 offset:0
    s_mov_b64 exec, -1
    v_readfirstlane_b32 s44, v6
    s_mov_b32 s60, 0x100000
L_web:
    s_nop 1
    ds_read_b32 v10, v2 offset:60
    s_sub_u32 s60, s60, 1
    s_cbranch_scc1 L_exit1
    s_waitcnt lgkmcnt(0)
    v_readfirstlane_b32 s48, v10
    s_cmp_eq_u32 s48, 0
    s_cbranch_scc1 L_web
    v_mul_u32_u24 v7, 4352, v1
    s_mov_b32 s48, 9502720
    s_mov_b64 exec, 0xfffff
    s_mov_b32 s60, 0x40000
L_pollb:
    s_nop 1
    buffer_load_dwordx3 v[16:18], v7, s[12:15], s48 offen sc1
    s_sub_u32 s60, s60, 1
    s_cbranch_scc1 L_exit1
    s_waitcnt vmcnt(0)
    v_min3_u32 v6, v16, v17, v18
    v_lshrrev_b32 v6, 24, v6
    v_cmp_ne_u32 vcc, 10, v6
    s_cbranch_vccnz L_pollb
    v_subrev_u32 v16, 0xa0a0000, v16
    v_subrev_u32 v17, 0xa0a0000, v17
    v_subrev_u32 v18, 0xa0a0000, v18
    v_add_u32_dpp v16, v16, v16 quad_perm:[1,0,3,2] row_mask:0xf bank_mask:0xf
    v_add_u32_dpp v17, v17, v17 quad_perm:[1,0,3,2] row_mask:0xf bank_mask:0xf
    s_nop 0
    v_add_u32_dpp v16, v16, v16 quad_perm:[2,3,0,1] row_mask:0xf bank_mask:0xf
    v_add_u32_dpp v17, v17, v17 quad_perm:[2,3,0,1] row_mask:0xf bank_mask:0xf
    v_ashrrev_i32 v6, 31, v16
    v_xor_b32 v17, v17, v6
    v_xor_b32 v4, v18, v6
    s_mov_b64 vcc, 0x55555
    v_cndmask_b32 v18, v18, v4, vcc
    s_nop 1
    v_add_u32_dpp v18, v18, v18 quad_perm:[1,0,3,2] row_mask:0xf bank_mask:0xf
    s_nop 1
    v_add_u32_dpp v18, v18, v18 quad_perm:[2,3,0,1] row_mask:0xf bank_mask:0xf
    v_and_b32 v20, 2, v6
    v_or_b32 v4, 1, v20
    v_cmp_gt_i32 vcc, -2800, v17
    s_nop 1
    v_cndmask_b32 v20, v20, v4, vcc
    v_or_b32 v4, 4, v20
    v_cmp_gt_i32 vcc, -2800, v18
    s_nop 1
    v_cndmask_b32 v20, v20, v4, vcc
    v_add_u32 v4, 56000, v16
    v_cmp_gt_u32 vcc, 112000, v4
    s_nop 1
    v_cndmask_b32 v20, v20, 8, vcc
    v_and_b32 v20, 15, v20
    s_nop 0
    v_readlane_b32 s24, v20, 0
    v_readlane_b32 s25, v20, 4
    v_readlane_b32 s26, v20, 8
    v_readlane_b32 s27, v20, 12
    v_readlane_b32 s28, v20, 16
    s_xor_b32 s48, s44, s26
    s_and_b32 s48, s48, 15
    s_and_b32 s49, s48, 14
    s_cselect_b32 s48, 0, s48
    s_xor_b32 s49, s24, s48
    s_bitcmp1_b32 s24, 3
    s_cselect_b32 s24, s24, s49
    s_xor_b32 s49, s25, s48
    s_bitcmp1_b32 s25, 3
    s_cselect_b32 s25, s25, s49
    s_xor_b32 s49, s26, s48
    s_bitcmp1_b32 s26, 3
    s_cselect_b32 s26, s26, s49
    s_xor_b32 s49, s27, s48
    s_bitcmp1_b32 s27, 3
    s_cselect_b32 s27, s27, s49
    s_xor_b32 s49, s28, s48
    s_bitcmp1_b32 s28, 3
    s_cselect_b32 s28, s28, s49
    s_xor_b32 s48, s24, s27
    s_and_b32 s48, s48, 10
    s_cselect_b32 s24, s24, s27
    s_xor_b32 s48, s25, s28
    s_and_b32 s48, s48, 10
    s_cselect_b32 s25, s25, s28
    s_or_b32 s24, s24, 16
    v_writelane_b32 v6, s24, 0
    s_or_b32 s25, s25, 16
    v_writelane_b32 v6, s25, 1
    s_or_b32 s26, s26, 16
    v_writelane_b32 v6, s26, 2
    s_or_b32 s27, s27, 16
    v_writelane_b32 v6, s27, 3
    s_or_b32 s28, s28, 16
    v_writelane_b32 v6, s28, 4
    s_mov_b64 exec, 0x1f
    ds_write_b32 v5, v6 offset:4
    s_mov_b64 exec, -1
    s_and_b32 s48, s3, 7
    s_cmp_lg_u32 s48, s4
    s_cbranch_scc1 L_exit1
    s_mul_i32 s48, s3, 3
    s_add_u32 s48, s48, 2
    s_lshr_b32 s48, s48, 5
    s_lshl_b32 s48, s48, 2
    v_mov_b32 v3, s48
    s_mul_i32 s57, s3, 24
    v_add_u32 v13, s57, v1
    v_and_b32 v12, 255, v13
    v_mul_u32_u24 v12, 4352, v12
    v_lshlrev_b32 v13, 6, v13
    s_mov_b32 s49, 8388608
    s_mov_b32 s50, 917504
    v_mov_b32 v4, 0xf149f2ca
    v_mov_b32 v5, 0
    s_mov_b32 s51, 93
    s_cmp_eq_u32 s48, 4
    s_cselect_b32 s51, 117, s51
    s_cmp_eq_u32 s48, 8
    s_cselect_b32 s51, 81, s51
    s_mov_b32 s60, 0x100000
L_wcg:
    s_nop 1
    ds_read_b32 v10, v2 offset:128
    s_sub_u32 s60, s60, 1
    s_cbranch_scc1 L_exit1
    s_waitcnt lgkmcnt(0)
    v_readfirstlane_b32 s48, v10
    s_cmp_lt_u32 s48, s51
    s_cbranch_scc1 L_wcg
    s_mov_b64 exec, 0xffffff
    s_mov_b32 s60, 0x40000
L_cpf:
    s_nop 1
    buffer_load_dword v7, v12, s[12:15], s49 offen sc1
    s_sub_u32 s60, s60, 1
    s_cbranch_scc1 L_exit1
    s_waitcnt vmcnt(0)
    v_cmpx_eq_u32 vcc, 0, v7
    s_cbranch_execnz L_cpf
    s_mov_b64 exec, 0xffffff
    s_mov_b32 s60, 0x40000
L_cpm:
    s_nop 1
    buffer_load_dwordx4 v[4:7], v13, s[12:15], s50 offen sc1
    s_sub_u32 s60, s60, 1
    s_cbranch_scc1 L_exit1
    s_waitcnt vmcnt(0)
    v_cmpx_eq_u32 vcc, 0, v7
    s_cbranch_execnz L_cpm
    s_mov_b64 exec, -1
    v_mov_b32 v6, v4
    s_nop 1
    v_max_f32_dpp v6, v6, v6 row_ror:8 row_mask:0xf bank_mask:0xf
    s_nop 1
    v_max_f32_dpp v6, v6, v6 row_ror:4 row_mask:0xf bank_mask:0xf
    s_nop 1
    v_max_f32_dpp v6, v6, v6 row_ror:2 row_mask:0xf bank_mask:0xf
    s_nop 1
    v_max_f32_dpp v6, v6, v6 row_ror:1 row_mask:0xf bank_mask:0xf
    v_mov_b32 v7, v6
    s_nop 1
    v_permlane32_swap_b32 v6, v7
    v_max_f32 v6, v6, v7
    v_mov_b32 v7, v6
    s_nop 1
    v_permlane16_swap_b32 v6, v7
    v_max_f32 v6, v6, v7
    v_sub_f32 v4, v4, v6
    v_exp_f32 v4, v4
    s_nop 0
    v_mul_f32 v5, v5, v4
    s_nop 1
    v_add_f32_dpp v5, v5, v5 row_ror:8 row_mask:0xf bank_mask:0xf
    s_nop 1
    v_add_f32_dpp v5, v5, v5 row_ror:4 row_mask:0xf bank_mask:0xf
    s_nop 1
    v_add_f32_dpp v5, v5, v5 row_ror:2 row_mask:0xf bank_mask:0xf
    s_nop 1
    v_add_f32_dpp v5, v5, v5 row_ror:1 row_mask:0xf bank_mask:0xf
    v_mov_b32 v7, v5
    s_nop 1
    v_permlane32_swap_b32 v5, v7
    v_add_f32 v5, v5, v7
    v_mov_b32 v7, v5
    s_nop 1
    v_permlane16_swap_b32 v5, v7
    v_add_f32 v5, v5, v7
    v_rcp_f32 v5, v5
    s_nop 0
    v_mul_f32 v4, v4, v5
    s_cmp_lt_u32 s3, 21
    s_cbranch_scc1 L_cown
    s_mul_i32 s48, s3, 4352
    s_add_u32 s48, s48, 9498368
    v_lshlrev_b32 v12, 2, v1
    v_mov_b32 v5, 1
    s_mov_b64 exec, 0xffffff
    buffer_store_dword v4, v12, s[12:15], s48 offen offset:128 sc1
    s_mov_b64 exec, 1
    s_waitcnt vmcnt(0)
    buffer_store_dword v5, off, s[12:15], s48 offset:4 sc1
    s_endpgm
L_cown:
    s_nop 1
    v_readlane_b32 s24, v4, 0
    v_readlane_b32 s25, v4, 1
    v_readlane_b32 s26, v4, 2
    v_readlane_b32 s27, v4, 3
    v_readlane_b32 s28, v4, 4
    v_readlane_b32 s29, v4, 5
    v_readlane_b32 s30, v4, 6
    v_readlane_b32 s31, v4, 7
    v_readlane_b32 s32, v4, 8
    v_readlane_b32 s33, v4, 9
    v_readlane_b32 s34, v4, 10
    v_readlane_b32 s35, v4, 11
    v_readlane_b32 s36, v4, 12
    v_readlane_b32 s37, v4, 13
    v_readlane_b32 s38, v4, 14
    v_readlane_b32 s39, v4, 15
    v_readlane_b32 s40, v4, 16
    v_readlane_b32 s41, v4, 17
    v_readlane_b32 s42, v4, 18
    v_readlane_b32 s43, v4, 19
    v_readlane_b32 s44, v4, 20
    v_readlane_b32 s45, v4, 21
    v_readlane_b32 s46, v4, 22
    v_readlane_b32 s47, v4, 23
    s_mov_b32 s92, s78
    s_and_b32 s93, s79, 0xffff
    s_mov_b32 s94, 12288
    s_mov_b32 s95, 0x00020000
    s_lshl_b32 s57, s57, 10
    v_lshlrev_b32 v13, 4, v1
    v_add_u32 v13, s57, v13
    s_mov_b32 s49, 4096
    s_mov_b32 s50, 8192
    s_mov_b32 s51, 12288
    s_mov_b32 s52, 16384
    s_mov_b32 s53, 20480
    v_mov_b32 v4, 0
    v_mov_b32 v5, 0
    v_mov_b32 v6, 0
    s_mov_b32 s56, 0xffffff
    v_lshlrev_b32 v12, 1, v1
    s_mul_i32 s57, s3, 384
    s_mov_b32 s60, 0x100000
L_wcc:
    s_nop 1
    ds_read_b32 v10, v3 offset:64
    s_sub_u32 s60, s60, 1
    s_cbranch_scc1 L_exit1
    s_waitcnt lgkmcnt(0)
    v_readfirstlane_b32 s48, v10
    s_cmp_lt_u32 s48, 1
    s_cbranch_scc1 L_wcc
    s_mov_b32 s60, 0x40000
L_cr:
    s_nop 1
    s_bitcmp0_b32 s56, 0
    s_cbranch_scc1 L_cl0
    buffer_load_dwordx4 v[16:19], v13, s[12:15], 0 offen offset:0 sc1
L_cl0:
    s_bitcmp0_b32 s56, 1
    s_cbranch_scc1 L_cl1
    buffer_load_dwordx4 v[20:23], v13, s[12:15], 0 offen offset:1024 sc1
L_cl1:
    s_bitcmp0_b32 s56, 2
    s_cbranch_scc1 L_cl2
    buffer_load_dwordx4 v[24:27], v13, s[12:15], 0 offen offset:2048 sc1
L_cl2:
    s_bitcmp0_b32 s56, 3
    s_cbranch_scc1 L_cl3
    buffer_load_dwordx4 v[28:31], v13, s[12:15], 0 offen offset:3072 sc1
L_cl3:
    s_bitcmp0_b32 s56, 4
    s_cbranch_scc1 L_cl4
    buffer_load_dwordx4 v[32:35], v13, s[12:15], s49 offen offset:0 sc1
L_cl4:
    s_bitcmp0_b32 s56, 5
    s_cbranch_scc1 L_cl5
    buffer_load_dwordx4 v[36:39], v13, s[12:15], s49 offen offset:1024 sc1
L_cl5:
    s_bitcmp0_b32 s56, 6
    s_cbranch_scc1 L_cl6
    buffer_load_dwordx4 v[40:43], v13, s[12:15], s49 offen offset:2048 sc1
L_cl6:
    s_bitcmp0_b32 s56, 7
    s_cbranch_scc1 L_cl7
    buffer_load_dwordx4 v[44:47], v13, s[12:15], s49 offen offset:3072 sc1
L_cl7:
    s_bitcmp0_b32 s56, 8
    s_cbranch_scc1 L_cl8
    buffer_load_dwordx4 v[48:51], v13, s[12:15], s50 offen offset:0 sc1
L_cl8:
    s_bitcmp0_b32 s56, 9
    s_cbranch_scc1 L_cl9
    buffer_load_dwordx4 v[52:55], v13, s[12:15], s50 offen offset:1024 sc1
L_cl9:
    s_bitcmp0_b32 s56, 10
    s_cbranch_scc1 L_cl10
    buffer_load_dwordx4 v[56:59], v13, s[12:15], s50 offen offset:2048 sc1
L_cl10:
    s_bitcmp0_b32 s56, 11
    s_cbranch_scc1 L_cl11
    buffer_load_dwordx4 v[60:63], v13, s[12:15], s50 offen offset:3072 sc1
L_cl11:
    s_bitcmp0_b32 s56, 12
    s_cbranch_scc1 L_cl12
    buffer_load_dwordx4 v[64:67], v13, s[12:15], s51 offen offset:0 sc1
L_cl12:
    s_bitcmp0_b32 s56, 13
    s_cbranch_scc1 L_cl13
    buffer_load_dwordx4 v[68:71], v13, s[12:15], s51 offen offset:1024 sc1
L_cl13:
    s_bitcmp0_b32 s56, 14
    s_cbranch_scc1 L_cl14
    buffer_load_dwordx4 v[72:75], v13, s[12:15], s51 offen offset:2048 sc1
L_cl14:
    s_bitcmp0_b32 s56, 15
    s_cbranch_scc1 L_cl15
    buffer_load_dwordx4 v[76:79], v13, s[12:15], s51 offen offset:3072 sc1
L_cl15:
    s_bitcmp0_b32 s56, 16
    s_cbranch_scc1 L_cl16
    buffer_load_dwordx4 v[80:83], v13, s[12:15], s52 offen offset:0 sc1
L_cl16:
    s_bitcmp0_b32 s56, 17
    s_cbranch_scc1 L_cl17
    buffer_load_dwordx4 v[84:87], v13, s[12:15], s52 offen offset:1024 sc1
L_cl17:
    s_bitcmp0_b32 s56, 18
    s_cbranch_scc1 L_cl18
    buffer_load_dwordx4 v[88:91], v13, s[12:15], s52 offen offset:2048 sc1
L_cl18:
    s_bitcmp0_b32 s56, 19
    s_cbranch_scc1 L_cl19
    buffer_load_dwordx4 v[92:95], v13, s[12:15], s52 offen offset:3072 sc1
L_cl19:
    s_bitcmp0_b32 s56, 20
    s_cbranch_scc1 L_cl20
    buffer_load_dwordx4 v[96:99], v13, s[12:15], s53 offen offset:0 sc1
L_cl20:
    s_bitcmp0_b32 s56, 21
    s_cbranch_scc1 L_cl21
    buffer_load_dwordx4 v[100:103], v13, s[12:15], s53 offen offset:1024 sc1
L_cl21:
    s_bitcmp0_b32 s56, 22
    s_cbranch_scc1 L_cl22
    buffer_load_dwordx4 v[104:107], v13, s[12:15], s53 offen offset:2048 sc1
L_cl22:
    s_bitcmp0_b32 s56, 23
    s_cbranch_scc1 L_cl23
    buffer_load_dwordx4 v[108:111], v13, s[12:15], s53 offen offset:3072 sc1
L_cl23:
    s_sub_u32 s60, s60, 1
    s_cbranch_scc1 L_exit1
    s_waitcnt vmcnt(0)
    s_bitcmp0_b32 s56, 0
    s_cbranch_scc1 L_cv0
    v_cmp_eq_u32 vcc, 0, v19
    s_cbranch_vccnz L_cv0
    v_fmac_f32 v4, s24, v16
    v_fmac_f32 v5, s24, v17
    v_fmac_f32 v6, s24, v18
    s_bitset0_b32 s56, 0
L_cv0:
    s_bitcmp0_b32 s56, 1
    s_cbranch_scc1 L_cv1
    v_cmp_eq_u32 vcc, 0, v23
    s_cbranch_vccnz L_cv1
    v_fmac_f32 v4, s25, v20
    v_fmac_f32 v5, s25, v21
    v_fmac_f32 v6, s25, v22
    s_bitset0_b32 s56, 1
L_cv1:
    s_bitcmp0_b32 s56, 2
    s_cbranch_scc1 L_cv2
    v_cmp_eq_u32 vcc, 0, v27
    s_cbranch_vccnz L_cv2
    v_fmac_f32 v4, s26, v24
    v_fmac_f32 v5, s26, v25
    v_fmac_f32 v6, s26, v26
    s_bitset0_b32 s56, 2
L_cv2:
    s_bitcmp0_b32 s56, 3
    s_cbranch_scc1 L_cv3
    v_cmp_eq_u32 vcc, 0, v31
    s_cbranch_vccnz L_cv3
    v_fmac_f32 v4, s27, v28
    v_fmac_f32 v5, s27, v29
    v_fmac_f32 v6, s27, v30
    s_bitset0_b32 s56, 3
L_cv3:
    s_bitcmp0_b32 s56, 4
    s_cbranch_scc1 L_cv4
    v_cmp_eq_u32 vcc, 0, v35
    s_cbranch_vccnz L_cv4
    v_fmac_f32 v4, s28, v32
    v_fmac_f32 v5, s28, v33
    v_fmac_f32 v6, s28, v34
    s_bitset0_b32 s56, 4
L_cv4:
    s_bitcmp0_b32 s56, 5
    s_cbranch_scc1 L_cv5
    v_cmp_eq_u32 vcc, 0, v39
    s_cbranch_vccnz L_cv5
    v_fmac_f32 v4, s29, v36
    v_fmac_f32 v5, s29, v37
    v_fmac_f32 v6, s29, v38
    s_bitset0_b32 s56, 5
L_cv5:
    s_bitcmp0_b32 s56, 6
    s_cbranch_scc1 L_cv6
    v_cmp_eq_u32 vcc, 0, v43
    s_cbranch_vccnz L_cv6
    v_fmac_f32 v4, s30, v40
    v_fmac_f32 v5, s30, v41
    v_fmac_f32 v6, s30, v42
    s_bitset0_b32 s56, 6
L_cv6:
    s_bitcmp0_b32 s56, 7
    s_cbranch_scc1 L_cv7
    v_cmp_eq_u32 vcc, 0, v47
    s_cbranch_vccnz L_cv7
    v_fmac_f32 v4, s31, v44
    v_fmac_f32 v5, s31, v45
    v_fmac_f32 v6, s31, v46
    s_bitset0_b32 s56, 7
L_cv7:
    s_bitcmp0_b32 s56, 8
    s_cbranch_scc1 L_cv8
    v_cmp_eq_u32 vcc, 0, v51
    s_cbranch_vccnz L_cv8
    v_fmac_f32 v4, s32, v48
    v_fmac_f32 v5, s32, v49
    v_fmac_f32 v6, s32, v50
    s_bitset0_b32 s56, 8
L_cv8:
    s_bitcmp0_b32 s56, 9
    s_cbranch_scc1 L_cv9
    v_cmp_eq_u32 vcc, 0, v55
    s_cbranch_vccnz L_cv9
    v_fmac_f32 v4, s33, v52
    v_fmac_f32 v5, s33, v53
    v_fmac_f32 v6, s33, v54
    s_bitset0_b32 s56, 9
L_cv9:
    s_bitcmp0_b32 s56, 10
    s_cbranch_scc1 L_cv10
    v_cmp_eq_u32 vcc, 0, v59
    s_cbranch_vccnz L_cv10
    v_fmac_f32 v4, s34, v56
    v_fmac_f32 v5, s34, v57
    v_fmac_f32 v6, s34, v58
    s_bitset0_b32 s56, 10
L_cv10:
    s_bitcmp0_b32 s56, 11
    s_cbranch_scc1 L_cv11
    v_cmp_eq_u32 vcc, 0, v63
    s_cbranch_vccnz L_cv11
    v_fmac_f32 v4, s35, v60
    v_fmac_f32 v5, s35, v61
    v_fmac_f32 v6, s35, v62
    s_bitset0_b32 s56, 11
L_cv11:
    s_bitcmp0_b32 s56, 12
    s_cbranch_scc1 L_cv12
    v_cmp_eq_u32 vcc, 0, v67
    s_cbranch_vccnz L_cv12
    v_fmac_f32 v4, s36, v64
    v_fmac_f32 v5, s36, v65
    v_fmac_f32 v6, s36, v66
    s_bitset0_b32 s56, 12
L_cv12:
    s_bitcmp0_b32 s56, 13
    s_cbranch_scc1 L_cv13
    v_cmp_eq_u32 vcc, 0, v71
    s_cbranch_vccnz L_cv13
    v_fmac_f32 v4, s37, v68
    v_fmac_f32 v5, s37, v69
    v_fmac_f32 v6, s37, v70
    s_bitset0_b32 s56, 13
L_cv13:
    s_bitcmp0_b32 s56, 14
    s_cbranch_scc1 L_cv14
    v_cmp_eq_u32 vcc, 0, v75
    s_cbranch_vccnz L_cv14
    v_fmac_f32 v4, s38, v72
    v_fmac_f32 v5, s38, v73
    v_fmac_f32 v6, s38, v74
    s_bitset0_b32 s56, 14
L_cv14:
    s_bitcmp0_b32 s56, 15
    s_cbranch_scc1 L_cv15
    v_cmp_eq_u32 vcc, 0, v79
    s_cbranch_vccnz L_cv15
    v_fmac_f32 v4, s39, v76
    v_fmac_f32 v5, s39, v77
    v_fmac_f32 v6, s39, v78
    s_bitset0_b32 s56, 15
L_cv15:
    s_bitcmp0_b32 s56, 16
    s_cbranch_scc1 L_cv16
    v_cmp_eq_u32 vcc, 0, v83
    s_cbranch_vccnz L_cv16
    v_fmac_f32 v4, s40, v80
    v_fmac_f32 v5, s40, v81
    v_fmac_f32 v6, s40, v82
    s_bitset0_b32 s56, 16
L_cv16:
    s_bitcmp0_b32 s56, 17
    s_cbranch_scc1 L_cv17
    v_cmp_eq_u32 vcc, 0, v87
    s_cbranch_vccnz L_cv17
    v_fmac_f32 v4, s41, v84
    v_fmac_f32 v5, s41, v85
    v_fmac_f32 v6, s41, v86
    s_bitset0_b32 s56, 17
L_cv17:
    s_bitcmp0_b32 s56, 18
    s_cbranch_scc1 L_cv18
    v_cmp_eq_u32 vcc, 0, v91
    s_cbranch_vccnz L_cv18
    v_fmac_f32 v4, s42, v88
    v_fmac_f32 v5, s42, v89
    v_fmac_f32 v6, s42, v90
    s_bitset0_b32 s56, 18
L_cv18:
    s_bitcmp0_b32 s56, 19
    s_cbranch_scc1 L_cv19
    v_cmp_eq_u32 vcc, 0, v95
    s_cbranch_vccnz L_cv19
    v_fmac_f32 v4, s43, v92
    v_fmac_f32 v5, s43, v93
    v_fmac_f32 v6, s43, v94
    s_bitset0_b32 s56, 19
L_cv19:
    s_bitcmp0_b32 s56, 20
    s_cbranch_scc1 L_cv20
    v_cmp_eq_u32 vcc, 0, v99
    s_cbranch_vccnz L_cv20
    v_fmac_f32 v4, s44, v96
    v_fmac_f32 v5, s44, v97
    v_fmac_f32 v6, s44, v98
    s_bitset0_b32 s56, 20
L_cv20:
    s_bitcmp0_b32 s56, 21
    s_cbranch_scc1 L_cv21
    v_cmp_eq_u32 vcc, 0, v103
    s_cbranch_vccnz L_cv21
    v_fmac_f32 v4, s45, v100
    v_fmac_f32 v5, s45, v101
    v_fmac_f32 v6, s45, v102
    s_bitset0_b32 s56, 21
L_cv21:
    s_bitcmp0_b32 s56, 22
    s_cbranch_scc1 L_cv22
    v_cmp_eq_u32 vcc, 0, v107
    s_cbranch_vccnz L_cv22
    v_fmac_f32 v4, s46, v104
    v_fmac_f32 v5, s46, v105
    v_fmac_f32 v6, s46, v106
    s_bitset0_b32 s56, 22
L_cv22:
    s_bitcmp0_b32 s56, 23
    s_cbranch_scc1 L_cv23
    v_cmp_eq_u32 vcc, 0, v111
    s_cbranch_vccnz L_cv23
    v_fmac_f32 v4, s47, v108
    v_fmac_f32 v5, s47, v109
    v_fmac_f32 v6, s47, v110
    s_bitset0_b32 s56, 23
L_cv23:
    s_cmp_lg_u32 s56, 0
    s_cbranch_scc1 L_cr
    v_cvt_pk_bf16_f32 v4, v4, v4
    buffer_store_short v4, v12, s[92:95], s57 offen offset:0
    v_cvt_pk_bf16_f32 v5, v5, v5
    buffer_store_short v5, v12, s[92:95], s57 offen offset:128
    v_cvt_pk_bf16_f32 v6, v6, v6
    buffer_store_short v6, v12, s[92:95], s57 offen offset:256
    s_endpgm
L_h0:
    s_nop 1
    s_mov_b32 s8, s64
    s_and_b32 s9, s65, 0xffff
    s_mov_b32 s10, 12288
    s_mov_b32 s11, 0x00020000
    s_mov_b32 s92, s70
    s_and_b32 s93, s71, 0xffff
    s_mov_b32 s94, 6291456
    s_mov_b32 s95, 0x00020000
    s_mov_b32 s96, s72
    s_and_b32 s97, s73, 0xffff
    s_mov_b32 s98, 6291456
    s_mov_b32 s99, 0x00020000
    v_lshrrev_b32 v4, 4, v1
    v_and_b32 v5, 15, v1
    v_lshlrev_b32 v6, 3, v5
    v_mul_u32_u24 v7, 384, v4
    v_add_u32 v7, v7, v6
    v_lshl_add_u32 v13, v5, 2, v4
    v_lshlrev_b32 v13, 2, v13
    v_lshlrev_b32 v4, 4, v1
    s_mul_i32 s32, s5, 4352
    s_add_u32 s32, s32, s59
    s_lshl_b32 s33, s3, 3
    s_add_u32 s33, s33, s5
    v_and_b32 v14, 7, v1
    v_lshrrev_b32 v10, 3, v1
    v_mul_u32_u24 v8, 24, v10
    v_mov_b32 v11, 768
    v_mad_u32_u24 v8, v14, v11, v8
    v_lshlrev_b32 v14, 7, v14
    v_lshl_add_u32 v14, v10, 4, v14
    s_mul_i32 s33, s33, 4096
    s_add_u32 s33, s33, 2097152
    v_mov_b32 v16, 0
    v_mov_b32 v17, 0
    v_mov_b32 v18, 0
    v_mov_b32 v19, 0
    s_add_u32 s48, s2, 0
    s_lshl_b32 s49, s48, 10
    s_lshl_b32 s48, s48, 6
    s_add_u32 s48, s48, 917504
    buffer_store_dwordx4 v[16:19], v4, s[12:15], s49 offen sc1
    s_mov_b64 exec, 15
    buffer_store_dwordx4 v[16:19], v4, s[12:15], s48 offen sc1
    s_mov_b64 exec, -1
    s_add_u32 s48, s2, 256
    s_lshl_b32 s49, s48, 10
    s_lshl_b32 s48, s48, 6
    s_add_u32 s48, s48, 917504
    buffer_store_dwordx4 v[16:19], v4, s[12:15], s49 offen sc1
    s_mov_b64 exec, 15
    buffer_store_dwordx4 v[16:19], v4, s[12:15], s48 offen sc1
    s_mov_b64 exec, -1
    s_add_u32 s48, s2, 512
    s_lshl_b32 s49, s48, 10
    s_lshl_b32 s48, s48, 6
    s_add_u32 s48, s48, 917504
    buffer_store_dwordx4 v[16:19], v4, s[12:15], s49 offen sc1
    s_mov_b64 exec, 15
    buffer_store_dwordx4 v[16:19], v4, s[12:15], s48 offen sc1
    s_mov_b64 exec, -1
    s_mov_b32 s61, 0
    s_lshl_b32 s62, s61, 5
    s_add_u32 s62, s62, s3
    s_lshl_b32 s63, s62, 15
    s_add_u32 s63, s63, 1
    s_mul_hi_u32 s63, s63, 0xaaaaaaab
    s_lshr_b32 s63, s63, 7
    s_mul_i32 s48, s62, 171
    s_lshr_b32 s48, s48, 9
    s_mul_i32 s48, s48, 384
    s_mul_i32 s49, s4, 24
    s_add_u32 s50, s49, s63
    s_mul_i32 s50, s50, 384
    v_add_u32 v10, s50, v7
    v_add_u32 v11, 3072, v10
    v_add_u32 v12, 6144, v10
    buffer_load_dwordx2 v[100:101], v6, s[8:11], s48 offen offset:0
    buffer_load_dwordx2 v[102:103], v6, s[8:11], s48 offen offset:128
    buffer_load_dwordx2 v[104:105], v6, s[8:11], s48 offen offset:256
    buffer_load_dwordx2 v[28:29], v10, s[92:95], 0 offen offset:0
    buffer_load_dwordx2 v[30:31], v10, s[92:95], 0 offen offset:128
    buffer_load_dwordx2 v[32:33], v10, s[92:95], 0 offen offset:256
    buffer_load_dwordx2 v[64:65], v10, s[96:99], 0 offen offset:0
    buffer_load_dwordx2 v[66:67], v10, s[96:99], 0 offen offset:128
    buffer_load_dwordx2 v[68:69], v10, s[96:99], 0 offen offset:256
    buffer_load_dwordx2 v[34:35], v10, s[92:95], 0 offen offset:1536
    buffer_load_dwordx2 v[36:37], v10, s[92:95], 0 offen offset:1664
    buffer_load_dwordx2 v[38:39], v10, s[92:95], 0 offen offset:1792
    buffer_load_dwordx2 v[70:71], v10, s[96:99], 0 offen offset:1536
    buffer_load_dwordx2 v[72:73], v10, s[96:99], 0 offen offset:1664
    buffer_load_dwordx2 v[74:75], v10, s[96:99], 0 offen offset:1792
    buffer_load_dwordx2 v[40:41], v11, s[92:95], 0 offen offset:0
    buffer_load_dwordx2 v[42:43], v11, s[92:95], 0 offen offset:128
    buffer_load_dwordx2 v[44:45], v11, s[92:95], 0 offen offset:256
    buffer_load_dwordx2 v[76:77], v11, s[96:99], 0 offen offset:0
    buffer_load_dwordx2 v[78:79], v11, s[96:99], 0 offen offset:128
    buffer_load_dwordx2 v[80:81], v11, s[96:99], 0 offen offset:256
    buffer_load_dwordx2 v[46:47], v11, s[92:95], 0 offen offset:1536
    buffer_load_dwordx2 v[48:49], v11, s[92:95], 0 offen offset:1664
    buffer_load_dwordx2 v[50:51], v11, s[92:95], 0 offen offset:1792
    buffer_load_dwordx2 v[82:83], v11, s[96:99], 0 offen offset:1536
    buffer_load_dwordx2 v[84:85], v11, s[96:99], 0 offen offset:1664
    buffer_load_dwordx2 v[86:87], v11, s[96:99], 0 offen offset:1792
    buffer_load_dwordx2 v[52:53], v12, s[92:95], 0 offen offset:0
    buffer_load_dwordx2 v[54:55], v12, s[92:95], 0 offen offset:128
    buffer_load_dwordx2 v[56:57], v12, s[92:95], 0 offen offset:256
    buffer_load_dwordx2 v[88:89], v12, s[96:99], 0 offen offset:0
    buffer_load_dwordx2 v[90:91], v12, s[96:99], 0 offen offset:128
    buffer_load_dwordx2 v[92:93], v12, s[96:99], 0 offen offset:256
    buffer_load_dwordx2 v[58:59], v12, s[92:95], 0 offen offset:1536
    buffer_load_dwordx2 v[60:61], v12, s[92:95], 0 offen offset:1664
    buffer_load_dwordx2 v[62:63], v12, s[92:95], 0 offen offset:1792
    buffer_load_dwordx2 v[94:95], v12, s[96:99], 0 offen offset:1536
    buffer_load_dwordx2 v[96:97], v12, s[96:99], 0 offen offset:1664
    buffer_load_dwordx2 v[98:99], v12, s[96:99], 0 offen offset:1792
    s_waitcnt vmcnt(0)
    v_lshlrev_b32 v16, 16, v100
    v_and_b32 v17, 0xffff0000, v100
    v_lshlrev_b32 v18, 16, v101
    v_and_b32 v19, 0xffff0000, v101
    v_lshlrev_b32 v20, 16, v102
    v_and_b32 v21, 0xffff0000, v102
    v_lshlrev_b32 v22, 16, v103
    v_and_b32 v23, 0xffff0000, v103
    v_lshlrev_b32 v24, 16, v104
    v_and_b32 v25, 0xffff0000, v104
    v_lshlrev_b32 v26, 16, v105
    v_and_b32 v27, 0xffff0000, v105
    v_lshlrev_b32 v10, 16, v28
    v_lshlrev_b32 v11, 16, v64
    v_and_b32 v28, 0xffff0000, v28
    v_and_b32 v64, 0xffff0000, v64
    v_mul_f32 v10, v10, v16
    v_mul_f32 v28, v28, v17
    v_mul_f32 v100, v10, v11
    v_fmac_f32 v100, v28, v64
    v_lshlrev_b32 v10, 16, v29
    v_lshlrev_b32 v11, 16, v65
    v_and_b32 v29, 0xffff0000, v29
    v_and_b32 v65, 0xffff0000, v65
    v_mul_f32 v10, v10, v18
    v_mul_f32 v29, v29, v19
    v_fmac_f32 v100, v10, v11
    v_fmac_f32 v100, v29, v65
    v_lshlrev_b32 v10, 16, v30
    v_lshlrev_b32 v11, 16, v66
    v_and_b32 v30, 0xffff0000, v30
    v_and_b32 v66, 0xffff0000, v66
    v_mul_f32 v10, v10, v20
    v_mul_f32 v30, v30, v21
    v_fmac_f32 v100, v10, v11
    v_fmac_f32 v100, v30, v66
    v_lshlrev_b32 v10, 16, v31
    v_lshlrev_b32 v11, 16, v67
    v_and_b32 v31, 0xffff0000, v31
    v_and_b32 v67, 0xffff0000, v67
    v_mul_f32 v10, v10, v22
    v_mul_f32 v31, v31, v23
    v_fmac_f32 v100, v10, v11
    v_fmac_f32 v100, v31, v67
    v_lshlrev_b32 v10, 16, v32
    v_lshlrev_b32 v11, 16, v68
    v_and_b32 v32, 0xffff0000, v32
    v_and_b32 v68, 0xffff0000, v68
    v_mul_f32 v10, v10, v24
    v_mul_f32 v32, v32, v25
    v_fmac_f32 v100, v10, v11
    v_fmac_f32 v100, v32, v68
    v_lshlrev_b32 v10, 16, v33
    v_lshlrev_b32 v11, 16, v69
    v_and_b32 v33, 0xffff0000, v33
    v_and_b32 v69, 0xffff0000, v69
    v_mul_f32 v10, v10, v26
    v_mul_f32 v33, v33, v27
    v_fmac_f32 v100, v10, v11
    v_fmac_f32 v100, v33, v69
    v_lshlrev_b32 v10, 16, v34
    v_lshlrev_b32 v11, 16, v70
    v_and_b32 v34, 0xffff0000, v34
    v_and_b32 v70, 0xffff0000, v70
    v_mul_f32 v10, v10, v16
    v_mul_f32 v34, v34, v17
    v_mul_f32 v101, v10, v11
    v_fmac_f32 v101, v34, v70
    v_lshlrev_b32 v10, 16, v35
    v_lshlrev_b32 v11, 16, v71
    v_and_b32 v35, 0xffff0000, v35
    v_and_b32 v71, 0xffff0000, v71
    v_mul_f32 v10, v10, v18
    v_mul_f32 v35, v35, v19
    v_fmac_f32 v101, v10, v11
    v_fmac_f32 v101, v35, v71
    v_lshlrev_b32 v10, 16, v36
    v_lshlrev_b32 v11, 16, v72
    v_and_b32 v36, 0xffff0000, v36
    v_and_b32 v72, 0xffff0000, v72
    v_mul_f32 v10, v10, v20
    v_mul_f32 v36, v36, v21
    v_fmac_f32 v101, v10, v11
    v_fmac_f32 v101, v36, v72
    v_lshlrev_b32 v10, 16, v37
    v_lshlrev_b32 v11, 16, v73
    v_and_b32 v37, 0xffff0000, v37
    v_and_b32 v73, 0xffff0000, v73
    v_mul_f32 v10, v10, v22
    v_mul_f32 v37, v37, v23
    v_fmac_f32 v101, v10, v11
    v_fmac_f32 v101, v37, v73
    v_lshlrev_b32 v10, 16, v38
    v_lshlrev_b32 v11, 16, v74
    v_and_b32 v38, 0xffff0000, v38
    v_and_b32 v74, 0xffff0000, v74
    v_mul_f32 v10, v10, v24
    v_mul_f32 v38, v38, v25
    v_fmac_f32 v101, v10, v11
    v_fmac_f32 v101, v38, v74
    v_lshlrev_b32 v10, 16, v39
    v_lshlrev_b32 v11, 16, v75
    v_and_b32 v39, 0xffff0000, v39
    v_and_b32 v75, 0xffff0000, v75
    v_mul_f32 v10, v10, v26
    v_mul_f32 v39, v39, v27
    v_fmac_f32 v101, v10, v11
    v_fmac_f32 v101, v39, v75
    v_lshlrev_b32 v10, 16, v40
    v_lshlrev_b32 v11, 16, v76
    v_and_b32 v40, 0xffff0000, v40
    v_and_b32 v76, 0xffff0000, v76
    v_mul_f32 v10, v10, v16
    v_mul_f32 v40, v40, v17
    v_mul_f32 v102, v10, v11
    v_fmac_f32 v102, v40, v76
    v_lshlrev_b32 v10, 16, v41
    v_lshlrev_b32 v11, 16, v77
    v_and_b32 v41, 0xffff0000, v41
    v_and_b32 v77, 0xffff0000, v77
    v_mul_f32 v10, v10, v18
    v_mul_f32 v41, v41, v19
    v_fmac_f32 v102, v10, v11
    v_fmac_f32 v102, v41, v77
    v_lshlrev_b32 v10, 16, v42
    v_lshlrev_b32 v11, 16, v78
    v_and_b32 v42, 0xffff0000, v42
    v_and_b32 v78, 0xffff0000, v78
    v_mul_f32 v10, v10, v20
    v_mul_f32 v42, v42, v21
    v_fmac_f32 v102, v10, v11
    v_fmac_f32 v102, v42, v78
    v_lshlrev_b32 v10, 16, v43
    v_lshlrev_b32 v11, 16, v79
    v_and_b32 v43, 0xffff0000, v43
    v_and_b32 v79, 0xffff0000, v79
    v_mul_f32 v10, v10, v22
    v_mul_f32 v43, v43, v23
    v_fmac_f32 v102, v10, v11
    v_fmac_f32 v102, v43, v79
    v_lshlrev_b32 v10, 16, v44
    v_lshlrev_b32 v11, 16, v80
    v_and_b32 v44, 0xffff0000, v44
    v_and_b32 v80, 0xffff0000, v80
    v_mul_f32 v10, v10, v24
    v_mul_f32 v44, v44, v25
    v_fmac_f32 v102, v10, v11
    v_fmac_f32 v102, v44, v80
    v_lshlrev_b32 v10, 16, v45
    v_lshlrev_b32 v11, 16, v81
    v_and_b32 v45, 0xffff0000, v45
    v_and_b32 v81, 0xffff0000, v81
    v_mul_f32 v10, v10, v26
    v_mul_f32 v45, v45, v27
    v_fmac_f32 v102, v10, v11
    v_fmac_f32 v102, v45, v81
    v_lshlrev_b32 v10, 16, v46
    v_lshlrev_b32 v11, 16, v82
    v_and_b32 v46, 0xffff0000, v46
    v_and_b32 v82, 0xffff0000, v82
    v_mul_f32 v10, v10, v16
    v_mul_f32 v46, v46, v17
    v_mul_f32 v103, v10, v11
    v_fmac_f32 v103, v46, v82
    v_lshlrev_b32 v10, 16, v47
    v_lshlrev_b32 v11, 16, v83
    v_and_b32 v47, 0xffff0000, v47
    v_and_b32 v83, 0xffff0000, v83
    v_mul_f32 v10, v10, v18
    v_mul_f32 v47, v47, v19
    v_fmac_f32 v103, v10, v11
    v_fmac_f32 v103, v47, v83
    v_lshlrev_b32 v10, 16, v48
    v_lshlrev_b32 v11, 16, v84
    v_and_b32 v48, 0xffff0000, v48
    v_and_b32 v84, 0xffff0000, v84
    v_mul_f32 v10, v10, v20
    v_mul_f32 v48, v48, v21
    v_fmac_f32 v103, v10, v11
    v_fmac_f32 v103, v48, v84
    v_lshlrev_b32 v10, 16, v49
    v_lshlrev_b32 v11, 16, v85
    v_and_b32 v49, 0xffff0000, v49
    v_and_b32 v85, 0xffff0000, v85
    v_mul_f32 v10, v10, v22
    v_mul_f32 v49, v49, v23
    v_fmac_f32 v103, v10, v11
    v_fmac_f32 v103, v49, v85
    v_lshlrev_b32 v10, 16, v50
    v_lshlrev_b32 v11, 16, v86
    v_and_b32 v50, 0xffff0000, v50
    v_and_b32 v86, 0xffff0000, v86
    v_mul_f32 v10, v10, v24
    v_mul_f32 v50, v50, v25
    v_fmac_f32 v103, v10, v11
    v_fmac_f32 v103, v50, v86
    v_lshlrev_b32 v10, 16, v51
    v_lshlrev_b32 v11, 16, v87
    v_and_b32 v51, 0xffff0000, v51
    v_and_b32 v87, 0xffff0000, v87
    v_mul_f32 v10, v10, v26
    v_mul_f32 v51, v51, v27
    v_fmac_f32 v103, v10, v11
    v_fmac_f32 v103, v51, v87
    v_lshlrev_b32 v10, 16, v52
    v_lshlrev_b32 v11, 16, v88
    v_and_b32 v52, 0xffff0000, v52
    v_and_b32 v88, 0xffff0000, v88
    v_mul_f32 v10, v10, v16
    v_mul_f32 v52, v52, v17
    v_mul_f32 v104, v10, v11
    v_fmac_f32 v104, v52, v88
    v_lshlrev_b32 v10, 16, v53
    v_lshlrev_b32 v11, 16, v89
    v_and_b32 v53, 0xffff0000, v53
    v_and_b32 v89, 0xffff0000, v89
    v_mul_f32 v10, v10, v18
    v_mul_f32 v53, v53, v19
    v_fmac_f32 v104, v10, v11
    v_fmac_f32 v104, v53, v89
    v_lshlrev_b32 v10, 16, v54
    v_lshlrev_b32 v11, 16, v90
    v_and_b32 v54, 0xffff0000, v54
    v_and_b32 v90, 0xffff0000, v90
    v_mul_f32 v10, v10, v20
    v_mul_f32 v54, v54, v21
    v_fmac_f32 v104, v10, v11
    v_fmac_f32 v104, v54, v90
    v_lshlrev_b32 v10, 16, v55
    v_lshlrev_b32 v11, 16, v91
    v_and_b32 v55, 0xffff0000, v55
    v_and_b32 v91, 0xffff0000, v91
    v_mul_f32 v10, v10, v22
    v_mul_f32 v55, v55, v23
    v_fmac_f32 v104, v10, v11
    v_fmac_f32 v104, v55, v91
    v_lshlrev_b32 v10, 16, v56
    v_lshlrev_b32 v11, 16, v92
    v_and_b32 v56, 0xffff0000, v56
    v_and_b32 v92, 0xffff0000, v92
    v_mul_f32 v10, v10, v24
    v_mul_f32 v56, v56, v25
    v_fmac_f32 v104, v10, v11
    v_fmac_f32 v104, v56, v92
    v_lshlrev_b32 v10, 16, v57
    v_lshlrev_b32 v11, 16, v93
    v_and_b32 v57, 0xffff0000, v57
    v_and_b32 v93, 0xffff0000, v93
    v_mul_f32 v10, v10, v26
    v_mul_f32 v57, v57, v27
    v_fmac_f32 v104, v10, v11
    v_fmac_f32 v104, v57, v93
    v_lshlrev_b32 v10, 16, v58
    v_lshlrev_b32 v11, 16, v94
    v_and_b32 v58, 0xffff0000, v58
    v_and_b32 v94, 0xffff0000, v94
    v_mul_f32 v10, v10, v16
    v_mul_f32 v58, v58, v17
    v_mul_f32 v105, v10, v11
    v_fmac_f32 v105, v58, v94
    v_lshlrev_b32 v10, 16, v59
    v_lshlrev_b32 v11, 16, v95
    v_and_b32 v59, 0xffff0000, v59
    v_and_b32 v95, 0xffff0000, v95
    v_mul_f32 v10, v10, v18
    v_mul_f32 v59, v59, v19
    v_fmac_f32 v105, v10, v11
    v_fmac_f32 v105, v59, v95
    v_lshlrev_b32 v10, 16, v60
    v_lshlrev_b32 v11, 16, v96
    v_and_b32 v60, 0xffff0000, v60
    v_and_b32 v96, 0xffff0000, v96
    v_mul_f32 v10, v10, v20
    v_mul_f32 v60, v60, v21
    v_fmac_f32 v105, v10, v11
    v_fmac_f32 v105, v60, v96
    v_lshlrev_b32 v10, 16, v61
    v_lshlrev_b32 v11, 16, v97
    v_and_b32 v61, 0xffff0000, v61
    v_and_b32 v97, 0xffff0000, v97
    v_mul_f32 v10, v10, v22
    v_mul_f32 v61, v61, v23
    v_fmac_f32 v105, v10, v11
    v_fmac_f32 v105, v61, v97
    v_lshlrev_b32 v10, 16, v62
    v_lshlrev_b32 v11, 16, v98
    v_and_b32 v62, 0xffff0000, v62
    v_and_b32 v98, 0xffff0000, v98
    v_mul_f32 v10, v10, v24
    v_mul_f32 v62, v62, v25
    v_fmac_f32 v105, v10, v11
    v_fmac_f32 v105, v62, v98
    v_lshlrev_b32 v10, 16, v63
    v_lshlrev_b32 v11, 16, v99
    v_and_b32 v63, 0xffff0000, v63
    v_and_b32 v99, 0xffff0000, v99
    v_mul_f32 v10, v10, v26
    v_mul_f32 v63, v63, v27
    v_fmac_f32 v105, v10, v11
    v_fmac_f32 v105, v63, v99
    v_add_f32_dpp v100, v100, v100 row_ror:8 row_mask:0xf bank_mask:0xf
    v_add_f32_dpp v101, v101, v101 row_ror:8 row_mask:0xf bank_mask:0xf
    v_add_f32_dpp v102, v102, v102 row_ror:8 row_mask:0xf bank_mask:0xf
    v_add_f32_dpp v103, v103, v103 row_ror:8 row_mask:0xf bank_mask:0xf
    v_add_f32_dpp v104, v104, v104 row_ror:8 row_mask:0xf bank_mask:0xf
    v_add_f32_dpp v105, v105, v105 row_ror:8 row_mask:0xf bank_mask:0xf
    v_add_f32_dpp v100, v100, v100 row_ror:4 row_mask:0xf bank_mask:0xf
    v_add_f32_dpp v101, v101, v101 row_ror:4 row_mask:0xf bank_mask:0xf
    v_add_f32_dpp v102, v102, v102 row_ror:4 row_mask:0xf bank_mask:0xf
    v_add_f32_dpp v103, v103, v103 row_ror:4 row_mask:0xf bank_mask:0xf
    v_add_f32_dpp v104, v104, v104 row_ror:4 row_mask:0xf bank_mask:0xf
    v_add_f32_dpp v105, v105, v105 row_ror:4 row_mask:0xf bank_mask:0xf
    v_add_f32_dpp v100, v100, v100 row_ror:2 row_mask:0xf bank_mask:0xf
    v_add_f32_dpp v101, v101, v101 row_ror:2 row_mask:0xf bank_mask:0xf
    v_add_f32_dpp v102, v102, v102 row_ror:2 row_mask:0xf bank_mask:0xf
    v_add_f32_dpp v103, v103, v103 row_ror:2 row_mask:0xf bank_mask:0xf
    v_add_f32_dpp v104, v104, v104 row_ror:2 row_mask:0xf bank_mask:0xf
    v_add_f32_dpp v105, v105, v105 row_ror:2 row_mask:0xf bank_mask:0xf
    v_add_f32_dpp v100, v100, v100 row_ror:1 row_mask:0xf bank_mask:0xf
    v_add_f32_dpp v101, v101, v101 row_ror:1 row_mask:0xf bank_mask:0xf
    v_add_f32_dpp v102, v102, v102 row_ror:1 row_mask:0xf bank_mask:0xf
    v_add_f32_dpp v103, v103, v103 row_ror:1 row_mask:0xf bank_mask:0xf
    v_add_f32_dpp v104, v104, v104 row_ror:1 row_mask:0xf bank_mask:0xf
    v_add_f32_dpp v105, v105, v105 row_ror:1 row_mask:0xf bank_mask:0xf
    v_cmp_eq_u32 vcc, 1, v5
    s_nop 1
    v_cndmask_b32 v100, v100, v101, vcc
    v_cmp_eq_u32 vcc, 2, v5
    s_nop 1
    v_cndmask_b32 v100, v100, v102, vcc
    v_cmp_eq_u32 vcc, 3, v5
    s_nop 1
    v_cndmask_b32 v100, v100, v103, vcc
    v_cmp_eq_u32 vcc, 4, v5
    s_nop 1
    v_cndmask_b32 v100, v100, v104, vcc
    v_cmp_eq_u32 vcc, 5, v5
    s_nop 1
    v_cndmask_b32 v100, v100, v105, vcc
    s_mul_i32 s48, s62, 768
    s_lshl_b32 s49, s49, 2
    s_add_u32 s48, s48, s49
    s_add_u32 s48, s48, 1179648
    s_mov_b32 exec_lo, 0x003f003f
    s_mov_b32 exec_hi, 0x003f003f
    buffer_store_dword v100, v13, s[12:15], s48 offen sc1
    s_mov_b64 exec, -1
    s_mov_b32 s61, 1
    s_lshl_b32 s62, s61, 5
    s_add_u32 s62, s62, s3
    s_lshl_b32 s63, s62, 15
    s_add_u32 s63, s63, 1
    s_mul_hi_u32 s63, s63, 0xaaaaaaab
    s_lshr_b32 s63, s63, 7
    s_mul_i32 s48, s62, 171
    s_lshr_b32 s48, s48, 9
    s_mul_i32 s48, s48, 384
    s_mul_i32 s49, s4, 24
    s_add_u32 s50, s49, s63
    s_mul_i32 s50, s50, 384
    v_add_u32 v10, s50, v7
    v_add_u32 v11, 3072, v10
    v_add_u32 v12, 6144, v10
    buffer_load_dwordx2 v[100:101], v6, s[8:11], s48 offen offset:0
    buffer_load_dwordx2 v[102:103], v6, s[8:11], s48 offen offset:128
    buffer_load_dwordx2 v[104:105], v6, s[8:11], s48 offen offset:256
    buffer_load_dwordx2 v[28:29], v10, s[92:95], 0 offen offset:0
    buffer_load_dwordx2 v[30:31], v10, s[92:95], 0 offen offset:128
    buffer_load_dwordx2 v[32:33], v10, s[92:95], 0 offen offset:256
    buffer_load_dwordx2 v[64:65], v10, s[96:99], 0 offen offset:0
    buffer_load_dwordx2 v[66:67], v10, s[96:99], 0 offen offset:128
    buffer_load_dwordx2 v[68:69], v10, s[96:99], 0 offen offset:256
    buffer_load_dwordx2 v[34:35], v10, s[92:95], 0 offen offset:1536
    buffer_load_dwordx2 v[36:37], v10, s[92:95], 0 offen offset:1664
    buffer_load_dwordx2 v[38:39], v10, s[92:95], 0 offen offset:1792
    buffer_load_dwordx2 v[70:71], v10, s[96:99], 0 offen offset:1536
    buffer_load_dwordx2 v[72:73], v10, s[96:99], 0 offen offset:1664
    buffer_load_dwordx2 v[74:75], v10, s[96:99], 0 offen offset:1792
    buffer_load_dwordx2 v[40:41], v11, s[92:95], 0 offen offset:0
    buffer_load_dwordx2 v[42:43], v11, s[92:95], 0 offen offset:128
    buffer_load_dwordx2 v[44:45], v11, s[92:95], 0 offen offset:256
    buffer_load_dwordx2 v[76:77], v11, s[96:99], 0 offen offset:0
    buffer_load_dwordx2 v[78:79], v11, s[96:99], 0 offen offset:128
    buffer_load_dwordx2 v[80:81], v11, s[96:99], 0 offen offset:256
    buffer_load_dwordx2 v[46:47], v11, s[92:95], 0 offen offset:1536
    buffer_load_dwordx2 v[48:49], v11, s[92:95], 0 offen offset:1664
    buffer_load_dwordx2 v[50:51], v11, s[92:95], 0 offen offset:1792
    buffer_load_dwordx2 v[82:83], v11, s[96:99], 0 offen offset:1536
    buffer_load_dwordx2 v[84:85], v11, s[96:99], 0 offen offset:1664
    buffer_load_dwordx2 v[86:87], v11, s[96:99], 0 offen offset:1792
    buffer_load_dwordx2 v[52:53], v12, s[92:95], 0 offen offset:0
    buffer_load_dwordx2 v[54:55], v12, s[92:95], 0 offen offset:128
    buffer_load_dwordx2 v[56:57], v12, s[92:95], 0 offen offset:256
    buffer_load_dwordx2 v[88:89], v12, s[96:99], 0 offen offset:0
    buffer_load_dwordx2 v[90:91], v12, s[96:99], 0 offen offset:128
    buffer_load_dwordx2 v[92:93], v12, s[96:99], 0 offen offset:256
    buffer_load_dwordx2 v[58:59], v12, s[92:95], 0 offen offset:1536
    buffer_load_dwordx2 v[60:61], v12, s[92:95], 0 offen offset:1664
    buffer_load_dwordx2 v[62:63], v12, s[92:95], 0 offen offset:1792
    buffer_load_dwordx2 v[94:95], v12, s[96:99], 0 offen offset:1536
    buffer_load_dwordx2 v[96:97], v12, s[96:99], 0 offen offset:1664
    buffer_load_dwordx2 v[98:99], v12, s[96:99], 0 offen offset:1792
    s_waitcnt vmcnt(0)
    v_lshlrev_b32 v16, 16, v100
    v_and_b32 v17, 0xffff0000, v100
    v_lshlrev_b32 v18, 16, v101
    v_and_b32 v19, 0xffff0000, v101
    v_lshlrev_b32 v20, 16, v102
    v_and_b32 v21, 0xffff0000, v102
    v_lshlrev_b32 v22, 16, v103
    v_and_b32 v23, 0xffff0000, v103
    v_lshlrev_b32 v24, 16, v104
    v_and_b32 v25, 0xffff0000, v104
    v_lshlrev_b32 v26, 16, v105
    v_and_b32 v27, 0xffff0000, v105
    v_lshlrev_b32 v10, 16, v28
    v_lshlrev_b32 v11, 16, v64
    v_and_b32 v28, 0xffff0000, v28
    v_and_b32 v64, 0xffff0000, v64
    v_mul_f32 v10, v10, v16
    v_mul_f32 v28, v28, v17
    v_mul_f32 v100, v10, v11
    v_fmac_f32 v100, v28, v64
    v_lshlrev_b32 v10, 16, v29
    v_lshlrev_b32 v11, 16, v65
    v_and_b32 v29, 0xffff0000, v29
    v_and_b32 v65, 0xffff0000, v65
    v_mul_f32 v10, v10, v18
    v_mul_f32 v29, v29, v19
    v_fmac_f32 v100, v10, v11
    v_fmac_f32 v100, v29, v65
    v_lshlrev_b32 v10, 16, v30
    v_lshlrev_b32 v11, 16, v66
    v_and_b32 v30, 0xffff0000, v30
    v_and_b32 v66, 0xffff0000, v66
    v_mul_f32 v10, v10, v20
    v_mul_f32 v30, v30, v21
    v_fmac_f32 v100, v10, v11
    v_fmac_f32 v100, v30, v66
    v_lshlrev_b32 v10, 16, v31
    v_lshlrev_b32 v11, 16, v67
    v_and_b32 v31, 0xffff0000, v31
    v_and_b32 v67, 0xffff0000, v67
    v_mul_f32 v10, v10, v22
    v_mul_f32 v31, v31, v23
    v_fmac_f32 v100, v10, v11
    v_fmac_f32 v100, v31, v67
    v_lshlrev_b32 v10, 16, v32
    v_lshlrev_b32 v11, 16, v68
    v_and_b32 v32, 0xffff0000, v32
    v_and_b32 v68, 0xffff0000, v68
    v_mul_f32 v10, v10, v24
    v_mul_f32 v32, v32, v25
    v_fmac_f32 v100, v10, v11
    v_fmac_f32 v100, v32, v68
    v_lshlrev_b32 v10, 16, v33
    v_lshlrev_b32 v11, 16, v69
    v_and_b32 v33, 0xffff0000, v33
    v_and_b32 v69, 0xffff0000, v69
    v_mul_f32 v10, v10, v26
    v_mul_f32 v33, v33, v27
    v_fmac_f32 v100, v10, v11
    v_fmac_f32 v100, v33, v69
    v_lshlrev_b32 v10, 16, v34
    v_lshlrev_b32 v11, 16, v70
    v_and_b32 v34, 0xffff0000, v34
    v_and_b32 v70, 0xffff0000, v70
    v_mul_f32 v10, v10, v16
    v_mul_f32 v34, v34, v17
    v_mul_f32 v101, v10, v11
    v_fmac_f32 v101, v34, v70
    v_lshlrev_b32 v10, 16, v35
    v_lshlrev_b32 v11, 16, v71
    v_and_b32 v35, 0xffff0000, v35
    v_and_b32 v71, 0xffff0000, v71
    v_mul_f32 v10, v10, v18
    v_mul_f32 v35, v35, v19
    v_fmac_f32 v101, v10, v11
    v_fmac_f32 v101, v35, v71
    v_lshlrev_b32 v10, 16, v36
    v_lshlrev_b32 v11, 16, v72
    v_and_b32 v36, 0xffff0000, v36
    v_and_b32 v72, 0xffff0000, v72
    v_mul_f32 v10, v10, v20
    v_mul_f32 v36, v36, v21
    v_fmac_f32 v101, v10, v11
    v_fmac_f32 v101, v36, v72
    v_lshlrev_b32 v10, 16, v37
    v_lshlrev_b32 v11, 16, v73
    v_and_b32 v37, 0xffff0000, v37
    v_and_b32 v73, 0xffff0000, v73
    v_mul_f32 v10, v10, v22
    v_mul_f32 v37, v37, v23
    v_fmac_f32 v101, v10, v11
    v_fmac_f32 v101, v37, v73
    v_lshlrev_b32 v10, 16, v38
    v_lshlrev_b32 v11, 16, v74
    v_and_b32 v38, 0xffff0000, v38
    v_and_b32 v74, 0xffff0000, v74
    v_mul_f32 v10, v10, v24
    v_mul_f32 v38, v38, v25
    v_fmac_f32 v101, v10, v11
    v_fmac_f32 v101, v38, v74
    v_lshlrev_b32 v10, 16, v39
    v_lshlrev_b32 v11, 16, v75
    v_and_b32 v39, 0xffff0000, v39
    v_and_b32 v75, 0xffff0000, v75
    v_mul_f32 v10, v10, v26
    v_mul_f32 v39, v39, v27
    v_fmac_f32 v101, v10, v11
    v_fmac_f32 v101, v39, v75
    v_lshlrev_b32 v10, 16, v40
    v_lshlrev_b32 v11, 16, v76
    v_and_b32 v40, 0xffff0000, v40
    v_and_b32 v76, 0xffff0000, v76
    v_mul_f32 v10, v10, v16
    v_mul_f32 v40, v40, v17
    v_mul_f32 v102, v10, v11
    v_fmac_f32 v102, v40, v76
    v_lshlrev_b32 v10, 16, v41
    v_lshlrev_b32 v11, 16, v77
    v_and_b32 v41, 0xffff0000, v41
    v_and_b32 v77, 0xffff0000, v77
    v_mul_f32 v10, v10, v18
    v_mul_f32 v41, v41, v19
    v_fmac_f32 v102, v10, v11
    v_fmac_f32 v102, v41, v77
    v_lshlrev_b32 v10, 16, v42
    v_lshlrev_b32 v11, 16, v78
    v_and_b32 v42, 0xffff0000, v42
    v_and_b32 v78, 0xffff0000, v78
    v_mul_f32 v10, v10, v20
    v_mul_f32 v42, v42, v21
    v_fmac_f32 v102, v10, v11
    v_fmac_f32 v102, v42, v78
    v_lshlrev_b32 v10, 16, v43
    v_lshlrev_b32 v11, 16, v79
    v_and_b32 v43, 0xffff0000, v43
    v_and_b32 v79, 0xffff0000, v79
    v_mul_f32 v10, v10, v22
    v_mul_f32 v43, v43, v23
    v_fmac_f32 v102, v10, v11
    v_fmac_f32 v102, v43, v79
    v_lshlrev_b32 v10, 16, v44
    v_lshlrev_b32 v11, 16, v80
    v_and_b32 v44, 0xffff0000, v44
    v_and_b32 v80, 0xffff0000, v80
    v_mul_f32 v10, v10, v24
    v_mul_f32 v44, v44, v25
    v_fmac_f32 v102, v10, v11
    v_fmac_f32 v102, v44, v80
    v_lshlrev_b32 v10, 16, v45
    v_lshlrev_b32 v11, 16, v81
    v_and_b32 v45, 0xffff0000, v45
    v_and_b32 v81, 0xffff0000, v81
    v_mul_f32 v10, v10, v26
    v_mul_f32 v45, v45, v27
    v_fmac_f32 v102, v10, v11
    v_fmac_f32 v102, v45, v81
    v_lshlrev_b32 v10, 16, v46
    v_lshlrev_b32 v11, 16, v82
    v_and_b32 v46, 0xffff0000, v46
    v_and_b32 v82, 0xffff0000, v82
    v_mul_f32 v10, v10, v16
    v_mul_f32 v46, v46, v17
    v_mul_f32 v103, v10, v11
    v_fmac_f32 v103, v46, v82
    v_lshlrev_b32 v10, 16, v47
    v_lshlrev_b32 v11, 16, v83
    v_and_b32 v47, 0xffff0000, v47
    v_and_b32 v83, 0xffff0000, v83
    v_mul_f32 v10, v10, v18
    v_mul_f32 v47, v47, v19
    v_fmac_f32 v103, v10, v11
    v_fmac_f32 v103, v47, v83
    v_lshlrev_b32 v10, 16, v48
    v_lshlrev_b32 v11, 16, v84
    v_and_b32 v48, 0xffff0000, v48
    v_and_b32 v84, 0xffff0000, v84
    v_mul_f32 v10, v10, v20
    v_mul_f32 v48, v48, v21
    v_fmac_f32 v103, v10, v11
    v_fmac_f32 v103, v48, v84
    v_lshlrev_b32 v10, 16, v49
    v_lshlrev_b32 v11, 16, v85
    v_and_b32 v49, 0xffff0000, v49
    v_and_b32 v85, 0xffff0000, v85
    v_mul_f32 v10, v10, v22
    v_mul_f32 v49, v49, v23
    v_fmac_f32 v103, v10, v11
    v_fmac_f32 v103, v49, v85
    v_lshlrev_b32 v10, 16, v50
    v_lshlrev_b32 v11, 16, v86
    v_and_b32 v50, 0xffff0000, v50
    v_and_b32 v86, 0xffff0000, v86
    v_mul_f32 v10, v10, v24
    v_mul_f32 v50, v50, v25
    v_fmac_f32 v103, v10, v11
    v_fmac_f32 v103, v50, v86
    v_lshlrev_b32 v10, 16, v51
    v_lshlrev_b32 v11, 16, v87
    v_and_b32 v51, 0xffff0000, v51
    v_and_b32 v87, 0xffff0000, v87
    v_mul_f32 v10, v10, v26
    v_mul_f32 v51, v51, v27
    v_fmac_f32 v103, v10, v11
    v_fmac_f32 v103, v51, v87
    v_lshlrev_b32 v10, 16, v52
    v_lshlrev_b32 v11, 16, v88
    v_and_b32 v52, 0xffff0000, v52
    v_and_b32 v88, 0xffff0000, v88
    v_mul_f32 v10, v10, v16
    v_mul_f32 v52, v52, v17
    v_mul_f32 v104, v10, v11
    v_fmac_f32 v104, v52, v88
    v_lshlrev_b32 v10, 16, v53
    v_lshlrev_b32 v11, 16, v89
    v_and_b32 v53, 0xffff0000, v53
    v_and_b32 v89, 0xffff0000, v89
    v_mul_f32 v10, v10, v18
    v_mul_f32 v53, v53, v19
    v_fmac_f32 v104, v10, v11
    v_fmac_f32 v104, v53, v89
    v_lshlrev_b32 v10, 16, v54
    v_lshlrev_b32 v11, 16, v90
    v_and_b32 v54, 0xffff0000, v54
    v_and_b32 v90, 0xffff0000, v90
    v_mul_f32 v10, v10, v20
    v_mul_f32 v54, v54, v21
    v_fmac_f32 v104, v10, v11
    v_fmac_f32 v104, v54, v90
    v_lshlrev_b32 v10, 16, v55
    v_lshlrev_b32 v11, 16, v91
    v_and_b32 v55, 0xffff0000, v55
    v_and_b32 v91, 0xffff0000, v91
    v_mul_f32 v10, v10, v22
    v_mul_f32 v55, v55, v23
    v_fmac_f32 v104, v10, v11
    v_fmac_f32 v104, v55, v91
    v_lshlrev_b32 v10, 16, v56
    v_lshlrev_b32 v11, 16, v92
    v_and_b32 v56, 0xffff0000, v56
    v_and_b32 v92, 0xffff0000, v92
    v_mul_f32 v10, v10, v24
    v_mul_f32 v56, v56, v25
    v_fmac_f32 v104, v10, v11
    v_fmac_f32 v104, v56, v92
    v_lshlrev_b32 v10, 16, v57
    v_lshlrev_b32 v11, 16, v93
    v_and_b32 v57, 0xffff0000, v57
    v_and_b32 v93, 0xffff0000, v93
    v_mul_f32 v10, v10, v26
    v_mul_f32 v57, v57, v27
    v_fmac_f32 v104, v10, v11
    v_fmac_f32 v104, v57, v93
    v_lshlrev_b32 v10, 16, v58
    v_lshlrev_b32 v11, 16, v94
    v_and_b32 v58, 0xffff0000, v58
    v_and_b32 v94, 0xffff0000, v94
    v_mul_f32 v10, v10, v16
    v_mul_f32 v58, v58, v17
    v_mul_f32 v105, v10, v11
    v_fmac_f32 v105, v58, v94
    v_lshlrev_b32 v10, 16, v59
    v_lshlrev_b32 v11, 16, v95
    v_and_b32 v59, 0xffff0000, v59
    v_and_b32 v95, 0xffff0000, v95
    v_mul_f32 v10, v10, v18
    v_mul_f32 v59, v59, v19
    v_fmac_f32 v105, v10, v11
    v_fmac_f32 v105, v59, v95
    v_lshlrev_b32 v10, 16, v60
    v_lshlrev_b32 v11, 16, v96
    v_and_b32 v60, 0xffff0000, v60
    v_and_b32 v96, 0xffff0000, v96
    v_mul_f32 v10, v10, v20
    v_mul_f32 v60, v60, v21
    v_fmac_f32 v105, v10, v11
    v_fmac_f32 v105, v60, v96
    v_lshlrev_b32 v10, 16, v61
    v_lshlrev_b32 v11, 16, v97
    v_and_b32 v61, 0xffff0000, v61
    v_and_b32 v97, 0xffff0000, v97
    v_mul_f32 v10, v10, v22
    v_mul_f32 v61, v61, v23
    v_fmac_f32 v105, v10, v11
    v_fmac_f32 v105, v61, v97
    v_lshlrev_b32 v10, 16, v62
    v_lshlrev_b32 v11, 16, v98
    v_and_b32 v62, 0xffff0000, v62
    v_and_b32 v98, 0xffff0000, v98
    v_mul_f32 v10, v10, v24
    v_mul_f32 v62, v62, v25
    v_fmac_f32 v105, v10, v11
    v_fmac_f32 v105, v62, v98
    v_lshlrev_b32 v10, 16, v63
    v_lshlrev_b32 v11, 16, v99
    v_and_b32 v63, 0xffff0000, v63
    v_and_b32 v99, 0xffff0000, v99
    v_mul_f32 v10, v10, v26
    v_mul_f32 v63, v63, v27
    v_fmac_f32 v105, v10, v11
    v_fmac_f32 v105, v63, v99
    v_add_f32_dpp v100, v100, v100 row_ror:8 row_mask:0xf bank_mask:0xf
    v_add_f32_dpp v101, v101, v101 row_ror:8 row_mask:0xf bank_mask:0xf
    v_add_f32_dpp v102, v102, v102 row_ror:8 row_mask:0xf bank_mask:0xf
    v_add_f32_dpp v103, v103, v103 row_ror:8 row_mask:0xf bank_mask:0xf
    v_add_f32_dpp v104, v104, v104 row_ror:8 row_mask:0xf bank_mask:0xf
    v_add_f32_dpp v105, v105, v105 row_ror:8 row_mask:0xf bank_mask:0xf
    v_add_f32_dpp v100, v100, v100 row_ror:4 row_mask:0xf bank_mask:0xf
    v_add_f32_dpp v101, v101, v101 row_ror:4 row_mask:0xf bank_mask:0xf
    v_add_f32_dpp v102, v102, v102 row_ror:4 row_mask:0xf bank_mask:0xf
    v_add_f32_dpp v103, v103, v103 row_ror:4 row_mask:0xf bank_mask:0xf
    v_add_f32_dpp v104, v104, v104 row_ror:4 row_mask:0xf bank_mask:0xf
    v_add_f32_dpp v105, v105, v105 row_ror:4 row_mask:0xf bank_mask:0xf
    v_add_f32_dpp v100, v100, v100 row_ror:2 row_mask:0xf bank_mask:0xf
    v_add_f32_dpp v101, v101, v101 row_ror:2 row_mask:0xf bank_mask:0xf
    v_add_f32_dpp v102, v102, v102 row_ror:2 row_mask:0xf bank_mask:0xf
    v_add_f32_dpp v103, v103, v103 row_ror:2 row_mask:0xf bank_mask:0xf
    v_add_f32_dpp v104, v104, v104 row_ror:2 row_mask:0xf bank_mask:0xf
    v_add_f32_dpp v105, v105, v105 row_ror:2 row_mask:0xf bank_mask:0xf
    v_add_f32_dpp v100, v100, v100 row_ror:1 row_mask:0xf bank_mask:0xf
    v_add_f32_dpp v101, v101, v101 row_ror:1 row_mask:0xf bank_mask:0xf
    v_add_f32_dpp v102, v102, v102 row_ror:1 row_mask:0xf bank_mask:0xf
    v_add_f32_dpp v103, v103, v103 row_ror:1 row_mask:0xf bank_mask:0xf
    v_add_f32_dpp v104, v104, v104 row_ror:1 row_mask:0xf bank_mask:0xf
    v_add_f32_dpp v105, v105, v105 row_ror:1 row_mask:0xf bank_mask:0xf
    v_cmp_eq_u32 vcc, 1, v5
    s_nop 1
    v_cndmask_b32 v100, v100, v101, vcc
    v_cmp_eq_u32 vcc, 2, v5
    s_nop 1
    v_cndmask_b32 v100, v100, v102, vcc
    v_cmp_eq_u32 vcc, 3, v5
    s_nop 1
    v_cndmask_b32 v100, v100, v103, vcc
    v_cmp_eq_u32 vcc, 4, v5
    s_nop 1
    v_cndmask_b32 v100, v100, v104, vcc
    v_cmp_eq_u32 vcc, 5, v5
    s_nop 1
    v_cndmask_b32 v100, v100, v105, vcc
    s_mul_i32 s48, s62, 768
    s_lshl_b32 s49, s49, 2
    s_add_u32 s48, s48, s49
    s_add_u32 s48, s48, 1179648
    s_mov_b32 exec_lo, 0x003f003f
    s_mov_b32 exec_hi, 0x003f003f
    buffer_store_dword v100, v13, s[12:15], s48 offen sc1
    s_mov_b64 exec, -1
    s_mov_b32 s61, 2
    s_lshl_b32 s62, s61, 5
    s_add_u32 s62, s62, s3
    s_lshl_b32 s63, s62, 15
    s_add_u32 s63, s63, 1
    s_mul_hi_u32 s63, s63, 0xaaaaaaab
    s_lshr_b32 s63, s63, 7
    s_mul_i32 s48, s62, 171
    s_lshr_b32 s48, s48, 9
    s_mul_i32 s48, s48, 384
    s_mul_i32 s49, s4, 24
    s_add_u32 s50, s49, s63
    s_mul_i32 s50, s50, 384
    v_add_u32 v10, s50, v7
    v_add_u32 v11, 3072, v10
    v_add_u32 v12, 6144, v10
    buffer_load_dwordx2 v[100:101], v6, s[8:11], s48 offen offset:0
    buffer_load_dwordx2 v[102:103], v6, s[8:11], s48 offen offset:128
    buffer_load_dwordx2 v[104:105], v6, s[8:11], s48 offen offset:256
    buffer_load_dwordx2 v[28:29], v10, s[92:95], 0 offen offset:0
    buffer_load_dwordx2 v[30:31], v10, s[92:95], 0 offen offset:128
    buffer_load_dwordx2 v[32:33], v10, s[92:95], 0 offen offset:256
    buffer_load_dwordx2 v[64:65], v10, s[96:99], 0 offen offset:0
    buffer_load_dwordx2 v[66:67], v10, s[96:99], 0 offen offset:128
    buffer_load_dwordx2 v[68:69], v10, s[96:99], 0 offen offset:256
    buffer_load_dwordx2 v[34:35], v10, s[92:95], 0 offen offset:1536
    buffer_load_dwordx2 v[36:37], v10, s[92:95], 0 offen offset:1664
    buffer_load_dwordx2 v[38:39], v10, s[92:95], 0 offen offset:1792
    buffer_load_dwordx2 v[70:71], v10, s[96:99], 0 offen offset:1536
    buffer_load_dwordx2 v[72:73], v10, s[96:99], 0 offen offset:1664
    buffer_load_dwordx2 v[74:75], v10, s[96:99], 0 offen offset:1792
    buffer_load_dwordx2 v[40:41], v11, s[92:95], 0 offen offset:0
    buffer_load_dwordx2 v[42:43], v11, s[92:95], 0 offen offset:128
    buffer_load_dwordx2 v[44:45], v11, s[92:95], 0 offen offset:256
    buffer_load_dwordx2 v[76:77], v11, s[96:99], 0 offen offset:0
    buffer_load_dwordx2 v[78:79], v11, s[96:99], 0 offen offset:128
    buffer_load_dwordx2 v[80:81], v11, s[96:99], 0 offen offset:256
    buffer_load_dwordx2 v[46:47], v11, s[92:95], 0 offen offset:1536
    buffer_load_dwordx2 v[48:49], v11, s[92:95], 0 offen offset:1664
    buffer_load_dwordx2 v[50:51], v11, s[92:95], 0 offen offset:1792
    buffer_load_dwordx2 v[82:83], v11, s[96:99], 0 offen offset:1536
    buffer_load_dwordx2 v[84:85], v11, s[96:99], 0 offen offset:1664
    buffer_load_dwordx2 v[86:87], v11, s[96:99], 0 offen offset:1792
    buffer_load_dwordx2 v[52:53], v12, s[92:95], 0 offen offset:0
    buffer_load_dwordx2 v[54:55], v12, s[92:95], 0 offen offset:128
    buffer_load_dwordx2 v[56:57], v12, s[92:95], 0 offen offset:256
    buffer_load_dwordx2 v[88:89], v12, s[96:99], 0 offen offset:0
    buffer_load_dwordx2 v[90:91], v12, s[96:99], 0 offen offset:128
    buffer_load_dwordx2 v[92:93], v12, s[96:99], 0 offen offset:256
    buffer_load_dwordx2 v[58:59], v12, s[92:95], 0 offen offset:1536
    buffer_load_dwordx2 v[60:61], v12, s[92:95], 0 offen offset:1664
    buffer_load_dwordx2 v[62:63], v12, s[92:95], 0 offen offset:1792
    buffer_load_dwordx2 v[94:95], v12, s[96:99], 0 offen offset:1536
    buffer_load_dwordx2 v[96:97], v12, s[96:99], 0 offen offset:1664
    buffer_load_dwordx2 v[98:99], v12, s[96:99], 0 offen offset:1792
    s_waitcnt vmcnt(0)
    v_lshlrev_b32 v16, 16, v100
    v_and_b32 v17, 0xffff0000, v100
    v_lshlrev_b32 v18, 16, v101
    v_and_b32 v19, 0xffff0000, v101
    v_lshlrev_b32 v20, 16, v102
    v_and_b32 v21, 0xffff0000, v102
    v_lshlrev_b32 v22, 16, v103
    v_and_b32 v23, 0xffff0000, v103
    v_lshlrev_b32 v24, 16, v104
    v_and_b32 v25, 0xffff0000, v104
    v_lshlrev_b32 v26, 16, v105
    v_and_b32 v27, 0xffff0000, v105
    v_lshlrev_b32 v10, 16, v28
    v_lshlrev_b32 v11, 16, v64
    v_and_b32 v28, 0xffff0000, v28
    v_and_b32 v64, 0xffff0000, v64
    v_mul_f32 v10, v10, v16
    v_mul_f32 v28, v28, v17
    v_mul_f32 v100, v10, v11
    v_fmac_f32 v100, v28, v64
    v_lshlrev_b32 v10, 16, v29
    v_lshlrev_b32 v11, 16, v65
    v_and_b32 v29, 0xffff0000, v29
    v_and_b32 v65, 0xffff0000, v65
    v_mul_f32 v10, v10, v18
    v_mul_f32 v29, v29, v19
    v_fmac_f32 v100, v10, v11
    v_fmac_f32 v100, v29, v65
    v_lshlrev_b32 v10, 16, v30
    v_lshlrev_b32 v11, 16, v66
    v_and_b32 v30, 0xffff0000, v30
    v_and_b32 v66, 0xffff0000, v66
    v_mul_f32 v10, v10, v20
    v_mul_f32 v30, v30, v21
    v_fmac_f32 v100, v10, v11
    v_fmac_f32 v100, v30, v66
    v_lshlrev_b32 v10, 16, v31
    v_lshlrev_b32 v11, 16, v67
    v_and_b32 v31, 0xffff0000, v31
    v_and_b32 v67, 0xffff0000, v67
    v_mul_f32 v10, v10, v22
    v_mul_f32 v31, v31, v23
    v_fmac_f32 v100, v10, v11
    v_fmac_f32 v100, v31, v67
    v_lshlrev_b32 v10, 16, v32
    v_lshlrev_b32 v11, 16, v68
    v_and_b32 v32, 0xffff0000, v32
    v_and_b32 v68, 0xffff0000, v68
    v_mul_f32 v10, v10, v24
    v_mul_f32 v32, v32, v25
    v_fmac_f32 v100, v10, v11
    v_fmac_f32 v100, v32, v68
    v_lshlrev_b32 v10, 16, v33
    v_lshlrev_b32 v11, 16, v69
    v_and_b32 v33, 0xffff0000, v33
    v_and_b32 v69, 0xffff0000, v69
    v_mul_f32 v10, v10, v26
    v_mul_f32 v33, v33, v27
    v_fmac_f32 v100, v10, v11
    v_fmac_f32 v100, v33, v69
    v_lshlrev_b32 v10, 16, v34
    v_lshlrev_b32 v11, 16, v70
    v_and_b32 v34, 0xffff0000, v34
    v_and_b32 v70, 0xffff0000, v70
    v_mul_f32 v10, v10, v16
    v_mul_f32 v34, v34, v17
    v_mul_f32 v101, v10, v11
    v_fmac_f32 v101, v34, v70
    v_lshlrev_b32 v10, 16, v35
    v_lshlrev_b32 v11, 16, v71
    v_and_b32 v35, 0xffff0000, v35
    v_and_b32 v71, 0xffff0000, v71
    v_mul_f32 v10, v10, v18
    v_mul_f32 v35, v35, v19
    v_fmac_f32 v101, v10, v11
    v_fmac_f32 v101, v35, v71
    v_lshlrev_b32 v10, 16, v36
    v_lshlrev_b32 v11, 16, v72
    v_and_b32 v36, 0xffff0000, v36
    v_and_b32 v72, 0xffff0000, v72
    v_mul_f32 v10, v10, v20
    v_mul_f32 v36, v36, v21
    v_fmac_f32 v101, v10, v11
    v_fmac_f32 v101, v36, v72
    v_lshlrev_b32 v10, 16, v37
    v_lshlrev_b32 v11, 16, v73
    v_and_b32 v37, 0xffff0000, v37
    v_and_b32 v73, 0xffff0000, v73
    v_mul_f32 v10, v10, v22
    v_mul_f32 v37, v37, v23
    v_fmac_f32 v101, v10, v11
    v_fmac_f32 v101, v37, v73
    v_lshlrev_b32 v10, 16, v38
    v_lshlrev_b32 v11, 16, v74
    v_and_b32 v38, 0xffff0000, v38
    v_and_b32 v74, 0xffff0000, v74
    v_mul_f32 v10, v10, v24
    v_mul_f32 v38, v38, v25
    v_fmac_f32 v101, v10, v11
    v_fmac_f32 v101, v38, v74
    v_lshlrev_b32 v10, 16, v39
    v_lshlrev_b32 v11, 16, v75
    v_and_b32 v39, 0xffff0000, v39
    v_and_b32 v75, 0xffff0000, v75
    v_mul_f32 v10, v10, v26
    v_mul_f32 v39, v39, v27
    v_fmac_f32 v101, v10, v11
    v_fmac_f32 v101, v39, v75
    v_lshlrev_b32 v10, 16, v40
    v_lshlrev_b32 v11, 16, v76
    v_and_b32 v40, 0xffff0000, v40
    v_and_b32 v76, 0xffff0000, v76
    v_mul_f32 v10, v10, v16
    v_mul_f32 v40, v40, v17
    v_mul_f32 v102, v10, v11
    v_fmac_f32 v102, v40, v76
    v_lshlrev_b32 v10, 16, v41
    v_lshlrev_b32 v11, 16, v77
    v_and_b32 v41, 0xffff0000, v41
    v_and_b32 v77, 0xffff0000, v77
    v_mul_f32 v10, v10, v18
    v_mul_f32 v41, v41, v19
    v_fmac_f32 v102, v10, v11
    v_fmac_f32 v102, v41, v77
    v_lshlrev_b32 v10, 16, v42
    v_lshlrev_b32 v11, 16, v78
    v_and_b32 v42, 0xffff0000, v42
    v_and_b32 v78, 0xffff0000, v78
    v_mul_f32 v10, v10, v20
    v_mul_f32 v42, v42, v21
    v_fmac_f32 v102, v10, v11
    v_fmac_f32 v102, v42, v78
    v_lshlrev_b32 v10, 16, v43
    v_lshlrev_b32 v11, 16, v79
    v_and_b32 v43, 0xffff0000, v43
    v_and_b32 v79, 0xffff0000, v79
    v_mul_f32 v10, v10, v22
    v_mul_f32 v43, v43, v23
    v_fmac_f32 v102, v10, v11
    v_fmac_f32 v102, v43, v79
    v_lshlrev_b32 v10, 16, v44
    v_lshlrev_b32 v11, 16, v80
    v_and_b32 v44, 0xffff0000, v44
    v_and_b32 v80, 0xffff0000, v80
    v_mul_f32 v10, v10, v24
    v_mul_f32 v44, v44, v25
    v_fmac_f32 v102, v10, v11
    v_fmac_f32 v102, v44, v80
    v_lshlrev_b32 v10, 16, v45
    v_lshlrev_b32 v11, 16, v81
    v_and_b32 v45, 0xffff0000, v45
    v_and_b32 v81, 0xffff0000, v81
    v_mul_f32 v10, v10, v26
    v_mul_f32 v45, v45, v27
    v_fmac_f32 v102, v10, v11
    v_fmac_f32 v102, v45, v81
    v_lshlrev_b32 v10, 16, v46
    v_lshlrev_b32 v11, 16, v82
    v_and_b32 v46, 0xffff0000, v46
    v_and_b32 v82, 0xffff0000, v82
    v_mul_f32 v10, v10, v16
    v_mul_f32 v46, v46, v17
    v_mul_f32 v103, v10, v11
    v_fmac_f32 v103, v46, v82
    v_lshlrev_b32 v10, 16, v47
    v_lshlrev_b32 v11, 16, v83
    v_and_b32 v47, 0xffff0000, v47
    v_and_b32 v83, 0xffff0000, v83
    v_mul_f32 v10, v10, v18
    v_mul_f32 v47, v47, v19
    v_fmac_f32 v103, v10, v11
    v_fmac_f32 v103, v47, v83
    v_lshlrev_b32 v10, 16, v48
    v_lshlrev_b32 v11, 16, v84
    v_and_b32 v48, 0xffff0000, v48
    v_and_b32 v84, 0xffff0000, v84
    v_mul_f32 v10, v10, v20
    v_mul_f32 v48, v48, v21
    v_fmac_f32 v103, v10, v11
    v_fmac_f32 v103, v48, v84
    v_lshlrev_b32 v10, 16, v49
    v_lshlrev_b32 v11, 16, v85
    v_and_b32 v49, 0xffff0000, v49
    v_and_b32 v85, 0xffff0000, v85
    v_mul_f32 v10, v10, v22
    v_mul_f32 v49, v49, v23
    v_fmac_f32 v103, v10, v11
    v_fmac_f32 v103, v49, v85
    v_lshlrev_b32 v10, 16, v50
    v_lshlrev_b32 v11, 16, v86
    v_and_b32 v50, 0xffff0000, v50
    v_and_b32 v86, 0xffff0000, v86
    v_mul_f32 v10, v10, v24
    v_mul_f32 v50, v50, v25
    v_fmac_f32 v103, v10, v11
    v_fmac_f32 v103, v50, v86
    v_lshlrev_b32 v10, 16, v51
    v_lshlrev_b32 v11, 16, v87
    v_and_b32 v51, 0xffff0000, v51
    v_and_b32 v87, 0xffff0000, v87
    v_mul_f32 v10, v10, v26
    v_mul_f32 v51, v51, v27
    v_fmac_f32 v103, v10, v11
    v_fmac_f32 v103, v51, v87
    v_lshlrev_b32 v10, 16, v52
    v_lshlrev_b32 v11, 16, v88
    v_and_b32 v52, 0xffff0000, v52
    v_and_b32 v88, 0xffff0000, v88
    v_mul_f32 v10, v10, v16
    v_mul_f32 v52, v52, v17
    v_mul_f32 v104, v10, v11
    v_fmac_f32 v104, v52, v88
    v_lshlrev_b32 v10, 16, v53
    v_lshlrev_b32 v11, 16, v89
    v_and_b32 v53, 0xffff0000, v53
    v_and_b32 v89, 0xffff0000, v89
    v_mul_f32 v10, v10, v18
    v_mul_f32 v53, v53, v19
    v_fmac_f32 v104, v10, v11
    v_fmac_f32 v104, v53, v89
    v_lshlrev_b32 v10, 16, v54
    v_lshlrev_b32 v11, 16, v90
    v_and_b32 v54, 0xffff0000, v54
    v_and_b32 v90, 0xffff0000, v90
    v_mul_f32 v10, v10, v20
    v_mul_f32 v54, v54, v21
    v_fmac_f32 v104, v10, v11
    v_fmac_f32 v104, v54, v90
    v_lshlrev_b32 v10, 16, v55
    v_lshlrev_b32 v11, 16, v91
    v_and_b32 v55, 0xffff0000, v55
    v_and_b32 v91, 0xffff0000, v91
    v_mul_f32 v10, v10, v22
    v_mul_f32 v55, v55, v23
    v_fmac_f32 v104, v10, v11
    v_fmac_f32 v104, v55, v91
    v_lshlrev_b32 v10, 16, v56
    v_lshlrev_b32 v11, 16, v92
    v_and_b32 v56, 0xffff0000, v56
    v_and_b32 v92, 0xffff0000, v92
    v_mul_f32 v10, v10, v24
    v_mul_f32 v56, v56, v25
    v_fmac_f32 v104, v10, v11
    v_fmac_f32 v104, v56, v92
    v_lshlrev_b32 v10, 16, v57
    v_lshlrev_b32 v11, 16, v93
    v_and_b32 v57, 0xffff0000, v57
    v_and_b32 v93, 0xffff0000, v93
    v_mul_f32 v10, v10, v26
    v_mul_f32 v57, v57, v27
    v_fmac_f32 v104, v10, v11
    v_fmac_f32 v104, v57, v93
    v_lshlrev_b32 v10, 16, v58
    v_lshlrev_b32 v11, 16, v94
    v_and_b32 v58, 0xffff0000, v58
    v_and_b32 v94, 0xffff0000, v94
    v_mul_f32 v10, v10, v16
    v_mul_f32 v58, v58, v17
    v_mul_f32 v105, v10, v11
    v_fmac_f32 v105, v58, v94
    v_lshlrev_b32 v10, 16, v59
    v_lshlrev_b32 v11, 16, v95
    v_and_b32 v59, 0xffff0000, v59
    v_and_b32 v95, 0xffff0000, v95
    v_mul_f32 v10, v10, v18
    v_mul_f32 v59, v59, v19
    v_fmac_f32 v105, v10, v11
    v_fmac_f32 v105, v59, v95
    v_lshlrev_b32 v10, 16, v60
    v_lshlrev_b32 v11, 16, v96
    v_and_b32 v60, 0xffff0000, v60
    v_and_b32 v96, 0xffff0000, v96
    v_mul_f32 v10, v10, v20
    v_mul_f32 v60, v60, v21
    v_fmac_f32 v105, v10, v11
    v_fmac_f32 v105, v60, v96
    v_lshlrev_b32 v10, 16, v61
    v_lshlrev_b32 v11, 16, v97
    v_and_b32 v61, 0xffff0000, v61
    v_and_b32 v97, 0xffff0000, v97
    v_mul_f32 v10, v10, v22
    v_mul_f32 v61, v61, v23
    v_fmac_f32 v105, v10, v11
    v_fmac_f32 v105, v61, v97
    v_lshlrev_b32 v10, 16, v62
    v_lshlrev_b32 v11, 16, v98
    v_and_b32 v62, 0xffff0000, v62
    v_and_b32 v98, 0xffff0000, v98
    v_mul_f32 v10, v10, v24
    v_mul_f32 v62, v62, v25
    v_fmac_f32 v105, v10, v11
    v_fmac_f32 v105, v62, v98
    v_lshlrev_b32 v10, 16, v63
    v_lshlrev_b32 v11, 16, v99
    v_and_b32 v63, 0xffff0000, v63
    v_and_b32 v99, 0xffff0000, v99
    v_mul_f32 v10, v10, v26
    v_mul_f32 v63, v63, v27
    v_fmac_f32 v105, v10, v11
    v_fmac_f32 v105, v63, v99
    v_add_f32_dpp v100, v100, v100 row_ror:8 row_mask:0xf bank_mask:0xf
    v_add_f32_dpp v101, v101, v101 row_ror:8 row_mask:0xf bank_mask:0xf
    v_add_f32_dpp v102, v102, v102 row_ror:8 row_mask:0xf bank_mask:0xf
    v_add_f32_dpp v103, v103, v103 row_ror:8 row_mask:0xf bank_mask:0xf
    v_add_f32_dpp v104, v104, v104 row_ror:8 row_mask:0xf bank_mask:0xf
    v_add_f32_dpp v105, v105, v105 row_ror:8 row_mask:0xf bank_mask:0xf
    v_add_f32_dpp v100, v100, v100 row_ror:4 row_mask:0xf bank_mask:0xf
    v_add_f32_dpp v101, v101, v101 row_ror:4 row_mask:0xf bank_mask:0xf
    v_add_f32_dpp v102, v102, v102 row_ror:4 row_mask:0xf bank_mask:0xf
    v_add_f32_dpp v103, v103, v103 row_ror:4 row_mask:0xf bank_mask:0xf
    v_add_f32_dpp v104, v104, v104 row_ror:4 row_mask:0xf bank_mask:0xf
    v_add_f32_dpp v105, v105, v105 row_ror:4 row_mask:0xf bank_mask:0xf
    v_add_f32_dpp v100, v100, v100 row_ror:2 row_mask:0xf bank_mask:0xf
    v_add_f32_dpp v101, v101, v101 row_ror:2 row_mask:0xf bank_mask:0xf
    v_add_f32_dpp v102, v102, v102 row_ror:2 row_mask:0xf bank_mask:0xf
    v_add_f32_dpp v103, v103, v103 row_ror:2 row_mask:0xf bank_mask:0xf
    v_add_f32_dpp v104, v104, v104 row_ror:2 row_mask:0xf bank_mask:0xf
    v_add_f32_dpp v105, v105, v105 row_ror:2 row_mask:0xf bank_mask:0xf
    v_add_f32_dpp v100, v100, v100 row_ror:1 row_mask:0xf bank_mask:0xf
    v_add_f32_dpp v101, v101, v101 row_ror:1 row_mask:0xf bank_mask:0xf
    v_add_f32_dpp v102, v102, v102 row_ror:1 row_mask:0xf bank_mask:0xf
    v_add_f32_dpp v103, v103, v103 row_ror:1 row_mask:0xf bank_mask:0xf
    v_add_f32_dpp v104, v104, v104 row_ror:1 row_mask:0xf bank_mask:0xf
    v_add_f32_dpp v105, v105, v105 row_ror:1 row_mask:0xf bank_mask:0xf
    v_cmp_eq_u32 vcc, 1, v5
    s_nop 1
    v_cndmask_b32 v100, v100, v101, vcc
    v_cmp_eq_u32 vcc, 2, v5
    s_nop 1
    v_cndmask_b32 v100, v100, v102, vcc
    v_cmp_eq_u32 vcc, 3, v5
    s_nop 1
    v_cndmask_b32 v100, v100, v103, vcc
    v_cmp_eq_u32 vcc, 4, v5
    s_nop 1
    v_cndmask_b32 v100, v100, v104, vcc
    v_cmp_eq_u32 vcc, 5, v5
    s_nop 1
    v_cndmask_b32 v100, v100, v105, vcc
    s_mul_i32 s48, s62, 768
    s_lshl_b32 s49, s49, 2
    s_add_u32 s48, s48, s49
    s_add_u32 s48, s48, 1179648
    s_mov_b32 exec_lo, 0x003f003f
    s_mov_b32 exec_hi, 0x003f003f
    buffer_store_dword v100, v13, s[12:15], s48 offen sc1
    s_mov_b64 exec, -1
    s_mov_b32 s92, s74
    s_and_b32 s93, s75, 0xffff
    s_mov_b32 s94, 2097152
    s_mov_b32 s95, 0x00020000
    s_mov_b32 s96, s76
    s_and_b32 s97, s77, 0xffff
    s_mov_b32 s98, 2097152
    s_mov_b32 s99, 0x00020000
    v_lshlrev_b32 v10, 4, v1
    s_lshl_b32 s48, s2, 13
    s_add_u32 s49, s48, 4096
    buffer_load_dwordx4 v[16:19], v10, s[92:95], s48 offen offset:0
    buffer_load_dwordx4 v[20:23], v10, s[92:95], s48 offen offset:1024
    buffer_load_dwordx4 v[24:27], v10, s[92:95], s48 offen offset:2048
    buffer_load_dwordx4 v[28:31], v10, s[92:95], s48 offen offset:3072
    buffer_load_dwordx4 v[32:35], v10, s[92:95], s49 offen offset:0
    buffer_load_dwordx4 v[36:39], v10, s[92:95], s49 offen offset:1024
    buffer_load_dwordx4 v[40:43], v10, s[92:95], s49 offen offset:2048
    buffer_load_dwordx4 v[44:47], v10, s[92:95], s49 offen offset:3072
    buffer_load_dwordx4 v[48:51], v10, s[96:99], s48 offen offset:0
    buffer_load_dwordx4 v[52:55], v10, s[96:99], s48 offen offset:1024
    buffer_load_dwordx4 v[56:59], v10, s[96:99], s48 offen offset:2048
    buffer_load_dwordx4 v[60:63], v10, s[96:99], s48 offen offset:3072
    buffer_load_dwordx4 v[64:67], v10, s[96:99], s49 offen offset:0
    buffer_load_dwordx4 v[68:71], v10, s[96:99], s49 offen offset:1024
    buffer_load_dwordx4 v[72:75], v10, s[96:99], s49 offen offset:2048
    buffer_load_dwordx4 v[76:79], v10, s[96:99], s49 offen offset:3072
    s_waitcnt vmcnt(0)
    s_mov_b32 s60, 0x100000
L_wd0:
    s_nop 1
    ds_read_b32 v10, v2 offset:20
    s_sub_u32 s60, s60, 1
    s_cbranch_scc1 L_exit1
    s_waitcnt lgkmcnt(0)
    v_readfirstlane_b32 s48, v10
    s_cmp_eq_u32 s48, 0
    s_cbranch_scc1 L_wd0
    ds_read_b128 v[16:19], v2 offset:0
    ds_read_b64 v[20:21], v2 offset:16
    s_waitcnt lgkmcnt(0)
    v_readfirstlane_b32 s84, v16
    v_readfirstlane_b32 s85, v17
    v_readfirstlane_b32 s86, v18
    v_readfirstlane_b32 s87, v19
    v_readfirstlane_b32 s88, v20
    v_readfirstlane_b32 s89, v21
    s_mov_b32 s60, 0x100000
L_wf0:
    s_nop 1
    ds_read_b32 v10, v2 offset:40
    s_sub_u32 s60, s60, 1
    s_cbranch_scc1 L_exit1
    s_waitcnt lgkmcnt(0)
    v_readfirstlane_b32 s48, v10
    s_cmp_lt_u32 s48, 4
    s_cbranch_scc1 L_wf0
    s_cmp_eq_u32 s84, s87
    ds_read_b64 v[16:17], v8 offset:256
    ds_read_b64 v[18:19], v8 offset:264
    ds_read_b64 v[20:21], v8 offset:272
    ds_read_b64 v[28:29], v8 offset:448
    ds_read_b64 v[30:31], v8 offset:456
    ds_read_b64 v[32:33], v8 offset:464
    ds_read_b64 v[40:41], v8 offset:640
    ds_read_b64 v[42:43], v8 offset:648
    ds_read_b64 v[44:45], v8 offset:656
    ds_read_b64 v[52:53], v8 offset:832
    ds_read_b64 v[54:55], v8 offset:840
    ds_read_b64 v[56:57], v8 offset:848
    s_add_u32 s54, s33, 0
    s_cmp_eq_u32 s84, s87
    s_waitcnt lgkmcnt(0)
    v_cmp_eq_f32 vcc, 0, v21
    v_max3_f32 v25, v16, v17, v18
    s_nop 0
    v_cndmask_b32 v24, v21, v20, vcc
    v_max3_f32 v25, v25, v19, v20
    v_max_f32 v24, v24, v25
    v_sub_f32 v16, v16, v24
    v_sub_f32 v17, v17, v24
    v_sub_f32 v18, v18, v24
    v_sub_f32 v19, v19, v24
    v_sub_f32 v20, v20, v24
    v_sub_f32 v21, v21, v24
    v_cvt_pk_f16_f32 v25, v16, v17
    v_cvt_pk_f16_f32 v26, v18, v19
    v_cvt_pk_f16_f32 v27, v20, v21
    buffer_store_dwordx4 v[24:27], v14, s[12:15], s54 offen offset:0 sc1
    s_cbranch_scc1 L_fl0
    v_cmp_eq_f32 vcc, 0, v33
    v_max3_f32 v37, v28, v29, v30
    s_nop 0
    v_cndmask_b32 v36, v33, v32, vcc
    v_max3_f32 v37, v37, v31, v32
    v_max_f32 v36, v36, v37
    v_sub_f32 v28, v28, v36
    v_sub_f32 v29, v29, v36
    v_sub_f32 v30, v30, v36
    v_sub_f32 v31, v31, v36
    v_sub_f32 v32, v32, v36
    v_sub_f32 v33, v33, v36
    v_cvt_pk_f16_f32 v37, v28, v29
    v_cvt_pk_f16_f32 v38, v30, v31
    v_cvt_pk_f16_f32 v39, v32, v33
    buffer_store_dwordx4 v[36:39], v14, s[12:15], s54 offen offset:1024 sc1
    v_cmp_eq_f32 vcc, 0, v45
    v_max3_f32 v49, v40, v41, v42
    s_nop 0
    v_cndmask_b32 v48, v45, v44, vcc
    v_max3_f32 v49, v49, v43, v44
    v_max_f32 v48, v48, v49
    v_sub_f32 v40, v40, v48
    v_sub_f32 v41, v41, v48
    v_sub_f32 v42, v42, v48
    v_sub_f32 v43, v43, v48
    v_sub_f32 v44, v44, v48
    v_sub_f32 v45, v45, v48
    v_cvt_pk_f16_f32 v49, v40, v41
    v_cvt_pk_f16_f32 v50, v42, v43
    v_cvt_pk_f16_f32 v51, v44, v45
    buffer_store_dwordx4 v[48:51], v14, s[12:15], s54 offen offset:2048 sc1
    v_cmp_eq_f32 vcc, 0, v57
    v_max3_f32 v61, v52, v53, v54
    s_nop 0
    v_cndmask_b32 v60, v57, v56, vcc
    v_max3_f32 v61, v61, v55, v56
    v_max_f32 v60, v60, v61
    v_sub_f32 v52, v52, v60
    v_sub_f32 v53, v53, v60
    v_sub_f32 v54, v54, v60
    v_sub_f32 v55, v55, v60
    v_sub_f32 v56, v56, v60
    v_sub_f32 v57, v57, v60
    v_cvt_pk_f16_f32 v61, v52, v53
    v_cvt_pk_f16_f32 v62, v54, v55
    v_cvt_pk_f16_f32 v63, v56, v57
    buffer_store_dwordx4 v[60:63], v14, s[12:15], s54 offen offset:3072 sc1
L_fl0:
    s_nop 1
    v_mov_b32 v10, 1
    s_waitcnt vmcnt(0)
    s_mov_b64 exec, 1
    buffer_store_dword v10, off, s[12:15], s32 sc1
    ds_write_b32 v2, v10 offset:52
    s_mov_b64 exec, -1
    s_mov_b32 s60, 0x100000
L_wf1:
    s_nop 1
    ds_read_b32 v10, v2 offset:44
    s_sub_u32 s60, s60, 1
    s_cbranch_scc1 L_exit1
    s_waitcnt lgkmcnt(0)
    v_readfirstlane_b32 s48, v10
    s_cmp_lt_u32 s48, 4
    s_cbranch_scc1 L_wf1
    s_cmp_eq_u32 s85, s88
    s_cbranch_scc1 L_fl1
    ds_read_b64 v[16:17], v8 offset:6400
    ds_read_b64 v[18:19], v8 offset:6408
    ds_read_b64 v[20:21], v8 offset:6416
    ds_read_b64 v[28:29], v8 offset:6592
    ds_read_b64 v[30:31], v8 offset:6600
    ds_read_b64 v[32:33], v8 offset:6608
    ds_read_b64 v[40:41], v8 offset:6784
    ds_read_b64 v[42:43], v8 offset:6792
    ds_read_b64 v[44:45], v8 offset:6800
    ds_read_b64 v[52:53], v8 offset:6976
    ds_read_b64 v[54:55], v8 offset:6984
    ds_read_b64 v[56:57], v8 offset:6992
    s_add_u32 s54, s33, 1048576
    s_cmp_eq_u32 s85, s88
    s_waitcnt lgkmcnt(0)
    v_cmp_eq_f32 vcc, 0, v21
    v_max3_f32 v25, v16, v17, v18
    s_nop 0
    v_cndmask_b32 v24, v21, v20, vcc
    v_max3_f32 v25, v25, v19, v20
    v_max_f32 v24, v24, v25
    v_sub_f32 v16, v16, v24
    v_sub_f32 v17, v17, v24
    v_sub_f32 v18, v18, v24
    v_sub_f32 v19, v19, v24
    v_sub_f32 v20, v20, v24
    v_sub_f32 v21, v21, v24
    v_cvt_pk_f16_f32 v25, v16, v17
    v_cvt_pk_f16_f32 v26, v18, v19
    v_cvt_pk_f16_f32 v27, v20, v21
    buffer_store_dwordx4 v[24:27], v14, s[12:15], s54 offen offset:0 sc1
    v_cmp_eq_f32 vcc, 0, v33
    v_max3_f32 v37, v28, v29, v30
    s_nop 0
    v_cndmask_b32 v36, v33, v32, vcc
    v_max3_f32 v37, v37, v31, v32
    v_max_f32 v36, v36, v37
    v_sub_f32 v28, v28, v36
    v_sub_f32 v29, v29, v36
    v_sub_f32 v30, v30, v36
    v_sub_f32 v31, v31, v36
    v_sub_f32 v32, v32, v36
    v_sub_f32 v33, v33, v36
    v_cvt_pk_f16_f32 v37, v28, v29
    v_cvt_pk_f16_f32 v38, v30, v31
    v_cvt_pk_f16_f32 v39, v32, v33
    buffer_store_dwordx4 v[36:39], v14, s[12:15], s54 offen offset:1024 sc1
    v_cmp_eq_f32 vcc, 0, v45
    v_max3_f32 v49, v40, v41, v42
    s_nop 0
    v_cndmask_b32 v48, v45, v44, vcc
    v_max3_f32 v49, v49, v43, v44
    v_max_f32 v48, v48, v49
    v_sub_f32 v40, v40, v48
    v_sub_f32 v41, v41, v48
    v_sub_f32 v42, v42, v48
    v_sub_f32 v43, v43, v48
    v_sub_f32 v44, v44, v48
    v_sub_f32 v45, v45, v48
    v_cvt_pk_f16_f32 v49, v40, v41
    v_cvt_pk_f16_f32 v50, v42, v43
    v_cvt_pk_f16_f32 v51, v44, v45
    buffer_store_dwordx4 v[48:51], v14, s[12:15], s54 offen offset:2048 sc1
    v_cmp_eq_f32 vcc, 0, v57
    v_max3_f32 v61, v52, v53, v54
    s_nop 0
    v_cndmask_b32 v60, v57, v56, vcc
    v_max3_f32 v61, v61, v55, v56
    v_max_f32 v60, v60, v61
    v_sub_f32 v52, v52, v60
    v_sub_f32 v53, v53, v60
    v_sub_f32 v54, v54, v60
    v_sub_f32 v55, v55, v60
    v_sub_f32 v56, v56, v60
    v_sub_f32 v57, v57, v60
    v_cvt_pk_f16_f32 v61, v52, v53
    v_cvt_pk_f16_f32 v62, v54, v55
    v_cvt_pk_f16_f32 v63, v56, v57
    buffer_store_dwordx4 v[60:63], v14, s[12:15], s54 offen offset:3072 sc1
L_fl1:
    s_nop 1
    v_mov_b32 v10, 2
    s_waitcnt vmcnt(0)
    s_mov_b64 exec, 1
    s_cbranch_scc1 L_fn1
    buffer_store_dword v10, off, s[12:15], s32 sc1
L_fn1:
    s_nop 1
    ds_write_b32 v2, v10 offset:52
    s_mov_b64 exec, -1
    s_mov_b32 s60, 0x100000
L_wf2:
    s_nop 1
    ds_read_b32 v10, v2 offset:48
    s_sub_u32 s60, s60, 1
    s_cbranch_scc1 L_exit1
    s_waitcnt lgkmcnt(0)
    v_readfirstlane_b32 s48, v10
    s_cmp_lt_u32 s48, 4
    s_cbranch_scc1 L_wf2
    s_cmp_eq_u32 s86, s89
    s_cbranch_scc1 L_fl2
    ds_read_b64 v[16:17], v8 offset:12544
    ds_read_b64 v[18:19], v8 offset:12552
    ds_read_b64 v[20:21], v8 offset:12560
    ds_read_b64 v[28:29], v8 offset:12736
    ds_read_b64 v[30:31], v8 offset:12744
    ds_read_b64 v[32:33], v8 offset:12752
    ds_read_b64 v[40:41], v8 offset:12928
    ds_read_b64 v[42:43], v8 offset:12936
    ds_read_b64 v[44:45], v8 offset:12944
    ds_read_b64 v[52:53], v8 offset:13120
    ds_read_b64 v[54:55], v8 offset:13128
    ds_read_b64 v[56:57], v8 offset:13136
    s_add_u32 s54, s33, 2097152
    s_cmp_eq_u32 s86, s89
    s_waitcnt lgkmcnt(0)
    v_cmp_eq_f32 vcc, 0, v21
    v_max3_f32 v25, v16, v17, v18
    s_nop 0
    v_cndmask_b32 v24, v21, v20, vcc
    v_max3_f32 v25, v25, v19, v20
    v_max_f32 v24, v24, v25
    v_sub_f32 v16, v16, v24
    v_sub_f32 v17, v17, v24
    v_sub_f32 v18, v18, v24
    v_sub_f32 v19, v19, v24
    v_sub_f32 v20, v20, v24
    v_sub_f32 v21, v21, v24
    v_cvt_pk_f16_f32 v25, v16, v17
    v_cvt_pk_f16_f32 v26, v18, v19
    v_cvt_pk_f16_f32 v27, v20, v21
    buffer_store_dwordx4 v[24:27], v14, s[12:15], s54 offen offset:0 sc1
    v_cmp_eq_f32 vcc, 0, v33
    v_max3_f32 v37, v28, v29, v30
    s_nop 0
    v_cndmask_b32 v36, v33, v32, vcc
    v_max3_f32 v37, v37, v31, v32
    v_max_f32 v36, v36, v37
    v_sub_f32 v28, v28, v36
    v_sub_f32 v29, v29, v36
    v_sub_f32 v30, v30, v36
    v_sub_f32 v31, v31, v36
    v_sub_f32 v32, v32, v36
    v_sub_f32 v33, v33, v36
    v_cvt_pk_f16_f32 v37, v28, v29
    v_cvt_pk_f16_f32 v38, v30, v31
    v_cvt_pk_f16_f32 v39, v32, v33
    buffer_store_dwordx4 v[36:39], v14, s[12:15], s54 offen offset:1024 sc1
    v_cmp_eq_f32 vcc, 0, v45
    v_max3_f32 v49, v40, v41, v42
    s_nop 0
    v_cndmask_b32 v48, v45, v44, vcc
    v_max3_f32 v49, v49, v43, v44
    v_max_f32 v48, v48, v49
    v_sub_f32 v40, v40, v48
    v_sub_f32 v41, v41, v48
    v_sub_f32 v42, v42, v48
    v_sub_f32 v43, v43, v48
    v_sub_f32 v44, v44, v48
    v_sub_f32 v45, v45, v48
    v_cvt_pk_f16_f32 v49, v40, v41
    v_cvt_pk_f16_f32 v50, v42, v43
    v_cvt_pk_f16_f32 v51, v44, v45
    buffer_store_dwordx4 v[48:51], v14, s[12:15], s54 offen offset:2048 sc1
    v_cmp_eq_f32 vcc, 0, v57
    v_max3_f32 v61, v52, v53, v54
    s_nop 0
    v_cndmask_b32 v60, v57, v56, vcc
    v_max3_f32 v61, v61, v55, v56
    v_max_f32 v60, v60, v61
    v_sub_f32 v52, v52, v60
    v_sub_f32 v53, v53, v60
    v_sub_f32 v54, v54, v60
    v_sub_f32 v55, v55, v60
    v_sub_f32 v56, v56, v60
    v_sub_f32 v57, v57, v60
    v_cvt_pk_f16_f32 v61, v52, v53
    v_cvt_pk_f16_f32 v62, v54, v55
    v_cvt_pk_f16_f32 v63, v56, v57
    buffer_store_dwordx4 v[60:63], v14, s[12:15], s54 offen offset:3072 sc1
L_fl2:
    s_nop 1
    v_mov_b32 v10, 3
    s_waitcnt vmcnt(0)
    s_mov_b64 exec, 1
    s_cbranch_scc1 L_fn2
    buffer_store_dword v10, off, s[12:15], s32 sc1
L_fn2:
    s_nop 1
    ds_write_b32 v2, v10 offset:52
    s_mov_b64 exec, -1
    s_endpgm
L_h3:
    s_nop 1
    s_waitcnt lgkmcnt(0)
    s_mov_b32 s12, s82
    s_and_b32 s13, s83, 0xffff
    s_mov_b32 s14, 10485760
    s_mov_b32 s15, 0x00020000
    s_barrier
    v_lshlrev_b32 v7, 2, v1
    s_mul_i32 s20, s4, 4352
    s_add_u32 s20, s20, 10223616
    s_lshl_b32 s21, s3, 2
    s_add_u32 s21, s21, s20
    s_mov_b32 s46, 0x155
    v_lshrrev_b32 v13, 2, v1
    v_mul_u32_u24 v13, 4352, v13
    v_and_or_b32 v13, v7, 12, v13
    s_and_b32 s7, s4, 3
    s_mul_i32 s47, s7, 4352
    s_lshl_b32 s7, s7, 2
    v_mov_b32 v8, 208
    s_mov_b32 s45, 2
    v_mov_b32 v3, 144
    v_bfrev_b32 v6, -2
    s_mov_b32 exec_hi, 0
L_h3loop:
    s_nop 1
    s_mov_b32 s60, 0x100000
L_wp1:
    s_nop 1
    ds_read_b32 v10, v2 offset:128
    s_sub_u32 s60, s60, 1
    s_cbranch_scc1 L_exit1
    s_waitcnt lgkmcnt(0)
    v_readfirstlane_b32 s48, v10
    s_cmp_lt_u32 s48, s45
    s_cbranch_scc1 L_wp1
    s_memrealtime s[40:41]
    s_add_u32 s45, s45, 3
    s_mov_b32 exec_lo, 1
    s_waitcnt lgkmcnt(0)
    v_mov_b32 v5, s40
    buffer_store_dword v5, off, s[12:15], s21
    s_mov_b32 exec_lo, -1
    s_mov_b32 s60, 0x100000
L_wp2:
    s_nop 1
    ds_read_b32 v10, v2 offset:128
    s_sub_u32 s60, s60, 1
    s_cbranch_scc1 L_exit1
    s_waitcnt lgkmcnt(0)
    v_readfirstlane_b32 s48, v10
    s_cmp_lt_u32 s48, s45
    s_cbranch_scc1 L_wp2
    buffer_load_dword v5, v7, s[12:15], s20 offen sc0
    s_add_u32 s45, s45, 4
    s_sub_u32 s40, s40, 4096
    s_waitcnt vmcnt(0)
    v_subrev_u32 v5, s40, v5
    v_cmp_gt_u32 vcc, 8192, v5
    s_nop 1
    v_cndmask_b32 v5, v6, v5, vcc
    s_mov_b32 s48, 2048
    s_add_u32 s49, s48, 2048
    v_cmp_gt_u32 vcc, s49, v5
    s_bcnt1_i32_b64 s50, vcc
    s_cmp_lt_u32 s50, 16
    s_cselect_b32 s48, s49, s48
    s_add_u32 s49, s48, 1024
    v_cmp_gt_u32 vcc, s49, v5
    s_bcnt1_i32_b64 s50, vcc
    s_cmp_lt_u32 s50, 16
    s_cselect_b32 s48, s49, s48
    s_add_u32 s49, s48, 512
    v_cmp_gt_u32 vcc, s49, v5
    s_bcnt1_i32_b64 s50, vcc
    s_cmp_lt_u32 s50, 16
    s_cselect_b32 s48, s49, s48
    s_add_u32 s49, s48, 256
    v_cmp_gt_u32 vcc, s49, v5
    s_bcnt1_i32_b64 s50, vcc
    s_cmp_lt_u32 s50, 16
    s_cselect_b32 s48, s49, s48
    s_add_u32 s49, s48, 128
    v_cmp_gt_u32 vcc, s49, v5
    s_bcnt1_i32_b64 s50, vcc
    s_cmp_lt_u32 s50, 16
    s_cselect_b32 s48, s49, s48
    s_add_u32 s49, s48, 64
    v_cmp_gt_u32 vcc, s49, v5
    s_bcnt1_i32_b64 s50, vcc
    s_cmp_lt_u32 s50, 16
    s_cselect_b32 s48, s49, s48
    s_add_u32 s49, s48, 32
    v_cmp_gt_u32 vcc, s49, v5
    s_bcnt1_i32_b64 s50, vcc
    s_cmp_lt_u32 s50, 16
    s_cselect_b32 s48, s49, s48
    s_add_u32 s49, s48, 16
    v_cmp_gt_u32 vcc, s49, v5
    s_bcnt1_i32_b64 s50, vcc
    s_cmp_lt_u32 s50, 16
    s_cselect_b32 s48, s49, s48
    s_add_u32 s49, s48, 8
    v_cmp_gt_u32 vcc, s49, v5
    s_bcnt1_i32_b64 s50, vcc
    s_cmp_lt_u32 s50, 16
    s_cselect_b32 s48, s49, s48
    s_add_u32 s49, s48, s40
    s_or_b32 s49, s49, 1
    v_mov_b32 v5, s49
    ds_write_b32 v3, v5
    v_add_u32 v3, 4, v3
    s_bitcmp1_b32 s46, 0
    s_cbranch_scc0 L_h3ng
    s_cmp_lt_u32 s48, 6136
    s_cselect_b32 exec_lo, 1, 0
    s_cmp_lt_u32 s3, 4
    s_cselect_b32 exec_lo, exec_lo, 0
    buffer_store_dword v5, off, s[12:15], s21 offset:2048 sc1
    s_mov_b32 exec_lo, 0xffff
    s_add_u32 s51, s45, 0
    s_mov_b32 s60, 0x100000
L_wp3:
    s_nop 1
    ds_read_b32 v10, v2 offset:128
    s_sub_u32 s60, s60, 1
    s_cbranch_scc1 L_exit1
    s_waitcnt lgkmcnt(0)
    v_readfirstlane_b32 s48, v10
    s_cmp_lt_u32 s48, s51
    s_cbranch_scc1 L_wp3
    s_sub_u32 s51, s20, s47
    s_mov_b32 s60, 8
    s_mov_b32 s48, 0
L_h3gp:
    s_nop 1
    buffer_load_dword v4, v13, s[12:15], s51 offen offset:2048 sc1
    s_sub_u32 s60, s60, 1
    s_cbranch_scc1 L_h3gw
L_h3gq:
    s_waitcnt vmcnt(0)
    v_subrev_u32 v4, s40, v4
    v_cmp_gt_u32 vcc, 8192, v4
    s_nop 1
    v_cndmask_b32 v4, v6, v4, vcc
    s_nop 1
    v_min_u32_dpp v4, v4, v4 quad_perm:[1,0,3,2] row_mask:0xf bank_mask:0xf
    s_nop 1
    v_min_u32_dpp v4, v4, v4 quad_perm:[2,3,0,1] row_mask:0xf bank_mask:0xf
    v_cmp_eq_u32 vcc, v6, v4
    s_cbranch_vccnz L_h3gp
    v_readlane_b32 s52, v4, 0
    v_readlane_b32 s53, v4, 4
    v_readlane_b32 s54, v4, 8
    v_readlane_b32 s55, v4, 12
    v_readlane_b32 s49, v4, s7
    s_max_u32 s52, s52, s53
    s_max_u32 s54, s54, s55
    s_max_u32 s48, s52, s54
    s_sub_u32 s48, s48, s49
    s_sub_u32 s48, s48, 10
    s_max_i32 s48, s48, 0
    s_min_i32 s48, s48, 1000
L_h3gw:
    s_nop 1
    s_or_b32 s48, s48, 0x10000
    v_mov_b32 v5, s48
    ds_write_b32 v8, v5
    s_mov_b32 exec_lo, -1
    v_add_u32 v8, 4, v8
    s_waitcnt vmcnt(0)
L_h3ng:
    s_nop 1
    s_lshr_b32 s46, s46, 1
    s_add_u32 s45, s45, 5
    s_add_u32 s20, s20, 128
    s_add_u32 s21, s21, 128
    s_cmp_lt_u32 s45, 132
    s_cbranch_scc1 L_h3loop
    s_mov_b64 exec, -1
    v_lshlrev_b32 v12, 2, v1
    v_add_u32 v13, 49408, v12
    v_lshlrev_b32 v8, 4, v1
    s_add_u32 s48, s3, 64
    s_mul_i32 s48, s48, 171
    s_lshr_b32 s48, s48, 9
    s_mul_i32 s58, s48, 4352
    s_add_u32 s58, s58, 9498368
    s_mul_i32 s59, s48, 384
    s_cmp_eq_u32 s48, 21
    s_cselect_b32 s20, 15, 23
    s_mul_i32 s48, s48, 24
    s_add_u32 s62, s2, 512
    s_sub_u32 s56, s62, s48
    s_lshl_b32 s62, s62, 10
    s_mov_b32 s60, 0x40000
L_fs:
    s_nop 1
    buffer_load_dword v4, off, s[12:15], s58 offset:4 sc1
    s_sub_u32 s60, s60, 1
    s_cbranch_scc1 L_exit1
    s_waitcnt vmcnt(0)
    v_cmp_eq_u32 vcc, 0, v4
    s_cbranch_vccnz L_fs
    buffer_load_dword v10, v12, s[12:15], s58 offen offset:128 sc1
    ds_read_b128 v[4:7], v2 offset:112
    v_xor_b32 v11, 1, v1
    v_cmp_eq_u32 vcc, s56, v1
    s_nop 1
    v_cndmask_b32 v11, v1, v11, vcc
    v_add_u32 v11, s48, v11
    v_lshlrev_b32 v11, 10, v11
    s_nop 0
    v_readlane_b32 s64, v11, 0
    v_readlane_b32 s65, v11, 1
    v_readlane_b32 s66, v11, 2
    v_readlane_b32 s67, v11, 3
    v_readlane_b32 s68, v11, 4
    v_readlane_b32 s69, v11, 5
    v_readlane_b32 s70, v11, 6
    v_readlane_b32 s71, v11, 7
    v_readlane_b32 s72, v11, 8
    v_readlane_b32 s73, v11, 9
    v_readlane_b32 s74, v11, 10
    v_readlane_b32 s75, v11, 11
    v_readlane_b32 s84, v11, 12
    v_readlane_b32 s85, v11, 13
    v_readlane_b32 s86, v11, 14
    v_readlane_b32 s87, v11, 15
    v_readlane_b32 s88, v11, 16
    v_readlane_b32 s89, v11, 17
    v_readlane_b32 s90, v11, 18
    v_readlane_b32 s91, v11, 19
    v_readlane_b32 s92, v11, 20
    v_readlane_b32 s93, v11, 21
    v_readlane_b32 s94, v11, 22
    v_readlane_b32 s95, v11, 23
    s_mov_b32 s96, s78
    s_and_b32 s97, s79, 0xffff
    s_mov_b32 s98, 12288
    s_mov_b32 s99, 0x00020000
    v_lshlrev_b32 v12, 1, v1
    s_waitcnt vmcnt(0)
    v_readlane_b32 s57, v10, s56
    v_cndmask_b32 v10, v10, v2, vcc
    s_nop 0
    v_readlane_b32 s24, v10, 0
    v_readlane_b32 s25, v10, 1
    v_readlane_b32 s26, v10, 2
    v_readlane_b32 s27, v10, 3
    v_readlane_b32 s28, v10, 4
    v_readlane_b32 s29, v10, 5
    v_readlane_b32 s30, v10, 6
    v_readlane_b32 s31, v10, 7
    v_readlane_b32 s32, v10, 8
    v_readlane_b32 s33, v10, 9
    v_readlane_b32 s34, v10, 10
    v_readlane_b32 s35, v10, 11
    v_readlane_b32 s36, v10, 12
    v_readlane_b32 s37, v10, 13
    v_readlane_b32 s38, v10, 14
    v_readlane_b32 s39, v10, 15
    v_readlane_b32 s40, v10, 16
    v_readlane_b32 s41, v10, 17
    v_readlane_b32 s42, v10, 18
    v_readlane_b32 s43, v10, 19
    v_readlane_b32 s44, v10, 20
    v_readlane_b32 s45, v10, 21
    v_readlane_b32 s46, v10, 22
    v_readlane_b32 s47, v10, 23
    v_mov_b32 v9, 1
    s_mov_b64 exec, 1
    s_mov_b32 s60, 0x100000
L_wel:
    s_nop 1
    ds_read_b32 v10, v2 offset:136
    s_sub_u32 s60, s60, 1
    s_cbranch_scc1 L_exit1
    s_waitcnt lgkmcnt(0)
    v_readfirstlane_b32 s48, v10
    s_cmp_lt_u32 s48, 4
    s_cbranch_scc1 L_wel
    buffer_atomic_add v9, off, s[12:15], s58 sc0
    s_mov_b64 exec, -1
    s_waitcnt vmcnt(0)
    v_readfirstlane_b32 s48, v9
    s_cmp_lg_u32 s48, s20
    s_cbranch_scc1 L_exit1
    buffer_load_dwordx4 v[32:35], v8, s[12:15], s64 offen sc1
    buffer_load_dwordx4 v[36:39], v8, s[12:15], s65 offen sc1
    buffer_load_dwordx4 v[40:43], v8, s[12:15], s66 offen sc1
    buffer_load_dwordx4 v[44:47], v8, s[12:15], s67 offen sc1
    buffer_load_dwordx4 v[48:51], v8, s[12:15], s68 offen sc1
    buffer_load_dwordx4 v[52:55], v8, s[12:15], s69 offen sc1
    buffer_load_dwordx4 v[56:59], v8, s[12:15], s70 offen sc1
    buffer_load_dwordx4 v[60:63], v8, s[12:15], s71 offen sc1
    buffer_load_dwordx4 v[64:67], v8, s[12:15], s72 offen sc1
    buffer_load_dwordx4 v[68:71], v8, s[12:15], s73 offen sc1
    buffer_load_dwordx4 v[72:75], v8, s[12:15], s74 offen sc1
    buffer_load_dwordx4 v[76:79], v8, s[12:15], s75 offen sc1
    buffer_load_dwordx4 v[80:83], v8, s[12:15], s84 offen sc1
    buffer_load_dwordx4 v[84:87], v8, s[12:15], s85 offen sc1
    buffer_load_dwordx4 v[88:91], v8, s[12:15], s86 offen sc1
    buffer_load_dwordx4 v[92:95], v8, s[12:15], s87 offen sc1
    buffer_load_dwordx4 v[96:99], v8, s[12:15], s88 offen sc1
    buffer_load_dwordx4 v[100:103], v8, s[12:15], s89 offen sc1
    buffer_load_dwordx4 v[104:107], v8, s[12:15], s90 offen sc1
    buffer_load_dwordx4 v[108:111], v8, s[12:15], s91 offen sc1
    buffer_load_dwordx4 v[112:115], v8, s[12:15], s92 offen sc1
    buffer_load_dwordx4 v[116:119], v8, s[12:15], s93 offen sc1
    buffer_load_dwordx4 v[120:123], v8, s[12:15], s94 offen sc1
    buffer_load_dwordx4 v[124:127], v8, s[12:15], s95 offen sc1
    s_mov_b32 s60, 0x100000
L_wn:
    s_nop 1
    ds_read_b32 v10, v2 offset:72
    s_sub_u32 s60, s60, 1
    s_cbranch_scc1 L_exit1
    s_waitcnt lgkmcnt(0)
    v_readfirstlane_b32 s48, v10
    s_cmp_lt_u32 s48, 4
    s_cbranch_scc1 L_wn
    ds_read_b32 v16, v13 offset:0
    ds_read_b32 v17, v13 offset:768
    ds_read_b32 v18, v13 offset:1536
    ds_read_b32 v19, v13 offset:2304
    ds_read_b32 v20, v13 offset:256
    ds_read_b32 v21, v13 offset:1024
    ds_read_b32 v22, v13 offset:1792
    ds_read_b32 v23, v13 offset:2560
    ds_read_b32 v24, v13 offset:512
    ds_read_b32 v25, v13 offset:1280
    ds_read_b32 v26, v13 offset:2048
    ds_read_b32 v27, v13 offset:2816
    s_mov_b32 s60, 0x40000
    s_waitcnt lgkmcnt(8)
    v_add_f32 v16, v16, v17
    v_add_f32 v18, v18, v19
    v_sub_f32 v16, v16, v6
    v_add_f32 v28, v16, v18
    s_waitcnt lgkmcnt(4)
    v_add_f32 v20, v20, v21
    v_add_f32 v22, v22, v23
    v_sub_f32 v20, v20, v6
    v_add_f32 v29, v20, v22
    s_waitcnt lgkmcnt(0)
    v_add_f32 v24, v24, v25
    v_add_f32 v26, v26, v27
    v_sub_f32 v24, v24, v6
    v_add_f32 v30, v24, v26
    s_branch L_fr2
L_fr:
    s_nop 1
    buffer_load_dwordx4 v[32:35], v8, s[12:15], s64 offen sc1
    buffer_load_dwordx4 v[36:39], v8, s[12:15], s65 offen sc1
    buffer_load_dwordx4 v[40:43], v8, s[12:15], s66 offen sc1
    buffer_load_dwordx4 v[44:47], v8, s[12:15], s67 offen sc1
    buffer_load_dwordx4 v[48:51], v8, s[12:15], s68 offen sc1
    buffer_load_dwordx4 v[52:55], v8, s[12:15], s69 offen sc1
    buffer_load_dwordx4 v[56:59], v8, s[12:15], s70 offen sc1
    buffer_load_dwordx4 v[60:63], v8, s[12:15], s71 offen sc1
    buffer_load_dwordx4 v[64:67], v8, s[12:15], s72 offen sc1
    buffer_load_dwordx4 v[68:71], v8, s[12:15], s73 offen sc1
    buffer_load_dwordx4 v[72:75], v8, s[12:15], s74 offen sc1
    buffer_load_dwordx4 v[76:79], v8, s[12:15], s75 offen sc1
    buffer_load_dwordx4 v[80:83], v8, s[12:15], s84 offen sc1
    buffer_load_dwordx4 v[84:87], v8, s[12:15], s85 offen sc1
    buffer_load_dwordx4 v[88:91], v8, s[12:15], s86 offen sc1
    buffer_load_dwordx4 v[92:95], v8, s[12:15], s87 offen sc1
    buffer_load_dwordx4 v[96:99], v8, s[12:15], s88 offen sc1
    buffer_load_dwordx4 v[100:103], v8, s[12:15], s89 offen sc1
    buffer_load_dwordx4 v[104:107], v8, s[12:15], s90 offen sc1
    buffer_load_dwordx4 v[108:111], v8, s[12:15], s91 offen sc1
    buffer_load_dwordx4 v[112:115], v8, s[12:15], s92 offen sc1
    buffer_load_dwordx4 v[116:119], v8, s[12:15], s93 offen sc1
    buffer_load_dwordx4 v[120:123], v8, s[12:15], s94 offen sc1
    buffer_load_dwordx4 v[124:127], v8, s[12:15], s95 offen sc1
L_fr2:
    v_mul_f32 v4, s57, v28
    v_mul_f32 v5, s57, v29
    v_mul_f32 v6, s57, v30
    v_mov_b32 v7, 1
    s_sub_u32 s60, s60, 1
    s_cbranch_scc1 L_exit1
    s_waitcnt vmcnt(22)
    v_fmac_f32 v4, s24, v32
    v_fmac_f32 v5, s24, v33
    v_fmac_f32 v6, s24, v34
    v_fmac_f32 v4, s25, v36
    v_fmac_f32 v5, s25, v37
    v_fmac_f32 v6, s25, v38
    v_min3_u32 v7, v7, v35, v39
    s_waitcnt vmcnt(20)
    v_fmac_f32 v4, s26, v40
    v_fmac_f32 v5, s26, v41
    v_fmac_f32 v6, s26, v42
    v_fmac_f32 v4, s27, v44
    v_fmac_f32 v5, s27, v45
    v_fmac_f32 v6, s27, v46
    v_min3_u32 v7, v7, v43, v47
    s_waitcnt vmcnt(18)
    v_fmac_f32 v4, s28, v48
    v_fmac_f32 v5, s28, v49
    v_fmac_f32 v6, s28, v50
    v_fmac_f32 v4, s29, v52
    v_fmac_f32 v5, s29, v53
    v_fmac_f32 v6, s29, v54
    v_min3_u32 v7, v7, v51, v55
    s_waitcnt vmcnt(16)
    v_fmac_f32 v4, s30, v56
    v_fmac_f32 v5, s30, v57
    v_fmac_f32 v6, s30, v58
    v_fmac_f32 v4, s31, v60
    v_fmac_f32 v5, s31, v61
    v_fmac_f32 v6, s31, v62
    v_min3_u32 v7, v7, v59, v63
    s_waitcnt vmcnt(14)
    v_fmac_f32 v4, s32, v64
    v_fmac_f32 v5, s32, v65
    v_fmac_f32 v6, s32, v66
    v_fmac_f32 v4, s33, v68
    v_fmac_f32 v5, s33, v69
    v_fmac_f32 v6, s33, v70
    v_min3_u32 v7, v7, v67, v71
    s_waitcnt vmcnt(12)
    v_fmac_f32 v4, s34, v72
    v_fmac_f32 v5, s34, v73
    v_fmac_f32 v6, s34, v74
    v_fmac_f32 v4, s35, v76
    v_fmac_f32 v5, s35, v77
    v_fmac_f32 v6, s35, v78
    v_min3_u32 v7, v7, v75, v79
    s_waitcnt vmcnt(10)
    v_fmac_f32 v4, s36, v80
    v_fmac_f32 v5, s36, v81
    v_fmac_f32 v6, s36, v82
    v_fmac_f32 v4, s37, v84
    v_fmac_f32 v5, s37, v85
    v_fmac_f32 v6, s37, v86
    v_min3_u32 v7, v7, v83, v87
    s_waitcnt vmcnt(8)
    v_fmac_f32 v4, s38, v88
    v_fmac_f32 v5, s38, v89
    v_fmac_f32 v6, s38, v90
    v_fmac_f32 v4, s39, v92
    v_fmac_f32 v5, s39, v93
    v_fmac_f32 v6, s39, v94
    v_min3_u32 v7, v7, v91, v95
    s_waitcnt vmcnt(6)
    v_fmac_f32 v4, s40, v96
    v_fmac_f32 v5, s40, v97
    v_fmac_f32 v6, s40, v98
    v_fmac_f32 v4, s41, v100
    v_fmac_f32 v5, s41, v101
    v_fmac_f32 v6, s41, v102
    v_min3_u32 v7, v7, v99, v103
    s_waitcnt vmcnt(4)
    v_fmac_f32 v4, s42, v104
    v_fmac_f32 v5, s42, v105
    v_fmac_f32 v6, s42, v106
    v_fmac_f32 v4, s43, v108
    v_fmac_f32 v5, s43, v109
    v_fmac_f32 v6, s43, v110
    v_min3_u32 v7, v7, v107, v111
    s_waitcnt vmcnt(2)
    v_fmac_f32 v4, s44, v112
    v_fmac_f32 v5, s44, v113
    v_fmac_f32 v6, s44, v114
    v_fmac_f32 v4, s45, v116
    v_fmac_f32 v5, s45, v117
    v_fmac_f32 v6, s45, v118
    v_min3_u32 v7, v7, v115, v119
    s_waitcnt vmcnt(0)
    v_fmac_f32 v4, s46, v120
    v_fmac_f32 v5, s46, v121
    v_fmac_f32 v6, s46, v122
    v_fmac_f32 v4, s47, v124
    v_fmac_f32 v5, s47, v125
    v_fmac_f32 v6, s47, v126
    v_min3_u32 v7, v7, v123, v127
    v_cmp_eq_u32 vcc, 0, v7
    v_cvt_pk_bf16_f32 v4, v4, v4
    v_cvt_pk_bf16_f32 v5, v5, v5
    v_cvt_pk_bf16_f32 v6, v6, v6
    s_cbranch_vccnz L_fr
    buffer_store_short v4, v12, s[96:99], s59 offen offset:0
    buffer_store_short v5, v12, s[96:99], s59 offen offset:128
    buffer_store_short v6, v12, s[96:99], s59 offen offset:256
L_fx:
    s_endpgm
L_h2:
    s_nop 1
    s_mov_b32 s92, s74
    s_and_b32 s93, s75, 0xffff
    s_mov_b32 s94, 2097152
    s_mov_b32 s95, 0x00020000
    s_mov_b32 s96, s76
    s_and_b32 s97, s77, 0xffff
    s_mov_b32 s98, 2097152
    s_mov_b32 s99, 0x00020000
    s_mov_b32 s60, 0x100000
L_wd2:
    s_nop 1
    ds_read_b32 v10, v2 offset:20
    s_sub_u32 s60, s60, 1
    s_cbranch_scc1 L_exit1
    s_waitcnt lgkmcnt(0)
    v_readfirstlane_b32 s48, v10
    s_cmp_eq_u32 s48, 0
    s_cbranch_scc1 L_wd2
    ds_read_b128 v[16:19], v2 offset:0
    ds_read_b64 v[20:21], v2 offset:16
    s_waitcnt lgkmcnt(0)
    v_readfirstlane_b32 s84, v16
    v_readfirstlane_b32 s85, v17
    v_readfirstlane_b32 s86, v18
    v_readfirstlane_b32 s87, v19
    v_readfirstlane_b32 s88, v20
    v_readfirstlane_b32 s89, v21
    v_and_b32 v3, 3, v1
    v_and_b32 v15, 7, v1
    v_lshrrev_b32 v12, 2, v1
    s_mov_b32 s37, 0x3dd53b95
    s_mov_b32 s38, 0xaaaaaaab
    s_mov_b32 s61, 0
    s_mul_i32 s35, s3, 32768
    s_add_u32 s35, s35, 2097152
    s_mov_b32 s40, 4096
    v_lshlrev_b32 v14, 5, v1
    v_lshrrev_b32 v8, 3, v1
    v_mul_u32_u24 v8, 24, v8
    v_mov_b32 v4, 768
    v_mad_u32_u24 v8, v15, v4, v8
    v_lshrrev_b32 v4, 3, v1
    v_lshlrev_b32 v104, 7, v15
    v_lshl_add_u32 v104, v4, 4, v104
    s_mov_b32 s34, 6
L_prep:
    s_nop 1
    s_lshl_b32 s62, s61, 5
    s_add_u32 s62, s62, s3
    s_lshl_b32 s63, s62, 15
    s_add_u32 s63, s63, 1
    s_mul_hi_u32 s63, s63, 0xaaaaaaab
    s_lshr_b32 s63, s63, 7
    s_mov_b32 s32, s84
    s_mov_b32 s39, s87
    s_mov_b32 s84, s85
    s_mov_b32 s85, s86
    s_mov_b32 s87, s88
    s_mov_b32 s88, s89
    s_lshl_b32 s33, s61, 3
    s_add_u32 s33, s33, 1
    s_and_b32 s48, s39, 7
    v_mov_b32 v9, s48
    s_bitcmp1_b32 s39, 3
    s_cselect_b64 vcc, -1, 0
    v_cndmask_b32 v9, v9, v15, vcc
    v_xor_b32 v13, s5, v9
    v_lshl_or_b32 v13, v3, 3, v13
    s_lshl_b32 s36, s62, 6
    s_mul_i32 s49, s62, 768
    s_lshl_b32 s50, s63, 2
    s_sub_u32 s49, s49, s50
    s_add_u32 s49, s49, 1179648
    s_add_u32 s33, s33, 4
    s_mov_b32 s60, 0x100000
L_wga:
    s_nop 1
    ds_read_b32 v10, v2 offset:60
    s_sub_u32 s60, s60, 1
    s_cbranch_scc1 L_exit1
    s_waitcnt lgkmcnt(0)
    v_readfirstlane_b32 s48, v10
    s_cmp_lt_u32 s48, s33
    s_cbranch_scc1 L_wga
    v_add_u32 v4, 0, v12
    v_bfe_u32 v5, v4, 3, 2
    v_and_or_b32 v5, v4, 4, v5
    v_xor_b32 v5, v13, v5
    v_add_u32 v4, s36, v4
    v_lshl_add_u32 v6, v4, 5, v5
    v_lshl_add_u32 v6, v6, 4, 1
    v_mul_hi_u32 v6, v6, s38
    v_lshrrev_b32 v6, 1, v6
    v_lshrrev_b32 v22, 6, v6
    v_lshl_add_u32 v22, v22, 2, s49
    v_and_b32 v7, 15, v6
    v_cmp_eq_u32 s[24:25], 5, v7
    v_and_b32 v23, 1, v6
    v_lshlrev_b32 v23, 4, v23
    s_waitcnt vmcnt(0)
    v_add_u32 v4, 16, v12
    v_bfe_u32 v5, v4, 3, 2
    v_and_or_b32 v5, v4, 4, v5
    v_xor_b32 v5, v13, v5
    v_add_u32 v4, s36, v4
    v_lshl_add_u32 v6, v4, 5, v5
    v_lshl_add_u32 v6, v6, 4, 1
    v_mul_hi_u32 v6, v6, s38
    v_lshrrev_b32 v6, 1, v6
    v_lshrrev_b32 v38, 6, v6
    v_lshl_add_u32 v38, v38, 2, s49
    v_and_b32 v7, 15, v6
    v_cmp_eq_u32 s[26:27], 5, v7
    v_and_b32 v39, 1, v6
    v_lshlrev_b32 v39, 4, v39
    s_waitcnt vmcnt(0)
    v_add_u32 v4, 32, v12
    v_bfe_u32 v5, v4, 3, 2
    v_and_or_b32 v5, v4, 4, v5
    v_xor_b32 v5, v13, v5
    v_add_u32 v4, s36, v4
    v_lshl_add_u32 v6, v4, 5, v5
    v_lshl_add_u32 v6, v6, 4, 1
    v_mul_hi_u32 v6, v6, s38
    v_lshrrev_b32 v6, 1, v6
    v_lshrrev_b32 v54, 6, v6
    v_lshl_add_u32 v54, v54, 2, s49
    v_and_b32 v7, 15, v6
    v_cmp_eq_u32 s[28:29], 5, v7
    v_and_b32 v55, 1, v6
    v_lshlrev_b32 v55, 4, v55
    s_waitcnt vmcnt(0)
    v_add_u32 v4, 48, v12
    v_bfe_u32 v5, v4, 3, 2
    v_and_or_b32 v5, v4, 4, v5
    v_xor_b32 v5, v13, v5
    v_add_u32 v4, s36, v4
    v_lshl_add_u32 v6, v4, 5, v5
    v_lshl_add_u32 v6, v6, 4, 1
    v_mul_hi_u32 v6, v6, s38
    v_lshrrev_b32 v6, 1, v6
    v_lshrrev_b32 v70, 6, v6
    v_lshl_add_u32 v70, v70, 2, s49
    v_and_b32 v7, 15, v6
    v_cmp_eq_u32 s[30:31], 5, v7
    v_and_b32 v71, 1, v6
    v_lshlrev_b32 v71, 4, v71
    s_waitcnt vmcnt(0)
    s_add_u32 s33, s61, 1
    s_mov_b32 s60, 0x100000
L_wfd:
    s_nop 1
    ds_read_b32 v10, v2 offset:52
    s_sub_u32 s60, s60, 1
    s_cbranch_scc1 L_exit1
    s_waitcnt lgkmcnt(0)
    v_readfirstlane_b32 s48, v10
    s_cmp_lt_u32 s48, s33
    s_cbranch_scc1 L_wfd
    v_mul_u32_u24 v4, 4352, v1
    s_xor_b32 s48, s32, s39
    s_xor_b32 s48, s48, s5
    s_and_b32 s48, s48, 7
    v_mov_b32 v6, s33
    s_lshl_b64 vcc, 1, s48
    s_or_b32 s48, s32, s39
    s_bitcmp1_b32 s48, 3
    s_cselect_b64 vcc, 0xff, vcc
    s_cmp_eq_u32 s32, s39
    s_cselect_b64 vcc, 0, vcc
    s_max_u32 s48, s61, 1
    v_mov_b32 v7, s48
    v_cndmask_b32 v6, v7, v6, vcc
    s_cmp_ge_u32 s61, 1
    s_cselect_b64 exec, vcc, 0xff
    s_mov_b32 s60, 0x40000
    s_cbranch_execz L_noflags
L_flags:
    s_nop 1
    buffer_load_dword v5, v4, s[12:15], s59 offen sc1
    s_sub_u32 s60, s60, 1
    s_cbranch_scc1 L_exit1
    s_waitcnt vmcnt(0)
    v_cmpx_gt_u32 vcc, v6, v5
    s_cbranch_execnz L_flags
L_noflags:
    s_nop 1
    s_mov_b64 exec, -1
    buffer_load_dword v22, v22, s[12:15], 0 offen sc1
    buffer_load_dword v38, v38, s[12:15], 0 offen sc1
    buffer_load_dword v54, v54, s[12:15], 0 offen sc1
    buffer_load_dword v70, v70, s[12:15], 0 offen sc1
    s_bitcmp1_b32 s39, 3
    s_cselect_b32 s49, 0, 7
    s_xor_b32 s50, s32, s39
    s_bitcmp1_b32 s50, 3
    s_cselect_b32 s51, 7, 0
    s_and_b32 s50, s50, 7
    s_and_b32 s52, s39, 7
    v_lshrrev_b32 v4, 3, v1
    v_cmp_gt_u32 vcc, s34, v4
    v_and_b32 v6, s51, v15
    v_xor_b32 v6, s50, v6
    v_and_b32 v5, s49, v15
    v_xor_b32 v5, s52, v5
    v_cndmask_b32 v5, v6, v5, vcc
    v_cmp_ne_u32 s[64:65], 0, v5
    v_xor_b32 v5, s5, v5
    v_mad_u32_u24 v5, v5, s40, v104
    v_cmp_ne_u32 s[66:67], 0, v6
    v_xor_b32 v6, s5, v6
    v_mad_u32_u24 v6, v6, s40, v104
    s_mov_b64 exec, s[64:65]
    buffer_load_dwordx4 v[80:83], v5, s[12:15], s35 offen offset:0 sc1
    s_mov_b64 exec, s[66:67]
    buffer_load_dwordx4 v[84:87], v6, s[12:15], s35 offen offset:1024 sc1
    buffer_load_dwordx4 v[88:91], v6, s[12:15], s35 offen offset:2048 sc1
    buffer_load_dwordx4 v[92:95], v6, s[12:15], s35 offen offset:3072 sc1
    s_mov_b64 exec, -1
    v_add_u32 v4, 0, v12
    v_bfe_u32 v5, v4, 3, 2
    v_and_or_b32 v5, v4, 4, v5
    v_xor_b32 v5, v13, v5
    v_add_u32 v4, s36, v4
    v_lshl_add_u32 v6, v4, 5, v5
    v_lshl_add_u32 v6, v6, 4, 1
    v_mul_hi_u32 v6, v6, s38
    v_lshrrev_b32 v6, 1, v6
    v_lshrrev_b32 v11, 1, v6
    v_lshlrev_b32 v11, 2, v11
    s_memrealtime s[42:43]
    s_waitcnt lgkmcnt(0)
L_tw1:
    s_nop 1
    s_memrealtime s[44:45]
    s_waitcnt lgkmcnt(0)
    s_sub_u32 s45, s44, s42
    s_cmp_lt_i32 s45, 0
    s_cbranch_scc1 L_tw1
    s_add_u32 s42, s44, 140
    s_mov_b32 exec_lo, 0xffffffff
    s_mov_b32 exec_hi, 0x0
    buffer_load_dwordx3 v[24:26], v11, s[92:95], 0 offen
    buffer_load_dword v27, v11, s[92:95], 0 offen offset:12
L_tw2:
    s_nop 1
    s_memrealtime s[44:45]
    s_waitcnt lgkmcnt(0)
    s_sub_u32 s45, s44, s42
    s_cmp_lt_i32 s45, 0
    s_cbranch_scc1 L_tw2
    s_add_u32 s42, s44, 140
    s_mov_b32 exec_lo, 0x0
    s_mov_b32 exec_hi, 0xffffffff
    buffer_load_dwordx3 v[24:26], v11, s[92:95], 0 offen
    buffer_load_dword v27, v11, s[92:95], 0 offen offset:12
    s_mov_b64 exec, -1
L_tw3:
    s_nop 1
    s_memrealtime s[44:45]
    s_waitcnt lgkmcnt(0)
    s_sub_u32 s45, s44, s42
    s_cmp_lt_i32 s45, 0
    s_cbranch_scc1 L_tw3
    s_add_u32 s42, s44, 140
    s_mov_b32 exec_lo, 0xffffffff
    s_mov_b32 exec_hi, 0x0
    buffer_load_dwordx3 v[28:30], v11, s[96:99], 0 offen
    buffer_load_dword v31, v11, s[96:99], 0 offen offset:12
L_tw4:
    s_nop 1
    s_memrealtime s[44:45]
    s_waitcnt lgkmcnt(0)
    s_sub_u32 s45, s44, s42
    s_cmp_lt_i32 s45, 0
    s_cbranch_scc1 L_tw4
    s_add_u32 s42, s44, 140
    s_mov_b32 exec_lo, 0x0
    s_mov_b32 exec_hi, 0xffffffff
    buffer_load_dwordx3 v[28:30], v11, s[96:99], 0 offen
    buffer_load_dword v31, v11, s[96:99], 0 offen offset:12
    s_mov_b64 exec, -1
    v_add_u32 v4, 16, v12
    v_bfe_u32 v5, v4, 3, 2
    v_and_or_b32 v5, v4, 4, v5
    v_xor_b32 v5, v13, v5
    v_add_u32 v4, s36, v4
    v_lshl_add_u32 v6, v4, 5, v5
    v_lshl_add_u32 v6, v6, 4, 1
    v_mul_hi_u32 v6, v6, s38
    v_lshrrev_b32 v6, 1, v6
    v_lshrrev_b32 v11, 1, v6
    v_lshlrev_b32 v11, 2, v11
L_tw5:
    s_nop 1
    s_memrealtime s[44:45]
    s_waitcnt lgkmcnt(0)
    s_sub_u32 s45, s44, s42
    s_cmp_lt_i32 s45, 0
    s_cbranch_scc1 L_tw5
    s_add_u32 s42, s44, 140
    s_mov_b32 exec_lo, 0xffffffff
    s_mov_b32 exec_hi, 0x0
    buffer_load_dwordx3 v[40:42], v11, s[92:95], 0 offen
    buffer_load_dword v43, v11, s[92:95], 0 offen offset:12
L_tw6:
    s_nop 1
    s_memrealtime s[44:45]
    s_waitcnt lgkmcnt(0)
    s_sub_u32 s45, s44, s42
    s_cmp_lt_i32 s45, 0
    s_cbranch_scc1 L_tw6
    s_add_u32 s42, s44, 140
    s_mov_b32 exec_lo, 0x0
    s_mov_b32 exec_hi, 0xffffffff
    buffer_load_dwordx3 v[40:42], v11, s[92:95], 0 offen
    buffer_load_dword v43, v11, s[92:95], 0 offen offset:12
    s_mov_b64 exec, -1
L_tw7:
    s_nop 1
    s_memrealtime s[44:45]
    s_waitcnt lgkmcnt(0)
    s_sub_u32 s45, s44, s42
    s_cmp_lt_i32 s45, 0
    s_cbranch_scc1 L_tw7
    s_add_u32 s42, s44, 140
    s_mov_b32 exec_lo, 0xffffffff
    s_mov_b32 exec_hi, 0x0
    buffer_load_dwordx3 v[44:46], v11, s[96:99], 0 offen
    buffer_load_dword v47, v11, s[96:99], 0 offen offset:12
L_tw8:
    s_nop 1
    s_memrealtime s[44:45]
    s_waitcnt lgkmcnt(0)
    s_sub_u32 s45, s44, s42
    s_cmp_lt_i32 s45, 0
    s_cbranch_scc1 L_tw8
    s_add_u32 s42, s44, 140
    s_mov_b32 exec_lo, 0x0
    s_mov_b32 exec_hi, 0xffffffff
    buffer_load_dwordx3 v[44:46], v11, s[96:99], 0 offen
    buffer_load_dword v47, v11, s[96:99], 0 offen offset:12
    s_mov_b64 exec, -1
    v_add_u32 v4, 32, v12
    v_bfe_u32 v5, v4, 3, 2
    v_and_or_b32 v5, v4, 4, v5
    v_xor_b32 v5, v13, v5
    v_add_u32 v4, s36, v4
    v_lshl_add_u32 v6, v4, 5, v5
    v_lshl_add_u32 v6, v6, 4, 1
    v_mul_hi_u32 v6, v6, s38
    v_lshrrev_b32 v6, 1, v6
    v_lshrrev_b32 v11, 1, v6
    v_lshlrev_b32 v11, 2, v11
L_tw9:
    s_nop 1
    s_memrealtime s[44:45]
    s_waitcnt lgkmcnt(0)
    s_sub_u32 s45, s44, s42
    s_cmp_lt_i32 s45, 0
    s_cbranch_scc1 L_tw9
    s_add_u32 s42, s44, 140
    s_mov_b32 exec_lo, 0xffffffff
    s_mov_b32 exec_hi, 0x0
    buffer_load_dwordx3 v[56:58], v11, s[92:95], 0 offen
    buffer_load_dword v59, v11, s[92:95], 0 offen offset:12
L_tw10:
    s_nop 1
    s_memrealtime s[44:45]
    s_waitcnt lgkmcnt(0)
    s_sub_u32 s45, s44, s42
    s_cmp_lt_i32 s45, 0
    s_cbranch_scc1 L_tw10
    s_add_u32 s42, s44, 140
    s_mov_b32 exec_lo, 0x0
    s_mov_b32 exec_hi, 0xffffffff
    buffer_load_dwordx3 v[56:58], v11, s[92:95], 0 offen
    buffer_load_dword v59, v11, s[92:95], 0 offen offset:12
    s_mov_b64 exec, -1
L_tw11:
    s_nop 1
    s_memrealtime s[44:45]
    s_waitcnt lgkmcnt(0)
    s_sub_u32 s45, s44, s42
    s_cmp_lt_i32 s45, 0
    s_cbranch_scc1 L_tw11
    s_add_u32 s42, s44, 140
    s_mov_b32 exec_lo, 0xffffffff
    s_mov_b32 exec_hi, 0x0
    buffer_load_dwordx3 v[60:62], v11, s[96:99], 0 offen
    buffer_load_dword v63, v11, s[96:99], 0 offen offset:12
L_tw12:
    s_nop 1
    s_memrealtime s[44:45]
    s_waitcnt lgkmcnt(0)
    s_sub_u32 s45, s44, s42
    s_cmp_lt_i32 s45, 0
    s_cbranch_scc1 L_tw12
    s_add_u32 s42, s44, 140
    s_mov_b32 exec_lo, 0x0
    s_mov_b32 exec_hi, 0xffffffff
    buffer_load_dwordx3 v[60:62], v11, s[96:99], 0 offen
    buffer_load_dword v63, v11, s[96:99], 0 offen offset:12
    s_mov_b64 exec, -1
    v_add_u32 v4, 48, v12
    v_bfe_u32 v5, v4, 3, 2
    v_and_or_b32 v5, v4, 4, v5
    v_xor_b32 v5, v13, v5
    v_add_u32 v4, s36, v4
    v_lshl_add_u32 v6, v4, 5, v5
    v_lshl_add_u32 v6, v6, 4, 1
    v_mul_hi_u32 v6, v6, s38
    v_lshrrev_b32 v6, 1, v6
    v_lshrrev_b32 v11, 1, v6
    v_lshlrev_b32 v11, 2, v11
L_tw13:
    s_nop 1
    s_memrealtime s[44:45]
    s_waitcnt lgkmcnt(0)
    s_sub_u32 s45, s44, s42
    s_cmp_lt_i32 s45, 0
    s_cbranch_scc1 L_tw13
    s_add_u32 s42, s44, 140
    s_mov_b32 exec_lo, 0xffffffff
    s_mov_b32 exec_hi, 0x0
    buffer_load_dwordx3 v[72:74], v11, s[92:95], 0 offen
    buffer_load_dword v75, v11, s[92:95], 0 offen offset:12
L_tw14:
    s_nop 1
    s_memrealtime s[44:45]
    s_waitcnt lgkmcnt(0)
    s_sub_u32 s45, s44, s42
    s_cmp_lt_i32 s45, 0
    s_cbranch_scc1 L_tw14
    s_add_u32 s42, s44, 140
    s_mov_b32 exec_lo, 0x0
    s_mov_b32 exec_hi, 0xffffffff
    buffer_load_dwordx3 v[72:74], v11, s[92:95], 0 offen
    buffer_load_dword v75, v11, s[92:95], 0 offen offset:12
    s_mov_b64 exec, -1
L_tw15:
    s_nop 1
    s_memrealtime s[44:45]
    s_waitcnt lgkmcnt(0)
    s_sub_u32 s45, s44, s42
    s_cmp_lt_i32 s45, 0
    s_cbranch_scc1 L_tw15
    s_add_u32 s42, s44, 140
    s_mov_b32 exec_lo, 0xffffffff
    s_mov_b32 exec_hi, 0x0
    buffer_load_dwordx3 v[76:78], v11, s[96:99], 0 offen
    buffer_load_dword v79, v11, s[96:99], 0 offen offset:12
L_tw16:
    s_nop 1
    s_memrealtime s[44:45]
    s_waitcnt lgkmcnt(0)
    s_sub_u32 s45, s44, s42
    s_cmp_lt_i32 s45, 0
    s_cbranch_scc1 L_tw16
    s_add_u32 s42, s44, 140
    s_mov_b32 exec_lo, 0x0
    s_mov_b32 exec_hi, 0xffffffff
    buffer_load_dwordx3 v[76:78], v11, s[96:99], 0 offen
    buffer_load_dword v79, v11, s[96:99], 0 offen offset:12
    s_mov_b64 exec, -1
    ds_read_b64 v[16:17], v8 offset:256
    ds_read_b64 v[18:19], v8 offset:264
    ds_read_b64 v[20:21], v8 offset:272
    ds_read_b64 v[32:33], v8 offset:448
    ds_read_b64 v[34:35], v8 offset:456
    ds_read_b64 v[36:37], v8 offset:464
    ds_read_b64 v[48:49], v8 offset:640
    ds_read_b64 v[50:51], v8 offset:648
    ds_read_b64 v[52:53], v8 offset:656
    ds_read_b64 v[64:65], v8 offset:832
    ds_read_b64 v[66:67], v8 offset:840
    ds_read_b64 v[68:69], v8 offset:848
    s_mov_b32 s34, 0
    v_mov_b32 v5, 0xf149f2ca
    v_mov_b32 v4, 0xf149f2ca
    s_waitcnt vmcnt(0) lgkmcnt(0)
    s_mov_b64 exec, s[64:65]
    v_fma_mix_f32 v16, v81, 1.0, v80 op_sel:[0,0,0] op_sel_hi:[1,0,0]
    v_fma_mix_f32 v17, v81, 1.0, v80 op_sel:[1,0,0] op_sel_hi:[1,0,0]
    v_fma_mix_f32 v18, v82, 1.0, v80 op_sel:[0,0,0] op_sel_hi:[1,0,0]
    v_fma_mix_f32 v19, v82, 1.0, v80 op_sel:[1,0,0] op_sel_hi:[1,0,0]
    v_fma_mix_f32 v20, v83, 1.0, v80 op_sel:[0,0,0] op_sel_hi:[1,0,0]
    v_fma_mix_f32 v21, v83, 1.0, v80 op_sel:[1,0,0] op_sel_hi:[1,0,0]
    v_cmp_lt_f32 vcc, v80, v21
    s_nop 1
    v_cndmask_b32 v21, v21, v2, vcc
    s_mov_b64 exec, s[66:67]
    v_fma_mix_f32 v32, v85, 1.0, v84 op_sel:[0,0,0] op_sel_hi:[1,0,0]
    v_fma_mix_f32 v33, v85, 1.0, v84 op_sel:[1,0,0] op_sel_hi:[1,0,0]
    v_fma_mix_f32 v34, v86, 1.0, v84 op_sel:[0,0,0] op_sel_hi:[1,0,0]
    v_fma_mix_f32 v35, v86, 1.0, v84 op_sel:[1,0,0] op_sel_hi:[1,0,0]
    v_fma_mix_f32 v36, v87, 1.0, v84 op_sel:[0,0,0] op_sel_hi:[1,0,0]
    v_fma_mix_f32 v37, v87, 1.0, v84 op_sel:[1,0,0] op_sel_hi:[1,0,0]
    v_cmp_lt_f32 vcc, v84, v37
    s_nop 1
    v_cndmask_b32 v37, v37, v2, vcc
    v_fma_mix_f32 v48, v89, 1.0, v88 op_sel:[0,0,0] op_sel_hi:[1,0,0]
    v_fma_mix_f32 v49, v89, 1.0, v88 op_sel:[1,0,0] op_sel_hi:[1,0,0]
    v_fma_mix_f32 v50, v90, 1.0, v88 op_sel:[0,0,0] op_sel_hi:[1,0,0]
    v_fma_mix_f32 v51, v90, 1.0, v88 op_sel:[1,0,0] op_sel_hi:[1,0,0]
    v_fma_mix_f32 v52, v91, 1.0, v88 op_sel:[0,0,0] op_sel_hi:[1,0,0]
    v_fma_mix_f32 v53, v91, 1.0, v88 op_sel:[1,0,0] op_sel_hi:[1,0,0]
    v_cmp_lt_f32 vcc, v88, v53
    s_nop 1
    v_cndmask_b32 v53, v53, v2, vcc
    v_fma_mix_f32 v64, v93, 1.0, v92 op_sel:[0,0,0] op_sel_hi:[1,0,0]
    v_fma_mix_f32 v65, v93, 1.0, v92 op_sel:[1,0,0] op_sel_hi:[1,0,0]
    v_fma_mix_f32 v66, v94, 1.0, v92 op_sel:[0,0,0] op_sel_hi:[1,0,0]
    v_fma_mix_f32 v67, v94, 1.0, v92 op_sel:[1,0,0] op_sel_hi:[1,0,0]
    v_fma_mix_f32 v68, v95, 1.0, v92 op_sel:[0,0,0] op_sel_hi:[1,0,0]
    v_fma_mix_f32 v69, v95, 1.0, v92 op_sel:[1,0,0] op_sel_hi:[1,0,0]
    v_cmp_lt_f32 vcc, v92, v69
    s_nop 1
    v_cndmask_b32 v69, v69, v2, vcc
    s_mov_b64 exec, -1
    v_sub_f32 v16, v16, v22
    v_sub_f32 v17, v17, v22
    v_sub_f32 v18, v18, v22
    v_sub_f32 v19, v19, v22
    v_sub_f32 v20, v20, v22
    v_sub_f32 v21, v21, v22
    v_mul_f32 v16, s37, v16
    v_mul_f32 v17, s37, v17
    v_mul_f32 v18, s37, v18
    v_mul_f32 v19, s37, v19
    v_mul_f32 v20, s37, v20
    v_mul_f32 v21, s37, v21
    v_cndmask_b32 v21, v5, v21, s[24:25]
    v_max3_f32 v4, v4, v16, v17
    v_max3_f32 v4, v4, v18, v19
    v_max3_f32 v4, v4, v20, v21
    v_alignbit_b32 v24, v25, v24, v23
    v_alignbit_b32 v25, v26, v25, v23
    v_alignbit_b32 v26, v27, v26, v23
    v_alignbit_b32 v28, v29, v28, v23
    v_alignbit_b32 v29, v30, v29, v23
    v_alignbit_b32 v30, v31, v30, v23
    v_sub_f32 v32, v32, v38
    v_sub_f32 v33, v33, v38
    v_sub_f32 v34, v34, v38
    v_sub_f32 v35, v35, v38
    v_sub_f32 v36, v36, v38
    v_sub_f32 v37, v37, v38
    v_mul_f32 v32, s37, v32
    v_mul_f32 v33, s37, v33
    v_mul_f32 v34, s37, v34
    v_mul_f32 v35, s37, v35
    v_mul_f32 v36, s37, v36
    v_mul_f32 v37, s37, v37
    v_cndmask_b32 v37, v5, v37, s[26:27]
    v_max3_f32 v4, v4, v32, v33
    v_max3_f32 v4, v4, v34, v35
    v_max3_f32 v4, v4, v36, v37
    v_alignbit_b32 v40, v41, v40, v39
    v_alignbit_b32 v41, v42, v41, v39
    v_alignbit_b32 v42, v43, v42, v39
    v_alignbit_b32 v44, v45, v44, v39
    v_alignbit_b32 v45, v46, v45, v39
    v_alignbit_b32 v46, v47, v46, v39
    v_sub_f32 v48, v48, v54
    v_sub_f32 v49, v49, v54
    v_sub_f32 v50, v50, v54
    v_sub_f32 v51, v51, v54
    v_sub_f32 v52, v52, v54
    v_sub_f32 v53, v53, v54
    v_mul_f32 v48, s37, v48
    v_mul_f32 v49, s37, v49
    v_mul_f32 v50, s37, v50
    v_mul_f32 v51, s37, v51
    v_mul_f32 v52, s37, v52
    v_mul_f32 v53, s37, v53
    v_cndmask_b32 v53, v5, v53, s[28:29]
    v_max3_f32 v4, v4, v48, v49
    v_max3_f32 v4, v4, v50, v51
    v_max3_f32 v4, v4, v52, v53
    v_alignbit_b32 v56, v57, v56, v55
    v_alignbit_b32 v57, v58, v57, v55
    v_alignbit_b32 v58, v59, v58, v55
    v_alignbit_b32 v60, v61, v60, v55
    v_alignbit_b32 v61, v62, v61, v55
    v_alignbit_b32 v62, v63, v62, v55
    v_sub_f32 v64, v64, v70
    v_sub_f32 v65, v65, v70
    v_sub_f32 v66, v66, v70
    v_sub_f32 v67, v67, v70
    v_sub_f32 v68, v68, v70
    v_sub_f32 v69, v69, v70
    v_mul_f32 v64, s37, v64
    v_mul_f32 v65, s37, v65
    v_mul_f32 v66, s37, v66
    v_mul_f32 v67, s37, v67
    v_mul_f32 v68, s37, v68
    v_mul_f32 v69, s37, v69
    v_cndmask_b32 v69, v5, v69, s[30:31]
    v_max3_f32 v4, v4, v64, v65
    v_max3_f32 v4, v4, v66, v67
    v_max3_f32 v4, v4, v68, v69
    v_alignbit_b32 v72, v73, v72, v71
    v_alignbit_b32 v73, v74, v73, v71
    v_alignbit_b32 v74, v75, v74, v71
    v_alignbit_b32 v76, v77, v76, v71
    v_alignbit_b32 v77, v78, v77, v71
    v_alignbit_b32 v78, v79, v78, v71
    v_max_f32_dpp v4, v4, v4 row_ror:8 row_mask:0xf bank_mask:0xf
    s_nop 1
    v_max_f32_dpp v4, v4, v4 row_ror:4 row_mask:0xf bank_mask:0xf
    s_nop 1
    v_max_f32_dpp v4, v4, v4 row_ror:2 row_mask:0xf bank_mask:0xf
    s_nop 1
    v_max_f32_dpp v4, v4, v4 row_ror:1 row_mask:0xf bank_mask:0xf
    v_mov_b32 v5, v4
    s_nop 1
    v_permlane32_swap_b32 v4, v5
    v_max_f32 v4, v4, v5
    v_mov_b32 v5, v4
    s_nop 1
    v_permlane16_swap_b32 v4, v5
    v_max_f32 v4, v4, v5
    v_mov_b32 v5, 0
    v_mov_b32 v6, 0
    v_sub_f32 v16, v16, v4
    v_sub_f32 v17, v17, v4
    v_sub_f32 v18, v18, v4
    v_sub_f32 v19, v19, v4
    v_sub_f32 v20, v20, v4
    v_sub_f32 v21, v21, v4
    v_exp_f32 v16, v16
    v_exp_f32 v17, v17
    v_exp_f32 v18, v18
    v_exp_f32 v19, v19
    v_exp_f32 v20, v20
    v_exp_f32 v21, v21
    v_add_f32 v5, v5, v16
    v_lshlrev_b32 v10, 16, v24
    v_lshlrev_b32 v11, 16, v28
    v_mul_f32 v16, v16, v10
    v_fmac_f32 v6, v16, v11
    v_add_f32 v5, v5, v17
    v_and_b32 v10, 0xffff0000, v24
    v_and_b32 v11, 0xffff0000, v28
    v_mul_f32 v17, v17, v10
    v_fmac_f32 v6, v17, v11
    v_add_f32 v5, v5, v18
    v_lshlrev_b32 v10, 16, v25
    v_lshlrev_b32 v11, 16, v29
    v_mul_f32 v18, v18, v10
    v_fmac_f32 v6, v18, v11
    v_add_f32 v5, v5, v19
    v_and_b32 v10, 0xffff0000, v25
    v_and_b32 v11, 0xffff0000, v29
    v_mul_f32 v19, v19, v10
    v_fmac_f32 v6, v19, v11
    v_add_f32 v5, v5, v20
    v_lshlrev_b32 v10, 16, v26
    v_lshlrev_b32 v11, 16, v30
    v_mul_f32 v20, v20, v10
    v_fmac_f32 v6, v20, v11
    v_add_f32 v5, v5, v21
    v_and_b32 v10, 0xffff0000, v26
    v_and_b32 v11, 0xffff0000, v30
    v_mul_f32 v21, v21, v10
    v_fmac_f32 v6, v21, v11
    ds_write_b128 v14, v[16:19] offset:18688
    ds_write_b64 v14, v[20:21] offset:18704
    v_sub_f32 v32, v32, v4
    v_sub_f32 v33, v33, v4
    v_sub_f32 v34, v34, v4
    v_sub_f32 v35, v35, v4
    v_sub_f32 v36, v36, v4
    v_sub_f32 v37, v37, v4
    v_exp_f32 v32, v32
    v_exp_f32 v33, v33
    v_exp_f32 v34, v34
    v_exp_f32 v35, v35
    v_exp_f32 v36, v36
    v_exp_f32 v37, v37
    v_add_f32 v5, v5, v32
    v_lshlrev_b32 v10, 16, v40
    v_lshlrev_b32 v11, 16, v44
    v_mul_f32 v32, v32, v10
    v_fmac_f32 v6, v32, v11
    v_add_f32 v5, v5, v33
    v_and_b32 v10, 0xffff0000, v40
    v_and_b32 v11, 0xffff0000, v44
    v_mul_f32 v33, v33, v10
    v_fmac_f32 v6, v33, v11
    v_add_f32 v5, v5, v34
    v_lshlrev_b32 v10, 16, v41
    v_lshlrev_b32 v11, 16, v45
    v_mul_f32 v34, v34, v10
    v_fmac_f32 v6, v34, v11
    v_add_f32 v5, v5, v35
    v_and_b32 v10, 0xffff0000, v41
    v_and_b32 v11, 0xffff0000, v45
    v_mul_f32 v35, v35, v10
    v_fmac_f32 v6, v35, v11
    v_add_f32 v5, v5, v36
    v_lshlrev_b32 v10, 16, v42
    v_lshlrev_b32 v11, 16, v46
    v_mul_f32 v36, v36, v10
    v_fmac_f32 v6, v36, v11
    v_add_f32 v5, v5, v37
    v_and_b32 v10, 0xffff0000, v42
    v_and_b32 v11, 0xffff0000, v46
    v_mul_f32 v37, v37, v10
    v_fmac_f32 v6, v37, v11
    ds_write_b128 v14, v[32:35] offset:20736
    ds_write_b64 v14, v[36:37] offset:20752
    v_sub_f32 v48, v48, v4
    v_sub_f32 v49, v49, v4
    v_sub_f32 v50, v50, v4
    v_sub_f32 v51, v51, v4
    v_sub_f32 v52, v52, v4
    v_sub_f32 v53, v53, v4
    v_exp_f32 v48, v48
    v_exp_f32 v49, v49
    v_exp_f32 v50, v50
    v_exp_f32 v51, v51
    v_exp_f32 v52, v52
    v_exp_f32 v53, v53
    v_add_f32 v5, v5, v48
    v_lshlrev_b32 v10, 16, v56
    v_lshlrev_b32 v11, 16, v60
    v_mul_f32 v48, v48, v10
    v_fmac_f32 v6, v48, v11
    v_add_f32 v5, v5, v49
    v_and_b32 v10, 0xffff0000, v56
    v_and_b32 v11, 0xffff0000, v60
    v_mul_f32 v49, v49, v10
    v_fmac_f32 v6, v49, v11
    v_add_f32 v5, v5, v50
    v_lshlrev_b32 v10, 16, v57
    v_lshlrev_b32 v11, 16, v61
    v_mul_f32 v50, v50, v10
    v_fmac_f32 v6, v50, v11
    v_add_f32 v5, v5, v51
    v_and_b32 v10, 0xffff0000, v57
    v_and_b32 v11, 0xffff0000, v61
    v_mul_f32 v51, v51, v10
    v_fmac_f32 v6, v51, v11
    v_add_f32 v5, v5, v52
    v_lshlrev_b32 v10, 16, v58
    v_lshlrev_b32 v11, 16, v62
    v_mul_f32 v52, v52, v10
    v_fmac_f32 v6, v52, v11
    v_add_f32 v5, v5, v53
    v_and_b32 v10, 0xffff0000, v58
    v_and_b32 v11, 0xffff0000, v62
    v_mul_f32 v53, v53, v10
    v_fmac_f32 v6, v53, v11
    ds_write_b128 v14, v[48:51] offset:22784
    ds_write_b64 v14, v[52:53] offset:22800
    v_sub_f32 v64, v64, v4
    v_sub_f32 v65, v65, v4
    v_sub_f32 v66, v66, v4
    v_sub_f32 v67, v67, v4
    v_sub_f32 v68, v68, v4
    v_sub_f32 v69, v69, v4
    v_exp_f32 v64, v64
    v_exp_f32 v65, v65
    v_exp_f32 v66, v66
    v_exp_f32 v67, v67
    v_exp_f32 v68, v68
    v_exp_f32 v69, v69
    v_add_f32 v5, v5, v64
    v_lshlrev_b32 v10, 16, v72
    v_lshlrev_b32 v11, 16, v76
    v_mul_f32 v64, v64, v10
    v_fmac_f32 v6, v64, v11
    v_add_f32 v5, v5, v65
    v_and_b32 v10, 0xffff0000, v72
    v_and_b32 v11, 0xffff0000, v76
    v_mul_f32 v65, v65, v10
    v_fmac_f32 v6, v65, v11
    v_add_f32 v5, v5, v66
    v_lshlrev_b32 v10, 16, v73
    v_lshlrev_b32 v11, 16, v77
    v_mul_f32 v66, v66, v10
    v_fmac_f32 v6, v66, v11
    v_add_f32 v5, v5, v67
    v_and_b32 v10, 0xffff0000, v73
    v_and_b32 v11, 0xffff0000, v77
    v_mul_f32 v67, v67, v10
    v_fmac_f32 v6, v67, v11
    v_add_f32 v5, v5, v68
    v_lshlrev_b32 v10, 16, v74
    v_lshlrev_b32 v11, 16, v78
    v_mul_f32 v68, v68, v10
    v_fmac_f32 v6, v68, v11
    v_add_f32 v5, v5, v69
    v_and_b32 v10, 0xffff0000, v74
    v_and_b32 v11, 0xffff0000, v78
    v_mul_f32 v69, v69, v10
    v_fmac_f32 v6, v69, v11
    ds_write_b128 v14, v[64:67] offset:24832
    ds_write_b64 v14, v[68:69] offset:24848
    v_add_f32_dpp v5, v5, v5 row_ror:8 row_mask:0xf bank_mask:0xf
    v_add_f32_dpp v6, v6, v6 row_ror:8 row_mask:0xf bank_mask:0xf
    s_nop 0
    v_add_f32_dpp v5, v5, v5 row_ror:4 row_mask:0xf bank_mask:0xf
    v_add_f32_dpp v6, v6, v6 row_ror:4 row_mask:0xf bank_mask:0xf
    s_nop 0
    v_add_f32_dpp v5, v5, v5 row_ror:2 row_mask:0xf bank_mask:0xf
    v_add_f32_dpp v6, v6, v6 row_ror:2 row_mask:0xf bank_mask:0xf
    s_nop 0
    v_add_f32_dpp v5, v5, v5 row_ror:1 row_mask:0xf bank_mask:0xf
    v_add_f32_dpp v6, v6, v6 row_ror:1 row_mask:0xf bank_mask:0xf
    v_mov_b32 v10, v5
    v_mov_b32 v11, v6
    s_nop 0
    v_permlane32_swap_b32 v5, v10
    v_permlane32_swap_b32 v6, v11
    v_add_f32 v5, v5, v10
    v_add_f32 v6, v6, v11
    v_mov_b32 v10, v5
    v_mov_b32 v11, v6
    s_nop 0
    v_permlane16_swap_b32 v5, v10
    v_permlane16_swap_b32 v6, v11
    v_add_f32 v5, v5, v10
    v_add_f32 v6, v6, v11
    s_lshl_b32 s48, s61, 2
    v_mov_b32 v10, s48
    v_lshlrev_b32 v11, 2, v10
    v_mov_b32 v7, s39
    s_mov_b64 exec, 1
    ds_write_b128 v11, v[4:7] offset:80
    ds_write_b32 v10, v7 offset:24
    s_lshl_b32 s48, s61, 8
    s_add_u32 s48, s48, s2
    s_lshl_b32 s48, s48, 6
    s_add_u32 s48, s48, 917504
    buffer_store_dwordx4 v[4:7], off, s[12:15], s48 sc1
    s_mov_b64 exec, -1
    v_add_u32 v14, 8192, v14
    v_add_u32 v8, 6144, v8
    s_add_u32 s35, s35, 1048576
    s_add_u32 s61, s61, 1
    s_cmp_lt_u32 s61, 3
    s_cbranch_scc1 L_prep
    s_mov_b32 s61, 0
    v_lshlrev_b32 v12, 2, v1
    v_add_u32 v13, 43264, v12
    v_lshlrev_b32 v8, 4, v1
    v_mov_b32 v31, 1
L_merge:
    s_nop 1
    s_lshl_b32 s48, s61, 2
    v_mov_b32 v3, s48
    v_lshlrev_b32 v11, 2, v3
    ds_read_b128 v[4:7], v11 offset:80
    s_lshl_b32 s62, s61, 8
    s_add_u32 s62, s62, s2
    s_lshl_b32 s62, s62, 10
    s_mov_b32 s60, 0x100000
L_wm:
    s_nop 1
    ds_read_b32 v10, v3 offset:64
    s_sub_u32 s60, s60, 1
    s_cbranch_scc1 L_exit1
    s_waitcnt lgkmcnt(0)
    v_readfirstlane_b32 s48, v10
    s_cmp_lt_u32 s48, 4
    s_cbranch_scc1 L_wm
    ds_read_b32 v16, v13 offset:0
    ds_read_b32 v17, v13 offset:768
    ds_read_b32 v18, v13 offset:1536
    ds_read_b32 v19, v13 offset:2304
    ds_read_b32 v20, v13 offset:256
    ds_read_b32 v21, v13 offset:1024
    ds_read_b32 v22, v13 offset:1792
    ds_read_b32 v23, v13 offset:2560
    ds_read_b32 v24, v13 offset:512
    ds_read_b32 v25, v13 offset:1280
    ds_read_b32 v26, v13 offset:2048
    ds_read_b32 v27, v13 offset:2816
    s_waitcnt lgkmcnt(8)
    v_add_f32 v16, v16, v17
    v_add_f32 v18, v18, v19
    v_sub_f32 v16, v16, v6
    v_add_f32 v28, v16, v18
    s_waitcnt lgkmcnt(4)
    v_add_f32 v20, v20, v21
    v_add_f32 v22, v22, v23
    v_sub_f32 v20, v20, v6
    v_add_f32 v29, v20, v22
    s_waitcnt lgkmcnt(0)
    v_add_f32 v24, v24, v25
    v_add_f32 v26, v26, v27
    v_sub_f32 v24, v24, v6
    v_add_f32 v30, v24, v26
    buffer_store_dwordx4 v[28:31], v8, s[12:15], s62 offen sc1
    v_add_u32 v13, 3072, v13
    s_add_u32 s61, s61, 1
    s_cmp_lt_u32 s61, 3
    s_cbranch_scc1 L_merge
    s_endpgm
.section .rodata,"a"
.p2align 6
.amdhsa_kernel standalone__kv_cache_quant_int4_int2_kv_with_per_channel_or_per_token_scales__decode_kernel
  .amdhsa_next_free_vgpr 136
  .amdhsa_next_free_sgpr 102
  .amdhsa_accum_offset 136
  .amdhsa_group_segment_fixed_size 0
  .amdhsa_kernarg_size 80
  .amdhsa_user_sgpr_count 2
  .amdhsa_user_sgpr_kernarg_segment_ptr 1
  .amdhsa_system_sgpr_workgroup_id_x 1
.end_amdhsa_kernel
```

```asm
; @launch kernel=standalone__kv_cache_quant_int4_int2_kv_with_per_channel_or_per_token_scales__decode_kernel grid=(256,1,1) block=(512,1,1) lds=52480
.amdgcn_target "amdgcn-amd-amdhsa--gfx950"
.text
.globl standalone__kv_cache_quant_int4_int2_kv_with_per_channel_or_per_token_scales__decode_kernel
.p2align 8
.type standalone__kv_cache_quant_int4_int2_kv_with_per_channel_or_per_token_scales__decode_kernel,@function
standalone__kv_cache_quant_int4_int2_kv_with_per_channel_or_per_token_scales__decode_kernel:
    s_cmp_ge_u32 s2, 256
    s_cbranch_scc1 L_exit1
    s_load_dwordx16 s[64:79], s[0:1], 0
    s_load_dwordx4 s[80:83], s[0:1], 64
    v_lshrrev_b32 v10, 6, v0
    v_and_b32 v11, 63, v0
    v_readfirstlane_b32 s28, v10
    s_lshr_b32 s3, s2, 3
    s_and_b32 s4, s2, 7
    s_lshr_b32 s32, s2, 6
    s_xor_b32 s32, s32, s4
    s_lshr_b32 s48, s32, 1
    s_and_b32 s32, s32, 1
    s_lshl_b32 s32, s32, 2
    s_or_b32 s48, s48, s32
    s_cmp_ge_u32 s28, 4
    s_cbranch_scc1 L_helper
    v_lshrrev_b32 v1, 4, v11
    v_and_b32 v52, 15, v11
    v_lshlrev_b32 v2, 4, v52
    v_lshlrev_b32 v3, 3, v52
    v_lshlrev_b32 v62, 7, v1
    v_and_b32 v63, 0x70, v0
    v_xor_b32 v63, v63, v62
    v_mov_b32 v50, v63
    s_mov_b32 s45, 768
    s_mov_b32 s46, 384
    s_mov_b32 s47, 0xaaaaaaab
    v_mov_b32 v51, 0xc0000000
    s_lshl_b32 s44, s3, 6
    s_bitcmp1_b32 s3, 0
    s_cselect_b32 s32, 4, 0
    s_xor_b32 s44, s44, s32
    s_bitcmp1_b32 s3, 1
    s_cselect_b32 s32, 8, 0
    s_xor_b32 s44, s44, s32
    s_bitcmp1_b32 s3, 3
    s_cselect_b32 s32, 32, 0
    s_xor_b32 s44, s44, s32
    s_mov_b32 s5, s48
    s_mov_b32 s29, s28
    s_lshr_b32 s33, s29, 6
    s_lshl_b32 s33, s33, 11
    s_and_b32 s32, s29, 33
    s_and_b32 s34, s29, 28
    s_lshr_b32 s34, s34, 1
    s_or_b32 s32, s32, s34
    s_and_b32 s34, s29, 2
    s_lshl_b32 s34, s34, 3
    s_or_b32 s32, s32, s34
    s_add_u32 s32, s32, s33
    s_xor_b32 s32, s32, s44
    s_bfe_u32 s33, s32, 0x20003
    s_and_b32 s34, s32, 4
    s_or_b32 s33, s33, s34
    s_xor_b32 s33, s33, s5
    s_lshl_b32 s50, s32, 5
    s_or_b32 s50, s50, s33
    s_lshl_b32 s50, s50, 4
    s_or_b32 s50, s50, 1
    v_xor_b32 v10, s50, v50
    v_mul_hi_u32 v10, v10, s47
    v_lshrrev_b32 v10, 1, v10
    v_and_b32 v11, 15, v10
    v_cmp_eq_u32 vcc, 5, v11
    v_mad_u32_u24 v48, v10, s45, v2
    v_add_u32 v11, 3840, v48
    v_cndmask_b32 v49, v51, v11, vcc
    v_lshrrev_b32 v10, 6, v10
    v_mad_u32_u24 v9, v10, s46, v3
    s_waitcnt lgkmcnt(0)
    s_mov_b32 s30, 0
    s_mov_b32 s8, s66
    s_and_b32 s9, s67, 0xffff
    s_mov_b32 s10, 805306368
    s_mov_b32 s11, 0x00020000
    buffer_load_dwordx4 v[64:67], v48, s[8:11], 0 offen offset:0 nt
    buffer_load_dwordx4 v[68:71], v48, s[8:11], 0 offen offset:256 nt
    buffer_load_dwordx4 v[72:75], v48, s[8:11], 0 offen offset:512 nt
    buffer_load_dwordx4 v[76:79], v48, s[8:11], 0 offen offset:768 nt
    buffer_load_dwordx4 v[80:83], v48, s[8:11], 0 offen offset:1024 nt
    buffer_load_dwordx4 v[84:87], v48, s[8:11], 0 offen offset:1280 nt
    s_mov_b32 s20, s64
    s_and_b32 s21, s65, 0xffff
    s_mov_b32 s22, 12288
    s_mov_b32 s23, 0x00020000
    s_lshl_b32 s31, s30, 5
    s_add_u32 s31, s31, s3
    s_mul_i32 s31, s31, 171
    s_lshr_b32 s31, s31, 9
    s_mul_i32 s31, s31, 384
    buffer_load_dwordx2 v[36:37], v3, s[20:23], s31 offen offset:0
    buffer_load_dwordx2 v[38:39], v3, s[20:23], s31 offen offset:128
    buffer_load_dwordx2 v[40:41], v3, s[20:23], s31 offen offset:256
    s_mov_b32 s16, s70
    s_and_b32 s17, s71, 0xffff
    s_mov_b32 s18, 6291456
    s_mov_b32 s19, 0x00020000
    buffer_load_dwordx2 v[42:43], v9, s[16:19], 0 offen offset:0
    buffer_load_dwordx2 v[44:45], v9, s[16:19], 0 offen offset:128
    buffer_load_dwordx2 v[46:47], v9, s[16:19], 0 offen offset:256
    buffer_load_dwordx4 v[88:91], v48, s[8:11], 0 offen offset:1536 nt
    buffer_load_dwordx4 v[92:95], v48, s[8:11], 0 offen offset:1792 nt
    buffer_load_dwordx4 v[96:99], v48, s[8:11], 0 offen offset:2048 nt
    buffer_load_dwordx4 v[100:103], v48, s[8:11], 0 offen offset:2304 nt
    buffer_load_dwordx4 v[104:107], v48, s[8:11], 0 offen offset:2560 nt
    buffer_load_dwordx4 v[108:111], v48, s[8:11], 0 offen offset:2816 nt
    buffer_load_dwordx4 v[112:115], v48, s[8:11], 0 offen offset:3072 nt
    buffer_load_dwordx4 v[116:119], v48, s[8:11], 0 offen offset:3328 nt
    buffer_load_dwordx4 v[120:123], v48, s[8:11], 0 offen offset:3584 nt
    buffer_load_dwordx4 v[124:127], v49, s[8:11], 0 offen offset:0 nt
    buffer_load_dwordx4 v[128:131], v49, s[8:11], 0 offen offset:256 nt
    buffer_load_dwordx4 v[132:135], v49, s[8:11], 0 offen offset:512 nt
    s_mov_b32 s12, s68
    s_and_b32 s13, s69, 0xffff
    s_mov_b32 s14, 805306368
    s_mov_b32 s15, 0x00020000
    v_lshlrev_b32 v11, 5, v1
    v_bfe_u32 v4, v0, 4, 3
    v_mul_u32_u24 v4, s45, v4
    v_lshl_add_u32 v4, v52, 1, v4
    s_lshr_b32 s32, s28, 1
    s_mul_i32 s32, s32, 24
    s_add_u32 s32, s32, 256
    v_add_u32 v4, s32, v4
    v_and_b32 v5, 7, v52
    v_lshl_add_u32 v5, v5, 2, v11
    v_add_u32 v5, 18688, v5
    v_lshlrev_b32 v8, 2, v1
    v_add_u32 v8, v2, v8
    s_mul_i32 s32, s28, 768
    s_add_u32 s32, s32, 43264
    v_add_u32 v8, s32, v8
    v_mov_b32 v53, 0
    v_mov_b32 v60, 0
    v_mov_b32 v61, 0
    s_mov_b32 s42, 0x01110111
    s_mov_b32 s43, 0x01110111
    s_mov_b32 s40, 0xea2bea0c
    s_mov_b32 s41, 0xea2b
    s_mov_b32 s64, 0x2020200
    s_mov_b32 s65, 0x202
    s_mov_b32 s66, 0x8080800
    s_mov_b32 s67, 0x808
    s_mov_b32 s68, 0x20202000
    s_mov_b32 s69, 0x2020
    s_mov_b32 s70, 0xc003c00c
    s_mov_b32 s71, 0xc003
    s_mov_b32 s59, 0
    s_mov_b32 s63, 0
    s_mov_b32 s7, 0
    s_mov_b32 s62, 144
    v_mov_b32 v12, 0
    v_mov_b32 v13, 0
    v_mov_b32 v14, 0
    v_mov_b32 v15, 0
    v_mov_b32 v16, 0
    v_mov_b32 v17, 0
    v_mov_b32 v18, 0
    v_mov_b32 v19, 0
    v_mov_b32 v20, 0
    v_mov_b32 v21, 0
    v_mov_b32 v22, 0
    v_mov_b32 v23, 0
    s_barrier
    s_waitcnt vmcnt(12)
    v_lshlrev_b32 v10, 16, v36
    v_lshlrev_b32 v24, 16, v42
    v_and_b32 v11, 0xffff0000, v36
    v_and_b32 v25, 0xffff0000, v42
    v_mul_f32 v24, v24, v10
    v_mul_f32 v25, v25, v11
    v_lshlrev_b32 v10, 16, v37
    v_lshlrev_b32 v26, 16, v43
    v_and_b32 v11, 0xffff0000, v37
    v_and_b32 v27, 0xffff0000, v43
    v_mul_f32 v26, v26, v10
    v_mul_f32 v27, v27, v11
    v_lshlrev_b32 v10, 16, v38
    v_lshlrev_b32 v28, 16, v44
    v_and_b32 v11, 0xffff0000, v38
    v_and_b32 v29, 0xffff0000, v44
    v_mul_f32 v28, v28, v10
    v_mul_f32 v29, v29, v11
    v_lshlrev_b32 v10, 16, v39
    v_lshlrev_b32 v30, 16, v45
    v_and_b32 v11, 0xffff0000, v39
    v_and_b32 v31, 0xffff0000, v45
    v_mul_f32 v30, v30, v10
    v_mul_f32 v31, v31, v11
    v_lshlrev_b32 v10, 16, v40
    v_lshlrev_b32 v32, 16, v46
    v_and_b32 v11, 0xffff0000, v40
    v_and_b32 v33, 0xffff0000, v46
    v_mul_f32 v32, v32, v10
    v_mul_f32 v33, v33, v11
    v_lshlrev_b32 v10, 16, v41
    v_lshlrev_b32 v34, 16, v47
    v_and_b32 v11, 0xffff0000, v41
    v_and_b32 v35, 0xffff0000, v47
    v_mul_f32 v34, v34, v10
    v_mul_f32 v35, v35, v11
    v_cvt_f32_i32 v64, v64
    v_cvt_f32_i32 v65, v65
    v_cvt_f32_i32 v66, v66
    v_cvt_f32_i32 v67, v67
    v_mul_f32 v54, v64, v24
    v_fmac_f32 v54, v65, v25
    v_fmac_f32 v54, v66, v26
    v_fmac_f32 v54, v67, v27
    v_cvt_f32_i32 v68, v68
    v_cvt_f32_i32 v69, v69
    v_cvt_f32_i32 v70, v70
    v_cvt_f32_i32 v71, v71
    v_fmac_f32 v54, v68, v28
    v_fmac_f32 v54, v69, v29
    v_fmac_f32 v54, v70, v30
    v_fmac_f32 v54, v71, v31
    v_cvt_f32_i32 v72, v72
    v_cvt_f32_i32 v73, v73
    v_cvt_f32_i32 v74, v74
    v_cvt_f32_i32 v75, v75
    v_fmac_f32 v54, v72, v32
    v_fmac_f32 v54, v73, v33
    v_fmac_f32 v54, v74, v34
    v_fmac_f32 v54, v75, v35
    v_cvt_f32_i32 v76, v76
    v_cvt_f32_i32 v77, v77
    v_add_f32_dpp v54, v54, v54 row_ror:8 row_mask:0xf bank_mask:0xf
    v_cvt_f32_i32 v78, v78
    v_cvt_f32_i32 v79, v79
    v_add_f32_dpp v54, v54, v54 row_ror:4 row_mask:0xf bank_mask:0xf
    v_mul_f32 v55, v76, v24
    v_fmac_f32 v55, v77, v25
    v_add_f32_dpp v54, v54, v54 row_ror:2 row_mask:0xf bank_mask:0xf
    v_fmac_f32 v55, v78, v26
    v_fmac_f32 v55, v79, v27
    v_add_f32_dpp v60, v54, v54 row_ror:1 row_mask:0xf bank_mask:0x1
    v_cvt_f32_i32 v80, v80
    v_cvt_f32_i32 v81, v81
    v_cvt_f32_i32 v82, v82
    v_cvt_f32_i32 v83, v83
    v_fmac_f32 v55, v80, v28
    v_fmac_f32 v55, v81, v29
    v_fmac_f32 v55, v82, v30
    v_fmac_f32 v55, v83, v31
    v_cvt_f32_i32 v84, v84
    v_cvt_f32_i32 v85, v85
    v_cvt_f32_i32 v86, v86
    v_cvt_f32_i32 v87, v87
    v_fmac_f32 v55, v84, v32
    v_fmac_f32 v55, v85, v33
    v_fmac_f32 v55, v86, v34
    v_fmac_f32 v55, v87, v35
    s_nop 1
    v_add_f32_dpp v55, v55, v55 row_ror:8 row_mask:0xf bank_mask:0xf
    s_nop 1
    v_add_f32_dpp v55, v55, v55 row_ror:4 row_mask:0xf bank_mask:0xf
    s_nop 1
    v_add_f32_dpp v55, v55, v55 row_ror:2 row_mask:0xf bank_mask:0xf
    s_nop 1
    v_add_f32_dpp v61, v55, v55 row_ror:1 row_mask:0xf bank_mask:0x1
    s_waitcnt vmcnt(6)
    s_add_u32 s29, s29, 4
    s_add_u32 s30, s30, 1
    s_lshr_b32 s33, s29, 6
    s_lshl_b32 s33, s33, 11
    s_and_b32 s32, s29, 33
    s_and_b32 s34, s29, 28
    s_lshr_b32 s34, s34, 1
    s_or_b32 s32, s32, s34
    s_and_b32 s34, s29, 2
    s_lshl_b32 s34, s34, 3
    s_or_b32 s32, s32, s34
    s_add_u32 s32, s32, s33
    s_xor_b32 s32, s32, s44
    s_bfe_u32 s33, s32, 0x20003
    s_and_b32 s34, s32, 4
    s_or_b32 s33, s33, s34
    s_xor_b32 s33, s33, s5
    s_lshl_b32 s50, s32, 5
    s_or_b32 s50, s50, s33
    s_lshl_b32 s50, s50, 4
    s_or_b32 s50, s50, 1
    v_xor_b32 v10, s50, v50
    v_mul_hi_u32 v10, v10, s47
    v_lshrrev_b32 v10, 1, v10
    v_and_b32 v11, 15, v10
    v_cmp_eq_u32 vcc, 5, v11
    v_mad_u32_u24 v48, v10, s45, v2
    v_add_u32 v11, 3840, v48
    v_cndmask_b32 v49, v51, v11, vcc
    v_lshrrev_b32 v10, 6, v10
    v_mad_u32_u24 v9, v10, s46, v3
    buffer_load_dwordx2 v[42:43], v9, s[16:19], 0 offen offset:0
    buffer_load_dwordx2 v[44:45], v9, s[16:19], 0 offen offset:128
    buffer_load_dwordx2 v[46:47], v9, s[16:19], 0 offen offset:256
    v_cvt_f32_i32 v88, v88
    v_cvt_f32_i32 v89, v89
    v_cvt_f32_i32 v90, v90
    v_cvt_f32_i32 v91, v91
    v_mul_f32 v56, v88, v24
    v_fmac_f32 v56, v89, v25
    v_fmac_f32 v56, v90, v26
    v_fmac_f32 v56, v91, v27
    v_cvt_f32_i32 v92, v92
    v_cvt_f32_i32 v93, v93
    v_cvt_f32_i32 v94, v94
    v_cvt_f32_i32 v95, v95
    v_fmac_f32 v56, v92, v28
    v_fmac_f32 v56, v93, v29
    v_fmac_f32 v56, v94, v30
    v_fmac_f32 v56, v95, v31
    v_cvt_f32_i32 v96, v96
    v_cvt_f32_i32 v97, v97
    v_cvt_f32_i32 v98, v98
    v_cvt_f32_i32 v99, v99
    v_fmac_f32 v56, v96, v32
    v_fmac_f32 v56, v97, v33
    v_fmac_f32 v56, v98, v34
    v_fmac_f32 v56, v99, v35
    v_cvt_f32_i32 v100, v100
    v_cvt_f32_i32 v101, v101
    v_add_f32_dpp v56, v56, v56 row_ror:8 row_mask:0xf bank_mask:0xf
    v_cvt_f32_i32 v102, v102
    v_cvt_f32_i32 v103, v103
    v_add_f32_dpp v56, v56, v56 row_ror:4 row_mask:0xf bank_mask:0xf
    v_mul_f32 v57, v100, v24
    v_fmac_f32 v57, v101, v25
    v_add_f32_dpp v56, v56, v56 row_ror:2 row_mask:0xf bank_mask:0xf
    v_fmac_f32 v57, v102, v26
    v_fmac_f32 v57, v103, v27
    v_add_f32_dpp v60, v56, v56 row_ror:1 row_mask:0xf bank_mask:0x2
    v_cvt_f32_i32 v104, v104
    v_cvt_f32_i32 v105, v105
    v_cvt_f32_i32 v106, v106
    v_cvt_f32_i32 v107, v107
    v_fmac_f32 v57, v104, v28
    v_fmac_f32 v57, v105, v29
    v_fmac_f32 v57, v106, v30
    v_fmac_f32 v57, v107, v31
    v_cvt_f32_i32 v108, v108
    v_cvt_f32_i32 v109, v109
    v_cvt_f32_i32 v110, v110
    v_cvt_f32_i32 v111, v111
    v_fmac_f32 v57, v108, v32
    v_fmac_f32 v57, v109, v33
    v_fmac_f32 v57, v110, v34
    v_fmac_f32 v57, v111, v35
    s_nop 1
    v_add_f32_dpp v57, v57, v57 row_ror:8 row_mask:0xf bank_mask:0xf
    s_nop 1
    v_add_f32_dpp v57, v57, v57 row_ror:4 row_mask:0xf bank_mask:0xf
    s_nop 1
    v_add_f32_dpp v57, v57, v57 row_ror:2 row_mask:0xf bank_mask:0xf
    s_nop 1
    v_add_f32_dpp v61, v57, v57 row_ror:1 row_mask:0xf bank_mask:0x2
    s_waitcnt vmcnt(3)
    buffer_load_dwordx4 v[64:67], v48, s[8:11], 0 offen offset:0 nt
    buffer_load_dwordx4 v[68:71], v48, s[8:11], 0 offen offset:256 nt
    buffer_load_dwordx4 v[72:75], v48, s[8:11], 0 offen offset:512 nt
    buffer_load_dwordx4 v[76:79], v48, s[8:11], 0 offen offset:768 nt
    buffer_load_dwordx4 v[80:83], v48, s[8:11], 0 offen offset:1024 nt
    buffer_load_dwordx4 v[84:87], v48, s[8:11], 0 offen offset:1280 nt
    v_cvt_f32_i32 v112, v112
    v_cvt_f32_i32 v113, v113
    v_cvt_f32_i32 v114, v114
    v_cvt_f32_i32 v115, v115
    v_mul_f32 v58, v112, v24
    v_fmac_f32 v58, v113, v25
    v_fmac_f32 v58, v114, v26
    v_fmac_f32 v58, v115, v27
    v_cvt_f32_i32 v116, v116
    v_cvt_f32_i32 v117, v117
    v_cvt_f32_i32 v118, v118
    v_cvt_f32_i32 v119, v119
    v_fmac_f32 v58, v116, v28
    v_fmac_f32 v58, v117, v29
    v_fmac_f32 v58, v118, v30
    v_fmac_f32 v58, v119, v31
    v_cvt_f32_i32 v120, v120
    v_cvt_f32_i32 v121, v121
    v_cvt_f32_i32 v122, v122
    v_cvt_f32_i32 v123, v123
    v_fmac_f32 v58, v120, v32
    v_fmac_f32 v58, v121, v33
    v_fmac_f32 v58, v122, v34
    v_fmac_f32 v58, v123, v35
    v_cvt_f32_i32 v124, v124
    v_cvt_f32_i32 v125, v125
    v_add_f32_dpp v58, v58, v58 row_ror:8 row_mask:0xf bank_mask:0xf
    v_cvt_f32_i32 v126, v126
    v_cvt_f32_i32 v127, v127
    v_add_f32_dpp v58, v58, v58 row_ror:4 row_mask:0xf bank_mask:0xf
    v_mul_f32 v59, v124, v24
    v_fmac_f32 v59, v125, v25
    v_add_f32_dpp v58, v58, v58 row_ror:2 row_mask:0xf bank_mask:0xf
    v_fmac_f32 v59, v126, v26
    v_fmac_f32 v59, v127, v27
    v_add_f32_dpp v60, v58, v58 row_ror:1 row_mask:0xf bank_mask:0x4
    v_cvt_f32_i32 v128, v128
    v_cvt_f32_i32 v129, v129
    v_cvt_f32_i32 v130, v130
    v_cvt_f32_i32 v131, v131
    v_fmac_f32 v59, v128, v28
    v_fmac_f32 v59, v129, v29
    v_fmac_f32 v59, v130, v30
    v_fmac_f32 v59, v131, v31
    v_cvt_f32_i32 v132, v132
    v_cvt_f32_i32 v133, v133
    v_cvt_f32_i32 v134, v134
    v_cvt_f32_i32 v135, v135
    v_fmac_f32 v59, v132, v32
    v_fmac_f32 v59, v133, v33
    v_fmac_f32 v59, v134, v34
    v_fmac_f32 v59, v135, v35
    s_nop 1
    v_add_f32_dpp v59, v59, v59 row_ror:8 row_mask:0xf bank_mask:0xf
    s_nop 1
    v_add_f32_dpp v59, v59, v59 row_ror:4 row_mask:0xf bank_mask:0xf
    s_nop 1
    v_add_f32_dpp v59, v59, v59 row_ror:2 row_mask:0xf bank_mask:0xf
    s_nop 1
    v_add_f32_dpp v61, v59, v59 row_ror:1 row_mask:0xf bank_mask:0x4
    s_mov_b64 exec, s[42:43]
    ds_write_b64 v4, v[60:61]
    s_mov_b64 exec, -1
    v_add_u32 v4, 48, v4
    s_waitcnt vmcnt(6)
    v_lshlrev_b32 v10, 16, v36
    v_lshlrev_b32 v24, 16, v42
    v_and_b32 v11, 0xffff0000, v36
    v_and_b32 v25, 0xffff0000, v42
    v_mul_f32 v24, v24, v10
    v_mul_f32 v25, v25, v11
    v_lshlrev_b32 v10, 16, v37
    v_lshlrev_b32 v26, 16, v43
    v_and_b32 v11, 0xffff0000, v37
    v_and_b32 v27, 0xffff0000, v43
    v_mul_f32 v26, v26, v10
    v_mul_f32 v27, v27, v11
    v_lshlrev_b32 v10, 16, v38
    v_lshlrev_b32 v28, 16, v44
    v_and_b32 v11, 0xffff0000, v38
    v_and_b32 v29, 0xffff0000, v44
    v_mul_f32 v28, v28, v10
    v_mul_f32 v29, v29, v11
    v_lshlrev_b32 v10, 16, v39
    v_lshlrev_b32 v30, 16, v45
    v_and_b32 v11, 0xffff0000, v39
    v_and_b32 v31, 0xffff0000, v45
    v_mul_f32 v30, v30, v10
    v_mul_f32 v31, v31, v11
    v_lshlrev_b32 v10, 16, v40
    v_lshlrev_b32 v32, 16, v46
    v_and_b32 v11, 0xffff0000, v40
    v_and_b32 v33, 0xffff0000, v46
    v_mul_f32 v32, v32, v10
    v_mul_f32 v33, v33, v11
    v_lshlrev_b32 v10, 16, v41
    v_lshlrev_b32 v34, 16, v47
    v_and_b32 v11, 0xffff0000, v41
    v_and_b32 v35, 0xffff0000, v47
    v_mul_f32 v34, v34, v10
    v_mul_f32 v35, v35, v11
.p2align 6
L_kloop:
    s_nop 1
    s_waitcnt vmcnt(0)
    buffer_load_dwordx4 v[88:91], v48, s[8:11], 0 offen offset:1536 nt
    buffer_load_dwordx4 v[92:95], v48, s[8:11], 0 offen offset:1792 nt
    buffer_load_dwordx4 v[96:99], v48, s[8:11], 0 offen offset:2048 nt
    buffer_load_dwordx4 v[100:103], v48, s[8:11], 0 offen offset:2304 nt
    buffer_load_dwordx4 v[104:107], v48, s[8:11], 0 offen offset:2560 nt
    buffer_load_dwordx4 v[108:111], v48, s[8:11], 0 offen offset:2816 nt
    v_cvt_f32_i32 v64, v64
    v_cvt_f32_i32 v65, v65
    v_cvt_f32_i32 v66, v66
    v_cvt_f32_i32 v67, v67
    v_mul_f32 v54, v64, v24
    v_fmac_f32 v54, v65, v25
    v_fmac_f32 v54, v66, v26
    v_fmac_f32 v54, v67, v27
    v_cvt_f32_i32 v68, v68
    v_cvt_f32_i32 v69, v69
    v_cvt_f32_i32 v70, v70
    v_cvt_f32_i32 v71, v71
    v_fmac_f32 v54, v68, v28
    v_fmac_f32 v54, v69, v29
    v_fmac_f32 v54, v70, v30
    v_fmac_f32 v54, v71, v31
    v_cvt_f32_i32 v72, v72
    v_cvt_f32_i32 v73, v73
    v_cvt_f32_i32 v74, v74
    v_cvt_f32_i32 v75, v75
    v_fmac_f32 v54, v72, v32
    v_fmac_f32 v54, v73, v33
    v_fmac_f32 v54, v74, v34
    v_fmac_f32 v54, v75, v35
    v_cvt_f32_i32 v76, v76
    v_cvt_f32_i32 v77, v77
    v_add_f32_dpp v54, v54, v54 row_ror:8 row_mask:0xf bank_mask:0xf
    v_cvt_f32_i32 v78, v78
    v_cvt_f32_i32 v79, v79
    v_add_f32_dpp v54, v54, v54 row_ror:4 row_mask:0xf bank_mask:0xf
    v_mul_f32 v55, v76, v24
    v_fmac_f32 v55, v77, v25
    v_add_f32_dpp v54, v54, v54 row_ror:2 row_mask:0xf bank_mask:0xf
    v_fmac_f32 v55, v78, v26
    v_fmac_f32 v55, v79, v27
    v_add_f32_dpp v60, v54, v54 row_ror:1 row_mask:0xf bank_mask:0x1
    v_cvt_f32_i32 v80, v80
    v_cvt_f32_i32 v81, v81
    v_cvt_f32_i32 v82, v82
    v_cvt_f32_i32 v83, v83
    v_fmac_f32 v55, v80, v28
    v_fmac_f32 v55, v81, v29
    v_fmac_f32 v55, v82, v30
    v_fmac_f32 v55, v83, v31
    v_cvt_f32_i32 v84, v84
    v_cvt_f32_i32 v85, v85
    v_cvt_f32_i32 v86, v86
    v_cvt_f32_i32 v87, v87
    v_fmac_f32 v55, v84, v32
    v_fmac_f32 v55, v85, v33
    v_fmac_f32 v55, v86, v34
    v_fmac_f32 v55, v87, v35
    s_nop 1
    v_add_f32_dpp v55, v55, v55 row_ror:8 row_mask:0xf bank_mask:0xf
    s_nop 1
    v_add_f32_dpp v55, v55, v55 row_ror:4 row_mask:0xf bank_mask:0xf
    s_nop 1
    v_add_f32_dpp v55, v55, v55 row_ror:2 row_mask:0xf bank_mask:0xf
    s_nop 1
    v_add_f32_dpp v61, v55, v55 row_ror:1 row_mask:0xf bank_mask:0x1
    s_waitcnt vmcnt(0)
    buffer_load_dwordx4 v[112:115], v48, s[8:11], 0 offen offset:3072 nt
    buffer_load_dwordx4 v[116:119], v48, s[8:11], 0 offen offset:3328 nt
    buffer_load_dwordx4 v[120:123], v48, s[8:11], 0 offen offset:3584 nt
    buffer_load_dwordx4 v[124:127], v49, s[8:11], 0 offen offset:0 nt
    buffer_load_dwordx4 v[128:131], v49, s[8:11], 0 offen offset:256 nt
    buffer_load_dwordx4 v[132:135], v49, s[8:11], 0 offen offset:512 nt
    s_add_u32 s29, s29, 4
    s_add_u32 s30, s30, 1
    s_bitcmp1_b64 s[40:41], s30
    s_cbranch_scc1 L_evK
L_evretK:
    s_nop 1
    s_lshr_b32 s33, s29, 6
    s_lshl_b32 s33, s33, 11
    s_and_b32 s32, s29, 33
    s_and_b32 s34, s29, 28
    s_lshr_b32 s34, s34, 1
    s_or_b32 s32, s32, s34
    s_and_b32 s34, s29, 2
    s_lshl_b32 s34, s34, 3
    s_or_b32 s32, s32, s34
    s_add_u32 s32, s32, s33
    s_xor_b32 s32, s32, s44
    s_bfe_u32 s33, s32, 0x20003
    s_and_b32 s34, s32, 4
    s_or_b32 s33, s33, s34
    s_xor_b32 s33, s33, s5
    s_lshl_b32 s50, s32, 5
    s_or_b32 s50, s50, s33
    s_lshl_b32 s50, s50, 4
    s_or_b32 s50, s50, 1
    v_xor_b32 v10, s50, v50
    v_mul_hi_u32 v10, v10, s47
    v_lshrrev_b32 v10, 1, v10
    v_and_b32 v11, 15, v10
    v_cmp_eq_u32 vcc, 5, v11
    v_mad_u32_u24 v48, v10, s45, v2
    v_add_u32 v11, 3840, v48
    v_cndmask_b32 v49, v51, v11, vcc
    v_lshrrev_b32 v10, 6, v10
    v_mad_u32_u24 v9, v10, s46, v3
    buffer_load_dwordx2 v[42:43], v9, s[16:19], 0 offen offset:0
    buffer_load_dwordx2 v[44:45], v9, s[16:19], 0 offen offset:128
    buffer_load_dwordx2 v[46:47], v9, s[16:19], 0 offen offset:256
    v_cvt_f32_i32 v88, v88
    v_cvt_f32_i32 v89, v89
    v_cvt_f32_i32 v90, v90
    v_cvt_f32_i32 v91, v91
    v_mul_f32 v56, v88, v24
    v_fmac_f32 v56, v89, v25
    v_fmac_f32 v56, v90, v26
    v_fmac_f32 v56, v91, v27
    v_cvt_f32_i32 v92, v92
    v_cvt_f32_i32 v93, v93
    v_cvt_f32_i32 v94, v94
    v_cvt_f32_i32 v95, v95
    v_fmac_f32 v56, v92, v28
    v_fmac_f32 v56, v93, v29
    v_fmac_f32 v56, v94, v30
    v_fmac_f32 v56, v95, v31
    v_cvt_f32_i32 v96, v96
    v_cvt_f32_i32 v97, v97
    v_cvt_f32_i32 v98, v98
    v_cvt_f32_i32 v99, v99
    v_fmac_f32 v56, v96, v32
    v_fmac_f32 v56, v97, v33
    v_fmac_f32 v56, v98, v34
    v_fmac_f32 v56, v99, v35
    v_cvt_f32_i32 v100, v100
    v_cvt_f32_i32 v101, v101
    v_add_f32_dpp v56, v56, v56 row_ror:8 row_mask:0xf bank_mask:0xf
    v_cvt_f32_i32 v102, v102
    v_cvt_f32_i32 v103, v103
    v_add_f32_dpp v56, v56, v56 row_ror:4 row_mask:0xf bank_mask:0xf
    v_mul_f32 v57, v100, v24
    v_fmac_f32 v57, v101, v25
    v_add_f32_dpp v56, v56, v56 row_ror:2 row_mask:0xf bank_mask:0xf
    v_fmac_f32 v57, v102, v26
    v_fmac_f32 v57, v103, v27
    v_add_f32_dpp v60, v56, v56 row_ror:1 row_mask:0xf bank_mask:0x2
    v_cvt_f32_i32 v104, v104
    v_cvt_f32_i32 v105, v105
    v_cvt_f32_i32 v106, v106
    v_cvt_f32_i32 v107, v107
    v_fmac_f32 v57, v104, v28
    v_fmac_f32 v57, v105, v29
    v_fmac_f32 v57, v106, v30
    v_fmac_f32 v57, v107, v31
    v_cvt_f32_i32 v108, v108
    v_cvt_f32_i32 v109, v109
    v_cvt_f32_i32 v110, v110
    v_cvt_f32_i32 v111, v111
    v_fmac_f32 v57, v108, v32
    v_fmac_f32 v57, v109, v33
    v_fmac_f32 v57, v110, v34
    v_fmac_f32 v57, v111, v35
    s_nop 1
    v_add_f32_dpp v57, v57, v57 row_ror:8 row_mask:0xf bank_mask:0xf
    s_nop 1
    v_add_f32_dpp v57, v57, v57 row_ror:4 row_mask:0xf bank_mask:0xf
    s_nop 1
    v_add_f32_dpp v57, v57, v57 row_ror:2 row_mask:0xf bank_mask:0xf
    s_nop 1
    v_add_f32_dpp v61, v57, v57 row_ror:1 row_mask:0xf bank_mask:0x2
    s_waitcnt vmcnt(3)
    buffer_load_dwordx4 v[64:67], v48, s[8:11], 0 offen offset:0 nt
    buffer_load_dwordx4 v[68:71], v48, s[8:11], 0 offen offset:256 nt
    buffer_load_dwordx4 v[72:75], v48, s[8:11], 0 offen offset:512 nt
    buffer_load_dwordx4 v[76:79], v48, s[8:11], 0 offen offset:768 nt
    buffer_load_dwordx4 v[80:83], v48, s[8:11], 0 offen offset:1024 nt
    buffer_load_dwordx4 v[84:87], v48, s[8:11], 0 offen offset:1280 nt
    v_cvt_f32_i32 v112, v112
    v_cvt_f32_i32 v113, v113
    v_cvt_f32_i32 v114, v114
    v_cvt_f32_i32 v115, v115
    v_mul_f32 v58, v112, v24
    v_fmac_f32 v58, v113, v25
    v_fmac_f32 v58, v114, v26
    v_fmac_f32 v58, v115, v27
    v_cvt_f32_i32 v116, v116
    v_cvt_f32_i32 v117, v117
    v_cvt_f32_i32 v118, v118
    v_cvt_f32_i32 v119, v119
    v_fmac_f32 v58, v116, v28
    v_fmac_f32 v58, v117, v29
    v_fmac_f32 v58, v118, v30
    v_fmac_f32 v58, v119, v31
    v_cvt_f32_i32 v120, v120
    v_cvt_f32_i32 v121, v121
    v_cvt_f32_i32 v122, v122
    v_cvt_f32_i32 v123, v123
    v_fmac_f32 v58, v120, v32
    v_fmac_f32 v58, v121, v33
    v_fmac_f32 v58, v122, v34
    v_fmac_f32 v58, v123, v35
    v_cvt_f32_i32 v124, v124
    v_cvt_f32_i32 v125, v125
    v_add_f32_dpp v58, v58, v58 row_ror:8 row_mask:0xf bank_mask:0xf
    v_cvt_f32_i32 v126, v126
    v_cvt_f32_i32 v127, v127
    v_add_f32_dpp v58, v58, v58 row_ror:4 row_mask:0xf bank_mask:0xf
    v_mul_f32 v59, v124, v24
    v_fmac_f32 v59, v125, v25
    v_add_f32_dpp v58, v58, v58 row_ror:2 row_mask:0xf bank_mask:0xf
    v_fmac_f32 v59, v126, v26
    v_fmac_f32 v59, v127, v27
    v_add_f32_dpp v60, v58, v58 row_ror:1 row_mask:0xf bank_mask:0x4
    v_cvt_f32_i32 v128, v128
    v_cvt_f32_i32 v129, v129
    v_cvt_f32_i32 v130, v130
    v_cvt_f32_i32 v131, v131
    v_fmac_f32 v59, v128, v28
    v_fmac_f32 v59, v129, v29
    v_fmac_f32 v59, v130, v30
    v_fmac_f32 v59, v131, v31
    v_cvt_f32_i32 v132, v132
    v_cvt_f32_i32 v133, v133
    v_cvt_f32_i32 v134, v134
    v_cvt_f32_i32 v135, v135
    v_fmac_f32 v59, v132, v32
    v_fmac_f32 v59, v133, v33
    v_fmac_f32 v59, v134, v34
    v_fmac_f32 v59, v135, v35
    s_nop 1
    v_add_f32_dpp v59, v59, v59 row_ror:8 row_mask:0xf bank_mask:0xf
    s_nop 1
    v_add_f32_dpp v59, v59, v59 row_ror:4 row_mask:0xf bank_mask:0xf
    s_nop 1
    v_add_f32_dpp v59, v59, v59 row_ror:2 row_mask:0xf bank_mask:0xf
    s_nop 1
    v_add_f32_dpp v61, v59, v59 row_ror:1 row_mask:0xf bank_mask:0x4
    s_mov_b64 exec, s[42:43]
    ds_write_b64 v4, v[60:61]
    s_mov_b64 exec, -1
    v_add_u32 v4, 48, v4
    s_waitcnt vmcnt(6)
    v_lshlrev_b32 v10, 16, v36
    v_lshlrev_b32 v24, 16, v42
    v_and_b32 v11, 0xffff0000, v36
    v_and_b32 v25, 0xffff0000, v42
    v_mul_f32 v24, v24, v10
    v_mul_f32 v25, v25, v11
    v_lshlrev_b32 v10, 16, v37
    v_lshlrev_b32 v26, 16, v43
    v_and_b32 v11, 0xffff0000, v37
    v_and_b32 v27, 0xffff0000, v43
    v_mul_f32 v26, v26, v10
    v_mul_f32 v27, v27, v11
    v_lshlrev_b32 v10, 16, v38
    v_lshlrev_b32 v28, 16, v44
    v_and_b32 v11, 0xffff0000, v38
    v_and_b32 v29, 0xffff0000, v44
    v_mul_f32 v28, v28, v10
    v_mul_f32 v29, v29, v11
    v_lshlrev_b32 v10, 16, v39
    v_lshlrev_b32 v30, 16, v45
    v_and_b32 v11, 0xffff0000, v39
    v_and_b32 v31, 0xffff0000, v45
    v_mul_f32 v30, v30, v10
    v_mul_f32 v31, v31, v11
    v_lshlrev_b32 v10, 16, v40
    v_lshlrev_b32 v32, 16, v46
    v_and_b32 v11, 0xffff0000, v40
    v_and_b32 v33, 0xffff0000, v46
    v_mul_f32 v32, v32, v10
    v_mul_f32 v33, v33, v11
    v_lshlrev_b32 v10, 16, v41
    v_lshlrev_b32 v34, 16, v47
    v_and_b32 v11, 0xffff0000, v41
    v_and_b32 v35, 0xffff0000, v47
    v_mul_f32 v34, v34, v10
    v_mul_f32 v35, v35, v11
L_kchk:
    s_nop 1
    s_cmp_lg_u32 s59, 0
    s_cbranch_scc1 L_kboost
L_kchk2:
    s_nop 1
    s_cmp_lg_u32 s30, 47
    s_cbranch_scc1 L_kloop
    s_waitcnt vmcnt(0)
    buffer_load_dwordx4 v[88:91], v48, s[8:11], 0 offen offset:1536 nt
    buffer_load_dwordx4 v[92:95], v48, s[8:11], 0 offen offset:1792 nt
    buffer_load_dwordx4 v[96:99], v48, s[8:11], 0 offen offset:2048 nt
    buffer_load_dwordx4 v[100:103], v48, s[8:11], 0 offen offset:2304 nt
    buffer_load_dwordx4 v[104:107], v48, s[8:11], 0 offen offset:2560 nt
    buffer_load_dwordx4 v[108:111], v48, s[8:11], 0 offen offset:2816 nt
    v_cvt_f32_i32 v64, v64
    v_cvt_f32_i32 v65, v65
    v_cvt_f32_i32 v66, v66
    v_cvt_f32_i32 v67, v67
    v_mul_f32 v54, v64, v24
    v_fmac_f32 v54, v65, v25
    v_fmac_f32 v54, v66, v26
    v_fmac_f32 v54, v67, v27
    v_cvt_f32_i32 v68, v68
    v_cvt_f32_i32 v69, v69
    v_cvt_f32_i32 v70, v70
    v_cvt_f32_i32 v71, v71
    v_fmac_f32 v54, v68, v28
    v_fmac_f32 v54, v69, v29
    v_fmac_f32 v54, v70, v30
    v_fmac_f32 v54, v71, v31
    v_cvt_f32_i32 v72, v72
    v_cvt_f32_i32 v73, v73
    v_cvt_f32_i32 v74, v74
    v_cvt_f32_i32 v75, v75
    v_fmac_f32 v54, v72, v32
    v_fmac_f32 v54, v73, v33
    v_fmac_f32 v54, v74, v34
    v_fmac_f32 v54, v75, v35
    v_cvt_f32_i32 v76, v76
    v_cvt_f32_i32 v77, v77
    v_add_f32_dpp v54, v54, v54 row_ror:8 row_mask:0xf bank_mask:0xf
    v_cvt_f32_i32 v78, v78
    v_cvt_f32_i32 v79, v79
    v_add_f32_dpp v54, v54, v54 row_ror:4 row_mask:0xf bank_mask:0xf
    v_mul_f32 v55, v76, v24
    v_fmac_f32 v55, v77, v25
    v_add_f32_dpp v54, v54, v54 row_ror:2 row_mask:0xf bank_mask:0xf
    v_fmac_f32 v55, v78, v26
    v_fmac_f32 v55, v79, v27
    v_add_f32_dpp v60, v54, v54 row_ror:1 row_mask:0xf bank_mask:0x1
    v_cvt_f32_i32 v80, v80
    v_cvt_f32_i32 v81, v81
    v_cvt_f32_i32 v82, v82
    v_cvt_f32_i32 v83, v83
    v_fmac_f32 v55, v80, v28
    v_fmac_f32 v55, v81, v29
    v_fmac_f32 v55, v82, v30
    v_fmac_f32 v55, v83, v31
    v_cvt_f32_i32 v84, v84
    v_cvt_f32_i32 v85, v85
    v_cvt_f32_i32 v86, v86
    v_cvt_f32_i32 v87, v87
    v_fmac_f32 v55, v84, v32
    v_fmac_f32 v55, v85, v33
    v_fmac_f32 v55, v86, v34
    v_fmac_f32 v55, v87, v35
    s_nop 1
    v_add_f32_dpp v55, v55, v55 row_ror:8 row_mask:0xf bank_mask:0xf
    s_nop 1
    v_add_f32_dpp v55, v55, v55 row_ror:4 row_mask:0xf bank_mask:0xf
    s_nop 1
    v_add_f32_dpp v55, v55, v55 row_ror:2 row_mask:0xf bank_mask:0xf
    s_nop 1
    v_add_f32_dpp v61, v55, v55 row_ror:1 row_mask:0xf bank_mask:0x1
    s_waitcnt vmcnt(0)
    buffer_load_dwordx4 v[112:115], v48, s[8:11], 0 offen offset:3072 nt
    buffer_load_dwordx4 v[116:119], v48, s[8:11], 0 offen offset:3328 nt
    buffer_load_dwordx4 v[120:123], v48, s[8:11], 0 offen offset:3584 nt
    buffer_load_dwordx4 v[124:127], v49, s[8:11], 0 offen offset:0 nt
    buffer_load_dwordx4 v[128:131], v49, s[8:11], 0 offen offset:256 nt
    buffer_load_dwordx4 v[132:135], v49, s[8:11], 0 offen offset:512 nt
    s_mov_b32 s29, s28
    s_mov_b32 s30, 0
    s_memrealtime s[36:37]
    s_mov_b32 s6, 0x100000
L_wgtv:
    s_nop 1
    ds_read_b32 v10, v53 offset:216
    s_sub_u32 s6, s6, 1
    s_cbranch_scc1 L_exit1
    s_waitcnt lgkmcnt(0)
    v_readfirstlane_b32 s32, v10
    s_cmp_eq_u32 s32, 0
    s_cbranch_scc1 L_wgtv
    s_and_b32 s32, s32, 0xffff
    s_cbranch_scc0 L_gxtv
    s_add_u32 s32, s32, s36
L_gltv:
    s_nop 1
    s_memrealtime s[36:37]
    s_waitcnt lgkmcnt(0)
    s_sub_u32 s36, s36, s32
    s_cmp_lt_i32 s36, 0
    s_cbranch_scc1 L_gltv
L_gxtv:
    s_nop 1
    s_lshr_b32 s33, s30, 4
    s_lshl_b32 s34, s33, 2
    v_mov_b32 v11, s34
    s_mov_b32 s6, 0x100000
L_wtv:
    s_nop 1
    ds_read_b32 v10, v11 offset:24
    s_sub_u32 s6, s6, 1
    s_cbranch_scc1 L_exit1
    s_waitcnt lgkmcnt(0)
    v_readfirstlane_b32 s32, v10
    s_cmp_eq_u32 s32, 0
    s_cbranch_scc1 L_wtv
    s_and_b32 s5, s32, 7
    s_xor_b32 s5, s5, s48
    s_bitcmp1_b32 s32, 3
    s_cselect_b64 vcc, -1, 0
    v_cndmask_b32 v50, v62, v63, vcc
    s_mov_b32 s49, 45
    s_mov_b32 s40, 0x2a2b2a2a
    s_mov_b32 s41, 0x152b
    s_mov_b32 s64, 0x2020202
    s_mov_b32 s65, 0x102
    s_mov_b32 s66, 0x8080808
    s_mov_b32 s67, 0x408
    s_mov_b32 s68, 0x20202020
    s_mov_b32 s69, 0x1020
    s_mov_b32 s70, 0x10000
    s_mov_b32 s71, 0x1
    s_lshr_b32 s33, s29, 6
    s_lshl_b32 s33, s33, 11
    s_and_b32 s32, s29, 33
    s_and_b32 s34, s29, 28
    s_lshr_b32 s34, s34, 1
    s_or_b32 s32, s32, s34
    s_and_b32 s34, s29, 2
    s_lshl_b32 s34, s34, 3
    s_or_b32 s32, s32, s34
    s_add_u32 s32, s32, s33
    s_xor_b32 s32, s32, s44
    s_bfe_u32 s33, s32, 0x20003
    s_and_b32 s34, s32, 4
    s_or_b32 s33, s33, s34
    s_xor_b32 s33, s33, s5
    s_lshl_b32 s50, s32, 5
    s_or_b32 s50, s50, s33
    s_lshl_b32 s50, s50, 4
    s_or_b32 s50, s50, 1
    s_lshl_b32 s53, s29, 7
    v_xor_b32 v10, s50, v50
    v_mul_hi_u32 v10, v10, s47
    v_lshrrev_b32 v10, 1, v10
    v_and_b32 v11, 15, v10
    v_cmp_eq_u32 vcc, 5, v11
    v_mad_u32_u24 v48, v10, s45, v2
    v_add_u32 v11, 3840, v48
    v_cndmask_b32 v49, v51, v11, vcc
    v_add_u32 v10, s53, v5
    ds_read_b32 v7, v10
    v_cvt_f32_i32 v88, v88
    v_cvt_f32_i32 v89, v89
    v_cvt_f32_i32 v90, v90
    v_cvt_f32_i32 v91, v91
    v_mul_f32 v56, v88, v24
    v_fmac_f32 v56, v89, v25
    v_fmac_f32 v56, v90, v26
    v_fmac_f32 v56, v91, v27
    v_cvt_f32_i32 v92, v92
    v_cvt_f32_i32 v93, v93
    v_cvt_f32_i32 v94, v94
    v_cvt_f32_i32 v95, v95
    v_fmac_f32 v56, v92, v28
    v_fmac_f32 v56, v93, v29
    v_fmac_f32 v56, v94, v30
    v_fmac_f32 v56, v95, v31
    v_cvt_f32_i32 v96, v96
    v_cvt_f32_i32 v97, v97
    v_cvt_f32_i32 v98, v98
    v_cvt_f32_i32 v99, v99
    v_fmac_f32 v56, v96, v32
    v_fmac_f32 v56, v97, v33
    v_fmac_f32 v56, v98, v34
    v_fmac_f32 v56, v99, v35
    v_cvt_f32_i32 v100, v100
    v_cvt_f32_i32 v101, v101
    v_add_f32_dpp v56, v56, v56 row_ror:8 row_mask:0xf bank_mask:0xf
    v_cvt_f32_i32 v102, v102
    v_cvt_f32_i32 v103, v103
    v_add_f32_dpp v56, v56, v56 row_ror:4 row_mask:0xf bank_mask:0xf
    v_mul_f32 v57, v100, v24
    v_fmac_f32 v57, v101, v25
    v_add_f32_dpp v56, v56, v56 row_ror:2 row_mask:0xf bank_mask:0xf
    v_fmac_f32 v57, v102, v26
    v_fmac_f32 v57, v103, v27
    v_add_f32_dpp v60, v56, v56 row_ror:1 row_mask:0xf bank_mask:0x2
    v_cvt_f32_i32 v104, v104
    v_cvt_f32_i32 v105, v105
    v_cvt_f32_i32 v106, v106
    v_cvt_f32_i32 v107, v107
    v_fmac_f32 v57, v104, v28
    v_fmac_f32 v57, v105, v29
    v_fmac_f32 v57, v106, v30
    v_fmac_f32 v57, v107, v31
    v_cvt_f32_i32 v108, v108
    v_cvt_f32_i32 v109, v109
    v_cvt_f32_i32 v110, v110
    v_cvt_f32_i32 v111, v111
    v_fmac_f32 v57, v108, v32
    v_fmac_f32 v57, v109, v33
    v_fmac_f32 v57, v110, v34
    v_fmac_f32 v57, v111, v35
    s_nop 1
    v_add_f32_dpp v57, v57, v57 row_ror:8 row_mask:0xf bank_mask:0xf
    s_nop 1
    v_add_f32_dpp v57, v57, v57 row_ror:4 row_mask:0xf bank_mask:0xf
    s_nop 1
    v_add_f32_dpp v57, v57, v57 row_ror:2 row_mask:0xf bank_mask:0xf
    s_nop 1
    v_add_f32_dpp v61, v57, v57 row_ror:1 row_mask:0xf bank_mask:0x2
    s_waitcnt vmcnt(0)
    buffer_load_dwordx4 v[64:67], v48, s[12:15], 0 offen offset:0 nt
    buffer_load_dwordx4 v[68:71], v48, s[12:15], 0 offen offset:256 nt
    buffer_load_dwordx4 v[72:75], v48, s[12:15], 0 offen offset:512 nt
    buffer_load_dwordx4 v[76:79], v48, s[12:15], 0 offen offset:768 nt
    buffer_load_dwordx4 v[80:83], v48, s[12:15], 0 offen offset:1024 nt
    buffer_load_dwordx4 v[84:87], v48, s[12:15], 0 offen offset:1280 nt
    v_cvt_f32_i32 v112, v112
    v_cvt_f32_i32 v113, v113
    v_cvt_f32_i32 v114, v114
    v_cvt_f32_i32 v115, v115
    v_mul_f32 v58, v112, v24
    v_fmac_f32 v58, v113, v25
    v_fmac_f32 v58, v114, v26
    v_fmac_f32 v58, v115, v27
    v_cvt_f32_i32 v116, v116
    v_cvt_f32_i32 v117, v117
    v_cvt_f32_i32 v118, v118
    v_cvt_f32_i32 v119, v119
    v_fmac_f32 v58, v116, v28
    v_fmac_f32 v58, v117, v29
    v_fmac_f32 v58, v118, v30
    v_fmac_f32 v58, v119, v31
    v_cvt_f32_i32 v120, v120
    v_cvt_f32_i32 v121, v121
    v_cvt_f32_i32 v122, v122
    v_cvt_f32_i32 v123, v123
    v_fmac_f32 v58, v120, v32
    v_fmac_f32 v58, v121, v33
    v_fmac_f32 v58, v122, v34
    v_fmac_f32 v58, v123, v35
    v_cvt_f32_i32 v124, v124
    v_cvt_f32_i32 v125, v125
    v_add_f32_dpp v58, v58, v58 row_ror:8 row_mask:0xf bank_mask:0xf
    v_cvt_f32_i32 v126, v126
    v_cvt_f32_i32 v127, v127
    v_add_f32_dpp v58, v58, v58 row_ror:4 row_mask:0xf bank_mask:0xf
    v_mul_f32 v59, v124, v24
    v_fmac_f32 v59, v125, v25
    v_add_f32_dpp v58, v58, v58 row_ror:2 row_mask:0xf bank_mask:0xf
    v_fmac_f32 v59, v126, v26
    v_fmac_f32 v59, v127, v27
    v_add_f32_dpp v60, v58, v58 row_ror:1 row_mask:0xf bank_mask:0x4
    v_cvt_f32_i32 v128, v128
    v_cvt_f32_i32 v129, v129
    v_cvt_f32_i32 v130, v130
    v_cvt_f32_i32 v131, v131
    v_fmac_f32 v59, v128, v28
    v_fmac_f32 v59, v129, v29
    v_fmac_f32 v59, v130, v30
    v_fmac_f32 v59, v131, v31
    v_cvt_f32_i32 v132, v132
    v_cvt_f32_i32 v133, v133
    v_cvt_f32_i32 v134, v134
    v_cvt_f32_i32 v135, v135
    v_fmac_f32 v59, v132, v32
    v_fmac_f32 v59, v133, v33
    v_fmac_f32 v59, v134, v34
    v_fmac_f32 v59, v135, v35
    s_nop 1
    v_add_f32_dpp v59, v59, v59 row_ror:8 row_mask:0xf bank_mask:0xf
    s_nop 1
    v_add_f32_dpp v59, v59, v59 row_ror:4 row_mask:0xf bank_mask:0xf
    s_nop 1
    v_add_f32_dpp v59, v59, v59 row_ror:2 row_mask:0xf bank_mask:0xf
    s_nop 1
    v_add_f32_dpp v61, v59, v59 row_ror:1 row_mask:0xf bank_mask:0x4
    s_mov_b64 exec, s[42:43]
    ds_write_b64 v4, v[60:61]
    s_mov_b64 exec, -1
    s_waitcnt lgkmcnt(0)
    v_mov_b32 v6, v7
    v_mov_b32 v11, 1
    s_mov_b64 exec, 1
    ds_add_u32 v53, v11 offset:48
    s_mov_b64 exec, -1
.p2align 6
L_vloop:
    s_nop 1
    s_waitcnt vmcnt(0)
    buffer_load_dwordx4 v[88:91], v48, s[12:15], 0 offen offset:1536 nt
    buffer_load_dwordx4 v[92:95], v48, s[12:15], 0 offen offset:1792 nt
    buffer_load_dwordx4 v[96:99], v48, s[12:15], 0 offen offset:2048 nt
    buffer_load_dwordx4 v[100:103], v48, s[12:15], 0 offen offset:2304 nt
    buffer_load_dwordx4 v[104:107], v48, s[12:15], 0 offen offset:2560 nt
    buffer_load_dwordx4 v[108:111], v48, s[12:15], 0 offen offset:2816 nt
    v_cvt_f32_i32 v64, v64
    v_cvt_f32_i32 v65, v65
    v_cvt_f32_i32 v66, v66
    v_cvt_f32_i32 v67, v67
    v_fmac_f32_dpp v12, v6, v64 row_newbcast:0 row_mask:0xf bank_mask:0xf
    v_fmac_f32_dpp v13, v6, v65 row_newbcast:0 row_mask:0xf bank_mask:0xf
    v_fmac_f32_dpp v14, v6, v66 row_newbcast:0 row_mask:0xf bank_mask:0xf
    v_fmac_f32_dpp v15, v6, v67 row_newbcast:0 row_mask:0xf bank_mask:0xf
    v_cvt_f32_i32 v68, v68
    v_cvt_f32_i32 v69, v69
    v_cvt_f32_i32 v70, v70
    v_cvt_f32_i32 v71, v71
    v_fmac_f32_dpp v16, v6, v68 row_newbcast:0 row_mask:0xf bank_mask:0xf
    v_fmac_f32_dpp v17, v6, v69 row_newbcast:0 row_mask:0xf bank_mask:0xf
    v_fmac_f32_dpp v18, v6, v70 row_newbcast:0 row_mask:0xf bank_mask:0xf
    v_fmac_f32_dpp v19, v6, v71 row_newbcast:0 row_mask:0xf bank_mask:0xf
    v_cvt_f32_i32 v72, v72
    v_cvt_f32_i32 v73, v73
    v_cvt_f32_i32 v74, v74
    v_cvt_f32_i32 v75, v75
    v_fmac_f32_dpp v20, v6, v72 row_newbcast:0 row_mask:0xf bank_mask:0xf
    v_fmac_f32_dpp v21, v6, v73 row_newbcast:0 row_mask:0xf bank_mask:0xf
    v_fmac_f32_dpp v22, v6, v74 row_newbcast:0 row_mask:0xf bank_mask:0xf
    v_fmac_f32_dpp v23, v6, v75 row_newbcast:0 row_mask:0xf bank_mask:0xf
    v_cvt_f32_i32 v76, v76
    v_cvt_f32_i32 v77, v77
    v_cvt_f32_i32 v78, v78
    v_cvt_f32_i32 v79, v79
    v_fmac_f32_dpp v12, v6, v76 row_newbcast:1 row_mask:0xf bank_mask:0xf
    v_fmac_f32_dpp v13, v6, v77 row_newbcast:1 row_mask:0xf bank_mask:0xf
    v_fmac_f32_dpp v14, v6, v78 row_newbcast:1 row_mask:0xf bank_mask:0xf
    v_fmac_f32_dpp v15, v6, v79 row_newbcast:1 row_mask:0xf bank_mask:0xf
    v_cvt_f32_i32 v80, v80
    v_cvt_f32_i32 v81, v81
    v_cvt_f32_i32 v82, v82
    v_cvt_f32_i32 v83, v83
    v_fmac_f32_dpp v16, v6, v80 row_newbcast:1 row_mask:0xf bank_mask:0xf
    v_fmac_f32_dpp v17, v6, v81 row_newbcast:1 row_mask:0xf bank_mask:0xf
    v_fmac_f32_dpp v18, v6, v82 row_newbcast:1 row_mask:0xf bank_mask:0xf
    v_fmac_f32_dpp v19, v6, v83 row_newbcast:1 row_mask:0xf bank_mask:0xf
    v_cvt_f32_i32 v84, v84
    v_cvt_f32_i32 v85, v85
    v_cvt_f32_i32 v86, v86
    v_cvt_f32_i32 v87, v87
    v_fmac_f32_dpp v20, v6, v84 row_newbcast:1 row_mask:0xf bank_mask:0xf
    v_fmac_f32_dpp v21, v6, v85 row_newbcast:1 row_mask:0xf bank_mask:0xf
    v_fmac_f32_dpp v22, v6, v86 row_newbcast:1 row_mask:0xf bank_mask:0xf
    v_fmac_f32_dpp v23, v6, v87 row_newbcast:1 row_mask:0xf bank_mask:0xf
    s_waitcnt vmcnt(0)
    buffer_load_dwordx4 v[112:115], v48, s[12:15], 0 offen offset:3072 nt
    buffer_load_dwordx4 v[116:119], v48, s[12:15], 0 offen offset:3328 nt
    buffer_load_dwordx4 v[120:123], v48, s[12:15], 0 offen offset:3584 nt
    buffer_load_dwordx4 v[124:127], v49, s[12:15], 0 offen offset:0 nt
    buffer_load_dwordx4 v[128:131], v49, s[12:15], 0 offen offset:256 nt
    buffer_load_dwordx4 v[132:135], v49, s[12:15], 0 offen offset:512 nt
    s_add_u32 s29, s29, 4
    s_add_u32 s30, s30, 1
    s_bitcmp1_b64 s[40:41], s30
    s_cbranch_scc1 L_evV
L_evretV:
    s_nop 1
    s_lshr_b32 s33, s29, 6
    s_lshl_b32 s33, s33, 11
    s_and_b32 s32, s29, 33
    s_and_b32 s34, s29, 28
    s_lshr_b32 s34, s34, 1
    s_or_b32 s32, s32, s34
    s_and_b32 s34, s29, 2
    s_lshl_b32 s34, s34, 3
    s_or_b32 s32, s32, s34
    s_add_u32 s32, s32, s33
    s_xor_b32 s32, s32, s44
    s_bfe_u32 s33, s32, 0x20003
    s_and_b32 s34, s32, 4
    s_or_b32 s33, s33, s34
    s_xor_b32 s33, s33, s5
    s_lshl_b32 s50, s32, 5
    s_or_b32 s50, s50, s33
    s_lshl_b32 s50, s50, 4
    s_or_b32 s50, s50, 1
    s_lshl_b32 s53, s29, 7
    v_xor_b32 v10, s50, v50
    v_mul_hi_u32 v10, v10, s47
    v_lshrrev_b32 v10, 1, v10
    v_and_b32 v11, 15, v10
    v_cmp_eq_u32 vcc, 5, v11
    v_mad_u32_u24 v48, v10, s45, v2
    v_add_u32 v11, 3840, v48
    v_cndmask_b32 v49, v51, v11, vcc
    v_add_u32 v10, s53, v5
    ds_read_b32 v7, v10
    s_cmp_eq_u32 s30, 48
    s_cbranch_scc1 L_el0
L_el0r:
    v_cvt_f32_i32 v88, v88
    v_cvt_f32_i32 v89, v89
    v_cvt_f32_i32 v90, v90
    v_cvt_f32_i32 v91, v91
    v_fmac_f32_dpp v12, v6, v88 row_newbcast:2 row_mask:0xf bank_mask:0xf
    v_fmac_f32_dpp v13, v6, v89 row_newbcast:2 row_mask:0xf bank_mask:0xf
    v_fmac_f32_dpp v14, v6, v90 row_newbcast:2 row_mask:0xf bank_mask:0xf
    v_fmac_f32_dpp v15, v6, v91 row_newbcast:2 row_mask:0xf bank_mask:0xf
    v_cvt_f32_i32 v92, v92
    v_cvt_f32_i32 v93, v93
    v_cvt_f32_i32 v94, v94
    v_cvt_f32_i32 v95, v95
    v_fmac_f32_dpp v16, v6, v92 row_newbcast:2 row_mask:0xf bank_mask:0xf
    v_fmac_f32_dpp v17, v6, v93 row_newbcast:2 row_mask:0xf bank_mask:0xf
    v_fmac_f32_dpp v18, v6, v94 row_newbcast:2 row_mask:0xf bank_mask:0xf
    v_fmac_f32_dpp v19, v6, v95 row_newbcast:2 row_mask:0xf bank_mask:0xf
    v_cvt_f32_i32 v96, v96
    v_cvt_f32_i32 v97, v97
    v_cvt_f32_i32 v98, v98
    v_cvt_f32_i32 v99, v99
    v_fmac_f32_dpp v20, v6, v96 row_newbcast:2 row_mask:0xf bank_mask:0xf
    v_fmac_f32_dpp v21, v6, v97 row_newbcast:2 row_mask:0xf bank_mask:0xf
    v_fmac_f32_dpp v22, v6, v98 row_newbcast:2 row_mask:0xf bank_mask:0xf
    v_fmac_f32_dpp v23, v6, v99 row_newbcast:2 row_mask:0xf bank_mask:0xf
    v_cvt_f32_i32 v100, v100
    v_cvt_f32_i32 v101, v101
    v_cvt_f32_i32 v102, v102
    v_cvt_f32_i32 v103, v103
    v_fmac_f32_dpp v12, v6, v100 row_newbcast:3 row_mask:0xf bank_mask:0xf
    v_fmac_f32_dpp v13, v6, v101 row_newbcast:3 row_mask:0xf bank_mask:0xf
    v_fmac_f32_dpp v14, v6, v102 row_newbcast:3 row_mask:0xf bank_mask:0xf
    v_fmac_f32_dpp v15, v6, v103 row_newbcast:3 row_mask:0xf bank_mask:0xf
    v_cvt_f32_i32 v104, v104
    v_cvt_f32_i32 v105, v105
    v_cvt_f32_i32 v106, v106
    v_cvt_f32_i32 v107, v107
    v_fmac_f32_dpp v16, v6, v104 row_newbcast:3 row_mask:0xf bank_mask:0xf
    v_fmac_f32_dpp v17, v6, v105 row_newbcast:3 row_mask:0xf bank_mask:0xf
    v_fmac_f32_dpp v18, v6, v106 row_newbcast:3 row_mask:0xf bank_mask:0xf
    v_fmac_f32_dpp v19, v6, v107 row_newbcast:3 row_mask:0xf bank_mask:0xf
    v_cvt_f32_i32 v108, v108
    v_cvt_f32_i32 v109, v109
    v_cvt_f32_i32 v110, v110
    v_cvt_f32_i32 v111, v111
    v_fmac_f32_dpp v20, v6, v108 row_newbcast:3 row_mask:0xf bank_mask:0xf
    v_fmac_f32_dpp v21, v6, v109 row_newbcast:3 row_mask:0xf bank_mask:0xf
    v_fmac_f32_dpp v22, v6, v110 row_newbcast:3 row_mask:0xf bank_mask:0xf
    v_fmac_f32_dpp v23, v6, v111 row_newbcast:3 row_mask:0xf bank_mask:0xf
    s_waitcnt vmcnt(0)
    buffer_load_dwordx4 v[64:67], v48, s[12:15], 0 offen offset:0 nt
    buffer_load_dwordx4 v[68:71], v48, s[12:15], 0 offen offset:256 nt
    buffer_load_dwordx4 v[72:75], v48, s[12:15], 0 offen offset:512 nt
    buffer_load_dwordx4 v[76:79], v48, s[12:15], 0 offen offset:768 nt
    buffer_load_dwordx4 v[80:83], v48, s[12:15], 0 offen offset:1024 nt
    buffer_load_dwordx4 v[84:87], v48, s[12:15], 0 offen offset:1280 nt
    v_cvt_f32_i32 v112, v112
    v_cvt_f32_i32 v113, v113
    v_cvt_f32_i32 v114, v114
    v_cvt_f32_i32 v115, v115
    v_fmac_f32_dpp v12, v6, v112 row_newbcast:4 row_mask:0xf bank_mask:0xf
    v_fmac_f32_dpp v13, v6, v113 row_newbcast:4 row_mask:0xf bank_mask:0xf
    v_fmac_f32_dpp v14, v6, v114 row_newbcast:4 row_mask:0xf bank_mask:0xf
    v_fmac_f32_dpp v15, v6, v115 row_newbcast:4 row_mask:0xf bank_mask:0xf
    v_cvt_f32_i32 v116, v116
    v_cvt_f32_i32 v117, v117
    v_cvt_f32_i32 v118, v118
    v_cvt_f32_i32 v119, v119
    v_fmac_f32_dpp v16, v6, v116 row_newbcast:4 row_mask:0xf bank_mask:0xf
    v_fmac_f32_dpp v17, v6, v117 row_newbcast:4 row_mask:0xf bank_mask:0xf
    v_fmac_f32_dpp v18, v6, v118 row_newbcast:4 row_mask:0xf bank_mask:0xf
    v_fmac_f32_dpp v19, v6, v119 row_newbcast:4 row_mask:0xf bank_mask:0xf
    v_cvt_f32_i32 v120, v120
    v_cvt_f32_i32 v121, v121
    v_cvt_f32_i32 v122, v122
    v_cvt_f32_i32 v123, v123
    v_fmac_f32_dpp v20, v6, v120 row_newbcast:4 row_mask:0xf bank_mask:0xf
    v_fmac_f32_dpp v21, v6, v121 row_newbcast:4 row_mask:0xf bank_mask:0xf
    v_fmac_f32_dpp v22, v6, v122 row_newbcast:4 row_mask:0xf bank_mask:0xf
    v_fmac_f32_dpp v23, v6, v123 row_newbcast:4 row_mask:0xf bank_mask:0xf
    v_cvt_f32_i32 v124, v124
    v_cvt_f32_i32 v125, v125
    v_cvt_f32_i32 v126, v126
    v_cvt_f32_i32 v127, v127
    v_fmac_f32_dpp v12, v6, v124 row_newbcast:5 row_mask:0xf bank_mask:0xf
    v_fmac_f32_dpp v13, v6, v125 row_newbcast:5 row_mask:0xf bank_mask:0xf
    v_fmac_f32_dpp v14, v6, v126 row_newbcast:5 row_mask:0xf bank_mask:0xf
    v_fmac_f32_dpp v15, v6, v127 row_newbcast:5 row_mask:0xf bank_mask:0xf
    v_cvt_f32_i32 v128, v128
    v_cvt_f32_i32 v129, v129
    v_cvt_f32_i32 v130, v130
    v_cvt_f32_i32 v131, v131
    v_fmac_f32_dpp v16, v6, v128 row_newbcast:5 row_mask:0xf bank_mask:0xf
    v_fmac_f32_dpp v17, v6, v129 row_newbcast:5 row_mask:0xf bank_mask:0xf
    v_fmac_f32_dpp v18, v6, v130 row_newbcast:5 row_mask:0xf bank_mask:0xf
    v_fmac_f32_dpp v19, v6, v131 row_newbcast:5 row_mask:0xf bank_mask:0xf
    v_cvt_f32_i32 v132, v132
    v_cvt_f32_i32 v133, v133
    v_cvt_f32_i32 v134, v134
    v_cvt_f32_i32 v135, v135
    v_fmac_f32_dpp v20, v6, v132 row_newbcast:5 row_mask:0xf bank_mask:0xf
    v_fmac_f32_dpp v21, v6, v133 row_newbcast:5 row_mask:0xf bank_mask:0xf
    v_fmac_f32_dpp v22, v6, v134 row_newbcast:5 row_mask:0xf bank_mask:0xf
    v_fmac_f32_dpp v23, v6, v135 row_newbcast:5 row_mask:0xf bank_mask:0xf
    s_waitcnt lgkmcnt(0)
    v_mov_b32 v6, v7
L_vchk:
    s_nop 1
    s_cmp_eq_u32 s30, s49
    s_cbranch_scc1 L_deep
    s_cmp_lg_u32 s59, 0
    s_cbranch_scc1 L_vboost
    s_and_b32 s32, s30, 15
    s_cbranch_scc1 L_vloop
L_vend:
    s_nop 1
    v_permlane32_swap_b32 v12, v14
    v_permlane32_swap_b32 v13, v15
    v_permlane32_swap_b32 v16, v18
    v_permlane32_swap_b32 v17, v19
    v_permlane32_swap_b32 v20, v22
    v_permlane32_swap_b32 v21, v23
    v_add_f32 v12, v12, v14
    v_add_f32 v13, v13, v15
    v_add_f32 v16, v16, v18
    v_add_f32 v17, v17, v19
    v_add_f32 v20, v20, v22
    v_add_f32 v21, v21, v23
    v_permlane16_swap_b32 v12, v13
    v_permlane16_swap_b32 v16, v17
    v_permlane16_swap_b32 v20, v21
    s_lshr_b32 s32, s30, 2
    v_mov_b32 v10, s32
    v_add_f32 v12, v12, v13
    ds_write_b32 v8, v12 offset:0
    v_add_f32 v16, v16, v17
    ds_write_b32 v8, v16 offset:256
    v_add_f32 v20, v20, v21
    ds_write_b32 v8, v20 offset:512
    v_mov_b32 v11, 1
    s_mov_b64 exec, 1
    ds_add_u32 v10, v11 offset:60
    s_mov_b64 exec, -1
    v_add_u32 v8, 3072, v8
    v_mov_b32 v12, 0
    v_mov_b32 v13, 0
    v_mov_b32 v14, 0
    v_mov_b32 v15, 0
    v_mov_b32 v16, 0
    v_mov_b32 v17, 0
    v_mov_b32 v18, 0
    v_mov_b32 v19, 0
    v_mov_b32 v20, 0
    v_mov_b32 v21, 0
    v_mov_b32 v22, 0
    v_mov_b32 v23, 0
    s_cmp_lg_u32 s59, 0
    s_cbranch_scc1 L_vboost2
L_vend2:
    s_nop 1
    s_cmp_lg_u32 s30, 48
    s_cbranch_scc1 L_vloop
L_exit1:
    s_endpgm
L_deep:
    s_nop 1
    buffer_load_dwordx4 v[88:91], v48, s[12:15], 0 offen offset:1536 nt
    buffer_load_dwordx4 v[92:95], v48, s[12:15], 0 offen offset:1792 nt
    buffer_load_dwordx4 v[96:99], v48, s[12:15], 0 offen offset:2048 nt
    buffer_load_dwordx4 v[100:103], v48, s[12:15], 0 offen offset:2304 nt
    buffer_load_dwordx4 v[104:107], v48, s[12:15], 0 offen offset:2560 nt
    buffer_load_dwordx4 v[108:111], v48, s[12:15], 0 offen offset:2816 nt
    buffer_load_dwordx4 v[112:115], v48, s[12:15], 0 offen offset:3072 nt
    buffer_load_dwordx4 v[116:119], v48, s[12:15], 0 offen offset:3328 nt
    buffer_load_dwordx4 v[120:123], v48, s[12:15], 0 offen offset:3584 nt
    buffer_load_dwordx4 v[124:127], v49, s[12:15], 0 offen offset:0 nt
    buffer_load_dwordx4 v[128:131], v49, s[12:15], 0 offen offset:256 nt
    buffer_load_dwordx4 v[132:135], v49, s[12:15], 0 offen offset:512 nt
.p2align 6
L_dloop:
    s_nop 1
    s_add_u32 s29, s29, 4
    s_add_u32 s30, s30, 1
    s_lshr_b32 s33, s29, 6
    s_lshl_b32 s33, s33, 11
    s_and_b32 s32, s29, 33
    s_and_b32 s34, s29, 28
    s_lshr_b32 s34, s34, 1
    s_or_b32 s32, s32, s34
    s_and_b32 s34, s29, 2
    s_lshl_b32 s34, s34, 3
    s_or_b32 s32, s32, s34
    s_add_u32 s32, s32, s33
    s_xor_b32 s32, s32, s44
    s_bfe_u32 s33, s32, 0x20003
    s_and_b32 s34, s32, 4
    s_or_b32 s33, s33, s34
    s_xor_b32 s33, s33, s5
    s_lshl_b32 s50, s32, 5
    s_or_b32 s50, s50, s33
    s_lshl_b32 s50, s50, 4
    s_or_b32 s50, s50, 1
    s_lshl_b32 s53, s29, 7
    v_xor_b32 v10, s50, v50
    v_mul_hi_u32 v10, v10, s47
    v_lshrrev_b32 v10, 1, v10
    v_and_b32 v11, 15, v10
    v_cmp_eq_u32 vcc, 5, v11
    v_mad_u32_u24 v48, v10, s45, v2
    v_add_u32 v11, 3840, v48
    v_cndmask_b32 v49, v51, v11, vcc
    v_add_u32 v10, s53, v5
    ds_read_b32 v7, v10
    s_waitcnt vmcnt(12)
    v_cvt_f32_i32 v64, v64
    v_cvt_f32_i32 v65, v65
    v_cvt_f32_i32 v66, v66
    v_cvt_f32_i32 v67, v67
    v_fmac_f32_dpp v12, v6, v64 row_newbcast:0 row_mask:0xf bank_mask:0xf
    v_fmac_f32_dpp v13, v6, v65 row_newbcast:0 row_mask:0xf bank_mask:0xf
    v_fmac_f32_dpp v14, v6, v66 row_newbcast:0 row_mask:0xf bank_mask:0xf
    v_fmac_f32_dpp v15, v6, v67 row_newbcast:0 row_mask:0xf bank_mask:0xf
    v_cvt_f32_i32 v68, v68
    v_cvt_f32_i32 v69, v69
    v_cvt_f32_i32 v70, v70
    v_cvt_f32_i32 v71, v71
    v_fmac_f32_dpp v16, v6, v68 row_newbcast:0 row_mask:0xf bank_mask:0xf
    v_fmac_f32_dpp v17, v6, v69 row_newbcast:0 row_mask:0xf bank_mask:0xf
    v_fmac_f32_dpp v18, v6, v70 row_newbcast:0 row_mask:0xf bank_mask:0xf
    v_fmac_f32_dpp v19, v6, v71 row_newbcast:0 row_mask:0xf bank_mask:0xf
    v_cvt_f32_i32 v72, v72
    v_cvt_f32_i32 v73, v73
    v_cvt_f32_i32 v74, v74
    v_cvt_f32_i32 v75, v75
    v_fmac_f32_dpp v20, v6, v72 row_newbcast:0 row_mask:0xf bank_mask:0xf
    v_fmac_f32_dpp v21, v6, v73 row_newbcast:0 row_mask:0xf bank_mask:0xf
    v_fmac_f32_dpp v22, v6, v74 row_newbcast:0 row_mask:0xf bank_mask:0xf
    v_fmac_f32_dpp v23, v6, v75 row_newbcast:0 row_mask:0xf bank_mask:0xf
    v_cvt_f32_i32 v76, v76
    v_cvt_f32_i32 v77, v77
    v_cvt_f32_i32 v78, v78
    v_cvt_f32_i32 v79, v79
    v_fmac_f32_dpp v12, v6, v76 row_newbcast:1 row_mask:0xf bank_mask:0xf
    v_fmac_f32_dpp v13, v6, v77 row_newbcast:1 row_mask:0xf bank_mask:0xf
    v_fmac_f32_dpp v14, v6, v78 row_newbcast:1 row_mask:0xf bank_mask:0xf
    v_fmac_f32_dpp v15, v6, v79 row_newbcast:1 row_mask:0xf bank_mask:0xf
    v_cvt_f32_i32 v80, v80
    v_cvt_f32_i32 v81, v81
    v_cvt_f32_i32 v82, v82
    v_cvt_f32_i32 v83, v83
    v_fmac_f32_dpp v16, v6, v80 row_newbcast:1 row_mask:0xf bank_mask:0xf
    v_fmac_f32_dpp v17, v6, v81 row_newbcast:1 row_mask:0xf bank_mask:0xf
    v_fmac_f32_dpp v18, v6, v82 row_newbcast:1 row_mask:0xf bank_mask:0xf
    v_fmac_f32_dpp v19, v6, v83 row_newbcast:1 row_mask:0xf bank_mask:0xf
    v_cvt_f32_i32 v84, v84
    v_cvt_f32_i32 v85, v85
    v_cvt_f32_i32 v86, v86
    v_cvt_f32_i32 v87, v87
    v_fmac_f32_dpp v20, v6, v84 row_newbcast:1 row_mask:0xf bank_mask:0xf
    v_fmac_f32_dpp v21, v6, v85 row_newbcast:1 row_mask:0xf bank_mask:0xf
    v_fmac_f32_dpp v22, v6, v86 row_newbcast:1 row_mask:0xf bank_mask:0xf
    v_fmac_f32_dpp v23, v6, v87 row_newbcast:1 row_mask:0xf bank_mask:0xf
    buffer_load_dwordx4 v[64:67], v48, s[12:15], 0 offen offset:0 nt
    buffer_load_dwordx4 v[68:71], v48, s[12:15], 0 offen offset:256 nt
    buffer_load_dwordx4 v[72:75], v48, s[12:15], 0 offen offset:512 nt
    buffer_load_dwordx4 v[76:79], v48, s[12:15], 0 offen offset:768 nt
    buffer_load_dwordx4 v[80:83], v48, s[12:15], 0 offen offset:1024 nt
    buffer_load_dwordx4 v[84:87], v48, s[12:15], 0 offen offset:1280 nt
    s_waitcnt vmcnt(12)
    s_cmp_eq_u32 s30, 48
    s_cbranch_scc1 L_el1
L_el1r:
    v_cvt_f32_i32 v88, v88
    v_cvt_f32_i32 v89, v89
    v_cvt_f32_i32 v90, v90
    v_cvt_f32_i32 v91, v91
    v_fmac_f32_dpp v12, v6, v88 row_newbcast:2 row_mask:0xf bank_mask:0xf
    v_fmac_f32_dpp v13, v6, v89 row_newbcast:2 row_mask:0xf bank_mask:0xf
    v_fmac_f32_dpp v14, v6, v90 row_newbcast:2 row_mask:0xf bank_mask:0xf
    v_fmac_f32_dpp v15, v6, v91 row_newbcast:2 row_mask:0xf bank_mask:0xf
    v_cvt_f32_i32 v92, v92
    v_cvt_f32_i32 v93, v93
    v_cvt_f32_i32 v94, v94
    v_cvt_f32_i32 v95, v95
    v_fmac_f32_dpp v16, v6, v92 row_newbcast:2 row_mask:0xf bank_mask:0xf
    v_fmac_f32_dpp v17, v6, v93 row_newbcast:2 row_mask:0xf bank_mask:0xf
    v_fmac_f32_dpp v18, v6, v94 row_newbcast:2 row_mask:0xf bank_mask:0xf
    v_fmac_f32_dpp v19, v6, v95 row_newbcast:2 row_mask:0xf bank_mask:0xf
    v_cvt_f32_i32 v96, v96
    v_cvt_f32_i32 v97, v97
    v_cvt_f32_i32 v98, v98
    v_cvt_f32_i32 v99, v99
    v_fmac_f32_dpp v20, v6, v96 row_newbcast:2 row_mask:0xf bank_mask:0xf
    v_fmac_f32_dpp v21, v6, v97 row_newbcast:2 row_mask:0xf bank_mask:0xf
    v_fmac_f32_dpp v22, v6, v98 row_newbcast:2 row_mask:0xf bank_mask:0xf
    v_fmac_f32_dpp v23, v6, v99 row_newbcast:2 row_mask:0xf bank_mask:0xf
    v_cvt_f32_i32 v100, v100
    v_cvt_f32_i32 v101, v101
    v_cvt_f32_i32 v102, v102
    v_cvt_f32_i32 v103, v103
    v_fmac_f32_dpp v12, v6, v100 row_newbcast:3 row_mask:0xf bank_mask:0xf
    v_fmac_f32_dpp v13, v6, v101 row_newbcast:3 row_mask:0xf bank_mask:0xf
    v_fmac_f32_dpp v14, v6, v102 row_newbcast:3 row_mask:0xf bank_mask:0xf
    v_fmac_f32_dpp v15, v6, v103 row_newbcast:3 row_mask:0xf bank_mask:0xf
    v_cvt_f32_i32 v104, v104
    v_cvt_f32_i32 v105, v105
    v_cvt_f32_i32 v106, v106
    v_cvt_f32_i32 v107, v107
    v_fmac_f32_dpp v16, v6, v104 row_newbcast:3 row_mask:0xf bank_mask:0xf
    v_fmac_f32_dpp v17, v6, v105 row_newbcast:3 row_mask:0xf bank_mask:0xf
    v_fmac_f32_dpp v18, v6, v106 row_newbcast:3 row_mask:0xf bank_mask:0xf
    v_fmac_f32_dpp v19, v6, v107 row_newbcast:3 row_mask:0xf bank_mask:0xf
    v_cvt_f32_i32 v108, v108
    v_cvt_f32_i32 v109, v109
    v_cvt_f32_i32 v110, v110
    v_cvt_f32_i32 v111, v111
    v_fmac_f32_dpp v20, v6, v108 row_newbcast:3 row_mask:0xf bank_mask:0xf
    v_fmac_f32_dpp v21, v6, v109 row_newbcast:3 row_mask:0xf bank_mask:0xf
    v_fmac_f32_dpp v22, v6, v110 row_newbcast:3 row_mask:0xf bank_mask:0xf
    v_fmac_f32_dpp v23, v6, v111 row_newbcast:3 row_mask:0xf bank_mask:0xf
    buffer_load_dwordx4 v[88:91], v48, s[12:15], 0 offen offset:1536 nt
    buffer_load_dwordx4 v[92:95], v48, s[12:15], 0 offen offset:1792 nt
    buffer_load_dwordx4 v[96:99], v48, s[12:15], 0 offen offset:2048 nt
    buffer_load_dwordx4 v[100:103], v48, s[12:15], 0 offen offset:2304 nt
    buffer_load_dwordx4 v[104:107], v48, s[12:15], 0 offen offset:2560 nt
    buffer_load_dwordx4 v[108:111], v48, s[12:15], 0 offen offset:2816 nt
    s_waitcnt vmcnt(12)
    v_cvt_f32_i32 v112, v112
    v_cvt_f32_i32 v113, v113
    v_cvt_f32_i32 v114, v114
    v_cvt_f32_i32 v115, v115
    v_fmac_f32_dpp v12, v6, v112 row_newbcast:4 row_mask:0xf bank_mask:0xf
    v_fmac_f32_dpp v13, v6, v113 row_newbcast:4 row_mask:0xf bank_mask:0xf
    v_fmac_f32_dpp v14, v6, v114 row_newbcast:4 row_mask:0xf bank_mask:0xf
    v_fmac_f32_dpp v15, v6, v115 row_newbcast:4 row_mask:0xf bank_mask:0xf
    v_cvt_f32_i32 v116, v116
    v_cvt_f32_i32 v117, v117
    v_cvt_f32_i32 v118, v118
    v_cvt_f32_i32 v119, v119
    v_fmac_f32_dpp v16, v6, v116 row_newbcast:4 row_mask:0xf bank_mask:0xf
    v_fmac_f32_dpp v17, v6, v117 row_newbcast:4 row_mask:0xf bank_mask:0xf
    v_fmac_f32_dpp v18, v6, v118 row_newbcast:4 row_mask:0xf bank_mask:0xf
    v_fmac_f32_dpp v19, v6, v119 row_newbcast:4 row_mask:0xf bank_mask:0xf
    v_cvt_f32_i32 v120, v120
    v_cvt_f32_i32 v121, v121
    v_cvt_f32_i32 v122, v122
    v_cvt_f32_i32 v123, v123
    v_fmac_f32_dpp v20, v6, v120 row_newbcast:4 row_mask:0xf bank_mask:0xf
    v_fmac_f32_dpp v21, v6, v121 row_newbcast:4 row_mask:0xf bank_mask:0xf
    v_fmac_f32_dpp v22, v6, v122 row_newbcast:4 row_mask:0xf bank_mask:0xf
    v_fmac_f32_dpp v23, v6, v123 row_newbcast:4 row_mask:0xf bank_mask:0xf
    v_cvt_f32_i32 v124, v124
    v_cvt_f32_i32 v125, v125
    v_cvt_f32_i32 v126, v126
    v_cvt_f32_i32 v127, v127
    v_fmac_f32_dpp v12, v6, v124 row_newbcast:5 row_mask:0xf bank_mask:0xf
    v_fmac_f32_dpp v13, v6, v125 row_newbcast:5 row_mask:0xf bank_mask:0xf
    v_fmac_f32_dpp v14, v6, v126 row_newbcast:5 row_mask:0xf bank_mask:0xf
    v_fmac_f32_dpp v15, v6, v127 row_newbcast:5 row_mask:0xf bank_mask:0xf
    v_cvt_f32_i32 v128, v128
    v_cvt_f32_i32 v129, v129
    v_cvt_f32_i32 v130, v130
    v_cvt_f32_i32 v131, v131
    v_fmac_f32_dpp v16, v6, v128 row_newbcast:5 row_mask:0xf bank_mask:0xf
    v_fmac_f32_dpp v17, v6, v129 row_newbcast:5 row_mask:0xf bank_mask:0xf
    v_fmac_f32_dpp v18, v6, v130 row_newbcast:5 row_mask:0xf bank_mask:0xf
    v_fmac_f32_dpp v19, v6, v131 row_newbcast:5 row_mask:0xf bank_mask:0xf
    v_cvt_f32_i32 v132, v132
    v_cvt_f32_i32 v133, v133
    v_cvt_f32_i32 v134, v134
    v_cvt_f32_i32 v135, v135
    v_fmac_f32_dpp v20, v6, v132 row_newbcast:5 row_mask:0xf bank_mask:0xf
    v_fmac_f32_dpp v21, v6, v133 row_newbcast:5 row_mask:0xf bank_mask:0xf
    v_fmac_f32_dpp v22, v6, v134 row_newbcast:5 row_mask:0xf bank_mask:0xf
    v_fmac_f32_dpp v23, v6, v135 row_newbcast:5 row_mask:0xf bank_mask:0xf
    buffer_load_dwordx4 v[112:115], v48, s[12:15], 0 offen offset:3072 nt
    buffer_load_dwordx4 v[116:119], v48, s[12:15], 0 offen offset:3328 nt
    buffer_load_dwordx4 v[120:123], v48, s[12:15], 0 offen offset:3584 nt
    buffer_load_dwordx4 v[124:127], v49, s[12:15], 0 offen offset:0 nt
    buffer_load_dwordx4 v[128:131], v49, s[12:15], 0 offen offset:256 nt
    buffer_load_dwordx4 v[132:135], v49, s[12:15], 0 offen offset:512 nt
    s_waitcnt lgkmcnt(0)
    v_mov_b32 v6, v7
    s_cmp_lg_u32 s30, 48
    s_cbranch_scc1 L_dloop
    s_branch L_vend
L_kboost:
    s_nop 1
    s_cmp_eq_u32 s30, 47
    s_cbranch_scc1 L_kchk2
    buffer_load_dwordx4 v[88:91], v48, s[8:11], 0 offen offset:1536 nt
    buffer_load_dwordx4 v[92:95], v48, s[8:11], 0 offen offset:1792 nt
    buffer_load_dwordx4 v[96:99], v48, s[8:11], 0 offen offset:2048 nt
    buffer_load_dwordx4 v[100:103], v48, s[8:11], 0 offen offset:2304 nt
    buffer_load_dwordx4 v[104:107], v48, s[8:11], 0 offen offset:2560 nt
    buffer_load_dwordx4 v[108:111], v48, s[8:11], 0 offen offset:2816 nt
    buffer_load_dwordx4 v[112:115], v48, s[8:11], 0 offen offset:3072 nt
    buffer_load_dwordx4 v[116:119], v48, s[8:11], 0 offen offset:3328 nt
    buffer_load_dwordx4 v[120:123], v48, s[8:11], 0 offen offset:3584 nt
    buffer_load_dwordx4 v[124:127], v49, s[8:11], 0 offen offset:0 nt
    buffer_load_dwordx4 v[128:131], v49, s[8:11], 0 offen offset:256 nt
    buffer_load_dwordx4 v[132:135], v49, s[8:11], 0 offen offset:512 nt
    s_sub_u32 s59, s59, 1
    s_add_u32 s29, s29, 4
    s_add_u32 s30, s30, 1
    s_bitcmp1_b64 s[40:41], s30
    s_cbranch_scc1 L_evKB
L_evretKB:
    s_nop 1
    s_lshr_b32 s33, s29, 6
    s_lshl_b32 s33, s33, 11
    s_and_b32 s32, s29, 33
    s_and_b32 s34, s29, 28
    s_lshr_b32 s34, s34, 1
    s_or_b32 s32, s32, s34
    s_and_b32 s34, s29, 2
    s_lshl_b32 s34, s34, 3
    s_or_b32 s32, s32, s34
    s_add_u32 s32, s32, s33
    s_xor_b32 s32, s32, s44
    s_bfe_u32 s33, s32, 0x20003
    s_and_b32 s34, s32, 4
    s_or_b32 s33, s33, s34
    s_xor_b32 s33, s33, s5
    s_lshl_b32 s50, s32, 5
    s_or_b32 s50, s50, s33
    s_lshl_b32 s50, s50, 4
    s_or_b32 s50, s50, 1
    v_xor_b32 v10, s50, v50
    v_mul_hi_u32 v10, v10, s47
    v_lshrrev_b32 v10, 1, v10
    v_and_b32 v11, 15, v10
    v_cmp_eq_u32 vcc, 5, v11
    v_mad_u32_u24 v48, v10, s45, v2
    v_add_u32 v11, 3840, v48
    v_cndmask_b32 v49, v51, v11, vcc
    v_lshrrev_b32 v10, 6, v10
    v_mad_u32_u24 v9, v10, s46, v3
    buffer_load_dwordx2 v[42:43], v9, s[16:19], 0 offen offset:0
    buffer_load_dwordx2 v[44:45], v9, s[16:19], 0 offen offset:128
    buffer_load_dwordx2 v[46:47], v9, s[16:19], 0 offen offset:256
    s_waitcnt vmcnt(15)
    v_cvt_f32_i32 v64, v64
    v_cvt_f32_i32 v65, v65
    v_cvt_f32_i32 v66, v66
    v_cvt_f32_i32 v67, v67
    v_mul_f32 v54, v64, v24
    v_fmac_f32 v54, v65, v25
    v_fmac_f32 v54, v66, v26
    v_fmac_f32 v54, v67, v27
    v_cvt_f32_i32 v68, v68
    v_cvt_f32_i32 v69, v69
    v_cvt_f32_i32 v70, v70
    v_cvt_f32_i32 v71, v71
    v_fmac_f32 v54, v68, v28
    v_fmac_f32 v54, v69, v29
    v_fmac_f32 v54, v70, v30
    v_fmac_f32 v54, v71, v31
    v_cvt_f32_i32 v72, v72
    v_cvt_f32_i32 v73, v73
    v_cvt_f32_i32 v74, v74
    v_cvt_f32_i32 v75, v75
    v_fmac_f32 v54, v72, v32
    v_fmac_f32 v54, v73, v33
    v_fmac_f32 v54, v74, v34
    v_fmac_f32 v54, v75, v35
    v_cvt_f32_i32 v76, v76
    v_cvt_f32_i32 v77, v77
    v_add_f32_dpp v54, v54, v54 row_ror:8 row_mask:0xf bank_mask:0xf
    v_cvt_f32_i32 v78, v78
    v_cvt_f32_i32 v79, v79
    v_add_f32_dpp v54, v54, v54 row_ror:4 row_mask:0xf bank_mask:0xf
    v_mul_f32 v55, v76, v24
    v_fmac_f32 v55, v77, v25
    v_add_f32_dpp v54, v54, v54 row_ror:2 row_mask:0xf bank_mask:0xf
    v_fmac_f32 v55, v78, v26
    v_fmac_f32 v55, v79, v27
    v_add_f32_dpp v60, v54, v54 row_ror:1 row_mask:0xf bank_mask:0x1
    v_cvt_f32_i32 v80, v80
    v_cvt_f32_i32 v81, v81
    v_cvt_f32_i32 v82, v82
    v_cvt_f32_i32 v83, v83
    v_fmac_f32 v55, v80, v28
    v_fmac_f32 v55, v81, v29
    v_fmac_f32 v55, v82, v30
    v_fmac_f32 v55, v83, v31
    v_cvt_f32_i32 v84, v84
    v_cvt_f32_i32 v85, v85
    v_cvt_f32_i32 v86, v86
    v_cvt_f32_i32 v87, v87
    v_fmac_f32 v55, v84, v32
    v_fmac_f32 v55, v85, v33
    v_fmac_f32 v55, v86, v34
    v_fmac_f32 v55, v87, v35
    s_nop 1
    v_add_f32_dpp v55, v55, v55 row_ror:8 row_mask:0xf bank_mask:0xf
    s_nop 1
    v_add_f32_dpp v55, v55, v55 row_ror:4 row_mask:0xf bank_mask:0xf
    s_nop 1
    v_add_f32_dpp v55, v55, v55 row_ror:2 row_mask:0xf bank_mask:0xf
    s_nop 1
    v_add_f32_dpp v61, v55, v55 row_ror:1 row_mask:0xf bank_mask:0x1
    buffer_load_dwordx4 v[64:67], v48, s[8:11], 0 offen offset:0 nt
    buffer_load_dwordx4 v[68:71], v48, s[8:11], 0 offen offset:256 nt
    buffer_load_dwordx4 v[72:75], v48, s[8:11], 0 offen offset:512 nt
    buffer_load_dwordx4 v[76:79], v48, s[8:11], 0 offen offset:768 nt
    buffer_load_dwordx4 v[80:83], v48, s[8:11], 0 offen offset:1024 nt
    buffer_load_dwordx4 v[84:87], v48, s[8:11], 0 offen offset:1280 nt
    s_waitcnt vmcnt(15)
    v_cvt_f32_i32 v88, v88
    v_cvt_f32_i32 v89, v89
    v_cvt_f32_i32 v90, v90
    v_cvt_f32_i32 v91, v91
    v_mul_f32 v56, v88, v24
    v_fmac_f32 v56, v89, v25
    v_fmac_f32 v56, v90, v26
    v_fmac_f32 v56, v91, v27
    v_cvt_f32_i32 v92, v92
    v_cvt_f32_i32 v93, v93
    v_cvt_f32_i32 v94, v94
    v_cvt_f32_i32 v95, v95
    v_fmac_f32 v56, v92, v28
    v_fmac_f32 v56, v93, v29
    v_fmac_f32 v56, v94, v30
    v_fmac_f32 v56, v95, v31
    v_cvt_f32_i32 v96, v96
    v_cvt_f32_i32 v97, v97
    v_cvt_f32_i32 v98, v98
    v_cvt_f32_i32 v99, v99
    v_fmac_f32 v56, v96, v32
    v_fmac_f32 v56, v97, v33
    v_fmac_f32 v56, v98, v34
    v_fmac_f32 v56, v99, v35
    v_cvt_f32_i32 v100, v100
    v_cvt_f32_i32 v101, v101
    v_add_f32_dpp v56, v56, v56 row_ror:8 row_mask:0xf bank_mask:0xf
    v_cvt_f32_i32 v102, v102
    v_cvt_f32_i32 v103, v103
    v_add_f32_dpp v56, v56, v56 row_ror:4 row_mask:0xf bank_mask:0xf
    v_mul_f32 v57, v100, v24
    v_fmac_f32 v57, v101, v25
    v_add_f32_dpp v56, v56, v56 row_ror:2 row_mask:0xf bank_mask:0xf
    v_fmac_f32 v57, v102, v26
    v_fmac_f32 v57, v103, v27
    v_add_f32_dpp v60, v56, v56 row_ror:1 row_mask:0xf bank_mask:0x2
    v_cvt_f32_i32 v104, v104
    v_cvt_f32_i32 v105, v105
    v_cvt_f32_i32 v106, v106
    v_cvt_f32_i32 v107, v107
    v_fmac_f32 v57, v104, v28
    v_fmac_f32 v57, v105, v29
    v_fmac_f32 v57, v106, v30
    v_fmac_f32 v57, v107, v31
    v_cvt_f32_i32 v108, v108
    v_cvt_f32_i32 v109, v109
    v_cvt_f32_i32 v110, v110
    v_cvt_f32_i32 v111, v111
    v_fmac_f32 v57, v108, v32
    v_fmac_f32 v57, v109, v33
    v_fmac_f32 v57, v110, v34
    v_fmac_f32 v57, v111, v35
    s_nop 1
    v_add_f32_dpp v57, v57, v57 row_ror:8 row_mask:0xf bank_mask:0xf
    s_nop 1
    v_add_f32_dpp v57, v57, v57 row_ror:4 row_mask:0xf bank_mask:0xf
    s_nop 1
    v_add_f32_dpp v57, v57, v57 row_ror:2 row_mask:0xf bank_mask:0xf
    s_nop 1
    v_add_f32_dpp v61, v57, v57 row_ror:1 row_mask:0xf bank_mask:0x2
    s_waitcnt vmcnt(9)
    v_cvt_f32_i32 v112, v112
    v_cvt_f32_i32 v113, v113
    v_cvt_f32_i32 v114, v114
    v_cvt_f32_i32 v115, v115
    v_mul_f32 v58, v112, v24
    v_fmac_f32 v58, v113, v25
    v_fmac_f32 v58, v114, v26
    v_fmac_f32 v58, v115, v27
    v_cvt_f32_i32 v116, v116
    v_cvt_f32_i32 v117, v117
    v_cvt_f32_i32 v118, v118
    v_cvt_f32_i32 v119, v119
    v_fmac_f32 v58, v116, v28
    v_fmac_f32 v58, v117, v29
    v_fmac_f32 v58, v118, v30
    v_fmac_f32 v58, v119, v31
    v_cvt_f32_i32 v120, v120
    v_cvt_f32_i32 v121, v121
    v_cvt_f32_i32 v122, v122
    v_cvt_f32_i32 v123, v123
    v_fmac_f32 v58, v120, v32
    v_fmac_f32 v58, v121, v33
    v_fmac_f32 v58, v122, v34
    v_fmac_f32 v58, v123, v35
    v_cvt_f32_i32 v124, v124
    v_cvt_f32_i32 v125, v125
    v_add_f32_dpp v58, v58, v58 row_ror:8 row_mask:0xf bank_mask:0xf
    v_cvt_f32_i32 v126, v126
    v_cvt_f32_i32 v127, v127
    v_add_f32_dpp v58, v58, v58 row_ror:4 row_mask:0xf bank_mask:0xf
    v_mul_f32 v59, v124, v24
    v_fmac_f32 v59, v125, v25
    v_add_f32_dpp v58, v58, v58 row_ror:2 row_mask:0xf bank_mask:0xf
    v_fmac_f32 v59, v126, v26
    v_fmac_f32 v59, v127, v27
    v_add_f32_dpp v60, v58, v58 row_ror:1 row_mask:0xf bank_mask:0x4
    v_cvt_f32_i32 v128, v128
    v_cvt_f32_i32 v129, v129
    v_cvt_f32_i32 v130, v130
    v_cvt_f32_i32 v131, v131
    v_fmac_f32 v59, v128, v28
    v_fmac_f32 v59, v129, v29
    v_fmac_f32 v59, v130, v30
    v_fmac_f32 v59, v131, v31
    v_cvt_f32_i32 v132, v132
    v_cvt_f32_i32 v133, v133
    v_cvt_f32_i32 v134, v134
    v_cvt_f32_i32 v135, v135
    v_fmac_f32 v59, v132, v32
    v_fmac_f32 v59, v133, v33
    v_fmac_f32 v59, v134, v34
    v_fmac_f32 v59, v135, v35
    s_nop 1
    v_add_f32_dpp v59, v59, v59 row_ror:8 row_mask:0xf bank_mask:0xf
    s_nop 1
    v_add_f32_dpp v59, v59, v59 row_ror:4 row_mask:0xf bank_mask:0xf
    s_nop 1
    v_add_f32_dpp v59, v59, v59 row_ror:2 row_mask:0xf bank_mask:0xf
    s_nop 1
    v_add_f32_dpp v61, v59, v59 row_ror:1 row_mask:0xf bank_mask:0x4
    s_mov_b64 exec, s[42:43]
    ds_write_b64 v4, v[60:61]
    s_mov_b64 exec, -1
    v_add_u32 v4, 48, v4
    s_waitcnt vmcnt(6)
    v_lshlrev_b32 v10, 16, v36
    v_lshlrev_b32 v24, 16, v42
    v_and_b32 v11, 0xffff0000, v36
    v_and_b32 v25, 0xffff0000, v42
    v_mul_f32 v24, v24, v10
    v_mul_f32 v25, v25, v11
    v_lshlrev_b32 v10, 16, v37
    v_lshlrev_b32 v26, 16, v43
    v_and_b32 v11, 0xffff0000, v37
    v_and_b32 v27, 0xffff0000, v43
    v_mul_f32 v26, v26, v10
    v_mul_f32 v27, v27, v11
    v_lshlrev_b32 v10, 16, v38
    v_lshlrev_b32 v28, 16, v44
    v_and_b32 v11, 0xffff0000, v38
    v_and_b32 v29, 0xffff0000, v44
    v_mul_f32 v28, v28, v10
    v_mul_f32 v29, v29, v11
    v_lshlrev_b32 v10, 16, v39
    v_lshlrev_b32 v30, 16, v45
    v_and_b32 v11, 0xffff0000, v39
    v_and_b32 v31, 0xffff0000, v45
    v_mul_f32 v30, v30, v10
    v_mul_f32 v31, v31, v11
    v_lshlrev_b32 v10, 16, v40
    v_lshlrev_b32 v32, 16, v46
    v_and_b32 v11, 0xffff0000, v40
    v_and_b32 v33, 0xffff0000, v46
    v_mul_f32 v32, v32, v10
    v_mul_f32 v33, v33, v11
    v_lshlrev_b32 v10, 16, v41
    v_lshlrev_b32 v34, 16, v47
    v_and_b32 v11, 0xffff0000, v41
    v_and_b32 v35, 0xffff0000, v47
    v_mul_f32 v34, v34, v10
    v_mul_f32 v35, v35, v11
    s_branch L_kchk
L_vboost:
    s_nop 1
    s_and_b32 s32, s30, 15
    s_cbranch_scc0 L_vend
L_vboost2:
    s_nop 1
    s_cmp_eq_u32 s30, 48
    s_cbranch_scc1 L_vend2
    buffer_load_dwordx4 v[88:91], v48, s[12:15], 0 offen offset:1536 nt
    buffer_load_dwordx4 v[92:95], v48, s[12:15], 0 offen offset:1792 nt
    buffer_load_dwordx4 v[96:99], v48, s[12:15], 0 offen offset:2048 nt
    buffer_load_dwordx4 v[100:103], v48, s[12:15], 0 offen offset:2304 nt
    buffer_load_dwordx4 v[104:107], v48, s[12:15], 0 offen offset:2560 nt
    buffer_load_dwordx4 v[108:111], v48, s[12:15], 0 offen offset:2816 nt
    buffer_load_dwordx4 v[112:115], v48, s[12:15], 0 offen offset:3072 nt
    buffer_load_dwordx4 v[116:119], v48, s[12:15], 0 offen offset:3328 nt
    buffer_load_dwordx4 v[120:123], v48, s[12:15], 0 offen offset:3584 nt
    buffer_load_dwordx4 v[124:127], v49, s[12:15], 0 offen offset:0 nt
    buffer_load_dwordx4 v[128:131], v49, s[12:15], 0 offen offset:256 nt
    buffer_load_dwordx4 v[132:135], v49, s[12:15], 0 offen offset:512 nt
    s_sub_u32 s59, s59, 1
    s_add_u32 s29, s29, 4
    s_add_u32 s30, s30, 1
    s_bitcmp1_b64 s[40:41], s30
    s_cbranch_scc1 L_evVB
L_evretVB:
    s_nop 1
    s_lshr_b32 s33, s29, 6
    s_lshl_b32 s33, s33, 11
    s_and_b32 s32, s29, 33
    s_and_b32 s34, s29, 28
    s_lshr_b32 s34, s34, 1
    s_or_b32 s32, s32, s34
    s_and_b32 s34, s29, 2
    s_lshl_b32 s34, s34, 3
    s_or_b32 s32, s32, s34
    s_add_u32 s32, s32, s33
    s_xor_b32 s32, s32, s44
    s_bfe_u32 s33, s32, 0x20003
    s_and_b32 s34, s32, 4
    s_or_b32 s33, s33, s34
    s_xor_b32 s33, s33, s5
    s_lshl_b32 s50, s32, 5
    s_or_b32 s50, s50, s33
    s_lshl_b32 s50, s50, 4
    s_or_b32 s50, s50, 1
    s_lshl_b32 s53, s29, 7
    v_xor_b32 v10, s50, v50
    v_mul_hi_u32 v10, v10, s47
    v_lshrrev_b32 v10, 1, v10
    v_and_b32 v11, 15, v10
    v_cmp_eq_u32 vcc, 5, v11
    v_mad_u32_u24 v48, v10, s45, v2
    v_add_u32 v11, 3840, v48
    v_cndmask_b32 v49, v51, v11, vcc
    v_add_u32 v10, s53, v5
    ds_read_b32 v7, v10
    s_waitcnt vmcnt(12)
    v_cvt_f32_i32 v64, v64
    v_cvt_f32_i32 v65, v65
    v_cvt_f32_i32 v66, v66
    v_cvt_f32_i32 v67, v67
    v_fmac_f32_dpp v12, v6, v64 row_newbcast:0 row_mask:0xf bank_mask:0xf
    v_fmac_f32_dpp v13, v6, v65 row_newbcast:0 row_mask:0xf bank_mask:0xf
    v_fmac_f32_dpp v14, v6, v66 row_newbcast:0 row_mask:0xf bank_mask:0xf
    v_fmac_f32_dpp v15, v6, v67 row_newbcast:0 row_mask:0xf bank_mask:0xf
    v_cvt_f32_i32 v68, v68
    v_cvt_f32_i32 v69, v69
    v_cvt_f32_i32 v70, v70
    v_cvt_f32_i32 v71, v71
    v_fmac_f32_dpp v16, v6, v68 row_newbcast:0 row_mask:0xf bank_mask:0xf
    v_fmac_f32_dpp v17, v6, v69 row_newbcast:0 row_mask:0xf bank_mask:0xf
    v_fmac_f32_dpp v18, v6, v70 row_newbcast:0 row_mask:0xf bank_mask:0xf
    v_fmac_f32_dpp v19, v6, v71 row_newbcast:0 row_mask:0xf bank_mask:0xf
    v_cvt_f32_i32 v72, v72
    v_cvt_f32_i32 v73, v73
    v_cvt_f32_i32 v74, v74
    v_cvt_f32_i32 v75, v75
    v_fmac_f32_dpp v20, v6, v72 row_newbcast:0 row_mask:0xf bank_mask:0xf
    v_fmac_f32_dpp v21, v6, v73 row_newbcast:0 row_mask:0xf bank_mask:0xf
    v_fmac_f32_dpp v22, v6, v74 row_newbcast:0 row_mask:0xf bank_mask:0xf
    v_fmac_f32_dpp v23, v6, v75 row_newbcast:0 row_mask:0xf bank_mask:0xf
    v_cvt_f32_i32 v76, v76
    v_cvt_f32_i32 v77, v77
    v_cvt_f32_i32 v78, v78
    v_cvt_f32_i32 v79, v79
    v_fmac_f32_dpp v12, v6, v76 row_newbcast:1 row_mask:0xf bank_mask:0xf
    v_fmac_f32_dpp v13, v6, v77 row_newbcast:1 row_mask:0xf bank_mask:0xf
    v_fmac_f32_dpp v14, v6, v78 row_newbcast:1 row_mask:0xf bank_mask:0xf
    v_fmac_f32_dpp v15, v6, v79 row_newbcast:1 row_mask:0xf bank_mask:0xf
    v_cvt_f32_i32 v80, v80
    v_cvt_f32_i32 v81, v81
    v_cvt_f32_i32 v82, v82
    v_cvt_f32_i32 v83, v83
    v_fmac_f32_dpp v16, v6, v80 row_newbcast:1 row_mask:0xf bank_mask:0xf
    v_fmac_f32_dpp v17, v6, v81 row_newbcast:1 row_mask:0xf bank_mask:0xf
    v_fmac_f32_dpp v18, v6, v82 row_newbcast:1 row_mask:0xf bank_mask:0xf
    v_fmac_f32_dpp v19, v6, v83 row_newbcast:1 row_mask:0xf bank_mask:0xf
    v_cvt_f32_i32 v84, v84
    v_cvt_f32_i32 v85, v85
    v_cvt_f32_i32 v86, v86
    v_cvt_f32_i32 v87, v87
    v_fmac_f32_dpp v20, v6, v84 row_newbcast:1 row_mask:0xf bank_mask:0xf
    v_fmac_f32_dpp v21, v6, v85 row_newbcast:1 row_mask:0xf bank_mask:0xf
    v_fmac_f32_dpp v22, v6, v86 row_newbcast:1 row_mask:0xf bank_mask:0xf
    v_fmac_f32_dpp v23, v6, v87 row_newbcast:1 row_mask:0xf bank_mask:0xf
    buffer_load_dwordx4 v[64:67], v48, s[12:15], 0 offen offset:0 nt
    buffer_load_dwordx4 v[68:71], v48, s[12:15], 0 offen offset:256 nt
    buffer_load_dwordx4 v[72:75], v48, s[12:15], 0 offen offset:512 nt
    buffer_load_dwordx4 v[76:79], v48, s[12:15], 0 offen offset:768 nt
    buffer_load_dwordx4 v[80:83], v48, s[12:15], 0 offen offset:1024 nt
    buffer_load_dwordx4 v[84:87], v48, s[12:15], 0 offen offset:1280 nt
    s_waitcnt vmcnt(12)
    s_cmp_eq_u32 s30, 48
    s_cbranch_scc1 L_el2
L_el2r:
    v_cvt_f32_i32 v88, v88
    v_cvt_f32_i32 v89, v89
    v_cvt_f32_i32 v90, v90
    v_cvt_f32_i32 v91, v91
    v_fmac_f32_dpp v12, v6, v88 row_newbcast:2 row_mask:0xf bank_mask:0xf
    v_fmac_f32_dpp v13, v6, v89 row_newbcast:2 row_mask:0xf bank_mask:0xf
    v_fmac_f32_dpp v14, v6, v90 row_newbcast:2 row_mask:0xf bank_mask:0xf
    v_fmac_f32_dpp v15, v6, v91 row_newbcast:2 row_mask:0xf bank_mask:0xf
    v_cvt_f32_i32 v92, v92
    v_cvt_f32_i32 v93, v93
    v_cvt_f32_i32 v94, v94
    v_cvt_f32_i32 v95, v95
    v_fmac_f32_dpp v16, v6, v92 row_newbcast:2 row_mask:0xf bank_mask:0xf
    v_fmac_f32_dpp v17, v6, v93 row_newbcast:2 row_mask:0xf bank_mask:0xf
    v_fmac_f32_dpp v18, v6, v94 row_newbcast:2 row_mask:0xf bank_mask:0xf
    v_fmac_f32_dpp v19, v6, v95 row_newbcast:2 row_mask:0xf bank_mask:0xf
    v_cvt_f32_i32 v96, v96
    v_cvt_f32_i32 v97, v97
    v_cvt_f32_i32 v98, v98
    v_cvt_f32_i32 v99, v99
    v_fmac_f32_dpp v20, v6, v96 row_newbcast:2 row_mask:0xf bank_mask:0xf
    v_fmac_f32_dpp v21, v6, v97 row_newbcast:2 row_mask:0xf bank_mask:0xf
    v_fmac_f32_dpp v22, v6, v98 row_newbcast:2 row_mask:0xf bank_mask:0xf
    v_fmac_f32_dpp v23, v6, v99 row_newbcast:2 row_mask:0xf bank_mask:0xf
    v_cvt_f32_i32 v100, v100
    v_cvt_f32_i32 v101, v101
    v_cvt_f32_i32 v102, v102
    v_cvt_f32_i32 v103, v103
    v_fmac_f32_dpp v12, v6, v100 row_newbcast:3 row_mask:0xf bank_mask:0xf
    v_fmac_f32_dpp v13, v6, v101 row_newbcast:3 row_mask:0xf bank_mask:0xf
    v_fmac_f32_dpp v14, v6, v102 row_newbcast:3 row_mask:0xf bank_mask:0xf
    v_fmac_f32_dpp v15, v6, v103 row_newbcast:3 row_mask:0xf bank_mask:0xf
    v_cvt_f32_i32 v104, v104
    v_cvt_f32_i32 v105, v105
    v_cvt_f32_i32 v106, v106
    v_cvt_f32_i32 v107, v107
    v_fmac_f32_dpp v16, v6, v104 row_newbcast:3 row_mask:0xf bank_mask:0xf
    v_fmac_f32_dpp v17, v6, v105 row_newbcast:3 row_mask:0xf bank_mask:0xf
    v_fmac_f32_dpp v18, v6, v106 row_newbcast:3 row_mask:0xf bank_mask:0xf
    v_fmac_f32_dpp v19, v6, v107 row_newbcast:3 row_mask:0xf bank_mask:0xf
    v_cvt_f32_i32 v108, v108
    v_cvt_f32_i32 v109, v109
    v_cvt_f32_i32 v110, v110
    v_cvt_f32_i32 v111, v111
    v_fmac_f32_dpp v20, v6, v108 row_newbcast:3 row_mask:0xf bank_mask:0xf
    v_fmac_f32_dpp v21, v6, v109 row_newbcast:3 row_mask:0xf bank_mask:0xf
    v_fmac_f32_dpp v22, v6, v110 row_newbcast:3 row_mask:0xf bank_mask:0xf
    v_fmac_f32_dpp v23, v6, v111 row_newbcast:3 row_mask:0xf bank_mask:0xf
    s_waitcnt vmcnt(6)
    v_cvt_f32_i32 v112, v112
    v_cvt_f32_i32 v113, v113
    v_cvt_f32_i32 v114, v114
    v_cvt_f32_i32 v115, v115
    v_fmac_f32_dpp v12, v6, v112 row_newbcast:4 row_mask:0xf bank_mask:0xf
    v_fmac_f32_dpp v13, v6, v113 row_newbcast:4 row_mask:0xf bank_mask:0xf
    v_fmac_f32_dpp v14, v6, v114 row_newbcast:4 row_mask:0xf bank_mask:0xf
    v_fmac_f32_dpp v15, v6, v115 row_newbcast:4 row_mask:0xf bank_mask:0xf
    v_cvt_f32_i32 v116, v116
    v_cvt_f32_i32 v117, v117
    v_cvt_f32_i32 v118, v118
    v_cvt_f32_i32 v119, v119
    v_fmac_f32_dpp v16, v6, v116 row_newbcast:4 row_mask:0xf bank_mask:0xf
    v_fmac_f32_dpp v17, v6, v117 row_newbcast:4 row_mask:0xf bank_mask:0xf
    v_fmac_f32_dpp v18, v6, v118 row_newbcast:4 row_mask:0xf bank_mask:0xf
    v_fmac_f32_dpp v19, v6, v119 row_newbcast:4 row_mask:0xf bank_mask:0xf
    v_cvt_f32_i32 v120, v120
    v_cvt_f32_i32 v121, v121
    v_cvt_f32_i32 v122, v122
    v_cvt_f32_i32 v123, v123
    v_fmac_f32_dpp v20, v6, v120 row_newbcast:4 row_mask:0xf bank_mask:0xf
    v_fmac_f32_dpp v21, v6, v121 row_newbcast:4 row_mask:0xf bank_mask:0xf
    v_fmac_f32_dpp v22, v6, v122 row_newbcast:4 row_mask:0xf bank_mask:0xf
    v_fmac_f32_dpp v23, v6, v123 row_newbcast:4 row_mask:0xf bank_mask:0xf
    v_cvt_f32_i32 v124, v124
    v_cvt_f32_i32 v125, v125
    v_cvt_f32_i32 v126, v126
    v_cvt_f32_i32 v127, v127
    v_fmac_f32_dpp v12, v6, v124 row_newbcast:5 row_mask:0xf bank_mask:0xf
    v_fmac_f32_dpp v13, v6, v125 row_newbcast:5 row_mask:0xf bank_mask:0xf
    v_fmac_f32_dpp v14, v6, v126 row_newbcast:5 row_mask:0xf bank_mask:0xf
    v_fmac_f32_dpp v15, v6, v127 row_newbcast:5 row_mask:0xf bank_mask:0xf
    v_cvt_f32_i32 v128, v128
    v_cvt_f32_i32 v129, v129
    v_cvt_f32_i32 v130, v130
    v_cvt_f32_i32 v131, v131
    v_fmac_f32_dpp v16, v6, v128 row_newbcast:5 row_mask:0xf bank_mask:0xf
    v_fmac_f32_dpp v17, v6, v129 row_newbcast:5 row_mask:0xf bank_mask:0xf
    v_fmac_f32_dpp v18, v6, v130 row_newbcast:5 row_mask:0xf bank_mask:0xf
    v_fmac_f32_dpp v19, v6, v131 row_newbcast:5 row_mask:0xf bank_mask:0xf
    v_cvt_f32_i32 v132, v132
    v_cvt_f32_i32 v133, v133
    v_cvt_f32_i32 v134, v134
    v_cvt_f32_i32 v135, v135
    v_fmac_f32_dpp v20, v6, v132 row_newbcast:5 row_mask:0xf bank_mask:0xf
    v_fmac_f32_dpp v21, v6, v133 row_newbcast:5 row_mask:0xf bank_mask:0xf
    v_fmac_f32_dpp v22, v6, v134 row_newbcast:5 row_mask:0xf bank_mask:0xf
    v_fmac_f32_dpp v23, v6, v135 row_newbcast:5 row_mask:0xf bank_mask:0xf
    s_waitcnt lgkmcnt(0)
    v_mov_b32 v6, v7
    s_branch L_vchk
L_el0:
    s_nop 1
    v_mov_b32 v11, 1
    s_mov_b64 exec, 1
    ds_add_u32 v53, v11 offset:136
    s_mov_b64 exec, -1
    s_branch L_el0r
L_el1:
    s_nop 1
    v_mov_b32 v11, 1
    s_mov_b64 exec, 1
    ds_add_u32 v53, v11 offset:136
    s_mov_b64 exec, -1
    s_branch L_el1r
L_el2:
    s_nop 1
    v_mov_b32 v11, 1
    s_mov_b64 exec, 1
    ds_add_u32 v53, v11 offset:136
    s_mov_b64 exec, -1
    s_branch L_el2r
L_evK:
    s_nop 1
    s_bitcmp1_b64 s[64:65], s30
    s_cbranch_scc0 L_paK
    s_memrealtime s[60:61]
    s_mov_b32 s72, s59
    v_mov_b32 v11, 1
    s_mov_b64 exec, 1
    ds_add_u32 v53, v11 offset:128
    s_mov_b64 exec, -1
L_paK:
    s_nop 1
    s_bitcmp1_b64 s[66:67], s30
    s_cbranch_scc0 L_pbK
    v_mov_b32 v11, 1
    s_mov_b64 exec, 1
    ds_add_u32 v53, v11 offset:128
    s_mov_b64 exec, -1
L_pbK:
    s_nop 1
    s_bitcmp1_b64 s[68:69], s30
    s_cbranch_scc0 L_pcK
    v_mov_b32 v11, s62
    ds_read_b32 v10, v11
    v_mov_b32 v11, 1
    s_mov_b64 exec, 1
    ds_add_u32 v53, v11 offset:128
    s_mov_b64 exec, -1
    s_add_u32 s62, s62, 4
    s_waitcnt lgkmcnt(0)
    v_readfirstlane_b32 s32, v10
    s_cmp_eq_u32 s32, 0
    s_cbranch_scc1 L_pcK
    s_sub_u32 s32, s60, s32
    s_max_i32 s32, s32, -4096
    s_min_i32 s32, s32, 4096
    s_mul_i32 s32, s32, 8
    s_add_u32 s32, s32, 512
    s_ashr_i32 s32, s32, 10
    s_sub_u32 s32, s32, s72
    s_add_u32 s32, s32, s59
    s_max_i32 s32, s32, 0
    s_min_i32 s59, s32, 6
L_pcK:
    s_nop 1
    s_bitcmp1_b64 s[70:71], s30
    s_cbranch_scc0 L_evretK
    s_and_b32 s32, s30, 15
    s_cbranch_scc0 L_evK2
    s_cmp_eq_u32 s30, 3
    s_cbranch_scc1 L_evK2
    s_lshr_b32 s33, s30, 2
    s_andn2_b32 s33, s33, 3
    s_add_u32 s33, s33, 36
    s_cmp_eq_u32 s32, 1
    s_cselect_b32 s32, s33, 60
    s_cselect_b32 s33, 5376, 0
    v_add_u32 v4, s33, v4
    s_cmp_eq_u32 s30, 2
    s_cselect_b32 s32, 56, s32
    v_mov_b32 v10, s32
    v_mov_b32 v11, 1
    s_mov_b64 exec, 1
    ds_add_u32 v10, v11 offset:0
    s_mov_b64 exec, -1
    s_branch L_evretK
L_evK2:
    s_nop 1
    s_cmp_eq_u32 s30, 16
    s_cbranch_scc0 L_gxtk16
    s_memrealtime s[36:37]
    s_mov_b32 s6, 0x100000
L_wgtk16:
    s_nop 1
    ds_read_b32 v10, v53 offset:208
    s_sub_u32 s6, s6, 1
    s_cbranch_scc1 L_exit1
    s_waitcnt lgkmcnt(0)
    v_readfirstlane_b32 s32, v10
    s_cmp_eq_u32 s32, 0
    s_cbranch_scc1 L_wgtk16
    s_and_b32 s32, s32, 0xffff
    s_cbranch_scc0 L_gxtk16
    s_add_u32 s32, s32, s36
L_gltk16:
    s_nop 1
    s_memrealtime s[36:37]
    s_waitcnt lgkmcnt(0)
    s_sub_u32 s36, s36, s32
    s_cmp_lt_i32 s36, 0
    s_cbranch_scc1 L_gltk16
L_gxtk16:
    s_nop 1
    s_cmp_eq_u32 s30, 32
    s_cbranch_scc0 L_gxtk32
    s_memrealtime s[36:37]
    s_mov_b32 s6, 0x100000
L_wgtk32:
    s_nop 1
    ds_read_b32 v10, v53 offset:212
    s_sub_u32 s6, s6, 1
    s_cbranch_scc1 L_exit1
    s_waitcnt lgkmcnt(0)
    v_readfirstlane_b32 s32, v10
    s_cmp_eq_u32 s32, 0
    s_cbranch_scc1 L_wgtk32
    s_and_b32 s32, s32, 0xffff
    s_cbranch_scc0 L_gxtk32
    s_add_u32 s32, s32, s36
L_gltk32:
    s_nop 1
    s_memrealtime s[36:37]
    s_waitcnt lgkmcnt(0)
    s_sub_u32 s36, s36, s32
    s_cmp_lt_i32 s36, 0
    s_cbranch_scc1 L_gltk32
L_gxtk32:
    s_nop 1
    s_lshr_b32 s33, s30, 4
    s_lshl_b32 s34, s33, 2
    v_mov_b32 v11, s34
    s_lshl_b32 s31, s33, 5
    s_add_u32 s31, s31, s3
    s_mul_i32 s31, s31, 171
    s_lshr_b32 s31, s31, 9
    s_mul_i32 s31, s31, 384
    buffer_load_dwordx2 v[36:37], v3, s[20:23], s31 offen offset:0
    buffer_load_dwordx2 v[38:39], v3, s[20:23], s31 offen offset:128
    buffer_load_dwordx2 v[40:41], v3, s[20:23], s31 offen offset:256
    s_mov_b32 s6, 0x100000
L_wtk:
    s_nop 1
    ds_read_b32 v10, v11 offset:0
    s_sub_u32 s6, s6, 1
    s_cbranch_scc1 L_exit1
    s_waitcnt lgkmcnt(0)
    v_readfirstlane_b32 s32, v10
    s_cmp_eq_u32 s32, 0
    s_cbranch_scc1 L_wtk
    s_and_b32 s5, s32, 7
    s_xor_b32 s5, s5, s48
    s_bitcmp1_b32 s32, 3
    s_cselect_b64 vcc, -1, 0
    v_cndmask_b32 v50, v62, v63, vcc
    s_branch L_evretK
L_evV:
    s_nop 1
    s_bitcmp1_b64 s[64:65], s30
    s_cbranch_scc0 L_paV
    s_memrealtime s[60:61]
    s_mov_b32 s72, s59
    v_mov_b32 v11, 1
    s_mov_b64 exec, 1
    ds_add_u32 v53, v11 offset:128
    s_mov_b64 exec, -1
L_paV:
    s_nop 1
    s_bitcmp1_b64 s[66:67], s30
    s_cbranch_scc0 L_pbV
    v_mov_b32 v11, 1
    s_mov_b64 exec, 1
    ds_add_u32 v53, v11 offset:128
    s_mov_b64 exec, -1
L_pbV:
    s_nop 1
    s_bitcmp1_b64 s[68:69], s30
    s_cbranch_scc0 L_pcV
    v_mov_b32 v11, s62
    ds_read_b32 v10, v11
    v_mov_b32 v11, 1
    s_mov_b64 exec, 1
    ds_add_u32 v53, v11 offset:128
    s_mov_b64 exec, -1
    s_add_u32 s62, s62, 4
    s_waitcnt lgkmcnt(0)
    v_readfirstlane_b32 s32, v10
    s_cmp_eq_u32 s32, 0
    s_cbranch_scc1 L_pcV
    s_sub_u32 s32, s60, s32
    s_max_i32 s32, s32, -4096
    s_min_i32 s32, s32, 4096
    s_cmp_eq_u32 s30, 44
    s_cbranch_scc0 L_pd
    s_mul_i32 s32, s32, 9
    s_add_u32 s32, s32, 2048
    s_ashr_i32 s32, s32, 10
    s_max_i32 s32, s32, 0
    s_min_i32 s32, s32, 4
    s_sub_u32 s49, 48, s32
    s_cmp_eq_u32 s49, 48
    s_cselect_b32 s49, 255, s49
    s_mov_b32 s59, 0
    s_branch L_pcV
L_pd:
    s_nop 1
    s_mul_i32 s32, s32, 8
    s_add_u32 s32, s32, 512
    s_ashr_i32 s32, s32, 10
    s_sub_u32 s32, s32, s72
    s_add_u32 s32, s32, s59
    s_max_i32 s32, s32, 0
    s_min_i32 s59, s32, 6
L_pcV:
    s_nop 1
    s_bitcmp1_b64 s[70:71], s30
    s_cbranch_scc0 L_evretV
    s_cmp_eq_u32 s30, 16
    s_cbranch_scc0 L_gxtv264
    s_memrealtime s[36:37]
    s_mov_b32 s6, 0x100000
L_wgtv264:
    s_nop 1
    ds_read_b32 v10, v53 offset:220
    s_sub_u32 s6, s6, 1
    s_cbranch_scc1 L_exit1
    s_waitcnt lgkmcnt(0)
    v_readfirstlane_b32 s32, v10
    s_cmp_eq_u32 s32, 0
    s_cbranch_scc1 L_wgtv264
    s_and_b32 s32, s32, 0xffff
    s_cbranch_scc0 L_gxtv264
    s_add_u32 s32, s32, s36
L_gltv264:
    s_nop 1
    s_memrealtime s[36:37]
    s_waitcnt lgkmcnt(0)
    s_sub_u32 s36, s36, s32
    s_cmp_lt_i32 s36, 0
    s_cbranch_scc1 L_gltv264
L_gxtv264:
    s_nop 1
    s_cmp_eq_u32 s30, 32
    s_cbranch_scc0 L_gxtv280
    s_memrealtime s[36:37]
    s_mov_b32 s6, 0x100000
L_wgtv280:
    s_nop 1
    ds_read_b32 v10, v53 offset:224
    s_sub_u32 s6, s6, 1
    s_cbranch_scc1 L_exit1
    s_waitcnt lgkmcnt(0)
    v_readfirstlane_b32 s32, v10
    s_cmp_eq_u32 s32, 0
    s_cbranch_scc1 L_wgtv280
    s_and_b32 s32, s32, 0xffff
    s_cbranch_scc0 L_gxtv280
    s_add_u32 s32, s32, s36
L_gltv280:
    s_nop 1
    s_memrealtime s[36:37]
    s_waitcnt lgkmcnt(0)
    s_sub_u32 s36, s36, s32
    s_cmp_lt_i32 s36, 0
    s_cbranch_scc1 L_gltv280
L_gxtv280:
    s_nop 1
    s_lshr_b32 s33, s30, 4
    s_lshl_b32 s34, s33, 2
    v_mov_b32 v11, s34
    s_mov_b32 s6, 0x100000
L_wtv2:
    s_nop 1
    ds_read_b32 v10, v11 offset:24
    s_sub_u32 s6, s6, 1
    s_cbranch_scc1 L_exit1
    s_waitcnt lgkmcnt(0)
    v_readfirstlane_b32 s32, v10
    s_cmp_eq_u32 s32, 0
    s_cbranch_scc1 L_wtv2
    s_and_b32 s5, s32, 7
    s_xor_b32 s5, s5, s48
    s_bitcmp1_b32 s32, 3
    s_cselect_b64 vcc, -1, 0
    v_cndmask_b32 v50, v62, v63, vcc
    s_branch L_evretV
L_evKB:
    s_nop 1
    s_bitcmp1_b64 s[64:65], s30
    s_cbranch_scc0 L_paKB
    s_memrealtime s[60:61]
    s_mov_b32 s72, s59
    v_mov_b32 v11, 1
    s_mov_b64 exec, 1
    ds_add_u32 v53, v11 offset:128
    s_mov_b64 exec, -1
L_paKB:
    s_nop 1
    s_bitcmp1_b64 s[66:67], s30
    s_cbranch_scc0 L_pbKB
    v_mov_b32 v11, 1
    s_mov_b64 exec, 1
    ds_add_u32 v53, v11 offset:128
    s_mov_b64 exec, -1
L_pbKB:
    s_nop 1
    s_bitcmp1_b64 s[68:69], s30
    s_cbranch_scc0 L_pcKB
    v_mov_b32 v11, s62
    ds_read_b32 v10, v11
    v_mov_b32 v11, 1
    s_mov_b64 exec, 1
    ds_add_u32 v53, v11 offset:128
    s_mov_b64 exec, -1
    s_add_u32 s62, s62, 4
    s_waitcnt lgkmcnt(0)
    v_readfirstlane_b32 s32, v10
    s_cmp_eq_u32 s32, 0
    s_cbranch_scc1 L_pcKB
    s_sub_u32 s32, s60, s32
    s_max_i32 s32, s32, -4096
    s_min_i32 s32, s32, 4096
    s_mul_i32 s32, s32, 8
    s_add_u32 s32, s32, 512
    s_ashr_i32 s32, s32, 10
    s_sub_u32 s32, s32, s72
    s_add_u32 s32, s32, s59
    s_max_i32 s32, s32, 0
    s_min_i32 s59, s32, 6
L_pcKB:
    s_nop 1
    s_bitcmp1_b64 s[70:71], s30
    s_cbranch_scc0 L_evretKB
    s_and_b32 s32, s30, 15
    s_cbranch_scc0 L_evK2B
    s_cmp_eq_u32 s30, 3
    s_cbranch_scc1 L_evK2B
    s_lshr_b32 s33, s30, 2
    s_andn2_b32 s33, s33, 3
    s_add_u32 s33, s33, 36
    s_cmp_eq_u32 s32, 1
    s_cselect_b32 s32, s33, 60
    s_cselect_b32 s33, 5376, 0
    v_add_u32 v4, s33, v4
    s_cmp_eq_u32 s30, 2
    s_cselect_b32 s32, 56, s32
    v_mov_b32 v10, s32
    v_mov_b32 v11, 1
    s_mov_b64 exec, 1
    ds_add_u32 v10, v11 offset:0
    s_mov_b64 exec, -1
    s_branch L_evretKB
L_evK2B:
    s_nop 1
    s_cmp_eq_u32 s30, 16
    s_cbranch_scc0 L_gxtkB16
    s_memrealtime s[36:37]
    s_mov_b32 s6, 0x100000
L_wgtkB16:
    s_nop 1
    ds_read_b32 v10, v53 offset:208
    s_sub_u32 s6, s6, 1
    s_cbranch_scc1 L_exit1
    s_waitcnt lgkmcnt(0)
    v_readfirstlane_b32 s32, v10
    s_cmp_eq_u32 s32, 0
    s_cbranch_scc1 L_wgtkB16
    s_and_b32 s32, s32, 0xffff
    s_cbranch_scc0 L_gxtkB16
    s_add_u32 s32, s32, s36
L_gltkB16:
    s_nop 1
    s_memrealtime s[36:37]
    s_waitcnt lgkmcnt(0)
    s_sub_u32 s36, s36, s32
    s_cmp_lt_i32 s36, 0
    s_cbranch_scc1 L_gltkB16
L_gxtkB16:
    s_nop 1
    s_cmp_eq_u32 s30, 32
    s_cbranch_scc0 L_gxtkB32
    s_memrealtime s[36:37]
    s_mov_b32 s6, 0x100000
L_wgtkB32:
    s_nop 1
    ds_read_b32 v10, v53 offset:212
    s_sub_u32 s6, s6, 1
    s_cbranch_scc1 L_exit1
    s_waitcnt lgkmcnt(0)
    v_readfirstlane_b32 s32, v10
    s_cmp_eq_u32 s32, 0
    s_cbranch_scc1 L_wgtkB32
    s_and_b32 s32, s32, 0xffff
    s_cbranch_scc0 L_gxtkB32
    s_add_u32 s32, s32, s36
L_gltkB32:
    s_nop 1
    s_memrealtime s[36:37]
    s_waitcnt lgkmcnt(0)
    s_sub_u32 s36, s36, s32
    s_cmp_lt_i32 s36, 0
    s_cbranch_scc1 L_gltkB32
L_gxtkB32:
    s_nop 1
    s_lshr_b32 s33, s30, 4
    s_lshl_b32 s34, s33, 2
    v_mov_b32 v11, s34
    s_lshl_b32 s31, s33, 5
    s_add_u32 s31, s31, s3
    s_mul_i32 s31, s31, 171
    s_lshr_b32 s31, s31, 9
    s_mul_i32 s31, s31, 384
    buffer_load_dwordx2 v[36:37], v3, s[20:23], s31 offen offset:0
    buffer_load_dwordx2 v[38:39], v3, s[20:23], s31 offen offset:128
    buffer_load_dwordx2 v[40:41], v3, s[20:23], s31 offen offset:256
    s_mov_b32 s6, 0x100000
L_wtkB:
    s_nop 1
    ds_read_b32 v10, v11 offset:0
    s_sub_u32 s6, s6, 1
    s_cbranch_scc1 L_exit1
    s_waitcnt lgkmcnt(0)
    v_readfirstlane_b32 s32, v10
    s_cmp_eq_u32 s32, 0
    s_cbranch_scc1 L_wtkB
    s_and_b32 s5, s32, 7
    s_xor_b32 s5, s5, s48
    s_bitcmp1_b32 s32, 3
    s_cselect_b64 vcc, -1, 0
    v_cndmask_b32 v50, v62, v63, vcc
    s_branch L_evretKB
L_evVB:
    s_nop 1
    s_bitcmp1_b64 s[64:65], s30
    s_cbranch_scc0 L_paVB
    s_memrealtime s[60:61]
    s_mov_b32 s72, s59
    v_mov_b32 v11, 1
    s_mov_b64 exec, 1
    ds_add_u32 v53, v11 offset:128
    s_mov_b64 exec, -1
L_paVB:
    s_nop 1
    s_bitcmp1_b64 s[66:67], s30
    s_cbranch_scc0 L_pbVB
    v_mov_b32 v11, 1
    s_mov_b64 exec, 1
    ds_add_u32 v53, v11 offset:128
    s_mov_b64 exec, -1
L_pbVB:
    s_nop 1
    s_bitcmp1_b64 s[68:69], s30
    s_cbranch_scc0 L_pcVB
    v_mov_b32 v11, s62
    ds_read_b32 v10, v11
    v_mov_b32 v11, 1
    s_mov_b64 exec, 1
    ds_add_u32 v53, v11 offset:128
    s_mov_b64 exec, -1
    s_add_u32 s62, s62, 4
    s_waitcnt lgkmcnt(0)
    v_readfirstlane_b32 s32, v10
    s_cmp_eq_u32 s32, 0
    s_cbranch_scc1 L_pcVB
    s_sub_u32 s32, s60, s32
    s_max_i32 s32, s32, -4096
    s_min_i32 s32, s32, 4096
    s_cmp_eq_u32 s30, 44
    s_cbranch_scc0 L_pdB
    s_mul_i32 s32, s32, 9
    s_add_u32 s32, s32, 2048
    s_ashr_i32 s32, s32, 10
    s_max_i32 s32, s32, 0
    s_min_i32 s32, s32, 4
    s_sub_u32 s49, 48, s32
    s_cmp_eq_u32 s49, 48
    s_cselect_b32 s49, 255, s49
    s_mov_b32 s59, 0
    s_branch L_pcVB
L_pdB:
    s_nop 1
    s_mul_i32 s32, s32, 8
    s_add_u32 s32, s32, 512
    s_ashr_i32 s32, s32, 10
    s_sub_u32 s32, s32, s72
    s_add_u32 s32, s32, s59
    s_max_i32 s32, s32, 0
    s_min_i32 s59, s32, 6
L_pcVB:
    s_nop 1
    s_bitcmp1_b64 s[70:71], s30
    s_cbranch_scc0 L_evretVB
    s_cmp_eq_u32 s30, 16
    s_cbranch_scc0 L_gxtv2B64
    s_memrealtime s[36:37]
    s_mov_b32 s6, 0x100000
L_wgtv2B64:
    s_nop 1
    ds_read_b32 v10, v53 offset:220
    s_sub_u32 s6, s6, 1
    s_cbranch_scc1 L_exit1
    s_waitcnt lgkmcnt(0)
    v_readfirstlane_b32 s32, v10
    s_cmp_eq_u32 s32, 0
    s_cbranch_scc1 L_wgtv2B64
    s_and_b32 s32, s32, 0xffff
    s_cbranch_scc0 L_gxtv2B64
    s_add_u32 s32, s32, s36
L_gltv2B64:
    s_nop 1
    s_memrealtime s[36:37]
    s_waitcnt lgkmcnt(0)
    s_sub_u32 s36, s36, s32
    s_cmp_lt_i32 s36, 0
    s_cbranch_scc1 L_gltv2B64
L_gxtv2B64:
    s_nop 1
    s_cmp_eq_u32 s30, 32
    s_cbranch_scc0 L_gxtv2B80
    s_memrealtime s[36:37]
    s_mov_b32 s6, 0x100000
L_wgtv2B80:
    s_nop 1
    ds_read_b32 v10, v53 offset:224
    s_sub_u32 s6, s6, 1
    s_cbranch_scc1 L_exit1
    s_waitcnt lgkmcnt(0)
    v_readfirstlane_b32 s32, v10
    s_cmp_eq_u32 s32, 0
    s_cbranch_scc1 L_wgtv2B80
    s_and_b32 s32, s32, 0xffff
    s_cbranch_scc0 L_gxtv2B80
    s_add_u32 s32, s32, s36
L_gltv2B80:
    s_nop 1
    s_memrealtime s[36:37]
    s_waitcnt lgkmcnt(0)
    s_sub_u32 s36, s36, s32
    s_cmp_lt_i32 s36, 0
    s_cbranch_scc1 L_gltv2B80
L_gxtv2B80:
    s_nop 1
    s_lshr_b32 s33, s30, 4
    s_lshl_b32 s34, s33, 2
    v_mov_b32 v11, s34
    s_mov_b32 s6, 0x100000
L_wtv2B:
    s_nop 1
    ds_read_b32 v10, v11 offset:24
    s_sub_u32 s6, s6, 1
    s_cbranch_scc1 L_exit1
    s_waitcnt lgkmcnt(0)
    v_readfirstlane_b32 s32, v10
    s_cmp_eq_u32 s32, 0
    s_cbranch_scc1 L_wtv2B
    s_and_b32 s5, s32, 7
    s_xor_b32 s5, s5, s48
    s_bitcmp1_b32 s32, 3
    s_cselect_b64 vcc, -1, 0
    v_cndmask_b32 v50, v62, v63, vcc
    s_branch L_evretVB
L_helper:
    s_nop 1
    s_sub_u32 s6, s28, 4
    s_mov_b32 s5, s48
    v_and_b32 v1, 63, v0
    v_mov_b32 v2, 0
    s_mul_i32 s59, s3, 34816
    s_add_u32 s59, s59, 8388608
    s_cmp_eq_u32 s6, 3
    s_cbranch_scc1 L_h3
    s_mul_i32 s48, s6, 25
    s_sub_u32 s48, s48, 22
    s_cmp_lt_i32 s3, s48
    s_cselect_b32 s90, 1, 0
    s_cbranch_scc0 L_noprobe1
    s_add_u32 s49, s3, 2
    s_mul_i32 s48, s49, 205
    s_lshr_b32 s48, s48, 10
    s_mul_i32 s7, s48, 5
    s_sub_u32 s7, s49, s7
    s_add_u32 s7, s7, 1
    s_lshl_b32 s49, s3, 1
    s_add_u32 s49, s49, s6
    s_sub_u32 s49, s49, 1
    s_cmp_lt_u32 s3, 3
    s_cselect_b32 s7, 0, s7
    s_cselect_b32 s49, s49, s48
    s_and_b32 s48, s49, 1
    s_mul_i32 s20, s49, 20
    s_add_u32 s20, s20, s48
    s_add_u32 s20, s20, 2
    s_lshr_b32 s91, s20, 5
    s_xor_b32 s91, s91, s4
    s_lshl_b32 s20, s20, 21
    s_xor_b32 s21, s4, s6
    s_and_b32 s21, s21, 1
    s_lshr_b32 s49, s4, 2
    s_xor_b32 s48, s48, s49
    s_xor_b32 s48, s48, s21
    s_lshl_b32 s48, s48, 13
    s_lshl_b32 s49, s6, 14
    s_and_b32 s49, s49, 0x4000
    s_or_b32 s48, s48, s49
    s_xor_b32 s32, s48, 0x0
    s_xor_b32 s33, s48, 0x2000
    s_xor_b32 s34, s48, 0x1000
    s_xor_b32 s35, s48, 0x3000
    s_xor_b32 s36, s48, 0x4000
    s_xor_b32 s37, s48, 0x6000
    s_xor_b32 s38, s48, 0x5000
    s_xor_b32 s39, s48, 0x7000
    v_and_b32 v3, 7, v1
    v_lshlrev_b32 v3, 12, v3
    s_lshl_b32 s48, s4, 8
    v_add_u32 v3, s48, v3
    s_mov_b32 s10, 805306368
    s_mov_b32 s11, 0x00020000
    s_cmp_ge_u32 s7, 3
    s_cselect_b32 s48, 3, 0
    s_sub_u32 s48, s7, s48
    s_lshl_b32 s48, s48, 28
    s_add_u32 s20, s20, s48
    s_cmp_ge_u32 s7, 3
    s_waitcnt lgkmcnt(0)
    s_cselect_b32 s8, s68, s66
    s_cselect_b32 s23, s69, s67
    s_and_b32 s9, s23, 0xffff
    s_add_u32 s22, s8, s20
    s_addc_u32 s23, s23, 0
    s_lshl_b32 s48, s4, 8
    s_add_u32 s56, s22, s48
    s_addc_u32 s57, s23, 0
    s_load_dword s24, s[56:57], 0x0
    s_load_dword s25, s[56:57], 0x1000
    s_load_dword s26, s[56:57], 0x2000
    s_load_dword s27, s[56:57], 0x3000
    s_load_dword s28, s[56:57], 0x4000
    s_load_dword s29, s[56:57], 0x5000
    s_load_dword s30, s[56:57], 0x6000
    s_load_dword s31, s[56:57], 0x7000
    s_mov_b32 s12, s82
    s_and_b32 s13, s83, 0xffff
    s_mov_b32 s14, 10485760
    s_mov_b32 s15, 0x00020000
    s_lshl_b32 s48, s2, 1
    s_add_u32 s48, s48, s6
    s_mul_i32 s48, s48, 26112
    s_add_u32 s48, s48, 8362496
    v_mul_u32_u24 v5, 4352, v1
    v_mov_b32 v3, 0
    v_mov_b32 v4, 0
    s_cmp_eq_u32 s7, 0
    s_cselect_b64 exec, 0x3f, 0
    buffer_store_dwordx3 v[2:4], v5, s[12:15], s48 offen sc1
    s_mov_b64 exec, -1
    s_cmp_lg_u32 s7, 0
    s_cbranch_scc1 L_noprobe2
L_noprobe1:
    s_nop 1
    s_waitcnt lgkmcnt(0)
L_noprobe2:
    s_nop 1
    s_mov_b32 s12, s82
    s_and_b32 s13, s83, 0xffff
    s_mov_b32 s14, 10485760
    s_mov_b32 s15, 0x00020000
    s_mov_b32 s16, s80
    s_and_b32 s17, s81, 0xffff
    s_mov_b32 s18, 256
    s_mov_b32 s19, 0x00020000
    s_cmp_lg_u32 s6, 0
    s_cbranch_scc1 L_hbar
    v_lshlrev_b32 v5, 2, v1
    ds_write_b32 v5, v2
    s_waitcnt lgkmcnt(0)
L_hbar:
    s_nop 1
    s_barrier
    s_cmp_eq_u32 s90, 0
    s_cbranch_scc1 L_role
    s_mov_b32 s46, 1
    s_mov_b32 s58, 0
    s_mov_b32 s61, 0
    s_mov_b32 s62, 0
    s_mov_b32 s63, 0
    s_cmp_eq_u32 s7, 0
    s_cselect_b32 s47, 1, 7
    s_waitcnt lgkmcnt(0)
L_round:
    s_nop 1
    s_add_u32 s48, s4, s46
    s_and_b32 s48, s48, 7
    s_lshl_b32 s48, s48, 8
    s_add_u32 s56, s22, s48
    s_addc_u32 s57, s23, 0
    s_mov_b32 s44, -1
    s_memtime s[40:41]
    s_waitcnt lgkmcnt(0)
    s_load_dword s45, s[56:57], s32
    s_waitcnt lgkmcnt(0)
    s_memtime s[42:43]
    s_waitcnt lgkmcnt(0)
    s_sub_u32 s24, s42, s40
    s_load_dword s45, s[56:57], s33
    s_waitcnt lgkmcnt(0)
    s_memtime s[40:41]
    s_waitcnt lgkmcnt(0)
    s_sub_u32 s25, s40, s42
    s_load_dword s45, s[56:57], s34
    s_waitcnt lgkmcnt(0)
    s_memtime s[42:43]
    s_waitcnt lgkmcnt(0)
    s_sub_u32 s26, s42, s40
    s_load_dword s45, s[56:57], s35
    s_waitcnt lgkmcnt(0)
    s_memtime s[40:41]
    s_waitcnt lgkmcnt(0)
    s_sub_u32 s27, s40, s42
    s_mov_b32 s28, -1
    s_mov_b32 s29, -1
    s_mov_b32 s30, -1
    s_mov_b32 s31, -1
    s_cmp_eq_u32 s7, 0
    s_cbranch_scc1 L_few
    s_load_dword s45, s[56:57], s36
    s_waitcnt lgkmcnt(0)
    s_memtime s[42:43]
    s_waitcnt lgkmcnt(0)
    s_sub_u32 s28, s42, s40
    s_load_dword s45, s[56:57], s37
    s_waitcnt lgkmcnt(0)
    s_memtime s[40:41]
    s_waitcnt lgkmcnt(0)
    s_sub_u32 s29, s40, s42
    s_load_dword s45, s[56:57], s38
    s_waitcnt lgkmcnt(0)
    s_memtime s[42:43]
    s_waitcnt lgkmcnt(0)
    s_sub_u32 s30, s42, s40
    s_load_dword s45, s[56:57], s39
    s_waitcnt lgkmcnt(0)
    s_memtime s[40:41]
    s_waitcnt lgkmcnt(0)
    s_sub_u32 s31, s40, s42
L_few:
    s_nop 1
    s_min_u32 s24, s24, 1400
    s_min_u32 s44, s44, s24
    s_min_u32 s25, s25, 1400
    s_min_u32 s44, s44, s25
    s_min_u32 s26, s26, 1400
    s_min_u32 s44, s44, s26
    s_min_u32 s27, s27, 1400
    s_min_u32 s44, s44, s27
    s_min_u32 s28, s28, 1400
    s_min_u32 s44, s44, s28
    s_min_u32 s29, s29, 1400
    s_min_u32 s44, s44, s29
    s_min_u32 s30, s30, 1400
    s_min_u32 s44, s44, s30
    s_min_u32 s31, s31, 1400
    s_min_u32 s44, s44, s31
    s_cmp_lt_u32 s44, 290
    s_cbranch_scc1 L_skip
    s_sub_u32 s58, s58, s24
    s_add_u32 s58, s58, s25
    s_sub_u32 s58, s58, s26
    s_add_u32 s58, s58, s27
    s_sub_u32 s58, s58, s28
    s_add_u32 s58, s58, s29
    s_sub_u32 s58, s58, s30
    s_add_u32 s58, s58, s31
    s_cmp_eq_u32 s7, 0
    s_cbranch_scc1 L_skip
    s_min_u32 s48, s24, s26
    s_min_u32 s50, s28, s30
    s_min_u32 s48, s48, s50
    s_add_u32 s48, s48, 100
    s_min_u32 s49, s25, s27
    s_min_u32 s50, s29, s31
    s_min_u32 s49, s49, s50
    s_add_u32 s49, s49, 100
    s_min_u32 s24, s24, s48
    s_min_u32 s25, s25, s49
    s_min_u32 s26, s26, s48
    s_min_u32 s27, s27, s49
    s_min_u32 s28, s28, s48
    s_min_u32 s29, s29, s49
    s_min_u32 s30, s30, s48
    s_min_u32 s31, s31, s49
    s_sub_u32 s61, s61, s24
    s_sub_u32 s62, s62, s24
    s_sub_u32 s63, s63, s24
    s_add_u32 s61, s61, s25
    s_sub_u32 s62, s62, s25
    s_add_u32 s63, s63, s25
    s_add_u32 s61, s61, s26
    s_sub_u32 s62, s62, s26
    s_sub_u32 s63, s63, s26
    s_sub_u32 s61, s61, s27
    s_sub_u32 s62, s62, s27
    s_add_u32 s63, s63, s27
    s_sub_u32 s61, s61, s28
    s_add_u32 s62, s62, s28
    s_add_u32 s63, s63, s28
    s_add_u32 s61, s61, s29
    s_add_u32 s62, s62, s29
    s_sub_u32 s63, s63, s29
    s_add_u32 s61, s61, s30
    s_add_u32 s62, s62, s30
    s_add_u32 s63, s63, s30
    s_sub_u32 s61, s61, s31
    s_add_u32 s62, s62, s31
    s_sub_u32 s63, s63, s31
L_skip:
    s_nop 1
    s_add_u32 s46, s46, 1
    s_cmp_le_u32 s46, s47
    s_cbranch_scc1 L_round
    s_sub_u32 s48, 0, s58
    s_cmp_eq_u32 s21, 0
    s_cselect_b32 s58, s58, s48
    s_add_u32 s58, s58, 0x1010000
    v_mov_b32 v4, s58
    s_mov_b64 exec, 1
    s_lshl_b32 s48, s7, 2
    s_add_u32 s48, s48, 124
    s_cmp_eq_u32 s7, 0
    s_cbranch_scc0 L_post
    s_waitcnt vmcnt(0)
    ds_add_rtn_u32 v5, v2, v4 offset:36
    s_mov_b32 s48, 0
    s_waitcnt lgkmcnt(0)
    v_add_u32 v4, v4, v5
    v_cmp_ne_u32 vcc, 0, v5
    s_and_b64 exec, exec, vcc
    buffer_atomic_add v4, off, s[16:19], s48
    s_branch L_posted
L_post:
    s_nop 1
    s_mov_b32 s60, 0x100000
L_wvw:
    s_nop 1
    ds_read_b32 v10, v2 offset:0
    s_sub_u32 s60, s60, 1
    s_cbranch_scc1 L_exit1
    s_waitcnt lgkmcnt(0)
    v_readfirstlane_b32 s48, v10
    s_cmp_eq_u32 s48, 0
    s_cbranch_scc1 L_wvw
    s_lshr_b32 s48, s91, 1
    s_xor_b32 s48, s48, s21
    s_sub_u32 s49, 0, s61
    s_bitcmp1_b32 s48, 0
    s_cselect_b32 s61, s49, s61
    s_xor_b32 s48, s91, s21
    s_bitcmp1_b32 s4, 0
    s_cselect_b32 s48, s91, s48
    s_cselect_b32 s62, s62, s63
    s_sub_u32 s49, 0, s62
    s_bitcmp1_b32 s48, 0
    s_cselect_b32 s62, s49, s62
    s_add_u32 s61, s61, 0x1010000
    v_writelane_b32 v4, s61, 1
    s_add_u32 s62, s62, 0x1010000
    v_writelane_b32 v4, s62, 2
    s_lshl_b32 s48, s7, 2
    s_and_b32 s49, s4, 1
    s_or_b32 s48, s48, s49
    s_lshr_b32 s49, s4, 1
    s_and_b32 s49, s49, 2
    s_or_b32 s48, s48, s49
    s_mul_i32 s48, s48, 4352
    s_add_u32 s48, s48, 9485312
    s_mov_b64 exec, 7
    v_lshlrev_b32 v5, 2, v1
    buffer_atomic_add v4, v5, s[12:15], s48 offen
L_posted:
    s_nop 1
    s_mov_b64 exec, -1
L_role:
    s_nop 1
    s_cmp_eq_u32 s6, 0
    s_cbranch_scc1 L_h0
    s_cmp_eq_u32 s6, 2
    s_cbranch_scc1 L_h2
    v_lshlrev_b32 v5, 2, v1
    s_mov_b32 s60, 0x100000
L_wea:
    s_nop 1
    ds_read_b32 v10, v2 offset:56
    s_sub_u32 s60, s60, 1
    s_cbranch_scc1 L_exit1
    s_waitcnt lgkmcnt(0)
    v_readfirstlane_b32 s48, v10
    s_cmp_lt_u32 s48, 4
    s_cbranch_scc1 L_wea
    s_mov_b64 exec, 0x1
    s_mov_b32 s60, 0x40000
L_polla:
    s_nop 1
    buffer_load_dword v4, v5, s[16:19], 0 offen offset:0 sc1
    s_sub_u32 s60, s60, 1
    s_cbranch_scc1 L_exit1
L_pollwa:
    s_waitcnt vmcnt(0)
    v_lshrrev_b32 v6, 24, v4
    v_cmp_ne_u32 vcc, 48, v6
    s_cbranch_vccnz L_polla
    v_and_b32 v4, 0xffffff, v4
    v_subrev_u32 v4, 3145728, v4
    v_lshrrev_b32 v6, 30, v4
    v_and_b32 v6, 2, v6
    v_add_u32 v4, 4800, v4
    v_cmp_gt_u32 vcc, 9600, v4
    s_nop 1
    v_cndmask_b32 v6, v6, 8, vcc
    v_or_b32 v6, 16, v6
    ds_write_b32 v5, v6 offset:0
    s_mov_b64 exec, -1
    v_readfirstlane_b32 s44, v6
    s_mov_b32 s60, 0x100000
L_web:
    s_nop 1
    ds_read_b32 v10, v2 offset:60
    s_sub_u32 s60, s60, 1
    s_cbranch_scc1 L_exit1
    s_waitcnt lgkmcnt(0)
    v_readfirstlane_b32 s48, v10
    s_cmp_eq_u32 s48, 0
    s_cbranch_scc1 L_web
    v_mul_u32_u24 v7, 4352, v1
    s_mov_b32 s48, 9502720
    s_mov_b64 exec, 0xfffff
    s_mov_b32 s60, 0x40000
L_pollb:
    s_nop 1
    buffer_load_dwordx3 v[16:18], v7, s[12:15], s48 offen sc1
    s_sub_u32 s60, s60, 1
    s_cbranch_scc1 L_exit1
    s_waitcnt vmcnt(0)
    v_min3_u32 v6, v16, v17, v18
    v_lshrrev_b32 v6, 24, v6
    v_cmp_ne_u32 vcc, 10, v6
    s_cbranch_vccnz L_pollb
    v_subrev_u32 v16, 0xa0a0000, v16
    v_subrev_u32 v17, 0xa0a0000, v17
    v_subrev_u32 v18, 0xa0a0000, v18
    v_add_u32_dpp v16, v16, v16 quad_perm:[1,0,3,2] row_mask:0xf bank_mask:0xf
    v_add_u32_dpp v17, v17, v17 quad_perm:[1,0,3,2] row_mask:0xf bank_mask:0xf
    s_nop 0
    v_add_u32_dpp v16, v16, v16 quad_perm:[2,3,0,1] row_mask:0xf bank_mask:0xf
    v_add_u32_dpp v17, v17, v17 quad_perm:[2,3,0,1] row_mask:0xf bank_mask:0xf
    v_ashrrev_i32 v6, 31, v16
    v_xor_b32 v17, v17, v6
    v_xor_b32 v4, v18, v6
    s_mov_b64 vcc, 0x55555
    v_cndmask_b32 v18, v18, v4, vcc
    s_nop 1
    v_add_u32_dpp v18, v18, v18 quad_perm:[1,0,3,2] row_mask:0xf bank_mask:0xf
    s_nop 1
    v_add_u32_dpp v18, v18, v18 quad_perm:[2,3,0,1] row_mask:0xf bank_mask:0xf
    v_and_b32 v20, 2, v6
    v_or_b32 v4, 1, v20
    v_cmp_gt_i32 vcc, -2800, v17
    s_nop 1
    v_cndmask_b32 v20, v20, v4, vcc
    v_or_b32 v4, 4, v20
    v_cmp_gt_i32 vcc, -2800, v18
    s_nop 1
    v_cndmask_b32 v20, v20, v4, vcc
    v_add_u32 v4, 56000, v16
    v_cmp_gt_u32 vcc, 112000, v4
    s_nop 1
    v_cndmask_b32 v20, v20, 8, vcc
    v_and_b32 v20, 15, v20
    s_nop 0
    v_readlane_b32 s24, v20, 0
    v_readlane_b32 s25, v20, 4
    v_readlane_b32 s26, v20, 8
    v_readlane_b32 s27, v20, 12
    v_readlane_b32 s28, v20, 16
    s_xor_b32 s48, s44, s26
    s_and_b32 s48, s48, 15
    s_and_b32 s49, s48, 14
    s_cselect_b32 s48, 0, s48
    s_xor_b32 s49, s24, s48
    s_bitcmp1_b32 s24, 3
    s_cselect_b32 s24, s24, s49
    s_xor_b32 s49, s25, s48
    s_bitcmp1_b32 s25, 3
    s_cselect_b32 s25, s25, s49
    s_xor_b32 s49, s26, s48
    s_bitcmp1_b32 s26, 3
    s_cselect_b32 s26, s26, s49
    s_xor_b32 s49, s27, s48
    s_bitcmp1_b32 s27, 3
    s_cselect_b32 s27, s27, s49
    s_xor_b32 s49, s28, s48
    s_bitcmp1_b32 s28, 3
    s_cselect_b32 s28, s28, s49
    s_xor_b32 s48, s24, s27
    s_and_b32 s48, s48, 10
    s_cselect_b32 s24, s24, s27
    s_xor_b32 s48, s25, s28
    s_and_b32 s48, s48, 10
    s_cselect_b32 s25, s25, s28
    s_or_b32 s24, s24, 16
    v_writelane_b32 v6, s24, 0
    s_or_b32 s25, s25, 16
    v_writelane_b32 v6, s25, 1
    s_or_b32 s26, s26, 16
    v_writelane_b32 v6, s26, 2
    s_or_b32 s27, s27, 16
    v_writelane_b32 v6, s27, 3
    s_or_b32 s28, s28, 16
    v_writelane_b32 v6, s28, 4
    s_mov_b64 exec, 0x1f
    ds_write_b32 v5, v6 offset:4
    s_mov_b64 exec, -1
    s_and_b32 s48, s3, 7
    s_cmp_lg_u32 s48, s4
    s_cbranch_scc1 L_exit1
    s_mul_i32 s48, s3, 3
    s_add_u32 s48, s48, 2
    s_lshr_b32 s48, s48, 5
    s_lshl_b32 s48, s48, 2
    v_mov_b32 v3, s48
    s_mul_i32 s57, s3, 24
    v_add_u32 v13, s57, v1
    v_and_b32 v12, 255, v13
    v_mul_u32_u24 v12, 4352, v12
    v_lshlrev_b32 v13, 6, v13
    s_mov_b32 s49, 8388608
    s_mov_b32 s50, 917504
    v_mov_b32 v4, 0xf149f2ca
    v_mov_b32 v5, 0
    s_mov_b32 s51, 93
    s_cmp_eq_u32 s48, 4
    s_cselect_b32 s51, 117, s51
    s_cmp_eq_u32 s48, 8
    s_cselect_b32 s51, 81, s51
    s_mov_b32 s60, 0x100000
L_wcg:
    s_nop 1
    ds_read_b32 v10, v2 offset:128
    s_sub_u32 s60, s60, 1
    s_cbranch_scc1 L_exit1
    s_waitcnt lgkmcnt(0)
    v_readfirstlane_b32 s48, v10
    s_cmp_lt_u32 s48, s51
    s_cbranch_scc1 L_wcg
    s_mov_b64 exec, 0xffffff
    s_mov_b32 s60, 0x40000
L_cpf:
    s_nop 1
    buffer_load_dword v7, v12, s[12:15], s49 offen sc1
    s_sub_u32 s60, s60, 1
    s_cbranch_scc1 L_exit1
    s_waitcnt vmcnt(0)
    v_cmpx_eq_u32 vcc, 0, v7
    s_cbranch_execnz L_cpf
    s_mov_b64 exec, 0xffffff
    s_mov_b32 s60, 0x40000
L_cpm:
    s_nop 1
    buffer_load_dwordx4 v[4:7], v13, s[12:15], s50 offen sc1
    s_sub_u32 s60, s60, 1
    s_cbranch_scc1 L_exit1
    s_waitcnt vmcnt(0)
    v_cmpx_eq_u32 vcc, 0, v7
    s_cbranch_execnz L_cpm
    s_mov_b64 exec, -1
    v_mov_b32 v6, v4
    s_nop 1
    v_max_f32_dpp v6, v6, v6 row_ror:8 row_mask:0xf bank_mask:0xf
    s_nop 1
    v_max_f32_dpp v6, v6, v6 row_ror:4 row_mask:0xf bank_mask:0xf
    s_nop 1
    v_max_f32_dpp v6, v6, v6 row_ror:2 row_mask:0xf bank_mask:0xf
    s_nop 1
    v_max_f32_dpp v6, v6, v6 row_ror:1 row_mask:0xf bank_mask:0xf
    v_mov_b32 v7, v6
    s_nop 1
    v_permlane32_swap_b32 v6, v7
    v_max_f32 v6, v6, v7
    v_mov_b32 v7, v6
    s_nop 1
    v_permlane16_swap_b32 v6, v7
    v_max_f32 v6, v6, v7
    v_sub_f32 v4, v4, v6
    v_exp_f32 v4, v4
    s_nop 0
    v_mul_f32 v5, v5, v4
    s_nop 1
    v_add_f32_dpp v5, v5, v5 row_ror:8 row_mask:0xf bank_mask:0xf
    s_nop 1
    v_add_f32_dpp v5, v5, v5 row_ror:4 row_mask:0xf bank_mask:0xf
    s_nop 1
    v_add_f32_dpp v5, v5, v5 row_ror:2 row_mask:0xf bank_mask:0xf
    s_nop 1
    v_add_f32_dpp v5, v5, v5 row_ror:1 row_mask:0xf bank_mask:0xf
    v_mov_b32 v7, v5
    s_nop 1
    v_permlane32_swap_b32 v5, v7
    v_add_f32 v5, v5, v7
    v_mov_b32 v7, v5
    s_nop 1
    v_permlane16_swap_b32 v5, v7
    v_add_f32 v5, v5, v7
    v_rcp_f32 v5, v5
    s_nop 0
    v_mul_f32 v4, v4, v5
    s_cmp_lt_u32 s3, 21
    s_cbranch_scc1 L_cown
    s_mul_i32 s48, s3, 4352
    s_add_u32 s48, s48, 9498368
    v_lshlrev_b32 v12, 2, v1
    v_mov_b32 v5, 1
    s_mov_b64 exec, 0xffffff
    buffer_store_dword v4, v12, s[12:15], s48 offen offset:128 sc1
    s_mov_b64 exec, 1
    s_waitcnt vmcnt(0)
    buffer_store_dword v5, off, s[12:15], s48 offset:4 sc1
    s_endpgm
L_cown:
    s_nop 1
    v_readlane_b32 s24, v4, 0
    v_readlane_b32 s25, v4, 1
    v_readlane_b32 s26, v4, 2
    v_readlane_b32 s27, v4, 3
    v_readlane_b32 s28, v4, 4
    v_readlane_b32 s29, v4, 5
    v_readlane_b32 s30, v4, 6
    v_readlane_b32 s31, v4, 7
    v_readlane_b32 s32, v4, 8
    v_readlane_b32 s33, v4, 9
    v_readlane_b32 s34, v4, 10
    v_readlane_b32 s35, v4, 11
    v_readlane_b32 s36, v4, 12
    v_readlane_b32 s37, v4, 13
    v_readlane_b32 s38, v4, 14
    v_readlane_b32 s39, v4, 15
    v_readlane_b32 s40, v4, 16
    v_readlane_b32 s41, v4, 17
    v_readlane_b32 s42, v4, 18
    v_readlane_b32 s43, v4, 19
    v_readlane_b32 s44, v4, 20
    v_readlane_b32 s45, v4, 21
    v_readlane_b32 s46, v4, 22
    v_readlane_b32 s47, v4, 23
    s_mov_b32 s92, s78
    s_and_b32 s93, s79, 0xffff
    s_mov_b32 s94, 12288
    s_mov_b32 s95, 0x00020000
    s_lshl_b32 s57, s57, 10
    v_lshlrev_b32 v13, 4, v1
    v_add_u32 v13, s57, v13
    s_mov_b32 s49, 4096
    s_mov_b32 s50, 8192
    s_mov_b32 s51, 12288
    s_mov_b32 s52, 16384
    s_mov_b32 s53, 20480
    v_mov_b32 v4, 0
    v_mov_b32 v5, 0
    v_mov_b32 v6, 0
    s_mov_b32 s56, 0xffffff
    v_lshlrev_b32 v12, 1, v1
    s_mul_i32 s57, s3, 384
    s_mov_b32 s60, 0x100000
L_wcc:
    s_nop 1
    ds_read_b32 v10, v3 offset:64
    s_sub_u32 s60, s60, 1
    s_cbranch_scc1 L_exit1
    s_waitcnt lgkmcnt(0)
    v_readfirstlane_b32 s48, v10
    s_cmp_lt_u32 s48, 1
    s_cbranch_scc1 L_wcc
    s_mov_b32 s60, 0x40000
L_cr:
    s_nop 1
    s_bitcmp0_b32 s56, 0
    s_cbranch_scc1 L_cl0
    buffer_load_dwordx4 v[16:19], v13, s[12:15], 0 offen offset:0 sc1
L_cl0:
    s_bitcmp0_b32 s56, 1
    s_cbranch_scc1 L_cl1
    buffer_load_dwordx4 v[20:23], v13, s[12:15], 0 offen offset:1024 sc1
L_cl1:
    s_bitcmp0_b32 s56, 2
    s_cbranch_scc1 L_cl2
    buffer_load_dwordx4 v[24:27], v13, s[12:15], 0 offen offset:2048 sc1
L_cl2:
    s_bitcmp0_b32 s56, 3
    s_cbranch_scc1 L_cl3
    buffer_load_dwordx4 v[28:31], v13, s[12:15], 0 offen offset:3072 sc1
L_cl3:
    s_bitcmp0_b32 s56, 4
    s_cbranch_scc1 L_cl4
    buffer_load_dwordx4 v[32:35], v13, s[12:15], s49 offen offset:0 sc1
L_cl4:
    s_bitcmp0_b32 s56, 5
    s_cbranch_scc1 L_cl5
    buffer_load_dwordx4 v[36:39], v13, s[12:15], s49 offen offset:1024 sc1
L_cl5:
    s_bitcmp0_b32 s56, 6
    s_cbranch_scc1 L_cl6
    buffer_load_dwordx4 v[40:43], v13, s[12:15], s49 offen offset:2048 sc1
L_cl6:
    s_bitcmp0_b32 s56, 7
    s_cbranch_scc1 L_cl7
    buffer_load_dwordx4 v[44:47], v13, s[12:15], s49 offen offset:3072 sc1
L_cl7:
    s_bitcmp0_b32 s56, 8
    s_cbranch_scc1 L_cl8
    buffer_load_dwordx4 v[48:51], v13, s[12:15], s50 offen offset:0 sc1
L_cl8:
    s_bitcmp0_b32 s56, 9
    s_cbranch_scc1 L_cl9
    buffer_load_dwordx4 v[52:55], v13, s[12:15], s50 offen offset:1024 sc1
L_cl9:
    s_bitcmp0_b32 s56, 10
    s_cbranch_scc1 L_cl10
    buffer_load_dwordx4 v[56:59], v13, s[12:15], s50 offen offset:2048 sc1
L_cl10:
    s_bitcmp0_b32 s56, 11
    s_cbranch_scc1 L_cl11
    buffer_load_dwordx4 v[60:63], v13, s[12:15], s50 offen offset:3072 sc1
L_cl11:
    s_bitcmp0_b32 s56, 12
    s_cbranch_scc1 L_cl12
    buffer_load_dwordx4 v[64:67], v13, s[12:15], s51 offen offset:0 sc1
L_cl12:
    s_bitcmp0_b32 s56, 13
    s_cbranch_scc1 L_cl13
    buffer_load_dwordx4 v[68:71], v13, s[12:15], s51 offen offset:1024 sc1
L_cl13:
    s_bitcmp0_b32 s56, 14
    s_cbranch_scc1 L_cl14
    buffer_load_dwordx4 v[72:75], v13, s[12:15], s51 offen offset:2048 sc1
L_cl14:
    s_bitcmp0_b32 s56, 15
    s_cbranch_scc1 L_cl15
    buffer_load_dwordx4 v[76:79], v13, s[12:15], s51 offen offset:3072 sc1
L_cl15:
    s_bitcmp0_b32 s56, 16
    s_cbranch_scc1 L_cl16
    buffer_load_dwordx4 v[80:83], v13, s[12:15], s52 offen offset:0 sc1
L_cl16:
    s_bitcmp0_b32 s56, 17
    s_cbranch_scc1 L_cl17
    buffer_load_dwordx4 v[84:87], v13, s[12:15], s52 offen offset:1024 sc1
L_cl17:
    s_bitcmp0_b32 s56, 18
    s_cbranch_scc1 L_cl18
    buffer_load_dwordx4 v[88:91], v13, s[12:15], s52 offen offset:2048 sc1
L_cl18:
    s_bitcmp0_b32 s56, 19
    s_cbranch_scc1 L_cl19
    buffer_load_dwordx4 v[92:95], v13, s[12:15], s52 offen offset:3072 sc1
L_cl19:
    s_bitcmp0_b32 s56, 20
    s_cbranch_scc1 L_cl20
    buffer_load_dwordx4 v[96:99], v13, s[12:15], s53 offen offset:0 sc1
L_cl20:
    s_bitcmp0_b32 s56, 21
    s_cbranch_scc1 L_cl21
    buffer_load_dwordx4 v[100:103], v13, s[12:15], s53 offen offset:1024 sc1
L_cl21:
    s_bitcmp0_b32 s56, 22
    s_cbranch_scc1 L_cl22
    buffer_load_dwordx4 v[104:107], v13, s[12:15], s53 offen offset:2048 sc1
L_cl22:
    s_bitcmp0_b32 s56, 23
    s_cbranch_scc1 L_cl23
    buffer_load_dwordx4 v[108:111], v13, s[12:15], s53 offen offset:3072 sc1
L_cl23:
    s_sub_u32 s60, s60, 1
    s_cbranch_scc1 L_exit1
    s_waitcnt vmcnt(0)
    s_bitcmp0_b32 s56, 0
    s_cbranch_scc1 L_cv0
    v_cmp_eq_u32 vcc, 0, v19
    s_cbranch_vccnz L_cv0
    v_fmac_f32 v4, s24, v16
    v_fmac_f32 v5, s24, v17
    v_fmac_f32 v6, s24, v18
    s_bitset0_b32 s56, 0
L_cv0:
    s_bitcmp0_b32 s56, 1
    s_cbranch_scc1 L_cv1
    v_cmp_eq_u32 vcc, 0, v23
    s_cbranch_vccnz L_cv1
    v_fmac_f32 v4, s25, v20
    v_fmac_f32 v5, s25, v21
    v_fmac_f32 v6, s25, v22
    s_bitset0_b32 s56, 1
L_cv1:
    s_bitcmp0_b32 s56, 2
    s_cbranch_scc1 L_cv2
    v_cmp_eq_u32 vcc, 0, v27
    s_cbranch_vccnz L_cv2
    v_fmac_f32 v4, s26, v24
    v_fmac_f32 v5, s26, v25
    v_fmac_f32 v6, s26, v26
    s_bitset0_b32 s56, 2
L_cv2:
    s_bitcmp0_b32 s56, 3
    s_cbranch_scc1 L_cv3
    v_cmp_eq_u32 vcc, 0, v31
    s_cbranch_vccnz L_cv3
    v_fmac_f32 v4, s27, v28
    v_fmac_f32 v5, s27, v29
    v_fmac_f32 v6, s27, v30
    s_bitset0_b32 s56, 3
L_cv3:
    s_bitcmp0_b32 s56, 4
    s_cbranch_scc1 L_cv4
    v_cmp_eq_u32 vcc, 0, v35
    s_cbranch_vccnz L_cv4
    v_fmac_f32 v4, s28, v32
    v_fmac_f32 v5, s28, v33
    v_fmac_f32 v6, s28, v34
    s_bitset0_b32 s56, 4
L_cv4:
    s_bitcmp0_b32 s56, 5
    s_cbranch_scc1 L_cv5
    v_cmp_eq_u32 vcc, 0, v39
    s_cbranch_vccnz L_cv5
    v_fmac_f32 v4, s29, v36
    v_fmac_f32 v5, s29, v37
    v_fmac_f32 v6, s29, v38
    s_bitset0_b32 s56, 5
L_cv5:
    s_bitcmp0_b32 s56, 6
    s_cbranch_scc1 L_cv6
    v_cmp_eq_u32 vcc, 0, v43
    s_cbranch_vccnz L_cv6
    v_fmac_f32 v4, s30, v40
    v_fmac_f32 v5, s30, v41
    v_fmac_f32 v6, s30, v42
    s_bitset0_b32 s56, 6
L_cv6:
    s_bitcmp0_b32 s56, 7
    s_cbranch_scc1 L_cv7
    v_cmp_eq_u32 vcc, 0, v47
    s_cbranch_vccnz L_cv7
    v_fmac_f32 v4, s31, v44
    v_fmac_f32 v5, s31, v45
    v_fmac_f32 v6, s31, v46
    s_bitset0_b32 s56, 7
L_cv7:
    s_bitcmp0_b32 s56, 8
    s_cbranch_scc1 L_cv8
    v_cmp_eq_u32 vcc, 0, v51
    s_cbranch_vccnz L_cv8
    v_fmac_f32 v4, s32, v48
    v_fmac_f32 v5, s32, v49
    v_fmac_f32 v6, s32, v50
    s_bitset0_b32 s56, 8
L_cv8:
    s_bitcmp0_b32 s56, 9
    s_cbranch_scc1 L_cv9
    v_cmp_eq_u32 vcc, 0, v55
    s_cbranch_vccnz L_cv9
    v_fmac_f32 v4, s33, v52
    v_fmac_f32 v5, s33, v53
    v_fmac_f32 v6, s33, v54
    s_bitset0_b32 s56, 9
L_cv9:
    s_bitcmp0_b32 s56, 10
    s_cbranch_scc1 L_cv10
    v_cmp_eq_u32 vcc, 0, v59
    s_cbranch_vccnz L_cv10
    v_fmac_f32 v4, s34, v56
    v_fmac_f32 v5, s34, v57
    v_fmac_f32 v6, s34, v58
    s_bitset0_b32 s56, 10
L_cv10:
    s_bitcmp0_b32 s56, 11
    s_cbranch_scc1 L_cv11
    v_cmp_eq_u32 vcc, 0, v63
    s_cbranch_vccnz L_cv11
    v_fmac_f32 v4, s35, v60
    v_fmac_f32 v5, s35, v61
    v_fmac_f32 v6, s35, v62
    s_bitset0_b32 s56, 11
L_cv11:
    s_bitcmp0_b32 s56, 12
    s_cbranch_scc1 L_cv12
    v_cmp_eq_u32 vcc, 0, v67
    s_cbranch_vccnz L_cv12
    v_fmac_f32 v4, s36, v64
    v_fmac_f32 v5, s36, v65
    v_fmac_f32 v6, s36, v66
    s_bitset0_b32 s56, 12
L_cv12:
    s_bitcmp0_b32 s56, 13
    s_cbranch_scc1 L_cv13
    v_cmp_eq_u32 vcc, 0, v71
    s_cbranch_vccnz L_cv13
    v_fmac_f32 v4, s37, v68
    v_fmac_f32 v5, s37, v69
    v_fmac_f32 v6, s37, v70
    s_bitset0_b32 s56, 13
L_cv13:
    s_bitcmp0_b32 s56, 14
    s_cbranch_scc1 L_cv14
    v_cmp_eq_u32 vcc, 0, v75
    s_cbranch_vccnz L_cv14
    v_fmac_f32 v4, s38, v72
    v_fmac_f32 v5, s38, v73
    v_fmac_f32 v6, s38, v74
    s_bitset0_b32 s56, 14
L_cv14:
    s_bitcmp0_b32 s56, 15
    s_cbranch_scc1 L_cv15
    v_cmp_eq_u32 vcc, 0, v79
    s_cbranch_vccnz L_cv15
    v_fmac_f32 v4, s39, v76
    v_fmac_f32 v5, s39, v77
    v_fmac_f32 v6, s39, v78
    s_bitset0_b32 s56, 15
L_cv15:
    s_bitcmp0_b32 s56, 16
    s_cbranch_scc1 L_cv16
    v_cmp_eq_u32 vcc, 0, v83
    s_cbranch_vccnz L_cv16
    v_fmac_f32 v4, s40, v80
    v_fmac_f32 v5, s40, v81
    v_fmac_f32 v6, s40, v82
    s_bitset0_b32 s56, 16
L_cv16:
    s_bitcmp0_b32 s56, 17
    s_cbranch_scc1 L_cv17
    v_cmp_eq_u32 vcc, 0, v87
    s_cbranch_vccnz L_cv17
    v_fmac_f32 v4, s41, v84
    v_fmac_f32 v5, s41, v85
    v_fmac_f32 v6, s41, v86
    s_bitset0_b32 s56, 17
L_cv17:
    s_bitcmp0_b32 s56, 18
    s_cbranch_scc1 L_cv18
    v_cmp_eq_u32 vcc, 0, v91
    s_cbranch_vccnz L_cv18
    v_fmac_f32 v4, s42, v88
    v_fmac_f32 v5, s42, v89
    v_fmac_f32 v6, s42, v90
    s_bitset0_b32 s56, 18
L_cv18:
    s_bitcmp0_b32 s56, 19
    s_cbranch_scc1 L_cv19
    v_cmp_eq_u32 vcc, 0, v95
    s_cbranch_vccnz L_cv19
    v_fmac_f32 v4, s43, v92
    v_fmac_f32 v5, s43, v93
    v_fmac_f32 v6, s43, v94
    s_bitset0_b32 s56, 19
L_cv19:
    s_bitcmp0_b32 s56, 20
    s_cbranch_scc1 L_cv20
    v_cmp_eq_u32 vcc, 0, v99
    s_cbranch_vccnz L_cv20
    v_fmac_f32 v4, s44, v96
    v_fmac_f32 v5, s44, v97
    v_fmac_f32 v6, s44, v98
    s_bitset0_b32 s56, 20
L_cv20:
    s_bitcmp0_b32 s56, 21
    s_cbranch_scc1 L_cv21
    v_cmp_eq_u32 vcc, 0, v103
    s_cbranch_vccnz L_cv21
    v_fmac_f32 v4, s45, v100
    v_fmac_f32 v5, s45, v101
    v_fmac_f32 v6, s45, v102
    s_bitset0_b32 s56, 21
L_cv21:
    s_bitcmp0_b32 s56, 22
    s_cbranch_scc1 L_cv22
    v_cmp_eq_u32 vcc, 0, v107
    s_cbranch_vccnz L_cv22
    v_fmac_f32 v4, s46, v104
    v_fmac_f32 v5, s46, v105
    v_fmac_f32 v6, s46, v106
    s_bitset0_b32 s56, 22
L_cv22:
    s_bitcmp0_b32 s56, 23
    s_cbranch_scc1 L_cv23
    v_cmp_eq_u32 vcc, 0, v111
    s_cbranch_vccnz L_cv23
    v_fmac_f32 v4, s47, v108
    v_fmac_f32 v5, s47, v109
    v_fmac_f32 v6, s47, v110
    s_bitset0_b32 s56, 23
L_cv23:
    s_cmp_lg_u32 s56, 0
    s_cbranch_scc1 L_cr
    v_cvt_pk_bf16_f32 v4, v4, v4
    buffer_store_short v4, v12, s[92:95], s57 offen offset:0
    v_cvt_pk_bf16_f32 v5, v5, v5
    buffer_store_short v5, v12, s[92:95], s57 offen offset:128
    v_cvt_pk_bf16_f32 v6, v6, v6
    buffer_store_short v6, v12, s[92:95], s57 offen offset:256
    s_endpgm
L_h0:
    s_nop 1
    s_mov_b32 s8, s64
    s_and_b32 s9, s65, 0xffff
    s_mov_b32 s10, 12288
    s_mov_b32 s11, 0x00020000
    s_mov_b32 s92, s70
    s_and_b32 s93, s71, 0xffff
    s_mov_b32 s94, 6291456
    s_mov_b32 s95, 0x00020000
    s_mov_b32 s96, s72
    s_and_b32 s97, s73, 0xffff
    s_mov_b32 s98, 6291456
    s_mov_b32 s99, 0x00020000
    v_lshrrev_b32 v4, 4, v1
    v_and_b32 v5, 15, v1
    v_lshlrev_b32 v6, 3, v5
    v_mul_u32_u24 v7, 384, v4
    v_add_u32 v7, v7, v6
    v_lshl_add_u32 v13, v5, 2, v4
    v_lshlrev_b32 v13, 2, v13
    v_lshlrev_b32 v4, 4, v1
    s_mul_i32 s32, s5, 4352
    s_add_u32 s32, s32, s59
    s_lshl_b32 s33, s3, 3
    s_add_u32 s33, s33, s5
    v_and_b32 v14, 7, v1
    v_lshrrev_b32 v10, 3, v1
    v_mul_u32_u24 v8, 24, v10
    v_mov_b32 v11, 768
    v_mad_u32_u24 v8, v14, v11, v8
    v_lshlrev_b32 v14, 7, v14
    v_lshl_add_u32 v14, v10, 4, v14
    s_mul_i32 s33, s33, 4096
    s_add_u32 s33, s33, 2097152
    v_mov_b32 v16, 0
    v_mov_b32 v17, 0
    v_mov_b32 v18, 0
    v_mov_b32 v19, 0
    s_add_u32 s48, s2, 0
    s_lshl_b32 s49, s48, 10
    s_lshl_b32 s48, s48, 6
    s_add_u32 s48, s48, 917504
    buffer_store_dwordx4 v[16:19], v4, s[12:15], s49 offen sc1
    s_mov_b64 exec, 15
    buffer_store_dwordx4 v[16:19], v4, s[12:15], s48 offen sc1
    s_mov_b64 exec, -1
    s_add_u32 s48, s2, 256
    s_lshl_b32 s49, s48, 10
    s_lshl_b32 s48, s48, 6
    s_add_u32 s48, s48, 917504
    buffer_store_dwordx4 v[16:19], v4, s[12:15], s49 offen sc1
    s_mov_b64 exec, 15
    buffer_store_dwordx4 v[16:19], v4, s[12:15], s48 offen sc1
    s_mov_b64 exec, -1
    s_add_u32 s48, s2, 512
    s_lshl_b32 s49, s48, 10
    s_lshl_b32 s48, s48, 6
    s_add_u32 s48, s48, 917504
    buffer_store_dwordx4 v[16:19], v4, s[12:15], s49 offen sc1
    s_mov_b64 exec, 15
    buffer_store_dwordx4 v[16:19], v4, s[12:15], s48 offen sc1
    s_mov_b64 exec, -1
    s_mov_b32 s61, 0
    s_lshl_b32 s62, s61, 5
    s_add_u32 s62, s62, s3
    s_lshl_b32 s63, s62, 15
    s_add_u32 s63, s63, 1
    s_mul_hi_u32 s63, s63, 0xaaaaaaab
    s_lshr_b32 s63, s63, 7
    s_mul_i32 s48, s62, 171
    s_lshr_b32 s48, s48, 9
    s_mul_i32 s48, s48, 384
    s_mul_i32 s49, s4, 24
    s_add_u32 s50, s49, s63
    s_mul_i32 s50, s50, 384
    v_add_u32 v10, s50, v7
    v_add_u32 v11, 3072, v10
    v_add_u32 v12, 6144, v10
    buffer_load_dwordx2 v[100:101], v6, s[8:11], s48 offen offset:0
    buffer_load_dwordx2 v[102:103], v6, s[8:11], s48 offen offset:128
    buffer_load_dwordx2 v[104:105], v6, s[8:11], s48 offen offset:256
    buffer_load_dwordx2 v[28:29], v10, s[92:95], 0 offen offset:0
    buffer_load_dwordx2 v[30:31], v10, s[92:95], 0 offen offset:128
    buffer_load_dwordx2 v[32:33], v10, s[92:95], 0 offen offset:256
    buffer_load_dwordx2 v[64:65], v10, s[96:99], 0 offen offset:0
    buffer_load_dwordx2 v[66:67], v10, s[96:99], 0 offen offset:128
    buffer_load_dwordx2 v[68:69], v10, s[96:99], 0 offen offset:256
    buffer_load_dwordx2 v[34:35], v10, s[92:95], 0 offen offset:1536
    buffer_load_dwordx2 v[36:37], v10, s[92:95], 0 offen offset:1664
    buffer_load_dwordx2 v[38:39], v10, s[92:95], 0 offen offset:1792
    buffer_load_dwordx2 v[70:71], v10, s[96:99], 0 offen offset:1536
    buffer_load_dwordx2 v[72:73], v10, s[96:99], 0 offen offset:1664
    buffer_load_dwordx2 v[74:75], v10, s[96:99], 0 offen offset:1792
    buffer_load_dwordx2 v[40:41], v11, s[92:95], 0 offen offset:0
    buffer_load_dwordx2 v[42:43], v11, s[92:95], 0 offen offset:128
    buffer_load_dwordx2 v[44:45], v11, s[92:95], 0 offen offset:256
    buffer_load_dwordx2 v[76:77], v11, s[96:99], 0 offen offset:0
    buffer_load_dwordx2 v[78:79], v11, s[96:99], 0 offen offset:128
    buffer_load_dwordx2 v[80:81], v11, s[96:99], 0 offen offset:256
    buffer_load_dwordx2 v[46:47], v11, s[92:95], 0 offen offset:1536
    buffer_load_dwordx2 v[48:49], v11, s[92:95], 0 offen offset:1664
    buffer_load_dwordx2 v[50:51], v11, s[92:95], 0 offen offset:1792
    buffer_load_dwordx2 v[82:83], v11, s[96:99], 0 offen offset:1536
    buffer_load_dwordx2 v[84:85], v11, s[96:99], 0 offen offset:1664
    buffer_load_dwordx2 v[86:87], v11, s[96:99], 0 offen offset:1792
    buffer_load_dwordx2 v[52:53], v12, s[92:95], 0 offen offset:0
    buffer_load_dwordx2 v[54:55], v12, s[92:95], 0 offen offset:128
    buffer_load_dwordx2 v[56:57], v12, s[92:95], 0 offen offset:256
    buffer_load_dwordx2 v[88:89], v12, s[96:99], 0 offen offset:0
    buffer_load_dwordx2 v[90:91], v12, s[96:99], 0 offen offset:128
    buffer_load_dwordx2 v[92:93], v12, s[96:99], 0 offen offset:256
    buffer_load_dwordx2 v[58:59], v12, s[92:95], 0 offen offset:1536
    buffer_load_dwordx2 v[60:61], v12, s[92:95], 0 offen offset:1664
    buffer_load_dwordx2 v[62:63], v12, s[92:95], 0 offen offset:1792
    buffer_load_dwordx2 v[94:95], v12, s[96:99], 0 offen offset:1536
    buffer_load_dwordx2 v[96:97], v12, s[96:99], 0 offen offset:1664
    buffer_load_dwordx2 v[98:99], v12, s[96:99], 0 offen offset:1792
    s_waitcnt vmcnt(0)
    v_lshlrev_b32 v16, 16, v100
    v_and_b32 v17, 0xffff0000, v100
    v_lshlrev_b32 v18, 16, v101
    v_and_b32 v19, 0xffff0000, v101
    v_lshlrev_b32 v20, 16, v102
    v_and_b32 v21, 0xffff0000, v102
    v_lshlrev_b32 v22, 16, v103
    v_and_b32 v23, 0xffff0000, v103
    v_lshlrev_b32 v24, 16, v104
    v_and_b32 v25, 0xffff0000, v104
    v_lshlrev_b32 v26, 16, v105
    v_and_b32 v27, 0xffff0000, v105
    v_lshlrev_b32 v10, 16, v28
    v_lshlrev_b32 v11, 16, v64
    v_and_b32 v28, 0xffff0000, v28
    v_and_b32 v64, 0xffff0000, v64
    v_mul_f32 v10, v10, v16
    v_mul_f32 v28, v28, v17
    v_mul_f32 v100, v10, v11
    v_fmac_f32 v100, v28, v64
    v_lshlrev_b32 v10, 16, v29
    v_lshlrev_b32 v11, 16, v65
    v_and_b32 v29, 0xffff0000, v29
    v_and_b32 v65, 0xffff0000, v65
    v_mul_f32 v10, v10, v18
    v_mul_f32 v29, v29, v19
    v_fmac_f32 v100, v10, v11
    v_fmac_f32 v100, v29, v65
    v_lshlrev_b32 v10, 16, v30
    v_lshlrev_b32 v11, 16, v66
    v_and_b32 v30, 0xffff0000, v30
    v_and_b32 v66, 0xffff0000, v66
    v_mul_f32 v10, v10, v20
    v_mul_f32 v30, v30, v21
    v_fmac_f32 v100, v10, v11
    v_fmac_f32 v100, v30, v66
    v_lshlrev_b32 v10, 16, v31
    v_lshlrev_b32 v11, 16, v67
    v_and_b32 v31, 0xffff0000, v31
    v_and_b32 v67, 0xffff0000, v67
    v_mul_f32 v10, v10, v22
    v_mul_f32 v31, v31, v23
    v_fmac_f32 v100, v10, v11
    v_fmac_f32 v100, v31, v67
    v_lshlrev_b32 v10, 16, v32
    v_lshlrev_b32 v11, 16, v68
    v_and_b32 v32, 0xffff0000, v32
    v_and_b32 v68, 0xffff0000, v68
    v_mul_f32 v10, v10, v24
    v_mul_f32 v32, v32, v25
    v_fmac_f32 v100, v10, v11
    v_fmac_f32 v100, v32, v68
    v_lshlrev_b32 v10, 16, v33
    v_lshlrev_b32 v11, 16, v69
    v_and_b32 v33, 0xffff0000, v33
    v_and_b32 v69, 0xffff0000, v69
    v_mul_f32 v10, v10, v26
    v_mul_f32 v33, v33, v27
    v_fmac_f32 v100, v10, v11
    v_fmac_f32 v100, v33, v69
    v_lshlrev_b32 v10, 16, v34
    v_lshlrev_b32 v11, 16, v70
    v_and_b32 v34, 0xffff0000, v34
    v_and_b32 v70, 0xffff0000, v70
    v_mul_f32 v10, v10, v16
    v_mul_f32 v34, v34, v17
    v_mul_f32 v101, v10, v11
    v_fmac_f32 v101, v34, v70
    v_lshlrev_b32 v10, 16, v35
    v_lshlrev_b32 v11, 16, v71
    v_and_b32 v35, 0xffff0000, v35
    v_and_b32 v71, 0xffff0000, v71
    v_mul_f32 v10, v10, v18
    v_mul_f32 v35, v35, v19
    v_fmac_f32 v101, v10, v11
    v_fmac_f32 v101, v35, v71
    v_lshlrev_b32 v10, 16, v36
    v_lshlrev_b32 v11, 16, v72
    v_and_b32 v36, 0xffff0000, v36
    v_and_b32 v72, 0xffff0000, v72
    v_mul_f32 v10, v10, v20
    v_mul_f32 v36, v36, v21
    v_fmac_f32 v101, v10, v11
    v_fmac_f32 v101, v36, v72
    v_lshlrev_b32 v10, 16, v37
    v_lshlrev_b32 v11, 16, v73
    v_and_b32 v37, 0xffff0000, v37
    v_and_b32 v73, 0xffff0000, v73
    v_mul_f32 v10, v10, v22
    v_mul_f32 v37, v37, v23
    v_fmac_f32 v101, v10, v11
    v_fmac_f32 v101, v37, v73
    v_lshlrev_b32 v10, 16, v38
    v_lshlrev_b32 v11, 16, v74
    v_and_b32 v38, 0xffff0000, v38
    v_and_b32 v74, 0xffff0000, v74
    v_mul_f32 v10, v10, v24
    v_mul_f32 v38, v38, v25
    v_fmac_f32 v101, v10, v11
    v_fmac_f32 v101, v38, v74
    v_lshlrev_b32 v10, 16, v39
    v_lshlrev_b32 v11, 16, v75
    v_and_b32 v39, 0xffff0000, v39
    v_and_b32 v75, 0xffff0000, v75
    v_mul_f32 v10, v10, v26
    v_mul_f32 v39, v39, v27
    v_fmac_f32 v101, v10, v11
    v_fmac_f32 v101, v39, v75
    v_lshlrev_b32 v10, 16, v40
    v_lshlrev_b32 v11, 16, v76
    v_and_b32 v40, 0xffff0000, v40
    v_and_b32 v76, 0xffff0000, v76
    v_mul_f32 v10, v10, v16
    v_mul_f32 v40, v40, v17
    v_mul_f32 v102, v10, v11
    v_fmac_f32 v102, v40, v76
    v_lshlrev_b32 v10, 16, v41
    v_lshlrev_b32 v11, 16, v77
    v_and_b32 v41, 0xffff0000, v41
    v_and_b32 v77, 0xffff0000, v77
    v_mul_f32 v10, v10, v18
    v_mul_f32 v41, v41, v19
    v_fmac_f32 v102, v10, v11
    v_fmac_f32 v102, v41, v77
    v_lshlrev_b32 v10, 16, v42
    v_lshlrev_b32 v11, 16, v78
    v_and_b32 v42, 0xffff0000, v42
    v_and_b32 v78, 0xffff0000, v78
    v_mul_f32 v10, v10, v20
    v_mul_f32 v42, v42, v21
    v_fmac_f32 v102, v10, v11
    v_fmac_f32 v102, v42, v78
    v_lshlrev_b32 v10, 16, v43
    v_lshlrev_b32 v11, 16, v79
    v_and_b32 v43, 0xffff0000, v43
    v_and_b32 v79, 0xffff0000, v79
    v_mul_f32 v10, v10, v22
    v_mul_f32 v43, v43, v23
    v_fmac_f32 v102, v10, v11
    v_fmac_f32 v102, v43, v79
    v_lshlrev_b32 v10, 16, v44
    v_lshlrev_b32 v11, 16, v80
    v_and_b32 v44, 0xffff0000, v44
    v_and_b32 v80, 0xffff0000, v80
    v_mul_f32 v10, v10, v24
    v_mul_f32 v44, v44, v25
    v_fmac_f32 v102, v10, v11
    v_fmac_f32 v102, v44, v80
    v_lshlrev_b32 v10, 16, v45
    v_lshlrev_b32 v11, 16, v81
    v_and_b32 v45, 0xffff0000, v45
    v_and_b32 v81, 0xffff0000, v81
    v_mul_f32 v10, v10, v26
    v_mul_f32 v45, v45, v27
    v_fmac_f32 v102, v10, v11
    v_fmac_f32 v102, v45, v81
    v_lshlrev_b32 v10, 16, v46
    v_lshlrev_b32 v11, 16, v82
    v_and_b32 v46, 0xffff0000, v46
    v_and_b32 v82, 0xffff0000, v82
    v_mul_f32 v10, v10, v16
    v_mul_f32 v46, v46, v17
    v_mul_f32 v103, v10, v11
    v_fmac_f32 v103, v46, v82
    v_lshlrev_b32 v10, 16, v47
    v_lshlrev_b32 v11, 16, v83
    v_and_b32 v47, 0xffff0000, v47
    v_and_b32 v83, 0xffff0000, v83
    v_mul_f32 v10, v10, v18
    v_mul_f32 v47, v47, v19
    v_fmac_f32 v103, v10, v11
    v_fmac_f32 v103, v47, v83
    v_lshlrev_b32 v10, 16, v48
    v_lshlrev_b32 v11, 16, v84
    v_and_b32 v48, 0xffff0000, v48
    v_and_b32 v84, 0xffff0000, v84
    v_mul_f32 v10, v10, v20
    v_mul_f32 v48, v48, v21
    v_fmac_f32 v103, v10, v11
    v_fmac_f32 v103, v48, v84
    v_lshlrev_b32 v10, 16, v49
    v_lshlrev_b32 v11, 16, v85
    v_and_b32 v49, 0xffff0000, v49
    v_and_b32 v85, 0xffff0000, v85
    v_mul_f32 v10, v10, v22
    v_mul_f32 v49, v49, v23
    v_fmac_f32 v103, v10, v11
    v_fmac_f32 v103, v49, v85
    v_lshlrev_b32 v10, 16, v50
    v_lshlrev_b32 v11, 16, v86
    v_and_b32 v50, 0xffff0000, v50
    v_and_b32 v86, 0xffff0000, v86
    v_mul_f32 v10, v10, v24
    v_mul_f32 v50, v50, v25
    v_fmac_f32 v103, v10, v11
    v_fmac_f32 v103, v50, v86
    v_lshlrev_b32 v10, 16, v51
    v_lshlrev_b32 v11, 16, v87
    v_and_b32 v51, 0xffff0000, v51
    v_and_b32 v87, 0xffff0000, v87
    v_mul_f32 v10, v10, v26
    v_mul_f32 v51, v51, v27
    v_fmac_f32 v103, v10, v11
    v_fmac_f32 v103, v51, v87
    v_lshlrev_b32 v10, 16, v52
    v_lshlrev_b32 v11, 16, v88
    v_and_b32 v52, 0xffff0000, v52
    v_and_b32 v88, 0xffff0000, v88
    v_mul_f32 v10, v10, v16
    v_mul_f32 v52, v52, v17
    v_mul_f32 v104, v10, v11
    v_fmac_f32 v104, v52, v88
    v_lshlrev_b32 v10, 16, v53
    v_lshlrev_b32 v11, 16, v89
    v_and_b32 v53, 0xffff0000, v53
    v_and_b32 v89, 0xffff0000, v89
    v_mul_f32 v10, v10, v18
    v_mul_f32 v53, v53, v19
    v_fmac_f32 v104, v10, v11
    v_fmac_f32 v104, v53, v89
    v_lshlrev_b32 v10, 16, v54
    v_lshlrev_b32 v11, 16, v90
    v_and_b32 v54, 0xffff0000, v54
    v_and_b32 v90, 0xffff0000, v90
    v_mul_f32 v10, v10, v20
    v_mul_f32 v54, v54, v21
    v_fmac_f32 v104, v10, v11
    v_fmac_f32 v104, v54, v90
    v_lshlrev_b32 v10, 16, v55
    v_lshlrev_b32 v11, 16, v91
    v_and_b32 v55, 0xffff0000, v55
    v_and_b32 v91, 0xffff0000, v91
    v_mul_f32 v10, v10, v22
    v_mul_f32 v55, v55, v23
    v_fmac_f32 v104, v10, v11
    v_fmac_f32 v104, v55, v91
    v_lshlrev_b32 v10, 16, v56
    v_lshlrev_b32 v11, 16, v92
    v_and_b32 v56, 0xffff0000, v56
    v_and_b32 v92, 0xffff0000, v92
    v_mul_f32 v10, v10, v24
    v_mul_f32 v56, v56, v25
    v_fmac_f32 v104, v10, v11
    v_fmac_f32 v104, v56, v92
    v_lshlrev_b32 v10, 16, v57
    v_lshlrev_b32 v11, 16, v93
    v_and_b32 v57, 0xffff0000, v57
    v_and_b32 v93, 0xffff0000, v93
    v_mul_f32 v10, v10, v26
    v_mul_f32 v57, v57, v27
    v_fmac_f32 v104, v10, v11
    v_fmac_f32 v104, v57, v93
    v_lshlrev_b32 v10, 16, v58
    v_lshlrev_b32 v11, 16, v94
    v_and_b32 v58, 0xffff0000, v58
    v_and_b32 v94, 0xffff0000, v94
    v_mul_f32 v10, v10, v16
    v_mul_f32 v58, v58, v17
    v_mul_f32 v105, v10, v11
    v_fmac_f32 v105, v58, v94
    v_lshlrev_b32 v10, 16, v59
    v_lshlrev_b32 v11, 16, v95
    v_and_b32 v59, 0xffff0000, v59
    v_and_b32 v95, 0xffff0000, v95
    v_mul_f32 v10, v10, v18
    v_mul_f32 v59, v59, v19
    v_fmac_f32 v105, v10, v11
    v_fmac_f32 v105, v59, v95
    v_lshlrev_b32 v10, 16, v60
    v_lshlrev_b32 v11, 16, v96
    v_and_b32 v60, 0xffff0000, v60
    v_and_b32 v96, 0xffff0000, v96
    v_mul_f32 v10, v10, v20
    v_mul_f32 v60, v60, v21
    v_fmac_f32 v105, v10, v11
    v_fmac_f32 v105, v60, v96
    v_lshlrev_b32 v10, 16, v61
    v_lshlrev_b32 v11, 16, v97
    v_and_b32 v61, 0xffff0000, v61
    v_and_b32 v97, 0xffff0000, v97
    v_mul_f32 v10, v10, v22
    v_mul_f32 v61, v61, v23
    v_fmac_f32 v105, v10, v11
    v_fmac_f32 v105, v61, v97
    v_lshlrev_b32 v10, 16, v62
    v_lshlrev_b32 v11, 16, v98
    v_and_b32 v62, 0xffff0000, v62
    v_and_b32 v98, 0xffff0000, v98
    v_mul_f32 v10, v10, v24
    v_mul_f32 v62, v62, v25
    v_fmac_f32 v105, v10, v11
    v_fmac_f32 v105, v62, v98
    v_lshlrev_b32 v10, 16, v63
    v_lshlrev_b32 v11, 16, v99
    v_and_b32 v63, 0xffff0000, v63
    v_and_b32 v99, 0xffff0000, v99
    v_mul_f32 v10, v10, v26
    v_mul_f32 v63, v63, v27
    v_fmac_f32 v105, v10, v11
    v_fmac_f32 v105, v63, v99
    v_add_f32_dpp v100, v100, v100 row_ror:8 row_mask:0xf bank_mask:0xf
    v_add_f32_dpp v101, v101, v101 row_ror:8 row_mask:0xf bank_mask:0xf
    v_add_f32_dpp v102, v102, v102 row_ror:8 row_mask:0xf bank_mask:0xf
    v_add_f32_dpp v103, v103, v103 row_ror:8 row_mask:0xf bank_mask:0xf
    v_add_f32_dpp v104, v104, v104 row_ror:8 row_mask:0xf bank_mask:0xf
    v_add_f32_dpp v105, v105, v105 row_ror:8 row_mask:0xf bank_mask:0xf
    v_add_f32_dpp v100, v100, v100 row_ror:4 row_mask:0xf bank_mask:0xf
    v_add_f32_dpp v101, v101, v101 row_ror:4 row_mask:0xf bank_mask:0xf
    v_add_f32_dpp v102, v102, v102 row_ror:4 row_mask:0xf bank_mask:0xf
    v_add_f32_dpp v103, v103, v103 row_ror:4 row_mask:0xf bank_mask:0xf
    v_add_f32_dpp v104, v104, v104 row_ror:4 row_mask:0xf bank_mask:0xf
    v_add_f32_dpp v105, v105, v105 row_ror:4 row_mask:0xf bank_mask:0xf
    v_add_f32_dpp v100, v100, v100 row_ror:2 row_mask:0xf bank_mask:0xf
    v_add_f32_dpp v101, v101, v101 row_ror:2 row_mask:0xf bank_mask:0xf
    v_add_f32_dpp v102, v102, v102 row_ror:2 row_mask:0xf bank_mask:0xf
    v_add_f32_dpp v103, v103, v103 row_ror:2 row_mask:0xf bank_mask:0xf
    v_add_f32_dpp v104, v104, v104 row_ror:2 row_mask:0xf bank_mask:0xf
    v_add_f32_dpp v105, v105, v105 row_ror:2 row_mask:0xf bank_mask:0xf
    v_add_f32_dpp v100, v100, v100 row_ror:1 row_mask:0xf bank_mask:0xf
    v_add_f32_dpp v101, v101, v101 row_ror:1 row_mask:0xf bank_mask:0xf
    v_add_f32_dpp v102, v102, v102 row_ror:1 row_mask:0xf bank_mask:0xf
    v_add_f32_dpp v103, v103, v103 row_ror:1 row_mask:0xf bank_mask:0xf
    v_add_f32_dpp v104, v104, v104 row_ror:1 row_mask:0xf bank_mask:0xf
    v_add_f32_dpp v105, v105, v105 row_ror:1 row_mask:0xf bank_mask:0xf
    v_cmp_eq_u32 vcc, 1, v5
    s_nop 1
    v_cndmask_b32 v100, v100, v101, vcc
    v_cmp_eq_u32 vcc, 2, v5
    s_nop 1
    v_cndmask_b32 v100, v100, v102, vcc
    v_cmp_eq_u32 vcc, 3, v5
    s_nop 1
    v_cndmask_b32 v100, v100, v103, vcc
    v_cmp_eq_u32 vcc, 4, v5
    s_nop 1
    v_cndmask_b32 v100, v100, v104, vcc
    v_cmp_eq_u32 vcc, 5, v5
    s_nop 1
    v_cndmask_b32 v100, v100, v105, vcc
    s_mul_i32 s48, s62, 768
    s_lshl_b32 s49, s49, 2
    s_add_u32 s48, s48, s49
    s_add_u32 s48, s48, 1179648
    s_mov_b32 exec_lo, 0x003f003f
    s_mov_b32 exec_hi, 0x003f003f
    buffer_store_dword v100, v13, s[12:15], s48 offen sc1
    s_mov_b64 exec, -1
    s_mov_b32 s61, 1
    s_lshl_b32 s62, s61, 5
    s_add_u32 s62, s62, s3
    s_lshl_b32 s63, s62, 15
    s_add_u32 s63, s63, 1
    s_mul_hi_u32 s63, s63, 0xaaaaaaab
    s_lshr_b32 s63, s63, 7
    s_mul_i32 s48, s62, 171
    s_lshr_b32 s48, s48, 9
    s_mul_i32 s48, s48, 384
    s_mul_i32 s49, s4, 24
    s_add_u32 s50, s49, s63
    s_mul_i32 s50, s50, 384
    v_add_u32 v10, s50, v7
    v_add_u32 v11, 3072, v10
    v_add_u32 v12, 6144, v10
    buffer_load_dwordx2 v[100:101], v6, s[8:11], s48 offen offset:0
    buffer_load_dwordx2 v[102:103], v6, s[8:11], s48 offen offset:128
    buffer_load_dwordx2 v[104:105], v6, s[8:11], s48 offen offset:256
    buffer_load_dwordx2 v[28:29], v10, s[92:95], 0 offen offset:0
    buffer_load_dwordx2 v[30:31], v10, s[92:95], 0 offen offset:128
    buffer_load_dwordx2 v[32:33], v10, s[92:95], 0 offen offset:256
    buffer_load_dwordx2 v[64:65], v10, s[96:99], 0 offen offset:0
    buffer_load_dwordx2 v[66:67], v10, s[96:99], 0 offen offset:128
    buffer_load_dwordx2 v[68:69], v10, s[96:99], 0 offen offset:256
    buffer_load_dwordx2 v[34:35], v10, s[92:95], 0 offen offset:1536
    buffer_load_dwordx2 v[36:37], v10, s[92:95], 0 offen offset:1664
    buffer_load_dwordx2 v[38:39], v10, s[92:95], 0 offen offset:1792
    buffer_load_dwordx2 v[70:71], v10, s[96:99], 0 offen offset:1536
    buffer_load_dwordx2 v[72:73], v10, s[96:99], 0 offen offset:1664
    buffer_load_dwordx2 v[74:75], v10, s[96:99], 0 offen offset:1792
    buffer_load_dwordx2 v[40:41], v11, s[92:95], 0 offen offset:0
    buffer_load_dwordx2 v[42:43], v11, s[92:95], 0 offen offset:128
    buffer_load_dwordx2 v[44:45], v11, s[92:95], 0 offen offset:256
    buffer_load_dwordx2 v[76:77], v11, s[96:99], 0 offen offset:0
    buffer_load_dwordx2 v[78:79], v11, s[96:99], 0 offen offset:128
    buffer_load_dwordx2 v[80:81], v11, s[96:99], 0 offen offset:256
    buffer_load_dwordx2 v[46:47], v11, s[92:95], 0 offen offset:1536
    buffer_load_dwordx2 v[48:49], v11, s[92:95], 0 offen offset:1664
    buffer_load_dwordx2 v[50:51], v11, s[92:95], 0 offen offset:1792
    buffer_load_dwordx2 v[82:83], v11, s[96:99], 0 offen offset:1536
    buffer_load_dwordx2 v[84:85], v11, s[96:99], 0 offen offset:1664
    buffer_load_dwordx2 v[86:87], v11, s[96:99], 0 offen offset:1792
    buffer_load_dwordx2 v[52:53], v12, s[92:95], 0 offen offset:0
    buffer_load_dwordx2 v[54:55], v12, s[92:95], 0 offen offset:128
    buffer_load_dwordx2 v[56:57], v12, s[92:95], 0 offen offset:256
    buffer_load_dwordx2 v[88:89], v12, s[96:99], 0 offen offset:0
    buffer_load_dwordx2 v[90:91], v12, s[96:99], 0 offen offset:128
    buffer_load_dwordx2 v[92:93], v12, s[96:99], 0 offen offset:256
    buffer_load_dwordx2 v[58:59], v12, s[92:95], 0 offen offset:1536
    buffer_load_dwordx2 v[60:61], v12, s[92:95], 0 offen offset:1664
    buffer_load_dwordx2 v[62:63], v12, s[92:95], 0 offen offset:1792
    buffer_load_dwordx2 v[94:95], v12, s[96:99], 0 offen offset:1536
    buffer_load_dwordx2 v[96:97], v12, s[96:99], 0 offen offset:1664
    buffer_load_dwordx2 v[98:99], v12, s[96:99], 0 offen offset:1792
    s_waitcnt vmcnt(0)
    v_lshlrev_b32 v16, 16, v100
    v_and_b32 v17, 0xffff0000, v100
    v_lshlrev_b32 v18, 16, v101
    v_and_b32 v19, 0xffff0000, v101
    v_lshlrev_b32 v20, 16, v102
    v_and_b32 v21, 0xffff0000, v102
    v_lshlrev_b32 v22, 16, v103
    v_and_b32 v23, 0xffff0000, v103
    v_lshlrev_b32 v24, 16, v104
    v_and_b32 v25, 0xffff0000, v104
    v_lshlrev_b32 v26, 16, v105
    v_and_b32 v27, 0xffff0000, v105
    v_lshlrev_b32 v10, 16, v28
    v_lshlrev_b32 v11, 16, v64
    v_and_b32 v28, 0xffff0000, v28
    v_and_b32 v64, 0xffff0000, v64
    v_mul_f32 v10, v10, v16
    v_mul_f32 v28, v28, v17
    v_mul_f32 v100, v10, v11
    v_fmac_f32 v100, v28, v64
    v_lshlrev_b32 v10, 16, v29
    v_lshlrev_b32 v11, 16, v65
    v_and_b32 v29, 0xffff0000, v29
    v_and_b32 v65, 0xffff0000, v65
    v_mul_f32 v10, v10, v18
    v_mul_f32 v29, v29, v19
    v_fmac_f32 v100, v10, v11
    v_fmac_f32 v100, v29, v65
    v_lshlrev_b32 v10, 16, v30
    v_lshlrev_b32 v11, 16, v66
    v_and_b32 v30, 0xffff0000, v30
    v_and_b32 v66, 0xffff0000, v66
    v_mul_f32 v10, v10, v20
    v_mul_f32 v30, v30, v21
    v_fmac_f32 v100, v10, v11
    v_fmac_f32 v100, v30, v66
    v_lshlrev_b32 v10, 16, v31
    v_lshlrev_b32 v11, 16, v67
    v_and_b32 v31, 0xffff0000, v31
    v_and_b32 v67, 0xffff0000, v67
    v_mul_f32 v10, v10, v22
    v_mul_f32 v31, v31, v23
    v_fmac_f32 v100, v10, v11
    v_fmac_f32 v100, v31, v67
    v_lshlrev_b32 v10, 16, v32
    v_lshlrev_b32 v11, 16, v68
    v_and_b32 v32, 0xffff0000, v32
    v_and_b32 v68, 0xffff0000, v68
    v_mul_f32 v10, v10, v24
    v_mul_f32 v32, v32, v25
    v_fmac_f32 v100, v10, v11
    v_fmac_f32 v100, v32, v68
    v_lshlrev_b32 v10, 16, v33
    v_lshlrev_b32 v11, 16, v69
    v_and_b32 v33, 0xffff0000, v33
    v_and_b32 v69, 0xffff0000, v69
    v_mul_f32 v10, v10, v26
    v_mul_f32 v33, v33, v27
    v_fmac_f32 v100, v10, v11
    v_fmac_f32 v100, v33, v69
    v_lshlrev_b32 v10, 16, v34
    v_lshlrev_b32 v11, 16, v70
    v_and_b32 v34, 0xffff0000, v34
    v_and_b32 v70, 0xffff0000, v70
    v_mul_f32 v10, v10, v16
    v_mul_f32 v34, v34, v17
    v_mul_f32 v101, v10, v11
    v_fmac_f32 v101, v34, v70
    v_lshlrev_b32 v10, 16, v35
    v_lshlrev_b32 v11, 16, v71
    v_and_b32 v35, 0xffff0000, v35
    v_and_b32 v71, 0xffff0000, v71
    v_mul_f32 v10, v10, v18
    v_mul_f32 v35, v35, v19
    v_fmac_f32 v101, v10, v11
    v_fmac_f32 v101, v35, v71
    v_lshlrev_b32 v10, 16, v36
    v_lshlrev_b32 v11, 16, v72
    v_and_b32 v36, 0xffff0000, v36
    v_and_b32 v72, 0xffff0000, v72
    v_mul_f32 v10, v10, v20
    v_mul_f32 v36, v36, v21
    v_fmac_f32 v101, v10, v11
    v_fmac_f32 v101, v36, v72
    v_lshlrev_b32 v10, 16, v37
    v_lshlrev_b32 v11, 16, v73
    v_and_b32 v37, 0xffff0000, v37
    v_and_b32 v73, 0xffff0000, v73
    v_mul_f32 v10, v10, v22
    v_mul_f32 v37, v37, v23
    v_fmac_f32 v101, v10, v11
    v_fmac_f32 v101, v37, v73
    v_lshlrev_b32 v10, 16, v38
    v_lshlrev_b32 v11, 16, v74
    v_and_b32 v38, 0xffff0000, v38
    v_and_b32 v74, 0xffff0000, v74
    v_mul_f32 v10, v10, v24
    v_mul_f32 v38, v38, v25
    v_fmac_f32 v101, v10, v11
    v_fmac_f32 v101, v38, v74
    v_lshlrev_b32 v10, 16, v39
    v_lshlrev_b32 v11, 16, v75
    v_and_b32 v39, 0xffff0000, v39
    v_and_b32 v75, 0xffff0000, v75
    v_mul_f32 v10, v10, v26
    v_mul_f32 v39, v39, v27
    v_fmac_f32 v101, v10, v11
    v_fmac_f32 v101, v39, v75
    v_lshlrev_b32 v10, 16, v40
    v_lshlrev_b32 v11, 16, v76
    v_and_b32 v40, 0xffff0000, v40
    v_and_b32 v76, 0xffff0000, v76
    v_mul_f32 v10, v10, v16
    v_mul_f32 v40, v40, v17
    v_mul_f32 v102, v10, v11
    v_fmac_f32 v102, v40, v76
    v_lshlrev_b32 v10, 16, v41
    v_lshlrev_b32 v11, 16, v77
    v_and_b32 v41, 0xffff0000, v41
    v_and_b32 v77, 0xffff0000, v77
    v_mul_f32 v10, v10, v18
    v_mul_f32 v41, v41, v19
    v_fmac_f32 v102, v10, v11
    v_fmac_f32 v102, v41, v77
    v_lshlrev_b32 v10, 16, v42
    v_lshlrev_b32 v11, 16, v78
    v_and_b32 v42, 0xffff0000, v42
    v_and_b32 v78, 0xffff0000, v78
    v_mul_f32 v10, v10, v20
    v_mul_f32 v42, v42, v21
    v_fmac_f32 v102, v10, v11
    v_fmac_f32 v102, v42, v78
    v_lshlrev_b32 v10, 16, v43
    v_lshlrev_b32 v11, 16, v79
    v_and_b32 v43, 0xffff0000, v43
    v_and_b32 v79, 0xffff0000, v79
    v_mul_f32 v10, v10, v22
    v_mul_f32 v43, v43, v23
    v_fmac_f32 v102, v10, v11
    v_fmac_f32 v102, v43, v79
    v_lshlrev_b32 v10, 16, v44
    v_lshlrev_b32 v11, 16, v80
    v_and_b32 v44, 0xffff0000, v44
    v_and_b32 v80, 0xffff0000, v80
    v_mul_f32 v10, v10, v24
    v_mul_f32 v44, v44, v25
    v_fmac_f32 v102, v10, v11
    v_fmac_f32 v102, v44, v80
    v_lshlrev_b32 v10, 16, v45
    v_lshlrev_b32 v11, 16, v81
    v_and_b32 v45, 0xffff0000, v45
    v_and_b32 v81, 0xffff0000, v81
    v_mul_f32 v10, v10, v26
    v_mul_f32 v45, v45, v27
    v_fmac_f32 v102, v10, v11
    v_fmac_f32 v102, v45, v81
    v_lshlrev_b32 v10, 16, v46
    v_lshlrev_b32 v11, 16, v82
    v_and_b32 v46, 0xffff0000, v46
    v_and_b32 v82, 0xffff0000, v82
    v_mul_f32 v10, v10, v16
    v_mul_f32 v46, v46, v17
    v_mul_f32 v103, v10, v11
    v_fmac_f32 v103, v46, v82
    v_lshlrev_b32 v10, 16, v47
    v_lshlrev_b32 v11, 16, v83
    v_and_b32 v47, 0xffff0000, v47
    v_and_b32 v83, 0xffff0000, v83
    v_mul_f32 v10, v10, v18
    v_mul_f32 v47, v47, v19
    v_fmac_f32 v103, v10, v11
    v_fmac_f32 v103, v47, v83
    v_lshlrev_b32 v10, 16, v48
    v_lshlrev_b32 v11, 16, v84
    v_and_b32 v48, 0xffff0000, v48
    v_and_b32 v84, 0xffff0000, v84
    v_mul_f32 v10, v10, v20
    v_mul_f32 v48, v48, v21
    v_fmac_f32 v103, v10, v11
    v_fmac_f32 v103, v48, v84
    v_lshlrev_b32 v10, 16, v49
    v_lshlrev_b32 v11, 16, v85
    v_and_b32 v49, 0xffff0000, v49
    v_and_b32 v85, 0xffff0000, v85
    v_mul_f32 v10, v10, v22
    v_mul_f32 v49, v49, v23
    v_fmac_f32 v103, v10, v11
    v_fmac_f32 v103, v49, v85
    v_lshlrev_b32 v10, 16, v50
    v_lshlrev_b32 v11, 16, v86
    v_and_b32 v50, 0xffff0000, v50
    v_and_b32 v86, 0xffff0000, v86
    v_mul_f32 v10, v10, v24
    v_mul_f32 v50, v50, v25
    v_fmac_f32 v103, v10, v11
    v_fmac_f32 v103, v50, v86
    v_lshlrev_b32 v10, 16, v51
    v_lshlrev_b32 v11, 16, v87
    v_and_b32 v51, 0xffff0000, v51
    v_and_b32 v87, 0xffff0000, v87
    v_mul_f32 v10, v10, v26
    v_mul_f32 v51, v51, v27
    v_fmac_f32 v103, v10, v11
    v_fmac_f32 v103, v51, v87
    v_lshlrev_b32 v10, 16, v52
    v_lshlrev_b32 v11, 16, v88
    v_and_b32 v52, 0xffff0000, v52
    v_and_b32 v88, 0xffff0000, v88
    v_mul_f32 v10, v10, v16
    v_mul_f32 v52, v52, v17
    v_mul_f32 v104, v10, v11
    v_fmac_f32 v104, v52, v88
    v_lshlrev_b32 v10, 16, v53
    v_lshlrev_b32 v11, 16, v89
    v_and_b32 v53, 0xffff0000, v53
    v_and_b32 v89, 0xffff0000, v89
    v_mul_f32 v10, v10, v18
    v_mul_f32 v53, v53, v19
    v_fmac_f32 v104, v10, v11
    v_fmac_f32 v104, v53, v89
    v_lshlrev_b32 v10, 16, v54
    v_lshlrev_b32 v11, 16, v90
    v_and_b32 v54, 0xffff0000, v54
    v_and_b32 v90, 0xffff0000, v90
    v_mul_f32 v10, v10, v20
    v_mul_f32 v54, v54, v21
    v_fmac_f32 v104, v10, v11
    v_fmac_f32 v104, v54, v90
    v_lshlrev_b32 v10, 16, v55
    v_lshlrev_b32 v11, 16, v91
    v_and_b32 v55, 0xffff0000, v55
    v_and_b32 v91, 0xffff0000, v91
    v_mul_f32 v10, v10, v22
    v_mul_f32 v55, v55, v23
    v_fmac_f32 v104, v10, v11
    v_fmac_f32 v104, v55, v91
    v_lshlrev_b32 v10, 16, v56
    v_lshlrev_b32 v11, 16, v92
    v_and_b32 v56, 0xffff0000, v56
    v_and_b32 v92, 0xffff0000, v92
    v_mul_f32 v10, v10, v24
    v_mul_f32 v56, v56, v25
    v_fmac_f32 v104, v10, v11
    v_fmac_f32 v104, v56, v92
    v_lshlrev_b32 v10, 16, v57
    v_lshlrev_b32 v11, 16, v93
    v_and_b32 v57, 0xffff0000, v57
    v_and_b32 v93, 0xffff0000, v93
    v_mul_f32 v10, v10, v26
    v_mul_f32 v57, v57, v27
    v_fmac_f32 v104, v10, v11
    v_fmac_f32 v104, v57, v93
    v_lshlrev_b32 v10, 16, v58
    v_lshlrev_b32 v11, 16, v94
    v_and_b32 v58, 0xffff0000, v58
    v_and_b32 v94, 0xffff0000, v94
    v_mul_f32 v10, v10, v16
    v_mul_f32 v58, v58, v17
    v_mul_f32 v105, v10, v11
    v_fmac_f32 v105, v58, v94
    v_lshlrev_b32 v10, 16, v59
    v_lshlrev_b32 v11, 16, v95
    v_and_b32 v59, 0xffff0000, v59
    v_and_b32 v95, 0xffff0000, v95
    v_mul_f32 v10, v10, v18
    v_mul_f32 v59, v59, v19
    v_fmac_f32 v105, v10, v11
    v_fmac_f32 v105, v59, v95
    v_lshlrev_b32 v10, 16, v60
    v_lshlrev_b32 v11, 16, v96
    v_and_b32 v60, 0xffff0000, v60
    v_and_b32 v96, 0xffff0000, v96
    v_mul_f32 v10, v10, v20
    v_mul_f32 v60, v60, v21
    v_fmac_f32 v105, v10, v11
    v_fmac_f32 v105, v60, v96
    v_lshlrev_b32 v10, 16, v61
    v_lshlrev_b32 v11, 16, v97
    v_and_b32 v61, 0xffff0000, v61
    v_and_b32 v97, 0xffff0000, v97
    v_mul_f32 v10, v10, v22
    v_mul_f32 v61, v61, v23
    v_fmac_f32 v105, v10, v11
    v_fmac_f32 v105, v61, v97
    v_lshlrev_b32 v10, 16, v62
    v_lshlrev_b32 v11, 16, v98
    v_and_b32 v62, 0xffff0000, v62
    v_and_b32 v98, 0xffff0000, v98
    v_mul_f32 v10, v10, v24
    v_mul_f32 v62, v62, v25
    v_fmac_f32 v105, v10, v11
    v_fmac_f32 v105, v62, v98
    v_lshlrev_b32 v10, 16, v63
    v_lshlrev_b32 v11, 16, v99
    v_and_b32 v63, 0xffff0000, v63
    v_and_b32 v99, 0xffff0000, v99
    v_mul_f32 v10, v10, v26
    v_mul_f32 v63, v63, v27
    v_fmac_f32 v105, v10, v11
    v_fmac_f32 v105, v63, v99
    v_add_f32_dpp v100, v100, v100 row_ror:8 row_mask:0xf bank_mask:0xf
    v_add_f32_dpp v101, v101, v101 row_ror:8 row_mask:0xf bank_mask:0xf
    v_add_f32_dpp v102, v102, v102 row_ror:8 row_mask:0xf bank_mask:0xf
    v_add_f32_dpp v103, v103, v103 row_ror:8 row_mask:0xf bank_mask:0xf
    v_add_f32_dpp v104, v104, v104 row_ror:8 row_mask:0xf bank_mask:0xf
    v_add_f32_dpp v105, v105, v105 row_ror:8 row_mask:0xf bank_mask:0xf
    v_add_f32_dpp v100, v100, v100 row_ror:4 row_mask:0xf bank_mask:0xf
    v_add_f32_dpp v101, v101, v101 row_ror:4 row_mask:0xf bank_mask:0xf
    v_add_f32_dpp v102, v102, v102 row_ror:4 row_mask:0xf bank_mask:0xf
    v_add_f32_dpp v103, v103, v103 row_ror:4 row_mask:0xf bank_mask:0xf
    v_add_f32_dpp v104, v104, v104 row_ror:4 row_mask:0xf bank_mask:0xf
    v_add_f32_dpp v105, v105, v105 row_ror:4 row_mask:0xf bank_mask:0xf
    v_add_f32_dpp v100, v100, v100 row_ror:2 row_mask:0xf bank_mask:0xf
    v_add_f32_dpp v101, v101, v101 row_ror:2 row_mask:0xf bank_mask:0xf
    v_add_f32_dpp v102, v102, v102 row_ror:2 row_mask:0xf bank_mask:0xf
    v_add_f32_dpp v103, v103, v103 row_ror:2 row_mask:0xf bank_mask:0xf
    v_add_f32_dpp v104, v104, v104 row_ror:2 row_mask:0xf bank_mask:0xf
    v_add_f32_dpp v105, v105, v105 row_ror:2 row_mask:0xf bank_mask:0xf
    v_add_f32_dpp v100, v100, v100 row_ror:1 row_mask:0xf bank_mask:0xf
    v_add_f32_dpp v101, v101, v101 row_ror:1 row_mask:0xf bank_mask:0xf
    v_add_f32_dpp v102, v102, v102 row_ror:1 row_mask:0xf bank_mask:0xf
    v_add_f32_dpp v103, v103, v103 row_ror:1 row_mask:0xf bank_mask:0xf
    v_add_f32_dpp v104, v104, v104 row_ror:1 row_mask:0xf bank_mask:0xf
    v_add_f32_dpp v105, v105, v105 row_ror:1 row_mask:0xf bank_mask:0xf
    v_cmp_eq_u32 vcc, 1, v5
    s_nop 1
    v_cndmask_b32 v100, v100, v101, vcc
    v_cmp_eq_u32 vcc, 2, v5
    s_nop 1
    v_cndmask_b32 v100, v100, v102, vcc
    v_cmp_eq_u32 vcc, 3, v5
    s_nop 1
    v_cndmask_b32 v100, v100, v103, vcc
    v_cmp_eq_u32 vcc, 4, v5
    s_nop 1
    v_cndmask_b32 v100, v100, v104, vcc
    v_cmp_eq_u32 vcc, 5, v5
    s_nop 1
    v_cndmask_b32 v100, v100, v105, vcc
    s_mul_i32 s48, s62, 768
    s_lshl_b32 s49, s49, 2
    s_add_u32 s48, s48, s49
    s_add_u32 s48, s48, 1179648
    s_mov_b32 exec_lo, 0x003f003f
    s_mov_b32 exec_hi, 0x003f003f
    buffer_store_dword v100, v13, s[12:15], s48 offen sc1
    s_mov_b64 exec, -1
    s_mov_b32 s61, 2
    s_lshl_b32 s62, s61, 5
    s_add_u32 s62, s62, s3
    s_lshl_b32 s63, s62, 15
    s_add_u32 s63, s63, 1
    s_mul_hi_u32 s63, s63, 0xaaaaaaab
    s_lshr_b32 s63, s63, 7
    s_mul_i32 s48, s62, 171
    s_lshr_b32 s48, s48, 9
    s_mul_i32 s48, s48, 384
    s_mul_i32 s49, s4, 24
    s_add_u32 s50, s49, s63
    s_mul_i32 s50, s50, 384
    v_add_u32 v10, s50, v7
    v_add_u32 v11, 3072, v10
    v_add_u32 v12, 6144, v10
    buffer_load_dwordx2 v[100:101], v6, s[8:11], s48 offen offset:0
    buffer_load_dwordx2 v[102:103], v6, s[8:11], s48 offen offset:128
    buffer_load_dwordx2 v[104:105], v6, s[8:11], s48 offen offset:256
    buffer_load_dwordx2 v[28:29], v10, s[92:95], 0 offen offset:0
    buffer_load_dwordx2 v[30:31], v10, s[92:95], 0 offen offset:128
    buffer_load_dwordx2 v[32:33], v10, s[92:95], 0 offen offset:256
    buffer_load_dwordx2 v[64:65], v10, s[96:99], 0 offen offset:0
    buffer_load_dwordx2 v[66:67], v10, s[96:99], 0 offen offset:128
    buffer_load_dwordx2 v[68:69], v10, s[96:99], 0 offen offset:256
    buffer_load_dwordx2 v[34:35], v10, s[92:95], 0 offen offset:1536
    buffer_load_dwordx2 v[36:37], v10, s[92:95], 0 offen offset:1664
    buffer_load_dwordx2 v[38:39], v10, s[92:95], 0 offen offset:1792
    buffer_load_dwordx2 v[70:71], v10, s[96:99], 0 offen offset:1536
    buffer_load_dwordx2 v[72:73], v10, s[96:99], 0 offen offset:1664
    buffer_load_dwordx2 v[74:75], v10, s[96:99], 0 offen offset:1792
    buffer_load_dwordx2 v[40:41], v11, s[92:95], 0 offen offset:0
    buffer_load_dwordx2 v[42:43], v11, s[92:95], 0 offen offset:128
    buffer_load_dwordx2 v[44:45], v11, s[92:95], 0 offen offset:256
    buffer_load_dwordx2 v[76:77], v11, s[96:99], 0 offen offset:0
    buffer_load_dwordx2 v[78:79], v11, s[96:99], 0 offen offset:128
    buffer_load_dwordx2 v[80:81], v11, s[96:99], 0 offen offset:256
    buffer_load_dwordx2 v[46:47], v11, s[92:95], 0 offen offset:1536
    buffer_load_dwordx2 v[48:49], v11, s[92:95], 0 offen offset:1664
    buffer_load_dwordx2 v[50:51], v11, s[92:95], 0 offen offset:1792
    buffer_load_dwordx2 v[82:83], v11, s[96:99], 0 offen offset:1536
    buffer_load_dwordx2 v[84:85], v11, s[96:99], 0 offen offset:1664
    buffer_load_dwordx2 v[86:87], v11, s[96:99], 0 offen offset:1792
    buffer_load_dwordx2 v[52:53], v12, s[92:95], 0 offen offset:0
    buffer_load_dwordx2 v[54:55], v12, s[92:95], 0 offen offset:128
    buffer_load_dwordx2 v[56:57], v12, s[92:95], 0 offen offset:256
    buffer_load_dwordx2 v[88:89], v12, s[96:99], 0 offen offset:0
    buffer_load_dwordx2 v[90:91], v12, s[96:99], 0 offen offset:128
    buffer_load_dwordx2 v[92:93], v12, s[96:99], 0 offen offset:256
    buffer_load_dwordx2 v[58:59], v12, s[92:95], 0 offen offset:1536
    buffer_load_dwordx2 v[60:61], v12, s[92:95], 0 offen offset:1664
    buffer_load_dwordx2 v[62:63], v12, s[92:95], 0 offen offset:1792
    buffer_load_dwordx2 v[94:95], v12, s[96:99], 0 offen offset:1536
    buffer_load_dwordx2 v[96:97], v12, s[96:99], 0 offen offset:1664
    buffer_load_dwordx2 v[98:99], v12, s[96:99], 0 offen offset:1792
    s_waitcnt vmcnt(0)
    v_lshlrev_b32 v16, 16, v100
    v_and_b32 v17, 0xffff0000, v100
    v_lshlrev_b32 v18, 16, v101
    v_and_b32 v19, 0xffff0000, v101
    v_lshlrev_b32 v20, 16, v102
    v_and_b32 v21, 0xffff0000, v102
    v_lshlrev_b32 v22, 16, v103
    v_and_b32 v23, 0xffff0000, v103
    v_lshlrev_b32 v24, 16, v104
    v_and_b32 v25, 0xffff0000, v104
    v_lshlrev_b32 v26, 16, v105
    v_and_b32 v27, 0xffff0000, v105
    v_lshlrev_b32 v10, 16, v28
    v_lshlrev_b32 v11, 16, v64
    v_and_b32 v28, 0xffff0000, v28
    v_and_b32 v64, 0xffff0000, v64
    v_mul_f32 v10, v10, v16
    v_mul_f32 v28, v28, v17
    v_mul_f32 v100, v10, v11
    v_fmac_f32 v100, v28, v64
    v_lshlrev_b32 v10, 16, v29
    v_lshlrev_b32 v11, 16, v65
    v_and_b32 v29, 0xffff0000, v29
    v_and_b32 v65, 0xffff0000, v65
    v_mul_f32 v10, v10, v18
    v_mul_f32 v29, v29, v19
    v_fmac_f32 v100, v10, v11
    v_fmac_f32 v100, v29, v65
    v_lshlrev_b32 v10, 16, v30
    v_lshlrev_b32 v11, 16, v66
    v_and_b32 v30, 0xffff0000, v30
    v_and_b32 v66, 0xffff0000, v66
    v_mul_f32 v10, v10, v20
    v_mul_f32 v30, v30, v21
    v_fmac_f32 v100, v10, v11
    v_fmac_f32 v100, v30, v66
    v_lshlrev_b32 v10, 16, v31
    v_lshlrev_b32 v11, 16, v67
    v_and_b32 v31, 0xffff0000, v31
    v_and_b32 v67, 0xffff0000, v67
    v_mul_f32 v10, v10, v22
    v_mul_f32 v31, v31, v23
    v_fmac_f32 v100, v10, v11
    v_fmac_f32 v100, v31, v67
    v_lshlrev_b32 v10, 16, v32
    v_lshlrev_b32 v11, 16, v68
    v_and_b32 v32, 0xffff0000, v32
    v_and_b32 v68, 0xffff0000, v68
    v_mul_f32 v10, v10, v24
    v_mul_f32 v32, v32, v25
    v_fmac_f32 v100, v10, v11
    v_fmac_f32 v100, v32, v68
    v_lshlrev_b32 v10, 16, v33
    v_lshlrev_b32 v11, 16, v69
    v_and_b32 v33, 0xffff0000, v33
    v_and_b32 v69, 0xffff0000, v69
    v_mul_f32 v10, v10, v26
    v_mul_f32 v33, v33, v27
    v_fmac_f32 v100, v10, v11
    v_fmac_f32 v100, v33, v69
    v_lshlrev_b32 v10, 16, v34
    v_lshlrev_b32 v11, 16, v70
    v_and_b32 v34, 0xffff0000, v34
    v_and_b32 v70, 0xffff0000, v70
    v_mul_f32 v10, v10, v16
    v_mul_f32 v34, v34, v17
    v_mul_f32 v101, v10, v11
    v_fmac_f32 v101, v34, v70
    v_lshlrev_b32 v10, 16, v35
    v_lshlrev_b32 v11, 16, v71
    v_and_b32 v35, 0xffff0000, v35
    v_and_b32 v71, 0xffff0000, v71
    v_mul_f32 v10, v10, v18
    v_mul_f32 v35, v35, v19
    v_fmac_f32 v101, v10, v11
    v_fmac_f32 v101, v35, v71
    v_lshlrev_b32 v10, 16, v36
    v_lshlrev_b32 v11, 16, v72
    v_and_b32 v36, 0xffff0000, v36
    v_and_b32 v72, 0xffff0000, v72
    v_mul_f32 v10, v10, v20
    v_mul_f32 v36, v36, v21
    v_fmac_f32 v101, v10, v11
    v_fmac_f32 v101, v36, v72
    v_lshlrev_b32 v10, 16, v37
    v_lshlrev_b32 v11, 16, v73
    v_and_b32 v37, 0xffff0000, v37
    v_and_b32 v73, 0xffff0000, v73
    v_mul_f32 v10, v10, v22
    v_mul_f32 v37, v37, v23
    v_fmac_f32 v101, v10, v11
    v_fmac_f32 v101, v37, v73
    v_lshlrev_b32 v10, 16, v38
    v_lshlrev_b32 v11, 16, v74
    v_and_b32 v38, 0xffff0000, v38
    v_and_b32 v74, 0xffff0000, v74
    v_mul_f32 v10, v10, v24
    v_mul_f32 v38, v38, v25
    v_fmac_f32 v101, v10, v11
    v_fmac_f32 v101, v38, v74
    v_lshlrev_b32 v10, 16, v39
    v_lshlrev_b32 v11, 16, v75
    v_and_b32 v39, 0xffff0000, v39
    v_and_b32 v75, 0xffff0000, v75
    v_mul_f32 v10, v10, v26
    v_mul_f32 v39, v39, v27
    v_fmac_f32 v101, v10, v11
    v_fmac_f32 v101, v39, v75
    v_lshlrev_b32 v10, 16, v40
    v_lshlrev_b32 v11, 16, v76
    v_and_b32 v40, 0xffff0000, v40
    v_and_b32 v76, 0xffff0000, v76
    v_mul_f32 v10, v10, v16
    v_mul_f32 v40, v40, v17
    v_mul_f32 v102, v10, v11
    v_fmac_f32 v102, v40, v76
    v_lshlrev_b32 v10, 16, v41
    v_lshlrev_b32 v11, 16, v77
    v_and_b32 v41, 0xffff0000, v41
    v_and_b32 v77, 0xffff0000, v77
    v_mul_f32 v10, v10, v18
    v_mul_f32 v41, v41, v19
    v_fmac_f32 v102, v10, v11
    v_fmac_f32 v102, v41, v77
    v_lshlrev_b32 v10, 16, v42
    v_lshlrev_b32 v11, 16, v78
    v_and_b32 v42, 0xffff0000, v42
    v_and_b32 v78, 0xffff0000, v78
    v_mul_f32 v10, v10, v20
    v_mul_f32 v42, v42, v21
    v_fmac_f32 v102, v10, v11
    v_fmac_f32 v102, v42, v78
    v_lshlrev_b32 v10, 16, v43
    v_lshlrev_b32 v11, 16, v79
    v_and_b32 v43, 0xffff0000, v43
    v_and_b32 v79, 0xffff0000, v79
    v_mul_f32 v10, v10, v22
    v_mul_f32 v43, v43, v23
    v_fmac_f32 v102, v10, v11
    v_fmac_f32 v102, v43, v79
    v_lshlrev_b32 v10, 16, v44
    v_lshlrev_b32 v11, 16, v80
    v_and_b32 v44, 0xffff0000, v44
    v_and_b32 v80, 0xffff0000, v80
    v_mul_f32 v10, v10, v24
    v_mul_f32 v44, v44, v25
    v_fmac_f32 v102, v10, v11
    v_fmac_f32 v102, v44, v80
    v_lshlrev_b32 v10, 16, v45
    v_lshlrev_b32 v11, 16, v81
    v_and_b32 v45, 0xffff0000, v45
    v_and_b32 v81, 0xffff0000, v81
    v_mul_f32 v10, v10, v26
    v_mul_f32 v45, v45, v27
    v_fmac_f32 v102, v10, v11
    v_fmac_f32 v102, v45, v81
    v_lshlrev_b32 v10, 16, v46
    v_lshlrev_b32 v11, 16, v82
    v_and_b32 v46, 0xffff0000, v46
    v_and_b32 v82, 0xffff0000, v82
    v_mul_f32 v10, v10, v16
    v_mul_f32 v46, v46, v17
    v_mul_f32 v103, v10, v11
    v_fmac_f32 v103, v46, v82
    v_lshlrev_b32 v10, 16, v47
    v_lshlrev_b32 v11, 16, v83
    v_and_b32 v47, 0xffff0000, v47
    v_and_b32 v83, 0xffff0000, v83
    v_mul_f32 v10, v10, v18
    v_mul_f32 v47, v47, v19
    v_fmac_f32 v103, v10, v11
    v_fmac_f32 v103, v47, v83
    v_lshlrev_b32 v10, 16, v48
    v_lshlrev_b32 v11, 16, v84
    v_and_b32 v48, 0xffff0000, v48
    v_and_b32 v84, 0xffff0000, v84
    v_mul_f32 v10, v10, v20
    v_mul_f32 v48, v48, v21
    v_fmac_f32 v103, v10, v11
    v_fmac_f32 v103, v48, v84
    v_lshlrev_b32 v10, 16, v49
    v_lshlrev_b32 v11, 16, v85
    v_and_b32 v49, 0xffff0000, v49
    v_and_b32 v85, 0xffff0000, v85
    v_mul_f32 v10, v10, v22
    v_mul_f32 v49, v49, v23
    v_fmac_f32 v103, v10, v11
    v_fmac_f32 v103, v49, v85
    v_lshlrev_b32 v10, 16, v50
    v_lshlrev_b32 v11, 16, v86
    v_and_b32 v50, 0xffff0000, v50
    v_and_b32 v86, 0xffff0000, v86
    v_mul_f32 v10, v10, v24
    v_mul_f32 v50, v50, v25
    v_fmac_f32 v103, v10, v11
    v_fmac_f32 v103, v50, v86
    v_lshlrev_b32 v10, 16, v51
    v_lshlrev_b32 v11, 16, v87
    v_and_b32 v51, 0xffff0000, v51
    v_and_b32 v87, 0xffff0000, v87
    v_mul_f32 v10, v10, v26
    v_mul_f32 v51, v51, v27
    v_fmac_f32 v103, v10, v11
    v_fmac_f32 v103, v51, v87
    v_lshlrev_b32 v10, 16, v52
    v_lshlrev_b32 v11, 16, v88
    v_and_b32 v52, 0xffff0000, v52
    v_and_b32 v88, 0xffff0000, v88
    v_mul_f32 v10, v10, v16
    v_mul_f32 v52, v52, v17
    v_mul_f32 v104, v10, v11
    v_fmac_f32 v104, v52, v88
    v_lshlrev_b32 v10, 16, v53
    v_lshlrev_b32 v11, 16, v89
    v_and_b32 v53, 0xffff0000, v53
    v_and_b32 v89, 0xffff0000, v89
    v_mul_f32 v10, v10, v18
    v_mul_f32 v53, v53, v19
    v_fmac_f32 v104, v10, v11
    v_fmac_f32 v104, v53, v89
    v_lshlrev_b32 v10, 16, v54
    v_lshlrev_b32 v11, 16, v90
    v_and_b32 v54, 0xffff0000, v54
    v_and_b32 v90, 0xffff0000, v90
    v_mul_f32 v10, v10, v20
    v_mul_f32 v54, v54, v21
    v_fmac_f32 v104, v10, v11
    v_fmac_f32 v104, v54, v90
    v_lshlrev_b32 v10, 16, v55
    v_lshlrev_b32 v11, 16, v91
    v_and_b32 v55, 0xffff0000, v55
    v_and_b32 v91, 0xffff0000, v91
    v_mul_f32 v10, v10, v22
    v_mul_f32 v55, v55, v23
    v_fmac_f32 v104, v10, v11
    v_fmac_f32 v104, v55, v91
    v_lshlrev_b32 v10, 16, v56
    v_lshlrev_b32 v11, 16, v92
    v_and_b32 v56, 0xffff0000, v56
    v_and_b32 v92, 0xffff0000, v92
    v_mul_f32 v10, v10, v24
    v_mul_f32 v56, v56, v25
    v_fmac_f32 v104, v10, v11
    v_fmac_f32 v104, v56, v92
    v_lshlrev_b32 v10, 16, v57
    v_lshlrev_b32 v11, 16, v93
    v_and_b32 v57, 0xffff0000, v57
    v_and_b32 v93, 0xffff0000, v93
    v_mul_f32 v10, v10, v26
    v_mul_f32 v57, v57, v27
    v_fmac_f32 v104, v10, v11
    v_fmac_f32 v104, v57, v93
    v_lshlrev_b32 v10, 16, v58
    v_lshlrev_b32 v11, 16, v94
    v_and_b32 v58, 0xffff0000, v58
    v_and_b32 v94, 0xffff0000, v94
    v_mul_f32 v10, v10, v16
    v_mul_f32 v58, v58, v17
    v_mul_f32 v105, v10, v11
    v_fmac_f32 v105, v58, v94
    v_lshlrev_b32 v10, 16, v59
    v_lshlrev_b32 v11, 16, v95
    v_and_b32 v59, 0xffff0000, v59
    v_and_b32 v95, 0xffff0000, v95
    v_mul_f32 v10, v10, v18
    v_mul_f32 v59, v59, v19
    v_fmac_f32 v105, v10, v11
    v_fmac_f32 v105, v59, v95
    v_lshlrev_b32 v10, 16, v60
    v_lshlrev_b32 v11, 16, v96
    v_and_b32 v60, 0xffff0000, v60
    v_and_b32 v96, 0xffff0000, v96
    v_mul_f32 v10, v10, v20
    v_mul_f32 v60, v60, v21
    v_fmac_f32 v105, v10, v11
    v_fmac_f32 v105, v60, v96
    v_lshlrev_b32 v10, 16, v61
    v_lshlrev_b32 v11, 16, v97
    v_and_b32 v61, 0xffff0000, v61
    v_and_b32 v97, 0xffff0000, v97
    v_mul_f32 v10, v10, v22
    v_mul_f32 v61, v61, v23
    v_fmac_f32 v105, v10, v11
    v_fmac_f32 v105, v61, v97
    v_lshlrev_b32 v10, 16, v62
    v_lshlrev_b32 v11, 16, v98
    v_and_b32 v62, 0xffff0000, v62
    v_and_b32 v98, 0xffff0000, v98
    v_mul_f32 v10, v10, v24
    v_mul_f32 v62, v62, v25
    v_fmac_f32 v105, v10, v11
    v_fmac_f32 v105, v62, v98
    v_lshlrev_b32 v10, 16, v63
    v_lshlrev_b32 v11, 16, v99
    v_and_b32 v63, 0xffff0000, v63
    v_and_b32 v99, 0xffff0000, v99
    v_mul_f32 v10, v10, v26
    v_mul_f32 v63, v63, v27
    v_fmac_f32 v105, v10, v11
    v_fmac_f32 v105, v63, v99
    v_add_f32_dpp v100, v100, v100 row_ror:8 row_mask:0xf bank_mask:0xf
    v_add_f32_dpp v101, v101, v101 row_ror:8 row_mask:0xf bank_mask:0xf
    v_add_f32_dpp v102, v102, v102 row_ror:8 row_mask:0xf bank_mask:0xf
    v_add_f32_dpp v103, v103, v103 row_ror:8 row_mask:0xf bank_mask:0xf
    v_add_f32_dpp v104, v104, v104 row_ror:8 row_mask:0xf bank_mask:0xf
    v_add_f32_dpp v105, v105, v105 row_ror:8 row_mask:0xf bank_mask:0xf
    v_add_f32_dpp v100, v100, v100 row_ror:4 row_mask:0xf bank_mask:0xf
    v_add_f32_dpp v101, v101, v101 row_ror:4 row_mask:0xf bank_mask:0xf
    v_add_f32_dpp v102, v102, v102 row_ror:4 row_mask:0xf bank_mask:0xf
    v_add_f32_dpp v103, v103, v103 row_ror:4 row_mask:0xf bank_mask:0xf
    v_add_f32_dpp v104, v104, v104 row_ror:4 row_mask:0xf bank_mask:0xf
    v_add_f32_dpp v105, v105, v105 row_ror:4 row_mask:0xf bank_mask:0xf
    v_add_f32_dpp v100, v100, v100 row_ror:2 row_mask:0xf bank_mask:0xf
    v_add_f32_dpp v101, v101, v101 row_ror:2 row_mask:0xf bank_mask:0xf
    v_add_f32_dpp v102, v102, v102 row_ror:2 row_mask:0xf bank_mask:0xf
    v_add_f32_dpp v103, v103, v103 row_ror:2 row_mask:0xf bank_mask:0xf
    v_add_f32_dpp v104, v104, v104 row_ror:2 row_mask:0xf bank_mask:0xf
    v_add_f32_dpp v105, v105, v105 row_ror:2 row_mask:0xf bank_mask:0xf
    v_add_f32_dpp v100, v100, v100 row_ror:1 row_mask:0xf bank_mask:0xf
    v_add_f32_dpp v101, v101, v101 row_ror:1 row_mask:0xf bank_mask:0xf
    v_add_f32_dpp v102, v102, v102 row_ror:1 row_mask:0xf bank_mask:0xf
    v_add_f32_dpp v103, v103, v103 row_ror:1 row_mask:0xf bank_mask:0xf
    v_add_f32_dpp v104, v104, v104 row_ror:1 row_mask:0xf bank_mask:0xf
    v_add_f32_dpp v105, v105, v105 row_ror:1 row_mask:0xf bank_mask:0xf
    v_cmp_eq_u32 vcc, 1, v5
    s_nop 1
    v_cndmask_b32 v100, v100, v101, vcc
    v_cmp_eq_u32 vcc, 2, v5
    s_nop 1
    v_cndmask_b32 v100, v100, v102, vcc
    v_cmp_eq_u32 vcc, 3, v5
    s_nop 1
    v_cndmask_b32 v100, v100, v103, vcc
    v_cmp_eq_u32 vcc, 4, v5
    s_nop 1
    v_cndmask_b32 v100, v100, v104, vcc
    v_cmp_eq_u32 vcc, 5, v5
    s_nop 1
    v_cndmask_b32 v100, v100, v105, vcc
    s_mul_i32 s48, s62, 768
    s_lshl_b32 s49, s49, 2
    s_add_u32 s48, s48, s49
    s_add_u32 s48, s48, 1179648
    s_mov_b32 exec_lo, 0x003f003f
    s_mov_b32 exec_hi, 0x003f003f
    buffer_store_dword v100, v13, s[12:15], s48 offen sc1
    s_mov_b64 exec, -1
    s_mov_b32 s92, s74
    s_and_b32 s93, s75, 0xffff
    s_mov_b32 s94, 2097152
    s_mov_b32 s95, 0x00020000
    s_mov_b32 s96, s76
    s_and_b32 s97, s77, 0xffff
    s_mov_b32 s98, 2097152
    s_mov_b32 s99, 0x00020000
    v_lshlrev_b32 v10, 4, v1
    s_lshl_b32 s48, s2, 13
    s_add_u32 s49, s48, 4096
    buffer_load_dwordx4 v[16:19], v10, s[92:95], s48 offen offset:0
    buffer_load_dwordx4 v[20:23], v10, s[92:95], s48 offen offset:1024
    buffer_load_dwordx4 v[24:27], v10, s[92:95], s48 offen offset:2048
    buffer_load_dwordx4 v[28:31], v10, s[92:95], s48 offen offset:3072
    buffer_load_dwordx4 v[32:35], v10, s[92:95], s49 offen offset:0
    buffer_load_dwordx4 v[36:39], v10, s[92:95], s49 offen offset:1024
    buffer_load_dwordx4 v[40:43], v10, s[92:95], s49 offen offset:2048
    buffer_load_dwordx4 v[44:47], v10, s[92:95], s49 offen offset:3072
    buffer_load_dwordx4 v[48:51], v10, s[96:99], s48 offen offset:0
    buffer_load_dwordx4 v[52:55], v10, s[96:99], s48 offen offset:1024
    buffer_load_dwordx4 v[56:59], v10, s[96:99], s48 offen offset:2048
    buffer_load_dwordx4 v[60:63], v10, s[96:99], s48 offen offset:3072
    buffer_load_dwordx4 v[64:67], v10, s[96:99], s49 offen offset:0
    buffer_load_dwordx4 v[68:71], v10, s[96:99], s49 offen offset:1024
    buffer_load_dwordx4 v[72:75], v10, s[96:99], s49 offen offset:2048
    buffer_load_dwordx4 v[76:79], v10, s[96:99], s49 offen offset:3072
    s_waitcnt vmcnt(0)
    s_mov_b32 s60, 0x100000
L_wd0:
    s_nop 1
    ds_read_b32 v10, v2 offset:20
    s_sub_u32 s60, s60, 1
    s_cbranch_scc1 L_exit1
    s_waitcnt lgkmcnt(0)
    v_readfirstlane_b32 s48, v10
    s_cmp_eq_u32 s48, 0
    s_cbranch_scc1 L_wd0
    ds_read_b128 v[16:19], v2 offset:0
    ds_read_b64 v[20:21], v2 offset:16
    s_waitcnt lgkmcnt(0)
    v_readfirstlane_b32 s84, v16
    v_readfirstlane_b32 s85, v17
    v_readfirstlane_b32 s86, v18
    v_readfirstlane_b32 s87, v19
    v_readfirstlane_b32 s88, v20
    v_readfirstlane_b32 s89, v21
    s_mov_b32 s60, 0x100000
L_wf0:
    s_nop 1
    ds_read_b32 v10, v2 offset:40
    s_sub_u32 s60, s60, 1
    s_cbranch_scc1 L_exit1
    s_waitcnt lgkmcnt(0)
    v_readfirstlane_b32 s48, v10
    s_cmp_lt_u32 s48, 4
    s_cbranch_scc1 L_wf0
    s_cmp_eq_u32 s84, s87
    ds_read_b64 v[16:17], v8 offset:256
    ds_read_b64 v[18:19], v8 offset:264
    ds_read_b64 v[20:21], v8 offset:272
    ds_read_b64 v[28:29], v8 offset:448
    ds_read_b64 v[30:31], v8 offset:456
    ds_read_b64 v[32:33], v8 offset:464
    ds_read_b64 v[40:41], v8 offset:640
    ds_read_b64 v[42:43], v8 offset:648
    ds_read_b64 v[44:45], v8 offset:656
    ds_read_b64 v[52:53], v8 offset:832
    ds_read_b64 v[54:55], v8 offset:840
    ds_read_b64 v[56:57], v8 offset:848
    s_add_u32 s54, s33, 0
    s_cmp_eq_u32 s84, s87
    s_waitcnt lgkmcnt(0)
    v_cmp_eq_f32 vcc, 0, v21
    v_max3_f32 v25, v16, v17, v18
    s_nop 0
    v_cndmask_b32 v24, v21, v20, vcc
    v_max3_f32 v25, v25, v19, v20
    v_max_f32 v24, v24, v25
    v_sub_f32 v16, v16, v24
    v_sub_f32 v17, v17, v24
    v_sub_f32 v18, v18, v24
    v_sub_f32 v19, v19, v24
    v_sub_f32 v20, v20, v24
    v_sub_f32 v21, v21, v24
    v_cvt_pk_f16_f32 v25, v16, v17
    v_cvt_pk_f16_f32 v26, v18, v19
    v_cvt_pk_f16_f32 v27, v20, v21
    buffer_store_dwordx4 v[24:27], v14, s[12:15], s54 offen offset:0 sc1
    s_cbranch_scc1 L_fl0
    v_cmp_eq_f32 vcc, 0, v33
    v_max3_f32 v37, v28, v29, v30
    s_nop 0
    v_cndmask_b32 v36, v33, v32, vcc
    v_max3_f32 v37, v37, v31, v32
    v_max_f32 v36, v36, v37
    v_sub_f32 v28, v28, v36
    v_sub_f32 v29, v29, v36
    v_sub_f32 v30, v30, v36
    v_sub_f32 v31, v31, v36
    v_sub_f32 v32, v32, v36
    v_sub_f32 v33, v33, v36
    v_cvt_pk_f16_f32 v37, v28, v29
    v_cvt_pk_f16_f32 v38, v30, v31
    v_cvt_pk_f16_f32 v39, v32, v33
    buffer_store_dwordx4 v[36:39], v14, s[12:15], s54 offen offset:1024 sc1
    v_cmp_eq_f32 vcc, 0, v45
    v_max3_f32 v49, v40, v41, v42
    s_nop 0
    v_cndmask_b32 v48, v45, v44, vcc
    v_max3_f32 v49, v49, v43, v44
    v_max_f32 v48, v48, v49
    v_sub_f32 v40, v40, v48
    v_sub_f32 v41, v41, v48
    v_sub_f32 v42, v42, v48
    v_sub_f32 v43, v43, v48
    v_sub_f32 v44, v44, v48
    v_sub_f32 v45, v45, v48
    v_cvt_pk_f16_f32 v49, v40, v41
    v_cvt_pk_f16_f32 v50, v42, v43
    v_cvt_pk_f16_f32 v51, v44, v45
    buffer_store_dwordx4 v[48:51], v14, s[12:15], s54 offen offset:2048 sc1
    v_cmp_eq_f32 vcc, 0, v57
    v_max3_f32 v61, v52, v53, v54
    s_nop 0
    v_cndmask_b32 v60, v57, v56, vcc
    v_max3_f32 v61, v61, v55, v56
    v_max_f32 v60, v60, v61
    v_sub_f32 v52, v52, v60
    v_sub_f32 v53, v53, v60
    v_sub_f32 v54, v54, v60
    v_sub_f32 v55, v55, v60
    v_sub_f32 v56, v56, v60
    v_sub_f32 v57, v57, v60
    v_cvt_pk_f16_f32 v61, v52, v53
    v_cvt_pk_f16_f32 v62, v54, v55
    v_cvt_pk_f16_f32 v63, v56, v57
    buffer_store_dwordx4 v[60:63], v14, s[12:15], s54 offen offset:3072 sc1
L_fl0:
    s_nop 1
    v_mov_b32 v10, 1
    s_waitcnt vmcnt(0)
    s_mov_b64 exec, 1
    buffer_store_dword v10, off, s[12:15], s32 sc1
    ds_write_b32 v2, v10 offset:52
    s_mov_b64 exec, -1
    s_mov_b32 s60, 0x100000
L_wf1:
    s_nop 1
    ds_read_b32 v10, v2 offset:44
    s_sub_u32 s60, s60, 1
    s_cbranch_scc1 L_exit1
    s_waitcnt lgkmcnt(0)
    v_readfirstlane_b32 s48, v10
    s_cmp_lt_u32 s48, 4
    s_cbranch_scc1 L_wf1
    s_cmp_eq_u32 s85, s88
    s_cbranch_scc1 L_fl1
    ds_read_b64 v[16:17], v8 offset:6400
    ds_read_b64 v[18:19], v8 offset:6408
    ds_read_b64 v[20:21], v8 offset:6416
    ds_read_b64 v[28:29], v8 offset:6592
    ds_read_b64 v[30:31], v8 offset:6600
    ds_read_b64 v[32:33], v8 offset:6608
    ds_read_b64 v[40:41], v8 offset:6784
    ds_read_b64 v[42:43], v8 offset:6792
    ds_read_b64 v[44:45], v8 offset:6800
    ds_read_b64 v[52:53], v8 offset:6976
    ds_read_b64 v[54:55], v8 offset:6984
    ds_read_b64 v[56:57], v8 offset:6992
    s_add_u32 s54, s33, 1048576
    s_cmp_eq_u32 s85, s88
    s_waitcnt lgkmcnt(0)
    v_cmp_eq_f32 vcc, 0, v21
    v_max3_f32 v25, v16, v17, v18
    s_nop 0
    v_cndmask_b32 v24, v21, v20, vcc
    v_max3_f32 v25, v25, v19, v20
    v_max_f32 v24, v24, v25
    v_sub_f32 v16, v16, v24
    v_sub_f32 v17, v17, v24
    v_sub_f32 v18, v18, v24
    v_sub_f32 v19, v19, v24
    v_sub_f32 v20, v20, v24
    v_sub_f32 v21, v21, v24
    v_cvt_pk_f16_f32 v25, v16, v17
    v_cvt_pk_f16_f32 v26, v18, v19
    v_cvt_pk_f16_f32 v27, v20, v21
    buffer_store_dwordx4 v[24:27], v14, s[12:15], s54 offen offset:0 sc1
    v_cmp_eq_f32 vcc, 0, v33
    v_max3_f32 v37, v28, v29, v30
    s_nop 0
    v_cndmask_b32 v36, v33, v32, vcc
    v_max3_f32 v37, v37, v31, v32
    v_max_f32 v36, v36, v37
    v_sub_f32 v28, v28, v36
    v_sub_f32 v29, v29, v36
    v_sub_f32 v30, v30, v36
    v_sub_f32 v31, v31, v36
    v_sub_f32 v32, v32, v36
    v_sub_f32 v33, v33, v36
    v_cvt_pk_f16_f32 v37, v28, v29
    v_cvt_pk_f16_f32 v38, v30, v31
    v_cvt_pk_f16_f32 v39, v32, v33
    buffer_store_dwordx4 v[36:39], v14, s[12:15], s54 offen offset:1024 sc1
    v_cmp_eq_f32 vcc, 0, v45
    v_max3_f32 v49, v40, v41, v42
    s_nop 0
    v_cndmask_b32 v48, v45, v44, vcc
    v_max3_f32 v49, v49, v43, v44
    v_max_f32 v48, v48, v49
    v_sub_f32 v40, v40, v48
    v_sub_f32 v41, v41, v48
    v_sub_f32 v42, v42, v48
    v_sub_f32 v43, v43, v48
    v_sub_f32 v44, v44, v48
    v_sub_f32 v45, v45, v48
    v_cvt_pk_f16_f32 v49, v40, v41
    v_cvt_pk_f16_f32 v50, v42, v43
    v_cvt_pk_f16_f32 v51, v44, v45
    buffer_store_dwordx4 v[48:51], v14, s[12:15], s54 offen offset:2048 sc1
    v_cmp_eq_f32 vcc, 0, v57
    v_max3_f32 v61, v52, v53, v54
    s_nop 0
    v_cndmask_b32 v60, v57, v56, vcc
    v_max3_f32 v61, v61, v55, v56
    v_max_f32 v60, v60, v61
    v_sub_f32 v52, v52, v60
    v_sub_f32 v53, v53, v60
    v_sub_f32 v54, v54, v60
    v_sub_f32 v55, v55, v60
    v_sub_f32 v56, v56, v60
    v_sub_f32 v57, v57, v60
    v_cvt_pk_f16_f32 v61, v52, v53
    v_cvt_pk_f16_f32 v62, v54, v55
    v_cvt_pk_f16_f32 v63, v56, v57
    buffer_store_dwordx4 v[60:63], v14, s[12:15], s54 offen offset:3072 sc1
L_fl1:
    s_nop 1
    v_mov_b32 v10, 2
    s_waitcnt vmcnt(0)
    s_mov_b64 exec, 1
    s_cbranch_scc1 L_fn1
    buffer_store_dword v10, off, s[12:15], s32 sc1
L_fn1:
    s_nop 1
    ds_write_b32 v2, v10 offset:52
    s_mov_b64 exec, -1
    s_mov_b32 s60, 0x100000
L_wf2:
    s_nop 1
    ds_read_b32 v10, v2 offset:48
    s_sub_u32 s60, s60, 1
    s_cbranch_scc1 L_exit1
    s_waitcnt lgkmcnt(0)
    v_readfirstlane_b32 s48, v10
    s_cmp_lt_u32 s48, 4
    s_cbranch_scc1 L_wf2
    s_cmp_eq_u32 s86, s89
    s_cbranch_scc1 L_fl2
    ds_read_b64 v[16:17], v8 offset:12544
    ds_read_b64 v[18:19], v8 offset:12552
    ds_read_b64 v[20:21], v8 offset:12560
    ds_read_b64 v[28:29], v8 offset:12736
    ds_read_b64 v[30:31], v8 offset:12744
    ds_read_b64 v[32:33], v8 offset:12752
    ds_read_b64 v[40:41], v8 offset:12928
    ds_read_b64 v[42:43], v8 offset:12936
    ds_read_b64 v[44:45], v8 offset:12944
    ds_read_b64 v[52:53], v8 offset:13120
    ds_read_b64 v[54:55], v8 offset:13128
    ds_read_b64 v[56:57], v8 offset:13136
    s_add_u32 s54, s33, 2097152
    s_cmp_eq_u32 s86, s89
    s_waitcnt lgkmcnt(0)
    v_cmp_eq_f32 vcc, 0, v21
    v_max3_f32 v25, v16, v17, v18
    s_nop 0
    v_cndmask_b32 v24, v21, v20, vcc
    v_max3_f32 v25, v25, v19, v20
    v_max_f32 v24, v24, v25
    v_sub_f32 v16, v16, v24
    v_sub_f32 v17, v17, v24
    v_sub_f32 v18, v18, v24
    v_sub_f32 v19, v19, v24
    v_sub_f32 v20, v20, v24
    v_sub_f32 v21, v21, v24
    v_cvt_pk_f16_f32 v25, v16, v17
    v_cvt_pk_f16_f32 v26, v18, v19
    v_cvt_pk_f16_f32 v27, v20, v21
    buffer_store_dwordx4 v[24:27], v14, s[12:15], s54 offen offset:0 sc1
    v_cmp_eq_f32 vcc, 0, v33
    v_max3_f32 v37, v28, v29, v30
    s_nop 0
    v_cndmask_b32 v36, v33, v32, vcc
    v_max3_f32 v37, v37, v31, v32
    v_max_f32 v36, v36, v37
    v_sub_f32 v28, v28, v36
    v_sub_f32 v29, v29, v36
    v_sub_f32 v30, v30, v36
    v_sub_f32 v31, v31, v36
    v_sub_f32 v32, v32, v36
    v_sub_f32 v33, v33, v36
    v_cvt_pk_f16_f32 v37, v28, v29
    v_cvt_pk_f16_f32 v38, v30, v31
    v_cvt_pk_f16_f32 v39, v32, v33
    buffer_store_dwordx4 v[36:39], v14, s[12:15], s54 offen offset:1024 sc1
    v_cmp_eq_f32 vcc, 0, v45
    v_max3_f32 v49, v40, v41, v42
    s_nop 0
    v_cndmask_b32 v48, v45, v44, vcc
    v_max3_f32 v49, v49, v43, v44
    v_max_f32 v48, v48, v49
    v_sub_f32 v40, v40, v48
    v_sub_f32 v41, v41, v48
    v_sub_f32 v42, v42, v48
    v_sub_f32 v43, v43, v48
    v_sub_f32 v44, v44, v48
    v_sub_f32 v45, v45, v48
    v_cvt_pk_f16_f32 v49, v40, v41
    v_cvt_pk_f16_f32 v50, v42, v43
    v_cvt_pk_f16_f32 v51, v44, v45
    buffer_store_dwordx4 v[48:51], v14, s[12:15], s54 offen offset:2048 sc1
    v_cmp_eq_f32 vcc, 0, v57
    v_max3_f32 v61, v52, v53, v54
    s_nop 0
    v_cndmask_b32 v60, v57, v56, vcc
    v_max3_f32 v61, v61, v55, v56
    v_max_f32 v60, v60, v61
    v_sub_f32 v52, v52, v60
    v_sub_f32 v53, v53, v60
    v_sub_f32 v54, v54, v60
    v_sub_f32 v55, v55, v60
    v_sub_f32 v56, v56, v60
    v_sub_f32 v57, v57, v60
    v_cvt_pk_f16_f32 v61, v52, v53
    v_cvt_pk_f16_f32 v62, v54, v55
    v_cvt_pk_f16_f32 v63, v56, v57
    buffer_store_dwordx4 v[60:63], v14, s[12:15], s54 offen offset:3072 sc1
L_fl2:
    s_nop 1
    v_mov_b32 v10, 3
    s_waitcnt vmcnt(0)
    s_mov_b64 exec, 1
    s_cbranch_scc1 L_fn2
    buffer_store_dword v10, off, s[12:15], s32 sc1
L_fn2:
    s_nop 1
    ds_write_b32 v2, v10 offset:52
    s_mov_b64 exec, -1
    s_endpgm
L_h3:
    s_nop 1
    s_waitcnt lgkmcnt(0)
    s_mov_b32 s12, s82
    s_and_b32 s13, s83, 0xffff
    s_mov_b32 s14, 10485760
    s_mov_b32 s15, 0x00020000
    s_barrier
    v_lshlrev_b32 v7, 2, v1
    s_mul_i32 s20, s4, 4352
    s_add_u32 s20, s20, 10223616
    s_lshl_b32 s21, s3, 2
    s_add_u32 s21, s21, s20
    s_mov_b32 s46, 0x155
    v_lshrrev_b32 v13, 2, v1
    v_mul_u32_u24 v13, 4352, v13
    v_and_or_b32 v13, v7, 12, v13
    s_and_b32 s7, s4, 3
    s_mul_i32 s47, s7, 4352
    s_lshl_b32 s7, s7, 2
    v_mov_b32 v8, 208
    s_mov_b32 s45, 2
    v_mov_b32 v3, 144
    v_bfrev_b32 v6, -2
    s_mov_b32 exec_hi, 0
L_h3loop:
    s_nop 1
    s_mov_b32 s60, 0x100000
L_wp1:
    s_nop 1
    ds_read_b32 v10, v2 offset:128
    s_sub_u32 s60, s60, 1
    s_cbranch_scc1 L_exit1
    s_waitcnt lgkmcnt(0)
    v_readfirstlane_b32 s48, v10
    s_cmp_lt_u32 s48, s45
    s_cbranch_scc1 L_wp1
    s_memrealtime s[40:41]
    s_add_u32 s45, s45, 3
    s_mov_b32 exec_lo, 1
    s_waitcnt lgkmcnt(0)
    v_mov_b32 v5, s40
    buffer_store_dword v5, off, s[12:15], s21
    s_mov_b32 exec_lo, -1
    s_mov_b32 s60, 0x100000
L_wp2:
    s_nop 1
    ds_read_b32 v10, v2 offset:128
    s_sub_u32 s60, s60, 1
    s_cbranch_scc1 L_exit1
    s_waitcnt lgkmcnt(0)
    v_readfirstlane_b32 s48, v10
    s_cmp_lt_u32 s48, s45
    s_cbranch_scc1 L_wp2
    buffer_load_dword v5, v7, s[12:15], s20 offen sc0
    s_add_u32 s45, s45, 4
    s_sub_u32 s40, s40, 4096
    s_waitcnt vmcnt(0)
    v_subrev_u32 v5, s40, v5
    v_cmp_gt_u32 vcc, 8192, v5
    s_nop 1
    v_cndmask_b32 v5, v6, v5, vcc
    s_mov_b32 s48, 2048
    s_add_u32 s49, s48, 2048
    v_cmp_gt_u32 vcc, s49, v5
    s_bcnt1_i32_b64 s50, vcc
    s_cmp_lt_u32 s50, 16
    s_cselect_b32 s48, s49, s48
    s_add_u32 s49, s48, 1024
    v_cmp_gt_u32 vcc, s49, v5
    s_bcnt1_i32_b64 s50, vcc
    s_cmp_lt_u32 s50, 16
    s_cselect_b32 s48, s49, s48
    s_add_u32 s49, s48, 512
    v_cmp_gt_u32 vcc, s49, v5
    s_bcnt1_i32_b64 s50, vcc
    s_cmp_lt_u32 s50, 16
    s_cselect_b32 s48, s49, s48
    s_add_u32 s49, s48, 256
    v_cmp_gt_u32 vcc, s49, v5
    s_bcnt1_i32_b64 s50, vcc
    s_cmp_lt_u32 s50, 16
    s_cselect_b32 s48, s49, s48
    s_add_u32 s49, s48, 128
    v_cmp_gt_u32 vcc, s49, v5
    s_bcnt1_i32_b64 s50, vcc
    s_cmp_lt_u32 s50, 16
    s_cselect_b32 s48, s49, s48
    s_add_u32 s49, s48, 64
    v_cmp_gt_u32 vcc, s49, v5
    s_bcnt1_i32_b64 s50, vcc
    s_cmp_lt_u32 s50, 16
    s_cselect_b32 s48, s49, s48
    s_add_u32 s49, s48, 32
    v_cmp_gt_u32 vcc, s49, v5
    s_bcnt1_i32_b64 s50, vcc
    s_cmp_lt_u32 s50, 16
    s_cselect_b32 s48, s49, s48
    s_add_u32 s49, s48, 16
    v_cmp_gt_u32 vcc, s49, v5
    s_bcnt1_i32_b64 s50, vcc
    s_cmp_lt_u32 s50, 16
    s_cselect_b32 s48, s49, s48
    s_add_u32 s49, s48, 8
    v_cmp_gt_u32 vcc, s49, v5
    s_bcnt1_i32_b64 s50, vcc
    s_cmp_lt_u32 s50, 16
    s_cselect_b32 s48, s49, s48
    s_add_u32 s49, s48, s40
    s_or_b32 s49, s49, 1
    v_mov_b32 v5, s49
    ds_write_b32 v3, v5
    v_add_u32 v3, 4, v3
    s_bitcmp1_b32 s46, 0
    s_cbranch_scc0 L_h3ng
    s_cmp_lt_u32 s48, 6136
    s_cselect_b32 exec_lo, 1, 0
    s_cmp_lt_u32 s3, 4
    s_cselect_b32 exec_lo, exec_lo, 0
    buffer_store_dword v5, off, s[12:15], s21 offset:2048 sc1
    s_mov_b32 exec_lo, 0xffff
    s_add_u32 s51, s45, 0
    s_mov_b32 s60, 0x100000
L_wp3:
    s_nop 1
    ds_read_b32 v10, v2 offset:128
    s_sub_u32 s60, s60, 1
    s_cbranch_scc1 L_exit1
    s_waitcnt lgkmcnt(0)
    v_readfirstlane_b32 s48, v10
    s_cmp_lt_u32 s48, s51
    s_cbranch_scc1 L_wp3
    s_sub_u32 s51, s20, s47
    s_mov_b32 s60, 8
    s_mov_b32 s48, 0
L_h3gp:
    s_nop 1
    buffer_load_dword v4, v13, s[12:15], s51 offen offset:2048 sc1
    s_sub_u32 s60, s60, 1
    s_cbranch_scc1 L_h3gw
L_h3gq:
    s_waitcnt vmcnt(0)
    v_subrev_u32 v4, s40, v4
    v_cmp_gt_u32 vcc, 8192, v4
    s_nop 1
    v_cndmask_b32 v4, v6, v4, vcc
    s_nop 1
    v_min_u32_dpp v4, v4, v4 quad_perm:[1,0,3,2] row_mask:0xf bank_mask:0xf
    s_nop 1
    v_min_u32_dpp v4, v4, v4 quad_perm:[2,3,0,1] row_mask:0xf bank_mask:0xf
    v_cmp_eq_u32 vcc, v6, v4
    s_cbranch_vccnz L_h3gp
    v_readlane_b32 s52, v4, 0
    v_readlane_b32 s53, v4, 4
    v_readlane_b32 s54, v4, 8
    v_readlane_b32 s55, v4, 12
    v_readlane_b32 s49, v4, s7
    s_max_u32 s52, s52, s53
    s_max_u32 s54, s54, s55
    s_max_u32 s48, s52, s54
    s_sub_u32 s48, s48, s49
    s_sub_u32 s48, s48, 10
    s_max_i32 s48, s48, 0
    s_min_i32 s48, s48, 1000
L_h3gw:
    s_nop 1
    s_or_b32 s48, s48, 0x10000
    v_mov_b32 v5, s48
    ds_write_b32 v8, v5
    s_mov_b32 exec_lo, -1
    v_add_u32 v8, 4, v8
    s_waitcnt vmcnt(0)
L_h3ng:
    s_nop 1
    s_lshr_b32 s46, s46, 1
    s_add_u32 s45, s45, 5
    s_add_u32 s20, s20, 128
    s_add_u32 s21, s21, 128
    s_cmp_lt_u32 s45, 132
    s_cbranch_scc1 L_h3loop
    s_mov_b64 exec, -1
    v_lshlrev_b32 v12, 2, v1
    v_add_u32 v13, 49408, v12
    v_lshlrev_b32 v8, 4, v1
    s_add_u32 s48, s3, 64
    s_mul_i32 s48, s48, 171
    s_lshr_b32 s48, s48, 9
    s_mul_i32 s58, s48, 4352
    s_add_u32 s58, s58, 9498368
    s_mul_i32 s59, s48, 384
    s_cmp_eq_u32 s48, 21
    s_cselect_b32 s20, 15, 23
    s_mul_i32 s48, s48, 24
    s_add_u32 s62, s2, 512
    s_sub_u32 s56, s62, s48
    s_lshl_b32 s62, s62, 10
    s_mov_b32 s60, 0x40000
L_fs:
    s_nop 1
    buffer_load_dword v4, off, s[12:15], s58 offset:4 sc1
    s_sub_u32 s60, s60, 1
    s_cbranch_scc1 L_exit1
    s_waitcnt vmcnt(0)
    v_cmp_eq_u32 vcc, 0, v4
    s_cbranch_vccnz L_fs
    buffer_load_dword v10, v12, s[12:15], s58 offen offset:128 sc1
    ds_read_b128 v[4:7], v2 offset:112
    v_xor_b32 v11, 1, v1
    v_cmp_eq_u32 vcc, s56, v1
    s_nop 1
    v_cndmask_b32 v11, v1, v11, vcc
    v_add_u32 v11, s48, v11
    v_lshlrev_b32 v11, 10, v11
    s_nop 0
    v_readlane_b32 s64, v11, 0
    v_readlane_b32 s65, v11, 1
    v_readlane_b32 s66, v11, 2
    v_readlane_b32 s67, v11, 3
    v_readlane_b32 s68, v11, 4
    v_readlane_b32 s69, v11, 5
    v_readlane_b32 s70, v11, 6
    v_readlane_b32 s71, v11, 7
    v_readlane_b32 s72, v11, 8
    v_readlane_b32 s73, v11, 9
    v_readlane_b32 s74, v11, 10
    v_readlane_b32 s75, v11, 11
    v_readlane_b32 s84, v11, 12
    v_readlane_b32 s85, v11, 13
    v_readlane_b32 s86, v11, 14
    v_readlane_b32 s87, v11, 15
    v_readlane_b32 s88, v11, 16
    v_readlane_b32 s89, v11, 17
    v_readlane_b32 s90, v11, 18
    v_readlane_b32 s91, v11, 19
    v_readlane_b32 s92, v11, 20
    v_readlane_b32 s93, v11, 21
    v_readlane_b32 s94, v11, 22
    v_readlane_b32 s95, v11, 23
    s_mov_b32 s96, s78
    s_and_b32 s97, s79, 0xffff
    s_mov_b32 s98, 12288
    s_mov_b32 s99, 0x00020000
    v_lshlrev_b32 v12, 1, v1
    s_waitcnt vmcnt(0)
    v_readlane_b32 s57, v10, s56
    v_cndmask_b32 v10, v10, v2, vcc
    s_nop 0
    v_readlane_b32 s24, v10, 0
    v_readlane_b32 s25, v10, 1
    v_readlane_b32 s26, v10, 2
    v_readlane_b32 s27, v10, 3
    v_readlane_b32 s28, v10, 4
    v_readlane_b32 s29, v10, 5
    v_readlane_b32 s30, v10, 6
    v_readlane_b32 s31, v10, 7
    v_readlane_b32 s32, v10, 8
    v_readlane_b32 s33, v10, 9
    v_readlane_b32 s34, v10, 10
    v_readlane_b32 s35, v10, 11
    v_readlane_b32 s36, v10, 12
    v_readlane_b32 s37, v10, 13
    v_readlane_b32 s38, v10, 14
    v_readlane_b32 s39, v10, 15
    v_readlane_b32 s40, v10, 16
    v_readlane_b32 s41, v10, 17
    v_readlane_b32 s42, v10, 18
    v_readlane_b32 s43, v10, 19
    v_readlane_b32 s44, v10, 20
    v_readlane_b32 s45, v10, 21
    v_readlane_b32 s46, v10, 22
    v_readlane_b32 s47, v10, 23
    v_mov_b32 v9, 1
    s_mov_b64 exec, 1
    s_mov_b32 s60, 0x100000
L_wel:
    s_nop 1
    ds_read_b32 v10, v2 offset:136
    s_sub_u32 s60, s60, 1
    s_cbranch_scc1 L_exit1
    s_waitcnt lgkmcnt(0)
    v_readfirstlane_b32 s48, v10
    s_cmp_lt_u32 s48, 4
    s_cbranch_scc1 L_wel
    buffer_atomic_add v9, off, s[12:15], s58 sc0
    s_mov_b64 exec, -1
    s_waitcnt vmcnt(0)
    v_readfirstlane_b32 s48, v9
    s_cmp_lg_u32 s48, s20
    s_cbranch_scc1 L_exit1
    buffer_load_dwordx4 v[32:35], v8, s[12:15], s64 offen sc1
    buffer_load_dwordx4 v[36:39], v8, s[12:15], s65 offen sc1
    buffer_load_dwordx4 v[40:43], v8, s[12:15], s66 offen sc1
    buffer_load_dwordx4 v[44:47], v8, s[12:15], s67 offen sc1
    buffer_load_dwordx4 v[48:51], v8, s[12:15], s68 offen sc1
    buffer_load_dwordx4 v[52:55], v8, s[12:15], s69 offen sc1
    buffer_load_dwordx4 v[56:59], v8, s[12:15], s70 offen sc1
    buffer_load_dwordx4 v[60:63], v8, s[12:15], s71 offen sc1
    buffer_load_dwordx4 v[64:67], v8, s[12:15], s72 offen sc1
    buffer_load_dwordx4 v[68:71], v8, s[12:15], s73 offen sc1
    buffer_load_dwordx4 v[72:75], v8, s[12:15], s74 offen sc1
    buffer_load_dwordx4 v[76:79], v8, s[12:15], s75 offen sc1
    buffer_load_dwordx4 v[80:83], v8, s[12:15], s84 offen sc1
    buffer_load_dwordx4 v[84:87], v8, s[12:15], s85 offen sc1
    buffer_load_dwordx4 v[88:91], v8, s[12:15], s86 offen sc1
    buffer_load_dwordx4 v[92:95], v8, s[12:15], s87 offen sc1
    buffer_load_dwordx4 v[96:99], v8, s[12:15], s88 offen sc1
    buffer_load_dwordx4 v[100:103], v8, s[12:15], s89 offen sc1
    buffer_load_dwordx4 v[104:107], v8, s[12:15], s90 offen sc1
    buffer_load_dwordx4 v[108:111], v8, s[12:15], s91 offen sc1
    buffer_load_dwordx4 v[112:115], v8, s[12:15], s92 offen sc1
    buffer_load_dwordx4 v[116:119], v8, s[12:15], s93 offen sc1
    buffer_load_dwordx4 v[120:123], v8, s[12:15], s94 offen sc1
    buffer_load_dwordx4 v[124:127], v8, s[12:15], s95 offen sc1
    s_mov_b32 s60, 0x100000
L_wn:
    s_nop 1
    ds_read_b32 v10, v2 offset:72
    s_sub_u32 s60, s60, 1
    s_cbranch_scc1 L_exit1
    s_waitcnt lgkmcnt(0)
    v_readfirstlane_b32 s48, v10
    s_cmp_lt_u32 s48, 4
    s_cbranch_scc1 L_wn
    ds_read_b32 v16, v13 offset:0
    ds_read_b32 v17, v13 offset:768
    ds_read_b32 v18, v13 offset:1536
    ds_read_b32 v19, v13 offset:2304
    ds_read_b32 v20, v13 offset:256
    ds_read_b32 v21, v13 offset:1024
    ds_read_b32 v22, v13 offset:1792
    ds_read_b32 v23, v13 offset:2560
    ds_read_b32 v24, v13 offset:512
    ds_read_b32 v25, v13 offset:1280
    ds_read_b32 v26, v13 offset:2048
    ds_read_b32 v27, v13 offset:2816
    s_mov_b32 s60, 0x40000
    s_waitcnt lgkmcnt(8)
    v_add_f32 v16, v16, v17
    v_add_f32 v18, v18, v19
    v_sub_f32 v16, v16, v6
    v_add_f32 v28, v16, v18
    s_waitcnt lgkmcnt(4)
    v_add_f32 v20, v20, v21
    v_add_f32 v22, v22, v23
    v_sub_f32 v20, v20, v6
    v_add_f32 v29, v20, v22
    s_waitcnt lgkmcnt(0)
    v_add_f32 v24, v24, v25
    v_add_f32 v26, v26, v27
    v_sub_f32 v24, v24, v6
    v_add_f32 v30, v24, v26
    s_branch L_fr2
L_fr:
    s_nop 1
    buffer_load_dwordx4 v[32:35], v8, s[12:15], s64 offen sc1
    buffer_load_dwordx4 v[36:39], v8, s[12:15], s65 offen sc1
    buffer_load_dwordx4 v[40:43], v8, s[12:15], s66 offen sc1
    buffer_load_dwordx4 v[44:47], v8, s[12:15], s67 offen sc1
    buffer_load_dwordx4 v[48:51], v8, s[12:15], s68 offen sc1
    buffer_load_dwordx4 v[52:55], v8, s[12:15], s69 offen sc1
    buffer_load_dwordx4 v[56:59], v8, s[12:15], s70 offen sc1
    buffer_load_dwordx4 v[60:63], v8, s[12:15], s71 offen sc1
    buffer_load_dwordx4 v[64:67], v8, s[12:15], s72 offen sc1
    buffer_load_dwordx4 v[68:71], v8, s[12:15], s73 offen sc1
    buffer_load_dwordx4 v[72:75], v8, s[12:15], s74 offen sc1
    buffer_load_dwordx4 v[76:79], v8, s[12:15], s75 offen sc1
    buffer_load_dwordx4 v[80:83], v8, s[12:15], s84 offen sc1
    buffer_load_dwordx4 v[84:87], v8, s[12:15], s85 offen sc1
    buffer_load_dwordx4 v[88:91], v8, s[12:15], s86 offen sc1
    buffer_load_dwordx4 v[92:95], v8, s[12:15], s87 offen sc1
    buffer_load_dwordx4 v[96:99], v8, s[12:15], s88 offen sc1
    buffer_load_dwordx4 v[100:103], v8, s[12:15], s89 offen sc1
    buffer_load_dwordx4 v[104:107], v8, s[12:15], s90 offen sc1
    buffer_load_dwordx4 v[108:111], v8, s[12:15], s91 offen sc1
    buffer_load_dwordx4 v[112:115], v8, s[12:15], s92 offen sc1
    buffer_load_dwordx4 v[116:119], v8, s[12:15], s93 offen sc1
    buffer_load_dwordx4 v[120:123], v8, s[12:15], s94 offen sc1
    buffer_load_dwordx4 v[124:127], v8, s[12:15], s95 offen sc1
L_fr2:
    v_mul_f32 v4, s57, v28
    v_mul_f32 v5, s57, v29
    v_mul_f32 v6, s57, v30
    v_mov_b32 v7, 1
    s_sub_u32 s60, s60, 1
    s_cbranch_scc1 L_exit1
    s_waitcnt vmcnt(22)
    v_fmac_f32 v4, s24, v32
    v_fmac_f32 v5, s24, v33
    v_fmac_f32 v6, s24, v34
    v_fmac_f32 v4, s25, v36
    v_fmac_f32 v5, s25, v37
    v_fmac_f32 v6, s25, v38
    v_min3_u32 v7, v7, v35, v39
    s_waitcnt vmcnt(20)
    v_fmac_f32 v4, s26, v40
    v_fmac_f32 v5, s26, v41
    v_fmac_f32 v6, s26, v42
    v_fmac_f32 v4, s27, v44
    v_fmac_f32 v5, s27, v45
    v_fmac_f32 v6, s27, v46
    v_min3_u32 v7, v7, v43, v47
    s_waitcnt vmcnt(18)
    v_fmac_f32 v4, s28, v48
    v_fmac_f32 v5, s28, v49
    v_fmac_f32 v6, s28, v50
    v_fmac_f32 v4, s29, v52
    v_fmac_f32 v5, s29, v53
    v_fmac_f32 v6, s29, v54
    v_min3_u32 v7, v7, v51, v55
    s_waitcnt vmcnt(16)
    v_fmac_f32 v4, s30, v56
    v_fmac_f32 v5, s30, v57
    v_fmac_f32 v6, s30, v58
    v_fmac_f32 v4, s31, v60
    v_fmac_f32 v5, s31, v61
    v_fmac_f32 v6, s31, v62
    v_min3_u32 v7, v7, v59, v63
    s_waitcnt vmcnt(14)
    v_fmac_f32 v4, s32, v64
    v_fmac_f32 v5, s32, v65
    v_fmac_f32 v6, s32, v66
    v_fmac_f32 v4, s33, v68
    v_fmac_f32 v5, s33, v69
    v_fmac_f32 v6, s33, v70
    v_min3_u32 v7, v7, v67, v71
    s_waitcnt vmcnt(12)
    v_fmac_f32 v4, s34, v72
    v_fmac_f32 v5, s34, v73
    v_fmac_f32 v6, s34, v74
    v_fmac_f32 v4, s35, v76
    v_fmac_f32 v5, s35, v77
    v_fmac_f32 v6, s35, v78
    v_min3_u32 v7, v7, v75, v79
    s_waitcnt vmcnt(10)
    v_fmac_f32 v4, s36, v80
    v_fmac_f32 v5, s36, v81
    v_fmac_f32 v6, s36, v82
    v_fmac_f32 v4, s37, v84
    v_fmac_f32 v5, s37, v85
    v_fmac_f32 v6, s37, v86
    v_min3_u32 v7, v7, v83, v87
    s_waitcnt vmcnt(8)
    v_fmac_f32 v4, s38, v88
    v_fmac_f32 v5, s38, v89
    v_fmac_f32 v6, s38, v90
    v_fmac_f32 v4, s39, v92
    v_fmac_f32 v5, s39, v93
    v_fmac_f32 v6, s39, v94
    v_min3_u32 v7, v7, v91, v95
    s_waitcnt vmcnt(6)
    v_fmac_f32 v4, s40, v96
    v_fmac_f32 v5, s40, v97
    v_fmac_f32 v6, s40, v98
    v_fmac_f32 v4, s41, v100
    v_fmac_f32 v5, s41, v101
    v_fmac_f32 v6, s41, v102
    v_min3_u32 v7, v7, v99, v103
    s_waitcnt vmcnt(4)
    v_fmac_f32 v4, s42, v104
    v_fmac_f32 v5, s42, v105
    v_fmac_f32 v6, s42, v106
    v_fmac_f32 v4, s43, v108
    v_fmac_f32 v5, s43, v109
    v_fmac_f32 v6, s43, v110
    v_min3_u32 v7, v7, v107, v111
    s_waitcnt vmcnt(2)
    v_fmac_f32 v4, s44, v112
    v_fmac_f32 v5, s44, v113
    v_fmac_f32 v6, s44, v114
    v_fmac_f32 v4, s45, v116
    v_fmac_f32 v5, s45, v117
    v_fmac_f32 v6, s45, v118
    v_min3_u32 v7, v7, v115, v119
    s_waitcnt vmcnt(0)
    v_fmac_f32 v4, s46, v120
    v_fmac_f32 v5, s46, v121
    v_fmac_f32 v6, s46, v122
    v_fmac_f32 v4, s47, v124
    v_fmac_f32 v5, s47, v125
    v_fmac_f32 v6, s47, v126
    v_min3_u32 v7, v7, v123, v127
    v_cmp_eq_u32 vcc, 0, v7
    v_cvt_pk_bf16_f32 v4, v4, v4
    v_cvt_pk_bf16_f32 v5, v5, v5
    v_cvt_pk_bf16_f32 v6, v6, v6
    s_cbranch_vccnz L_fr
    buffer_store_short v4, v12, s[96:99], s59 offen offset:0
    buffer_store_short v5, v12, s[96:99], s59 offen offset:128
    buffer_store_short v6, v12, s[96:99], s59 offen offset:256
L_fx:
    s_endpgm
L_h2:
    s_nop 1
    s_mov_b32 s92, s74
    s_and_b32 s93, s75, 0xffff
    s_mov_b32 s94, 2097152
    s_mov_b32 s95, 0x00020000
    s_mov_b32 s96, s76
    s_and_b32 s97, s77, 0xffff
    s_mov_b32 s98, 2097152
    s_mov_b32 s99, 0x00020000
    s_mov_b32 s60, 0x100000
L_wd2:
    s_nop 1
    ds_read_b32 v10, v2 offset:20
    s_sub_u32 s60, s60, 1
    s_cbranch_scc1 L_exit1
    s_waitcnt lgkmcnt(0)
    v_readfirstlane_b32 s48, v10
    s_cmp_eq_u32 s48, 0
    s_cbranch_scc1 L_wd2
    ds_read_b128 v[16:19], v2 offset:0
    ds_read_b64 v[20:21], v2 offset:16
    s_waitcnt lgkmcnt(0)
    v_readfirstlane_b32 s84, v16
    v_readfirstlane_b32 s85, v17
    v_readfirstlane_b32 s86, v18
    v_readfirstlane_b32 s87, v19
    v_readfirstlane_b32 s88, v20
    v_readfirstlane_b32 s89, v21
    v_and_b32 v3, 3, v1
    v_and_b32 v15, 7, v1
    v_lshrrev_b32 v12, 2, v1
    v_mov_b32 v5, v12
    v_and_b32 v12, 1, v5
    v_and_b32 v4, 12, v5
    v_lshrrev_b32 v4, 1, v4
    v_or_b32 v12, v12, v4
    v_and_b32 v4, 2, v5
    v_lshlrev_b32 v4, 3, v4
    v_or_b32 v12, v12, v4
    s_bitcmp1_b32 s3, 0
    s_cselect_b32 s48, 4, 0
    v_xor_b32 v12, s48, v12
    s_bitcmp1_b32 s3, 1
    s_cselect_b32 s48, 8, 0
    v_xor_b32 v12, s48, v12
    s_bitcmp1_b32 s3, 3
    s_cselect_b32 s48, 32, 0
    v_xor_b32 v12, s48, v12
    s_mov_b32 s37, 0x3dd53b95
    s_mov_b32 s38, 0xaaaaaaab
    s_mov_b32 s61, 0
    s_mul_i32 s35, s3, 32768
    s_add_u32 s35, s35, 2097152
    s_mov_b32 s40, 4096
    v_lshlrev_b32 v14, 5, v1
    v_lshrrev_b32 v8, 3, v1
    v_mul_u32_u24 v8, 24, v8
    v_mov_b32 v4, 768
    v_mad_u32_u24 v8, v15, v4, v8
    v_lshrrev_b32 v4, 3, v1
    v_lshlrev_b32 v104, 7, v15
    v_lshl_add_u32 v104, v4, 4, v104
    s_mov_b32 s34, 6
L_prep:
    s_nop 1
    s_lshl_b32 s62, s61, 5
    s_add_u32 s62, s62, s3
    s_lshl_b32 s63, s62, 15
    s_add_u32 s63, s63, 1
    s_mul_hi_u32 s63, s63, 0xaaaaaaab
    s_lshr_b32 s63, s63, 7
    s_mov_b32 s32, s84
    s_mov_b32 s39, s87
    s_mov_b32 s84, s85
    s_mov_b32 s85, s86
    s_mov_b32 s87, s88
    s_mov_b32 s88, s89
    s_lshl_b32 s33, s61, 3
    s_add_u32 s33, s33, 1
    s_and_b32 s48, s39, 7
    v_mov_b32 v9, s48
    s_bitcmp1_b32 s39, 3
    s_cselect_b64 vcc, -1, 0
    v_cndmask_b32 v9, v9, v15, vcc
    v_xor_b32 v13, s5, v9
    v_lshl_or_b32 v13, v3, 3, v13
    s_lshl_b32 s36, s62, 6
    s_mul_i32 s49, s62, 768
    s_lshl_b32 s50, s63, 2
    s_sub_u32 s49, s49, s50
    s_add_u32 s49, s49, 1179648
    s_add_u32 s33, s33, 4
    s_mov_b32 s60, 0x100000
L_wga:
    s_nop 1
    ds_read_b32 v10, v2 offset:60
    s_sub_u32 s60, s60, 1
    s_cbranch_scc1 L_exit1
    s_waitcnt lgkmcnt(0)
    v_readfirstlane_b32 s48, v10
    s_cmp_lt_u32 s48, s33
    s_cbranch_scc1 L_wga
    v_xor_b32 v4, 0, v12
    v_bfe_u32 v5, v4, 3, 2
    v_and_or_b32 v5, v4, 4, v5
    v_xor_b32 v5, v13, v5
    v_add_u32 v4, s36, v4
    v_lshl_add_u32 v6, v4, 5, v5
    v_lshl_add_u32 v6, v6, 4, 1
    v_mul_hi_u32 v6, v6, s38
    v_lshrrev_b32 v6, 1, v6
    v_lshrrev_b32 v22, 6, v6
    v_lshl_add_u32 v22, v22, 2, s49
    v_and_b32 v7, 15, v6
    v_cmp_eq_u32 s[24:25], 5, v7
    v_and_b32 v23, 1, v6
    v_lshlrev_b32 v23, 4, v23
    s_waitcnt vmcnt(0)
    v_xor_b32 v4, 8, v12
    v_bfe_u32 v5, v4, 3, 2
    v_and_or_b32 v5, v4, 4, v5
    v_xor_b32 v5, v13, v5
    v_add_u32 v4, s36, v4
    v_lshl_add_u32 v6, v4, 5, v5
    v_lshl_add_u32 v6, v6, 4, 1
    v_mul_hi_u32 v6, v6, s38
    v_lshrrev_b32 v6, 1, v6
    v_lshrrev_b32 v38, 6, v6
    v_lshl_add_u32 v38, v38, 2, s49
    v_and_b32 v7, 15, v6
    v_cmp_eq_u32 s[26:27], 5, v7
    v_and_b32 v39, 1, v6
    v_lshlrev_b32 v39, 4, v39
    s_waitcnt vmcnt(0)
    v_xor_b32 v4, 32, v12
    v_bfe_u32 v5, v4, 3, 2
    v_and_or_b32 v5, v4, 4, v5
    v_xor_b32 v5, v13, v5
    v_add_u32 v4, s36, v4
    v_lshl_add_u32 v6, v4, 5, v5
    v_lshl_add_u32 v6, v6, 4, 1
    v_mul_hi_u32 v6, v6, s38
    v_lshrrev_b32 v6, 1, v6
    v_lshrrev_b32 v54, 6, v6
    v_lshl_add_u32 v54, v54, 2, s49
    v_and_b32 v7, 15, v6
    v_cmp_eq_u32 s[28:29], 5, v7
    v_and_b32 v55, 1, v6
    v_lshlrev_b32 v55, 4, v55
    s_waitcnt vmcnt(0)
    v_xor_b32 v4, 40, v12
    v_bfe_u32 v5, v4, 3, 2
    v_and_or_b32 v5, v4, 4, v5
    v_xor_b32 v5, v13, v5
    v_add_u32 v4, s36, v4
    v_lshl_add_u32 v6, v4, 5, v5
    v_lshl_add_u32 v6, v6, 4, 1
    v_mul_hi_u32 v6, v6, s38
    v_lshrrev_b32 v6, 1, v6
    v_lshrrev_b32 v70, 6, v6
    v_lshl_add_u32 v70, v70, 2, s49
    v_and_b32 v7, 15, v6
    v_cmp_eq_u32 s[30:31], 5, v7
    v_and_b32 v71, 1, v6
    v_lshlrev_b32 v71, 4, v71
    s_waitcnt vmcnt(0)
    s_add_u32 s33, s61, 1
    s_mov_b32 s60, 0x100000
L_wfd:
    s_nop 1
    ds_read_b32 v10, v2 offset:52
    s_sub_u32 s60, s60, 1
    s_cbranch_scc1 L_exit1
    s_waitcnt lgkmcnt(0)
    v_readfirstlane_b32 s48, v10
    s_cmp_lt_u32 s48, s33
    s_cbranch_scc1 L_wfd
    v_mul_u32_u24 v4, 4352, v1
    s_xor_b32 s48, s32, s39
    s_xor_b32 s48, s48, s5
    s_and_b32 s48, s48, 7
    v_mov_b32 v6, s33
    s_lshl_b64 vcc, 1, s48
    s_or_b32 s48, s32, s39
    s_bitcmp1_b32 s48, 3
    s_cselect_b64 vcc, 0xff, vcc
    s_cmp_eq_u32 s32, s39
    s_cselect_b64 vcc, 0, vcc
    s_max_u32 s48, s61, 1
    v_mov_b32 v7, s48
    v_cndmask_b32 v6, v7, v6, vcc
    s_cmp_ge_u32 s61, 1
    s_cselect_b64 exec, vcc, 0xff
    s_mov_b32 s60, 0x40000
    s_cbranch_execz L_noflags
L_flags:
    s_nop 1
    buffer_load_dword v5, v4, s[12:15], s59 offen sc1
    s_sub_u32 s60, s60, 1
    s_cbranch_scc1 L_exit1
    s_waitcnt vmcnt(0)
    v_cmpx_gt_u32 vcc, v6, v5
    s_cbranch_execnz L_flags
L_noflags:
    s_nop 1
    s_mov_b64 exec, -1
    buffer_load_dword v22, v22, s[12:15], 0 offen sc1
    buffer_load_dword v38, v38, s[12:15], 0 offen sc1
    buffer_load_dword v54, v54, s[12:15], 0 offen sc1
    buffer_load_dword v70, v70, s[12:15], 0 offen sc1
    s_bitcmp1_b32 s39, 3
    s_cselect_b32 s49, 0, 7
    s_xor_b32 s50, s32, s39
    s_bitcmp1_b32 s50, 3
    s_cselect_b32 s51, 7, 0
    s_and_b32 s50, s50, 7
    s_and_b32 s52, s39, 7
    v_lshrrev_b32 v4, 3, v1
    v_cmp_gt_u32 vcc, s34, v4
    v_and_b32 v6, s51, v15
    v_xor_b32 v6, s50, v6
    v_and_b32 v5, s49, v15
    v_xor_b32 v5, s52, v5
    v_cndmask_b32 v5, v6, v5, vcc
    v_cmp_ne_u32 s[64:65], 0, v5
    v_xor_b32 v5, s5, v5
    v_mad_u32_u24 v5, v5, s40, v104
    v_cmp_ne_u32 s[66:67], 0, v6
    v_xor_b32 v6, s5, v6
    v_mad_u32_u24 v6, v6, s40, v104
    s_mov_b64 exec, s[64:65]
    buffer_load_dwordx4 v[80:83], v5, s[12:15], s35 offen offset:0 sc1
    s_mov_b64 exec, s[66:67]
    buffer_load_dwordx4 v[84:87], v6, s[12:15], s35 offen offset:1024 sc1
    buffer_load_dwordx4 v[88:91], v6, s[12:15], s35 offen offset:2048 sc1
    buffer_load_dwordx4 v[92:95], v6, s[12:15], s35 offen offset:3072 sc1
    s_mov_b64 exec, -1
    v_xor_b32 v4, 0, v12
    v_bfe_u32 v5, v4, 3, 2
    v_and_or_b32 v5, v4, 4, v5
    v_xor_b32 v5, v13, v5
    v_add_u32 v4, s36, v4
    v_lshl_add_u32 v6, v4, 5, v5
    v_lshl_add_u32 v6, v6, 4, 1
    v_mul_hi_u32 v6, v6, s38
    v_lshrrev_b32 v6, 1, v6
    v_lshrrev_b32 v11, 1, v6
    v_lshlrev_b32 v11, 2, v11
    s_memrealtime s[42:43]
    s_waitcnt lgkmcnt(0)
L_tw1:
    s_nop 1
    s_memrealtime s[44:45]
    s_waitcnt lgkmcnt(0)
    s_sub_u32 s45, s44, s42
    s_cmp_lt_i32 s45, 0
    s_cbranch_scc1 L_tw1
    s_add_u32 s42, s44, 140
    s_mov_b32 exec_lo, 0xffffffff
    s_mov_b32 exec_hi, 0x0
    buffer_load_dwordx3 v[24:26], v11, s[92:95], 0 offen
    buffer_load_dword v27, v11, s[92:95], 0 offen offset:12
L_tw2:
    s_nop 1
    s_memrealtime s[44:45]
    s_waitcnt lgkmcnt(0)
    s_sub_u32 s45, s44, s42
    s_cmp_lt_i32 s45, 0
    s_cbranch_scc1 L_tw2
    s_add_u32 s42, s44, 140
    s_mov_b32 exec_lo, 0x0
    s_mov_b32 exec_hi, 0xffffffff
    buffer_load_dwordx3 v[24:26], v11, s[92:95], 0 offen
    buffer_load_dword v27, v11, s[92:95], 0 offen offset:12
    s_mov_b64 exec, -1
L_tw3:
    s_nop 1
    s_memrealtime s[44:45]
    s_waitcnt lgkmcnt(0)
    s_sub_u32 s45, s44, s42
    s_cmp_lt_i32 s45, 0
    s_cbranch_scc1 L_tw3
    s_add_u32 s42, s44, 140
    s_mov_b32 exec_lo, 0xffffffff
    s_mov_b32 exec_hi, 0x0
    buffer_load_dwordx3 v[28:30], v11, s[96:99], 0 offen
    buffer_load_dword v31, v11, s[96:99], 0 offen offset:12
L_tw4:
    s_nop 1
    s_memrealtime s[44:45]
    s_waitcnt lgkmcnt(0)
    s_sub_u32 s45, s44, s42
    s_cmp_lt_i32 s45, 0
    s_cbranch_scc1 L_tw4
    s_add_u32 s42, s44, 140
    s_mov_b32 exec_lo, 0x0
    s_mov_b32 exec_hi, 0xffffffff
    buffer_load_dwordx3 v[28:30], v11, s[96:99], 0 offen
    buffer_load_dword v31, v11, s[96:99], 0 offen offset:12
    s_mov_b64 exec, -1
    v_xor_b32 v4, 8, v12
    v_bfe_u32 v5, v4, 3, 2
    v_and_or_b32 v5, v4, 4, v5
    v_xor_b32 v5, v13, v5
    v_add_u32 v4, s36, v4
    v_lshl_add_u32 v6, v4, 5, v5
    v_lshl_add_u32 v6, v6, 4, 1
    v_mul_hi_u32 v6, v6, s38
    v_lshrrev_b32 v6, 1, v6
    v_lshrrev_b32 v11, 1, v6
    v_lshlrev_b32 v11, 2, v11
L_tw5:
    s_nop 1
    s_memrealtime s[44:45]
    s_waitcnt lgkmcnt(0)
    s_sub_u32 s45, s44, s42
    s_cmp_lt_i32 s45, 0
    s_cbranch_scc1 L_tw5
    s_add_u32 s42, s44, 140
    s_mov_b32 exec_lo, 0xffffffff
    s_mov_b32 exec_hi, 0x0
    buffer_load_dwordx3 v[40:42], v11, s[92:95], 0 offen
    buffer_load_dword v43, v11, s[92:95], 0 offen offset:12
L_tw6:
    s_nop 1
    s_memrealtime s[44:45]
    s_waitcnt lgkmcnt(0)
    s_sub_u32 s45, s44, s42
    s_cmp_lt_i32 s45, 0
    s_cbranch_scc1 L_tw6
    s_add_u32 s42, s44, 140
    s_mov_b32 exec_lo, 0x0
    s_mov_b32 exec_hi, 0xffffffff
    buffer_load_dwordx3 v[40:42], v11, s[92:95], 0 offen
    buffer_load_dword v43, v11, s[92:95], 0 offen offset:12
    s_mov_b64 exec, -1
L_tw7:
    s_nop 1
    s_memrealtime s[44:45]
    s_waitcnt lgkmcnt(0)
    s_sub_u32 s45, s44, s42
    s_cmp_lt_i32 s45, 0
    s_cbranch_scc1 L_tw7
    s_add_u32 s42, s44, 140
    s_mov_b32 exec_lo, 0xffffffff
    s_mov_b32 exec_hi, 0x0
    buffer_load_dwordx3 v[44:46], v11, s[96:99], 0 offen
    buffer_load_dword v47, v11, s[96:99], 0 offen offset:12
L_tw8:
    s_nop 1
    s_memrealtime s[44:45]
    s_waitcnt lgkmcnt(0)
    s_sub_u32 s45, s44, s42
    s_cmp_lt_i32 s45, 0
    s_cbranch_scc1 L_tw8
    s_add_u32 s42, s44, 140
    s_mov_b32 exec_lo, 0x0
    s_mov_b32 exec_hi, 0xffffffff
    buffer_load_dwordx3 v[44:46], v11, s[96:99], 0 offen
    buffer_load_dword v47, v11, s[96:99], 0 offen offset:12
    s_mov_b64 exec, -1
    v_xor_b32 v4, 32, v12
    v_bfe_u32 v5, v4, 3, 2
    v_and_or_b32 v5, v4, 4, v5
    v_xor_b32 v5, v13, v5
    v_add_u32 v4, s36, v4
    v_lshl_add_u32 v6, v4, 5, v5
    v_lshl_add_u32 v6, v6, 4, 1
    v_mul_hi_u32 v6, v6, s38
    v_lshrrev_b32 v6, 1, v6
    v_lshrrev_b32 v11, 1, v6
    v_lshlrev_b32 v11, 2, v11
L_tw9:
    s_nop 1
    s_memrealtime s[44:45]
    s_waitcnt lgkmcnt(0)
    s_sub_u32 s45, s44, s42
    s_cmp_lt_i32 s45, 0
    s_cbranch_scc1 L_tw9
    s_add_u32 s42, s44, 140
    s_mov_b32 exec_lo, 0xffffffff
    s_mov_b32 exec_hi, 0x0
    buffer_load_dwordx3 v[56:58], v11, s[92:95], 0 offen
    buffer_load_dword v59, v11, s[92:95], 0 offen offset:12
L_tw10:
    s_nop 1
    s_memrealtime s[44:45]
    s_waitcnt lgkmcnt(0)
    s_sub_u32 s45, s44, s42
    s_cmp_lt_i32 s45, 0
    s_cbranch_scc1 L_tw10
    s_add_u32 s42, s44, 140
    s_mov_b32 exec_lo, 0x0
    s_mov_b32 exec_hi, 0xffffffff
    buffer_load_dwordx3 v[56:58], v11, s[92:95], 0 offen
    buffer_load_dword v59, v11, s[92:95], 0 offen offset:12
    s_mov_b64 exec, -1
L_tw11:
    s_nop 1
    s_memrealtime s[44:45]
    s_waitcnt lgkmcnt(0)
    s_sub_u32 s45, s44, s42
    s_cmp_lt_i32 s45, 0
    s_cbranch_scc1 L_tw11
    s_add_u32 s42, s44, 140
    s_mov_b32 exec_lo, 0xffffffff
    s_mov_b32 exec_hi, 0x0
    buffer_load_dwordx3 v[60:62], v11, s[96:99], 0 offen
    buffer_load_dword v63, v11, s[96:99], 0 offen offset:12
L_tw12:
    s_nop 1
    s_memrealtime s[44:45]
    s_waitcnt lgkmcnt(0)
    s_sub_u32 s45, s44, s42
    s_cmp_lt_i32 s45, 0
    s_cbranch_scc1 L_tw12
    s_add_u32 s42, s44, 140
    s_mov_b32 exec_lo, 0x0
    s_mov_b32 exec_hi, 0xffffffff
    buffer_load_dwordx3 v[60:62], v11, s[96:99], 0 offen
    buffer_load_dword v63, v11, s[96:99], 0 offen offset:12
    s_mov_b64 exec, -1
    v_xor_b32 v4, 40, v12
    v_bfe_u32 v5, v4, 3, 2
    v_and_or_b32 v5, v4, 4, v5
    v_xor_b32 v5, v13, v5
    v_add_u32 v4, s36, v4
    v_lshl_add_u32 v6, v4, 5, v5
    v_lshl_add_u32 v6, v6, 4, 1
    v_mul_hi_u32 v6, v6, s38
    v_lshrrev_b32 v6, 1, v6
    v_lshrrev_b32 v11, 1, v6
    v_lshlrev_b32 v11, 2, v11
L_tw13:
    s_nop 1
    s_memrealtime s[44:45]
    s_waitcnt lgkmcnt(0)
    s_sub_u32 s45, s44, s42
    s_cmp_lt_i32 s45, 0
    s_cbranch_scc1 L_tw13
    s_add_u32 s42, s44, 140
    s_mov_b32 exec_lo, 0xffffffff
    s_mov_b32 exec_hi, 0x0
    buffer_load_dwordx3 v[72:74], v11, s[92:95], 0 offen
    buffer_load_dword v75, v11, s[92:95], 0 offen offset:12
L_tw14:
    s_nop 1
    s_memrealtime s[44:45]
    s_waitcnt lgkmcnt(0)
    s_sub_u32 s45, s44, s42
    s_cmp_lt_i32 s45, 0
    s_cbranch_scc1 L_tw14
    s_add_u32 s42, s44, 140
    s_mov_b32 exec_lo, 0x0
    s_mov_b32 exec_hi, 0xffffffff
    buffer_load_dwordx3 v[72:74], v11, s[92:95], 0 offen
    buffer_load_dword v75, v11, s[92:95], 0 offen offset:12
    s_mov_b64 exec, -1
L_tw15:
    s_nop 1
    s_memrealtime s[44:45]
    s_waitcnt lgkmcnt(0)
    s_sub_u32 s45, s44, s42
    s_cmp_lt_i32 s45, 0
    s_cbranch_scc1 L_tw15
    s_add_u32 s42, s44, 140
    s_mov_b32 exec_lo, 0xffffffff
    s_mov_b32 exec_hi, 0x0
    buffer_load_dwordx3 v[76:78], v11, s[96:99], 0 offen
    buffer_load_dword v79, v11, s[96:99], 0 offen offset:12
L_tw16:
    s_nop 1
    s_memrealtime s[44:45]
    s_waitcnt lgkmcnt(0)
    s_sub_u32 s45, s44, s42
    s_cmp_lt_i32 s45, 0
    s_cbranch_scc1 L_tw16
    s_add_u32 s42, s44, 140
    s_mov_b32 exec_lo, 0x0
    s_mov_b32 exec_hi, 0xffffffff
    buffer_load_dwordx3 v[76:78], v11, s[96:99], 0 offen
    buffer_load_dword v79, v11, s[96:99], 0 offen offset:12
    s_mov_b64 exec, -1
    ds_read_b64 v[16:17], v8 offset:256
    ds_read_b64 v[18:19], v8 offset:264
    ds_read_b64 v[20:21], v8 offset:272
    ds_read_b64 v[32:33], v8 offset:448
    ds_read_b64 v[34:35], v8 offset:456
    ds_read_b64 v[36:37], v8 offset:464
    ds_read_b64 v[48:49], v8 offset:640
    ds_read_b64 v[50:51], v8 offset:648
    ds_read_b64 v[52:53], v8 offset:656
    ds_read_b64 v[64:65], v8 offset:832
    ds_read_b64 v[66:67], v8 offset:840
    ds_read_b64 v[68:69], v8 offset:848
    s_mov_b32 s34, 0
    v_mov_b32 v5, 0xf149f2ca
    v_mov_b32 v4, 0xf149f2ca
    s_waitcnt vmcnt(0) lgkmcnt(0)
    s_mov_b64 exec, s[64:65]
    v_fma_mix_f32 v16, v81, 1.0, v80 op_sel:[0,0,0] op_sel_hi:[1,0,0]
    v_fma_mix_f32 v17, v81, 1.0, v80 op_sel:[1,0,0] op_sel_hi:[1,0,0]
    v_fma_mix_f32 v18, v82, 1.0, v80 op_sel:[0,0,0] op_sel_hi:[1,0,0]
    v_fma_mix_f32 v19, v82, 1.0, v80 op_sel:[1,0,0] op_sel_hi:[1,0,0]
    v_fma_mix_f32 v20, v83, 1.0, v80 op_sel:[0,0,0] op_sel_hi:[1,0,0]
    v_fma_mix_f32 v21, v83, 1.0, v80 op_sel:[1,0,0] op_sel_hi:[1,0,0]
    v_cmp_lt_f32 vcc, v80, v21
    s_nop 1
    v_cndmask_b32 v21, v21, v2, vcc
    s_mov_b64 exec, s[66:67]
    v_fma_mix_f32 v32, v85, 1.0, v84 op_sel:[0,0,0] op_sel_hi:[1,0,0]
    v_fma_mix_f32 v33, v85, 1.0, v84 op_sel:[1,0,0] op_sel_hi:[1,0,0]
    v_fma_mix_f32 v34, v86, 1.0, v84 op_sel:[0,0,0] op_sel_hi:[1,0,0]
    v_fma_mix_f32 v35, v86, 1.0, v84 op_sel:[1,0,0] op_sel_hi:[1,0,0]
    v_fma_mix_f32 v36, v87, 1.0, v84 op_sel:[0,0,0] op_sel_hi:[1,0,0]
    v_fma_mix_f32 v37, v87, 1.0, v84 op_sel:[1,0,0] op_sel_hi:[1,0,0]
    v_cmp_lt_f32 vcc, v84, v37
    s_nop 1
    v_cndmask_b32 v37, v37, v2, vcc
    v_fma_mix_f32 v48, v89, 1.0, v88 op_sel:[0,0,0] op_sel_hi:[1,0,0]
    v_fma_mix_f32 v49, v89, 1.0, v88 op_sel:[1,0,0] op_sel_hi:[1,0,0]
    v_fma_mix_f32 v50, v90, 1.0, v88 op_sel:[0,0,0] op_sel_hi:[1,0,0]
    v_fma_mix_f32 v51, v90, 1.0, v88 op_sel:[1,0,0] op_sel_hi:[1,0,0]
    v_fma_mix_f32 v52, v91, 1.0, v88 op_sel:[0,0,0] op_sel_hi:[1,0,0]
    v_fma_mix_f32 v53, v91, 1.0, v88 op_sel:[1,0,0] op_sel_hi:[1,0,0]
    v_cmp_lt_f32 vcc, v88, v53
    s_nop 1
    v_cndmask_b32 v53, v53, v2, vcc
    v_fma_mix_f32 v64, v93, 1.0, v92 op_sel:[0,0,0] op_sel_hi:[1,0,0]
    v_fma_mix_f32 v65, v93, 1.0, v92 op_sel:[1,0,0] op_sel_hi:[1,0,0]
    v_fma_mix_f32 v66, v94, 1.0, v92 op_sel:[0,0,0] op_sel_hi:[1,0,0]
    v_fma_mix_f32 v67, v94, 1.0, v92 op_sel:[1,0,0] op_sel_hi:[1,0,0]
    v_fma_mix_f32 v68, v95, 1.0, v92 op_sel:[0,0,0] op_sel_hi:[1,0,0]
    v_fma_mix_f32 v69, v95, 1.0, v92 op_sel:[1,0,0] op_sel_hi:[1,0,0]
    v_cmp_lt_f32 vcc, v92, v69
    s_nop 1
    v_cndmask_b32 v69, v69, v2, vcc
    s_mov_b64 exec, -1
    v_sub_f32 v16, v16, v22
    v_sub_f32 v17, v17, v22
    v_sub_f32 v18, v18, v22
    v_sub_f32 v19, v19, v22
    v_sub_f32 v20, v20, v22
    v_sub_f32 v21, v21, v22
    v_mul_f32 v16, s37, v16
    v_mul_f32 v17, s37, v17
    v_mul_f32 v18, s37, v18
    v_mul_f32 v19, s37, v19
    v_mul_f32 v20, s37, v20
    v_mul_f32 v21, s37, v21
    v_cndmask_b32 v21, v5, v21, s[24:25]
    v_max3_f32 v4, v4, v16, v17
    v_max3_f32 v4, v4, v18, v19
    v_max3_f32 v4, v4, v20, v21
    v_alignbit_b32 v24, v25, v24, v23
    v_alignbit_b32 v25, v26, v25, v23
    v_alignbit_b32 v26, v27, v26, v23
    v_alignbit_b32 v28, v29, v28, v23
    v_alignbit_b32 v29, v30, v29, v23
    v_alignbit_b32 v30, v31, v30, v23
    v_sub_f32 v32, v32, v38
    v_sub_f32 v33, v33, v38
    v_sub_f32 v34, v34, v38
    v_sub_f32 v35, v35, v38
    v_sub_f32 v36, v36, v38
    v_sub_f32 v37, v37, v38
    v_mul_f32 v32, s37, v32
    v_mul_f32 v33, s37, v33
    v_mul_f32 v34, s37, v34
    v_mul_f32 v35, s37, v35
    v_mul_f32 v36, s37, v36
    v_mul_f32 v37, s37, v37
    v_cndmask_b32 v37, v5, v37, s[26:27]
    v_max3_f32 v4, v4, v32, v33
    v_max3_f32 v4, v4, v34, v35
    v_max3_f32 v4, v4, v36, v37
    v_alignbit_b32 v40, v41, v40, v39
    v_alignbit_b32 v41, v42, v41, v39
    v_alignbit_b32 v42, v43, v42, v39
    v_alignbit_b32 v44, v45, v44, v39
    v_alignbit_b32 v45, v46, v45, v39
    v_alignbit_b32 v46, v47, v46, v39
    v_sub_f32 v48, v48, v54
    v_sub_f32 v49, v49, v54
    v_sub_f32 v50, v50, v54
    v_sub_f32 v51, v51, v54
    v_sub_f32 v52, v52, v54
    v_sub_f32 v53, v53, v54
    v_mul_f32 v48, s37, v48
    v_mul_f32 v49, s37, v49
    v_mul_f32 v50, s37, v50
    v_mul_f32 v51, s37, v51
    v_mul_f32 v52, s37, v52
    v_mul_f32 v53, s37, v53
    v_cndmask_b32 v53, v5, v53, s[28:29]
    v_max3_f32 v4, v4, v48, v49
    v_max3_f32 v4, v4, v50, v51
    v_max3_f32 v4, v4, v52, v53
    v_alignbit_b32 v56, v57, v56, v55
    v_alignbit_b32 v57, v58, v57, v55
    v_alignbit_b32 v58, v59, v58, v55
    v_alignbit_b32 v60, v61, v60, v55
    v_alignbit_b32 v61, v62, v61, v55
    v_alignbit_b32 v62, v63, v62, v55
    v_sub_f32 v64, v64, v70
    v_sub_f32 v65, v65, v70
    v_sub_f32 v66, v66, v70
    v_sub_f32 v67, v67, v70
    v_sub_f32 v68, v68, v70
    v_sub_f32 v69, v69, v70
    v_mul_f32 v64, s37, v64
    v_mul_f32 v65, s37, v65
    v_mul_f32 v66, s37, v66
    v_mul_f32 v67, s37, v67
    v_mul_f32 v68, s37, v68
    v_mul_f32 v69, s37, v69
    v_cndmask_b32 v69, v5, v69, s[30:31]
    v_max3_f32 v4, v4, v64, v65
    v_max3_f32 v4, v4, v66, v67
    v_max3_f32 v4, v4, v68, v69
    v_alignbit_b32 v72, v73, v72, v71
    v_alignbit_b32 v73, v74, v73, v71
    v_alignbit_b32 v74, v75, v74, v71
    v_alignbit_b32 v76, v77, v76, v71
    v_alignbit_b32 v77, v78, v77, v71
    v_alignbit_b32 v78, v79, v78, v71
    v_max_f32_dpp v4, v4, v4 row_ror:8 row_mask:0xf bank_mask:0xf
    s_nop 1
    v_max_f32_dpp v4, v4, v4 row_ror:4 row_mask:0xf bank_mask:0xf
    s_nop 1
    v_max_f32_dpp v4, v4, v4 row_ror:2 row_mask:0xf bank_mask:0xf
    s_nop 1
    v_max_f32_dpp v4, v4, v4 row_ror:1 row_mask:0xf bank_mask:0xf
    v_mov_b32 v5, v4
    s_nop 1
    v_permlane32_swap_b32 v4, v5
    v_max_f32 v4, v4, v5
    v_mov_b32 v5, v4
    s_nop 1
    v_permlane16_swap_b32 v4, v5
    v_max_f32 v4, v4, v5
    v_mov_b32 v5, 0
    v_mov_b32 v6, 0
    v_sub_f32 v16, v16, v4
    v_sub_f32 v17, v17, v4
    v_sub_f32 v18, v18, v4
    v_sub_f32 v19, v19, v4
    v_sub_f32 v20, v20, v4
    v_sub_f32 v21, v21, v4
    v_exp_f32 v16, v16
    v_exp_f32 v17, v17
    v_exp_f32 v18, v18
    v_exp_f32 v19, v19
    v_exp_f32 v20, v20
    v_exp_f32 v21, v21
    v_add_f32 v5, v5, v16
    v_lshlrev_b32 v10, 16, v24
    v_lshlrev_b32 v11, 16, v28
    v_mul_f32 v16, v16, v10
    v_fmac_f32 v6, v16, v11
    v_add_f32 v5, v5, v17
    v_and_b32 v10, 0xffff0000, v24
    v_and_b32 v11, 0xffff0000, v28
    v_mul_f32 v17, v17, v10
    v_fmac_f32 v6, v17, v11
    v_add_f32 v5, v5, v18
    v_lshlrev_b32 v10, 16, v25
    v_lshlrev_b32 v11, 16, v29
    v_mul_f32 v18, v18, v10
    v_fmac_f32 v6, v18, v11
    v_add_f32 v5, v5, v19
    v_and_b32 v10, 0xffff0000, v25
    v_and_b32 v11, 0xffff0000, v29
    v_mul_f32 v19, v19, v10
    v_fmac_f32 v6, v19, v11
    v_add_f32 v5, v5, v20
    v_lshlrev_b32 v10, 16, v26
    v_lshlrev_b32 v11, 16, v30
    v_mul_f32 v20, v20, v10
    v_fmac_f32 v6, v20, v11
    v_add_f32 v5, v5, v21
    v_and_b32 v10, 0xffff0000, v26
    v_and_b32 v11, 0xffff0000, v30
    v_mul_f32 v21, v21, v10
    v_fmac_f32 v6, v21, v11
    ds_write_b128 v14, v[16:19] offset:18688
    ds_write_b64 v14, v[20:21] offset:18704
    v_sub_f32 v32, v32, v4
    v_sub_f32 v33, v33, v4
    v_sub_f32 v34, v34, v4
    v_sub_f32 v35, v35, v4
    v_sub_f32 v36, v36, v4
    v_sub_f32 v37, v37, v4
    v_exp_f32 v32, v32
    v_exp_f32 v33, v33
    v_exp_f32 v34, v34
    v_exp_f32 v35, v35
    v_exp_f32 v36, v36
    v_exp_f32 v37, v37
    v_add_f32 v5, v5, v32
    v_lshlrev_b32 v10, 16, v40
    v_lshlrev_b32 v11, 16, v44
    v_mul_f32 v32, v32, v10
    v_fmac_f32 v6, v32, v11
    v_add_f32 v5, v5, v33
    v_and_b32 v10, 0xffff0000, v40
    v_and_b32 v11, 0xffff0000, v44
    v_mul_f32 v33, v33, v10
    v_fmac_f32 v6, v33, v11
    v_add_f32 v5, v5, v34
    v_lshlrev_b32 v10, 16, v41
    v_lshlrev_b32 v11, 16, v45
    v_mul_f32 v34, v34, v10
    v_fmac_f32 v6, v34, v11
    v_add_f32 v5, v5, v35
    v_and_b32 v10, 0xffff0000, v41
    v_and_b32 v11, 0xffff0000, v45
    v_mul_f32 v35, v35, v10
    v_fmac_f32 v6, v35, v11
    v_add_f32 v5, v5, v36
    v_lshlrev_b32 v10, 16, v42
    v_lshlrev_b32 v11, 16, v46
    v_mul_f32 v36, v36, v10
    v_fmac_f32 v6, v36, v11
    v_add_f32 v5, v5, v37
    v_and_b32 v10, 0xffff0000, v42
    v_and_b32 v11, 0xffff0000, v46
    v_mul_f32 v37, v37, v10
    v_fmac_f32 v6, v37, v11
    ds_write_b128 v14, v[32:35] offset:20736
    ds_write_b64 v14, v[36:37] offset:20752
    v_sub_f32 v48, v48, v4
    v_sub_f32 v49, v49, v4
    v_sub_f32 v50, v50, v4
    v_sub_f32 v51, v51, v4
    v_sub_f32 v52, v52, v4
    v_sub_f32 v53, v53, v4
    v_exp_f32 v48, v48
    v_exp_f32 v49, v49
    v_exp_f32 v50, v50
    v_exp_f32 v51, v51
    v_exp_f32 v52, v52
    v_exp_f32 v53, v53
    v_add_f32 v5, v5, v48
    v_lshlrev_b32 v10, 16, v56
    v_lshlrev_b32 v11, 16, v60
    v_mul_f32 v48, v48, v10
    v_fmac_f32 v6, v48, v11
    v_add_f32 v5, v5, v49
    v_and_b32 v10, 0xffff0000, v56
    v_and_b32 v11, 0xffff0000, v60
    v_mul_f32 v49, v49, v10
    v_fmac_f32 v6, v49, v11
    v_add_f32 v5, v5, v50
    v_lshlrev_b32 v10, 16, v57
    v_lshlrev_b32 v11, 16, v61
    v_mul_f32 v50, v50, v10
    v_fmac_f32 v6, v50, v11
    v_add_f32 v5, v5, v51
    v_and_b32 v10, 0xffff0000, v57
    v_and_b32 v11, 0xffff0000, v61
    v_mul_f32 v51, v51, v10
    v_fmac_f32 v6, v51, v11
    v_add_f32 v5, v5, v52
    v_lshlrev_b32 v10, 16, v58
    v_lshlrev_b32 v11, 16, v62
    v_mul_f32 v52, v52, v10
    v_fmac_f32 v6, v52, v11
    v_add_f32 v5, v5, v53
    v_and_b32 v10, 0xffff0000, v58
    v_and_b32 v11, 0xffff0000, v62
    v_mul_f32 v53, v53, v10
    v_fmac_f32 v6, v53, v11
    ds_write_b128 v14, v[48:51] offset:22784
    ds_write_b64 v14, v[52:53] offset:22800
    v_sub_f32 v64, v64, v4
    v_sub_f32 v65, v65, v4
    v_sub_f32 v66, v66, v4
    v_sub_f32 v67, v67, v4
    v_sub_f32 v68, v68, v4
    v_sub_f32 v69, v69, v4
    v_exp_f32 v64, v64
    v_exp_f32 v65, v65
    v_exp_f32 v66, v66
    v_exp_f32 v67, v67
    v_exp_f32 v68, v68
    v_exp_f32 v69, v69
    v_add_f32 v5, v5, v64
    v_lshlrev_b32 v10, 16, v72
    v_lshlrev_b32 v11, 16, v76
    v_mul_f32 v64, v64, v10
    v_fmac_f32 v6, v64, v11
    v_add_f32 v5, v5, v65
    v_and_b32 v10, 0xffff0000, v72
    v_and_b32 v11, 0xffff0000, v76
    v_mul_f32 v65, v65, v10
    v_fmac_f32 v6, v65, v11
    v_add_f32 v5, v5, v66
    v_lshlrev_b32 v10, 16, v73
    v_lshlrev_b32 v11, 16, v77
    v_mul_f32 v66, v66, v10
    v_fmac_f32 v6, v66, v11
    v_add_f32 v5, v5, v67
    v_and_b32 v10, 0xffff0000, v73
    v_and_b32 v11, 0xffff0000, v77
    v_mul_f32 v67, v67, v10
    v_fmac_f32 v6, v67, v11
    v_add_f32 v5, v5, v68
    v_lshlrev_b32 v10, 16, v74
    v_lshlrev_b32 v11, 16, v78
    v_mul_f32 v68, v68, v10
    v_fmac_f32 v6, v68, v11
    v_add_f32 v5, v5, v69
    v_and_b32 v10, 0xffff0000, v74
    v_and_b32 v11, 0xffff0000, v78
    v_mul_f32 v69, v69, v10
    v_fmac_f32 v6, v69, v11
    ds_write_b128 v14, v[64:67] offset:24832
    ds_write_b64 v14, v[68:69] offset:24848
    v_add_f32_dpp v5, v5, v5 row_ror:8 row_mask:0xf bank_mask:0xf
    v_add_f32_dpp v6, v6, v6 row_ror:8 row_mask:0xf bank_mask:0xf
    s_nop 0
    v_add_f32_dpp v5, v5, v5 row_ror:4 row_mask:0xf bank_mask:0xf
    v_add_f32_dpp v6, v6, v6 row_ror:4 row_mask:0xf bank_mask:0xf
    s_nop 0
    v_add_f32_dpp v5, v5, v5 row_ror:2 row_mask:0xf bank_mask:0xf
    v_add_f32_dpp v6, v6, v6 row_ror:2 row_mask:0xf bank_mask:0xf
    s_nop 0
    v_add_f32_dpp v5, v5, v5 row_ror:1 row_mask:0xf bank_mask:0xf
    v_add_f32_dpp v6, v6, v6 row_ror:1 row_mask:0xf bank_mask:0xf
    v_mov_b32 v10, v5
    v_mov_b32 v11, v6
    s_nop 0
    v_permlane32_swap_b32 v5, v10
    v_permlane32_swap_b32 v6, v11
    v_add_f32 v5, v5, v10
    v_add_f32 v6, v6, v11
    v_mov_b32 v10, v5
    v_mov_b32 v11, v6
    s_nop 0
    v_permlane16_swap_b32 v5, v10
    v_permlane16_swap_b32 v6, v11
    v_add_f32 v5, v5, v10
    v_add_f32 v6, v6, v11
    s_lshl_b32 s48, s61, 2
    v_mov_b32 v10, s48
    v_lshlrev_b32 v11, 2, v10
    v_mov_b32 v7, s39
    s_mov_b64 exec, 1
    ds_write_b128 v11, v[4:7] offset:80
    ds_write_b32 v10, v7 offset:24
    s_lshl_b32 s48, s61, 8
    s_add_u32 s48, s48, s2
    s_lshl_b32 s48, s48, 6
    s_add_u32 s48, s48, 917504
    buffer_store_dwordx4 v[4:7], off, s[12:15], s48 sc1
    s_mov_b64 exec, -1
    v_add_u32 v14, 8192, v14
    v_add_u32 v8, 6144, v8
    s_add_u32 s35, s35, 1048576
    s_add_u32 s61, s61, 1
    s_cmp_lt_u32 s61, 3
    s_cbranch_scc1 L_prep
    s_mov_b32 s61, 0
    v_lshlrev_b32 v12, 2, v1
    v_add_u32 v13, 43264, v12
    v_lshlrev_b32 v8, 4, v1
    v_mov_b32 v31, 1
L_merge:
    s_nop 1
    s_lshl_b32 s48, s61, 2
    v_mov_b32 v3, s48
    v_lshlrev_b32 v11, 2, v3
    ds_read_b128 v[4:7], v11 offset:80
    s_lshl_b32 s62, s61, 8
    s_add_u32 s62, s62, s2
    s_lshl_b32 s62, s62, 10
    s_mov_b32 s60, 0x100000
L_wm:
    s_nop 1
    ds_read_b32 v10, v3 offset:64
    s_sub_u32 s60, s60, 1
    s_cbranch_scc1 L_exit1
    s_waitcnt lgkmcnt(0)
    v_readfirstlane_b32 s48, v10
    s_cmp_lt_u32 s48, 4
    s_cbranch_scc1 L_wm
    ds_read_b32 v16, v13 offset:0
    ds_read_b32 v17, v13 offset:768
    ds_read_b32 v18, v13 offset:1536
    ds_read_b32 v19, v13 offset:2304
    ds_read_b32 v20, v13 offset:256
    ds_read_b32 v21, v13 offset:1024
    ds_read_b32 v22, v13 offset:1792
    ds_read_b32 v23, v13 offset:2560
    ds_read_b32 v24, v13 offset:512
    ds_read_b32 v25, v13 offset:1280
    ds_read_b32 v26, v13 offset:2048
    ds_read_b32 v27, v13 offset:2816
    s_waitcnt lgkmcnt(8)
    v_add_f32 v16, v16, v17
    v_add_f32 v18, v18, v19
    v_sub_f32 v16, v16, v6
    v_add_f32 v28, v16, v18
    s_waitcnt lgkmcnt(4)
    v_add_f32 v20, v20, v21
    v_add_f32 v22, v22, v23
    v_sub_f32 v20, v20, v6
    v_add_f32 v29, v20, v22
    s_waitcnt lgkmcnt(0)
    v_add_f32 v24, v24, v25
    v_add_f32 v26, v26, v27
    v_sub_f32 v24, v24, v6
    v_add_f32 v30, v24, v26
    buffer_store_dwordx4 v[28:31], v8, s[12:15], s62 offen sc1
    v_add_u32 v13, 3072, v13
    s_add_u32 s61, s61, 1
    s_cmp_lt_u32 s61, 3
    s_cbranch_scc1 L_merge
    s_endpgm
.section .rodata,"a"
.p2align 6
.amdhsa_kernel standalone__kv_cache_quant_int4_int2_kv_with_per_channel_or_per_token_scales__decode_kernel
  .amdhsa_next_free_vgpr 136
  .amdhsa_next_free_sgpr 102
  .amdhsa_accum_offset 136
  .amdhsa_group_segment_fixed_size 0
  .amdhsa_kernarg_size 80
  .amdhsa_user_sgpr_count 2
  .amdhsa_user_sgpr_kernarg_segment_ptr 1
  .amdhsa_system_sgpr_workgroup_id_x 1
.end_amdhsa_kernel
```
